```python
import torch

def _softmax(x, axis=-1):
    return torch.softmax(x, dim=axis)
def _gelu(x):
    return torch.nn.functional.gelu(x, approximate="tanh")
def _silu(x):
    return torch.nn.functional.silu(x)
def _sigmoid(x):
    return torch.sigmoid(x)
def _layernorm(x, axis=-1, eps=1e-5):
    m = x.mean(dim=axis, keepdim=True)
    v = x.var(dim=axis, keepdim=True, unbiased=False)
    return (x - m) / torch.sqrt(v + eps)
def _scatter_add(tgt, idx, src, axis=0):
    return tgt.clone().index_add_(axis, idx, src)
def _segment_sum(src, seg, n):
    out = torch.zeros((n,) + src.shape[1:], dtype=src.dtype)
    return out.index_add_(0, seg, src)
def _pad(x, pw):
    flat = tuple(v for pair in reversed(pw) for v in pair)
    return torch.nn.functional.pad(x, flat)

kernel_name = 'interleave_layers__sliding_block_cached__glu_gated_swiglu__decode'

def setup_inputs():

    _w = (lambda a: (lambda t: t.to(torch.bfloat16) if t.is_floating_point() else t)(torch.as_tensor(a)))
    def _A_setup():
        B, Sq, D = 1, 1, 640
        Hq, Hkv, Sk, Dh = 32, 32, 32768, 192
        assert Hq % Hkv == 0, (Hq, Hkv)
        return {
            "x": _w((lambda *s: torch.randn(*s, dtype=torch.bfloat16) * 0.05)(B, Sq, D)),
            "k_cache": _w((lambda *s: torch.randn(*s, dtype=torch.bfloat16) * 0.8)(B, Hkv, Sk, Dh)),
            "v_cache": _w((lambda *s: torch.randn(*s, dtype=torch.bfloat16) * 1.6)(B, Hkv, Sk, Dh)),
            "wq": _w((lambda *s: torch.randn(*s, dtype=torch.bfloat16) * 0.8)(D, Hq * Dh) * (D ** -0.5)),
            "wo": _w((lambda *s: torch.randn(*s, dtype=torch.bfloat16) * 1.6)(Hq * Dh, D) * ((Hq * Dh) ** -0.5)),
        }
    _A_in = _A_setup()

    def _B_setup():
        B, S, D, F = 1, 1, 640, 1536
        return {
            "x": _w((lambda *s: torch.randn(*s, dtype=torch.bfloat16) * 0.05)(B, S, D)),
            "w1": _w((lambda *s: torch.randn(*s, dtype=torch.bfloat16) * 0.4)(D, F) * (2.0 / D) ** 0.5),
            "w3": _w((lambda *s: torch.randn(*s, dtype=torch.bfloat16) * 0.4)(D, F) * (2.0 / D) ** 0.5),
            "w2": _w((lambda *s: torch.randn(*s, dtype=torch.bfloat16) * 0.4)(F, D) * (2.0 / F) ** 0.5),
        }
    _B_in = _B_setup()

    return {
        "A_x": _A_in["x"],
        "A_k_cache": _A_in["k_cache"],
        "A_v_cache": _A_in["v_cache"],
        "A_wq": _A_in["wq"],
        "A_wo": _A_in["wo"],
        "B_x": _B_in["x"],
        "B_w1": _B_in["w1"],
        "B_w3": _B_in["w3"],
        "B_w2": _B_in["w2"],
    }

def reference(A_x, A_k_cache, A_v_cache, A_wq, A_wo, B_x, B_w1, B_w3, B_w2):
    def _A_ref(x, k_cache, v_cache, wq, wo):
        B, Sq, D = x.shape
        Hq, Dh = 32, 192
        Hkv, Sk = k_cache.shape[1], k_cache.shape[2]
        W = min(4096, max(256, Sk // 4))
        rep = Hq // Hkv
        q = (lambda x, *d: x.permute(*d))((x @ wq).reshape(B, Sq, Hq, Dh), 0, 2, 1, 3)
        k = (lambda x, n, axis: torch.repeat_interleave(x, n, dim=axis))(k_cache[:, :, Sk - W:, :], rep, axis=1)
        v = (lambda x, n, axis: torch.repeat_interleave(x, n, dim=axis))(v_cache[:, :, Sk - W:, :], rep, axis=1)
        scores = torch.einsum("bhqd,bhkd->bhqk", q, k) * (Dh ** -0.5)
        p = _softmax(scores, axis=-1)
        o = torch.einsum("bhqk,bhkd->bhqd", p, v)
        return (lambda x, *d: x.permute(*d))(o, 0, 2, 1, 3).reshape(B, Sq, Hq * Dh) @ wo

    def _B_ref(x, w1, w3, w2):
        gate = torch.einsum("bsd,df->bsf", x, w1)
        up = torch.einsum("bsd,df->bsf", x, w3)
        h = _silu(gate) * up
        out = torch.einsum("bsf,fd->bsd", h, w2)
        return out

    x = A_x
    x = x + _A_ref(_layernorm(x, axis=-1), A_k_cache, A_v_cache, A_wq, A_wo)
    x = x + _B_ref(_layernorm(x, axis=-1), B_w1, B_w3, B_w2)
    x = x + _A_ref(_layernorm(x, axis=-1), A_k_cache, A_v_cache, A_wq, A_wo)
    x = x + _B_ref(_layernorm(x, axis=-1), B_w1, B_w3, B_w2)
    return x
```

```asm
; @launch grid=(256,1,1) block=(256,1,1) lds=122368
.amdgcn_target "amdgcn-amd-amdhsa--gfx950"
.text
.globl interleave_layers__sliding_block_cached__glu_gated_swiglu__decode_kernel
.p2align 8
.type interleave_layers__sliding_block_cached__glu_gated_swiglu__decode_kernel,@function
interleave_layers__sliding_block_cached__glu_gated_swiglu__decode_kernel:
    s_cmp_ge_u32 s2, 256
    s_cbranch_scc1 DONE
    s_load_dwordx16 s[44:59], s[0:1], 0
    s_load_dwordx8 s[60:67], s[0:1], 64
    v_lshrrev_b32 v2, 6, v0
    v_and_b32 v24, 63, v0
    v_readfirstlane_b32 s72, v2
    s_and_b32 s68, s2, 7
    s_lshr_b32 s69, s2, 3
    s_lshr_b32 s70, s69, 3
    s_and_b32 s71, s69, 7
    v_lshlrev_b32 v1, 4, v24
    s_lshl_b32 s77, s70, 3
    s_add_u32 s77, s77, s68
    s_mul_i32 s73, s77, 12582912
    s_lshl_b32 s78, s71, 2
    s_add_u32 s78, s78, s72
    s_mul_i32 s78, s78, 6144
    s_add_u32 s73, s73, s78
    s_add_u32 s73, s73, 11010048
    s_mul_i32 s79, s77, 384
    s_mov_b32 s74, 0
    s_mul_i32 s3, s68, 81920
    s_mov_b32 s75, 0
    v_mov_b32 v32, -1
    v_mov_b32 v33, -1
    v_mov_b32 v34, -1
    v_mov_b32 v35, -1
    s_mul_i32 s77, s69, 2560
    s_add_u32 s77, s77, s3
    v_lshl_add_u32 v20, v0, 4, s77
    v_cmp_le_u32 vcc, 160, v0
    v_add_u32 v25, 685568, v20
    s_nop 0
    v_cndmask_b32 v20, v20, v25, vcc
    s_add_u32 s77, s77, 689664
    s_lshl_b32 s78, s69, 10
    s_add_u32 s78, s78, s3
    s_add_u32 s78, s78, 1376256
    s_cmp_eq_u32 s72, 0
    s_cselect_b32 s4, s77, s78
    s_mul_i32 s77, s2, 80
    s_add_u32 s77, s77, 655360
    s_cmp_ge_u32 s72, 2
    s_cselect_b32 s4, s77, s4
    v_add_u32 v25, 688048, v1
    v_cmp_le_u32 vcc, 133, v0
    s_nop 1
    v_cndmask_b32 v21, v1, v25, vcc
    v_mov_b32 v25, 1879048176
    v_cmp_le_u32 vcc, 138, v0
    s_nop 1
    v_cndmask_b32 v21, v21, v25, vcc
    s_waitcnt lgkmcnt(0)
    s_mov_b32 s8, s46
    s_and_b32 s9, s47, 0xffff
    s_mov_b32 s10, 402653184
    s_mov_b32 s11, 0x20000
    s_add_u32 s6, s73, 0
    buffer_load_dwordx4 a[0:3], v1, s[8:11], s6 offen offset:0 nt
    buffer_load_dwordx4 a[4:7], v1, s[8:11], s6 offen offset:1024 nt
    buffer_load_dwordx4 a[8:11], v1, s[8:11], s6 offen offset:2048 nt
    buffer_load_dwordx4 a[12:15], v1, s[8:11], s6 offen offset:3072 nt
    s_add_u32 s6, s6, 4096
    buffer_load_dwordx4 a[16:19], v1, s[8:11], s6 offen offset:0 nt
    buffer_load_dwordx4 a[20:23], v1, s[8:11], s6 offen offset:1024 nt
    s_mov_b32 s16, s66
    s_and_b32 s17, s67, 0xffff
    s_mov_b32 s18, 1610612736
    s_mov_b32 s19, 0x20000
    buffer_store_dwordx4 v[32:35], v20, s[16:19], 0 offen sc1
    buffer_store_dwordx4 v[32:35], v21, s[16:19], s4 offen sc1
    s_getpc_b64 s[100:101]
PCREF:
    s_sub_u32 s100, s100, PCREF-interleave_layers__sliding_block_cached__glu_gated_swiglu__decode_kernel
    s_subb_u32 s101, s101, 0
    v_lshlrev_b32 v25, 4, v0
    v_min_u32 v26, CODE_END-interleave_layers__sliding_block_cached__glu_gated_swiglu__decode_kernel-16, v25
    global_load_dwordx4 a[240:243], v26, s[100:101]
    v_add_u32 v25, 4096, v25
    v_min_u32 v26, CODE_END-interleave_layers__sliding_block_cached__glu_gated_swiglu__decode_kernel-16, v25
    global_load_dwordx4 a[240:243], v26, s[100:101]
    v_add_u32 v25, 4096, v25
    v_min_u32 v26, CODE_END-interleave_layers__sliding_block_cached__glu_gated_swiglu__decode_kernel-16, v25
    global_load_dwordx4 a[240:243], v26, s[100:101]
    v_add_u32 v25, 4096, v25
    v_min_u32 v26, CODE_END-interleave_layers__sliding_block_cached__glu_gated_swiglu__decode_kernel-16, v25
    global_load_dwordx4 a[240:243], v26, s[100:101]
    s_add_u32 s6, s73, 196608
    buffer_load_dwordx4 a[24:27], v1, s[8:11], s6 offen offset:0 nt
    buffer_load_dwordx4 a[28:31], v1, s[8:11], s6 offen offset:1024 nt
    buffer_load_dwordx4 a[32:35], v1, s[8:11], s6 offen offset:2048 nt
    buffer_load_dwordx4 a[36:39], v1, s[8:11], s6 offen offset:3072 nt
    s_add_u32 s6, s6, 4096
    buffer_load_dwordx4 a[40:43], v1, s[8:11], s6 offen offset:0 nt
    buffer_load_dwordx4 a[44:47], v1, s[8:11], s6 offen offset:1024 nt
    s_mov_b32 s12, s48
    s_and_b32 s13, s49, 0xffff
    s_mov_b32 s14, 402653184
    s_mov_b32 s15, 0x20000
    s_mov_b32 s20, s50
    s_and_b32 s21, s51, 0xffff
    s_mov_b32 s22, 7864320
    s_mov_b32 s23, 0x20000
    s_mov_b32 s36, s44
    s_and_b32 s37, s45, 0xffff
    s_mov_b32 s38, 1280
    s_mov_b32 s39, 0x20000
    s_mov_b32 s40, s62
    s_and_b32 s41, s63, 0xffff
    s_mov_b32 s42, 1280
    s_mov_b32 s43, 0x20000
    s_mov_b32 s28, s58
    s_and_b32 s29, s59, 0xffff
    s_mov_b32 s30, 1966080
    s_mov_b32 s31, 0x20000
    s_mov_b32 s32, s60
    s_and_b32 s33, s61, 0xffff
    s_mov_b32 s34, 1966080
    s_mov_b32 s35, 0x20000
    s_cmp_lt_u32 s69, 20
    s_cselect_b32 s24, s52, s56
    s_cselect_b32 s25, s53, s57
    s_cselect_b32 s26, s22, s30
    s_and_b32 s25, s25, 0xffff
    s_mov_b32 s27, 0x20000
    s_waitcnt vmcnt(10)
    s_barrier
    s_getreg_b32 s5, hwreg(HW_REG_XCC_ID, 0, 4)
    s_lshr_b32 s77, s5, 2
    s_lshl_b32 s78, s68, 2
    s_add_u32 s77, s77, s78
    s_and_b32 s78, s5, 3
    s_lshl_b32 s78, s78, 3
    s_lshl_b32 s7, 1, s78
    s_lshl_b32 s96, 32, s78
    s_mov_b32 s5, s77
    s_cmp_lg_u32 s72, 0
    s_cbranch_scc1 NOATOM
    s_lshl_b32 s77, s77, 2
    v_mov_b32 v36, s77
    v_mov_b32 v37, s7
    s_mov_b64 exec, 1
    global_atomic_add v36, v37, s[64:65] sc1
    s_mov_b64 exec, -1
NOATOM:
    v_mov_b32 v36, 0
    v_mov_b32 v37, 0
    v_mov_b32 v38, 0
    v_mov_b32 v39, 0
    v_min_u32 v25, 191, v0
    v_lshlrev_b32 v25, 4, v25
    v_add_u32 v25, 119296, v25
    ds_write_b128 v25, v[36:39]
    v_mov_b32 v0, v24
    s_mul_i32 s77, s72, 6656
    v_add_u32 v25, 0, v0
    v_mul_u32_u24 v26, 171, v25
    v_lshrrev_b32 v26, 12, v26
    v_mul_u32_u24 v27, 24, v26
    v_sub_u32 v27, v25, v27
    v_lshlrev_b32 v27, 4, v27
    v_mul_u32_u24 v25, 416, v26
    v_add3_u32 v2, v25, v27, s77
    v_mul_u32_u24 v25, 12288, v26
    v_add_u32 v40, v25, v27
    v_add_u32 v25, 64, v0
    v_mul_u32_u24 v26, 171, v25
    v_lshrrev_b32 v26, 12, v26
    v_mul_u32_u24 v27, 24, v26
    v_sub_u32 v27, v25, v27
    v_lshlrev_b32 v27, 4, v27
    v_mul_u32_u24 v25, 416, v26
    v_add3_u32 v3, v25, v27, s77
    v_mul_u32_u24 v25, 12288, v26
    v_add_u32 v41, v25, v27
    v_add_u32 v25, 128, v0
    v_mul_u32_u24 v26, 171, v25
    v_lshrrev_b32 v26, 12, v26
    v_mul_u32_u24 v27, 24, v26
    v_sub_u32 v27, v25, v27
    v_lshlrev_b32 v27, 4, v27
    v_mul_u32_u24 v25, 416, v26
    v_add3_u32 v4, v25, v27, s77
    v_mul_u32_u24 v25, 12288, v26
    v_add_u32 v42, v25, v27
    s_mul_i32 s78, s71, 983040
    s_add_u32 s79, s79, s78
    s_mul_i32 s78, s72, 98304
    s_add_u32 s79, s79, s78
    s_mul_i32 s78, s72, 3072
    s_add_u32 s78, s78, 26624
    s_add_u32 m0, s78, 0
    s_nop 0
    buffer_load_dwordx4 v40, s[20:23], s79 offen nt lds
    s_add_u32 m0, s78, 1024
    s_nop 0
    buffer_load_dwordx4 v41, s[20:23], s79 offen nt lds
    s_add_u32 m0, s78, 2048
    s_nop 0
    buffer_load_dwordx4 v42, s[20:23], s79 offen nt lds
    s_add_u32 s79, s79, 393216
    s_add_u32 m0, s78, 12288
    s_nop 0
    buffer_load_dwordx4 v40, s[20:23], s79 offen nt lds
    s_add_u32 m0, s78, 13312
    s_nop 0
    buffer_load_dwordx4 v41, s[20:23], s79 offen nt lds
    s_add_u32 m0, s78, 14336
    s_nop 0
    buffer_load_dwordx4 v42, s[20:23], s79 offen nt lds
    s_add_u32 s79, s79, 393216
    s_cmp_ge_u32 s72, 2
    s_cbranch_scc1 NOWQ3
    s_add_u32 m0, s78, 24576
    s_nop 0
    buffer_load_dwordx4 v40, s[20:23], s79 offen nt lds
    s_add_u32 m0, s78, 25600
    s_nop 0
    buffer_load_dwordx4 v41, s[20:23], s79 offen nt lds
    s_add_u32 m0, s78, 26624
    s_nop 0
    buffer_load_dwordx4 v42, s[20:23], s79 offen nt lds
NOWQ3:
    v_and_b32 v25, 15, v0
    v_lshrrev_b32 v26, 4, v0
    v_bfe_u32 v27, v0, 2, 2
    v_and_b32 v28, 3, v0
    v_cmp_eq_u32 vcc, 12, v25
    v_mov_b32 v36, 0x3f803f80
    s_nop 0
    v_cndmask_b32 v70, 0, v36, vcc
    v_mov_b32 v71, v70
    v_mov_b32 v72, v70
    v_mov_b32 v73, v70
    v_mov_b32 v74, v70
    v_mov_b32 v75, v70
    v_mov_b32 v76, v70
    v_mov_b32 v77, v70
    v_mov_b32 v78, v70
    v_mov_b32 v79, v70
    v_mov_b32 v88, v70
    v_mov_b32 v89, v70
    v_mov_b32 v90, v70
    v_mov_b32 v91, v70
    v_mov_b32 v92, v70
    v_mov_b32 v93, v70
    v_mov_b32 v94, v70
    v_mov_b32 v95, v70
    v_mov_b32 v96, v70
    v_mov_b32 v97, v70
    s_mul_i32 s78, s71, 160
    v_lshlrev_b32 v36, 4, v26
    v_lshlrev_b32 v37, 3, v26
    s_mov_b32 exec_lo, 0x1000100
    s_mov_b32 exec_hi, 0x1000100
    buffer_load_dwordx4 v[88:91], v36, s[36:39], s78 offen
    buffer_load_dwordx4 v[92:95], v36, s[36:39], s78 offen offset:64
    buffer_load_dwordx2 v[96:97], v37, s[36:39], s78 offen offset:128
    s_mov_b64 exec, -1
    s_lshl_b32 s79, s69, 6
    v_lshlrev_b32 v38, 2, v25
    buffer_load_dword v22, v38, s[36:39], s79 offen
    s_add_u32 s6, s73, 393216
    buffer_load_dwordx4 a[48:51], v1, s[8:11], s6 offen offset:0 nt
    buffer_load_dwordx4 a[52:55], v1, s[8:11], s6 offen offset:1024 nt
    buffer_load_dwordx4 a[56:59], v1, s[8:11], s6 offen offset:2048 nt
    buffer_load_dwordx4 a[60:63], v1, s[8:11], s6 offen offset:3072 nt
    s_add_u32 s6, s6, 4096
    buffer_load_dwordx4 a[64:67], v1, s[8:11], s6 offen offset:0 nt
    buffer_load_dwordx4 a[68:71], v1, s[8:11], s6 offen offset:1024 nt
    v_mul_u32_u24 v29, 416, v25
    v_lshl_add_u32 v29, v26, 4, v29
    v_add_u32 v5, s77, v29
    v_lshrrev_b32 v29, 2, v0
    v_mul_u32_u24 v29, 416, v29
    v_lshl_add_u32 v29, v28, 3, v29
    v_add_u32 v6, s77, v29
    s_mul_i32 s79, s72, 96
    s_add_u32 s79, s79, 26624
    v_lshl_add_u32 v29, v26, 3, v27
    v_mul_u32_u24 v29, 384, v29
    v_lshl_add_u32 v29, v28, 3, v29
    v_add_u32 v16, s79, v29
    v_lshl_add_u32 v29, v26, 2, v27
    v_mul_u32_u24 v29, 384, v29
    v_lshl_add_u32 v29, v28, 3, v29
    v_add_u32 v17, s79, v29
    v_mul_u32_u24 v29, 1280, v25
    v_add_u32 v29, 665600, v29
    s_mul_i32 s7, s68, 81920
    s_add_u32 s7, s7, 78080
    v_mov_b32 v30, s7
    v_cmp_eq_u32 vcc, s68, v25
    s_nop 1
    v_cndmask_b32 v29, v29, v30, vcc
    v_add_u32 v30, 2560, v30
    v_cmp_le_u32 vcc, 8, v25
    s_nop 1
    v_cndmask_b32 v29, v29, v30, vcc
    v_add_u32 v29, s78, v29
    v_lshl_add_u32 v8, v26, 4, v29
    v_lshl_add_u32 v9, v26, 3, v29
    s_lshl_b32 s78, s69, 10
    s_lshl_b32 s79, s72, 8
    s_add_u32 s78, s78, s79
    v_lshl_add_u32 v10, v0, 2, s78
    s_lshl_b32 s78, s70, 13
    s_add_u32 s78, s78, s79
    v_lshlrev_b32 v29, 10, v26
    v_lshl_add_u32 v29, v25, 4, v29
    v_add_u32 v11, s78, v29
    s_mul_i32 s78, s72, 96
    s_add_u32 s78, s78, 118784
    v_lshl_add_u32 v29, v25, 2, v26
    v_lshl_add_u32 v29, v29, 1, s78
    v_mov_b32 v30, 119168
    v_cmp_le_u32 vcc, 12, v25
    s_nop 1
    v_cndmask_b32 v12, v29, v30, vcc
    v_lshlrev_b32 v29, 4, v26
    v_add_u32 v13, 118784, v29
    s_lshl_b32 s78, s70, 8
    s_add_u32 s78, s78, 45056
    v_and_b32 v29, 31, v0
    v_lshl_add_u32 v14, v29, 3, s78
    v_lshlrev_b32 v29, 2, v0
    v_add_u32 v15, 119296, v29
    s_mov_b32 s80, 0x1010101
    s_mov_b32 s81, 0x1010101
    s_mov_b32 s82, 0x2020202
    s_mov_b32 s83, 0x2020202
    s_mov_b32 s84, 0x4040404
    s_mov_b32 s85, 0x4040404
    s_mov_b32 s86, 0x8080808
    s_mov_b32 s87, 0x8080808
    s_mov_b32 s88, 0x10101010
    s_mov_b32 s89, 0x10101010
    s_mov_b32 s90, 0x20202020
    s_mov_b32 s91, 0x20202020
    s_mov_b32 s92, 0x40404040
    s_mov_b32 s93, 0x40404040
    s_mov_b32 s94, 0x80808080
    s_mov_b32 s95, 0x80808080
    s_mov_b32 s44, 0x10001
    s_mov_b32 s45, 0x10001
    s_mov_b32 s46, 0x20002
    s_mov_b32 s47, 0x20002
    s_mov_b32 s48, 0x40004
    s_mov_b32 s49, 0x40004
    s_mov_b32 s50, 0x80008
    s_mov_b32 s51, 0x80008
    s_mov_b32 s52, 0x100010
    s_mov_b32 s53, 0x100010
    s_mov_b32 s54, 0x200020
    s_mov_b32 s55, 0x200020
    s_mov_b32 s56, 0x400040
    s_mov_b32 s57, 0x400040
    s_mov_b32 s58, 0x800080
    s_mov_b32 s59, 0x800080
    s_mov_b32 s60, 0x1000100
    s_mov_b32 s61, 0x1000100
    s_mov_b32 s62, 0x2000200
    s_mov_b32 s63, 0x2000200
    ds_write_b128 v2, a[0:3] offset:0
    ds_write_b128 v3, a[4:7] offset:0
    ds_write_b128 v4, a[8:11] offset:0
    ds_write_b128 v2, a[12:15] offset:3328
    ds_write_b128 v3, a[16:19] offset:3328
    ds_write_b128 v4, a[20:23] offset:3328
    ds_read_b128 a[0:3], v5 offset:0
    ds_read_b128 a[4:7], v5 offset:64
    ds_read_b128 a[8:11], v5 offset:128
    ds_read_b128 a[12:15], v5 offset:192
    ds_read_b128 a[16:19], v5 offset:256
    ds_read_b128 a[20:23], v5 offset:320
    s_add_u32 s6, s73, 589824
    buffer_load_dwordx4 a[72:75], v1, s[8:11], s6 offen offset:0 nt
    buffer_load_dwordx4 a[76:79], v1, s[8:11], s6 offen offset:1024 nt
    buffer_load_dwordx4 a[80:83], v1, s[8:11], s6 offen offset:2048 nt
    buffer_load_dwordx4 a[84:87], v1, s[8:11], s6 offen offset:3072 nt
    s_add_u32 s6, s6, 4096
    buffer_load_dwordx4 a[88:91], v1, s[8:11], s6 offen offset:0 nt
    buffer_load_dwordx4 a[92:95], v1, s[8:11], s6 offen offset:1024 nt
    s_waitcnt vmcnt(22)
    ds_write_b128 v2, a[24:27] offset:0
    ds_write_b128 v3, a[28:31] offset:0
    ds_write_b128 v4, a[32:35] offset:0
    ds_write_b128 v2, a[36:39] offset:3328
    ds_write_b128 v3, a[40:43] offset:3328
    ds_write_b128 v4, a[44:47] offset:3328
    ds_read_b128 a[24:27], v5 offset:0
    ds_read_b128 a[28:31], v5 offset:64
    ds_read_b128 a[32:35], v5 offset:128
    ds_read_b128 a[36:39], v5 offset:192
    ds_read_b128 a[40:43], v5 offset:256
    ds_read_b128 a[44:47], v5 offset:320
    s_add_u32 s6, s73, 786432
    buffer_load_dwordx4 a[96:99], v1, s[8:11], s6 offen offset:0 nt
    buffer_load_dwordx4 a[100:103], v1, s[8:11], s6 offen offset:1024 nt
    buffer_load_dwordx4 a[104:107], v1, s[8:11], s6 offen offset:2048 nt
    buffer_load_dwordx4 a[108:111], v1, s[8:11], s6 offen offset:3072 nt
    s_add_u32 s6, s6, 4096
    buffer_load_dwordx4 a[112:115], v1, s[8:11], s6 offen offset:0 nt
    buffer_load_dwordx4 a[116:119], v1, s[8:11], s6 offen offset:1024 nt
    s_waitcnt vmcnt(12)
    ds_write_b128 v2, a[48:51] offset:0
    ds_write_b128 v3, a[52:55] offset:0
    ds_write_b128 v4, a[56:59] offset:0
    ds_write_b128 v2, a[60:63] offset:3328
    ds_write_b128 v3, a[64:67] offset:3328
    ds_write_b128 v4, a[68:71] offset:3328
    ds_read_b128 a[48:51], v5 offset:0
    ds_read_b128 a[52:55], v5 offset:64
    ds_read_b128 a[56:59], v5 offset:128
    ds_read_b128 a[60:63], v5 offset:192
    ds_read_b128 a[64:67], v5 offset:256
    ds_read_b128 a[68:71], v5 offset:320
    s_waitcnt lgkmcnt(0)
    s_barrier
    ds_read_b64_tr_b16 v[40:41], v16 offset:0
    ds_read_b64_tr_b16 v[42:43], v16 offset:1536
    ds_read_b64_tr_b16 v[44:45], v16 offset:12288
    ds_read_b64_tr_b16 v[46:47], v16 offset:13824
    ds_read_b64_tr_b16 v[48:49], v17 offset:24576
    ds_read_b64_tr_b16 v[50:51], v16 offset:32
    ds_read_b64_tr_b16 v[52:53], v16 offset:1568
    ds_read_b64_tr_b16 v[54:55], v16 offset:12320
    ds_read_b64_tr_b16 v[56:57], v16 offset:13856
    ds_read_b64_tr_b16 v[58:59], v17 offset:24608
    ds_read_b64_tr_b16 v[60:61], v16 offset:64
    ds_read_b64_tr_b16 v[62:63], v16 offset:1600
    ds_read_b64_tr_b16 v[64:65], v16 offset:12352
    ds_read_b64_tr_b16 v[66:67], v16 offset:13888
    ds_read_b64_tr_b16 v[68:69], v17 offset:24640
    s_add_u32 s6, s73, 983040
    buffer_load_dwordx4 a[120:123], v1, s[8:11], s6 offen offset:0 nt
    buffer_load_dwordx4 a[124:127], v1, s[8:11], s6 offen offset:1024 nt
    buffer_load_dwordx4 a[128:131], v1, s[8:11], s6 offen offset:2048 nt
    buffer_load_dwordx4 a[132:135], v1, s[8:11], s6 offen offset:3072 nt
    s_add_u32 s6, s6, 4096
    buffer_load_dwordx4 a[136:139], v1, s[8:11], s6 offen offset:0 nt
    buffer_load_dwordx4 a[140:143], v1, s[8:11], s6 offen offset:1024 nt
    s_waitcnt vmcnt(12)
    ds_write_b128 v2, a[72:75] offset:0
    ds_write_b128 v3, a[76:79] offset:0
    ds_write_b128 v4, a[80:83] offset:0
    ds_write_b128 v2, a[84:87] offset:3328
    ds_write_b128 v3, a[88:91] offset:3328
    ds_write_b128 v4, a[92:95] offset:3328
    ds_read_b128 a[72:75], v5 offset:0
    ds_read_b128 a[76:79], v5 offset:64
    ds_read_b128 a[80:83], v5 offset:128
    ds_read_b128 a[84:87], v5 offset:192
    ds_read_b128 a[88:91], v5 offset:256
    ds_read_b128 a[92:95], v5 offset:320
    v_lshlrev_b32 v98, 2, v0
    global_load_dword v99, v98, s[64:65] sc1
    s_add_u32 s6, s73, 1179648
    buffer_load_dwordx4 a[144:147], v1, s[8:11], s6 offen offset:0 nt
    buffer_load_dwordx4 a[148:151], v1, s[8:11], s6 offen offset:1024 nt
    buffer_load_dwordx4 a[152:155], v1, s[8:11], s6 offen offset:2048 nt
    buffer_load_dwordx4 a[156:159], v1, s[8:11], s6 offen offset:3072 nt
    s_add_u32 s6, s6, 4096
    buffer_load_dwordx4 a[160:163], v1, s[8:11], s6 offen offset:0 nt
    buffer_load_dwordx4 a[164:167], v1, s[8:11], s6 offen offset:1024 nt
    s_waitcnt vmcnt(13)
    ds_write_b128 v2, a[96:99] offset:0
    ds_write_b128 v3, a[100:103] offset:0
    ds_write_b128 v4, a[104:107] offset:0
    ds_write_b128 v2, a[108:111] offset:3328
    ds_write_b128 v3, a[112:115] offset:3328
    ds_write_b128 v4, a[116:119] offset:3328
    ds_read_b128 a[96:99], v5 offset:0
    ds_read_b128 a[100:103], v5 offset:64
    ds_read_b128 a[104:107], v5 offset:128
    ds_read_b128 a[108:111], v5 offset:192
    ds_read_b128 a[112:115], v5 offset:256
    ds_read_b128 a[116:119], v5 offset:320
    s_add_u32 s6, s73, 1376256
    buffer_load_dwordx4 a[168:171], v1, s[8:11], s6 offen offset:0 nt
    buffer_load_dwordx4 a[172:175], v1, s[8:11], s6 offen offset:1024 nt
    buffer_load_dwordx4 a[176:179], v1, s[8:11], s6 offen offset:2048 nt
    buffer_load_dwordx4 a[180:183], v1, s[8:11], s6 offen offset:3072 nt
    s_add_u32 s6, s6, 4096
    buffer_load_dwordx4 a[184:187], v1, s[8:11], s6 offen offset:0 nt
    buffer_load_dwordx4 a[188:191], v1, s[8:11], s6 offen offset:1024 nt
    s_waitcnt vmcnt(13)
    ds_write_b128 v2, a[120:123] offset:0
    ds_write_b128 v3, a[124:127] offset:0
    ds_write_b128 v4, a[128:131] offset:0
    ds_write_b128 v2, a[132:135] offset:3328
    ds_write_b128 v3, a[136:139] offset:3328
    ds_write_b128 v4, a[140:143] offset:3328
    ds_read_b128 a[120:123], v5 offset:0
    ds_read_b128 a[124:127], v5 offset:64
    ds_read_b128 a[128:131], v5 offset:128
    ds_read_b128 a[132:135], v5 offset:192
    ds_read_b128 a[136:139], v5 offset:256
    ds_read_b128 a[140:143], v5 offset:320
    s_waitcnt vmcnt(12)
    v_sad_u8 v100, v99, 0, 0
    s_nop 1
    v_add_u32_dpp v100, v100, v100 quad_perm:[1,0,3,2] row_mask:0xf bank_mask:0xf
    s_nop 1
    v_add_u32_dpp v100, v100, v100 quad_perm:[2,3,0,1] row_mask:0xf bank_mask:0xf
    v_cmp_ne_u32 vcc, 32, v100
    s_mov_b32 vcc_hi, 0
    s_cmp_eq_u64 vcc, 0
    s_cbranch_scc0 RDYLOOP
RDYOK:
    v_readlane_b32 s77, v99, s5
    s_nop 0
    s_cmp_eq_u32 s77, s96
    s_cselect_b32 s75, 1, 0
    buffer_load_dwordx4 a[240:243], v20, s[16:19], 0 offen sc1
    buffer_load_dwordx4 a[240:243], v21, s[16:19], s4 offen sc1
    s_waitcnt lgkmcnt(0)
    s_add_u32 s79, s3, 1376256
    v_mfma_f32_16x16x32_bf16 v[24:27], v[70:73], v[40:43], 0
    v_mfma_f32_16x16x32_bf16 v[28:31], v[70:73], v[50:53], 0
    v_mfma_f32_16x16x32_bf16 v[32:35], v[70:73], v[60:63], 0
    v_mfma_f32_16x16x32_bf16 v[36:39], v[70:73], v[70:73], 0
    v_mfma_f32_16x16x32_bf16 v[24:27], v[74:77], v[44:47], v[24:27]
    v_mfma_f32_16x16x32_bf16 v[28:31], v[74:77], v[54:57], v[28:31]
    v_mfma_f32_16x16x32_bf16 v[32:35], v[74:77], v[64:67], v[32:35]
    v_mfma_f32_16x16x32_bf16 v[36:39], v[74:77], v[74:77], v[36:39]
    v_mfma_f32_16x16x16_bf16 v[24:27], v[78:79], v[48:49], v[24:27]
    v_mfma_f32_16x16x16_bf16 v[28:31], v[78:79], v[58:59], v[28:31]
    v_mfma_f32_16x16x16_bf16 v[32:35], v[78:79], v[68:69], v[32:35]
    v_mfma_f32_16x16x16_bf16 v[36:39], v[78:79], v[78:79], v[36:39]
    s_nop 4
    v_add_f32 v24, v24, v25
    v_add_f32 v26, v26, v27
    v_add_f32 v28, v28, v29
    v_add_f32 v30, v30, v31
    v_add_f32 v32, v32, v33
    v_add_f32 v34, v34, v35
    v_add_f32 v36, v36, v37
    v_add_f32 v38, v38, v39
    v_add_f32 v24, v24, v26
    v_add_f32 v28, v28, v30
    v_add_f32 v32, v32, v34
    v_add_f32 v36, v36, v38
    s_nop 0
    v_permlane32_swap_b32 v24, v32
    v_permlane32_swap_b32 v28, v36
    v_add_f32 v24, v24, v32
    v_add_f32 v28, v28, v36
    s_nop 1
    v_permlane16_swap_b32 v24, v28
    v_add_f32 v24, v24, v28
    s_cmp_eq_u32 s75, 1
    s_cbranch_scc0 SLOW1
    buffer_store_dword v24, v10, s[16:19], s79 offen
BACK1:
    v_mfma_f32_16x16x32_bf16 v[24:27], v[88:91], v[40:43], 0
    v_mfma_f32_16x16x32_bf16 v[28:31], v[88:91], v[50:53], 0
    v_mfma_f32_16x16x32_bf16 v[32:35], v[88:91], v[60:63], 0
    v_mfma_f32_16x16x32_bf16 v[36:39], v[88:91], v[88:91], 0
    v_mfma_f32_16x16x32_bf16 v[24:27], v[92:95], v[44:47], v[24:27]
    v_mfma_f32_16x16x32_bf16 v[28:31], v[92:95], v[54:57], v[28:31]
    v_mfma_f32_16x16x32_bf16 v[32:35], v[92:95], v[64:67], v[32:35]
    v_mfma_f32_16x16x32_bf16 v[36:39], v[92:95], v[92:95], v[36:39]
    v_mfma_f32_16x16x16_bf16 v[24:27], v[96:97], v[48:49], v[24:27]
    v_mfma_f32_16x16x16_bf16 v[28:31], v[96:97], v[58:59], v[28:31]
    v_mfma_f32_16x16x16_bf16 v[32:35], v[96:97], v[68:69], v[32:35]
    v_mfma_f32_16x16x16_bf16 v[36:39], v[96:97], v[96:97], v[36:39]
    s_nop 4
    v_add_f32 v24, v24, v25
    v_add_f32 v26, v26, v27
    v_add_f32 v28, v28, v29
    v_add_f32 v30, v30, v31
    v_add_f32 v32, v32, v33
    v_add_f32 v34, v34, v35
    v_add_f32 v36, v36, v37
    v_add_f32 v38, v38, v39
    v_add_f32 v24, v24, v26
    v_add_f32 v28, v28, v30
    v_add_f32 v32, v32, v34
    v_add_f32 v36, v36, v38
    s_nop 0
    v_permlane32_swap_b32 v24, v32
    v_permlane32_swap_b32 v28, v36
    v_add_f32 v24, v24, v32
    v_add_f32 v28, v28, v36
    s_nop 1
    v_permlane16_swap_b32 v24, v28
    v_add_f32 v24, v24, v28
    s_cmp_eq_u32 s75, 1
    s_cbranch_scc0 SLOW2
    buffer_store_dword v24, v10, s[16:19], s3 offen
BACK2:
    s_cmp_lg_u32 s72, 1
    s_cbranch_scc1 NOBASE0
    s_cmp_ge_u32 s69, 20
    s_cbranch_scc1 NOBASE0
    v_mov_b32 v28, v22
    s_lshl_b32 s77, s69, 6
    s_add_u32 s77, s77, s3
    s_add_u32 s77, s77, 79360
    v_lshlrev_b32 v27, 2, v0
    v_mov_b32_dpp v29, v28 quad_perm:[1,1,1,1] row_mask:0xf bank_mask:0xf
    v_mov_b32_dpp v30, v28 quad_perm:[2,2,2,2] row_mask:0xf bank_mask:0xf
    v_mov_b32_dpp v31, v28 quad_perm:[3,3,3,3] row_mask:0xf bank_mask:0xf
    s_mov_b32 exec_lo, 0x1111
    s_mov_b32 exec_hi, 0x0
    s_cmp_eq_u32 s75, 1
    s_cbranch_scc0 SLOW3
    buffer_store_dwordx4 v[28:31], v27, s[16:19], s77 offen
BACK3:
    s_mov_b64 exec, -1
NOBASE0:
    v_and_b32 v23, 0xffff0000, v22
    v_lshlrev_b32 v22, 16, v22
    s_cmp_ge_u32 s69, 20
    s_cbranch_scc1 DMAF
    v_lshrrev_b32 v24, 2, v0
    v_mul_u32_u24 v24, 1280, v24
    v_and_b32 v25, 3, v0
    v_lshl_add_u32 v24, v25, 4, v24
    s_lshl_b32 s77, s72, 3
    s_add_u32 s77, s77, s68
    s_mul_i32 s77, s77, 245760
    s_lshl_b32 s78, s69, 6
    s_add_u32 s77, s77, s78
    s_mul_i32 s78, s72, 12288
    s_add_u32 m0, s78, 57344
    s_nop 0
    buffer_load_dwordx4 v24, s[24:27], s77 offen nt lds
    s_add_u32 m0, m0, 1024
    s_add_u32 s77, s77, 20480
    buffer_load_dwordx4 v24, s[24:27], s77 offen nt lds
    s_add_u32 m0, m0, 1024
    s_add_u32 s77, s77, 20480
    buffer_load_dwordx4 v24, s[24:27], s77 offen nt lds
    s_add_u32 m0, m0, 1024
    s_add_u32 s77, s77, 20480
    buffer_load_dwordx4 v24, s[24:27], s77 offen nt lds
    s_add_u32 m0, m0, 1024
    s_add_u32 s77, s77, 20480
    buffer_load_dwordx4 v24, s[24:27], s77 offen nt lds
    s_add_u32 m0, m0, 1024
    s_add_u32 s77, s77, 20480
    buffer_load_dwordx4 v24, s[24:27], s77 offen nt lds
    s_add_u32 m0, m0, 1024
    s_add_u32 s77, s77, 20480
    buffer_load_dwordx4 v24, s[24:27], s77 offen nt lds
    s_add_u32 m0, m0, 1024
    s_add_u32 s77, s77, 20480
    buffer_load_dwordx4 v24, s[24:27], s77 offen nt lds
    s_add_u32 m0, m0, 1024
    s_add_u32 s77, s77, 20480
    buffer_load_dwordx4 v24, s[24:27], s77 offen nt lds
    s_add_u32 m0, m0, 1024
    s_add_u32 s77, s77, 20480
    buffer_load_dwordx4 v24, s[24:27], s77 offen nt lds
    s_add_u32 m0, m0, 1024
    s_add_u32 s77, s77, 20480
    buffer_load_dwordx4 v24, s[24:27], s77 offen nt lds
    s_add_u32 m0, m0, 1024
    s_add_u32 s77, s77, 20480
    buffer_load_dwordx4 v24, s[24:27], s77 offen nt lds
DMAX:
    s_waitcnt vmcnt(22)
    ds_write_b128 v2, a[144:147] offset:0
    ds_write_b128 v3, a[148:151] offset:0
    ds_write_b128 v4, a[152:155] offset:0
    ds_write_b128 v2, a[156:159] offset:3328
    ds_write_b128 v3, a[160:163] offset:3328
    ds_write_b128 v4, a[164:167] offset:3328
    ds_read_b128 a[144:147], v5 offset:0
    ds_read_b128 a[148:151], v5 offset:64
    ds_read_b128 a[152:155], v5 offset:128
    ds_read_b128 a[156:159], v5 offset:192
    ds_read_b128 a[160:163], v5 offset:256
    ds_read_b128 a[164:167], v5 offset:320
    s_waitcnt vmcnt(16)
    ds_write_b128 v2, a[168:171] offset:0
    ds_write_b128 v3, a[172:175] offset:0
    ds_write_b128 v4, a[176:179] offset:0
    ds_write_b128 v2, a[180:183] offset:3328
    ds_write_b128 v3, a[184:187] offset:3328
    ds_write_b128 v4, a[188:191] offset:3328
    ds_read_b128 a[168:171], v5 offset:0
    ds_read_b128 a[172:175], v5 offset:64
    ds_read_b128 a[176:179], v5 offset:128
    ds_read_b128 a[180:183], v5 offset:192
    ds_read_b128 a[184:187], v5 offset:256
    ds_read_b128 a[188:191], v5 offset:320
    s_add_u32 s6, s73, 0
    buffer_load_dwordx4 a[216:219], v1, s[12:15], s6 offen offset:0 nt
    buffer_load_dwordx4 a[220:223], v1, s[12:15], s6 offen offset:1024 nt
    buffer_load_dwordx4 a[224:227], v1, s[12:15], s6 offen offset:2048 nt
    buffer_load_dwordx4 a[228:231], v1, s[12:15], s6 offen offset:3072 nt
    s_add_u32 s6, s6, 4096
    buffer_load_dwordx4 a[232:235], v1, s[12:15], s6 offen offset:0 nt
    buffer_load_dwordx4 a[236:239], v1, s[12:15], s6 offen offset:1024 nt
    s_add_u32 s77, s3, 1376256
    s_add_u32 s78, s3, 1380352
    s_add_u32 s79, s3, 4096
    buffer_load_dwordx4 v[64:67], v11, s[16:19], s77 offen sc1
    buffer_load_dwordx4 v[68:71], v11, s[16:19], s78 offen sc1
    buffer_load_dwordx4 v[72:75], v11, s[16:19], s3 offen sc1
    buffer_load_dwordx4 v[76:79], v11, s[16:19], s79 offen sc1
    s_add_u32 s6, s73, 196608
    buffer_load_dwordx4 v[112:115], v1, s[12:15], s6 offen offset:0 nt
    buffer_load_dwordx4 v[116:119], v1, s[12:15], s6 offen offset:1024 nt
    buffer_load_dwordx4 v[120:123], v1, s[12:15], s6 offen offset:2048 nt
    buffer_load_dwordx4 v[124:127], v1, s[12:15], s6 offen offset:3072 nt
    s_add_u32 s6, s6, 4096
    buffer_load_dwordx4 v[128:131], v1, s[12:15], s6 offen offset:0 nt
    buffer_load_dwordx4 v[132:135], v1, s[12:15], s6 offen offset:1024 nt
    s_add_u32 s6, s73, 393216
    buffer_load_dwordx4 v[136:139], v1, s[12:15], s6 offen offset:0 nt
    buffer_load_dwordx4 v[140:143], v1, s[12:15], s6 offen offset:1024 nt
    buffer_load_dwordx4 v[144:147], v1, s[12:15], s6 offen offset:2048 nt
    buffer_load_dwordx4 v[148:151], v1, s[12:15], s6 offen offset:3072 nt
    s_add_u32 s6, s6, 4096
    buffer_load_dwordx4 v[152:155], v1, s[12:15], s6 offen offset:0 nt
    buffer_load_dwordx4 v[156:159], v1, s[12:15], s6 offen offset:1024 nt
    s_waitcnt vmcnt(16)
    ds_write_b128 v2, a[216:219] offset:0
    ds_write_b128 v3, a[220:223] offset:0
    ds_write_b128 v4, a[224:227] offset:0
    ds_write_b128 v2, a[228:231] offset:3328
    ds_write_b128 v3, a[232:235] offset:3328
    ds_write_b128 v4, a[236:239] offset:3328
    ds_read_b64_tr_b16 a[192:193], v6 offset:0
    ds_read_b64_tr_b16 a[196:197], v6 offset:32
    ds_read_b64_tr_b16 a[200:201], v6 offset:64
    ds_read_b64_tr_b16 a[204:205], v6 offset:96
    ds_read_b64_tr_b16 a[208:209], v6 offset:128
    ds_read_b64_tr_b16 a[212:213], v6 offset:160
    ds_read_b64_tr_b16 a[216:217], v6 offset:192
    ds_read_b64_tr_b16 a[220:221], v6 offset:224
    ds_read_b64_tr_b16 a[224:225], v6 offset:256
    ds_read_b64_tr_b16 a[228:229], v6 offset:288
    ds_read_b64_tr_b16 a[232:233], v6 offset:320
    ds_read_b64_tr_b16 a[236:237], v6 offset:352
    s_waitcnt vmcnt(12)
    v_max3_u32 v24, v64, v65, v66
    v_max3_u32 v24, v24, v67, v68
    v_max3_u32 v24, v24, v69, v70
    v_max3_u32 v24, v24, v71, v72
    v_max3_u32 v24, v24, v73, v74
    v_max3_u32 v24, v24, v75, v76
    v_max3_u32 v24, v24, v77, v78
    v_max_u32 v24, v24, v79
    v_cmp_eq_u32 vcc, -1, v24
    s_cbranch_vccnz RETRY4
OK4:
    v_add_f32 v64, v64, v68
    v_add_f32 v65, v65, v69
    v_add_f32 v66, v66, v70
    v_add_f32 v67, v67, v71
    s_nop 0
    v_permlane32_swap_b32 v64, v66
    v_permlane32_swap_b32 v65, v67
    v_add_f32 v64, v64, v66
    v_add_f32 v65, v65, v67
    s_nop 1
    v_permlane16_swap_b32 v64, v65
    v_add_f32 v64, v64, v65
    v_add_f32 v72, v72, v76
    v_add_f32 v73, v73, v77
    v_add_f32 v74, v74, v78
    v_add_f32 v75, v75, v79
    s_nop 0
    v_permlane32_swap_b32 v72, v74
    v_permlane32_swap_b32 v73, v75
    v_add_f32 v72, v72, v74
    v_add_f32 v73, v73, v75
    s_nop 1
    v_permlane16_swap_b32 v72, v73
    v_add_f32 v72, v72, v73
    v_mul_f32 v7, 0x3acccccd, v64
    v_mov_b32 v24, v72
    s_nop 0
    v_readlane_b32 s77, v24, 15
    s_nop 1
    v_fma_f32 v25, -s77, v7, v24
    v_cvt_pk_bf16_f32 v25, v25, v25
    ds_write_b16 v12, v25
    s_mov_b32 vcc_lo, 0x70007000
    s_mov_b32 vcc_hi, 0x70007000
    v_cndmask_b32 v26, 0, v24, vcc
    s_waitcnt lgkmcnt(0)
    s_barrier
    ds_read_b128 v[40:43], v13 offset:0
    ds_read_b128 v[44:47], v13 offset:64
    ds_read_b128 v[48:51], v13 offset:128
    ds_read_b128 v[52:55], v13 offset:192
    ds_read_b128 v[56:59], v13 offset:256
    ds_read_b128 v[60:63], v13 offset:320
    v_add_f32_dpp v26, v26, v26 row_ror:8 row_mask:0xf bank_mask:0xf
    s_nop 1
    v_add_f32_dpp v26, v26, v26 row_ror:4 row_mask:0xf bank_mask:0xf
    s_nop 1
    v_add_f32_dpp v26, v26, v26 row_ror:2 row_mask:0xf bank_mask:0xf
    s_nop 1
    v_add_f32_dpp v26, v26, v26 row_ror:1 row_mask:0xf bank_mask:0xf
    v_mov_b32 v27, v26
    s_nop 1
    v_permlane32_swap_b32 v26, v27
    v_add_f32 v26, v26, v27
    v_mov_b32 v27, v26
    s_nop 1
    v_permlane16_swap_b32 v26, v27
    v_add_f32 v26, v26, v27
    v_mov_b32 v27, s77
    v_subrev_f32 v27, 0x44200000, v27
    v_sub_f32 v26, v26, v27
    v_mul_f32 v27, 0x3acccccd, v27
    v_mul_f32 v26, 0x3acccccd, v26
    v_fma_f32 v26, -v27, v27, v26
    v_max_f32 v26, 0, v26
    v_add_f32 v26, 0x3727c5ac, v26
    v_rsq_f32 v26, v26
    s_nop 0
    v_mul_f32 v18, 0x3dd53b94, v26
    s_waitcnt lgkmcnt(0)
    v_mfma_f32_16x16x32_bf16 v[80:83], a[0:3], v[40:43], 0
    v_mfma_f32_16x16x32_bf16 v[80:83], a[4:7], v[44:47], v[80:83]
    v_mfma_f32_16x16x32_bf16 v[80:83], a[8:11], v[48:51], v[80:83]
    v_mfma_f32_16x16x32_bf16 v[80:83], a[12:15], v[52:55], v[80:83]
    v_mfma_f32_16x16x32_bf16 v[80:83], a[16:19], v[56:59], v[80:83]
    v_mfma_f32_16x16x32_bf16 v[80:83], a[20:23], v[60:63], v[80:83]
    v_mfma_f32_16x16x32_bf16 v[68:71], a[24:27], v[40:43], 0
    v_mfma_f32_16x16x32_bf16 v[68:71], a[28:31], v[44:47], v[68:71]
    v_mfma_f32_16x16x32_bf16 v[68:71], a[32:35], v[48:51], v[68:71]
    v_mfma_f32_16x16x32_bf16 v[68:71], a[36:39], v[52:55], v[68:71]
    v_mfma_f32_16x16x32_bf16 v[68:71], a[40:43], v[56:59], v[68:71]
    v_mfma_f32_16x16x32_bf16 v[68:71], a[44:47], v[60:63], v[68:71]
    v_mfma_f32_16x16x32_bf16 v[72:75], a[48:51], v[40:43], 0
    v_mfma_f32_16x16x32_bf16 v[72:75], a[52:55], v[44:47], v[72:75]
    v_mfma_f32_16x16x32_bf16 v[72:75], a[56:59], v[48:51], v[72:75]
    v_mfma_f32_16x16x32_bf16 v[72:75], a[60:63], v[52:55], v[72:75]
    v_mfma_f32_16x16x32_bf16 v[72:75], a[64:67], v[56:59], v[72:75]
    v_mfma_f32_16x16x32_bf16 v[72:75], a[68:71], v[60:63], v[72:75]
    v_mfma_f32_16x16x32_bf16 v[76:79], a[72:75], v[40:43], 0
    v_mfma_f32_16x16x32_bf16 v[76:79], a[76:79], v[44:47], v[76:79]
    v_mfma_f32_16x16x32_bf16 v[76:79], a[80:83], v[48:51], v[76:79]
    v_cndmask_b32 v80, v80, v68, s[82:83]
    v_mfma_f32_16x16x32_bf16 v[76:79], a[84:87], v[52:55], v[76:79]
    v_cndmask_b32 v81, v81, v69, s[82:83]
    v_mfma_f32_16x16x32_bf16 v[76:79], a[88:91], v[56:59], v[76:79]
    v_cndmask_b32 v82, v82, v70, s[82:83]
    v_mfma_f32_16x16x32_bf16 v[76:79], a[92:95], v[60:63], v[76:79]
    v_cndmask_b32 v83, v83, v71, s[82:83]
    v_mfma_f32_16x16x32_bf16 v[64:67], a[96:99], v[40:43], 0
    v_mfma_f32_16x16x32_bf16 v[64:67], a[100:103], v[44:47], v[64:67]
    v_mfma_f32_16x16x32_bf16 v[64:67], a[104:107], v[48:51], v[64:67]
    v_cndmask_b32 v80, v80, v72, s[84:85]
    v_mfma_f32_16x16x32_bf16 v[64:67], a[108:111], v[52:55], v[64:67]
    v_cndmask_b32 v81, v81, v73, s[84:85]
    v_mfma_f32_16x16x32_bf16 v[64:67], a[112:115], v[56:59], v[64:67]
    v_cndmask_b32 v82, v82, v74, s[84:85]
    v_mfma_f32_16x16x32_bf16 v[64:67], a[116:119], v[60:63], v[64:67]
    v_cndmask_b32 v83, v83, v75, s[84:85]
    v_mfma_f32_16x16x32_bf16 v[68:71], a[120:123], v[40:43], 0
    v_mfma_f32_16x16x32_bf16 v[68:71], a[124:127], v[44:47], v[68:71]
    v_mfma_f32_16x16x32_bf16 v[68:71], a[128:131], v[48:51], v[68:71]
    v_cndmask_b32 v80, v80, v76, s[86:87]
    v_mfma_f32_16x16x32_bf16 v[68:71], a[132:135], v[52:55], v[68:71]
    v_cndmask_b32 v81, v81, v77, s[86:87]
    v_mfma_f32_16x16x32_bf16 v[68:71], a[136:139], v[56:59], v[68:71]
    v_cndmask_b32 v82, v82, v78, s[86:87]
    v_mfma_f32_16x16x32_bf16 v[68:71], a[140:143], v[60:63], v[68:71]
    v_cndmask_b32 v83, v83, v79, s[86:87]
    v_mfma_f32_16x16x32_bf16 v[72:75], a[144:147], v[40:43], 0
    v_mfma_f32_16x16x32_bf16 v[72:75], a[148:151], v[44:47], v[72:75]
    v_mfma_f32_16x16x32_bf16 v[72:75], a[152:155], v[48:51], v[72:75]
    v_cndmask_b32 v80, v80, v64, s[88:89]
    v_mfma_f32_16x16x32_bf16 v[72:75], a[156:159], v[52:55], v[72:75]
    v_cndmask_b32 v81, v81, v65, s[88:89]
    v_mfma_f32_16x16x32_bf16 v[72:75], a[160:163], v[56:59], v[72:75]
    v_cndmask_b32 v82, v82, v66, s[88:89]
    v_mfma_f32_16x16x32_bf16 v[72:75], a[164:167], v[60:63], v[72:75]
    v_cndmask_b32 v83, v83, v67, s[88:89]
    v_mfma_f32_16x16x32_bf16 v[76:79], a[168:171], v[40:43], 0
    v_mfma_f32_16x16x32_bf16 v[76:79], a[172:175], v[44:47], v[76:79]
    v_mfma_f32_16x16x32_bf16 v[76:79], a[176:179], v[48:51], v[76:79]
    v_cndmask_b32 v80, v80, v68, s[90:91]
    v_mfma_f32_16x16x32_bf16 v[76:79], a[180:183], v[52:55], v[76:79]
    v_cndmask_b32 v81, v81, v69, s[90:91]
    v_mfma_f32_16x16x32_bf16 v[76:79], a[184:187], v[56:59], v[76:79]
    v_cndmask_b32 v82, v82, v70, s[90:91]
    v_mfma_f32_16x16x32_bf16 v[76:79], a[188:191], v[60:63], v[76:79]
    v_cndmask_b32 v83, v83, v71, s[90:91]
    v_cndmask_b32 v80, v80, v72, s[92:93]
    v_cndmask_b32 v81, v81, v73, s[92:93]
    v_cndmask_b32 v82, v82, v74, s[92:93]
    v_cndmask_b32 v83, v83, v75, s[92:93]
    s_nop 2
    v_cndmask_b32 v80, v80, v76, s[94:95]
    v_cndmask_b32 v81, v81, v77, s[94:95]
    v_cndmask_b32 v82, v82, v78, s[94:95]
    v_cndmask_b32 v83, v83, v79, s[94:95]
    v_max3_f32 v19, v80, v81, v82
    v_max_f32 v19, v19, v83
    s_nop 1
    v_max_f32_dpp v19, v19, v19 row_ror:4 row_mask:0xf bank_mask:0xf
    s_nop 1
    v_max_f32_dpp v19, v19, v19 row_ror:2 row_mask:0xf bank_mask:0xf
    s_nop 1
    v_max_f32_dpp v19, v19, v19 row_ror:1 row_mask:0xf bank_mask:0xf
    v_mov_b32 v64, v19
    s_nop 1
    v_permlane32_swap_b32 v19, v64
    v_max_f32 v19, v19, v64
    v_mov_b32 v64, v19
    s_nop 1
    v_permlane16_swap_b32 v19, v64
    v_max_f32 v19, v19, v64
    v_mul_f32 v19, v19, v18
    v_fma_f32 v80, v80, v18, -v19
    v_fma_f32 v81, v81, v18, -v19
    v_fma_f32 v82, v82, v18, -v19
    v_fma_f32 v83, v83, v18, -v19
    v_exp_f32 v80, v80
    v_exp_f32 v81, v81
    v_exp_f32 v82, v82
    v_exp_f32 v83, v83
    v_cvt_pk_bf16_f32 v32, v80, v81
    v_cvt_pk_bf16_f32 v33, v82, v83
    v_add_f32 v37, v80, v81
    v_add_f32 v38, v82, v83
    v_add_f32 v37, v37, v38
    s_nop 1
    v_add_f32_dpp v37, v37, v37 row_ror:4 row_mask:0xf bank_mask:0xf
    s_nop 1
    v_add_f32_dpp v37, v37, v37 row_ror:2 row_mask:0xf bank_mask:0xf
    s_nop 1
    v_add_f32_dpp v37, v37, v37 row_ror:1 row_mask:0xf bank_mask:0xf
    v_mov_b32 v38, v37
    s_nop 1
    v_permlane32_swap_b32 v37, v38
    v_add_f32 v37, v37, v38
    v_mov_b32 v38, v37
    s_nop 1
    v_permlane16_swap_b32 v37, v38
    v_add_f32 v37, v37, v38
    v_mov_b32 v36, v19
    s_lshl_b32 s77, s71, 5
    s_lshl_b32 s78, s72, 3
    s_add_u32 s77, s77, s78
    s_add_u32 s77, s77, s3
    s_mov_b64 exec, 1
    s_cmp_eq_u32 s75, 1
    s_cbranch_scc0 SLOW5
    buffer_store_dwordx2 v[36:37], v14, s[16:19], s77 offen
BACK5:
    s_mov_b64 exec, -1
    s_add_u32 s6, s73, 589824
    buffer_load_dwordx4 v[160:163], v1, s[12:15], s6 offen offset:0 nt
    buffer_load_dwordx4 v[164:167], v1, s[12:15], s6 offen offset:1024 nt
    buffer_load_dwordx4 v[168:171], v1, s[12:15], s6 offen offset:2048 nt
    buffer_load_dwordx4 v[172:175], v1, s[12:15], s6 offen offset:3072 nt
    s_add_u32 s6, s6, 4096
    buffer_load_dwordx4 v[176:179], v1, s[12:15], s6 offen offset:0 nt
    buffer_load_dwordx4 v[180:183], v1, s[12:15], s6 offen offset:1024 nt
    s_waitcnt vmcnt(13)
    ds_write_b128 v2, v[112:115] offset:0
    ds_write_b128 v3, v[116:119] offset:0
    ds_write_b128 v4, v[120:123] offset:0
    ds_write_b128 v2, v[124:127] offset:3328
    ds_write_b128 v3, v[128:131] offset:3328
    ds_write_b128 v4, v[132:135] offset:3328
    ds_read_b64_tr_b16 a[194:195], v6 offset:0
    ds_read_b64_tr_b16 a[198:199], v6 offset:32
    ds_read_b64_tr_b16 a[202:203], v6 offset:64
    ds_read_b64_tr_b16 a[206:207], v6 offset:96
    ds_read_b64_tr_b16 a[210:211], v6 offset:128
    ds_read_b64_tr_b16 a[214:215], v6 offset:160
    ds_read_b64_tr_b16 a[218:219], v6 offset:192
    ds_read_b64_tr_b16 a[222:223], v6 offset:224
    ds_read_b64_tr_b16 a[226:227], v6 offset:256
    ds_read_b64_tr_b16 a[230:231], v6 offset:288
    ds_read_b64_tr_b16 a[234:235], v6 offset:320
    ds_read_b64_tr_b16 a[238:239], v6 offset:352
    s_add_u32 s6, s73, 786432
    buffer_load_dwordx4 v[184:187], v1, s[12:15], s6 offen offset:0 nt
    buffer_load_dwordx4 v[188:191], v1, s[12:15], s6 offen offset:1024 nt
    buffer_load_dwordx4 v[192:195], v1, s[12:15], s6 offen offset:2048 nt
    buffer_load_dwordx4 v[196:199], v1, s[12:15], s6 offen offset:3072 nt
    s_add_u32 s6, s6, 4096
    buffer_load_dwordx4 v[200:203], v1, s[12:15], s6 offen offset:0 nt
    buffer_load_dwordx4 v[204:207], v1, s[12:15], s6 offen offset:1024 nt
    v_mov_b32_dpp v24, v32 row_newbcast:0 row_mask:0xf bank_mask:0xf
    v_mov_b32_dpp v25, v33 row_newbcast:0 row_mask:0xf bank_mask:0xf
    v_mov_b32_dpp v26, v32 row_newbcast:1 row_mask:0xf bank_mask:0xf
    v_mov_b32_dpp v27, v33 row_newbcast:1 row_mask:0xf bank_mask:0xf
    s_waitcnt lgkmcnt(0)
    s_nop 0
    v_mfma_f32_16x16x32_bf16 v[40:43], v[24:27], a[192:195], 0
    v_mfma_f32_16x16x32_bf16 v[44:47], v[24:27], a[196:199], 0
    v_mfma_f32_16x16x32_bf16 v[48:51], v[24:27], a[200:203], 0
    v_mfma_f32_16x16x32_bf16 v[52:55], v[24:27], a[204:207], 0
    v_mfma_f32_16x16x32_bf16 v[56:59], v[24:27], a[208:211], 0
    v_mfma_f32_16x16x32_bf16 v[60:63], v[24:27], a[212:215], 0
    v_mfma_f32_16x16x32_bf16 v[64:67], v[24:27], a[216:219], 0
    v_mfma_f32_16x16x32_bf16 v[68:71], v[24:27], a[220:223], 0
    v_mfma_f32_16x16x32_bf16 v[72:75], v[24:27], a[224:227], 0
    v_mfma_f32_16x16x32_bf16 v[76:79], v[24:27], a[228:231], 0
    v_mfma_f32_16x16x32_bf16 v[80:83], v[24:27], a[232:235], 0
    v_mfma_f32_16x16x32_bf16 v[84:87], v[24:27], a[236:239], 0
    s_waitcnt vmcnt(13)
    ds_write_b128 v2, v[136:139] offset:0
    ds_write_b128 v3, v[140:143] offset:0
    ds_write_b128 v4, v[144:147] offset:0
    ds_write_b128 v2, v[148:151] offset:3328
    ds_write_b128 v3, v[152:155] offset:3328
    ds_write_b128 v4, v[156:159] offset:3328
    ds_read_b64_tr_b16 v[112:113], v6 offset:0
    ds_read_b64_tr_b16 v[116:117], v6 offset:32
    ds_read_b64_tr_b16 v[120:121], v6 offset:64
    ds_read_b64_tr_b16 v[124:125], v6 offset:96
    ds_read_b64_tr_b16 v[128:129], v6 offset:128
    ds_read_b64_tr_b16 v[132:133], v6 offset:160
    ds_read_b64_tr_b16 v[136:137], v6 offset:192
    ds_read_b64_tr_b16 v[140:141], v6 offset:224
    ds_read_b64_tr_b16 v[144:145], v6 offset:256
    ds_read_b64_tr_b16 v[148:149], v6 offset:288
    ds_read_b64_tr_b16 v[152:153], v6 offset:320
    ds_read_b64_tr_b16 v[156:157], v6 offset:352
    s_add_u32 s6, s73, 983040
    buffer_load_dwordx4 v[208:211], v1, s[12:15], s6 offen offset:0 nt
    buffer_load_dwordx4 v[212:215], v1, s[12:15], s6 offen offset:1024 nt
    buffer_load_dwordx4 v[216:219], v1, s[12:15], s6 offen offset:2048 nt
    buffer_load_dwordx4 v[220:223], v1, s[12:15], s6 offen offset:3072 nt
    s_add_u32 s6, s6, 4096
    buffer_load_dwordx4 v[224:227], v1, s[12:15], s6 offen offset:0 nt
    buffer_load_dwordx4 v[228:231], v1, s[12:15], s6 offen offset:1024 nt
    s_waitcnt vmcnt(12)
    ds_write_b128 v2, v[160:163] offset:0
    ds_write_b128 v3, v[164:167] offset:0
    ds_write_b128 v4, v[168:171] offset:0
    ds_write_b128 v2, v[172:175] offset:3328
    ds_write_b128 v3, v[176:179] offset:3328
    ds_write_b128 v4, v[180:183] offset:3328
    ds_read_b64_tr_b16 v[114:115], v6 offset:0
    ds_read_b64_tr_b16 v[118:119], v6 offset:32
    ds_read_b64_tr_b16 v[122:123], v6 offset:64
    ds_read_b64_tr_b16 v[126:127], v6 offset:96
    ds_read_b64_tr_b16 v[130:131], v6 offset:128
    ds_read_b64_tr_b16 v[134:135], v6 offset:160
    ds_read_b64_tr_b16 v[138:139], v6 offset:192
    ds_read_b64_tr_b16 v[142:143], v6 offset:224
    ds_read_b64_tr_b16 v[146:147], v6 offset:256
    ds_read_b64_tr_b16 v[150:151], v6 offset:288
    ds_read_b64_tr_b16 v[154:155], v6 offset:320
    ds_read_b64_tr_b16 v[158:159], v6 offset:352
    s_add_u32 s6, s73, 1179648
    buffer_load_dwordx4 v[232:235], v1, s[12:15], s6 offen offset:0 nt
    buffer_load_dwordx4 v[236:239], v1, s[12:15], s6 offen offset:1024 nt
    buffer_load_dwordx4 v[240:243], v1, s[12:15], s6 offen offset:2048 nt
    buffer_load_dwordx4 v[244:247], v1, s[12:15], s6 offen offset:3072 nt
    s_add_u32 s6, s6, 4096
    buffer_load_dwordx4 v[248:251], v1, s[12:15], s6 offen offset:0 nt
    buffer_load_dwordx4 v[252:255], v1, s[12:15], s6 offen offset:1024 nt
    v_mov_b32_dpp v28, v32 row_newbcast:2 row_mask:0xf bank_mask:0xf
    v_mov_b32_dpp v29, v33 row_newbcast:2 row_mask:0xf bank_mask:0xf
    v_mov_b32_dpp v30, v32 row_newbcast:3 row_mask:0xf bank_mask:0xf
    v_mov_b32_dpp v31, v33 row_newbcast:3 row_mask:0xf bank_mask:0xf
    s_waitcnt lgkmcnt(0)
    s_nop 0
    v_mfma_f32_16x16x32_bf16 v[40:43], v[28:31], v[112:115], v[40:43]
    v_mfma_f32_16x16x32_bf16 v[44:47], v[28:31], v[116:119], v[44:47]
    v_mfma_f32_16x16x32_bf16 v[48:51], v[28:31], v[120:123], v[48:51]
    v_mfma_f32_16x16x32_bf16 v[52:55], v[28:31], v[124:127], v[52:55]
    v_mfma_f32_16x16x32_bf16 v[56:59], v[28:31], v[128:131], v[56:59]
    v_mfma_f32_16x16x32_bf16 v[60:63], v[28:31], v[132:135], v[60:63]
    v_mfma_f32_16x16x32_bf16 v[64:67], v[28:31], v[136:139], v[64:67]
    v_mfma_f32_16x16x32_bf16 v[68:71], v[28:31], v[140:143], v[68:71]
    v_mfma_f32_16x16x32_bf16 v[72:75], v[28:31], v[144:147], v[72:75]
    v_mfma_f32_16x16x32_bf16 v[76:79], v[28:31], v[148:151], v[76:79]
    v_mfma_f32_16x16x32_bf16 v[80:83], v[28:31], v[152:155], v[80:83]
    v_mfma_f32_16x16x32_bf16 v[84:87], v[28:31], v[156:159], v[84:87]
    s_waitcnt vmcnt(12)
    ds_write_b128 v2, v[184:187] offset:0
    ds_write_b128 v3, v[188:191] offset:0
    ds_write_b128 v4, v[192:195] offset:0
    ds_write_b128 v2, v[196:199] offset:3328
    ds_write_b128 v3, v[200:203] offset:3328
    ds_write_b128 v4, v[204:207] offset:3328
    ds_read_b64_tr_b16 v[160:161], v6 offset:0
    ds_read_b64_tr_b16 v[164:165], v6 offset:32
    ds_read_b64_tr_b16 v[168:169], v6 offset:64
    ds_read_b64_tr_b16 v[172:173], v6 offset:96
    ds_read_b64_tr_b16 v[176:177], v6 offset:128
    ds_read_b64_tr_b16 v[180:181], v6 offset:160
    ds_read_b64_tr_b16 v[184:185], v6 offset:192
    ds_read_b64_tr_b16 v[188:189], v6 offset:224
    ds_read_b64_tr_b16 v[192:193], v6 offset:256
    ds_read_b64_tr_b16 v[196:197], v6 offset:288
    ds_read_b64_tr_b16 v[200:201], v6 offset:320
    ds_read_b64_tr_b16 v[204:205], v6 offset:352
    s_add_u32 s6, s73, 1376256
    buffer_load_dwordx4 v[88:91], v1, s[12:15], s6 offen offset:0 nt
    buffer_load_dwordx4 v[92:95], v1, s[12:15], s6 offen offset:1024 nt
    buffer_load_dwordx4 v[96:99], v1, s[12:15], s6 offen offset:2048 nt
    buffer_load_dwordx4 v[100:103], v1, s[12:15], s6 offen offset:3072 nt
    s_add_u32 s6, s6, 4096
    buffer_load_dwordx4 v[104:107], v1, s[12:15], s6 offen offset:0 nt
    buffer_load_dwordx4 v[108:111], v1, s[12:15], s6 offen offset:1024 nt
    s_waitcnt vmcnt(12)
    ds_write_b128 v2, v[208:211] offset:0
    ds_write_b128 v3, v[212:215] offset:0
    ds_write_b128 v4, v[216:219] offset:0
    ds_write_b128 v2, v[220:223] offset:3328
    ds_write_b128 v3, v[224:227] offset:3328
    ds_write_b128 v4, v[228:231] offset:3328
    ds_read_b64_tr_b16 v[162:163], v6 offset:0
    ds_read_b64_tr_b16 v[166:167], v6 offset:32
    ds_read_b64_tr_b16 v[170:171], v6 offset:64
    ds_read_b64_tr_b16 v[174:175], v6 offset:96
    ds_read_b64_tr_b16 v[178:179], v6 offset:128
    ds_read_b64_tr_b16 v[182:183], v6 offset:160
    ds_read_b64_tr_b16 v[186:187], v6 offset:192
    ds_read_b64_tr_b16 v[190:191], v6 offset:224
    ds_read_b64_tr_b16 v[194:195], v6 offset:256
    ds_read_b64_tr_b16 v[198:199], v6 offset:288
    ds_read_b64_tr_b16 v[202:203], v6 offset:320
    ds_read_b64_tr_b16 v[206:207], v6 offset:352
    v_mov_b32_dpp v24, v32 row_newbcast:4 row_mask:0xf bank_mask:0xf
    v_mov_b32_dpp v25, v33 row_newbcast:4 row_mask:0xf bank_mask:0xf
    v_mov_b32_dpp v26, v32 row_newbcast:5 row_mask:0xf bank_mask:0xf
    v_mov_b32_dpp v27, v33 row_newbcast:5 row_mask:0xf bank_mask:0xf
    s_waitcnt lgkmcnt(0)
    s_nop 0
    v_mfma_f32_16x16x32_bf16 v[40:43], v[24:27], v[160:163], v[40:43]
    v_mfma_f32_16x16x32_bf16 v[44:47], v[24:27], v[164:167], v[44:47]
    v_mfma_f32_16x16x32_bf16 v[48:51], v[24:27], v[168:171], v[48:51]
    v_mfma_f32_16x16x32_bf16 v[52:55], v[24:27], v[172:175], v[52:55]
    v_mfma_f32_16x16x32_bf16 v[56:59], v[24:27], v[176:179], v[56:59]
    v_mfma_f32_16x16x32_bf16 v[60:63], v[24:27], v[180:183], v[60:63]
    v_mfma_f32_16x16x32_bf16 v[64:67], v[24:27], v[184:187], v[64:67]
    v_mfma_f32_16x16x32_bf16 v[68:71], v[24:27], v[188:191], v[68:71]
    v_mfma_f32_16x16x32_bf16 v[72:75], v[24:27], v[192:195], v[72:75]
    v_mfma_f32_16x16x32_bf16 v[76:79], v[24:27], v[196:199], v[76:79]
    v_mfma_f32_16x16x32_bf16 v[80:83], v[24:27], v[200:203], v[80:83]
    v_mfma_f32_16x16x32_bf16 v[84:87], v[24:27], v[204:207], v[84:87]
    s_waitcnt vmcnt(6)
    ds_write_b128 v2, v[232:235] offset:0
    ds_write_b128 v3, v[236:239] offset:0
    ds_write_b128 v4, v[240:243] offset:0
    ds_write_b128 v2, v[244:247] offset:3328
    ds_write_b128 v3, v[248:251] offset:3328
    ds_write_b128 v4, v[252:255] offset:3328
    ds_read_b64_tr_b16 v[208:209], v6 offset:0
    ds_read_b64_tr_b16 v[212:213], v6 offset:32
    ds_read_b64_tr_b16 v[216:217], v6 offset:64
    ds_read_b64_tr_b16 v[220:221], v6 offset:96
    ds_read_b64_tr_b16 v[224:225], v6 offset:128
    ds_read_b64_tr_b16 v[228:229], v6 offset:160
    ds_read_b64_tr_b16 v[232:233], v6 offset:192
    ds_read_b64_tr_b16 v[236:237], v6 offset:224
    ds_read_b64_tr_b16 v[240:241], v6 offset:256
    ds_read_b64_tr_b16 v[244:245], v6 offset:288
    ds_read_b64_tr_b16 v[248:249], v6 offset:320
    ds_read_b64_tr_b16 v[252:253], v6 offset:352
    v_mov_b32_dpp v28, v32 row_newbcast:6 row_mask:0xf bank_mask:0xf
    v_mov_b32_dpp v29, v33 row_newbcast:6 row_mask:0xf bank_mask:0xf
    v_mov_b32_dpp v30, v32 row_newbcast:7 row_mask:0xf bank_mask:0xf
    v_mov_b32_dpp v31, v33 row_newbcast:7 row_mask:0xf bank_mask:0xf
    s_waitcnt vmcnt(0)
    ds_write_b128 v2, v[88:91] offset:0
    ds_write_b128 v3, v[92:95] offset:0
    ds_write_b128 v4, v[96:99] offset:0
    ds_write_b128 v2, v[100:103] offset:3328
    ds_write_b128 v3, v[104:107] offset:3328
    ds_write_b128 v4, v[108:111] offset:3328
    ds_read_b64_tr_b16 v[210:211], v6 offset:0
    ds_read_b64_tr_b16 v[214:215], v6 offset:32
    ds_read_b64_tr_b16 v[218:219], v6 offset:64
    ds_read_b64_tr_b16 v[222:223], v6 offset:96
    ds_read_b64_tr_b16 v[226:227], v6 offset:128
    ds_read_b64_tr_b16 v[230:231], v6 offset:160
    ds_read_b64_tr_b16 v[234:235], v6 offset:192
    ds_read_b64_tr_b16 v[238:239], v6 offset:224
    ds_read_b64_tr_b16 v[242:243], v6 offset:256
    ds_read_b64_tr_b16 v[246:247], v6 offset:288
    ds_read_b64_tr_b16 v[250:251], v6 offset:320
    ds_read_b64_tr_b16 v[254:255], v6 offset:352
    buffer_load_dwordx2 v[34:35], v14, s[16:19], s3 offen sc1
    s_waitcnt lgkmcnt(0)
    v_mfma_f32_16x16x32_bf16 v[40:43], v[28:31], v[208:211], v[40:43]
    v_mfma_f32_16x16x32_bf16 v[44:47], v[28:31], v[212:215], v[44:47]
    v_mfma_f32_16x16x32_bf16 v[48:51], v[28:31], v[216:219], v[48:51]
    v_mfma_f32_16x16x32_bf16 v[52:55], v[28:31], v[220:223], v[52:55]
    v_mfma_f32_16x16x32_bf16 v[56:59], v[28:31], v[224:227], v[56:59]
    v_mfma_f32_16x16x32_bf16 v[60:63], v[28:31], v[228:231], v[60:63]
    v_mfma_f32_16x16x32_bf16 v[64:67], v[28:31], v[232:235], v[64:67]
    v_mfma_f32_16x16x32_bf16 v[68:71], v[28:31], v[236:239], v[68:71]
    v_mfma_f32_16x16x32_bf16 v[72:75], v[28:31], v[240:243], v[72:75]
    v_mfma_f32_16x16x32_bf16 v[76:79], v[28:31], v[244:247], v[76:79]
    v_mfma_f32_16x16x32_bf16 v[80:83], v[28:31], v[248:251], v[80:83]
    v_mfma_f32_16x16x32_bf16 v[84:87], v[28:31], v[252:255], v[84:87]
    s_branch ATT_END
LOOP:
    ds_read_b64_tr_b16 v[40:41], v16 offset:0
    ds_read_b64_tr_b16 v[42:43], v16 offset:1536
    ds_read_b64_tr_b16 v[44:45], v16 offset:12288
    ds_read_b64_tr_b16 v[46:47], v16 offset:13824
    ds_read_b64_tr_b16 v[48:49], v17 offset:24576
    ds_read_b64_tr_b16 v[50:51], v16 offset:32
    ds_read_b64_tr_b16 v[52:53], v16 offset:1568
    ds_read_b64_tr_b16 v[54:55], v16 offset:12320
    ds_read_b64_tr_b16 v[56:57], v16 offset:13856
    ds_read_b64_tr_b16 v[58:59], v17 offset:24608
    ds_read_b64_tr_b16 v[60:61], v16 offset:64
    ds_read_b64_tr_b16 v[62:63], v16 offset:1600
    ds_read_b64_tr_b16 v[64:65], v16 offset:12352
    ds_read_b64_tr_b16 v[66:67], v16 offset:13888
    ds_read_b64_tr_b16 v[68:69], v17 offset:24640
    v_and_b32 v25, 15, v0
    v_cmp_eq_u32 vcc, 12, v25
    v_mov_b32 v36, 0x3f803f80
    s_nop 0
    v_cndmask_b32 v70, 0, v36, vcc
    v_mov_b32 v71, v70
    v_mov_b32 v72, v70
    v_mov_b32 v73, v70
    v_mov_b32 v74, v70
    v_mov_b32 v75, v70
    v_mov_b32 v76, v70
    v_mov_b32 v77, v70
    v_mov_b32 v78, v70
    v_mov_b32 v79, v70
    s_mov_b32 exec_lo, 0x1ff01ff
    s_mov_b32 exec_hi, 0x1ff01ff
    s_mov_b32 s76, 0
POLL6:
    buffer_load_dwordx4 v[70:73], v8, s[16:19], 0 offen sc1
    buffer_load_dwordx4 v[74:77], v8, s[16:19], 0 offen offset:64 sc1
    buffer_load_dwordx2 v[78:79], v9, s[16:19], 0 offen offset:128 sc1
    s_add_u32 s76, s76, 1
    s_cmp_ge_u32 s76, 32768
    s_waitcnt vmcnt(0)
    v_max3_u32 v24, v70, v74, v78
    v_cmp_eq_u32 vcc, -1, v24
    s_cbranch_scc1 POLLX6
    s_cbranch_vccnz POLL6
POLLX6:
    s_mov_b64 exec, -1
    s_waitcnt lgkmcnt(0)
    v_mfma_f32_16x16x32_bf16 v[24:27], v[70:73], v[40:43], 0
    v_mfma_f32_16x16x32_bf16 v[28:31], v[70:73], v[50:53], 0
    v_mfma_f32_16x16x32_bf16 v[32:35], v[70:73], v[60:63], 0
    v_mfma_f32_16x16x32_bf16 v[36:39], v[70:73], v[70:73], 0
    v_mfma_f32_16x16x32_bf16 v[24:27], v[74:77], v[44:47], v[24:27]
    v_mfma_f32_16x16x32_bf16 v[28:31], v[74:77], v[54:57], v[28:31]
    v_mfma_f32_16x16x32_bf16 v[32:35], v[74:77], v[64:67], v[32:35]
    v_mfma_f32_16x16x32_bf16 v[36:39], v[74:77], v[74:77], v[36:39]
    v_mfma_f32_16x16x16_bf16 v[24:27], v[78:79], v[48:49], v[24:27]
    v_mfma_f32_16x16x16_bf16 v[28:31], v[78:79], v[58:59], v[28:31]
    v_mfma_f32_16x16x16_bf16 v[32:35], v[78:79], v[68:69], v[32:35]
    v_mfma_f32_16x16x16_bf16 v[36:39], v[78:79], v[78:79], v[36:39]
    s_nop 4
    v_add_f32 v24, v24, v25
    v_add_f32 v26, v26, v27
    v_add_f32 v28, v28, v29
    v_add_f32 v30, v30, v31
    v_add_f32 v32, v32, v33
    v_add_f32 v34, v34, v35
    v_add_f32 v36, v36, v37
    v_add_f32 v38, v38, v39
    v_add_f32 v24, v24, v26
    v_add_f32 v28, v28, v30
    v_add_f32 v32, v32, v34
    v_add_f32 v36, v36, v38
    s_nop 0
    v_permlane32_swap_b32 v24, v32
    v_permlane32_swap_b32 v28, v36
    v_add_f32 v24, v24, v32
    v_add_f32 v28, v28, v36
    s_nop 1
    v_permlane16_swap_b32 v24, v28
    v_add_f32 v24, v24, v28
    s_cmp_eq_u32 s75, 1
    s_cbranch_scc0 SLOW7
    buffer_store_dword v24, v10, s[16:19], s3 offen
BACK7:
    s_add_u32 s79, s3, 4096
    s_mov_b32 s76, 0
POLL8:
    buffer_load_dwordx4 v[24:27], v11, s[16:19], s3 offen sc1
    buffer_load_dwordx4 v[28:31], v11, s[16:19], s79 offen sc1
    s_add_u32 s76, s76, 1
    s_cmp_ge_u32 s76, 32768
    s_waitcnt vmcnt(0)
    v_max3_u32 v32, v24, v25, v26
    v_max3_u32 v32, v32, v27, v28
    v_max3_u32 v32, v32, v29, v30
    v_max_u32 v32, v32, v31
    v_cmp_eq_u32 vcc, -1, v32
    s_cbranch_scc1 POLLX8
    s_cbranch_vccnz POLL8
POLLX8:
    v_add_f32 v24, v24, v28
    v_add_f32 v25, v25, v29
    v_add_f32 v26, v26, v30
    v_add_f32 v27, v27, v31
    s_nop 0
    v_permlane32_swap_b32 v24, v26
    v_permlane32_swap_b32 v25, v27
    v_add_f32 v24, v24, v26
    v_add_f32 v25, v25, v27
    s_nop 1
    v_permlane16_swap_b32 v24, v25
    v_add_f32 v24, v24, v25
    s_nop 0
    v_readlane_b32 s77, v24, 15
    s_nop 1
    v_fma_f32 v25, -s77, v7, v24
    v_cvt_pk_bf16_f32 v25, v25, v25
    ds_write_b16 v12, v25
    s_mov_b32 vcc_lo, 0x70007000
    s_mov_b32 vcc_hi, 0x70007000
    v_cndmask_b32 v26, 0, v24, vcc
    s_waitcnt lgkmcnt(0)
    s_barrier
    ds_read_b128 v[40:43], v13 offset:0
    ds_read_b128 v[44:47], v13 offset:64
    ds_read_b128 v[48:51], v13 offset:128
    ds_read_b128 v[52:55], v13 offset:192
    ds_read_b128 v[56:59], v13 offset:256
    ds_read_b128 v[60:63], v13 offset:320
    v_add_f32_dpp v26, v26, v26 row_ror:8 row_mask:0xf bank_mask:0xf
    s_nop 1
    v_add_f32_dpp v26, v26, v26 row_ror:4 row_mask:0xf bank_mask:0xf
    s_nop 1
    v_add_f32_dpp v26, v26, v26 row_ror:2 row_mask:0xf bank_mask:0xf
    s_nop 1
    v_add_f32_dpp v26, v26, v26 row_ror:1 row_mask:0xf bank_mask:0xf
    v_mov_b32 v27, v26
    s_nop 1
    v_permlane32_swap_b32 v26, v27
    v_add_f32 v26, v26, v27
    v_mov_b32 v27, v26
    s_nop 1
    v_permlane16_swap_b32 v26, v27
    v_add_f32 v26, v26, v27
    v_mov_b32 v27, s77
    v_subrev_f32 v27, 0x44200000, v27
    v_sub_f32 v26, v26, v27
    v_mul_f32 v27, 0x3acccccd, v27
    v_mul_f32 v26, 0x3acccccd, v26
    v_fma_f32 v26, -v27, v27, v26
    v_max_f32 v26, 0, v26
    v_add_f32 v26, 0x3727c5ac, v26
    v_rsq_f32 v26, v26
    s_nop 0
    v_mul_f32 v18, 0x3dd53b94, v26
    s_waitcnt lgkmcnt(0)
    v_mfma_f32_16x16x32_bf16 v[80:83], a[0:3], v[40:43], 0
    v_mfma_f32_16x16x32_bf16 v[80:83], a[4:7], v[44:47], v[80:83]
    v_mfma_f32_16x16x32_bf16 v[80:83], a[8:11], v[48:51], v[80:83]
    v_mfma_f32_16x16x32_bf16 v[80:83], a[12:15], v[52:55], v[80:83]
    v_mfma_f32_16x16x32_bf16 v[80:83], a[16:19], v[56:59], v[80:83]
    v_mfma_f32_16x16x32_bf16 v[80:83], a[20:23], v[60:63], v[80:83]
    v_mfma_f32_16x16x32_bf16 v[68:71], a[24:27], v[40:43], 0
    v_mfma_f32_16x16x32_bf16 v[68:71], a[28:31], v[44:47], v[68:71]
    v_mfma_f32_16x16x32_bf16 v[68:71], a[32:35], v[48:51], v[68:71]
    v_mfma_f32_16x16x32_bf16 v[68:71], a[36:39], v[52:55], v[68:71]
    v_mfma_f32_16x16x32_bf16 v[68:71], a[40:43], v[56:59], v[68:71]
    v_mfma_f32_16x16x32_bf16 v[68:71], a[44:47], v[60:63], v[68:71]
    v_mfma_f32_16x16x32_bf16 v[72:75], a[48:51], v[40:43], 0
    v_mfma_f32_16x16x32_bf16 v[72:75], a[52:55], v[44:47], v[72:75]
    v_mfma_f32_16x16x32_bf16 v[72:75], a[56:59], v[48:51], v[72:75]
    v_mfma_f32_16x16x32_bf16 v[72:75], a[60:63], v[52:55], v[72:75]
    v_mfma_f32_16x16x32_bf16 v[72:75], a[64:67], v[56:59], v[72:75]
    v_mfma_f32_16x16x32_bf16 v[72:75], a[68:71], v[60:63], v[72:75]
    v_mfma_f32_16x16x32_bf16 v[76:79], a[72:75], v[40:43], 0
    v_mfma_f32_16x16x32_bf16 v[76:79], a[76:79], v[44:47], v[76:79]
    v_mfma_f32_16x16x32_bf16 v[76:79], a[80:83], v[48:51], v[76:79]
    v_cndmask_b32 v80, v80, v68, s[82:83]
    v_mfma_f32_16x16x32_bf16 v[76:79], a[84:87], v[52:55], v[76:79]
    v_cndmask_b32 v81, v81, v69, s[82:83]
    v_mfma_f32_16x16x32_bf16 v[76:79], a[88:91], v[56:59], v[76:79]
    v_cndmask_b32 v82, v82, v70, s[82:83]
    v_mfma_f32_16x16x32_bf16 v[76:79], a[92:95], v[60:63], v[76:79]
    v_cndmask_b32 v83, v83, v71, s[82:83]
    v_mfma_f32_16x16x32_bf16 v[64:67], a[96:99], v[40:43], 0
    v_mfma_f32_16x16x32_bf16 v[64:67], a[100:103], v[44:47], v[64:67]
    v_mfma_f32_16x16x32_bf16 v[64:67], a[104:107], v[48:51], v[64:67]
    v_cndmask_b32 v80, v80, v72, s[84:85]
    v_mfma_f32_16x16x32_bf16 v[64:67], a[108:111], v[52:55], v[64:67]
    v_cndmask_b32 v81, v81, v73, s[84:85]
    v_mfma_f32_16x16x32_bf16 v[64:67], a[112:115], v[56:59], v[64:67]
    v_cndmask_b32 v82, v82, v74, s[84:85]
    v_mfma_f32_16x16x32_bf16 v[64:67], a[116:119], v[60:63], v[64:67]
    v_cndmask_b32 v83, v83, v75, s[84:85]
    v_mfma_f32_16x16x32_bf16 v[68:71], a[120:123], v[40:43], 0
    v_mfma_f32_16x16x32_bf16 v[68:71], a[124:127], v[44:47], v[68:71]
    v_mfma_f32_16x16x32_bf16 v[68:71], a[128:131], v[48:51], v[68:71]
    v_cndmask_b32 v80, v80, v76, s[86:87]
    v_mfma_f32_16x16x32_bf16 v[68:71], a[132:135], v[52:55], v[68:71]
    v_cndmask_b32 v81, v81, v77, s[86:87]
    v_mfma_f32_16x16x32_bf16 v[68:71], a[136:139], v[56:59], v[68:71]
    v_cndmask_b32 v82, v82, v78, s[86:87]
    v_mfma_f32_16x16x32_bf16 v[68:71], a[140:143], v[60:63], v[68:71]
    v_cndmask_b32 v83, v83, v79, s[86:87]
    v_mfma_f32_16x16x32_bf16 v[72:75], a[144:147], v[40:43], 0
    v_mfma_f32_16x16x32_bf16 v[72:75], a[148:151], v[44:47], v[72:75]
    v_mfma_f32_16x16x32_bf16 v[72:75], a[152:155], v[48:51], v[72:75]
    v_cndmask_b32 v80, v80, v64, s[88:89]
    v_mfma_f32_16x16x32_bf16 v[72:75], a[156:159], v[52:55], v[72:75]
    v_cndmask_b32 v81, v81, v65, s[88:89]
    v_mfma_f32_16x16x32_bf16 v[72:75], a[160:163], v[56:59], v[72:75]
    v_cndmask_b32 v82, v82, v66, s[88:89]
    v_mfma_f32_16x16x32_bf16 v[72:75], a[164:167], v[60:63], v[72:75]
    v_cndmask_b32 v83, v83, v67, s[88:89]
    v_mfma_f32_16x16x32_bf16 v[76:79], a[168:171], v[40:43], 0
    v_mfma_f32_16x16x32_bf16 v[76:79], a[172:175], v[44:47], v[76:79]
    v_mfma_f32_16x16x32_bf16 v[76:79], a[176:179], v[48:51], v[76:79]
    v_cndmask_b32 v80, v80, v68, s[90:91]
    v_mfma_f32_16x16x32_bf16 v[76:79], a[180:183], v[52:55], v[76:79]
    v_cndmask_b32 v81, v81, v69, s[90:91]
    v_mfma_f32_16x16x32_bf16 v[76:79], a[184:187], v[56:59], v[76:79]
    v_cndmask_b32 v82, v82, v70, s[90:91]
    v_mfma_f32_16x16x32_bf16 v[76:79], a[188:191], v[60:63], v[76:79]
    v_cndmask_b32 v83, v83, v71, s[90:91]
    v_cndmask_b32 v80, v80, v72, s[92:93]
    v_cndmask_b32 v81, v81, v73, s[92:93]
    v_cndmask_b32 v82, v82, v74, s[92:93]
    v_cndmask_b32 v83, v83, v75, s[92:93]
    s_nop 2
    v_cndmask_b32 v80, v80, v76, s[94:95]
    v_cndmask_b32 v81, v81, v77, s[94:95]
    v_cndmask_b32 v82, v82, v78, s[94:95]
    v_cndmask_b32 v83, v83, v79, s[94:95]
    v_max3_f32 v19, v80, v81, v82
    v_max_f32 v19, v19, v83
    s_nop 1
    v_max_f32_dpp v19, v19, v19 row_ror:4 row_mask:0xf bank_mask:0xf
    s_nop 1
    v_max_f32_dpp v19, v19, v19 row_ror:2 row_mask:0xf bank_mask:0xf
    s_nop 1
    v_max_f32_dpp v19, v19, v19 row_ror:1 row_mask:0xf bank_mask:0xf
    v_mov_b32 v64, v19
    s_nop 1
    v_permlane32_swap_b32 v19, v64
    v_max_f32 v19, v19, v64
    v_mov_b32 v64, v19
    s_nop 1
    v_permlane16_swap_b32 v19, v64
    v_max_f32 v19, v19, v64
    v_mul_f32 v19, v19, v18
    v_fma_f32 v80, v80, v18, -v19
    v_fma_f32 v81, v81, v18, -v19
    v_fma_f32 v82, v82, v18, -v19
    v_fma_f32 v83, v83, v18, -v19
    v_exp_f32 v80, v80
    v_exp_f32 v81, v81
    v_exp_f32 v82, v82
    v_exp_f32 v83, v83
    v_cvt_pk_bf16_f32 v32, v80, v81
    v_cvt_pk_bf16_f32 v33, v82, v83
    v_add_f32 v37, v80, v81
    v_add_f32 v38, v82, v83
    v_add_f32 v37, v37, v38
    s_nop 1
    v_add_f32_dpp v37, v37, v37 row_ror:4 row_mask:0xf bank_mask:0xf
    s_nop 1
    v_add_f32_dpp v37, v37, v37 row_ror:2 row_mask:0xf bank_mask:0xf
    s_nop 1
    v_add_f32_dpp v37, v37, v37 row_ror:1 row_mask:0xf bank_mask:0xf
    v_mov_b32 v38, v37
    s_nop 1
    v_permlane32_swap_b32 v37, v38
    v_add_f32 v37, v37, v38
    v_mov_b32 v38, v37
    s_nop 1
    v_permlane16_swap_b32 v37, v38
    v_add_f32 v37, v37, v38
    v_mov_b32 v36, v19
    s_lshl_b32 s77, s71, 5
    s_lshl_b32 s78, s72, 3
    s_add_u32 s77, s77, s78
    s_add_u32 s77, s77, s3
    s_mov_b64 exec, 1
    s_cmp_eq_u32 s75, 1
    s_cbranch_scc0 SLOW9
    buffer_store_dwordx2 v[36:37], v14, s[16:19], s77 offen
BACK9:
    s_mov_b64 exec, -1
    v_mov_b32_dpp v24, v32 row_newbcast:0 row_mask:0xf bank_mask:0xf
    v_mov_b32_dpp v25, v33 row_newbcast:0 row_mask:0xf bank_mask:0xf
    v_mov_b32_dpp v26, v32 row_newbcast:1 row_mask:0xf bank_mask:0xf
    v_mov_b32_dpp v27, v33 row_newbcast:1 row_mask:0xf bank_mask:0xf
    s_nop 1
    v_mfma_f32_16x16x32_bf16 v[40:43], v[24:27], a[192:195], 0
    v_mov_b32_dpp v28, v32 row_newbcast:2 row_mask:0xf bank_mask:0xf
    v_mfma_f32_16x16x32_bf16 v[44:47], v[24:27], a[196:199], 0
    v_mov_b32_dpp v29, v33 row_newbcast:2 row_mask:0xf bank_mask:0xf
    v_mfma_f32_16x16x32_bf16 v[48:51], v[24:27], a[200:203], 0
    v_mov_b32_dpp v30, v32 row_newbcast:3 row_mask:0xf bank_mask:0xf
    v_mfma_f32_16x16x32_bf16 v[52:55], v[24:27], a[204:207], 0
    v_mov_b32_dpp v31, v33 row_newbcast:3 row_mask:0xf bank_mask:0xf
    v_mfma_f32_16x16x32_bf16 v[56:59], v[24:27], a[208:211], 0
    v_mfma_f32_16x16x32_bf16 v[60:63], v[24:27], a[212:215], 0
    v_mfma_f32_16x16x32_bf16 v[64:67], v[24:27], a[216:219], 0
    v_mfma_f32_16x16x32_bf16 v[68:71], v[24:27], a[220:223], 0
    v_mfma_f32_16x16x32_bf16 v[72:75], v[24:27], a[224:227], 0
    v_mfma_f32_16x16x32_bf16 v[76:79], v[24:27], a[228:231], 0
    v_mfma_f32_16x16x32_bf16 v[80:83], v[24:27], a[232:235], 0
    v_mfma_f32_16x16x32_bf16 v[84:87], v[24:27], a[236:239], 0
    v_mfma_f32_16x16x32_bf16 v[40:43], v[28:31], v[112:115], v[40:43]
    v_mov_b32_dpp v24, v32 row_newbcast:4 row_mask:0xf bank_mask:0xf
    v_mfma_f32_16x16x32_bf16 v[44:47], v[28:31], v[116:119], v[44:47]
    v_mov_b32_dpp v25, v33 row_newbcast:4 row_mask:0xf bank_mask:0xf
    v_mfma_f32_16x16x32_bf16 v[48:51], v[28:31], v[120:123], v[48:51]
    v_mov_b32_dpp v26, v32 row_newbcast:5 row_mask:0xf bank_mask:0xf
    v_mfma_f32_16x16x32_bf16 v[52:55], v[28:31], v[124:127], v[52:55]
    v_mov_b32_dpp v27, v33 row_newbcast:5 row_mask:0xf bank_mask:0xf
    v_mfma_f32_16x16x32_bf16 v[56:59], v[28:31], v[128:131], v[56:59]
    v_mfma_f32_16x16x32_bf16 v[60:63], v[28:31], v[132:135], v[60:63]
    v_mfma_f32_16x16x32_bf16 v[64:67], v[28:31], v[136:139], v[64:67]
    v_mfma_f32_16x16x32_bf16 v[68:71], v[28:31], v[140:143], v[68:71]
    v_mfma_f32_16x16x32_bf16 v[72:75], v[28:31], v[144:147], v[72:75]
    v_mfma_f32_16x16x32_bf16 v[76:79], v[28:31], v[148:151], v[76:79]
    v_mfma_f32_16x16x32_bf16 v[80:83], v[28:31], v[152:155], v[80:83]
    v_mfma_f32_16x16x32_bf16 v[84:87], v[28:31], v[156:159], v[84:87]
    v_mfma_f32_16x16x32_bf16 v[40:43], v[24:27], v[160:163], v[40:43]
    v_mov_b32_dpp v28, v32 row_newbcast:6 row_mask:0xf bank_mask:0xf
    v_mfma_f32_16x16x32_bf16 v[44:47], v[24:27], v[164:167], v[44:47]
    v_mov_b32_dpp v29, v33 row_newbcast:6 row_mask:0xf bank_mask:0xf
    v_mfma_f32_16x16x32_bf16 v[48:51], v[24:27], v[168:171], v[48:51]
    v_mov_b32_dpp v30, v32 row_newbcast:7 row_mask:0xf bank_mask:0xf
    v_mfma_f32_16x16x32_bf16 v[52:55], v[24:27], v[172:175], v[52:55]
    v_mov_b32_dpp v31, v33 row_newbcast:7 row_mask:0xf bank_mask:0xf
    v_mfma_f32_16x16x32_bf16 v[56:59], v[24:27], v[176:179], v[56:59]
    v_mfma_f32_16x16x32_bf16 v[60:63], v[24:27], v[180:183], v[60:63]
    v_mfma_f32_16x16x32_bf16 v[64:67], v[24:27], v[184:187], v[64:67]
    v_mfma_f32_16x16x32_bf16 v[68:71], v[24:27], v[188:191], v[68:71]
    v_mfma_f32_16x16x32_bf16 v[72:75], v[24:27], v[192:195], v[72:75]
    v_mfma_f32_16x16x32_bf16 v[76:79], v[24:27], v[196:199], v[76:79]
    v_mfma_f32_16x16x32_bf16 v[80:83], v[24:27], v[200:203], v[80:83]
    v_mfma_f32_16x16x32_bf16 v[84:87], v[24:27], v[204:207], v[84:87]
    buffer_load_dwordx2 v[34:35], v14, s[16:19], s3 offen sc1
    v_mfma_f32_16x16x32_bf16 v[40:43], v[28:31], v[208:211], v[40:43]
    v_mfma_f32_16x16x32_bf16 v[44:47], v[28:31], v[212:215], v[44:47]
    v_mfma_f32_16x16x32_bf16 v[48:51], v[28:31], v[216:219], v[48:51]
    v_mfma_f32_16x16x32_bf16 v[52:55], v[28:31], v[220:223], v[52:55]
    v_mfma_f32_16x16x32_bf16 v[56:59], v[28:31], v[224:227], v[56:59]
    v_mfma_f32_16x16x32_bf16 v[60:63], v[28:31], v[228:231], v[60:63]
    v_mfma_f32_16x16x32_bf16 v[64:67], v[28:31], v[232:235], v[64:67]
    v_mfma_f32_16x16x32_bf16 v[68:71], v[28:31], v[236:239], v[68:71]
    v_mfma_f32_16x16x32_bf16 v[72:75], v[28:31], v[240:243], v[72:75]
    v_mfma_f32_16x16x32_bf16 v[76:79], v[28:31], v[244:247], v[76:79]
    v_mfma_f32_16x16x32_bf16 v[80:83], v[28:31], v[248:251], v[80:83]
    v_mfma_f32_16x16x32_bf16 v[84:87], v[28:31], v[252:255], v[84:87]
ATT_END:
    s_waitcnt vmcnt(0)
    v_max_u32 v36, v34, v35
    v_cmp_eq_u32 vcc, -1, v36
    s_cbranch_vccnz RETRY10
OK10:
    v_mov_b32 v36, v34
    s_nop 1
    v_max_f32_dpp v36, v36, v36 row_ror:8 row_mask:0xf bank_mask:0xf
    s_nop 1
    v_max_f32_dpp v36, v36, v36 row_ror:4 row_mask:0xf bank_mask:0xf
    s_nop 1
    v_max_f32_dpp v36, v36, v36 row_ror:2 row_mask:0xf bank_mask:0xf
    s_nop 1
    v_max_f32_dpp v36, v36, v36 row_ror:1 row_mask:0xf bank_mask:0xf
    v_mov_b32 v37, v36
    s_nop 1
    v_permlane16_swap_b32 v36, v37
    v_max_f32 v36, v36, v37
    v_sub_f32 v34, v34, v36
    v_sub_f32 v36, v19, v36
    v_exp_f32 v34, v34
    v_exp_f32 v36, v36
    v_mul_f32 v34, v34, v35
    v_mov_b32_dpp v40, v44 quad_perm:[0,1,2,3] row_mask:0x2 bank_mask:0xf
    s_nop 1
    v_mov_b32_dpp v40, v48 quad_perm:[0,1,2,3] row_mask:0x4 bank_mask:0xf
    s_nop 1
    v_mov_b32_dpp v40, v52 quad_perm:[0,1,2,3] row_mask:0x8 bank_mask:0xf
    v_mov_b32_dpp v56, v60 quad_perm:[0,1,2,3] row_mask:0x2 bank_mask:0xf
    s_nop 1
    v_mov_b32_dpp v56, v64 quad_perm:[0,1,2,3] row_mask:0x4 bank_mask:0xf
    s_nop 1
    v_mov_b32_dpp v56, v68 quad_perm:[0,1,2,3] row_mask:0x8 bank_mask:0xf
    v_mov_b32_dpp v72, v76 quad_perm:[0,1,2,3] row_mask:0x2 bank_mask:0xf
    s_nop 1
    v_mov_b32_dpp v72, v80 quad_perm:[0,1,2,3] row_mask:0x4 bank_mask:0xf
    s_nop 1
    v_mov_b32_dpp v72, v84 quad_perm:[0,1,2,3] row_mask:0x8 bank_mask:0xf
    v_add_f32_dpp v34, v34, v34 row_ror:8 row_mask:0xf bank_mask:0xf
    s_nop 1
    v_add_f32_dpp v34, v34, v34 row_ror:4 row_mask:0xf bank_mask:0xf
    s_nop 1
    v_add_f32_dpp v34, v34, v34 row_ror:2 row_mask:0xf bank_mask:0xf
    s_nop 1
    v_add_f32_dpp v34, v34, v34 row_ror:1 row_mask:0xf bank_mask:0xf
    v_mov_b32 v37, v34
    s_nop 1
    v_permlane16_swap_b32 v34, v37
    v_add_f32 v34, v34, v37
    v_rcp_f32 v34, v34
    s_nop 0
    v_mul_f32 v34, v34, v36
    v_mul_f32 v40, v40, v34
    v_mul_f32 v56, v56, v34
    v_mul_f32 v72, v72, v34
    ds_add_f32 v15, v40 offset:0
    ds_add_f32 v15, v56 offset:256
    ds_add_f32 v15, v72 offset:512
    v_lshlrev_b32 v24, 5, v0
    s_cmp_eq_u32 s74, 0
    s_cselect_b32 s79, 0, 1536
    s_add_u32 s79, s79, 119296
    v_add_u32 v24, s79, v24
    s_mul_i32 s77, s69, 384
    s_add_u32 s77, s77, s3
    s_add_u32 s77, s77, 32768
    s_waitcnt lgkmcnt(0)
    s_barrier
    s_cmp_lg_u32 s72, 0
    s_cbranch_scc1 NOOPUB
    s_mov_b32 exec_lo, 0xffffff
    s_mov_b32 exec_hi, 0x0
    ds_read_b128 v[28:31], v24 offset:0
    ds_read_b128 v[32:35], v24 offset:16
    s_waitcnt lgkmcnt(0)
    v_cvt_pk_bf16_f32 v28, v28, v29
    v_cvt_pk_bf16_f32 v29, v30, v31
    v_cvt_pk_bf16_f32 v30, v32, v33
    v_cvt_pk_bf16_f32 v31, v34, v35
    s_cmp_eq_u32 s75, 1
    s_cbranch_scc0 SLOW11
    buffer_store_dwordx4 v[28:31], v1, s[16:19], s77 offen
BACK11:
    s_mov_b64 exec, -1
NOOPUB:
    v_and_b32 v25, 15, v0
    v_lshrrev_b32 v26, 4, v0
    v_bfe_u32 v27, v0, 2, 2
    v_and_b32 v36, 3, v0
    s_cmp_ge_u32 s69, 20
    s_cbranch_scc1 ROLEF
    s_mul_i32 s77, s72, 12288
    s_add_u32 s77, s77, 57344
    v_lshl_add_u32 v37, v26, 3, v27
    v_lshlrev_b32 v37, 6, v37
    v_lshl_add_u32 v37, v36, 3, v37
    v_add_u32 v37, s77, v37
    ds_read_b64_tr_b16 v[40:41], v37 offset:0
    ds_read_b64_tr_b16 v[42:43], v37 offset:256
    ds_read_b64_tr_b16 v[44:45], v37 offset:2048
    ds_read_b64_tr_b16 v[46:47], v37 offset:2304
    ds_read_b64_tr_b16 v[48:49], v37 offset:4096
    ds_read_b64_tr_b16 v[50:51], v37 offset:4352
    ds_read_b64_tr_b16 v[52:53], v37 offset:6144
    ds_read_b64_tr_b16 v[54:55], v37 offset:6400
    ds_read_b64_tr_b16 v[56:57], v37 offset:8192
    ds_read_b64_tr_b16 v[58:59], v37 offset:8448
    ds_read_b64_tr_b16 v[60:61], v37 offset:10240
    ds_read_b64_tr_b16 v[62:63], v37 offset:10496
    ds_read_b64_tr_b16 v[64:65], v37 offset:32
    ds_read_b64_tr_b16 v[66:67], v37 offset:288
    ds_read_b64_tr_b16 v[68:69], v37 offset:2080
    ds_read_b64_tr_b16 v[70:71], v37 offset:2336
    ds_read_b64_tr_b16 v[72:73], v37 offset:4128
    ds_read_b64_tr_b16 v[74:75], v37 offset:4384
    ds_read_b64_tr_b16 v[76:77], v37 offset:6176
    ds_read_b64_tr_b16 v[78:79], v37 offset:6432
    ds_read_b64_tr_b16 v[80:81], v37 offset:8224
    ds_read_b64_tr_b16 v[82:83], v37 offset:8480
    ds_read_b64_tr_b16 v[84:85], v37 offset:10272
    ds_read_b64_tr_b16 v[86:87], v37 offset:10528
    s_cmp_lg_u32 s72, 1
    s_cbranch_scc1 NOOWN0
    s_cmp_eq_u32 s74, 0
    s_cbranch_scc1 NOOWN0
    v_mul_u32_u24 v37, 1280, v26
    v_add_u32 v37, 665600, v37
    s_mul_i32 s7, s68, 81920
    s_add_u32 s7, s7, 78080
    v_mov_b32 v38, s7
    v_cmp_eq_u32 vcc, s68, v26
    s_nop 1
    v_cndmask_b32 v37, v37, v38, vcc
    v_add_u32 v39, 4, v26
    v_mul_u32_u24 v38, 1280, v39
    v_add_u32 v38, 665600, v38
    s_mul_i32 s7, s68, 81920
    s_add_u32 s7, s7, 78080
    v_mov_b32 v28, s7
    v_cmp_eq_u32 vcc, s68, v39
    s_nop 1
    v_cndmask_b32 v38, v38, v28, vcc
    s_lshl_b32 s77, s69, 6
    s_add_u32 s77, s77, 0
    v_lshl_add_u32 v37, v25, 2, v37
    v_lshl_add_u32 v38, v25, 2, v38
    s_mov_b32 s76, 0
POLL12:
    buffer_load_dword v28, v37, s[16:19], s77 offen sc1
    buffer_load_dword v29, v38, s[16:19], s77 offen sc1
    s_add_u32 s76, s76, 1
    s_cmp_ge_u32 s76, 32768
    s_waitcnt vmcnt(0)
    v_max_u32 v30, v28, v29
    v_cmp_eq_u32 vcc, -1, v30
    s_cbranch_scc1 POLLX12
    s_cbranch_vccnz POLL12
POLLX12:
    v_lshlrev_b32 v30, 16, v28
    v_and_b32 v28, 0xffff0000, v28
    v_lshlrev_b32 v31, 16, v29
    v_and_b32 v29, 0xffff0000, v29
    v_add_f32 v30, v30, v31
    v_add_f32 v28, v28, v29
    v_mov_b32 v31, v30
    s_nop 1
    v_permlane32_swap_b32 v30, v31
    v_add_f32 v30, v30, v31
    v_mov_b32 v31, v30
    s_nop 1
    v_permlane16_swap_b32 v30, v31
    v_add_f32 v30, v30, v31
    v_mov_b32 v29, v28
    s_nop 1
    v_permlane32_swap_b32 v28, v29
    v_add_f32 v28, v28, v29
    v_mov_b32 v29, v28
    s_nop 1
    v_permlane16_swap_b32 v28, v29
    v_add_f32 v28, v28, v29
    v_add_f32 v22, v22, v30
    v_add_f32 v23, v23, v28
    v_cvt_pk_bf16_f32 v28, v22, v23
    s_lshl_b32 s77, s69, 6
    s_add_u32 s77, s77, s3
    s_add_u32 s77, s77, 79360
    v_lshlrev_b32 v37, 2, v0
    v_mov_b32_dpp v29, v28 quad_perm:[1,1,1,1] row_mask:0xf bank_mask:0xf
    v_mov_b32_dpp v30, v28 quad_perm:[2,2,2,2] row_mask:0xf bank_mask:0xf
    v_mov_b32_dpp v31, v28 quad_perm:[3,3,3,3] row_mask:0xf bank_mask:0xf
    s_mov_b32 exec_lo, 0x1111
    s_mov_b32 exec_hi, 0x0
    s_cmp_eq_u32 s75, 1
    s_cbranch_scc0 SLOW13
    buffer_store_dwordx4 v[28:31], v37, s[16:19], s77 offen
BACK13:
    s_mov_b64 exec, -1
NOOWN0:
    v_and_b32 v37, 7, v25
    v_mul_u32_u24 v37, 384, v37
    v_lshl_add_u32 v37, v26, 4, v37
    s_mul_i32 s77, s72, 3072
    s_add_u32 s77, s77, s3
    s_add_u32 s77, s77, 32768
    s_mov_b32 s76, 0
POLL14:
    buffer_load_dwordx4 v[88:91], v37, s[16:19], s77 offen offset:0 sc1
    buffer_load_dwordx4 v[92:95], v37, s[16:19], s77 offen offset:64 sc1
    buffer_load_dwordx4 v[96:99], v37, s[16:19], s77 offen offset:128 sc1
    buffer_load_dwordx4 v[100:103], v37, s[16:19], s77 offen offset:192 sc1
    buffer_load_dwordx4 v[104:107], v37, s[16:19], s77 offen offset:256 sc1
    buffer_load_dwordx4 v[108:111], v37, s[16:19], s77 offen offset:320 sc1
    s_add_u32 s76, s76, 1
    s_cmp_ge_u32 s76, 32768
    s_waitcnt vmcnt(0)
    v_max3_u32 v38, v88, v92, v96
    v_max3_u32 v38, v38, v100, v104
    v_max_u32 v38, v38, v108
    v_cmp_eq_u32 vcc, -1, v38
    s_cbranch_scc1 POLLX14
    s_cbranch_vccnz POLL14
POLLX14:
    s_waitcnt lgkmcnt(0)
    v_mfma_f32_16x16x32_bf16 v[28:31], v[88:91], v[40:43], 0
    v_mfma_f32_16x16x32_bf16 v[32:35], v[88:91], v[64:67], 0
    v_mfma_f32_16x16x32_bf16 v[28:31], v[92:95], v[44:47], v[28:31]
    v_mfma_f32_16x16x32_bf16 v[32:35], v[92:95], v[68:71], v[32:35]
    v_mfma_f32_16x16x32_bf16 v[28:31], v[96:99], v[48:51], v[28:31]
    v_mfma_f32_16x16x32_bf16 v[32:35], v[96:99], v[72:75], v[32:35]
    v_mfma_f32_16x16x32_bf16 v[28:31], v[100:103], v[52:55], v[28:31]
    v_mfma_f32_16x16x32_bf16 v[32:35], v[100:103], v[76:79], v[32:35]
    v_mfma_f32_16x16x32_bf16 v[28:31], v[104:107], v[56:59], v[28:31]
    v_mfma_f32_16x16x32_bf16 v[32:35], v[104:107], v[80:83], v[32:35]
    v_mfma_f32_16x16x32_bf16 v[28:31], v[108:111], v[60:63], v[28:31]
    v_mfma_f32_16x16x32_bf16 v[32:35], v[108:111], v[84:87], v[32:35]
    s_lshl_b32 s77, s69, 6
    s_mul_i32 s78, s68, 1280
    s_add_u32 s78, s78, s77
    s_add_u32 s78, s78, s74
    s_add_u32 s77, s77, s3
    s_add_u32 s96, s78, 655360
    s_add_u32 s97, s77, 76800
    v_add_f32 v28, v28, v29
    v_add_f32 v30, v30, v31
    v_add_f32 v32, v32, v33
    v_add_f32 v34, v34, v35
    v_add_f32 v28, v28, v30
    v_add_f32 v32, v32, v34
    s_nop 1
    v_permlane16_swap_b32 v28, v32
    v_add_f32 v28, v28, v32
    ds_add_f32 v15, v28 offset:768
    s_waitcnt lgkmcnt(0)
    s_barrier
    s_cmp_lg_u32 s72, 0
    s_cbranch_scc1 WNOT0
    s_mov_b64 exec, 15
    ds_read_b128 v[28:31], v24 offset:768
    ds_read_b128 v[32:35], v24 offset:784
    s_waitcnt lgkmcnt(0)
    v_cvt_pk_bf16_f32 v28, v28, v29
    v_cvt_pk_bf16_f32 v29, v30, v31
    v_cvt_pk_bf16_f32 v30, v32, v33
    v_cvt_pk_bf16_f32 v31, v34, v35
    buffer_store_dwordx4 v[28:31], v1, s[16:19], s96 offen sc1
    s_cmp_eq_u32 s75, 1
    s_cbranch_scc0 SLOW15
    buffer_store_dwordx4 v[28:31], v1, s[16:19], s97 offen
BACK15:
    s_mov_b64 exec, -1
    v_lshrrev_b32 v37, 5, v0
    v_mul_u32_u24 v37, 2560, v37
    v_and_b32 v38, 31, v0
    v_lshl_add_u32 v37, v38, 2, v37
    v_add_u32 v41, 5120, v37
    v_add_u32 v42, 10240, v37
    v_add_u32 v43, 15360, v37
    v_add_u32 v44, 20480, v37
    v_add_u32 v45, 25600, v37
    s_lshl_b32 s79, s69, 7
    s_add_u32 s79, s79, s3
    s_add_u32 s79, s79, 46080
    s_add_u32 s96, s78, 665600
    s_add_u32 s97, s77, 78080
    v_lshlrev_b32 v39, 1, v0
    s_mov_b32 s76, 0
POLL16:
    buffer_load_dword v28, v37, s[16:19], s79 offen sc1
    buffer_load_dword v29, v41, s[16:19], s79 offen sc1
    buffer_load_dword v30, v42, s[16:19], s79 offen sc1
    buffer_load_dword v31, v43, s[16:19], s79 offen sc1
    buffer_load_dword v32, v44, s[16:19], s79 offen sc1
    buffer_load_dword v33, v45, s[16:19], s79 offen sc1
    s_add_u32 s76, s76, 1
    s_cmp_ge_u32 s76, 32768
    s_waitcnt vmcnt(0)
    v_max3_u32 v38, v28, v29, v30
    v_max3_u32 v38, v38, v31, v32
    v_max_u32 v38, v38, v33
    v_cmp_eq_u32 vcc, -1, v38
    s_cbranch_scc1 POLLX16
    s_cbranch_vccnz POLL16
POLLX16:
    v_add_f32 v28, v28, v29
    v_add_f32 v30, v30, v31
    v_add_f32 v32, v32, v33
    v_add_f32 v28, v28, v30
    v_add_f32 v28, v28, v32
    v_mov_b32 v29, v28
    s_nop 1
    v_permlane32_swap_b32 v28, v29
    v_add_f32 v28, v28, v29
    s_nop 1
    v_mov_b32_dpp v29, v28 row_shl:1 row_mask:0xf bank_mask:0xf
    v_cvt_pk_bf16_f32 v28, v28, v29
    s_nop 1
    v_mov_b32_dpp v29, v28 row_shl:2 row_mask:0xf bank_mask:0xf
    v_mov_b32_dpp v30, v28 row_shl:4 row_mask:0xf bank_mask:0xf
    v_mov_b32_dpp v31, v28 row_shl:6 row_mask:0xf bank_mask:0xf
    s_mov_b32 exec_lo, 0x1010101
    s_mov_b32 exec_hi, 0x0
    buffer_store_dwordx4 v[28:31], v39, s[16:19], s96 offen sc1
    s_cmp_eq_u32 s75, 1
    s_cbranch_scc0 SLOW17
    buffer_store_dwordx4 v[28:31], v39, s[16:19], s97 offen
BACK17:
    s_mov_b64 exec, -1
    s_branch NEXT
WNOT0:
    s_cmp_lg_u32 s72, 1
    s_cbranch_scc1 NEXT
    v_mul_u32_u24 v37, 1280, v26
    v_add_u32 v37, 655360, v37
    s_mul_i32 s7, s68, 81920
    s_add_u32 s7, s7, 76800
    v_mov_b32 v38, s7
    v_cmp_eq_u32 vcc, s68, v26
    s_nop 1
    v_cndmask_b32 v37, v37, v38, vcc
    v_add_u32 v39, 4, v26
    v_mul_u32_u24 v38, 1280, v39
    v_add_u32 v38, 655360, v38
    s_mul_i32 s7, s68, 81920
    s_add_u32 s7, s7, 76800
    v_mov_b32 v28, s7
    v_cmp_eq_u32 vcc, s68, v39
    s_nop 1
    v_cndmask_b32 v38, v38, v28, vcc
    s_lshl_b32 s77, s69, 6
    s_add_u32 s77, s77, s74
    v_lshl_add_u32 v37, v25, 2, v37
    v_lshl_add_u32 v38, v25, 2, v38
    s_mov_b32 s76, 0
POLL18:
    buffer_load_dword v28, v37, s[16:19], s77 offen sc1
    buffer_load_dword v29, v38, s[16:19], s77 offen sc1
    s_add_u32 s76, s76, 1
    s_cmp_ge_u32 s76, 32768
    s_waitcnt vmcnt(0)
    v_max_u32 v30, v28, v29
    v_cmp_eq_u32 vcc, -1, v30
    s_cbranch_scc1 POLLX18
    s_cbranch_vccnz POLL18
POLLX18:
    v_lshlrev_b32 v30, 16, v28
    v_and_b32 v28, 0xffff0000, v28
    v_lshlrev_b32 v31, 16, v29
    v_and_b32 v29, 0xffff0000, v29
    v_add_f32 v30, v30, v31
    v_add_f32 v28, v28, v29
    v_mov_b32 v31, v30
    s_nop 1
    v_permlane32_swap_b32 v30, v31
    v_add_f32 v30, v30, v31
    v_mov_b32 v31, v30
    s_nop 1
    v_permlane16_swap_b32 v30, v31
    v_add_f32 v30, v30, v31
    v_mov_b32 v29, v28
    s_nop 1
    v_permlane32_swap_b32 v28, v29
    v_add_f32 v28, v28, v29
    v_mov_b32 v29, v28
    s_nop 1
    v_permlane16_swap_b32 v28, v29
    v_add_f32 v28, v28, v29
    v_add_f32 v22, v22, v30
    v_add_f32 v23, v23, v28
    v_cvt_pk_bf16_f32 v28, v22, v23
    s_cmp_lg_u32 s74, 0
    s_cbranch_scc1 FINAL
    s_lshl_b32 s77, s69, 6
    s_add_u32 s77, s77, s3
    s_add_u32 s77, s77, 80640
    v_lshlrev_b32 v37, 2, v0
    v_mov_b32_dpp v29, v28 quad_perm:[1,1,1,1] row_mask:0xf bank_mask:0xf
    v_mov_b32_dpp v30, v28 quad_perm:[2,2,2,2] row_mask:0xf bank_mask:0xf
    v_mov_b32_dpp v31, v28 quad_perm:[3,3,3,3] row_mask:0xf bank_mask:0xf
    s_mov_b32 exec_lo, 0x1111
    s_mov_b32 exec_hi, 0x0
    s_cmp_eq_u32 s75, 1
    s_cbranch_scc0 SLOW19
    buffer_store_dwordx4 v[28:31], v37, s[16:19], s77 offen
BACK19:
    s_mov_b64 exec, -1
    s_branch NEXT
FINAL:
    s_cmp_lg_u32 s68, 0
    s_cbranch_scc1 DONE
    v_mul_u32_u24 v37, 1280, v26
    v_add_u32 v37, 665600, v37
    s_mul_i32 s7, s68, 81920
    s_add_u32 s7, s7, 78080
    v_mov_b32 v38, s7
    v_cmp_eq_u32 vcc, s68, v26
    s_nop 1
    v_cndmask_b32 v37, v37, v38, vcc
    v_add_u32 v39, 4, v26
    v_mul_u32_u24 v38, 1280, v39
    v_add_u32 v38, 665600, v38
    s_mul_i32 s7, s68, 81920
    s_add_u32 s7, s7, 78080
    v_mov_b32 v28, s7
    v_cmp_eq_u32 vcc, s68, v39
    s_nop 1
    v_cndmask_b32 v38, v38, v28, vcc
    s_lshl_b32 s77, s69, 6
    s_add_u32 s77, s77, s74
    v_lshl_add_u32 v37, v25, 2, v37
    v_lshl_add_u32 v38, v25, 2, v38
    s_mov_b32 s76, 0
POLL20:
    buffer_load_dword v28, v37, s[16:19], s77 offen sc1
    buffer_load_dword v29, v38, s[16:19], s77 offen sc1
    s_add_u32 s76, s76, 1
    s_cmp_ge_u32 s76, 32768
    s_waitcnt vmcnt(0)
    v_max_u32 v30, v28, v29
    v_cmp_eq_u32 vcc, -1, v30
    s_cbranch_scc1 POLLX20
    s_cbranch_vccnz POLL20
POLLX20:
    v_lshlrev_b32 v30, 16, v28
    v_and_b32 v28, 0xffff0000, v28
    v_lshlrev_b32 v31, 16, v29
    v_and_b32 v29, 0xffff0000, v29
    v_add_f32 v30, v30, v31
    v_add_f32 v28, v28, v29
    v_mov_b32 v31, v30
    s_nop 1
    v_permlane32_swap_b32 v30, v31
    v_add_f32 v30, v30, v31
    v_mov_b32 v31, v30
    s_nop 1
    v_permlane16_swap_b32 v30, v31
    v_add_f32 v30, v30, v31
    v_mov_b32 v29, v28
    s_nop 1
    v_permlane32_swap_b32 v28, v29
    v_add_f32 v28, v28, v29
    v_mov_b32 v29, v28
    s_nop 1
    v_permlane16_swap_b32 v28, v29
    v_add_f32 v28, v28, v29
    v_add_f32 v22, v22, v30
    v_add_f32 v23, v23, v28
    v_cvt_pk_bf16_f32 v28, v22, v23
    s_lshl_b32 s77, s69, 6
    v_lshlrev_b32 v37, 2, v0
    s_mov_b32 exec_lo, 0xffff
    s_mov_b32 exec_hi, 0x0
    buffer_store_dword v28, v37, s[40:43], s77 offen
    s_mov_b64 exec, -1
    s_endpgm
ROLEF:
    s_mul_i32 s77, s72, 5120
    s_add_u32 s77, s77, 57344
    v_lshl_add_u32 v37, v26, 3, v27
    v_lshlrev_b32 v37, 5, v37
    v_lshl_add_u32 v37, v36, 3, v37
    v_add_u32 v37, s77, v37
    ds_read_b64_tr_b16 v[40:41], v37 offset:0
    ds_read_b64_tr_b16 v[42:43], v37 offset:128
    ds_read_b64_tr_b16 v[44:45], v37 offset:1024
    ds_read_b64_tr_b16 v[46:47], v37 offset:1152
    ds_read_b64_tr_b16 v[48:49], v37 offset:2048
    ds_read_b64_tr_b16 v[50:51], v37 offset:2176
    ds_read_b64_tr_b16 v[52:53], v37 offset:3072
    ds_read_b64_tr_b16 v[54:55], v37 offset:3200
    ds_read_b64_tr_b16 v[56:57], v37 offset:4096
    ds_read_b64_tr_b16 v[58:59], v37 offset:4224
    ds_read_b64_tr_b16 v[60:61], v37 offset:20480
    ds_read_b64_tr_b16 v[62:63], v37 offset:20608
    ds_read_b64_tr_b16 v[64:65], v37 offset:21504
    ds_read_b64_tr_b16 v[66:67], v37 offset:21632
    ds_read_b64_tr_b16 v[68:69], v37 offset:22528
    ds_read_b64_tr_b16 v[70:71], v37 offset:22656
    ds_read_b64_tr_b16 v[72:73], v37 offset:23552
    ds_read_b64_tr_b16 v[74:75], v37 offset:23680
    ds_read_b64_tr_b16 v[76:77], v37 offset:24576
    ds_read_b64_tr_b16 v[78:79], v37 offset:24704
    s_mul_i32 s77, s72, 320
    s_add_u32 s77, s77, 98304
    v_lshrrev_b32 v80, 2, v0
    v_mul_u32_u24 v80, 1280, v80
    v_lshl_add_u32 v80, v36, 3, v80
    v_add_u32 v80, s77, v80
    s_add_u32 s79, s79, 1024
    v_lshl_add_u32 v81, v25, 2, s79
    v_add_u32 v38, 128, v81
    v_cmp_eq_u32 vcc, 3, v26
    s_nop 1
    v_cndmask_b32 v81, v81, v38, vcc
    v_mov_b32 v82, s79
    v_add_u32 v82, 256, v82
    v_add_u32 v38, 4, v82
    v_cndmask_b32 v82, v82, v38, vcc
    v_lshl_add_u32 v83, v26, 4, s79
    v_mov_b32 v85, s79
    v_lshlrev_b32 v84, 6, v25
    v_lshl_add_u32 v84, v26, 4, v84
    v_cmp_eq_u32 vcc, 12, v25
    v_mov_b32 v38, 0x3f803f80
    s_nop 0
    v_cndmask_b32 v88, 0, v38, vcc
    v_mov_b32 v89, v88
    v_mov_b32 v90, v88
    v_mov_b32 v91, v88
    v_mov_b32 v92, v88
    v_mov_b32 v93, v88
    v_mov_b32 v94, v88
    v_mov_b32 v95, v88
    v_mov_b32 v96, v88
    v_mov_b32 v97, v88
    v_mov_b32 v98, v88
    v_mov_b32 v99, v88
    v_mov_b32 v100, v88
    v_mov_b32 v101, v88
    v_mov_b32 v102, v88
    v_mov_b32 v103, v88
    v_mov_b32 v104, v88
    v_mov_b32 v105, v88
    v_mov_b32 v106, v88
    v_mov_b32 v107, v88
    v_mul_u32_u24 v37, 1280, v25
    v_add_u32 v37, 655360, v37
    s_mul_i32 s7, s68, 81920
    s_add_u32 s7, s7, 76800
    v_mov_b32 v38, s7
    v_cmp_eq_u32 vcc, s68, v25
    s_nop 1
    v_cndmask_b32 v37, v37, v38, vcc
    v_add_u32 v38, 2560, v38
    v_cmp_le_u32 vcc, 8, v25
    s_nop 1
    v_cndmask_b32 v37, v37, v38, vcc
    v_lshl_add_u32 v37, v26, 4, v37
    s_mul_i32 s77, s72, 320
    s_add_u32 s77, s77, s74
    s_sub_u32 s78, s69, 20
    s_mul_i32 s78, s78, 2560
    s_mul_i32 s7, s72, 640
    s_add_u32 s78, s78, s7
    s_add_u32 s78, s78, s3
    s_add_u32 s78, s78, 46080
    s_mov_b32 exec_lo, 0x1ff01ff
    s_mov_b32 exec_hi, 0x1ff01ff
    s_mov_b32 s76, 0
POLL21:
    buffer_load_dwordx4 v[88:91], v37, s[16:19], s77 offen offset:0 sc1
    buffer_load_dwordx4 v[92:95], v37, s[16:19], s77 offen offset:64 sc1
    buffer_load_dwordx4 v[96:99], v37, s[16:19], s77 offen offset:128 sc1
    buffer_load_dwordx4 v[100:103], v37, s[16:19], s77 offen offset:192 sc1
    buffer_load_dwordx4 v[104:107], v37, s[16:19], s77 offen offset:256 sc1
    s_add_u32 s76, s76, 1
    s_cmp_ge_u32 s76, 32768
    s_waitcnt vmcnt(0)
    v_max3_u32 v38, v88, v92, v96
    v_max3_u32 v38, v38, v100, v104
    v_cmp_eq_u32 vcc, -1, v38
    s_cbranch_scc1 POLLX21
    s_cbranch_vccnz POLL21
POLLX21:
    s_mov_b64 exec, -1
    s_waitcnt lgkmcnt(0)
    v_mfma_f32_16x16x32_bf16 v[24:27], v[88:91], v[40:43], 0
    v_mfma_f32_16x16x32_bf16 v[28:31], v[88:91], v[60:63], 0
    v_mfma_f32_16x16x32_bf16 v[32:35], v[88:91], v[88:91], 0
    v_mfma_f32_16x16x32_bf16 v[24:27], v[92:95], v[44:47], v[24:27]
    v_mfma_f32_16x16x32_bf16 v[28:31], v[92:95], v[64:67], v[28:31]
    v_mfma_f32_16x16x32_bf16 v[32:35], v[92:95], v[92:95], v[32:35]
    v_mfma_f32_16x16x32_bf16 v[24:27], v[96:99], v[48:51], v[24:27]
    v_mfma_f32_16x16x32_bf16 v[28:31], v[96:99], v[68:71], v[28:31]
    v_mfma_f32_16x16x32_bf16 v[32:35], v[96:99], v[96:99], v[32:35]
    v_mfma_f32_16x16x32_bf16 v[24:27], v[100:103], v[52:55], v[24:27]
    v_mfma_f32_16x16x32_bf16 v[28:31], v[100:103], v[72:75], v[28:31]
    v_mfma_f32_16x16x32_bf16 v[32:35], v[100:103], v[100:103], v[32:35]
    v_mfma_f32_16x16x32_bf16 v[24:27], v[104:107], v[56:59], v[24:27]
    v_mfma_f32_16x16x32_bf16 v[28:31], v[104:107], v[76:79], v[28:31]
    v_mfma_f32_16x16x32_bf16 v[32:35], v[104:107], v[104:107], v[32:35]
    s_nop 5
    v_add_f32 v24, v24, v25
    v_add_f32 v26, v26, v27
    v_add_f32 v28, v28, v29
    v_add_f32 v30, v30, v31
    v_add_f32 v32, v32, v33
    v_add_f32 v34, v34, v35
    v_add_f32 v24, v24, v26
    v_add_f32 v28, v28, v30
    v_add_f32 v32, v32, v34
    ds_add_f32 v81, v24
    ds_add_f32 v81, v28 offset:64
    s_mov_b32 exec_lo, 0x1ff01ff
    s_mov_b32 exec_hi, 0x1ff01ff
    ds_add_f32 v82, v32
    s_mov_b64 exec, -1
    s_waitcnt lgkmcnt(0)
    s_barrier
    ds_read_b64 v[36:37], v85 offset:256
    ds_read_b128 v[88:91], v83 offset:0
    ds_read_b128 v[92:95], v83 offset:64
    ds_read_b128 v[96:99], v83 offset:128
    ds_read_b128 v[100:103], v83 offset:192
    ds_read_b64_tr_b16 v[40:41], v80 offset:0
    ds_read_b64_tr_b16 v[42:43], v80 offset:32
    ds_read_b64_tr_b16 v[44:45], v80 offset:64
    ds_read_b64_tr_b16 v[46:47], v80 offset:96
    ds_read_b64_tr_b16 v[48:49], v80 offset:128
    ds_read_b64_tr_b16 v[50:51], v80 offset:160
    ds_read_b64_tr_b16 v[52:53], v80 offset:192
    ds_read_b64_tr_b16 v[54:55], v80 offset:224
    ds_read_b64_tr_b16 v[56:57], v80 offset:256
    ds_read_b64_tr_b16 v[58:59], v80 offset:288
    s_waitcnt lgkmcnt(14)
    v_mul_f32 v37, 0x3acccccd, v37
    v_mul_f32 v36, 0x3acccccd, v36
    v_fma_f32 v36, -v37, v37, v36
    v_max_f32 v36, 0, v36
    v_add_f32 v36, 0x3727c5ac, v36
    v_rsq_f32 v36, v36
    s_waitcnt lgkmcnt(10)
    v_fma_f32 v88, -v37, v96, v88
    v_fma_f32 v89, -v37, v97, v89
    v_fma_f32 v90, -v37, v98, v90
    v_fma_f32 v91, -v37, v99, v91
    v_fma_f32 v92, -v37, v100, v92
    v_fma_f32 v93, -v37, v101, v93
    v_fma_f32 v94, -v37, v102, v94
    v_fma_f32 v95, -v37, v103, v95
    v_mul_f32 v38, 0xbfb8aa3b, v36
    v_mul_f32 v39, v36, v36
    v_mul_f32 v96, v38, v88
    v_mul_f32 v97, v38, v89
    v_mul_f32 v98, v38, v90
    v_mul_f32 v99, v38, v91
    v_exp_f32 v96, v96
    v_exp_f32 v97, v97
    v_exp_f32 v98, v98
    v_exp_f32 v99, v99
    v_mul_f32 v88, v88, v92
    v_mul_f32 v89, v89, v93
    v_mul_f32 v90, v90, v94
    v_mul_f32 v91, v91, v95
    v_add_f32 v96, 1.0, v96
    v_add_f32 v97, 1.0, v97
    v_add_f32 v98, 1.0, v98
    v_add_f32 v99, 1.0, v99
    v_rcp_f32 v96, v96
    v_rcp_f32 v97, v97
    v_rcp_f32 v98, v98
    v_rcp_f32 v99, v99
    v_mul_f32 v88, v88, v39
    v_mul_f32 v89, v89, v39
    v_mul_f32 v90, v90, v39
    v_mul_f32 v91, v91, v39
    v_mul_f32 v88, v88, v96
    v_mul_f32 v89, v89, v97
    v_mul_f32 v90, v90, v98
    v_mul_f32 v91, v91, v99
    v_cvt_pk_bf16_f32 v88, v88, v89
    v_cvt_pk_bf16_f32 v89, v90, v91
    v_cndmask_b32 v60, 0, v88, s[44:45]
    v_cndmask_b32 v61, 0, v89, s[44:45]
    v_cndmask_b32 v62, 0, v88, s[46:47]
    v_cndmask_b32 v63, 0, v89, s[46:47]
    s_waitcnt lgkmcnt(0)
    v_mfma_f32_16x16x16_bf16 v[24:27], v[40:41], v[60:61], 0
    v_cndmask_b32 v64, 0, v88, s[48:49]
    v_cndmask_b32 v65, 0, v89, s[48:49]
    v_mfma_f32_16x16x16_bf16 v[24:27], v[42:43], v[62:63], v[24:27]
    v_cndmask_b32 v66, 0, v88, s[50:51]
    v_cndmask_b32 v67, 0, v89, s[50:51]
    v_mfma_f32_16x16x16_bf16 v[24:27], v[44:45], v[64:65], v[24:27]
    v_cndmask_b32 v68, 0, v88, s[52:53]
    v_cndmask_b32 v69, 0, v89, s[52:53]
    v_mfma_f32_16x16x16_bf16 v[24:27], v[46:47], v[66:67], v[24:27]
    v_cndmask_b32 v70, 0, v88, s[54:55]
    v_cndmask_b32 v71, 0, v89, s[54:55]
    v_mfma_f32_16x16x16_bf16 v[24:27], v[48:49], v[68:69], v[24:27]
    v_cndmask_b32 v72, 0, v88, s[56:57]
    v_cndmask_b32 v73, 0, v89, s[56:57]
    v_mfma_f32_16x16x16_bf16 v[24:27], v[50:51], v[70:71], v[24:27]
    v_cndmask_b32 v74, 0, v88, s[58:59]
    v_cndmask_b32 v75, 0, v89, s[58:59]
    v_mfma_f32_16x16x16_bf16 v[24:27], v[52:53], v[72:73], v[24:27]
    v_cndmask_b32 v76, 0, v88, s[60:61]
    v_cndmask_b32 v77, 0, v89, s[60:61]
    v_mfma_f32_16x16x16_bf16 v[24:27], v[54:55], v[74:75], v[24:27]
    v_cndmask_b32 v78, 0, v88, s[62:63]
    v_cndmask_b32 v79, 0, v89, s[62:63]
    v_mfma_f32_16x16x16_bf16 v[24:27], v[56:57], v[76:77], v[24:27]
    s_nop 0
    v_mfma_f32_16x16x16_bf16 v[24:27], v[58:59], v[78:79], v[24:27]
    s_mov_b32 exec_lo, 0x3ff03ff
    s_mov_b32 exec_hi, 0x3ff03ff
    s_cmp_eq_u32 s75, 1
    s_cbranch_scc0 SLOW22
    s_nop 3
    buffer_store_dwordx4 v[24:27], v84, s[16:19], s78 offen
BACK22:
    s_mov_b64 exec, -1
NEXT:
    s_cmp_lg_u32 s74, 0
    s_cbranch_scc1 DONE
    s_mov_b32 s74, 688128
    s_add_u32 s3, s3, 688128
    v_add_u32 v15, 1536, v15
    s_branch LOOP
DONE:
    s_endpgm
RDYLOOP:
    s_mov_b32 s76, 0
RDYL2:
    s_sleep 8
    global_load_dword v99, v98, s[64:65] sc1
    s_waitcnt vmcnt(0)
    v_sad_u8 v100, v99, 0, 0
    s_nop 1
    v_add_u32_dpp v100, v100, v100 quad_perm:[1,0,3,2] row_mask:0xf bank_mask:0xf
    s_nop 1
    v_add_u32_dpp v100, v100, v100 quad_perm:[2,3,0,1] row_mask:0xf bank_mask:0xf
    v_cmp_ne_u32 vcc, 32, v100
    s_mov_b32 vcc_hi, 0
    s_cmp_eq_u64 vcc, 0
    s_cbranch_scc1 RDYOK
    s_add_u32 s76, s76, 1
    s_cmp_lt_u32 s76, 32768
    s_cbranch_scc1 RDYL2
    s_branch RDYOK
SLOW1:
    buffer_store_dword v24, v10, s[16:19], s79 offen sc1
    s_branch BACK1
SLOW2:
    buffer_store_dword v24, v10, s[16:19], s3 offen sc1
    s_branch BACK2
SLOW3:
    buffer_store_dwordx4 v[28:31], v27, s[16:19], s77 offen sc1
    s_branch BACK3
DMAF:
    v_lshrrev_b32 v24, 1, v0
    v_mul_u32_u24 v24, 3072, v24
    v_and_b32 v25, 1, v0
    v_lshl_add_u32 v24, v25, 4, v24
    s_mul_i32 s79, s68, 12
    s_add_u32 s79, s79, s69
    s_sub_u32 s79, s79, 20
    s_mul_i32 s77, s72, 491520
    s_lshl_b32 s78, s79, 5
    s_add_u32 s77, s77, s78
    s_mul_i32 s78, s72, 5120
    s_add_u32 m0, s78, 57344
    s_nop 0
    buffer_load_dwordx4 v24, s[24:27], s77 offen nt lds
    s_add_u32 m0, s78, 77824
    s_nop 0
    buffer_load_dwordx4 v24, s[28:31], s77 offen nt lds
    s_add_u32 s77, s77, 98304
    s_add_u32 m0, s78, 58368
    s_nop 0
    buffer_load_dwordx4 v24, s[24:27], s77 offen nt lds
    s_add_u32 m0, s78, 78848
    s_nop 0
    buffer_load_dwordx4 v24, s[28:31], s77 offen nt lds
    s_add_u32 s77, s77, 98304
    s_add_u32 m0, s78, 59392
    s_nop 0
    buffer_load_dwordx4 v24, s[24:27], s77 offen nt lds
    s_add_u32 m0, s78, 79872
    s_nop 0
    buffer_load_dwordx4 v24, s[28:31], s77 offen nt lds
    s_add_u32 s77, s77, 98304
    s_add_u32 m0, s78, 60416
    s_nop 0
    buffer_load_dwordx4 v24, s[24:27], s77 offen nt lds
    s_add_u32 m0, s78, 80896
    s_nop 0
    buffer_load_dwordx4 v24, s[28:31], s77 offen nt lds
    s_add_u32 s77, s77, 98304
    s_add_u32 m0, s78, 61440
    s_nop 0
    buffer_load_dwordx4 v24, s[24:27], s77 offen nt lds
    s_add_u32 m0, s78, 81920
    s_nop 0
    buffer_load_dwordx4 v24, s[28:31], s77 offen nt lds
    s_mul_i32 s77, s79, 20480
    s_add_u32 s77, s77, s78
    s_add_u32 m0, s78, 98304
    s_nop 0
    buffer_load_dwordx4 v1, s[32:35], s77 offen nt lds
    s_add_u32 s77, s77, 1024
    s_add_u32 m0, s78, 99328
    s_nop 0
    buffer_load_dwordx4 v1, s[32:35], s77 offen nt lds
    s_add_u32 s77, s77, 1024
    s_add_u32 m0, s78, 100352
    s_nop 0
    buffer_load_dwordx4 v1, s[32:35], s77 offen nt lds
    s_add_u32 s77, s77, 1024
    s_add_u32 m0, s78, 101376
    s_nop 0
    buffer_load_dwordx4 v1, s[32:35], s77 offen nt lds
    s_add_u32 s77, s77, 1024
    s_add_u32 m0, s78, 102400
    s_nop 0
    buffer_load_dwordx4 v1, s[32:35], s77 offen nt lds
    s_branch DMAX
RETRY4:
    s_add_u32 s77, s3, 1376256
    s_add_u32 s78, s3, 1380352
    s_add_u32 s79, s3, 4096
    s_mov_b32 s76, 0
POLL23:
    buffer_load_dwordx4 v[64:67], v11, s[16:19], s77 offen sc1
    buffer_load_dwordx4 v[68:71], v11, s[16:19], s78 offen sc1
    buffer_load_dwordx4 v[72:75], v11, s[16:19], s3 offen sc1
    buffer_load_dwordx4 v[76:79], v11, s[16:19], s79 offen sc1
    s_add_u32 s76, s76, 1
    s_cmp_ge_u32 s76, 32768
    s_waitcnt vmcnt(0)
    v_max3_u32 v24, v64, v65, v66
    v_max3_u32 v24, v24, v67, v68
    v_max3_u32 v24, v24, v69, v70
    v_max3_u32 v24, v24, v71, v72
    v_max3_u32 v24, v24, v73, v74
    v_max3_u32 v24, v24, v75, v76
    v_max3_u32 v24, v24, v77, v78
    v_max_u32 v24, v24, v79
    v_cmp_eq_u32 vcc, -1, v24
    s_cbranch_scc1 POLLX23
    s_cbranch_vccnz POLL23
POLLX23:
    s_branch OK4
SLOW5:
    buffer_store_dwordx2 v[36:37], v14, s[16:19], s77 offen sc1
    s_branch BACK5
SLOW7:
    buffer_store_dword v24, v10, s[16:19], s3 offen sc1
    s_branch BACK7
SLOW9:
    buffer_store_dwordx2 v[36:37], v14, s[16:19], s77 offen sc1
    s_branch BACK9
RETRY10:
    s_mov_b32 s76, 0
POLL24:
    buffer_load_dwordx2 v[34:35], v14, s[16:19], s3 offen sc1
    s_add_u32 s76, s76, 1
    s_cmp_ge_u32 s76, 32768
    s_waitcnt vmcnt(0)
    v_max_u32 v36, v34, v35
    v_cmp_eq_u32 vcc, -1, v36
    s_cbranch_scc1 POLLX24
    s_cbranch_vccnz POLL24
POLLX24:
    s_branch OK10
SLOW11:
    buffer_store_dwordx4 v[28:31], v1, s[16:19], s77 offen sc1
    s_branch BACK11
SLOW13:
    buffer_store_dwordx4 v[28:31], v37, s[16:19], s77 offen sc1
    s_branch BACK13
SLOW15:
    buffer_store_dwordx4 v[28:31], v1, s[16:19], s97 offen sc1
    s_branch BACK15
SLOW17:
    buffer_store_dwordx4 v[28:31], v39, s[16:19], s97 offen sc1
    s_branch BACK17
SLOW19:
    buffer_store_dwordx4 v[28:31], v37, s[16:19], s77 offen sc1
    s_branch BACK19
SLOW22:
    s_nop 3
    buffer_store_dwordx4 v[24:27], v84, s[16:19], s78 offen sc1
    s_branch BACK22
CODE_END:
    s_endpgm
.section .rodata,"a"
.p2align 6
.amdhsa_kernel interleave_layers__sliding_block_cached__glu_gated_swiglu__decode_kernel
  .amdhsa_next_free_vgpr 512
  .amdhsa_next_free_sgpr 102
  .amdhsa_accum_offset 256
  .amdhsa_group_segment_fixed_size 0
  .amdhsa_kernarg_size 96
  .amdhsa_user_sgpr_count 2
  .amdhsa_user_sgpr_kernarg_segment_ptr 1
  .amdhsa_system_sgpr_workgroup_id_x 1
.end_amdhsa_kernel
```

```asm
; @launch grid=(256,1,1) block=(256,1,1) lds=124416
.amdgcn_target "amdgcn-amd-amdhsa--gfx950"
.text
.globl interleave_layers__sliding_block_cached__glu_gated_swiglu__decode_kernel
.p2align 8
.type interleave_layers__sliding_block_cached__glu_gated_swiglu__decode_kernel,@function
interleave_layers__sliding_block_cached__glu_gated_swiglu__decode_kernel:
    s_cmp_ge_u32 s2, 256
    s_cbranch_scc1 CODE_END
    s_load_dwordx16 s[44:59], s[0:1], 0
    s_load_dwordx8 s[60:67], s[0:1], 64
    v_lshrrev_b32 v2, 6, v0
    v_and_b32 v24, 63, v0
    v_readfirstlane_b32 s72, v2
    s_and_b32 s68, s2, 7
    s_lshr_b32 s69, s2, 3
    s_lshr_b32 s70, s69, 3
    s_and_b32 s71, s69, 7
    v_lshlrev_b32 v1, 4, v24
    s_lshl_b32 s77, s70, 3
    s_add_u32 s77, s77, s68
    s_mul_i32 s73, s77, 12582912
    s_lshl_b32 s78, s71, 2
    s_add_u32 s78, s78, s72
    s_mul_i32 s78, s78, 6144
    s_add_u32 s73, s73, s78
    s_add_u32 s73, s73, 11010048
    s_mul_i32 s79, s77, 384
    s_mov_b32 s74, 0
    s_mul_i32 s3, s68, 81920
    s_mov_b32 s75, 0
    v_mov_b32 v32, -1
    v_mov_b32 v33, -1
    v_mov_b32 v34, -1
    v_mov_b32 v35, -1
    s_mul_i32 s77, s69, 2560
    s_add_u32 s77, s77, s3
    v_lshl_add_u32 v20, v0, 4, s77
    v_cmp_le_u32 vcc, 160, v0
    v_add_u32 v25, 685568, v20
    s_nop 0
    v_cndmask_b32 v20, v20, v25, vcc
    s_add_u32 s77, s77, 689664
    s_lshl_b32 s78, s69, 10
    s_add_u32 s78, s78, s3
    s_add_u32 s78, s78, 1376256
    s_cmp_eq_u32 s72, 0
    s_cselect_b32 s4, s77, s78
    s_mul_i32 s77, s2, 80
    s_add_u32 s77, s77, 655360
    s_cmp_ge_u32 s72, 2
    s_cselect_b32 s4, s77, s4
    v_add_u32 v25, 688048, v1
    v_cmp_le_u32 vcc, 133, v0
    s_nop 1
    v_cndmask_b32 v21, v1, v25, vcc
    v_mov_b32 v25, 1879048176
    v_cmp_le_u32 vcc, 138, v0
    s_nop 1
    v_cndmask_b32 v21, v21, v25, vcc
    s_waitcnt lgkmcnt(0)
    s_mov_b32 s8, s46
    s_and_b32 s9, s47, 0xffff
    s_mov_b32 s10, 402653184
    s_mov_b32 s11, 0x20000
    s_add_u32 s6, s73, 0
    buffer_load_dwordx4 a[0:3], v1, s[8:11], s6 offen offset:0 nt
    buffer_load_dwordx4 a[4:7], v1, s[8:11], s6 offen offset:1024 nt
    buffer_load_dwordx4 a[8:11], v1, s[8:11], s6 offen offset:2048 nt
    buffer_load_dwordx4 a[12:15], v1, s[8:11], s6 offen offset:3072 nt
    s_add_u32 s6, s6, 4096
    buffer_load_dwordx4 a[16:19], v1, s[8:11], s6 offen offset:0 nt
    buffer_load_dwordx4 a[20:23], v1, s[8:11], s6 offen offset:1024 nt
    s_mov_b32 s16, s66
    s_and_b32 s17, s67, 0xffff
    s_mov_b32 s18, 1610612736
    s_mov_b32 s19, 0x20000
    buffer_store_dwordx4 v[32:35], v20, s[16:19], 0 offen sc1
    buffer_store_dwordx4 v[32:35], v21, s[16:19], s4 offen sc1
    s_getpc_b64 s[100:101]
PCREF:
    s_sub_u32 s100, s100, PCREF-interleave_layers__sliding_block_cached__glu_gated_swiglu__decode_kernel
    s_subb_u32 s101, s101, 0
    s_and_b32 s77, s69, 7
    s_lshl_b32 s77, s77, 12
    v_lshl_add_u32 v25, v0, 4, s77
    v_cmp_gt_u32 vcc, CODE_END-interleave_layers__sliding_block_cached__glu_gated_swiglu__decode_kernel-16, v25
    s_nop 0
    s_and_saveexec_b64 s[98:99], vcc
    s_cbranch_execz NOCPF
    global_load_dwordx4 a[240:243], v25, s[100:101]
NOCPF:
    s_mov_b64 exec, -1
    s_add_u32 s6, s73, 196608
    buffer_load_dwordx4 a[24:27], v1, s[8:11], s6 offen offset:0 nt
    buffer_load_dwordx4 a[28:31], v1, s[8:11], s6 offen offset:1024 nt
    buffer_load_dwordx4 a[32:35], v1, s[8:11], s6 offen offset:2048 nt
    buffer_load_dwordx4 a[36:39], v1, s[8:11], s6 offen offset:3072 nt
    s_add_u32 s6, s6, 4096
    buffer_load_dwordx4 a[40:43], v1, s[8:11], s6 offen offset:0 nt
    buffer_load_dwordx4 a[44:47], v1, s[8:11], s6 offen offset:1024 nt
    s_mov_b32 s12, s48
    s_and_b32 s13, s49, 0xffff
    s_mov_b32 s14, 402653184
    s_mov_b32 s15, 0x20000
    s_mov_b32 s20, s50
    s_and_b32 s21, s51, 0xffff
    s_mov_b32 s22, 7864320
    s_mov_b32 s23, 0x20000
    s_mov_b32 s36, s44
    s_and_b32 s37, s45, 0xffff
    s_mov_b32 s38, 1280
    s_mov_b32 s39, 0x20000
    s_mov_b32 s40, s62
    s_and_b32 s41, s63, 0xffff
    s_mov_b32 s42, 1280
    s_mov_b32 s43, 0x20000
    s_mov_b32 s28, s58
    s_and_b32 s29, s59, 0xffff
    s_mov_b32 s30, 1966080
    s_mov_b32 s31, 0x20000
    s_mov_b32 s32, s60
    s_and_b32 s33, s61, 0xffff
    s_mov_b32 s34, 1966080
    s_mov_b32 s35, 0x20000
    s_cmp_lt_u32 s69, 20
    s_cselect_b32 s24, s52, s56
    s_cselect_b32 s25, s53, s57
    s_cselect_b32 s26, s22, s30
    s_and_b32 s25, s25, 0xffff
    s_mov_b32 s27, 0x20000
    s_waitcnt vmcnt(6)
    s_barrier
    s_getreg_b32 s5, hwreg(HW_REG_XCC_ID, 0, 4)
    s_lshr_b32 s77, s5, 2
    s_lshl_b32 s78, s68, 2
    s_add_u32 s77, s77, s78
    s_and_b32 s78, s5, 3
    s_lshl_b32 s78, s78, 3
    s_lshl_b32 s7, 1, s78
    s_lshl_b32 s96, 32, s78
    s_mov_b32 s5, s77
    s_cmp_lg_u32 s72, 0
    s_cbranch_scc1 NOATOM
    s_lshl_b32 s77, s77, 2
    v_mov_b32 v36, s77
    v_mov_b32 v37, s7
    s_mov_b64 exec, 1
    global_atomic_add v36, v37, s[64:65] sc1
    s_mov_b64 exec, -1
NOATOM:
    v_mov_b32 v0, v24
    s_mul_i32 s77, s72, 6656
    v_add_u32 v25, 0, v0
    v_mul_u32_u24 v26, 171, v25
    v_lshrrev_b32 v26, 12, v26
    v_mul_u32_u24 v27, 24, v26
    v_sub_u32 v27, v25, v27
    v_lshlrev_b32 v27, 4, v27
    v_mul_u32_u24 v25, 416, v26
    v_add3_u32 v2, v25, v27, s77
    v_mul_u32_u24 v25, 12288, v26
    v_add_u32 v40, v25, v27
    v_add_u32 v25, 64, v0
    v_mul_u32_u24 v26, 171, v25
    v_lshrrev_b32 v26, 12, v26
    v_mul_u32_u24 v27, 24, v26
    v_sub_u32 v27, v25, v27
    v_lshlrev_b32 v27, 4, v27
    v_mul_u32_u24 v25, 416, v26
    v_add3_u32 v3, v25, v27, s77
    v_mul_u32_u24 v25, 12288, v26
    v_add_u32 v41, v25, v27
    v_add_u32 v25, 128, v0
    v_mul_u32_u24 v26, 171, v25
    v_lshrrev_b32 v26, 12, v26
    v_mul_u32_u24 v27, 24, v26
    v_sub_u32 v27, v25, v27
    v_lshlrev_b32 v27, 4, v27
    v_mul_u32_u24 v25, 416, v26
    v_add3_u32 v4, v25, v27, s77
    v_mul_u32_u24 v25, 12288, v26
    v_add_u32 v42, v25, v27
    s_mul_i32 s78, s71, 983040
    s_add_u32 s79, s79, s78
    s_mul_i32 s78, s72, 98304
    s_add_u32 s79, s79, s78
    s_mul_i32 s78, s72, 3072
    s_add_u32 s78, s78, 26624
    s_add_u32 m0, s78, 0
    s_nop 0
    buffer_load_dwordx4 v40, s[20:23], s79 offen nt lds
    s_add_u32 m0, s78, 1024
    s_nop 0
    buffer_load_dwordx4 v41, s[20:23], s79 offen nt lds
    s_add_u32 m0, s78, 2048
    s_nop 0
    buffer_load_dwordx4 v42, s[20:23], s79 offen nt lds
    s_add_u32 s79, s79, 393216
    s_add_u32 m0, s78, 12288
    s_nop 0
    buffer_load_dwordx4 v40, s[20:23], s79 offen nt lds
    s_add_u32 m0, s78, 13312
    s_nop 0
    buffer_load_dwordx4 v41, s[20:23], s79 offen nt lds
    s_add_u32 m0, s78, 14336
    s_nop 0
    buffer_load_dwordx4 v42, s[20:23], s79 offen nt lds
    s_add_u32 s79, s79, 393216
    s_cmp_ge_u32 s72, 2
    s_cbranch_scc1 NOWQ3
    s_add_u32 m0, s78, 24576
    s_nop 0
    buffer_load_dwordx4 v40, s[20:23], s79 offen nt lds
    s_add_u32 m0, s78, 25600
    s_nop 0
    buffer_load_dwordx4 v41, s[20:23], s79 offen nt lds
    s_add_u32 m0, s78, 26624
    s_nop 0
    buffer_load_dwordx4 v42, s[20:23], s79 offen nt lds
NOWQ3:
    v_and_b32 v25, 15, v0
    v_lshrrev_b32 v26, 4, v0
    v_bfe_u32 v27, v0, 2, 2
    v_and_b32 v28, 3, v0
    v_cmp_eq_u32 vcc, 12, v25
    v_mov_b32 v36, 0x3f803f80
    s_nop 0
    v_cndmask_b32 v70, 0, v36, vcc
    v_mov_b32 v71, v70
    v_mov_b32 v72, v70
    v_mov_b32 v73, v70
    v_mov_b32 v74, v70
    v_mov_b32 v75, v70
    v_mov_b32 v76, v70
    v_mov_b32 v77, v70
    v_mov_b32 v78, v70
    v_mov_b32 v79, v70
    v_mov_b32 v88, v70
    v_mov_b32 v89, v70
    v_mov_b32 v90, v70
    v_mov_b32 v91, v70
    v_mov_b32 v92, v70
    v_mov_b32 v93, v70
    v_mov_b32 v94, v70
    v_mov_b32 v95, v70
    v_mov_b32 v96, v70
    v_mov_b32 v97, v70
    s_mul_i32 s78, s71, 160
    v_lshlrev_b32 v36, 4, v26
    v_lshlrev_b32 v37, 3, v26
    s_mov_b32 exec_lo, 0x1000100
    s_mov_b32 exec_hi, 0x1000100
    buffer_load_dwordx4 v[88:91], v36, s[36:39], s78 offen
    buffer_load_dwordx4 v[92:95], v36, s[36:39], s78 offen offset:64
    buffer_load_dwordx2 v[96:97], v37, s[36:39], s78 offen offset:128
    s_mov_b64 exec, -1
    s_lshl_b32 s79, s69, 6
    v_lshlrev_b32 v38, 2, v25
    buffer_load_dword v22, v38, s[36:39], s79 offen
    s_mov_b32 s20, s52
    s_and_b32 s21, s53, 0xffff
    s_mov_b32 s22, 7864320
    s_mov_b32 s23, 0x20000
    s_cmp_lt_u32 s72, 2
    s_cselect_b32 s36, s56, s58
    s_cselect_b32 s37, s57, s59
    s_and_b32 s37, s37, 0xffff
    s_mov_b32 s38, 1966080
    s_add_u32 s6, s73, 393216
    buffer_load_dwordx4 a[48:51], v1, s[8:11], s6 offen offset:0 nt
    buffer_load_dwordx4 a[52:55], v1, s[8:11], s6 offen offset:1024 nt
    buffer_load_dwordx4 a[56:59], v1, s[8:11], s6 offen offset:2048 nt
    buffer_load_dwordx4 a[60:63], v1, s[8:11], s6 offen offset:3072 nt
    s_add_u32 s6, s6, 4096
    buffer_load_dwordx4 a[64:67], v1, s[8:11], s6 offen offset:0 nt
    buffer_load_dwordx4 a[68:71], v1, s[8:11], s6 offen offset:1024 nt
    v_mul_u32_u24 v29, 416, v25
    v_lshl_add_u32 v29, v26, 4, v29
    v_add_u32 v5, s77, v29
    v_lshrrev_b32 v29, 2, v0
    v_mul_u32_u24 v29, 416, v29
    v_lshl_add_u32 v29, v28, 3, v29
    v_add_u32 v6, s77, v29
    s_mul_i32 s79, s72, 96
    s_add_u32 s79, s79, 26624
    v_lshl_add_u32 v29, v26, 3, v27
    v_mul_u32_u24 v29, 384, v29
    v_lshl_add_u32 v29, v28, 3, v29
    v_add_u32 v16, s79, v29
    v_lshl_add_u32 v29, v26, 2, v27
    v_mul_u32_u24 v29, 384, v29
    v_lshl_add_u32 v29, v28, 3, v29
    v_add_u32 v17, s79, v29
    v_mul_u32_u24 v31, 103, v0
    v_lshrrev_b32 v31, 10, v31
    v_mul_u32_u24 v30, 10, v31
    v_sub_u32 v30, v0, v30
    v_lshl_add_u32 v29, v30, 4, s78
    v_mul_u32_u24 v8, 1280, v31
    v_add_u32 v8, 665600, v8
    s_mul_i32 s7, s68, 81920
    s_add_u32 s7, s7, 78080
    v_mov_b32 v30, s7
    v_cmp_eq_u32 vcc, s68, v31
    s_nop 1
    v_cndmask_b32 v8, v8, v30, vcc
    v_add_u32 v30, 2560, v30
    v_cmp_le_u32 vcc, 8, v31
    s_nop 1
    v_cndmask_b32 v8, v8, v30, vcc
    v_add_u32 v8, v8, v29
    v_add_u32 v31, 6, v31
    v_mul_u32_u24 v9, 1280, v31
    v_add_u32 v9, 665600, v9
    s_mul_i32 s7, s68, 81920
    s_add_u32 s7, s7, 78080
    v_mov_b32 v30, s7
    v_cmp_eq_u32 vcc, s68, v31
    s_nop 1
    v_cndmask_b32 v9, v9, v30, vcc
    v_add_u32 v30, 2560, v30
    v_cmp_le_u32 vcc, 8, v31
    s_nop 1
    v_cndmask_b32 v9, v9, v30, vcc
    v_add_u32 v9, v9, v29
    v_mov_b32 v30, 2147483632
    v_cmp_le_u32 vcc, 30, v0
    s_nop 1
    v_cndmask_b32 v9, v9, v30, vcc
    s_lshl_b32 s78, s69, 10
    s_lshl_b32 s79, s72, 8
    s_add_u32 s78, s78, s79
    v_lshl_add_u32 v10, v0, 2, s78
    s_lshl_b32 s78, s70, 13
    s_add_u32 s78, s78, s79
    v_lshlrev_b32 v29, 10, v26
    v_lshl_add_u32 v29, v25, 4, v29
    v_add_u32 v11, s78, v29
    s_mul_i32 s78, s72, 96
    s_add_u32 s78, s78, 118784
    v_lshl_add_u32 v29, v25, 2, v26
    v_lshl_add_u32 v29, v29, 1, s78
    v_mov_b32 v30, 119168
    v_cmp_le_u32 vcc, 12, v25
    s_nop 1
    v_cndmask_b32 v12, v29, v30, vcc
    v_lshlrev_b32 v29, 4, v26
    v_add_u32 v13, 118784, v29
    s_lshl_b32 s78, s70, 8
    s_add_u32 s78, s78, 45056
    v_and_b32 v29, 31, v0
    v_lshl_add_u32 v14, v29, 3, s78
    s_mul_i32 s78, s72, 768
    s_add_u32 s78, s78, 119296
    v_lshl_add_u32 v15, v0, 2, s78
    s_mov_b32 s80, 0x1010101
    s_mov_b32 s81, 0x1010101
    s_mov_b32 s82, 0x2020202
    s_mov_b32 s83, 0x2020202
    s_mov_b32 s84, 0x4040404
    s_mov_b32 s85, 0x4040404
    s_mov_b32 s86, 0x8080808
    s_mov_b32 s87, 0x8080808
    s_mov_b32 s88, 0x10101010
    s_mov_b32 s89, 0x10101010
    s_mov_b32 s90, 0x20202020
    s_mov_b32 s91, 0x20202020
    s_mov_b32 s92, 0x40404040
    s_mov_b32 s93, 0x40404040
    s_mov_b32 s94, 0x80808080
    s_mov_b32 s95, 0x80808080
    s_mov_b32 s44, 0x10001
    s_mov_b32 s45, 0x10001
    s_mov_b32 s46, 0x20002
    s_mov_b32 s47, 0x20002
    s_mov_b32 s48, 0x40004
    s_mov_b32 s49, 0x40004
    s_mov_b32 s50, 0x80008
    s_mov_b32 s51, 0x80008
    s_mov_b32 s52, 0x100010
    s_mov_b32 s53, 0x100010
    s_mov_b32 s54, 0x200020
    s_mov_b32 s55, 0x200020
    s_mov_b32 s56, 0x400040
    s_mov_b32 s57, 0x400040
    s_mov_b32 s58, 0x800080
    s_mov_b32 s59, 0x800080
    s_mov_b32 s60, 0x1000100
    s_mov_b32 s61, 0x1000100
    s_mov_b32 s62, 0x2000200
    s_mov_b32 s63, 0x2000200
    ds_write_b128 v2, a[0:3] offset:0
    ds_write_b128 v3, a[4:7] offset:0
    ds_write_b128 v4, a[8:11] offset:0
    ds_write_b128 v2, a[12:15] offset:3328
    ds_write_b128 v3, a[16:19] offset:3328
    ds_write_b128 v4, a[20:23] offset:3328
    ds_read_b128 a[0:3], v5 offset:0
    ds_read_b128 a[4:7], v5 offset:64
    ds_read_b128 a[8:11], v5 offset:128
    ds_read_b128 a[12:15], v5 offset:192
    ds_read_b128 a[16:19], v5 offset:256
    ds_read_b128 a[20:23], v5 offset:320
    s_add_u32 s6, s73, 589824
    buffer_load_dwordx4 a[72:75], v1, s[8:11], s6 offen offset:0 nt
    buffer_load_dwordx4 a[76:79], v1, s[8:11], s6 offen offset:1024 nt
    buffer_load_dwordx4 a[80:83], v1, s[8:11], s6 offen offset:2048 nt
    buffer_load_dwordx4 a[84:87], v1, s[8:11], s6 offen offset:3072 nt
    s_add_u32 s6, s6, 4096
    buffer_load_dwordx4 a[88:91], v1, s[8:11], s6 offen offset:0 nt
    buffer_load_dwordx4 a[92:95], v1, s[8:11], s6 offen offset:1024 nt
    s_waitcnt vmcnt(22)
    ds_write_b128 v2, a[24:27] offset:0
    ds_write_b128 v3, a[28:31] offset:0
    ds_write_b128 v4, a[32:35] offset:0
    ds_write_b128 v2, a[36:39] offset:3328
    ds_write_b128 v3, a[40:43] offset:3328
    ds_write_b128 v4, a[44:47] offset:3328
    ds_read_b128 a[24:27], v5 offset:0
    ds_read_b128 a[28:31], v5 offset:64
    ds_read_b128 a[32:35], v5 offset:128
    ds_read_b128 a[36:39], v5 offset:192
    ds_read_b128 a[40:43], v5 offset:256
    ds_read_b128 a[44:47], v5 offset:320
    s_lshl_b32 s77, s70, 3
    s_add_u32 s77, s77, s68
    s_lshl_b32 s77, s77, 3
    s_add_u32 s77, s77, s71
    s_lshl_b32 s77, s77, 2
    s_add_u32 s77, s77, s72
    s_mul_i32 s77, s77, 7680
    buffer_load_dwordx4 a[240:243], v1, s[20:23], s77 offen offset:0
    buffer_load_dwordx4 a[240:243], v1, s[20:23], s77 offen offset:1024
    buffer_load_dwordx4 a[240:243], v1, s[20:23], s77 offen offset:2048
    buffer_load_dwordx4 a[240:243], v1, s[20:23], s77 offen offset:3072
    s_add_u32 s77, s77, 4096
    buffer_load_dwordx4 a[240:243], v1, s[20:23], s77 offen offset:0
    buffer_load_dwordx4 a[240:243], v1, s[20:23], s77 offen offset:1024
    buffer_load_dwordx4 a[240:243], v1, s[20:23], s77 offen offset:2048
    s_mov_b32 exec_lo, 0xffffffff
    s_mov_b32 exec_hi, 0x0
    buffer_load_dwordx4 a[240:243], v1, s[20:23], s77 offen offset:3072
    s_mov_b64 exec, -1
    s_waitcnt vmcnt(14)
    ds_write_b128 v2, a[48:51] offset:0
    ds_write_b128 v3, a[52:55] offset:0
    ds_write_b128 v4, a[56:59] offset:0
    ds_write_b128 v2, a[60:63] offset:3328
    ds_write_b128 v3, a[64:67] offset:3328
    ds_write_b128 v4, a[68:71] offset:3328
    ds_read_b128 a[48:51], v5 offset:0
    ds_read_b128 a[52:55], v5 offset:64
    ds_read_b128 a[56:59], v5 offset:128
    ds_read_b128 a[60:63], v5 offset:192
    ds_read_b128 a[64:67], v5 offset:256
    ds_read_b128 a[68:71], v5 offset:320
    s_waitcnt lgkmcnt(0)
    s_barrier
    ds_read_b64_tr_b16 v[40:41], v16 offset:0
    ds_read_b64_tr_b16 v[42:43], v16 offset:1536
    ds_read_b64_tr_b16 v[44:45], v16 offset:12288
    ds_read_b64_tr_b16 v[46:47], v16 offset:13824
    ds_read_b64_tr_b16 v[48:49], v17 offset:24576
    ds_read_b64_tr_b16 v[50:51], v16 offset:32
    ds_read_b64_tr_b16 v[52:53], v16 offset:1568
    ds_read_b64_tr_b16 v[54:55], v16 offset:12320
    ds_read_b64_tr_b16 v[56:57], v16 offset:13856
    ds_read_b64_tr_b16 v[58:59], v17 offset:24608
    ds_read_b64_tr_b16 v[60:61], v16 offset:64
    ds_read_b64_tr_b16 v[62:63], v16 offset:1600
    ds_read_b64_tr_b16 v[64:65], v16 offset:12352
    ds_read_b64_tr_b16 v[66:67], v16 offset:13888
    ds_read_b64_tr_b16 v[68:69], v17 offset:24640
    s_add_u32 s6, s73, 786432
    buffer_load_dwordx4 a[96:99], v1, s[8:11], s6 offen offset:0 nt
    buffer_load_dwordx4 a[100:103], v1, s[8:11], s6 offen offset:1024 nt
    buffer_load_dwordx4 a[104:107], v1, s[8:11], s6 offen offset:2048 nt
    buffer_load_dwordx4 a[108:111], v1, s[8:11], s6 offen offset:3072 nt
    s_add_u32 s6, s6, 4096
    buffer_load_dwordx4 a[112:115], v1, s[8:11], s6 offen offset:0 nt
    buffer_load_dwordx4 a[116:119], v1, s[8:11], s6 offen offset:1024 nt
    s_add_u32 s6, s73, 983040
    buffer_load_dwordx4 a[120:123], v1, s[8:11], s6 offen offset:0 nt
    buffer_load_dwordx4 a[124:127], v1, s[8:11], s6 offen offset:1024 nt
    buffer_load_dwordx4 a[128:131], v1, s[8:11], s6 offen offset:2048 nt
    buffer_load_dwordx4 a[132:135], v1, s[8:11], s6 offen offset:3072 nt
    s_add_u32 s6, s6, 4096
    buffer_load_dwordx4 a[136:139], v1, s[8:11], s6 offen offset:0 nt
    buffer_load_dwordx4 a[140:143], v1, s[8:11], s6 offen offset:1024 nt
    s_waitcnt vmcnt(20)
    ds_write_b128 v2, a[72:75] offset:0
    ds_write_b128 v3, a[76:79] offset:0
    ds_write_b128 v4, a[80:83] offset:0
    ds_write_b128 v2, a[84:87] offset:3328
    ds_write_b128 v3, a[88:91] offset:3328
    ds_write_b128 v4, a[92:95] offset:3328
    ds_read_b128 a[72:75], v5 offset:0
    ds_read_b128 a[76:79], v5 offset:64
    ds_read_b128 a[80:83], v5 offset:128
    ds_read_b128 a[84:87], v5 offset:192
    ds_read_b128 a[88:91], v5 offset:256
    ds_read_b128 a[92:95], v5 offset:320
    v_lshlrev_b32 v98, 2, v0
    global_load_dword v99, v98, s[64:65] sc1
    s_add_u32 s6, s73, 1179648
    buffer_load_dwordx4 a[144:147], v1, s[8:11], s6 offen offset:0 nt
    buffer_load_dwordx4 a[148:151], v1, s[8:11], s6 offen offset:1024 nt
    buffer_load_dwordx4 a[152:155], v1, s[8:11], s6 offen offset:2048 nt
    buffer_load_dwordx4 a[156:159], v1, s[8:11], s6 offen offset:3072 nt
    s_add_u32 s6, s6, 4096
    buffer_load_dwordx4 a[160:163], v1, s[8:11], s6 offen offset:0 nt
    buffer_load_dwordx4 a[164:167], v1, s[8:11], s6 offen offset:1024 nt
    s_waitcnt vmcnt(13)
    ds_write_b128 v2, a[96:99] offset:0
    ds_write_b128 v3, a[100:103] offset:0
    ds_write_b128 v4, a[104:107] offset:0
    ds_write_b128 v2, a[108:111] offset:3328
    ds_write_b128 v3, a[112:115] offset:3328
    ds_write_b128 v4, a[116:119] offset:3328
    ds_read_b128 a[96:99], v5 offset:0
    ds_read_b128 a[100:103], v5 offset:64
    ds_read_b128 a[104:107], v5 offset:128
    ds_read_b128 a[108:111], v5 offset:192
    ds_read_b128 a[112:115], v5 offset:256
    ds_read_b128 a[116:119], v5 offset:320
    s_add_u32 s6, s73, 1376256
    buffer_load_dwordx4 a[168:171], v1, s[8:11], s6 offen offset:0 nt
    buffer_load_dwordx4 a[172:175], v1, s[8:11], s6 offen offset:1024 nt
    buffer_load_dwordx4 a[176:179], v1, s[8:11], s6 offen offset:2048 nt
    buffer_load_dwordx4 a[180:183], v1, s[8:11], s6 offen offset:3072 nt
    s_add_u32 s6, s6, 4096
    buffer_load_dwordx4 a[184:187], v1, s[8:11], s6 offen offset:0 nt
    buffer_load_dwordx4 a[188:191], v1, s[8:11], s6 offen offset:1024 nt
    s_waitcnt vmcnt(13)
    ds_write_b128 v2, a[120:123] offset:0
    ds_write_b128 v3, a[124:127] offset:0
    ds_write_b128 v4, a[128:131] offset:0
    ds_write_b128 v2, a[132:135] offset:3328
    ds_write_b128 v3, a[136:139] offset:3328
    ds_write_b128 v4, a[140:143] offset:3328
    ds_read_b128 a[120:123], v5 offset:0
    ds_read_b128 a[124:127], v5 offset:64
    ds_read_b128 a[128:131], v5 offset:128
    ds_read_b128 a[132:135], v5 offset:192
    ds_read_b128 a[136:139], v5 offset:256
    ds_read_b128 a[140:143], v5 offset:320
    s_waitcnt vmcnt(12)
    v_sad_u8 v100, v99, 0, 0
    s_nop 1
    v_add_u32_dpp v100, v100, v100 quad_perm:[1,0,3,2] row_mask:0xf bank_mask:0xf
    s_nop 1
    v_add_u32_dpp v100, v100, v100 quad_perm:[2,3,0,1] row_mask:0xf bank_mask:0xf
    v_cmp_gt_u32 vcc, 32, v100
    s_mov_b32 vcc_hi, 0
    s_cmp_eq_u64 vcc, 0
    s_cbranch_scc0 RDYLOOP
RDYOK:
    v_readlane_b32 s77, v99, s5
    s_nop 0
    s_cmp_eq_u32 s77, s96
    s_cselect_b32 s75, 1, 0
    buffer_load_dwordx4 a[240:243], v20, s[16:19], 0 offen sc1
    buffer_load_dwordx4 a[240:243], v21, s[16:19], s4 offen sc1
    s_waitcnt lgkmcnt(0)
    s_add_u32 s79, s3, 1376256
    v_mfma_f32_16x16x32_bf16 v[24:27], v[70:73], v[40:43], 0
    v_mfma_f32_16x16x32_bf16 v[28:31], v[70:73], v[50:53], 0
    v_mfma_f32_16x16x32_bf16 v[32:35], v[70:73], v[60:63], 0
    v_mfma_f32_16x16x32_bf16 v[36:39], v[70:73], v[70:73], 0
    v_mfma_f32_16x16x32_bf16 v[24:27], v[74:77], v[44:47], v[24:27]
    v_mfma_f32_16x16x32_bf16 v[28:31], v[74:77], v[54:57], v[28:31]
    v_mfma_f32_16x16x32_bf16 v[32:35], v[74:77], v[64:67], v[32:35]
    v_mfma_f32_16x16x32_bf16 v[36:39], v[74:77], v[74:77], v[36:39]
    v_mfma_f32_16x16x16_bf16 v[24:27], v[78:79], v[48:49], v[24:27]
    v_mfma_f32_16x16x16_bf16 v[28:31], v[78:79], v[58:59], v[28:31]
    v_mfma_f32_16x16x16_bf16 v[32:35], v[78:79], v[68:69], v[32:35]
    v_mfma_f32_16x16x16_bf16 v[36:39], v[78:79], v[78:79], v[36:39]
    s_nop 4
    v_add_f32 v24, v24, v25
    v_add_f32 v26, v26, v27
    v_add_f32 v28, v28, v29
    v_add_f32 v30, v30, v31
    v_add_f32 v32, v32, v33
    v_add_f32 v34, v34, v35
    v_add_f32 v36, v36, v37
    v_add_f32 v38, v38, v39
    v_add_f32 v24, v24, v26
    v_add_f32 v28, v28, v30
    v_add_f32 v32, v32, v34
    v_add_f32 v36, v36, v38
    s_nop 0
    v_permlane32_swap_b32 v24, v32
    v_permlane32_swap_b32 v28, v36
    v_add_f32 v24, v24, v32
    v_add_f32 v28, v28, v36
    s_nop 1
    v_permlane16_swap_b32 v24, v28
    v_add_f32 v24, v24, v28
    s_cmp_eq_u32 s75, 1
    s_cbranch_scc0 SLOW1
    buffer_store_dword v24, v10, s[16:19], s79 offen
BACK1:
    v_mfma_f32_16x16x32_bf16 v[24:27], v[88:91], v[40:43], 0
    v_mfma_f32_16x16x32_bf16 v[28:31], v[88:91], v[50:53], 0
    v_mfma_f32_16x16x32_bf16 v[32:35], v[88:91], v[60:63], 0
    v_mfma_f32_16x16x32_bf16 v[36:39], v[88:91], v[88:91], 0
    v_mfma_f32_16x16x32_bf16 v[24:27], v[92:95], v[44:47], v[24:27]
    v_mfma_f32_16x16x32_bf16 v[28:31], v[92:95], v[54:57], v[28:31]
    v_mfma_f32_16x16x32_bf16 v[32:35], v[92:95], v[64:67], v[32:35]
    v_mfma_f32_16x16x32_bf16 v[36:39], v[92:95], v[92:95], v[36:39]
    v_mfma_f32_16x16x16_bf16 v[24:27], v[96:97], v[48:49], v[24:27]
    v_mfma_f32_16x16x16_bf16 v[28:31], v[96:97], v[58:59], v[28:31]
    v_mfma_f32_16x16x16_bf16 v[32:35], v[96:97], v[68:69], v[32:35]
    v_mfma_f32_16x16x16_bf16 v[36:39], v[96:97], v[96:97], v[36:39]
    s_nop 4
    v_add_f32 v24, v24, v25
    v_add_f32 v26, v26, v27
    v_add_f32 v28, v28, v29
    v_add_f32 v30, v30, v31
    v_add_f32 v32, v32, v33
    v_add_f32 v34, v34, v35
    v_add_f32 v36, v36, v37
    v_add_f32 v38, v38, v39
    v_add_f32 v24, v24, v26
    v_add_f32 v28, v28, v30
    v_add_f32 v32, v32, v34
    v_add_f32 v36, v36, v38
    s_nop 0
    v_permlane32_swap_b32 v24, v32
    v_permlane32_swap_b32 v28, v36
    v_add_f32 v24, v24, v32
    v_add_f32 v28, v28, v36
    s_nop 1
    v_permlane16_swap_b32 v24, v28
    v_add_f32 v24, v24, v28
    s_cmp_eq_u32 s75, 1
    s_cbranch_scc0 SLOW2
    buffer_store_dword v24, v10, s[16:19], s3 offen
BACK2:
    s_cmp_lg_u32 s72, 1
    s_cbranch_scc1 NOBASE0
    s_cmp_ge_u32 s69, 20
    s_cbranch_scc1 NOBASE0
    v_mov_b32 v28, v22
    s_lshl_b32 s77, s69, 6
    s_add_u32 s77, s77, s3
    s_add_u32 s77, s77, 79360
    v_lshlrev_b32 v27, 2, v0
    v_mov_b32_dpp v29, v28 quad_perm:[1,1,1,1] row_mask:0xf bank_mask:0xf
    v_mov_b32_dpp v30, v28 quad_perm:[2,2,2,2] row_mask:0xf bank_mask:0xf
    v_mov_b32_dpp v31, v28 quad_perm:[3,3,3,3] row_mask:0xf bank_mask:0xf
    s_mov_b32 exec_lo, 0x1111
    s_mov_b32 exec_hi, 0x0
    s_cmp_eq_u32 s75, 1
    s_cbranch_scc0 SLOW3
    buffer_store_dwordx4 v[28:31], v27, s[16:19], s77 offen
BACK3:
    s_mov_b64 exec, -1
NOBASE0:
    v_and_b32 v23, 0xffff0000, v22
    v_lshlrev_b32 v22, 16, v22
    s_cmp_ge_u32 s69, 20
    s_cbranch_scc1 DMAF
    v_lshrrev_b32 v38, 2, v0
    v_mul_u32_u24 v38, 1280, v38
    v_and_b32 v39, 3, v0
    v_lshl_add_u32 v38, v39, 4, v38
    s_lshl_b32 s77, s72, 3
    s_add_u32 s77, s77, s68
    s_mul_i32 s77, s77, 245760
    s_lshl_b32 s78, s69, 6
    s_add_u32 s77, s77, s78
    s_mul_i32 s78, s72, 12288
    s_add_u32 m0, s78, 57344
    s_nop 0
    buffer_load_dwordx4 v38, s[24:27], s77 offen  lds
    s_add_u32 m0, m0, 1024
    s_add_u32 s77, s77, 20480
    buffer_load_dwordx4 v38, s[24:27], s77 offen  lds
    s_add_u32 m0, m0, 1024
    s_add_u32 s77, s77, 20480
    buffer_load_dwordx4 v38, s[24:27], s77 offen  lds
    s_add_u32 m0, m0, 1024
    s_add_u32 s77, s77, 20480
    buffer_load_dwordx4 v38, s[24:27], s77 offen  lds
    s_add_u32 m0, m0, 1024
    s_add_u32 s77, s77, 20480
    buffer_load_dwordx4 v38, s[24:27], s77 offen  lds
    s_add_u32 m0, m0, 1024
    s_add_u32 s77, s77, 20480
    buffer_load_dwordx4 v38, s[24:27], s77 offen  lds
    s_add_u32 m0, m0, 1024
    s_add_u32 s77, s77, 20480
    buffer_load_dwordx4 v38, s[24:27], s77 offen  lds
    s_add_u32 m0, m0, 1024
    s_add_u32 s77, s77, 20480
    buffer_load_dwordx4 v38, s[24:27], s77 offen  lds
    s_add_u32 m0, m0, 1024
    s_add_u32 s77, s77, 20480
    buffer_load_dwordx4 v38, s[24:27], s77 offen  lds
    s_add_u32 m0, m0, 1024
    s_add_u32 s77, s77, 20480
    buffer_load_dwordx4 v38, s[24:27], s77 offen  lds
    s_add_u32 m0, m0, 1024
    s_add_u32 s77, s77, 20480
    buffer_load_dwordx4 v38, s[24:27], s77 offen  lds
    s_add_u32 m0, m0, 1024
    s_add_u32 s77, s77, 20480
    buffer_load_dwordx4 v38, s[24:27], s77 offen  lds
DMAX:
    s_add_u32 s6, s73, 0
    buffer_load_dwordx4 a[216:219], v1, s[12:15], s6 offen offset:0 nt
    buffer_load_dwordx4 a[220:223], v1, s[12:15], s6 offen offset:1024 nt
    buffer_load_dwordx4 a[224:227], v1, s[12:15], s6 offen offset:2048 nt
    buffer_load_dwordx4 a[228:231], v1, s[12:15], s6 offen offset:3072 nt
    s_add_u32 s6, s6, 4096
    buffer_load_dwordx4 a[232:235], v1, s[12:15], s6 offen offset:0 nt
    buffer_load_dwordx4 a[236:239], v1, s[12:15], s6 offen offset:1024 nt
    s_waitcnt vmcnt(26)
    ds_write_b128 v2, a[144:147] offset:0
    ds_write_b128 v3, a[148:151] offset:0
    ds_write_b128 v4, a[152:155] offset:0
    ds_write_b128 v2, a[156:159] offset:3328
    ds_write_b128 v3, a[160:163] offset:3328
    ds_write_b128 v4, a[164:167] offset:3328
    ds_read_b128 a[144:147], v5 offset:0
    ds_read_b128 a[148:151], v5 offset:64
    ds_read_b128 a[152:155], v5 offset:128
    ds_read_b128 a[156:159], v5 offset:192
    ds_read_b128 a[160:163], v5 offset:256
    ds_read_b128 a[164:167], v5 offset:320
    s_add_u32 s77, s3, 1376256
    s_add_u32 s78, s3, 1380352
    s_add_u32 s79, s3, 4096
    buffer_load_dwordx4 v[64:67], v11, s[16:19], s77 offen sc1
    buffer_load_dwordx4 v[68:71], v11, s[16:19], s78 offen sc1
    buffer_load_dwordx4 v[72:75], v11, s[16:19], s3 offen sc1
    buffer_load_dwordx4 v[76:79], v11, s[16:19], s79 offen sc1
    s_add_u32 s6, s73, 196608
    buffer_load_dwordx4 v[112:115], v1, s[12:15], s6 offen offset:0 nt
    buffer_load_dwordx4 v[116:119], v1, s[12:15], s6 offen offset:1024 nt
    buffer_load_dwordx4 v[120:123], v1, s[12:15], s6 offen offset:2048 nt
    buffer_load_dwordx4 v[124:127], v1, s[12:15], s6 offen offset:3072 nt
    s_add_u32 s6, s6, 4096
    buffer_load_dwordx4 v[128:131], v1, s[12:15], s6 offen offset:0 nt
    buffer_load_dwordx4 v[132:135], v1, s[12:15], s6 offen offset:1024 nt
    s_waitcnt vmcnt(30)
    ds_write_b128 v2, a[168:171] offset:0
    ds_write_b128 v3, a[172:175] offset:0
    ds_write_b128 v4, a[176:179] offset:0
    ds_write_b128 v2, a[180:183] offset:3328
    ds_write_b128 v3, a[184:187] offset:3328
    ds_write_b128 v4, a[188:191] offset:3328
    ds_read_b128 a[168:171], v5 offset:0
    ds_read_b128 a[172:175], v5 offset:64
    ds_read_b128 a[176:179], v5 offset:128
    ds_read_b128 a[180:183], v5 offset:192
    ds_read_b128 a[184:187], v5 offset:256
    ds_read_b128 a[188:191], v5 offset:320
    v_and_b32 v25, 15, v0
    v_lshrrev_b32 v26, 4, v0
    v_add_u32 v27, 4, v26
    v_mul_u32_u24 v20, 1280, v26
    v_add_u32 v20, 665600, v20
    s_mul_i32 s7, s68, 81920
    s_add_u32 s7, s7, 78080
    v_mov_b32 v28, s7
    v_cmp_eq_u32 vcc, s68, v26
    s_nop 1
    v_cndmask_b32 v20, v20, v28, vcc
    v_mul_u32_u24 v21, 1280, v27
    v_add_u32 v21, 665600, v21
    s_mul_i32 s7, s68, 81920
    s_add_u32 s7, s7, 78080
    v_mov_b32 v28, s7
    v_cmp_eq_u32 vcc, s68, v27
    s_nop 1
    v_cndmask_b32 v21, v21, v28, vcc
    s_min_u32 s7, s69, 19
    s_lshl_b32 s7, s7, 6
    v_lshl_add_u32 v25, v25, 2, s7
    v_add_u32 v20, v20, v25
    v_add_u32 v21, v21, v25
    s_add_u32 s6, s73, 393216
    buffer_load_dwordx4 v[136:139], v1, s[12:15], s6 offen offset:0 nt
    buffer_load_dwordx4 v[140:143], v1, s[12:15], s6 offen offset:1024 nt
    buffer_load_dwordx4 v[144:147], v1, s[12:15], s6 offen offset:2048 nt
    buffer_load_dwordx4 v[148:151], v1, s[12:15], s6 offen offset:3072 nt
    s_add_u32 s6, s6, 4096
    buffer_load_dwordx4 v[152:155], v1, s[12:15], s6 offen offset:0 nt
    buffer_load_dwordx4 v[156:159], v1, s[12:15], s6 offen offset:1024 nt
    s_waitcnt vmcnt(16)
    ds_write_b128 v2, a[216:219] offset:0
    ds_write_b128 v3, a[220:223] offset:0
    ds_write_b128 v4, a[224:227] offset:0
    ds_write_b128 v2, a[228:231] offset:3328
    ds_write_b128 v3, a[232:235] offset:3328
    ds_write_b128 v4, a[236:239] offset:3328
    ds_read_b64_tr_b16 a[192:193], v6 offset:0
    ds_read_b64_tr_b16 a[196:197], v6 offset:32
    ds_read_b64_tr_b16 a[200:201], v6 offset:64
    ds_read_b64_tr_b16 a[204:205], v6 offset:96
    ds_read_b64_tr_b16 a[208:209], v6 offset:128
    ds_read_b64_tr_b16 a[212:213], v6 offset:160
    ds_read_b64_tr_b16 a[216:217], v6 offset:192
    ds_read_b64_tr_b16 a[220:221], v6 offset:224
    ds_read_b64_tr_b16 a[224:225], v6 offset:256
    ds_read_b64_tr_b16 a[228:229], v6 offset:288
    ds_read_b64_tr_b16 a[232:233], v6 offset:320
    ds_read_b64_tr_b16 a[236:237], v6 offset:352
    s_waitcnt vmcnt(12)
    v_max3_u32 v24, v64, v65, v66
    v_max3_u32 v24, v24, v67, v68
    v_max3_u32 v24, v24, v69, v70
    v_max3_u32 v24, v24, v71, v72
    v_max3_u32 v24, v24, v73, v74
    v_max3_u32 v24, v24, v75, v76
    v_max3_u32 v24, v24, v77, v78
    v_max_u32 v24, v24, v79
    v_cmp_eq_u32 vcc, -1, v24
    s_cbranch_vccnz RETRY4
OK4:
    v_add_f32 v64, v64, v68
    v_add_f32 v65, v65, v69
    v_add_f32 v66, v66, v70
    v_add_f32 v67, v67, v71
    s_nop 0
    v_permlane32_swap_b32 v64, v66
    v_permlane32_swap_b32 v65, v67
    v_add_f32 v64, v64, v66
    v_add_f32 v65, v65, v67
    s_nop 1
    v_permlane16_swap_b32 v64, v65
    v_add_f32 v64, v64, v65
    v_add_f32 v72, v72, v76
    v_add_f32 v73, v73, v77
    v_add_f32 v74, v74, v78
    v_add_f32 v75, v75, v79
    s_nop 0
    v_permlane32_swap_b32 v72, v74
    v_permlane32_swap_b32 v73, v75
    v_add_f32 v72, v72, v74
    v_add_f32 v73, v73, v75
    s_nop 1
    v_permlane16_swap_b32 v72, v73
    v_add_f32 v72, v72, v73
    v_mul_f32 v7, 0x3acccccd, v64
    v_mov_b32 v24, v72
    s_nop 0
    v_readlane_b32 s77, v24, 15
    s_nop 1
    v_fma_f32 v25, -s77, v7, v24
    v_cvt_pk_bf16_f32 v25, v25, v25
    ds_write_b16 v12, v25
    s_mov_b32 vcc_lo, 0x70007000
    s_mov_b32 vcc_hi, 0x70007000
    v_cndmask_b32 v26, 0, v24, vcc
    s_add_u32 s6, s73, 589824
    buffer_load_dwordx4 v[160:163], v1, s[12:15], s6 offen offset:0 nt
    buffer_load_dwordx4 v[164:167], v1, s[12:15], s6 offen offset:1024 nt
    buffer_load_dwordx4 v[168:171], v1, s[12:15], s6 offen offset:2048 nt
    buffer_load_dwordx4 v[172:175], v1, s[12:15], s6 offen offset:3072 nt
    s_add_u32 s6, s6, 4096
    buffer_load_dwordx4 v[176:179], v1, s[12:15], s6 offen offset:0 nt
    buffer_load_dwordx4 v[180:183], v1, s[12:15], s6 offen offset:1024 nt
    s_waitcnt lgkmcnt(0)
    s_barrier
    ds_read_b128 v[40:43], v13 offset:0
    ds_read_b128 v[44:47], v13 offset:64
    ds_read_b128 v[48:51], v13 offset:128
    ds_read_b128 v[52:55], v13 offset:192
    ds_read_b128 v[56:59], v13 offset:256
    ds_read_b128 v[60:63], v13 offset:320
    v_add_f32_dpp v26, v26, v26 row_ror:8 row_mask:0xf bank_mask:0xf
    s_nop 1
    v_add_f32_dpp v26, v26, v26 row_ror:4 row_mask:0xf bank_mask:0xf
    s_nop 1
    v_add_f32_dpp v26, v26, v26 row_ror:2 row_mask:0xf bank_mask:0xf
    s_nop 1
    v_add_f32_dpp v26, v26, v26 row_ror:1 row_mask:0xf bank_mask:0xf
    v_mov_b32 v27, v26
    s_nop 1
    v_permlane32_swap_b32 v26, v27
    v_add_f32 v26, v26, v27
    v_mov_b32 v27, v26
    s_nop 1
    v_permlane16_swap_b32 v26, v27
    v_add_f32 v26, v26, v27
    v_mov_b32 v27, s77
    v_subrev_f32 v27, 0x44200000, v27
    v_sub_f32 v26, v26, v27
    v_mul_f32 v27, 0x3acccccd, v27
    v_mul_f32 v26, 0x3acccccd, v26
    v_fma_f32 v26, -v27, v27, v26
    v_max_f32 v26, 0, v26
    v_add_f32 v26, 0x3727c5ac, v26
    v_rsq_f32 v26, v26
    s_nop 0
    v_mul_f32 v18, 0x3dd53b94, v26
    s_waitcnt lgkmcnt(0)
    v_mfma_f32_16x16x32_bf16 v[88:91], a[0:3], v[40:43], 0
    v_mfma_f32_16x16x32_bf16 v[88:91], a[4:7], v[44:47], v[88:91]
    v_mfma_f32_16x16x32_bf16 v[88:91], a[8:11], v[48:51], v[88:91]
    v_mfma_f32_16x16x32_bf16 v[88:91], a[12:15], v[52:55], v[88:91]
    v_mfma_f32_16x16x32_bf16 v[88:91], a[16:19], v[56:59], v[88:91]
    v_mfma_f32_16x16x32_bf16 v[88:91], a[20:23], v[60:63], v[88:91]
    v_mfma_f32_16x16x32_bf16 v[96:99], a[24:27], v[40:43], 0
    v_mfma_f32_16x16x32_bf16 v[96:99], a[28:31], v[44:47], v[96:99]
    v_mfma_f32_16x16x32_bf16 v[96:99], a[32:35], v[48:51], v[96:99]
    v_mfma_f32_16x16x32_bf16 v[96:99], a[36:39], v[52:55], v[96:99]
    v_mfma_f32_16x16x32_bf16 v[96:99], a[40:43], v[56:59], v[96:99]
    v_mfma_f32_16x16x32_bf16 v[96:99], a[44:47], v[60:63], v[96:99]
    v_mfma_f32_16x16x32_bf16 v[100:103], a[48:51], v[40:43], 0
    v_mfma_f32_16x16x32_bf16 v[100:103], a[52:55], v[44:47], v[100:103]
    v_mfma_f32_16x16x32_bf16 v[100:103], a[56:59], v[48:51], v[100:103]
    v_mfma_f32_16x16x32_bf16 v[100:103], a[60:63], v[52:55], v[100:103]
    v_mfma_f32_16x16x32_bf16 v[100:103], a[64:67], v[56:59], v[100:103]
    v_mfma_f32_16x16x32_bf16 v[100:103], a[68:71], v[60:63], v[100:103]
    v_mfma_f32_16x16x32_bf16 v[104:107], a[72:75], v[40:43], 0
    v_mfma_f32_16x16x32_bf16 v[104:107], a[76:79], v[44:47], v[104:107]
    v_mfma_f32_16x16x32_bf16 v[104:107], a[80:83], v[48:51], v[104:107]
    v_cndmask_b32 v88, v88, v96, s[82:83]
    v_mfma_f32_16x16x32_bf16 v[104:107], a[84:87], v[52:55], v[104:107]
    v_cndmask_b32 v89, v89, v97, s[82:83]
    v_mfma_f32_16x16x32_bf16 v[104:107], a[88:91], v[56:59], v[104:107]
    v_cndmask_b32 v90, v90, v98, s[82:83]
    v_mfma_f32_16x16x32_bf16 v[104:107], a[92:95], v[60:63], v[104:107]
    v_cndmask_b32 v91, v91, v99, s[82:83]
    v_mfma_f32_16x16x32_bf16 v[92:95], a[96:99], v[40:43], 0
    v_mfma_f32_16x16x32_bf16 v[92:95], a[100:103], v[44:47], v[92:95]
    v_mfma_f32_16x16x32_bf16 v[92:95], a[104:107], v[48:51], v[92:95]
    v_cndmask_b32 v88, v88, v100, s[84:85]
    v_mfma_f32_16x16x32_bf16 v[92:95], a[108:111], v[52:55], v[92:95]
    v_cndmask_b32 v89, v89, v101, s[84:85]
    v_mfma_f32_16x16x32_bf16 v[92:95], a[112:115], v[56:59], v[92:95]
    v_cndmask_b32 v90, v90, v102, s[84:85]
    v_mfma_f32_16x16x32_bf16 v[92:95], a[116:119], v[60:63], v[92:95]
    v_cndmask_b32 v91, v91, v103, s[84:85]
    v_mfma_f32_16x16x32_bf16 v[96:99], a[120:123], v[40:43], 0
    v_mfma_f32_16x16x32_bf16 v[96:99], a[124:127], v[44:47], v[96:99]
    v_mfma_f32_16x16x32_bf16 v[96:99], a[128:131], v[48:51], v[96:99]
    v_cndmask_b32 v88, v88, v104, s[86:87]
    v_mfma_f32_16x16x32_bf16 v[96:99], a[132:135], v[52:55], v[96:99]
    v_cndmask_b32 v89, v89, v105, s[86:87]
    v_mfma_f32_16x16x32_bf16 v[96:99], a[136:139], v[56:59], v[96:99]
    v_cndmask_b32 v90, v90, v106, s[86:87]
    v_mfma_f32_16x16x32_bf16 v[96:99], a[140:143], v[60:63], v[96:99]
    v_cndmask_b32 v91, v91, v107, s[86:87]
    v_mfma_f32_16x16x32_bf16 v[100:103], a[144:147], v[40:43], 0
    v_mfma_f32_16x16x32_bf16 v[100:103], a[148:151], v[44:47], v[100:103]
    v_mfma_f32_16x16x32_bf16 v[100:103], a[152:155], v[48:51], v[100:103]
    v_cndmask_b32 v88, v88, v92, s[88:89]
    v_mfma_f32_16x16x32_bf16 v[100:103], a[156:159], v[52:55], v[100:103]
    v_cndmask_b32 v89, v89, v93, s[88:89]
    v_mfma_f32_16x16x32_bf16 v[100:103], a[160:163], v[56:59], v[100:103]
    v_cndmask_b32 v90, v90, v94, s[88:89]
    v_mfma_f32_16x16x32_bf16 v[100:103], a[164:167], v[60:63], v[100:103]
    v_cndmask_b32 v91, v91, v95, s[88:89]
    v_mfma_f32_16x16x32_bf16 v[104:107], a[168:171], v[40:43], 0
    v_mfma_f32_16x16x32_bf16 v[104:107], a[172:175], v[44:47], v[104:107]
    v_mfma_f32_16x16x32_bf16 v[104:107], a[176:179], v[48:51], v[104:107]
    v_cndmask_b32 v88, v88, v96, s[90:91]
    v_mfma_f32_16x16x32_bf16 v[104:107], a[180:183], v[52:55], v[104:107]
    v_cndmask_b32 v89, v89, v97, s[90:91]
    v_mfma_f32_16x16x32_bf16 v[104:107], a[184:187], v[56:59], v[104:107]
    v_cndmask_b32 v90, v90, v98, s[90:91]
    v_mfma_f32_16x16x32_bf16 v[104:107], a[188:191], v[60:63], v[104:107]
    v_cndmask_b32 v91, v91, v99, s[90:91]
    v_cndmask_b32 v88, v88, v100, s[92:93]
    v_cndmask_b32 v89, v89, v101, s[92:93]
    v_cndmask_b32 v90, v90, v102, s[92:93]
    v_cndmask_b32 v91, v91, v103, s[92:93]
    s_nop 2
    v_cndmask_b32 v88, v88, v104, s[94:95]
    v_cndmask_b32 v89, v89, v105, s[94:95]
    v_cndmask_b32 v90, v90, v106, s[94:95]
    v_cndmask_b32 v91, v91, v107, s[94:95]
    v_max3_f32 v19, v88, v89, v90
    v_max_f32 v19, v19, v91
    s_nop 1
    v_max_f32_dpp v19, v19, v19 row_ror:4 row_mask:0xf bank_mask:0xf
    s_nop 1
    v_max_f32_dpp v19, v19, v19 row_ror:2 row_mask:0xf bank_mask:0xf
    s_nop 1
    v_max_f32_dpp v19, v19, v19 row_ror:1 row_mask:0xf bank_mask:0xf
    v_mov_b32 v92, v19
    s_nop 1
    v_permlane32_swap_b32 v19, v92
    v_max_f32 v19, v19, v92
    v_mov_b32 v92, v19
    s_nop 1
    v_permlane16_swap_b32 v19, v92
    v_max_f32 v19, v19, v92
    v_mul_f32 v19, v19, v18
    v_fma_f32 v88, v88, v18, -v19
    v_fma_f32 v89, v89, v18, -v19
    v_fma_f32 v90, v90, v18, -v19
    v_fma_f32 v91, v91, v18, -v19
    v_exp_f32 v88, v88
    v_exp_f32 v89, v89
    v_exp_f32 v90, v90
    v_exp_f32 v91, v91
    v_cvt_pk_bf16_f32 v32, v88, v89
    v_cvt_pk_bf16_f32 v33, v90, v91
    v_add_f32 v37, v88, v89
    v_add_f32 v38, v90, v91
    v_add_f32 v37, v37, v38
    v_mov_b32 v36, v19
    s_lshl_b32 s77, s71, 5
    v_add_f32_dpp v37, v37, v37 row_ror:4 row_mask:0xf bank_mask:0xf
    s_lshl_b32 s78, s72, 3
    s_nop 0
    v_add_f32_dpp v37, v37, v37 row_ror:2 row_mask:0xf bank_mask:0xf
    s_add_u32 s77, s77, s78
    s_nop 0
    v_add_f32_dpp v37, v37, v37 row_ror:1 row_mask:0xf bank_mask:0xf
    v_mov_b32 v38, v37
    s_add_u32 s77, s77, s3
    s_nop 0
    v_permlane32_swap_b32 v37, v38
    v_add_f32 v37, v37, v38
    v_mov_b32 v38, v37
    s_nop 0
    s_nop 0
    v_permlane16_swap_b32 v37, v38
    v_add_f32 v37, v37, v38
    s_mov_b64 exec, 1
    s_cmp_eq_u32 s75, 1
    s_cbranch_scc0 SLOW5
    buffer_store_dwordx2 v[36:37], v14, s[16:19], s77 offen
BACK5:
    s_mov_b64 exec, -1
    s_add_u32 s6, s73, 786432
    buffer_load_dwordx4 v[184:187], v1, s[12:15], s6 offen offset:0 nt
    buffer_load_dwordx4 v[188:191], v1, s[12:15], s6 offen offset:1024 nt
    buffer_load_dwordx4 v[192:195], v1, s[12:15], s6 offen offset:2048 nt
    buffer_load_dwordx4 v[196:199], v1, s[12:15], s6 offen offset:3072 nt
    s_add_u32 s6, s6, 4096
    buffer_load_dwordx4 v[200:203], v1, s[12:15], s6 offen offset:0 nt
    buffer_load_dwordx4 v[204:207], v1, s[12:15], s6 offen offset:1024 nt
    s_waitcnt vmcnt(19)
    ds_write_b128 v2, v[112:115] offset:0
    ds_write_b128 v3, v[116:119] offset:0
    ds_write_b128 v4, v[120:123] offset:0
    ds_write_b128 v2, v[124:127] offset:3328
    ds_write_b128 v3, v[128:131] offset:3328
    ds_write_b128 v4, v[132:135] offset:3328
    ds_read_b64_tr_b16 a[194:195], v6 offset:0
    ds_read_b64_tr_b16 a[198:199], v6 offset:32
    ds_read_b64_tr_b16 a[202:203], v6 offset:64
    ds_read_b64_tr_b16 a[206:207], v6 offset:96
    ds_read_b64_tr_b16 a[210:211], v6 offset:128
    ds_read_b64_tr_b16 a[214:215], v6 offset:160
    ds_read_b64_tr_b16 a[218:219], v6 offset:192
    ds_read_b64_tr_b16 a[222:223], v6 offset:224
    ds_read_b64_tr_b16 a[226:227], v6 offset:256
    ds_read_b64_tr_b16 a[230:231], v6 offset:288
    ds_read_b64_tr_b16 a[234:235], v6 offset:320
    ds_read_b64_tr_b16 a[238:239], v6 offset:352
    v_mov_b32_dpp v24, v32 row_newbcast:0 row_mask:0xf bank_mask:0xf
    v_mov_b32_dpp v25, v33 row_newbcast:0 row_mask:0xf bank_mask:0xf
    v_mov_b32_dpp v26, v32 row_newbcast:1 row_mask:0xf bank_mask:0xf
    v_mov_b32_dpp v27, v33 row_newbcast:1 row_mask:0xf bank_mask:0xf
    s_waitcnt lgkmcnt(0)
    s_nop 0
    v_mfma_f32_16x16x32_bf16 v[40:43], v[24:27], a[192:195], 0
    v_mfma_f32_16x16x32_bf16 v[44:47], v[24:27], a[196:199], 0
    v_mfma_f32_16x16x32_bf16 v[48:51], v[24:27], a[200:203], 0
    v_mfma_f32_16x16x32_bf16 v[52:55], v[24:27], a[204:207], 0
    v_mfma_f32_16x16x32_bf16 v[56:59], v[24:27], a[208:211], 0
    v_mfma_f32_16x16x32_bf16 v[60:63], v[24:27], a[212:215], 0
    v_mfma_f32_16x16x32_bf16 v[64:67], v[24:27], a[216:219], 0
    v_mfma_f32_16x16x32_bf16 v[68:71], v[24:27], a[220:223], 0
    v_mfma_f32_16x16x32_bf16 v[72:75], v[24:27], a[224:227], 0
    v_mfma_f32_16x16x32_bf16 v[76:79], v[24:27], a[228:231], 0
    v_mfma_f32_16x16x32_bf16 v[80:83], v[24:27], a[232:235], 0
    v_mfma_f32_16x16x32_bf16 v[84:87], v[24:27], a[236:239], 0
    s_add_u32 s6, s73, 983040
    buffer_load_dwordx4 v[208:211], v1, s[12:15], s6 offen offset:0 nt
    buffer_load_dwordx4 v[212:215], v1, s[12:15], s6 offen offset:1024 nt
    buffer_load_dwordx4 v[216:219], v1, s[12:15], s6 offen offset:2048 nt
    buffer_load_dwordx4 v[220:223], v1, s[12:15], s6 offen offset:3072 nt
    s_add_u32 s6, s6, 4096
    buffer_load_dwordx4 v[224:227], v1, s[12:15], s6 offen offset:0 nt
    buffer_load_dwordx4 v[228:231], v1, s[12:15], s6 offen offset:1024 nt
    s_waitcnt vmcnt(19)
    ds_write_b128 v2, v[136:139] offset:0
    ds_write_b128 v3, v[140:143] offset:0
    ds_write_b128 v4, v[144:147] offset:0
    ds_write_b128 v2, v[148:151] offset:3328
    ds_write_b128 v3, v[152:155] offset:3328
    ds_write_b128 v4, v[156:159] offset:3328
    ds_read_b64_tr_b16 v[112:113], v6 offset:0
    ds_read_b64_tr_b16 v[116:117], v6 offset:32
    ds_read_b64_tr_b16 v[120:121], v6 offset:64
    ds_read_b64_tr_b16 v[124:125], v6 offset:96
    ds_read_b64_tr_b16 v[128:129], v6 offset:128
    ds_read_b64_tr_b16 v[132:133], v6 offset:160
    ds_read_b64_tr_b16 v[136:137], v6 offset:192
    ds_read_b64_tr_b16 v[140:141], v6 offset:224
    ds_read_b64_tr_b16 v[144:145], v6 offset:256
    ds_read_b64_tr_b16 v[148:149], v6 offset:288
    ds_read_b64_tr_b16 v[152:153], v6 offset:320
    ds_read_b64_tr_b16 v[156:157], v6 offset:352
    s_waitcnt vmcnt(13)
    ds_write_b128 v2, v[160:163] offset:0
    ds_write_b128 v3, v[164:167] offset:0
    ds_write_b128 v4, v[168:171] offset:0
    ds_write_b128 v2, v[172:175] offset:3328
    ds_write_b128 v3, v[176:179] offset:3328
    ds_write_b128 v4, v[180:183] offset:3328
    ds_read_b64_tr_b16 v[114:115], v6 offset:0
    ds_read_b64_tr_b16 v[118:119], v6 offset:32
    ds_read_b64_tr_b16 v[122:123], v6 offset:64
    ds_read_b64_tr_b16 v[126:127], v6 offset:96
    ds_read_b64_tr_b16 v[130:131], v6 offset:128
    ds_read_b64_tr_b16 v[134:135], v6 offset:160
    ds_read_b64_tr_b16 v[138:139], v6 offset:192
    ds_read_b64_tr_b16 v[142:143], v6 offset:224
    ds_read_b64_tr_b16 v[146:147], v6 offset:256
    ds_read_b64_tr_b16 v[150:151], v6 offset:288
    ds_read_b64_tr_b16 v[154:155], v6 offset:320
    ds_read_b64_tr_b16 v[158:159], v6 offset:352
    s_add_u32 s6, s73, 1179648
    buffer_load_dwordx4 v[232:235], v1, s[12:15], s6 offen offset:0 nt
    buffer_load_dwordx4 v[236:239], v1, s[12:15], s6 offen offset:1024 nt
    buffer_load_dwordx4 v[240:243], v1, s[12:15], s6 offen offset:2048 nt
    buffer_load_dwordx4 v[244:247], v1, s[12:15], s6 offen offset:3072 nt
    s_add_u32 s6, s6, 4096
    buffer_load_dwordx4 v[248:251], v1, s[12:15], s6 offen offset:0 nt
    buffer_load_dwordx4 v[252:255], v1, s[12:15], s6 offen offset:1024 nt
    v_mov_b32_dpp v28, v32 row_newbcast:2 row_mask:0xf bank_mask:0xf
    v_mov_b32_dpp v29, v33 row_newbcast:2 row_mask:0xf bank_mask:0xf
    v_mov_b32_dpp v30, v32 row_newbcast:3 row_mask:0xf bank_mask:0xf
    v_mov_b32_dpp v31, v33 row_newbcast:3 row_mask:0xf bank_mask:0xf
    s_waitcnt lgkmcnt(0)
    s_nop 0
    v_mfma_f32_16x16x32_bf16 v[40:43], v[28:31], v[112:115], v[40:43]
    v_mfma_f32_16x16x32_bf16 v[44:47], v[28:31], v[116:119], v[44:47]
    v_mfma_f32_16x16x32_bf16 v[48:51], v[28:31], v[120:123], v[48:51]
    v_mfma_f32_16x16x32_bf16 v[52:55], v[28:31], v[124:127], v[52:55]
    v_mfma_f32_16x16x32_bf16 v[56:59], v[28:31], v[128:131], v[56:59]
    v_mfma_f32_16x16x32_bf16 v[60:63], v[28:31], v[132:135], v[60:63]
    v_mfma_f32_16x16x32_bf16 v[64:67], v[28:31], v[136:139], v[64:67]
    v_mfma_f32_16x16x32_bf16 v[68:71], v[28:31], v[140:143], v[68:71]
    v_mfma_f32_16x16x32_bf16 v[72:75], v[28:31], v[144:147], v[72:75]
    v_mfma_f32_16x16x32_bf16 v[76:79], v[28:31], v[148:151], v[76:79]
    v_mfma_f32_16x16x32_bf16 v[80:83], v[28:31], v[152:155], v[80:83]
    v_mfma_f32_16x16x32_bf16 v[84:87], v[28:31], v[156:159], v[84:87]
    s_waitcnt vmcnt(12)
    ds_write_b128 v2, v[184:187] offset:0
    ds_write_b128 v3, v[188:191] offset:0
    ds_write_b128 v4, v[192:195] offset:0
    ds_write_b128 v2, v[196:199] offset:3328
    ds_write_b128 v3, v[200:203] offset:3328
    ds_write_b128 v4, v[204:207] offset:3328
    ds_read_b64_tr_b16 v[160:161], v6 offset:0
    ds_read_b64_tr_b16 v[164:165], v6 offset:32
    ds_read_b64_tr_b16 v[168:169], v6 offset:64
    ds_read_b64_tr_b16 v[172:173], v6 offset:96
    ds_read_b64_tr_b16 v[176:177], v6 offset:128
    ds_read_b64_tr_b16 v[180:181], v6 offset:160
    ds_read_b64_tr_b16 v[184:185], v6 offset:192
    ds_read_b64_tr_b16 v[188:189], v6 offset:224
    ds_read_b64_tr_b16 v[192:193], v6 offset:256
    ds_read_b64_tr_b16 v[196:197], v6 offset:288
    ds_read_b64_tr_b16 v[200:201], v6 offset:320
    ds_read_b64_tr_b16 v[204:205], v6 offset:352
    buffer_load_dwordx2 v[34:35], v14, s[16:19], s3 offen sc1
    s_add_u32 s6, s73, 1376256
    buffer_load_dwordx4 v[88:91], v1, s[12:15], s6 offen offset:0 nt
    buffer_load_dwordx4 v[92:95], v1, s[12:15], s6 offen offset:1024 nt
    buffer_load_dwordx4 v[96:99], v1, s[12:15], s6 offen offset:2048 nt
    buffer_load_dwordx4 v[100:103], v1, s[12:15], s6 offen offset:3072 nt
    s_add_u32 s6, s6, 4096
    buffer_load_dwordx4 v[104:107], v1, s[12:15], s6 offen offset:0 nt
    buffer_load_dwordx4 v[108:111], v1, s[12:15], s6 offen offset:1024 nt
    s_waitcnt vmcnt(13)
    ds_write_b128 v2, v[208:211] offset:0
    ds_write_b128 v3, v[212:215] offset:0
    ds_write_b128 v4, v[216:219] offset:0
    ds_write_b128 v2, v[220:223] offset:3328
    ds_write_b128 v3, v[224:227] offset:3328
    ds_write_b128 v4, v[228:231] offset:3328
    ds_read_b64_tr_b16 v[162:163], v6 offset:0
    ds_read_b64_tr_b16 v[166:167], v6 offset:32
    ds_read_b64_tr_b16 v[170:171], v6 offset:64
    ds_read_b64_tr_b16 v[174:175], v6 offset:96
    ds_read_b64_tr_b16 v[178:179], v6 offset:128
    ds_read_b64_tr_b16 v[182:183], v6 offset:160
    ds_read_b64_tr_b16 v[186:187], v6 offset:192
    ds_read_b64_tr_b16 v[190:191], v6 offset:224
    ds_read_b64_tr_b16 v[194:195], v6 offset:256
    ds_read_b64_tr_b16 v[198:199], v6 offset:288
    ds_read_b64_tr_b16 v[202:203], v6 offset:320
    ds_read_b64_tr_b16 v[206:207], v6 offset:352
    v_mov_b32_dpp v24, v32 row_newbcast:4 row_mask:0xf bank_mask:0xf
    v_mov_b32_dpp v25, v33 row_newbcast:4 row_mask:0xf bank_mask:0xf
    v_mov_b32_dpp v26, v32 row_newbcast:5 row_mask:0xf bank_mask:0xf
    v_mov_b32_dpp v27, v33 row_newbcast:5 row_mask:0xf bank_mask:0xf
    s_waitcnt lgkmcnt(0)
    s_nop 0
    v_mfma_f32_16x16x32_bf16 v[40:43], v[24:27], v[160:163], v[40:43]
    v_mfma_f32_16x16x32_bf16 v[44:47], v[24:27], v[164:167], v[44:47]
    v_mfma_f32_16x16x32_bf16 v[48:51], v[24:27], v[168:171], v[48:51]
    v_mfma_f32_16x16x32_bf16 v[52:55], v[24:27], v[172:175], v[52:55]
    v_mfma_f32_16x16x32_bf16 v[56:59], v[24:27], v[176:179], v[56:59]
    v_mfma_f32_16x16x32_bf16 v[60:63], v[24:27], v[180:183], v[60:63]
    v_mfma_f32_16x16x32_bf16 v[64:67], v[24:27], v[184:187], v[64:67]
    v_mfma_f32_16x16x32_bf16 v[68:71], v[24:27], v[188:191], v[68:71]
    v_mfma_f32_16x16x32_bf16 v[72:75], v[24:27], v[192:195], v[72:75]
    v_mfma_f32_16x16x32_bf16 v[76:79], v[24:27], v[196:199], v[76:79]
    v_mfma_f32_16x16x32_bf16 v[80:83], v[24:27], v[200:203], v[80:83]
    v_mfma_f32_16x16x32_bf16 v[84:87], v[24:27], v[204:207], v[84:87]
    s_waitcnt vmcnt(7)
    ds_write_b128 v2, v[232:235] offset:0
    ds_write_b128 v3, v[236:239] offset:0
    ds_write_b128 v4, v[240:243] offset:0
    ds_write_b128 v2, v[244:247] offset:3328
    ds_write_b128 v3, v[248:251] offset:3328
    ds_write_b128 v4, v[252:255] offset:3328
    ds_read_b64_tr_b16 v[208:209], v6 offset:0
    ds_read_b64_tr_b16 v[212:213], v6 offset:32
    ds_read_b64_tr_b16 v[216:217], v6 offset:64
    ds_read_b64_tr_b16 v[220:221], v6 offset:96
    ds_read_b64_tr_b16 v[224:225], v6 offset:128
    ds_read_b64_tr_b16 v[228:229], v6 offset:160
    ds_read_b64_tr_b16 v[232:233], v6 offset:192
    ds_read_b64_tr_b16 v[236:237], v6 offset:224
    ds_read_b64_tr_b16 v[240:241], v6 offset:256
    ds_read_b64_tr_b16 v[244:245], v6 offset:288
    ds_read_b64_tr_b16 v[248:249], v6 offset:320
    ds_read_b64_tr_b16 v[252:253], v6 offset:352
    v_mov_b32_dpp v28, v32 row_newbcast:6 row_mask:0xf bank_mask:0xf
    v_mov_b32_dpp v29, v33 row_newbcast:6 row_mask:0xf bank_mask:0xf
    v_mov_b32_dpp v30, v32 row_newbcast:7 row_mask:0xf bank_mask:0xf
    v_mov_b32_dpp v31, v33 row_newbcast:7 row_mask:0xf bank_mask:0xf
    s_waitcnt vmcnt(0)
    ds_write_b128 v2, v[88:91] offset:0
    ds_write_b128 v3, v[92:95] offset:0
    ds_write_b128 v4, v[96:99] offset:0
    ds_write_b128 v2, v[100:103] offset:3328
    ds_write_b128 v3, v[104:107] offset:3328
    ds_write_b128 v4, v[108:111] offset:3328
    ds_read_b64_tr_b16 v[210:211], v6 offset:0
    ds_read_b64_tr_b16 v[214:215], v6 offset:32
    ds_read_b64_tr_b16 v[218:219], v6 offset:64
    ds_read_b64_tr_b16 v[222:223], v6 offset:96
    ds_read_b64_tr_b16 v[226:227], v6 offset:128
    ds_read_b64_tr_b16 v[230:231], v6 offset:160
    ds_read_b64_tr_b16 v[234:235], v6 offset:192
    ds_read_b64_tr_b16 v[238:239], v6 offset:224
    ds_read_b64_tr_b16 v[242:243], v6 offset:256
    ds_read_b64_tr_b16 v[246:247], v6 offset:288
    ds_read_b64_tr_b16 v[250:251], v6 offset:320
    ds_read_b64_tr_b16 v[254:255], v6 offset:352
    s_waitcnt lgkmcnt(0)
    s_branch ATT_LAST
LOOP:
    ds_read_b64_tr_b16 v[40:41], v16 offset:0
    ds_read_b64_tr_b16 v[42:43], v16 offset:1536
    ds_read_b64_tr_b16 v[44:45], v16 offset:12288
    ds_read_b64_tr_b16 v[46:47], v16 offset:13824
    ds_read_b64_tr_b16 v[48:49], v17 offset:24576
    ds_read_b64_tr_b16 v[50:51], v16 offset:32
    ds_read_b64_tr_b16 v[52:53], v16 offset:1568
    ds_read_b64_tr_b16 v[54:55], v16 offset:12320
    ds_read_b64_tr_b16 v[56:57], v16 offset:13856
    ds_read_b64_tr_b16 v[58:59], v17 offset:24608
    ds_read_b64_tr_b16 v[60:61], v16 offset:64
    ds_read_b64_tr_b16 v[62:63], v16 offset:1600
    ds_read_b64_tr_b16 v[64:65], v16 offset:12352
    ds_read_b64_tr_b16 v[66:67], v16 offset:13888
    ds_read_b64_tr_b16 v[68:69], v17 offset:24640
    v_and_b32 v25, 15, v0
    v_cmp_eq_u32 vcc, 12, v25
    v_mov_b32 v36, 0x3f803f80
    s_nop 0
    v_cndmask_b32 v70, 0, v36, vcc
    v_mov_b32 v71, v70
    v_mov_b32 v72, v70
    v_mov_b32 v73, v70
    v_mov_b32 v74, v70
    v_mov_b32 v75, v70
    v_mov_b32 v76, v70
    v_mov_b32 v77, v70
    v_mov_b32 v78, v70
    v_mov_b32 v79, v70
    s_add_u32 s79, s3, 4096
    s_mul_i32 s77, s72, 6656
    v_mul_u32_u24 v26, 103, v0
    v_lshrrev_b32 v26, 10, v26
    v_lshl_add_u32 v26, v26, 4, v1
    v_add_u32 v26, s77, v26
    v_mul_u32_u24 v27, 176, v25
    v_add_u32 v27, s77, v27
    v_lshrrev_b32 v28, 4, v0
    v_lshl_add_u32 v29, v28, 3, v27
    v_lshl_add_u32 v27, v28, 4, v27
    s_waitcnt lgkmcnt(0)
    s_mov_b32 exec_lo, 0xffffffff
    s_mov_b32 exec_hi, 0xfffffff
    s_mov_b32 s76, 0
POLL6:
    buffer_load_dwordx4 v[80:83], v8, s[16:19], 0 offen sc1
    buffer_load_dwordx4 v[84:87], v9, s[16:19], 0 offen sc1
    s_add_u32 s76, s76, 1
    s_cmp_ge_u32 s76, 32768
    s_waitcnt vmcnt(0)
    v_max_u32 v24, v80, v84
    v_cmp_eq_u32 vcc, -1, v24
    s_cbranch_scc1 POLLX6
    s_cbranch_vccnz POLL6
POLLX6:
    ds_write_b128 v26, v[80:83]
    ds_write_b128 v26, v[84:87] offset:1056
    s_mov_b32 exec_lo, 0x1ff01ff
    s_mov_b32 exec_hi, 0x1ff01ff
    ds_read_b128 v[70:73], v27
    ds_read_b128 v[74:77], v27 offset:64
    ds_read_b64 v[78:79], v29 offset:128
    s_mov_b64 exec, -1
    buffer_load_dword a244, v20, s[16:19], 0 offen sc1
    buffer_load_dword a245, v21, s[16:19], 0 offen sc1
    s_waitcnt lgkmcnt(0)
    v_mfma_f32_16x16x32_bf16 v[24:27], v[70:73], v[40:43], 0
    v_mfma_f32_16x16x32_bf16 v[28:31], v[70:73], v[50:53], 0
    v_mfma_f32_16x16x32_bf16 v[32:35], v[70:73], v[60:63], 0
    v_mfma_f32_16x16x32_bf16 v[36:39], v[70:73], v[70:73], 0
    v_mfma_f32_16x16x32_bf16 v[24:27], v[74:77], v[44:47], v[24:27]
    v_mfma_f32_16x16x32_bf16 v[28:31], v[74:77], v[54:57], v[28:31]
    v_mfma_f32_16x16x32_bf16 v[32:35], v[74:77], v[64:67], v[32:35]
    v_mfma_f32_16x16x32_bf16 v[36:39], v[74:77], v[74:77], v[36:39]
    v_mfma_f32_16x16x16_bf16 v[24:27], v[78:79], v[48:49], v[24:27]
    v_mfma_f32_16x16x16_bf16 v[28:31], v[78:79], v[58:59], v[28:31]
    v_mfma_f32_16x16x16_bf16 v[32:35], v[78:79], v[68:69], v[32:35]
    v_mfma_f32_16x16x16_bf16 v[36:39], v[78:79], v[78:79], v[36:39]
    s_nop 4
    v_add_f32 v24, v24, v25
    v_add_f32 v26, v26, v27
    v_add_f32 v28, v28, v29
    v_add_f32 v30, v30, v31
    v_add_f32 v32, v32, v33
    v_add_f32 v34, v34, v35
    v_add_f32 v36, v36, v37
    v_add_f32 v38, v38, v39
    v_add_f32 v24, v24, v26
    v_add_f32 v28, v28, v30
    v_add_f32 v32, v32, v34
    v_add_f32 v36, v36, v38
    s_nop 0
    v_permlane32_swap_b32 v24, v32
    v_permlane32_swap_b32 v28, v36
    v_add_f32 v24, v24, v32
    v_add_f32 v28, v28, v36
    s_nop 1
    v_permlane16_swap_b32 v24, v28
    v_add_f32 v24, v24, v28
    s_cmp_eq_u32 s75, 1
    s_cbranch_scc0 SLOW7
    buffer_store_dword v24, v10, s[16:19], s3 offen
BACK7:
    s_mov_b32 s76, 0
POLL8:
    buffer_load_dwordx4 v[24:27], v11, s[16:19], s3 offen sc1
    buffer_load_dwordx4 v[28:31], v11, s[16:19], s79 offen sc1
    s_add_u32 s76, s76, 1
    s_cmp_ge_u32 s76, 32768
    s_waitcnt vmcnt(0)
    v_max3_u32 v32, v24, v25, v26
    v_max3_u32 v32, v32, v27, v28
    v_max3_u32 v32, v32, v29, v30
    v_max_u32 v32, v32, v31
    v_cmp_eq_u32 vcc, -1, v32
    s_cbranch_scc1 POLLX8
    s_cbranch_vccnz POLL8
POLLX8:
    v_add_f32 v24, v24, v28
    v_add_f32 v25, v25, v29
    v_add_f32 v26, v26, v30
    v_add_f32 v27, v27, v31
    s_nop 0
    v_permlane32_swap_b32 v24, v26
    v_permlane32_swap_b32 v25, v27
    v_add_f32 v24, v24, v26
    v_add_f32 v25, v25, v27
    s_nop 1
    v_permlane16_swap_b32 v24, v25
    v_add_f32 v24, v24, v25
    s_nop 0
    v_readlane_b32 s77, v24, 15
    s_nop 1
    v_fma_f32 v25, -s77, v7, v24
    v_cvt_pk_bf16_f32 v25, v25, v25
    ds_write_b16 v12, v25
    s_mov_b32 vcc_lo, 0x70007000
    s_mov_b32 vcc_hi, 0x70007000
    v_cndmask_b32 v26, 0, v24, vcc
    s_waitcnt lgkmcnt(0)
    s_barrier
    ds_read_b128 v[40:43], v13 offset:0
    ds_read_b128 v[44:47], v13 offset:64
    ds_read_b128 v[48:51], v13 offset:128
    ds_read_b128 v[52:55], v13 offset:192
    ds_read_b128 v[56:59], v13 offset:256
    ds_read_b128 v[60:63], v13 offset:320
    v_add_f32_dpp v26, v26, v26 row_ror:8 row_mask:0xf bank_mask:0xf
    s_nop 1
    v_add_f32_dpp v26, v26, v26 row_ror:4 row_mask:0xf bank_mask:0xf
    s_nop 1
    v_add_f32_dpp v26, v26, v26 row_ror:2 row_mask:0xf bank_mask:0xf
    s_nop 1
    v_add_f32_dpp v26, v26, v26 row_ror:1 row_mask:0xf bank_mask:0xf
    v_mov_b32 v27, v26
    s_nop 1
    v_permlane32_swap_b32 v26, v27
    v_add_f32 v26, v26, v27
    v_mov_b32 v27, v26
    s_nop 1
    v_permlane16_swap_b32 v26, v27
    v_add_f32 v26, v26, v27
    v_mov_b32 v27, s77
    v_subrev_f32 v27, 0x44200000, v27
    v_sub_f32 v26, v26, v27
    v_mul_f32 v27, 0x3acccccd, v27
    v_mul_f32 v26, 0x3acccccd, v26
    v_fma_f32 v26, -v27, v27, v26
    v_max_f32 v26, 0, v26
    v_add_f32 v26, 0x3727c5ac, v26
    v_rsq_f32 v26, v26
    s_nop 0
    v_mul_f32 v18, 0x3dd53b94, v26
    s_waitcnt lgkmcnt(0)
    v_mfma_f32_16x16x32_bf16 v[88:91], a[0:3], v[40:43], 0
    v_mfma_f32_16x16x32_bf16 v[88:91], a[4:7], v[44:47], v[88:91]
    v_mfma_f32_16x16x32_bf16 v[88:91], a[8:11], v[48:51], v[88:91]
    v_mfma_f32_16x16x32_bf16 v[88:91], a[12:15], v[52:55], v[88:91]
    v_mfma_f32_16x16x32_bf16 v[88:91], a[16:19], v[56:59], v[88:91]
    v_mfma_f32_16x16x32_bf16 v[88:91], a[20:23], v[60:63], v[88:91]
    v_mfma_f32_16x16x32_bf16 v[96:99], a[24:27], v[40:43], 0
    v_mfma_f32_16x16x32_bf16 v[96:99], a[28:31], v[44:47], v[96:99]
    v_mfma_f32_16x16x32_bf16 v[96:99], a[32:35], v[48:51], v[96:99]
    v_mfma_f32_16x16x32_bf16 v[96:99], a[36:39], v[52:55], v[96:99]
    v_mfma_f32_16x16x32_bf16 v[96:99], a[40:43], v[56:59], v[96:99]
    v_mfma_f32_16x16x32_bf16 v[96:99], a[44:47], v[60:63], v[96:99]
    v_mfma_f32_16x16x32_bf16 v[100:103], a[48:51], v[40:43], 0
    v_mfma_f32_16x16x32_bf16 v[100:103], a[52:55], v[44:47], v[100:103]
    v_mfma_f32_16x16x32_bf16 v[100:103], a[56:59], v[48:51], v[100:103]
    v_mfma_f32_16x16x32_bf16 v[100:103], a[60:63], v[52:55], v[100:103]
    v_mfma_f32_16x16x32_bf16 v[100:103], a[64:67], v[56:59], v[100:103]
    v_mfma_f32_16x16x32_bf16 v[100:103], a[68:71], v[60:63], v[100:103]
    v_mfma_f32_16x16x32_bf16 v[104:107], a[72:75], v[40:43], 0
    v_mfma_f32_16x16x32_bf16 v[104:107], a[76:79], v[44:47], v[104:107]
    v_mfma_f32_16x16x32_bf16 v[104:107], a[80:83], v[48:51], v[104:107]
    v_cndmask_b32 v88, v88, v96, s[82:83]
    v_mfma_f32_16x16x32_bf16 v[104:107], a[84:87], v[52:55], v[104:107]
    v_cndmask_b32 v89, v89, v97, s[82:83]
    v_mfma_f32_16x16x32_bf16 v[104:107], a[88:91], v[56:59], v[104:107]
    v_cndmask_b32 v90, v90, v98, s[82:83]
    v_mfma_f32_16x16x32_bf16 v[104:107], a[92:95], v[60:63], v[104:107]
    v_cndmask_b32 v91, v91, v99, s[82:83]
    v_mfma_f32_16x16x32_bf16 v[92:95], a[96:99], v[40:43], 0
    v_mfma_f32_16x16x32_bf16 v[92:95], a[100:103], v[44:47], v[92:95]
    v_mfma_f32_16x16x32_bf16 v[92:95], a[104:107], v[48:51], v[92:95]
    v_cndmask_b32 v88, v88, v100, s[84:85]
    v_mfma_f32_16x16x32_bf16 v[92:95], a[108:111], v[52:55], v[92:95]
    v_cndmask_b32 v89, v89, v101, s[84:85]
    v_mfma_f32_16x16x32_bf16 v[92:95], a[112:115], v[56:59], v[92:95]
    v_cndmask_b32 v90, v90, v102, s[84:85]
    v_mfma_f32_16x16x32_bf16 v[92:95], a[116:119], v[60:63], v[92:95]
    v_cndmask_b32 v91, v91, v103, s[84:85]
    v_mfma_f32_16x16x32_bf16 v[96:99], a[120:123], v[40:43], 0
    v_mfma_f32_16x16x32_bf16 v[96:99], a[124:127], v[44:47], v[96:99]
    v_mfma_f32_16x16x32_bf16 v[96:99], a[128:131], v[48:51], v[96:99]
    v_cndmask_b32 v88, v88, v104, s[86:87]
    v_mfma_f32_16x16x32_bf16 v[96:99], a[132:135], v[52:55], v[96:99]
    v_cndmask_b32 v89, v89, v105, s[86:87]
    v_mfma_f32_16x16x32_bf16 v[96:99], a[136:139], v[56:59], v[96:99]
    v_cndmask_b32 v90, v90, v106, s[86:87]
    v_mfma_f32_16x16x32_bf16 v[96:99], a[140:143], v[60:63], v[96:99]
    v_cndmask_b32 v91, v91, v107, s[86:87]
    v_mfma_f32_16x16x32_bf16 v[100:103], a[144:147], v[40:43], 0
    v_mfma_f32_16x16x32_bf16 v[100:103], a[148:151], v[44:47], v[100:103]
    v_mfma_f32_16x16x32_bf16 v[100:103], a[152:155], v[48:51], v[100:103]
    v_cndmask_b32 v88, v88, v92, s[88:89]
    v_mfma_f32_16x16x32_bf16 v[100:103], a[156:159], v[52:55], v[100:103]
    v_cndmask_b32 v89, v89, v93, s[88:89]
    v_mfma_f32_16x16x32_bf16 v[100:103], a[160:163], v[56:59], v[100:103]
    v_cndmask_b32 v90, v90, v94, s[88:89]
    v_mfma_f32_16x16x32_bf16 v[100:103], a[164:167], v[60:63], v[100:103]
    v_cndmask_b32 v91, v91, v95, s[88:89]
    v_mfma_f32_16x16x32_bf16 v[104:107], a[168:171], v[40:43], 0
    v_mfma_f32_16x16x32_bf16 v[104:107], a[172:175], v[44:47], v[104:107]
    v_mfma_f32_16x16x32_bf16 v[104:107], a[176:179], v[48:51], v[104:107]
    v_cndmask_b32 v88, v88, v96, s[90:91]
    v_mfma_f32_16x16x32_bf16 v[104:107], a[180:183], v[52:55], v[104:107]
    v_cndmask_b32 v89, v89, v97, s[90:91]
    v_mfma_f32_16x16x32_bf16 v[104:107], a[184:187], v[56:59], v[104:107]
    v_cndmask_b32 v90, v90, v98, s[90:91]
    v_mfma_f32_16x16x32_bf16 v[104:107], a[188:191], v[60:63], v[104:107]
    v_cndmask_b32 v91, v91, v99, s[90:91]
    v_cndmask_b32 v88, v88, v100, s[92:93]
    v_cndmask_b32 v89, v89, v101, s[92:93]
    v_cndmask_b32 v90, v90, v102, s[92:93]
    v_cndmask_b32 v91, v91, v103, s[92:93]
    s_nop 2
    v_cndmask_b32 v88, v88, v104, s[94:95]
    v_cndmask_b32 v89, v89, v105, s[94:95]
    v_cndmask_b32 v90, v90, v106, s[94:95]
    v_cndmask_b32 v91, v91, v107, s[94:95]
    v_max3_f32 v19, v88, v89, v90
    v_max_f32 v19, v19, v91
    s_nop 1
    v_max_f32_dpp v19, v19, v19 row_ror:4 row_mask:0xf bank_mask:0xf
    s_nop 1
    v_max_f32_dpp v19, v19, v19 row_ror:2 row_mask:0xf bank_mask:0xf
    s_nop 1
    v_max_f32_dpp v19, v19, v19 row_ror:1 row_mask:0xf bank_mask:0xf
    v_mov_b32 v92, v19
    s_nop 1
    v_permlane32_swap_b32 v19, v92
    v_max_f32 v19, v19, v92
    v_mov_b32 v92, v19
    s_nop 1
    v_permlane16_swap_b32 v19, v92
    v_max_f32 v19, v19, v92
    v_mul_f32 v19, v19, v18
    v_fma_f32 v88, v88, v18, -v19
    v_fma_f32 v89, v89, v18, -v19
    v_fma_f32 v90, v90, v18, -v19
    v_fma_f32 v91, v91, v18, -v19
    v_exp_f32 v88, v88
    v_exp_f32 v89, v89
    v_exp_f32 v90, v90
    v_exp_f32 v91, v91
    v_cvt_pk_bf16_f32 v32, v88, v89
    v_cvt_pk_bf16_f32 v33, v90, v91
    s_nop 0
    v_mov_b32_dpp v24, v32 row_newbcast:0 row_mask:0xf bank_mask:0xf
    v_mov_b32_dpp v25, v33 row_newbcast:0 row_mask:0xf bank_mask:0xf
    v_mov_b32_dpp v26, v32 row_newbcast:1 row_mask:0xf bank_mask:0xf
    v_mov_b32_dpp v27, v33 row_newbcast:1 row_mask:0xf bank_mask:0xf
    s_nop 1
    v_mfma_f32_16x16x32_bf16 v[40:43], v[24:27], a[192:195], 0
    v_add_f32 v37, v88, v89
    v_add_f32 v38, v90, v91
    v_mfma_f32_16x16x32_bf16 v[44:47], v[24:27], a[196:199], 0
    v_add_f32 v37, v37, v38
    v_mov_b32 v36, v19
    v_mfma_f32_16x16x32_bf16 v[48:51], v[24:27], a[200:203], 0
    s_lshl_b32 s77, s71, 5
    v_add_f32_dpp v37, v37, v37 row_ror:4 row_mask:0xf bank_mask:0xf
    v_mfma_f32_16x16x32_bf16 v[52:55], v[24:27], a[204:207], 0
    s_lshl_b32 s78, s72, 3
    v_add_f32_dpp v37, v37, v37 row_ror:2 row_mask:0xf bank_mask:0xf
    v_mfma_f32_16x16x32_bf16 v[56:59], v[24:27], a[208:211], 0
    s_add_u32 s77, s77, s78
    v_add_f32_dpp v37, v37, v37 row_ror:1 row_mask:0xf bank_mask:0xf
    v_mfma_f32_16x16x32_bf16 v[60:63], v[24:27], a[212:215], 0
    v_mov_b32 v38, v37
    v_mfma_f32_16x16x32_bf16 v[64:67], v[24:27], a[216:219], 0
    s_add_u32 s77, s77, s3
    v_permlane32_swap_b32 v37, v38
    v_mfma_f32_16x16x32_bf16 v[68:71], v[24:27], a[220:223], 0
    v_add_f32 v37, v37, v38
    v_mov_b32 v38, v37
    v_mfma_f32_16x16x32_bf16 v[72:75], v[24:27], a[224:227], 0
    s_nop 0
    v_permlane16_swap_b32 v37, v38
    v_mfma_f32_16x16x32_bf16 v[76:79], v[24:27], a[228:231], 0
    v_add_f32 v37, v37, v38
    v_mfma_f32_16x16x32_bf16 v[80:83], v[24:27], a[232:235], 0
    v_mov_b32_dpp v28, v32 row_newbcast:2 row_mask:0xf bank_mask:0xf
    v_mov_b32_dpp v29, v33 row_newbcast:2 row_mask:0xf bank_mask:0xf
    v_mfma_f32_16x16x32_bf16 v[84:87], v[24:27], a[236:239], 0
    v_mov_b32_dpp v30, v32 row_newbcast:3 row_mask:0xf bank_mask:0xf
    v_mov_b32_dpp v31, v33 row_newbcast:3 row_mask:0xf bank_mask:0xf
    s_mov_b64 exec, 1
    s_cmp_eq_u32 s75, 1
    s_cbranch_scc0 SLOW9
    buffer_store_dwordx2 v[36:37], v14, s[16:19], s77 offen
BACK9:
    s_mov_b64 exec, -1
    v_mfma_f32_16x16x32_bf16 v[40:43], v[28:31], v[112:115], v[40:43]
    v_mov_b32_dpp v24, v32 row_newbcast:4 row_mask:0xf bank_mask:0xf
    v_mfma_f32_16x16x32_bf16 v[44:47], v[28:31], v[116:119], v[44:47]
    v_mov_b32_dpp v25, v33 row_newbcast:4 row_mask:0xf bank_mask:0xf
    v_mfma_f32_16x16x32_bf16 v[48:51], v[28:31], v[120:123], v[48:51]
    v_mov_b32_dpp v26, v32 row_newbcast:5 row_mask:0xf bank_mask:0xf
    v_mfma_f32_16x16x32_bf16 v[52:55], v[28:31], v[124:127], v[52:55]
    v_mov_b32_dpp v27, v33 row_newbcast:5 row_mask:0xf bank_mask:0xf
    v_mfma_f32_16x16x32_bf16 v[56:59], v[28:31], v[128:131], v[56:59]
    v_mfma_f32_16x16x32_bf16 v[60:63], v[28:31], v[132:135], v[60:63]
    v_mfma_f32_16x16x32_bf16 v[64:67], v[28:31], v[136:139], v[64:67]
    v_mfma_f32_16x16x32_bf16 v[68:71], v[28:31], v[140:143], v[68:71]
    v_mfma_f32_16x16x32_bf16 v[72:75], v[28:31], v[144:147], v[72:75]
    v_mfma_f32_16x16x32_bf16 v[76:79], v[28:31], v[148:151], v[76:79]
    v_mfma_f32_16x16x32_bf16 v[80:83], v[28:31], v[152:155], v[80:83]
    v_mfma_f32_16x16x32_bf16 v[84:87], v[28:31], v[156:159], v[84:87]
    v_mfma_f32_16x16x32_bf16 v[40:43], v[24:27], v[160:163], v[40:43]
    v_mov_b32_dpp v28, v32 row_newbcast:6 row_mask:0xf bank_mask:0xf
    v_mfma_f32_16x16x32_bf16 v[44:47], v[24:27], v[164:167], v[44:47]
    v_mov_b32_dpp v29, v33 row_newbcast:6 row_mask:0xf bank_mask:0xf
    v_mfma_f32_16x16x32_bf16 v[48:51], v[24:27], v[168:171], v[48:51]
    v_mov_b32_dpp v30, v32 row_newbcast:7 row_mask:0xf bank_mask:0xf
    v_mfma_f32_16x16x32_bf16 v[52:55], v[24:27], v[172:175], v[52:55]
    v_mov_b32_dpp v31, v33 row_newbcast:7 row_mask:0xf bank_mask:0xf
    v_mfma_f32_16x16x32_bf16 v[56:59], v[24:27], v[176:179], v[56:59]
    v_mfma_f32_16x16x32_bf16 v[60:63], v[24:27], v[180:183], v[60:63]
    v_mfma_f32_16x16x32_bf16 v[64:67], v[24:27], v[184:187], v[64:67]
    v_mfma_f32_16x16x32_bf16 v[68:71], v[24:27], v[188:191], v[68:71]
    v_mfma_f32_16x16x32_bf16 v[72:75], v[24:27], v[192:195], v[72:75]
    v_mfma_f32_16x16x32_bf16 v[76:79], v[24:27], v[196:199], v[76:79]
    v_mfma_f32_16x16x32_bf16 v[80:83], v[24:27], v[200:203], v[80:83]
    v_mfma_f32_16x16x32_bf16 v[84:87], v[24:27], v[204:207], v[84:87]
    buffer_load_dwordx2 v[34:35], v14, s[16:19], s3 offen sc1
ATT_LAST:
    v_mfma_f32_16x16x32_bf16 v[40:43], v[28:31], v[208:211], v[40:43]
    v_mfma_f32_16x16x32_bf16 v[44:47], v[28:31], v[212:215], v[44:47]
    v_mfma_f32_16x16x32_bf16 v[48:51], v[28:31], v[216:219], v[48:51]
    v_mfma_f32_16x16x32_bf16 v[52:55], v[28:31], v[220:223], v[52:55]
    v_mfma_f32_16x16x32_bf16 v[56:59], v[28:31], v[224:227], v[56:59]
    v_mfma_f32_16x16x32_bf16 v[60:63], v[28:31], v[228:231], v[60:63]
    v_mfma_f32_16x16x32_bf16 v[64:67], v[28:31], v[232:235], v[64:67]
    v_mfma_f32_16x16x32_bf16 v[68:71], v[28:31], v[236:239], v[68:71]
    s_nop 1
    v_mov_b32_dpp v40, v44 quad_perm:[0,1,2,3] row_mask:0x2 bank_mask:0xf
    v_mfma_f32_16x16x32_bf16 v[72:75], v[28:31], v[240:243], v[72:75]
    s_nop 0
    v_mov_b32_dpp v40, v48 quad_perm:[0,1,2,3] row_mask:0x4 bank_mask:0xf
    s_nop 1
    v_mov_b32_dpp v40, v52 quad_perm:[0,1,2,3] row_mask:0x8 bank_mask:0xf
    v_mfma_f32_16x16x32_bf16 v[76:79], v[28:31], v[244:247], v[76:79]
    ds_write_b32 v15, v40 offset:0
    v_mfma_f32_16x16x32_bf16 v[80:83], v[28:31], v[248:251], v[80:83]
    v_mov_b32_dpp v56, v60 quad_perm:[0,1,2,3] row_mask:0x2 bank_mask:0xf
    v_mfma_f32_16x16x32_bf16 v[84:87], v[28:31], v[252:255], v[84:87]
    s_nop 0
    v_mov_b32_dpp v56, v64 quad_perm:[0,1,2,3] row_mask:0x4 bank_mask:0xf
    s_nop 1
    v_mov_b32_dpp v56, v68 quad_perm:[0,1,2,3] row_mask:0x8 bank_mask:0xf
    ds_write_b32 v15, v56 offset:256
    v_mov_b32_dpp v72, v76 quad_perm:[0,1,2,3] row_mask:0x2 bank_mask:0xf
    s_nop 1
    v_mov_b32_dpp v72, v80 quad_perm:[0,1,2,3] row_mask:0x4 bank_mask:0xf
    s_nop 1
    v_mov_b32_dpp v72, v84 quad_perm:[0,1,2,3] row_mask:0x8 bank_mask:0xf
    ds_write_b32 v15, v72 offset:512
    v_add_u32 v24, 119296, v1
    s_cmp_lg_u32 s72, 0
    s_cbranch_scc1 ONOT0
    s_cmp_eq_u32 s74, 0
    s_cbranch_scc1 MLHERE
    s_waitcnt vmcnt(0)
MLHERE:
    v_max_u32 v36, v34, v35
    v_cmp_eq_u32 vcc, -1, v36
    s_cbranch_vccnz RETRY10
OK10:
    v_mov_b32 v36, v34
    s_nop 1
    v_max_f32_dpp v36, v36, v36 row_ror:8 row_mask:0xf bank_mask:0xf
    s_nop 1
    v_max_f32_dpp v36, v36, v36 row_ror:4 row_mask:0xf bank_mask:0xf
    s_nop 1
    v_max_f32_dpp v36, v36, v36 row_ror:2 row_mask:0xf bank_mask:0xf
    s_nop 1
    v_max_f32_dpp v36, v36, v36 row_ror:1 row_mask:0xf bank_mask:0xf
    v_mov_b32 v37, v36
    s_nop 1
    v_permlane16_swap_b32 v36, v37
    v_max_f32 v36, v36, v37
    v_sub_f32 v34, v34, v36
    v_exp_f32 v34, v34
    s_nop 0
    v_mul_f32 v35, v34, v35
    s_waitcnt lgkmcnt(0)
    s_barrier
    ds_read_b128 v[40:43], v24 offset:0
    ds_read_b128 v[44:47], v24 offset:768
    ds_read_b128 v[48:51], v24 offset:1536
    ds_read_b128 v[52:55], v24 offset:2304
    v_add_f32_dpp v35, v35, v35 row_ror:8 row_mask:0xf bank_mask:0xf
    s_nop 1
    v_add_f32_dpp v35, v35, v35 row_ror:4 row_mask:0xf bank_mask:0xf
    s_nop 1
    v_add_f32_dpp v35, v35, v35 row_ror:2 row_mask:0xf bank_mask:0xf
    s_nop 1
    v_add_f32_dpp v35, v35, v35 row_ror:1 row_mask:0xf bank_mask:0xf
    v_mov_b32 v37, v35
    s_nop 1
    v_permlane16_swap_b32 v35, v37
    v_add_f32 v35, v35, v37
    s_lshl_b32 s78, s71, 2
    s_add_u32 s79, s78, 1
    s_add_u32 s7, s78, 2
    s_add_u32 s76, s78, 3
    v_rcp_f32 v35, v35
    s_nop 0
    v_mul_f32 v34, v34, v35
    s_nop 0
    v_readlane_b32 s96, v34, s78
    v_readlane_b32 s97, v34, s79
    v_readlane_b32 s98, v34, s7
    v_readlane_b32 s99, v34, s76
    s_mul_i32 s77, s70, 3072
    s_lshl_b32 s78, s71, 4
    s_add_u32 s77, s77, s78
    s_add_u32 s77, s77, s3
    s_add_u32 s77, s77, 32768
    v_lshlrev_b32 v39, 6, v0
    s_waitcnt lgkmcnt(0)
    v_mul_f32 v28, s96, v40
    v_mul_f32 v29, s96, v41
    v_mul_f32 v30, s96, v42
    v_mul_f32 v31, s96, v43
    v_fmac_f32 v28, s97, v44
    v_fmac_f32 v29, s97, v45
    v_fmac_f32 v30, s97, v46
    v_fmac_f32 v31, s97, v47
    v_fmac_f32 v28, s98, v48
    v_fmac_f32 v29, s98, v49
    v_fmac_f32 v30, s98, v50
    v_fmac_f32 v31, s98, v51
    v_fmac_f32 v28, s99, v52
    v_fmac_f32 v29, s99, v53
    v_fmac_f32 v30, s99, v54
    v_fmac_f32 v31, s99, v55
    v_cvt_pk_bf16_f32 v28, v28, v29
    v_cvt_pk_bf16_f32 v29, v30, v31
    s_nop 0
    v_mov_b32_dpp v30, v28 quad_perm:[1,1,3,3] row_mask:0xf bank_mask:0xf
    v_mov_b32_dpp v31, v29 quad_perm:[1,1,3,3] row_mask:0xf bank_mask:0xf
    s_mov_b32 exec_lo, 0x55555555
    s_mov_b32 exec_hi, 0x5555
    s_cmp_eq_u32 s75, 1
    s_cbranch_scc0 SLOW11
    buffer_store_dwordx4 v[28:31], v39, s[16:19], s77 offen
BACK11:
    s_mov_b64 exec, -1
    s_waitcnt vmcnt(1)
    s_branch ODONE
ONOT0:
    s_waitcnt lgkmcnt(0)
    s_barrier
    s_waitcnt vmcnt(0)
ODONE:
    v_and_b32 v25, 15, v0
    v_lshrrev_b32 v26, 4, v0
    v_bfe_u32 v27, v0, 2, 2
    v_and_b32 v36, 3, v0
    s_cmp_ge_u32 s69, 20
    s_cbranch_scc1 ROLEF
    s_mul_i32 s77, s72, 12288
    s_add_u32 s77, s77, 57344
    v_lshl_add_u32 v37, v26, 3, v27
    v_lshlrev_b32 v37, 6, v37
    v_lshl_add_u32 v37, v36, 3, v37
    v_add_u32 v37, s77, v37
    ds_read_b64_tr_b16 v[40:41], v37 offset:0
    ds_read_b64_tr_b16 v[42:43], v37 offset:256
    ds_read_b64_tr_b16 v[44:45], v37 offset:2048
    ds_read_b64_tr_b16 v[46:47], v37 offset:2304
    ds_read_b64_tr_b16 v[48:49], v37 offset:4096
    ds_read_b64_tr_b16 v[50:51], v37 offset:4352
    ds_read_b64_tr_b16 v[52:53], v37 offset:6144
    ds_read_b64_tr_b16 v[54:55], v37 offset:6400
    ds_read_b64_tr_b16 v[56:57], v37 offset:8192
    ds_read_b64_tr_b16 v[58:59], v37 offset:8448
    ds_read_b64_tr_b16 v[60:61], v37 offset:10240
    ds_read_b64_tr_b16 v[62:63], v37 offset:10496
    ds_read_b64_tr_b16 v[64:65], v37 offset:32
    ds_read_b64_tr_b16 v[66:67], v37 offset:288
    ds_read_b64_tr_b16 v[68:69], v37 offset:2080
    ds_read_b64_tr_b16 v[70:71], v37 offset:2336
    ds_read_b64_tr_b16 v[72:73], v37 offset:4128
    ds_read_b64_tr_b16 v[74:75], v37 offset:4384
    ds_read_b64_tr_b16 v[76:77], v37 offset:6176
    ds_read_b64_tr_b16 v[78:79], v37 offset:6432
    ds_read_b64_tr_b16 v[80:81], v37 offset:8224
    ds_read_b64_tr_b16 v[82:83], v37 offset:8480
    ds_read_b64_tr_b16 v[84:85], v37 offset:10272
    ds_read_b64_tr_b16 v[86:87], v37 offset:10528
    s_cmp_lg_u32 s72, 1
    s_cbranch_scc1 NOOWN0
    s_cmp_eq_u32 s74, 0
    s_cbranch_scc1 NOOWN0
    v_accvgpr_read_b32 v28, a244
    v_accvgpr_read_b32 v29, a245
    v_max_u32 v30, v28, v29
    v_cmp_eq_u32 vcc, -1, v30
    s_cbranch_vccnz RETRY12
OK12:
    v_lshlrev_b32 v30, 16, v28
    v_and_b32 v28, 0xffff0000, v28
    v_lshlrev_b32 v31, 16, v29
    v_and_b32 v29, 0xffff0000, v29
    v_add_f32 v30, v30, v31
    v_add_f32 v28, v28, v29
    v_mov_b32 v31, v30
    v_mov_b32 v29, v28
    s_nop 0
    v_permlane32_swap_b32 v30, v31
    v_permlane32_swap_b32 v28, v29
    v_add_f32 v30, v30, v31
    v_add_f32 v28, v28, v29
    v_mov_b32 v31, v30
    v_mov_b32 v29, v28
    s_nop 0
    v_permlane16_swap_b32 v30, v31
    v_permlane16_swap_b32 v28, v29
    v_add_f32 v30, v30, v31
    v_add_f32 v28, v28, v29
    v_add_f32 v22, v22, v30
    v_add_f32 v23, v23, v28
    v_cvt_pk_bf16_f32 v28, v22, v23
    s_lshl_b32 s77, s69, 6
    s_add_u32 s77, s77, s3
    s_add_u32 s77, s77, 79360
    v_lshlrev_b32 v37, 2, v0
    v_mov_b32_dpp v29, v28 quad_perm:[1,1,1,1] row_mask:0xf bank_mask:0xf
    v_mov_b32_dpp v30, v28 quad_perm:[2,2,2,2] row_mask:0xf bank_mask:0xf
    v_mov_b32_dpp v31, v28 quad_perm:[3,3,3,3] row_mask:0xf bank_mask:0xf
    s_mov_b32 exec_lo, 0x1111
    s_mov_b32 exec_hi, 0x0
    s_cmp_eq_u32 s75, 1
    s_cbranch_scc0 SLOW13
    buffer_store_dwordx4 v[28:31], v37, s[16:19], s77 offen
BACK13:
    s_mov_b64 exec, -1
NOOWN0:
    v_lshlrev_b32 v37, 4, v25
    v_lshl_add_u32 v37, v26, 7, v37
    s_mul_i32 s79, s72, 3072
    s_add_u32 s79, s79, s3
    s_add_u32 s79, s79, 32768
    s_lshl_b32 s77, s69, 6
    s_mul_i32 s78, s68, 1280
    s_add_u32 s78, s78, s77
    s_add_u32 s78, s78, s74
    s_add_u32 s77, s77, s3
    s_add_u32 s96, s78, 655360
    s_add_u32 s97, s77, 76800
    s_lshl_b32 s7, s72, 8
    s_add_u32 s7, s7, 122368
    v_lshl_add_u32 v27, v0, 2, s7
    v_lshlrev_b32 v39, 3, v0
    s_waitcnt lgkmcnt(0)
    s_mov_b32 exec_lo, 0xff00ff
    s_mov_b32 exec_hi, 0xff00ff
    s_mov_b32 s76, 0
POLL14:
    buffer_load_dwordx4 v[88:91], v37, s[16:19], s79 offen offset:0 sc1
    buffer_load_dwordx4 v[92:95], v37, s[16:19], s79 offen offset:512 sc1
    buffer_load_dwordx4 v[96:99], v37, s[16:19], s79 offen offset:1024 sc1
    buffer_load_dwordx4 v[100:103], v37, s[16:19], s79 offen offset:1536 sc1
    buffer_load_dwordx4 v[104:107], v37, s[16:19], s79 offen offset:2048 sc1
    buffer_load_dwordx4 v[108:111], v37, s[16:19], s79 offen offset:2560 sc1
    s_add_u32 s76, s76, 1
    s_cmp_ge_u32 s76, 32768
    s_waitcnt vmcnt(0)
    v_max3_u32 v36, v88, v92, v96
    v_max3_u32 v36, v36, v100, v104
    v_max_u32 v36, v36, v108
    v_cmp_eq_u32 vcc, -1, v36
    s_cbranch_scc1 POLLX14
    s_cbranch_vccnz POLL14
POLLX14:
    s_mov_b64 exec, -1
    v_mfma_f32_16x16x32_bf16 v[28:31], v[88:91], v[40:43], 0
    v_mfma_f32_16x16x32_bf16 v[32:35], v[88:91], v[64:67], 0
    v_mfma_f32_16x16x32_bf16 v[28:31], v[92:95], v[44:47], v[28:31]
    v_mfma_f32_16x16x32_bf16 v[32:35], v[92:95], v[68:71], v[32:35]
    v_mfma_f32_16x16x32_bf16 v[28:31], v[96:99], v[48:51], v[28:31]
    v_mfma_f32_16x16x32_bf16 v[32:35], v[96:99], v[72:75], v[32:35]
    v_mfma_f32_16x16x32_bf16 v[28:31], v[100:103], v[52:55], v[28:31]
    v_mfma_f32_16x16x32_bf16 v[32:35], v[100:103], v[76:79], v[32:35]
    v_mfma_f32_16x16x32_bf16 v[28:31], v[104:107], v[56:59], v[28:31]
    v_mfma_f32_16x16x32_bf16 v[32:35], v[104:107], v[80:83], v[32:35]
    v_mfma_f32_16x16x32_bf16 v[28:31], v[108:111], v[60:63], v[28:31]
    v_mfma_f32_16x16x32_bf16 v[32:35], v[108:111], v[84:87], v[32:35]
    s_nop 6
    v_add_f32 v28, v28, v29
    v_add_f32 v30, v30, v31
    v_add_f32 v32, v32, v33
    v_add_f32 v34, v34, v35
    v_add_f32 v28, v28, v30
    v_add_f32 v32, v32, v34
    s_nop 1
    v_permlane16_swap_b32 v28, v32
    v_add_f32 v28, v28, v32
    ds_write_b32 v27, v28
    s_cmp_lg_u32 s72, 0
    s_waitcnt lgkmcnt(0)
    s_barrier
    s_cbranch_scc1 WNOT0
    ds_read_b128 v[40:43], v24 offset:3072
    ds_read_b128 v[44:47], v24 offset:3328
    ds_read_b128 v[48:51], v24 offset:3584
    ds_read_b128 v[52:55], v24 offset:3840
    s_waitcnt lgkmcnt(2)
    v_add_f32 v28, v40, v44
    v_add_f32 v29, v41, v45
    v_add_f32 v30, v42, v46
    v_add_f32 v31, v43, v47
    s_waitcnt lgkmcnt(0)
    v_add_f32 v32, v48, v52
    v_add_f32 v33, v49, v53
    v_add_f32 v34, v50, v54
    v_add_f32 v35, v51, v55
    v_add_f32 v28, v28, v32
    v_add_f32 v29, v29, v33
    v_add_f32 v30, v30, v34
    v_add_f32 v31, v31, v35
    v_cvt_pk_bf16_f32 v28, v28, v29
    v_cvt_pk_bf16_f32 v29, v30, v31
    s_nop 0
    v_mov_b32_dpp v30, v28 quad_perm:[1,1,3,3] row_mask:0xf bank_mask:0xf
    v_mov_b32_dpp v31, v29 quad_perm:[1,1,3,3] row_mask:0xf bank_mask:0xf
    s_mov_b32 exec_lo, 0x55
    s_mov_b32 exec_hi, 0x0
    buffer_store_dwordx4 v[28:31], v39, s[16:19], s96 offen sc1
    s_cmp_eq_u32 s75, 1
    s_cbranch_scc0 SLOW15
    buffer_store_dwordx4 v[28:31], v39, s[16:19], s97 offen
BACK15:
    s_mov_b64 exec, -1
    v_lshrrev_b32 v37, 5, v0
    v_mul_u32_u24 v37, 2560, v37
    v_and_b32 v38, 31, v0
    v_lshl_add_u32 v37, v38, 2, v37
    v_add_u32 v41, 5120, v37
    v_add_u32 v42, 10240, v37
    v_add_u32 v43, 15360, v37
    v_add_u32 v44, 20480, v37
    v_add_u32 v45, 25600, v37
    s_lshl_b32 s79, s69, 7
    s_add_u32 s79, s79, s3
    s_add_u32 s79, s79, 46080
    s_add_u32 s96, s78, 665600
    s_add_u32 s97, s77, 78080
    v_lshlrev_b32 v39, 1, v0
    s_mov_b32 s76, 0
POLL16:
    buffer_load_dword v28, v37, s[16:19], s79 offen sc1
    buffer_load_dword v29, v41, s[16:19], s79 offen sc1
    buffer_load_dword v30, v42, s[16:19], s79 offen sc1
    buffer_load_dword v31, v43, s[16:19], s79 offen sc1
    buffer_load_dword v32, v44, s[16:19], s79 offen sc1
    buffer_load_dword v33, v45, s[16:19], s79 offen sc1
    s_add_u32 s76, s76, 1
    s_cmp_ge_u32 s76, 32768
    s_waitcnt vmcnt(0)
    v_max3_u32 v36, v28, v29, v30
    v_max3_u32 v36, v36, v31, v32
    v_max_u32 v36, v36, v33
    v_cmp_eq_u32 vcc, -1, v36
    s_cbranch_scc1 POLLX16
    s_cbranch_vccnz POLL16
POLLX16:
    v_add_f32 v28, v28, v29
    v_add_f32 v30, v30, v31
    v_add_f32 v32, v32, v33
    v_add_f32 v28, v28, v30
    v_add_f32 v28, v28, v32
    v_mov_b32 v29, v28
    s_nop 1
    v_permlane32_swap_b32 v28, v29
    v_add_f32 v28, v28, v29
    s_nop 1
    v_mov_b32_dpp v29, v28 row_shl:1 row_mask:0xf bank_mask:0xf
    v_cvt_pk_bf16_f32 v28, v28, v29
    s_nop 1
    v_mov_b32_dpp v29, v28 row_shl:2 row_mask:0xf bank_mask:0xf
    v_mov_b32_dpp v30, v28 row_shl:4 row_mask:0xf bank_mask:0xf
    v_mov_b32_dpp v31, v28 row_shl:6 row_mask:0xf bank_mask:0xf
    s_mov_b32 exec_lo, 0x1010101
    s_mov_b32 exec_hi, 0x0
    buffer_store_dwordx4 v[28:31], v39, s[16:19], s96 offen sc1
    s_cmp_eq_u32 s75, 1
    s_cbranch_scc0 SLOW17
    buffer_store_dwordx4 v[28:31], v39, s[16:19], s97 offen
BACK17:
    s_mov_b64 exec, -1
    s_branch NEXT
WNOT0:
    s_cmp_lg_u32 s72, 1
    s_cbranch_scc1 NEXT
    v_mul_u32_u24 v37, 1280, v26
    v_add_u32 v37, 655360, v37
    s_mul_i32 s7, s68, 81920
    s_add_u32 s7, s7, 76800
    v_mov_b32 v38, s7
    v_cmp_eq_u32 vcc, s68, v26
    s_nop 1
    v_cndmask_b32 v37, v37, v38, vcc
    v_add_u32 v39, 4, v26
    v_mul_u32_u24 v38, 1280, v39
    v_add_u32 v38, 655360, v38
    s_mul_i32 s7, s68, 81920
    s_add_u32 s7, s7, 76800
    v_mov_b32 v28, s7
    v_cmp_eq_u32 vcc, s68, v39
    s_nop 1
    v_cndmask_b32 v38, v38, v28, vcc
    s_lshl_b32 s77, s69, 6
    s_add_u32 s77, s77, s74
    v_lshl_add_u32 v37, v25, 2, v37
    v_lshl_add_u32 v38, v25, 2, v38
    s_mov_b32 s76, 0
POLL18:
    buffer_load_dword v28, v37, s[16:19], s77 offen sc1
    buffer_load_dword v29, v38, s[16:19], s77 offen sc1
    s_add_u32 s76, s76, 1
    s_cmp_ge_u32 s76, 32768
    s_waitcnt vmcnt(0)
    v_max_u32 v30, v28, v29
    v_cmp_eq_u32 vcc, -1, v30
    s_cbranch_scc1 POLLX18
    s_cbranch_vccnz POLL18
POLLX18:
    v_lshlrev_b32 v30, 16, v28
    v_and_b32 v28, 0xffff0000, v28
    v_lshlrev_b32 v31, 16, v29
    v_and_b32 v29, 0xffff0000, v29
    v_add_f32 v30, v30, v31
    v_add_f32 v28, v28, v29
    v_mov_b32 v31, v30
    v_mov_b32 v29, v28
    s_nop 0
    v_permlane32_swap_b32 v30, v31
    v_permlane32_swap_b32 v28, v29
    v_add_f32 v30, v30, v31
    v_add_f32 v28, v28, v29
    v_mov_b32 v31, v30
    v_mov_b32 v29, v28
    s_nop 0
    v_permlane16_swap_b32 v30, v31
    v_permlane16_swap_b32 v28, v29
    v_add_f32 v30, v30, v31
    v_add_f32 v28, v28, v29
    v_add_f32 v22, v22, v30
    v_add_f32 v23, v23, v28
    v_cvt_pk_bf16_f32 v28, v22, v23
    s_cmp_lg_u32 s74, 0
    s_cbranch_scc1 FINAL
    s_lshl_b32 s77, s69, 6
    s_add_u32 s77, s77, s3
    s_add_u32 s77, s77, 80640
    v_lshlrev_b32 v37, 2, v0
    v_mov_b32_dpp v29, v28 quad_perm:[1,1,1,1] row_mask:0xf bank_mask:0xf
    v_mov_b32_dpp v30, v28 quad_perm:[2,2,2,2] row_mask:0xf bank_mask:0xf
    v_mov_b32_dpp v31, v28 quad_perm:[3,3,3,3] row_mask:0xf bank_mask:0xf
    s_mov_b32 exec_lo, 0x1111
    s_mov_b32 exec_hi, 0x0
    s_cmp_eq_u32 s75, 1
    s_cbranch_scc0 SLOW19
    buffer_store_dwordx4 v[28:31], v37, s[16:19], s77 offen
BACK19:
    s_mov_b64 exec, -1
    s_branch NEXT
FINAL:
    s_cmp_lg_u32 s68, 0
    s_cbranch_scc1 DONE
    s_lshl_b32 s77, s69, 6
    v_lshlrev_b32 v37, 2, v0
    s_mov_b32 s76, 0
POLL20:
    buffer_load_dword v28, v20, s[16:19], s74 offen sc1
    buffer_load_dword v29, v21, s[16:19], s74 offen sc1
    s_add_u32 s76, s76, 1
    s_cmp_ge_u32 s76, 32768
    s_waitcnt vmcnt(0)
    v_max_u32 v30, v28, v29
    v_cmp_eq_u32 vcc, -1, v30
    s_cbranch_scc1 POLLX20
    s_cbranch_vccnz POLL20
POLLX20:
    v_lshlrev_b32 v30, 16, v28
    v_and_b32 v28, 0xffff0000, v28
    v_lshlrev_b32 v31, 16, v29
    v_and_b32 v29, 0xffff0000, v29
    v_add_f32 v30, v30, v31
    v_add_f32 v28, v28, v29
    v_mov_b32 v31, v30
    v_mov_b32 v29, v28
    s_nop 0
    v_permlane32_swap_b32 v30, v31
    v_permlane32_swap_b32 v28, v29
    v_add_f32 v30, v30, v31
    v_add_f32 v28, v28, v29
    v_mov_b32 v31, v30
    v_mov_b32 v29, v28
    s_nop 0
    v_permlane16_swap_b32 v30, v31
    v_permlane16_swap_b32 v28, v29
    v_add_f32 v30, v30, v31
    v_add_f32 v28, v28, v29
    v_add_f32 v22, v22, v30
    v_add_f32 v23, v23, v28
    v_cvt_pk_bf16_f32 v28, v22, v23
    s_mov_b32 exec_lo, 0xffff
    s_mov_b32 exec_hi, 0x0
    buffer_store_dword v28, v37, s[40:43], s77 offen
    s_mov_b64 exec, -1
    s_endpgm
ROLEF:
    s_mov_b32 s4, 1
    s_cmp_lg_u32 s74, 0
    s_cbranch_scc1 FW
    s_mov_b32 s4, 0
    v_mov_b32 v86, v25
    v_lshrrev_b32 v24, 1, v0
    v_mul_u32_u24 v24, 3072, v24
    v_and_b32 v25, 1, v0
    v_lshl_add_u32 v24, v25, 4, v24
    s_mul_i32 s79, s68, 12
    s_add_u32 s79, s79, s69
    s_sub_u32 s79, s79, 20
    s_mul_i32 s77, s72, 491520
    s_lshl_b32 s78, s79, 5
    s_add_u32 s77, s77, s78
    s_mul_i32 s78, s72, 5120
    s_add_u32 m0, s78, 57344
    s_nop 0
    buffer_load_dwordx4 v24, s[24:27], s77 offen  lds
    s_add_u32 m0, s78, 77824
    s_nop 0
    buffer_load_dwordx4 v24, s[28:31], s77 offen  lds
    s_add_u32 s77, s77, 98304
    s_add_u32 m0, s78, 58368
    s_nop 0
    buffer_load_dwordx4 v24, s[24:27], s77 offen  lds
    s_add_u32 m0, s78, 78848
    s_nop 0
    buffer_load_dwordx4 v24, s[28:31], s77 offen  lds
    s_add_u32 s77, s77, 98304
    s_add_u32 m0, s78, 59392
    s_nop 0
    buffer_load_dwordx4 v24, s[24:27], s77 offen  lds
    s_add_u32 m0, s78, 79872
    s_nop 0
    buffer_load_dwordx4 v24, s[28:31], s77 offen  lds
    s_add_u32 s77, s77, 98304
    s_add_u32 m0, s78, 60416
    s_nop 0
    buffer_load_dwordx4 v24, s[24:27], s77 offen  lds
    s_add_u32 m0, s78, 80896
    s_nop 0
    buffer_load_dwordx4 v24, s[28:31], s77 offen  lds
    s_add_u32 s77, s77, 98304
    s_add_u32 m0, s78, 61440
    s_nop 0
    buffer_load_dwordx4 v24, s[24:27], s77 offen  lds
    s_add_u32 m0, s78, 81920
    s_nop 0
    buffer_load_dwordx4 v24, s[28:31], s77 offen  lds
    s_mul_i32 s77, s79, 20480
    s_add_u32 s77, s77, s78
    s_add_u32 m0, s78, 98304
    s_nop 0
    buffer_load_dwordx4 v1, s[32:35], s77 offen nt lds
    s_add_u32 s77, s77, 1024
    s_add_u32 m0, s78, 99328
    s_nop 0
    buffer_load_dwordx4 v1, s[32:35], s77 offen nt lds
    s_add_u32 s77, s77, 1024
    s_add_u32 m0, s78, 100352
    s_nop 0
    buffer_load_dwordx4 v1, s[32:35], s77 offen nt lds
    s_add_u32 s77, s77, 1024
    s_add_u32 m0, s78, 101376
    s_nop 0
    buffer_load_dwordx4 v1, s[32:35], s77 offen nt lds
    s_add_u32 s77, s77, 1024
    s_add_u32 m0, s78, 102400
    s_nop 0
    buffer_load_dwordx4 v1, s[32:35], s77 offen nt lds
    v_mov_b32 v25, v86
    s_waitcnt vmcnt(0)
FW:
    s_mul_i32 s77, s72, 5120
    s_add_u32 s77, s77, 57344
    v_lshl_add_u32 v37, v26, 3, v27
    v_lshlrev_b32 v37, 5, v37
    v_lshl_add_u32 v37, v36, 3, v37
    v_add_u32 v37, s77, v37
    ds_read_b64_tr_b16 v[40:41], v37 offset:0
    ds_read_b64_tr_b16 v[42:43], v37 offset:128
    ds_read_b64_tr_b16 v[44:45], v37 offset:1024
    ds_read_b64_tr_b16 v[46:47], v37 offset:1152
    ds_read_b64_tr_b16 v[48:49], v37 offset:2048
    ds_read_b64_tr_b16 v[50:51], v37 offset:2176
    ds_read_b64_tr_b16 v[52:53], v37 offset:3072
    ds_read_b64_tr_b16 v[54:55], v37 offset:3200
    ds_read_b64_tr_b16 v[56:57], v37 offset:4096
    ds_read_b64_tr_b16 v[58:59], v37 offset:4224
    ds_read_b64_tr_b16 v[60:61], v37 offset:20480
    ds_read_b64_tr_b16 v[62:63], v37 offset:20608
    ds_read_b64_tr_b16 v[64:65], v37 offset:21504
    ds_read_b64_tr_b16 v[66:67], v37 offset:21632
    ds_read_b64_tr_b16 v[68:69], v37 offset:22528
    ds_read_b64_tr_b16 v[70:71], v37 offset:22656
    ds_read_b64_tr_b16 v[72:73], v37 offset:23552
    ds_read_b64_tr_b16 v[74:75], v37 offset:23680
    ds_read_b64_tr_b16 v[76:77], v37 offset:24576
    ds_read_b64_tr_b16 v[78:79], v37 offset:24704
    s_mul_i32 s77, s72, 320
    s_add_u32 s77, s77, 98304
    v_lshrrev_b32 v80, 2, v0
    v_mul_u32_u24 v80, 1280, v80
    v_lshl_add_u32 v80, v36, 3, v80
    v_add_u32 v80, s77, v80
    s_lshl_b32 s79, s72, 2
    s_add_u32 s79, s79, 123392
    v_add_u32 v81, s79, v1
    v_lshl_add_u32 v82, v26, 2, v36
    v_lshlrev_b32 v82, 4, v82
    v_add_u32 v82, 123392, v82
    v_cmp_eq_u32 vcc, 12, v25
    v_mov_b32 v38, 13
    s_nop 0
    v_cndmask_b32 v83, v25, v38, vcc
    v_lshlrev_b32 v83, 4, v83
    v_add_u32 v83, 123904, v83
    v_mov_b32 v85, 124096
    v_lshlrev_b32 v84, 6, v25
    v_lshl_add_u32 v84, v26, 4, v84
    v_mov_b32 v38, 0x3f803f80
    v_cndmask_b32 v88, 0, v38, vcc
    v_mov_b32 v89, v88
    v_mov_b32 v90, v88
    v_mov_b32 v91, v88
    v_mov_b32 v92, v88
    v_mov_b32 v93, v88
    v_mov_b32 v94, v88
    v_mov_b32 v95, v88
    v_mov_b32 v96, v88
    v_mov_b32 v97, v88
    v_mov_b32 v98, v88
    v_mov_b32 v99, v88
    v_mov_b32 v100, v88
    v_mov_b32 v101, v88
    v_mov_b32 v102, v88
    v_mov_b32 v103, v88
    v_mov_b32 v104, v88
    v_mov_b32 v105, v88
    v_mov_b32 v106, v88
    v_mov_b32 v107, v88
    s_mul_i32 s77, s72, 6656
    v_mul_u32_u24 v6, 336, v25
    v_lshl_add_u32 v6, v26, 4, v6
    v_add_u32 v6, s77, v6
    v_mul_u32_u24 v37, 52, v0
    v_lshrrev_b32 v37, 10, v37
    v_lshl_add_u32 v87, v37, 4, v1
    v_add_u32 v87, s77, v87
    v_mul_u32_u24 v27, 320, v37
    v_sub_u32 v27, v1, v27
    v_mul_u32_u24 v86, 1280, v37
    v_add_u32 v86, 655360, v86
    s_mul_i32 s7, s68, 81920
    s_add_u32 s7, s7, 76800
    v_mov_b32 v38, s7
    v_cmp_eq_u32 vcc, s68, v37
    s_nop 1
    v_cndmask_b32 v86, v86, v38, vcc
    v_add_u32 v38, 2560, v38
    v_cmp_le_u32 vcc, 8, v37
    s_nop 1
    v_cndmask_b32 v86, v86, v38, vcc
    v_add_u32 v86, v86, v27
    v_add_u32 v37, 3, v37
    v_mul_u32_u24 v18, 1280, v37
    v_add_u32 v18, 655360, v18
    s_mul_i32 s7, s68, 81920
    s_add_u32 s7, s7, 76800
    v_mov_b32 v38, s7
    v_cmp_eq_u32 vcc, s68, v37
    s_nop 1
    v_cndmask_b32 v18, v18, v38, vcc
    v_add_u32 v38, 2560, v38
    v_cmp_le_u32 vcc, 8, v37
    s_nop 1
    v_cndmask_b32 v18, v18, v38, vcc
    v_add_u32 v18, v18, v27
    v_add_u32 v37, 3, v37
    v_mul_u32_u24 v19, 1280, v37
    v_add_u32 v19, 655360, v19
    s_mul_i32 s7, s68, 81920
    s_add_u32 s7, s7, 76800
    v_mov_b32 v38, s7
    v_cmp_eq_u32 vcc, s68, v37
    s_nop 1
    v_cndmask_b32 v19, v19, v38, vcc
    v_add_u32 v38, 2560, v38
    v_cmp_le_u32 vcc, 8, v37
    s_nop 1
    v_cndmask_b32 v19, v19, v38, vcc
    v_add_u32 v19, v19, v27
    s_mul_i32 s77, s72, 320
    s_add_u32 s77, s77, s74
    s_sub_u32 s78, s69, 20
    s_mul_i32 s78, s78, 2560
    s_mul_i32 s7, s72, 640
    s_add_u32 s78, s78, s7
    s_add_u32 s78, s78, s3
    s_add_u32 s78, s78, 46080
    s_waitcnt lgkmcnt(0)
    s_cmp_eq_u32 s4, 0
    s_cbranch_scc1 FMM
FPOLL:
    ds_read_b64_tr_b16 a[240:241], v80 offset:0
    ds_read_b64_tr_b16 a[242:243], v80 offset:32
    ds_read_b64_tr_b16 a[244:245], v80 offset:64
    ds_read_b64_tr_b16 a[246:247], v80 offset:96
    ds_read_b64_tr_b16 a[248:249], v80 offset:128
    ds_read_b64_tr_b16 a[250:251], v80 offset:160
    ds_read_b64_tr_b16 v[108:109], v80 offset:192
    ds_read_b64_tr_b16 v[110:111], v80 offset:224
    ds_read_b64_tr_b16 v[2:3], v80 offset:256
    ds_read_b64_tr_b16 v[4:5], v80 offset:288
    s_waitcnt lgkmcnt(0)
    s_mov_b32 exec_lo, 0xffffffff
    s_mov_b32 exec_hi, 0xfffffff
    s_mov_b32 s76, 0
POLL21:
    buffer_load_dwordx4 v[24:27], v86, s[16:19], s77 offen sc1
    buffer_load_dwordx4 v[28:31], v18, s[16:19], s77 offen sc1
    buffer_load_dwordx4 v[32:35], v19, s[16:19], s77 offen sc1
    s_add_u32 s76, s76, 1
    s_cmp_ge_u32 s76, 32768
    s_waitcnt vmcnt(0)
    v_max3_u32 v36, v24, v28, v32
    v_cmp_eq_u32 vcc, -1, v36
    s_cbranch_scc1 POLLX21
    s_cbranch_vccnz POLL21
POLLX21:
    ds_write_b128 v87, v[24:27] offset:0
    ds_write_b128 v87, v[28:31] offset:1008
    ds_write_b128 v87, v[32:35] offset:2016
    s_mov_b32 exec_lo, 0x1ff01ff
    s_mov_b32 exec_hi, 0x1ff01ff
    ds_read_b128 v[88:91], v6 offset:0
    ds_read_b128 v[92:95], v6 offset:64
    ds_read_b128 v[96:99], v6 offset:128
    ds_read_b128 v[100:103], v6 offset:192
    ds_read_b128 v[104:107], v6 offset:256
    s_mov_b64 exec, -1
    s_waitcnt lgkmcnt(0)
FMM:
    v_mfma_f32_16x16x32_bf16 v[24:27], v[88:91], v[40:43], 0
    v_mfma_f32_16x16x32_bf16 v[28:31], v[88:91], v[60:63], 0
    v_mfma_f32_16x16x32_bf16 v[32:35], v[88:91], v[88:91], 0
    v_mfma_f32_16x16x32_bf16 v[24:27], v[92:95], v[44:47], v[24:27]
    v_mfma_f32_16x16x32_bf16 v[28:31], v[92:95], v[64:67], v[28:31]
    v_mfma_f32_16x16x32_bf16 v[32:35], v[92:95], v[92:95], v[32:35]
    v_mfma_f32_16x16x32_bf16 v[24:27], v[96:99], v[48:51], v[24:27]
    v_mfma_f32_16x16x32_bf16 v[28:31], v[96:99], v[68:71], v[28:31]
    v_mfma_f32_16x16x32_bf16 v[32:35], v[96:99], v[96:99], v[32:35]
    v_mfma_f32_16x16x32_bf16 v[24:27], v[100:103], v[52:55], v[24:27]
    v_mfma_f32_16x16x32_bf16 v[28:31], v[100:103], v[72:75], v[28:31]
    v_mfma_f32_16x16x32_bf16 v[32:35], v[100:103], v[100:103], v[32:35]
    v_mfma_f32_16x16x32_bf16 v[24:27], v[104:107], v[56:59], v[24:27]
    v_mfma_f32_16x16x32_bf16 v[28:31], v[104:107], v[76:79], v[28:31]
    v_mfma_f32_16x16x32_bf16 v[32:35], v[104:107], v[104:107], v[32:35]
    s_nop 5
    v_add_f32 v24, v24, v25
    v_add_f32 v26, v26, v27
    v_add_f32 v28, v28, v29
    v_add_f32 v30, v30, v31
    v_add_f32 v32, v32, v33
    v_add_f32 v34, v34, v35
    v_add_f32 v24, v24, v26
    v_add_f32 v28, v28, v30
    v_add_f32 v32, v32, v34
    s_nop 1
    v_permlane32_swap_b32 v24, v32
    v_permlane32_swap_b32 v28, v25
    v_add_f32 v24, v24, v32
    v_add_f32 v28, v28, v25
    s_nop 1
    v_permlane16_swap_b32 v24, v28
    v_add_f32 v24, v24, v28
    ds_write_b32 v81, v24
    s_cmp_eq_u32 s4, 0
    s_waitcnt lgkmcnt(0)
    s_barrier
    ds_read_b128 v[24:27], v83
    ds_read_b128 v[28:31], v85
    ds_read_b128 v[32:35], v82
    ds_read_b128 v[36:39], v82 offset:256
    s_cbranch_scc1 FCS
    s_waitcnt lgkmcnt(3)
    v_add_f32 v24, v24, v25
    v_add_f32 v26, v26, v27
    v_add_f32 v24, v24, v26
    s_waitcnt lgkmcnt(2)
    v_add_f32 v28, v28, v29
    v_add_f32_dpp v24, v24, v24 row_ror:8 row_mask:0xf bank_mask:0xf
    v_add_f32 v30, v30, v31
    v_add_f32 v28, v28, v30
    v_add_f32_dpp v24, v24, v24 row_ror:4 row_mask:0xf bank_mask:0xf
    s_waitcnt lgkmcnt(0)
    v_subrev_f32 v29, 0x44200000, v28
    v_add_f32_dpp v24, v24, v24 row_ror:2 row_mask:0xf bank_mask:0xf
    v_add_f32 v32, v32, v33
    v_mul_f32 v30, 0x3acccccd, v29
    v_add_f32_dpp v24, v24, v24 row_ror:1 row_mask:0xf bank_mask:0xf
    v_add_f32 v34, v34, v35
    v_sub_f32 v24, v24, v29
    v_add_f32 v32, v32, v34
    v_mul_f32 v24, 0x3acccccd, v24
    v_add_f32 v36, v36, v37
    v_fma_f32 v24, -v30, v30, v24
    v_add_f32 v38, v38, v39
    v_max_f32 v24, 0, v24
    v_fma_f32 v32, -v28, v22, v32
    v_add_f32 v24, 0x3727c5ac, v24
    v_add_f32 v36, v36, v38
    v_rsq_f32 v24, v24
    v_fma_f32 v36, -v28, v23, v36
    v_mul_f32 v33, 0xbfb8aa3b, v32
    v_mul_f32 v33, v33, v24
    v_mul_f32 v36, v36, v32
    v_exp_f32 v33, v33
    v_mul_f32 v36, v36, v24
    v_add_f32 v33, 1.0, v33
    v_mul_f32 v36, v36, v24
    v_rcp_f32 v33, v33
    s_nop 0
    v_mul_f32 v36, v36, v33
    s_nop 1
    v_mov_b32_dpp v28, v36 quad_perm:[0,0,0,0] row_mask:0xf bank_mask:0xf
    v_mov_b32_dpp v29, v36 quad_perm:[1,1,1,1] row_mask:0xf bank_mask:0xf
    v_mov_b32_dpp v30, v36 quad_perm:[2,2,2,2] row_mask:0xf bank_mask:0xf
    v_mov_b32_dpp v31, v36 quad_perm:[3,3,3,3] row_mask:0xf bank_mask:0xf
    v_cvt_pk_bf16_f32 v28, v28, v29
    v_cvt_pk_bf16_f32 v29, v30, v31
    v_cndmask_b32 v60, 0, v28, s[44:45]
    v_cndmask_b32 v61, 0, v29, s[44:45]
    v_cndmask_b32 v62, 0, v28, s[46:47]
    v_cndmask_b32 v63, 0, v29, s[46:47]
    v_mfma_f32_16x16x16_bf16 v[24:27], a[240:241], v[60:61], 0
    v_cndmask_b32 v64, 0, v28, s[48:49]
    v_cndmask_b32 v65, 0, v29, s[48:49]
    v_mfma_f32_16x16x16_bf16 v[24:27], a[242:243], v[62:63], v[24:27]
    v_cndmask_b32 v66, 0, v28, s[50:51]
    v_cndmask_b32 v67, 0, v29, s[50:51]
    v_mfma_f32_16x16x16_bf16 v[24:27], a[244:245], v[64:65], v[24:27]
    v_cndmask_b32 v68, 0, v28, s[52:53]
    v_cndmask_b32 v69, 0, v29, s[52:53]
    v_mfma_f32_16x16x16_bf16 v[24:27], a[246:247], v[66:67], v[24:27]
    v_cndmask_b32 v70, 0, v28, s[54:55]
    v_cndmask_b32 v71, 0, v29, s[54:55]
    v_mfma_f32_16x16x16_bf16 v[24:27], a[248:249], v[68:69], v[24:27]
    v_cndmask_b32 v72, 0, v28, s[56:57]
    v_cndmask_b32 v73, 0, v29, s[56:57]
    v_mfma_f32_16x16x16_bf16 v[24:27], a[250:251], v[70:71], v[24:27]
    v_cndmask_b32 v74, 0, v28, s[58:59]
    v_cndmask_b32 v75, 0, v29, s[58:59]
    v_mfma_f32_16x16x16_bf16 v[24:27], v[108:109], v[72:73], v[24:27]
    v_cndmask_b32 v76, 0, v28, s[60:61]
    v_cndmask_b32 v77, 0, v29, s[60:61]
    v_mfma_f32_16x16x16_bf16 v[24:27], v[110:111], v[74:75], v[24:27]
    v_cndmask_b32 v78, 0, v28, s[62:63]
    v_cndmask_b32 v79, 0, v29, s[62:63]
    v_mfma_f32_16x16x16_bf16 v[24:27], v[2:3], v[76:77], v[24:27]
    s_nop 0
    v_mfma_f32_16x16x16_bf16 v[24:27], v[4:5], v[78:79], v[24:27]
    s_mov_b32 exec_lo, 0x3ff03ff
    s_mov_b32 exec_hi, 0x3ff03ff
    s_cmp_eq_u32 s75, 1
    s_cbranch_scc0 SLOW22
    s_nop 3
    buffer_store_dwordx4 v[24:27], v84, s[16:19], s78 offen
BACK22:
    s_mov_b64 exec, -1
NEXT:
    s_cmp_lg_u32 s74, 0
    s_cbranch_scc1 DONE
    s_mov_b32 s74, 688128
    s_add_u32 s3, s3, 688128
    s_branch LOOP
DONE:
    s_endpgm
RDYLOOP:
    s_mov_b32 s76, 0
RDYL2:
    s_sleep 8
    global_load_dword v99, v98, s[64:65] sc1
    s_waitcnt vmcnt(0)
    v_sad_u8 v100, v99, 0, 0
    s_nop 1
    v_add_u32_dpp v100, v100, v100 quad_perm:[1,0,3,2] row_mask:0xf bank_mask:0xf
    s_nop 1
    v_add_u32_dpp v100, v100, v100 quad_perm:[2,3,0,1] row_mask:0xf bank_mask:0xf
    v_cmp_gt_u32 vcc, 32, v100
    s_mov_b32 vcc_hi, 0
    s_cmp_eq_u64 vcc, 0
    s_cbranch_scc1 RDYOK
    s_add_u32 s76, s76, 1
    s_cmp_lt_u32 s76, 32768
    s_cbranch_scc1 RDYL2
    s_branch RDYOK
SLOW1:
    buffer_store_dword v24, v10, s[16:19], s79 offen sc1
    s_branch BACK1
SLOW2:
    buffer_store_dword v24, v10, s[16:19], s3 offen sc1
    s_branch BACK2
SLOW3:
    buffer_store_dwordx4 v[28:31], v27, s[16:19], s77 offen sc1
    s_branch BACK3
DMAF:
    s_sub_u32 s77, s69, 20
    s_lshl_b32 s77, s77, 1
    s_and_b32 s78, s72, 1
    s_add_u32 s77, s77, s78
    s_mul_i32 s77, s77, 640
    v_add_u32 v36, s77, v0
    s_mul_i32 s78, s68, 384
    v_mul_u32_u24 v37, 43691, v36
    v_lshrrev_b32 v37, 20, v37
    v_mul_u32_u24 v37, 2688, v37
    v_lshl_add_u32 v37, v36, 4, v37
    buffer_load_dwordx4 a[240:243], v37, s[36:39], s78 offen
    v_add_u32 v36, 64, v36
    v_mul_u32_u24 v37, 43691, v36
    v_lshrrev_b32 v37, 20, v37
    v_mul_u32_u24 v37, 2688, v37
    v_lshl_add_u32 v37, v36, 4, v37
    buffer_load_dwordx4 a[240:243], v37, s[36:39], s78 offen
    v_add_u32 v36, 64, v36
    v_mul_u32_u24 v37, 43691, v36
    v_lshrrev_b32 v37, 20, v37
    v_mul_u32_u24 v37, 2688, v37
    v_lshl_add_u32 v37, v36, 4, v37
    buffer_load_dwordx4 a[240:243], v37, s[36:39], s78 offen
    v_add_u32 v36, 64, v36
    v_mul_u32_u24 v37, 43691, v36
    v_lshrrev_b32 v37, 20, v37
    v_mul_u32_u24 v37, 2688, v37
    v_lshl_add_u32 v37, v36, 4, v37
    buffer_load_dwordx4 a[240:243], v37, s[36:39], s78 offen
    v_add_u32 v36, 64, v36
    v_mul_u32_u24 v37, 43691, v36
    v_lshrrev_b32 v37, 20, v37
    v_mul_u32_u24 v37, 2688, v37
    v_lshl_add_u32 v37, v36, 4, v37
    buffer_load_dwordx4 a[240:243], v37, s[36:39], s78 offen
    v_add_u32 v36, 64, v36
    v_mul_u32_u24 v37, 43691, v36
    v_lshrrev_b32 v37, 20, v37
    v_mul_u32_u24 v37, 2688, v37
    v_lshl_add_u32 v37, v36, 4, v37
    buffer_load_dwordx4 a[240:243], v37, s[36:39], s78 offen
    v_add_u32 v36, 64, v36
    v_mul_u32_u24 v37, 43691, v36
    v_lshrrev_b32 v37, 20, v37
    v_mul_u32_u24 v37, 2688, v37
    v_lshl_add_u32 v37, v36, 4, v37
    buffer_load_dwordx4 a[240:243], v37, s[36:39], s78 offen
    v_add_u32 v36, 64, v36
    v_mul_u32_u24 v37, 43691, v36
    v_lshrrev_b32 v37, 20, v37
    v_mul_u32_u24 v37, 2688, v37
    v_lshl_add_u32 v37, v36, 4, v37
    buffer_load_dwordx4 a[240:243], v37, s[36:39], s78 offen
    v_add_u32 v36, 64, v36
    v_mul_u32_u24 v37, 43691, v36
    v_lshrrev_b32 v37, 20, v37
    v_mul_u32_u24 v37, 2688, v37
    v_lshl_add_u32 v37, v36, 4, v37
    buffer_load_dwordx4 a[240:243], v37, s[36:39], s78 offen
    v_add_u32 v36, 64, v36
    v_mul_u32_u24 v37, 43691, v36
    v_lshrrev_b32 v37, 20, v37
    v_mul_u32_u24 v37, 2688, v37
    v_lshl_add_u32 v37, v36, 4, v37
    buffer_load_dwordx4 a[240:243], v37, s[36:39], s78 offen
    s_branch DMAX
RETRY4:
    s_add_u32 s77, s3, 1376256
    s_add_u32 s78, s3, 1380352
    s_add_u32 s79, s3, 4096
    s_mov_b32 s76, 0
POLL23:
    buffer_load_dwordx4 v[64:67], v11, s[16:19], s77 offen sc1
    buffer_load_dwordx4 v[68:71], v11, s[16:19], s78 offen sc1
    buffer_load_dwordx4 v[72:75], v11, s[16:19], s3 offen sc1
    buffer_load_dwordx4 v[76:79], v11, s[16:19], s79 offen sc1
    s_add_u32 s76, s76, 1
    s_cmp_ge_u32 s76, 32768
    s_waitcnt vmcnt(0)
    v_max3_u32 v24, v64, v65, v66
    v_max3_u32 v24, v24, v67, v68
    v_max3_u32 v24, v24, v69, v70
    v_max3_u32 v24, v24, v71, v72
    v_max3_u32 v24, v24, v73, v74
    v_max3_u32 v24, v24, v75, v76
    v_max3_u32 v24, v24, v77, v78
    v_max_u32 v24, v24, v79
    v_cmp_eq_u32 vcc, -1, v24
    s_cbranch_scc1 POLLX23
    s_cbranch_vccnz POLL23
POLLX23:
    s_branch OK4
SLOW5:
    buffer_store_dwordx2 v[36:37], v14, s[16:19], s77 offen sc1
    s_branch BACK5
SLOW7:
    buffer_store_dword v24, v10, s[16:19], s3 offen sc1
    s_branch BACK7
SLOW9:
    buffer_store_dwordx2 v[36:37], v14, s[16:19], s77 offen sc1
    s_branch BACK9
RETRY10:
    s_mov_b32 s76, 0
POLL24:
    buffer_load_dwordx2 v[34:35], v14, s[16:19], s3 offen sc1
    s_add_u32 s76, s76, 1
    s_cmp_ge_u32 s76, 32768
    s_waitcnt vmcnt(0)
    v_max_u32 v36, v34, v35
    v_cmp_eq_u32 vcc, -1, v36
    s_cbranch_scc1 POLLX24
    s_cbranch_vccnz POLL24
POLLX24:
    s_branch OK10
SLOW11:
    buffer_store_dwordx4 v[28:31], v39, s[16:19], s77 offen sc1
    s_branch BACK11
RETRY12:
    s_mov_b32 s76, 0
POLL25:
    buffer_load_dword v28, v20, s[16:19], 0 offen sc1
    buffer_load_dword v29, v21, s[16:19], 0 offen sc1
    s_add_u32 s76, s76, 1
    s_cmp_ge_u32 s76, 32768
    s_waitcnt vmcnt(0)
    v_max_u32 v30, v28, v29
    v_cmp_eq_u32 vcc, -1, v30
    s_cbranch_scc1 POLLX25
    s_cbranch_vccnz POLL25
POLLX25:
    s_branch OK12
SLOW13:
    buffer_store_dwordx4 v[28:31], v37, s[16:19], s77 offen sc1
    s_branch BACK13
SLOW15:
    buffer_store_dwordx4 v[28:31], v39, s[16:19], s97 offen sc1
    s_branch BACK15
SLOW17:
    buffer_store_dwordx4 v[28:31], v39, s[16:19], s97 offen sc1
    s_branch BACK17
SLOW19:
    buffer_store_dwordx4 v[28:31], v37, s[16:19], s77 offen sc1
    s_branch BACK19
SLOW22:
    s_nop 3
    buffer_store_dwordx4 v[24:27], v84, s[16:19], s78 offen sc1
    s_branch BACK22
FCS:
    s_waitcnt lgkmcnt(0)
    v_add_f32 v32, v32, v33
    v_add_f32 v34, v34, v35
    v_add_f32 v32, v32, v34
    v_add_f32 v36, v36, v37
    v_add_f32 v38, v38, v39
    v_add_f32 v36, v36, v38
    v_mul_f32 v22, 0x3acccccd, v32
    v_mul_f32 v23, 0x3acccccd, v36
    s_mov_b32 s4, 1
    s_barrier
    s_branch FPOLL
CODE_END:
    s_endpgm
.section .rodata,"a"
.p2align 6
.amdhsa_kernel interleave_layers__sliding_block_cached__glu_gated_swiglu__decode_kernel
  .amdhsa_next_free_vgpr 512
  .amdhsa_next_free_sgpr 102
  .amdhsa_accum_offset 256
  .amdhsa_group_segment_fixed_size 0
  .amdhsa_kernarg_size 96
  .amdhsa_user_sgpr_count 2
  .amdhsa_user_sgpr_kernarg_segment_ptr 1
  .amdhsa_system_sgpr_workgroup_id_x 1
.end_amdhsa_kernel
```

```asm
; @launch grid=(256,1,1) block=(256,1,1) lds=125504
.amdgcn_target "amdgcn-amd-amdhsa--gfx950"
.text
.globl interleave_layers__sliding_block_cached__glu_gated_swiglu__decode_kernel
.p2align 8
.type interleave_layers__sliding_block_cached__glu_gated_swiglu__decode_kernel,@function
interleave_layers__sliding_block_cached__glu_gated_swiglu__decode_kernel:
    s_cmp_ge_u32 s2, 256
    s_cbranch_scc1 CODE_END
    s_load_dwordx16 s[44:59], s[0:1], 0
    s_load_dwordx8 s[60:67], s[0:1], 64
    v_lshrrev_b32 v2, 6, v0
    v_and_b32 v24, 63, v0
    v_readfirstlane_b32 s72, v2
    s_and_b32 s68, s2, 7
    s_lshr_b32 s69, s2, 3
    s_lshr_b32 s70, s69, 3
    s_and_b32 s71, s69, 7
    v_lshlrev_b32 v1, 4, v24
    s_lshl_b32 s77, s70, 3
    s_add_u32 s77, s77, s68
    s_mul_i32 s73, s77, 12582912
    s_lshl_b32 s78, s71, 2
    s_add_u32 s78, s78, s72
    s_mul_i32 s78, s78, 6144
    s_add_u32 s73, s73, s78
    s_add_u32 s73, s73, 11010048
    s_mul_i32 s79, s77, 384
    s_mov_b32 s74, 0
    s_mul_i32 s3, s68, 81920
    s_mov_b32 s75, 0
    v_mov_b32 v32, -1
    v_mov_b32 v33, -1
    v_mov_b32 v34, -1
    v_mov_b32 v35, -1
    s_mul_i32 s77, s69, 2560
    s_add_u32 s77, s77, s3
    v_lshl_add_u32 v20, v0, 4, s77
    v_cmp_le_u32 vcc, 160, v0
    v_add_u32 v25, 685568, v20
    s_nop 0
    v_cndmask_b32 v20, v20, v25, vcc
    s_add_u32 s77, s77, 689664
    s_lshl_b32 s78, s69, 10
    s_add_u32 s78, s78, s3
    s_add_u32 s78, s78, 1376256
    s_cmp_eq_u32 s72, 0
    s_cselect_b32 s4, s77, s78
    s_mul_i32 s77, s2, 80
    s_add_u32 s77, s77, 655360
    s_cmp_ge_u32 s72, 2
    s_cselect_b32 s4, s77, s4
    v_add_u32 v25, 688048, v1
    v_cmp_le_u32 vcc, 133, v0
    s_nop 1
    v_cndmask_b32 v21, v1, v25, vcc
    v_mov_b32 v25, 1879048176
    v_cmp_le_u32 vcc, 138, v0
    s_nop 1
    v_cndmask_b32 v21, v21, v25, vcc
    s_waitcnt lgkmcnt(0)
    s_mov_b32 s8, s46
    s_and_b32 s9, s47, 0xffff
    s_mov_b32 s10, 402653184
    s_mov_b32 s11, 0x20000
    s_add_u32 s6, s73, 0
    buffer_load_dwordx4 a[0:3], v1, s[8:11], s6 offen offset:0 nt
    buffer_load_dwordx4 a[4:7], v1, s[8:11], s6 offen offset:1024 nt
    buffer_load_dwordx4 a[8:11], v1, s[8:11], s6 offen offset:2048 nt
    buffer_load_dwordx4 a[12:15], v1, s[8:11], s6 offen offset:3072 nt
    s_add_u32 s6, s6, 4096
    buffer_load_dwordx4 a[16:19], v1, s[8:11], s6 offen offset:0 nt
    buffer_load_dwordx4 a[20:23], v1, s[8:11], s6 offen offset:1024 nt
    s_mov_b32 s16, s66
    s_and_b32 s17, s67, 0xffff
    s_mov_b32 s18, 1610612736
    s_mov_b32 s19, 0x20000
    buffer_store_dwordx4 v[32:35], v20, s[16:19], 0 offen sc1
    buffer_store_dwordx4 v[32:35], v21, s[16:19], s4 offen sc1
    s_getpc_b64 s[100:101]
PCREF:
    s_sub_u32 s100, s100, PCREF-interleave_layers__sliding_block_cached__glu_gated_swiglu__decode_kernel
    s_subb_u32 s101, s101, 0
    s_and_b32 s77, s69, 7
    s_lshl_b32 s77, s77, 12
    v_lshl_add_u32 v25, v0, 4, s77
    v_cmp_gt_u32 vcc, CODE_END-interleave_layers__sliding_block_cached__glu_gated_swiglu__decode_kernel-16, v25
    s_nop 0
    s_and_saveexec_b64 s[98:99], vcc
    s_cbranch_execz NOCPF
    global_load_dwordx4 a[240:243], v25, s[100:101]
NOCPF:
    s_mov_b64 exec, -1
    s_add_u32 s6, s73, 196608
    buffer_load_dwordx4 a[24:27], v1, s[8:11], s6 offen offset:0 nt
    buffer_load_dwordx4 a[28:31], v1, s[8:11], s6 offen offset:1024 nt
    buffer_load_dwordx4 a[32:35], v1, s[8:11], s6 offen offset:2048 nt
    buffer_load_dwordx4 a[36:39], v1, s[8:11], s6 offen offset:3072 nt
    s_add_u32 s6, s6, 4096
    buffer_load_dwordx4 a[40:43], v1, s[8:11], s6 offen offset:0 nt
    buffer_load_dwordx4 a[44:47], v1, s[8:11], s6 offen offset:1024 nt
    s_mov_b32 s12, s48
    s_and_b32 s13, s49, 0xffff
    s_mov_b32 s14, 402653184
    s_mov_b32 s15, 0x20000
    s_mov_b32 s20, s50
    s_and_b32 s21, s51, 0xffff
    s_mov_b32 s22, 7864320
    s_mov_b32 s23, 0x20000
    s_mov_b32 s36, s44
    s_and_b32 s37, s45, 0xffff
    s_mov_b32 s38, 1280
    s_mov_b32 s39, 0x20000
    s_mov_b32 s40, s62
    s_and_b32 s41, s63, 0xffff
    s_mov_b32 s42, 1280
    s_mov_b32 s43, 0x20000
    s_mov_b32 s28, s58
    s_and_b32 s29, s59, 0xffff
    s_mov_b32 s30, 1966080
    s_mov_b32 s31, 0x20000
    s_mov_b32 s32, s60
    s_and_b32 s33, s61, 0xffff
    s_mov_b32 s34, 1966080
    s_mov_b32 s35, 0x20000
    s_cmp_lt_u32 s69, 20
    s_cselect_b32 s24, s52, s56
    s_cselect_b32 s25, s53, s57
    s_cselect_b32 s26, s22, s30
    s_and_b32 s25, s25, 0xffff
    s_mov_b32 s27, 0x20000
    s_waitcnt vmcnt(6)
    s_barrier
    s_getreg_b32 s5, hwreg(HW_REG_XCC_ID, 0, 4)
    s_lshr_b32 s77, s5, 2
    s_lshl_b32 s78, s68, 2
    s_add_u32 s77, s77, s78
    s_and_b32 s78, s5, 3
    s_lshl_b32 s78, s78, 3
    s_lshl_b32 s7, 1, s78
    s_lshl_b32 s96, 32, s78
    s_mov_b32 s5, s77
    s_cmp_lg_u32 s72, 0
    s_cbranch_scc1 NOATOM
    s_lshl_b32 s77, s77, 2
    v_mov_b32 v36, s77
    v_mov_b32 v37, s7
    s_mov_b64 exec, 1
    global_atomic_add v36, v37, s[64:65] sc1
    s_mov_b64 exec, -1
NOATOM:
    v_mov_b32 v0, v24
    s_mul_i32 s77, s72, 6656
    v_add_u32 v25, 0, v0
    v_mul_u32_u24 v26, 171, v25
    v_lshrrev_b32 v26, 12, v26
    v_mul_u32_u24 v27, 24, v26
    v_sub_u32 v27, v25, v27
    v_lshlrev_b32 v27, 4, v27
    v_mul_u32_u24 v25, 416, v26
    v_add3_u32 v2, v25, v27, s77
    v_mul_u32_u24 v25, 12288, v26
    v_add_u32 v40, v25, v27
    v_add_u32 v25, 64, v0
    v_mul_u32_u24 v26, 171, v25
    v_lshrrev_b32 v26, 12, v26
    v_mul_u32_u24 v27, 24, v26
    v_sub_u32 v27, v25, v27
    v_lshlrev_b32 v27, 4, v27
    v_mul_u32_u24 v25, 416, v26
    v_add3_u32 v3, v25, v27, s77
    v_mul_u32_u24 v25, 12288, v26
    v_add_u32 v41, v25, v27
    v_add_u32 v25, 128, v0
    v_mul_u32_u24 v26, 171, v25
    v_lshrrev_b32 v26, 12, v26
    v_mul_u32_u24 v27, 24, v26
    v_sub_u32 v27, v25, v27
    v_lshlrev_b32 v27, 4, v27
    v_mul_u32_u24 v25, 416, v26
    v_add3_u32 v4, v25, v27, s77
    v_mul_u32_u24 v25, 12288, v26
    v_add_u32 v42, v25, v27
    s_mul_i32 s78, s71, 983040
    s_add_u32 s79, s79, s78
    s_mul_i32 s78, s72, 98304
    s_add_u32 s79, s79, s78
    s_mul_i32 s78, s72, 3072
    s_add_u32 s78, s78, 26624
    s_add_u32 m0, s78, 0
    s_nop 0
    buffer_load_dwordx4 v40, s[20:23], s79 offen nt lds
    s_add_u32 m0, s78, 1024
    s_nop 0
    buffer_load_dwordx4 v41, s[20:23], s79 offen nt lds
    s_add_u32 m0, s78, 2048
    s_nop 0
    buffer_load_dwordx4 v42, s[20:23], s79 offen nt lds
    s_add_u32 s79, s79, 393216
    s_add_u32 m0, s78, 12288
    s_nop 0
    buffer_load_dwordx4 v40, s[20:23], s79 offen nt lds
    s_add_u32 m0, s78, 13312
    s_nop 0
    buffer_load_dwordx4 v41, s[20:23], s79 offen nt lds
    s_add_u32 m0, s78, 14336
    s_nop 0
    buffer_load_dwordx4 v42, s[20:23], s79 offen nt lds
    s_add_u32 s79, s79, 393216
    s_cmp_ge_u32 s72, 2
    s_cbranch_scc1 NOWQ3
    s_add_u32 m0, s78, 24576
    s_nop 0
    buffer_load_dwordx4 v40, s[20:23], s79 offen nt lds
    s_add_u32 m0, s78, 25600
    s_nop 0
    buffer_load_dwordx4 v41, s[20:23], s79 offen nt lds
    s_add_u32 m0, s78, 26624
    s_nop 0
    buffer_load_dwordx4 v42, s[20:23], s79 offen nt lds
NOWQ3:
    v_and_b32 v25, 15, v0
    v_lshrrev_b32 v26, 4, v0
    v_bfe_u32 v27, v0, 2, 2
    v_and_b32 v28, 3, v0
    v_cmp_eq_u32 vcc, 12, v25
    v_mov_b32 v36, 0x3f803f80
    s_nop 0
    v_cndmask_b32 v70, 0, v36, vcc
    v_mov_b32 v71, v70
    v_mov_b32 v72, v70
    v_mov_b32 v73, v70
    v_mov_b32 v74, v70
    v_mov_b32 v75, v70
    v_mov_b32 v76, v70
    v_mov_b32 v77, v70
    v_mov_b32 v78, v70
    v_mov_b32 v79, v70
    v_mov_b32 v88, v70
    v_mov_b32 v89, v70
    v_mov_b32 v90, v70
    v_mov_b32 v91, v70
    v_mov_b32 v92, v70
    v_mov_b32 v93, v70
    v_mov_b32 v94, v70
    v_mov_b32 v95, v70
    v_mov_b32 v96, v70
    v_mov_b32 v97, v70
    s_mul_i32 s78, s71, 160
    v_lshlrev_b32 v36, 4, v26
    v_lshlrev_b32 v37, 3, v26
    s_mov_b32 exec_lo, 0x1000100
    s_mov_b32 exec_hi, 0x1000100
    buffer_load_dwordx4 v[88:91], v36, s[36:39], s78 offen
    buffer_load_dwordx4 v[92:95], v36, s[36:39], s78 offen offset:64
    buffer_load_dwordx2 v[96:97], v37, s[36:39], s78 offen offset:128
    s_mov_b64 exec, -1
    s_lshl_b32 s79, s69, 6
    v_lshlrev_b32 v38, 2, v25
    buffer_load_dword v22, v38, s[36:39], s79 offen
    s_mov_b32 s20, s52
    s_and_b32 s21, s53, 0xffff
    s_mov_b32 s22, 7864320
    s_mov_b32 s23, 0x20000
    s_cmp_lt_u32 s72, 2
    s_cselect_b32 s36, s56, s58
    s_cselect_b32 s37, s57, s59
    s_and_b32 s37, s37, 0xffff
    s_mov_b32 s38, 1966080
    s_add_u32 s6, s73, 393216
    buffer_load_dwordx4 a[48:51], v1, s[8:11], s6 offen offset:0 nt
    buffer_load_dwordx4 a[52:55], v1, s[8:11], s6 offen offset:1024 nt
    buffer_load_dwordx4 a[56:59], v1, s[8:11], s6 offen offset:2048 nt
    buffer_load_dwordx4 a[60:63], v1, s[8:11], s6 offen offset:3072 nt
    s_add_u32 s6, s6, 4096
    buffer_load_dwordx4 a[64:67], v1, s[8:11], s6 offen offset:0 nt
    buffer_load_dwordx4 a[68:71], v1, s[8:11], s6 offen offset:1024 nt
    v_mul_u32_u24 v29, 416, v25
    v_lshl_add_u32 v29, v26, 4, v29
    v_add_u32 v5, s77, v29
    v_lshrrev_b32 v29, 2, v0
    v_mul_u32_u24 v29, 416, v29
    v_lshl_add_u32 v29, v28, 3, v29
    v_add_u32 v6, s77, v29
    s_mul_i32 s79, s72, 96
    s_add_u32 s79, s79, 26624
    v_lshl_add_u32 v29, v26, 3, v27
    v_mul_u32_u24 v29, 384, v29
    v_lshl_add_u32 v29, v28, 3, v29
    v_add_u32 v16, s79, v29
    v_lshl_add_u32 v29, v26, 2, v27
    v_mul_u32_u24 v29, 384, v29
    v_lshl_add_u32 v29, v28, 3, v29
    v_add_u32 v17, s79, v29
    v_mul_u32_u24 v31, 103, v0
    v_lshrrev_b32 v31, 10, v31
    v_mul_u32_u24 v30, 10, v31
    v_sub_u32 v30, v0, v30
    v_lshl_add_u32 v29, v30, 4, s78
    v_mul_u32_u24 v8, 1280, v31
    v_add_u32 v8, 665600, v8
    s_mul_i32 s7, s68, 81920
    s_add_u32 s7, s7, 78080
    v_mov_b32 v30, s7
    v_cmp_eq_u32 vcc, s68, v31
    s_nop 1
    v_cndmask_b32 v8, v8, v30, vcc
    v_add_u32 v30, 2560, v30
    v_cmp_le_u32 vcc, 8, v31
    s_nop 1
    v_cndmask_b32 v8, v8, v30, vcc
    v_add_u32 v8, v8, v29
    v_add_u32 v31, 6, v31
    v_mul_u32_u24 v9, 1280, v31
    v_add_u32 v9, 665600, v9
    s_mul_i32 s7, s68, 81920
    s_add_u32 s7, s7, 78080
    v_mov_b32 v30, s7
    v_cmp_eq_u32 vcc, s68, v31
    s_nop 1
    v_cndmask_b32 v9, v9, v30, vcc
    v_add_u32 v30, 2560, v30
    v_cmp_le_u32 vcc, 8, v31
    s_nop 1
    v_cndmask_b32 v9, v9, v30, vcc
    v_add_u32 v9, v9, v29
    v_mov_b32 v30, 2147483632
    v_cmp_le_u32 vcc, 30, v0
    s_nop 1
    v_cndmask_b32 v9, v9, v30, vcc
    s_lshl_b32 s78, s69, 10
    s_lshl_b32 s79, s72, 8
    s_add_u32 s78, s78, s79
    v_lshl_add_u32 v10, v0, 2, s78
    s_lshl_b32 s78, s70, 13
    s_add_u32 s78, s78, s79
    v_lshlrev_b32 v29, 10, v26
    v_lshl_add_u32 v29, v25, 4, v29
    v_add_u32 v11, s78, v29
    s_mul_i32 s78, s72, 96
    s_add_u32 s78, s78, 118784
    v_lshl_add_u32 v29, v27, 5, s78
    v_lshl_add_u32 v29, v28, 2, v29
    v_lshrrev_b32 v30, 1, v26
    v_lshl_add_u32 v29, v30, 4, v29
    v_and_b32 v30, 1, v26
    v_lshl_add_u32 v29, v30, 1, v29
    v_mov_b32 v30, 119168
    v_cmp_le_u32 vcc, 12, v25
    s_nop 1
    v_cndmask_b32 v12, v29, v30, vcc
    v_and_b32 v30, 1, v0
    v_lshlrev_b32 v29, 5, v26
    v_lshl_add_u32 v29, v30, 4, v29
    v_add_u32 v13, 118784, v29
    v_mul_u32_u24 v30, 0xaaaa, v30
    v_and_b32 v29, 1, v27
    v_mul_u32_u24 v29, 0xaaaa, v29
    v_lshl_or_b32 v29, v29, 16, v30
    v_add_u32 v14, 0x44444444, v29
    s_lshl_b32 s78, s72, 8
    s_add_u32 s78, s78, 124416
    v_lshrrev_b32 v29, 5, v0
    v_lshl_add_u32 v29, v29, 6, s78
    v_bfe_u32 v30, v0, 3, 1
    v_lshl_add_u32 v29, v30, 5, v29
    v_bfe_u32 v30, v0, 1, 1
    v_lshl_add_u32 v29, v30, 4, v29
    v_bfe_u32 v30, v0, 2, 1
    v_lshl_add_u32 v29, v30, 3, v29
    v_bfe_u32 v30, v0, 4, 1
    v_lshl_add_u32 v29, v30, 2, v29
    v_bfe_u32 v30, v0, 0, 1
    v_lshl_add_u32 v29, v30, 1, v29
    v_mov_b32 v19, v29
    s_mul_i32 s78, s72, 768
    s_add_u32 s78, s78, 119296
    v_lshl_add_u32 v29, v25, 2, s78
    v_bfe_u32 v30, v0, 4, 1
    v_lshl_add_u32 v29, v30, 7, v29
    v_lshrrev_b32 v30, 5, v0
    v_lshl_add_u32 v15, v30, 6, v29
    s_mov_b32 s44, 0x10001
    s_mov_b32 s45, 0x10001
    s_mov_b32 s46, 0x20002
    s_mov_b32 s47, 0x20002
    s_mov_b32 s48, 0x40004
    s_mov_b32 s49, 0x40004
    s_mov_b32 s50, 0x80008
    s_mov_b32 s51, 0x80008
    s_mov_b32 s52, 0x100010
    s_mov_b32 s53, 0x100010
    s_mov_b32 s54, 0x200020
    s_mov_b32 s55, 0x200020
    s_mov_b32 s56, 0x400040
    s_mov_b32 s57, 0x400040
    s_mov_b32 s58, 0x800080
    s_mov_b32 s59, 0x800080
    s_mov_b32 s60, 0x1000100
    s_mov_b32 s61, 0x1000100
    s_mov_b32 s62, 0x2000200
    s_mov_b32 s63, 0x2000200
    ds_write_b128 v2, a[0:3] offset:0
    ds_write_b128 v3, a[4:7] offset:0
    ds_write_b128 v4, a[8:11] offset:0
    ds_write_b128 v2, a[12:15] offset:3328
    ds_write_b128 v3, a[16:19] offset:3328
    ds_write_b128 v4, a[20:23] offset:3328
    ds_read_b128 a[0:3], v5 offset:0
    ds_read_b128 a[4:7], v5 offset:64
    ds_read_b128 a[8:11], v5 offset:128
    ds_read_b128 a[12:15], v5 offset:192
    ds_read_b128 a[16:19], v5 offset:256
    ds_read_b128 a[20:23], v5 offset:320
    s_add_u32 s6, s73, 589824
    buffer_load_dwordx4 a[72:75], v1, s[8:11], s6 offen offset:0 nt
    buffer_load_dwordx4 a[76:79], v1, s[8:11], s6 offen offset:1024 nt
    buffer_load_dwordx4 a[80:83], v1, s[8:11], s6 offen offset:2048 nt
    buffer_load_dwordx4 a[84:87], v1, s[8:11], s6 offen offset:3072 nt
    s_add_u32 s6, s6, 4096
    buffer_load_dwordx4 a[88:91], v1, s[8:11], s6 offen offset:0 nt
    buffer_load_dwordx4 a[92:95], v1, s[8:11], s6 offen offset:1024 nt
    s_waitcnt vmcnt(22)
    ds_write_b128 v2, a[24:27] offset:0
    ds_write_b128 v3, a[28:31] offset:0
    ds_write_b128 v4, a[32:35] offset:0
    ds_write_b128 v2, a[36:39] offset:3328
    ds_write_b128 v3, a[40:43] offset:3328
    ds_write_b128 v4, a[44:47] offset:3328
    ds_read_b128 a[24:27], v5 offset:0
    ds_read_b128 a[28:31], v5 offset:64
    ds_read_b128 a[32:35], v5 offset:128
    ds_read_b128 a[36:39], v5 offset:192
    ds_read_b128 a[40:43], v5 offset:256
    ds_read_b128 a[44:47], v5 offset:320
    s_lshl_b32 s77, s70, 3
    s_add_u32 s77, s77, s68
    s_lshl_b32 s77, s77, 3
    s_add_u32 s77, s77, s71
    s_lshl_b32 s77, s77, 2
    s_add_u32 s77, s77, s72
    s_mul_i32 s77, s77, 7680
    buffer_load_dwordx4 a[240:243], v1, s[20:23], s77 offen offset:0
    buffer_load_dwordx4 a[240:243], v1, s[20:23], s77 offen offset:1024
    buffer_load_dwordx4 a[240:243], v1, s[20:23], s77 offen offset:2048
    buffer_load_dwordx4 a[240:243], v1, s[20:23], s77 offen offset:3072
    s_add_u32 s77, s77, 4096
    buffer_load_dwordx4 a[240:243], v1, s[20:23], s77 offen offset:0
    buffer_load_dwordx4 a[240:243], v1, s[20:23], s77 offen offset:1024
    buffer_load_dwordx4 a[240:243], v1, s[20:23], s77 offen offset:2048
    s_mov_b32 exec_lo, 0xffffffff
    s_mov_b32 exec_hi, 0x0
    buffer_load_dwordx4 a[240:243], v1, s[20:23], s77 offen offset:3072
    s_mov_b64 exec, -1
    s_waitcnt vmcnt(14)
    ds_write_b128 v2, a[48:51] offset:0
    ds_write_b128 v3, a[52:55] offset:0
    ds_write_b128 v4, a[56:59] offset:0
    ds_write_b128 v2, a[60:63] offset:3328
    ds_write_b128 v3, a[64:67] offset:3328
    ds_write_b128 v4, a[68:71] offset:3328
    ds_read_b128 a[48:51], v5 offset:0
    ds_read_b128 a[52:55], v5 offset:64
    ds_read_b128 a[56:59], v5 offset:128
    ds_read_b128 a[60:63], v5 offset:192
    ds_read_b128 a[64:67], v5 offset:256
    ds_read_b128 a[68:71], v5 offset:320
    s_waitcnt lgkmcnt(0)
    s_barrier
    ds_read_b64_tr_b16 v[40:41], v16 offset:0
    ds_read_b64_tr_b16 v[42:43], v16 offset:1536
    ds_read_b64_tr_b16 v[44:45], v16 offset:12288
    ds_read_b64_tr_b16 v[46:47], v16 offset:13824
    ds_read_b64_tr_b16 v[48:49], v17 offset:24576
    ds_read_b64_tr_b16 v[50:51], v16 offset:32
    ds_read_b64_tr_b16 v[52:53], v16 offset:1568
    ds_read_b64_tr_b16 v[54:55], v16 offset:12320
    ds_read_b64_tr_b16 v[56:57], v16 offset:13856
    ds_read_b64_tr_b16 v[58:59], v17 offset:24608
    ds_read_b64_tr_b16 v[60:61], v16 offset:64
    ds_read_b64_tr_b16 v[62:63], v16 offset:1600
    ds_read_b64_tr_b16 v[64:65], v16 offset:12352
    ds_read_b64_tr_b16 v[66:67], v16 offset:13888
    ds_read_b64_tr_b16 v[68:69], v17 offset:24640
    s_add_u32 s6, s73, 786432
    buffer_load_dwordx4 a[96:99], v1, s[8:11], s6 offen offset:0 nt
    buffer_load_dwordx4 a[100:103], v1, s[8:11], s6 offen offset:1024 nt
    buffer_load_dwordx4 a[104:107], v1, s[8:11], s6 offen offset:2048 nt
    buffer_load_dwordx4 a[108:111], v1, s[8:11], s6 offen offset:3072 nt
    s_add_u32 s6, s6, 4096
    buffer_load_dwordx4 a[112:115], v1, s[8:11], s6 offen offset:0 nt
    buffer_load_dwordx4 a[116:119], v1, s[8:11], s6 offen offset:1024 nt
    s_add_u32 s6, s73, 983040
    buffer_load_dwordx4 a[120:123], v1, s[8:11], s6 offen offset:0 nt
    buffer_load_dwordx4 a[124:127], v1, s[8:11], s6 offen offset:1024 nt
    buffer_load_dwordx4 a[128:131], v1, s[8:11], s6 offen offset:2048 nt
    buffer_load_dwordx4 a[132:135], v1, s[8:11], s6 offen offset:3072 nt
    s_add_u32 s6, s6, 4096
    buffer_load_dwordx4 a[136:139], v1, s[8:11], s6 offen offset:0 nt
    buffer_load_dwordx4 a[140:143], v1, s[8:11], s6 offen offset:1024 nt
    s_waitcnt vmcnt(20)
    ds_write_b128 v2, a[72:75] offset:0
    ds_write_b128 v3, a[76:79] offset:0
    ds_write_b128 v4, a[80:83] offset:0
    ds_write_b128 v2, a[84:87] offset:3328
    ds_write_b128 v3, a[88:91] offset:3328
    ds_write_b128 v4, a[92:95] offset:3328
    ds_read_b128 a[72:75], v5 offset:0
    ds_read_b128 a[76:79], v5 offset:64
    ds_read_b128 a[80:83], v5 offset:128
    ds_read_b128 a[84:87], v5 offset:192
    ds_read_b128 a[88:91], v5 offset:256
    ds_read_b128 a[92:95], v5 offset:320
    v_lshlrev_b32 v98, 2, v0
    global_load_dword v99, v98, s[64:65] sc1
    s_add_u32 s6, s73, 1179648
    buffer_load_dwordx4 a[144:147], v1, s[8:11], s6 offen offset:0 nt
    buffer_load_dwordx4 a[148:151], v1, s[8:11], s6 offen offset:1024 nt
    buffer_load_dwordx4 a[152:155], v1, s[8:11], s6 offen offset:2048 nt
    buffer_load_dwordx4 a[156:159], v1, s[8:11], s6 offen offset:3072 nt
    s_add_u32 s6, s6, 4096
    buffer_load_dwordx4 a[160:163], v1, s[8:11], s6 offen offset:0 nt
    buffer_load_dwordx4 a[164:167], v1, s[8:11], s6 offen offset:1024 nt
    s_waitcnt vmcnt(13)
    ds_write_b128 v2, a[96:99] offset:0
    ds_write_b128 v3, a[100:103] offset:0
    ds_write_b128 v4, a[104:107] offset:0
    ds_write_b128 v2, a[108:111] offset:3328
    ds_write_b128 v3, a[112:115] offset:3328
    ds_write_b128 v4, a[116:119] offset:3328
    ds_read_b128 a[96:99], v5 offset:0
    ds_read_b128 a[100:103], v5 offset:64
    ds_read_b128 a[104:107], v5 offset:128
    ds_read_b128 a[108:111], v5 offset:192
    ds_read_b128 a[112:115], v5 offset:256
    ds_read_b128 a[116:119], v5 offset:320
    s_add_u32 s6, s73, 1376256
    buffer_load_dwordx4 a[168:171], v1, s[8:11], s6 offen offset:0 nt
    buffer_load_dwordx4 a[172:175], v1, s[8:11], s6 offen offset:1024 nt
    buffer_load_dwordx4 a[176:179], v1, s[8:11], s6 offen offset:2048 nt
    buffer_load_dwordx4 a[180:183], v1, s[8:11], s6 offen offset:3072 nt
    s_add_u32 s6, s6, 4096
    buffer_load_dwordx4 a[184:187], v1, s[8:11], s6 offen offset:0 nt
    buffer_load_dwordx4 a[188:191], v1, s[8:11], s6 offen offset:1024 nt
    s_waitcnt vmcnt(13)
    ds_write_b128 v2, a[120:123] offset:0
    ds_write_b128 v3, a[124:127] offset:0
    ds_write_b128 v4, a[128:131] offset:0
    ds_write_b128 v2, a[132:135] offset:3328
    ds_write_b128 v3, a[136:139] offset:3328
    ds_write_b128 v4, a[140:143] offset:3328
    ds_read_b128 a[120:123], v5 offset:0
    ds_read_b128 a[124:127], v5 offset:64
    ds_read_b128 a[128:131], v5 offset:128
    ds_read_b128 a[132:135], v5 offset:192
    ds_read_b128 a[136:139], v5 offset:256
    ds_read_b128 a[140:143], v5 offset:320
    s_waitcnt vmcnt(12)
    v_sad_u8 v100, v99, 0, 0
    s_nop 1
    v_add_u32_dpp v100, v100, v100 quad_perm:[1,0,3,2] row_mask:0xf bank_mask:0xf
    s_nop 1
    v_add_u32_dpp v100, v100, v100 quad_perm:[2,3,0,1] row_mask:0xf bank_mask:0xf
    v_cmp_gt_u32 vcc, 32, v100
    s_mov_b32 vcc_hi, 0
    s_cmp_eq_u64 vcc, 0
    s_cbranch_scc0 RDYLOOP
RDYOK:
    v_readlane_b32 s77, v99, s5
    s_nop 0
    s_cmp_eq_u32 s77, s96
    s_cselect_b32 s75, 1, 0
    buffer_load_dwordx4 a[240:243], v20, s[16:19], 0 offen sc1
    buffer_load_dwordx4 a[240:243], v21, s[16:19], s4 offen sc1
    s_waitcnt lgkmcnt(0)
    s_add_u32 s79, s3, 1376256
    v_mfma_f32_16x16x32_bf16 v[24:27], v[70:73], v[40:43], 0
    v_mfma_f32_16x16x32_bf16 v[32:35], v[70:73], v[60:63], 0
    v_mfma_f32_16x16x32_bf16 v[24:27], v[74:77], v[44:47], v[24:27]
    v_mfma_f32_16x16x32_bf16 v[32:35], v[74:77], v[64:67], v[32:35]
    v_mfma_f32_16x16x16_bf16 v[24:27], v[78:79], v[48:49], v[24:27]
    v_mfma_f32_16x16x16_bf16 v[32:35], v[78:79], v[68:69], v[32:35]
    v_mfma_f32_16x16x32_bf16 v[28:31], v[70:73], v[50:53], 0
    v_mfma_f32_16x16x32_bf16 v[36:39], v[70:73], v[70:73], 0
    v_mfma_f32_16x16x32_bf16 v[28:31], v[74:77], v[54:57], v[28:31]
    v_mfma_f32_16x16x32_bf16 v[36:39], v[74:77], v[74:77], v[36:39]
    v_mfma_f32_16x16x16_bf16 v[28:31], v[78:79], v[58:59], v[28:31]
    v_mfma_f32_16x16x16_bf16 v[36:39], v[78:79], v[78:79], v[36:39]
    s_nop 0
    v_add_f32 v24, v24, v25
    v_add_f32 v26, v26, v27
    v_add_f32 v24, v24, v26
    v_add_f32 v32, v32, v33
    v_add_f32 v34, v34, v35
    v_add_f32 v32, v32, v34
    s_nop 1
    v_permlane32_swap_b32 v24, v32
    v_add_f32 v28, v28, v29
    v_add_f32 v30, v30, v31
    v_add_f32 v36, v36, v37
    v_add_f32 v38, v38, v39
    v_add_f32 v24, v24, v32
    v_add_f32 v28, v28, v30
    v_add_f32 v36, v36, v38
    s_nop 1
    v_permlane32_swap_b32 v28, v36
    v_add_f32 v28, v28, v36
    s_nop 1
    v_permlane16_swap_b32 v24, v28
    v_add_f32 v24, v24, v28
    s_cmp_eq_u32 s75, 1
    s_cbranch_scc0 SLOW1
    buffer_store_dword v24, v10, s[16:19], s79 offen
BACK1:
    v_mfma_f32_16x16x32_bf16 v[24:27], v[88:91], v[40:43], 0
    v_mfma_f32_16x16x32_bf16 v[32:35], v[88:91], v[60:63], 0
    v_mfma_f32_16x16x32_bf16 v[24:27], v[92:95], v[44:47], v[24:27]
    v_mfma_f32_16x16x32_bf16 v[32:35], v[92:95], v[64:67], v[32:35]
    v_mfma_f32_16x16x16_bf16 v[24:27], v[96:97], v[48:49], v[24:27]
    v_mfma_f32_16x16x16_bf16 v[32:35], v[96:97], v[68:69], v[32:35]
    v_mfma_f32_16x16x32_bf16 v[28:31], v[88:91], v[50:53], 0
    v_mfma_f32_16x16x32_bf16 v[36:39], v[88:91], v[88:91], 0
    v_mfma_f32_16x16x32_bf16 v[28:31], v[92:95], v[54:57], v[28:31]
    v_mfma_f32_16x16x32_bf16 v[36:39], v[92:95], v[92:95], v[36:39]
    v_mfma_f32_16x16x16_bf16 v[28:31], v[96:97], v[58:59], v[28:31]
    v_mfma_f32_16x16x16_bf16 v[36:39], v[96:97], v[96:97], v[36:39]
    s_nop 0
    v_add_f32 v24, v24, v25
    v_add_f32 v26, v26, v27
    v_add_f32 v24, v24, v26
    v_add_f32 v32, v32, v33
    v_add_f32 v34, v34, v35
    v_add_f32 v32, v32, v34
    s_nop 1
    v_permlane32_swap_b32 v24, v32
    v_add_f32 v28, v28, v29
    v_add_f32 v30, v30, v31
    v_add_f32 v36, v36, v37
    v_add_f32 v38, v38, v39
    v_add_f32 v24, v24, v32
    v_add_f32 v28, v28, v30
    v_add_f32 v36, v36, v38
    s_nop 1
    v_permlane32_swap_b32 v28, v36
    v_add_f32 v28, v28, v36
    s_nop 1
    v_permlane16_swap_b32 v24, v28
    v_add_f32 v24, v24, v28
    s_cmp_eq_u32 s75, 1
    s_cbranch_scc0 SLOW2
    buffer_store_dword v24, v10, s[16:19], s3 offen
BACK2:
    s_cmp_lg_u32 s72, 1
    s_cbranch_scc1 NOBASE0
    s_cmp_ge_u32 s69, 20
    s_cbranch_scc1 NOBASE0
    v_mov_b32 v28, v22
    s_lshl_b32 s77, s69, 6
    s_add_u32 s77, s77, s3
    s_add_u32 s77, s77, 79360
    v_lshlrev_b32 v27, 2, v0
    v_mov_b32_dpp v29, v28 quad_perm:[1,1,1,1] row_mask:0xf bank_mask:0xf
    v_mov_b32_dpp v30, v28 quad_perm:[2,2,2,2] row_mask:0xf bank_mask:0xf
    v_mov_b32_dpp v31, v28 quad_perm:[3,3,3,3] row_mask:0xf bank_mask:0xf
    s_mov_b32 exec_lo, 0x1111
    s_mov_b32 exec_hi, 0x0
    s_cmp_eq_u32 s75, 1
    s_cbranch_scc0 SLOW3
    buffer_store_dwordx4 v[28:31], v27, s[16:19], s77 offen
BACK3:
    s_mov_b64 exec, -1
NOBASE0:
    v_and_b32 v23, 0xffff0000, v22
    v_lshlrev_b32 v22, 16, v22
    s_cmp_ge_u32 s69, 20
    s_cbranch_scc1 DMAF
    v_lshrrev_b32 v38, 2, v0
    v_mul_u32_u24 v38, 1280, v38
    v_and_b32 v39, 3, v0
    v_lshl_add_u32 v38, v39, 4, v38
    s_lshl_b32 s77, s72, 3
    s_add_u32 s77, s77, s68
    s_mul_i32 s77, s77, 245760
    s_lshl_b32 s78, s69, 6
    s_add_u32 s77, s77, s78
    s_mul_i32 s78, s72, 12288
    s_add_u32 m0, s78, 57344
    s_nop 0
    buffer_load_dwordx4 v38, s[24:27], s77 offen  lds
    s_add_u32 m0, m0, 1024
    s_add_u32 s77, s77, 20480
    buffer_load_dwordx4 v38, s[24:27], s77 offen  lds
    s_add_u32 m0, m0, 1024
    s_add_u32 s77, s77, 20480
    buffer_load_dwordx4 v38, s[24:27], s77 offen  lds
    s_add_u32 m0, m0, 1024
    s_add_u32 s77, s77, 20480
    buffer_load_dwordx4 v38, s[24:27], s77 offen  lds
    s_add_u32 m0, m0, 1024
    s_add_u32 s77, s77, 20480
    buffer_load_dwordx4 v38, s[24:27], s77 offen  lds
    s_add_u32 m0, m0, 1024
    s_add_u32 s77, s77, 20480
    buffer_load_dwordx4 v38, s[24:27], s77 offen  lds
    s_add_u32 m0, m0, 1024
    s_add_u32 s77, s77, 20480
    buffer_load_dwordx4 v38, s[24:27], s77 offen  lds
    s_add_u32 m0, m0, 1024
    s_add_u32 s77, s77, 20480
    buffer_load_dwordx4 v38, s[24:27], s77 offen  lds
    s_add_u32 m0, m0, 1024
    s_add_u32 s77, s77, 20480
    buffer_load_dwordx4 v38, s[24:27], s77 offen  lds
    s_add_u32 m0, m0, 1024
    s_add_u32 s77, s77, 20480
    buffer_load_dwordx4 v38, s[24:27], s77 offen  lds
    s_add_u32 m0, m0, 1024
    s_add_u32 s77, s77, 20480
    buffer_load_dwordx4 v38, s[24:27], s77 offen  lds
    s_add_u32 m0, m0, 1024
    s_add_u32 s77, s77, 20480
    buffer_load_dwordx4 v38, s[24:27], s77 offen  lds
DMAX:
    s_add_u32 s6, s73, 0
    buffer_load_dwordx4 a[216:219], v1, s[12:15], s6 offen offset:0 nt
    buffer_load_dwordx4 a[220:223], v1, s[12:15], s6 offen offset:1024 nt
    buffer_load_dwordx4 a[224:227], v1, s[12:15], s6 offen offset:2048 nt
    buffer_load_dwordx4 a[228:231], v1, s[12:15], s6 offen offset:3072 nt
    s_add_u32 s6, s6, 4096
    buffer_load_dwordx4 a[232:235], v1, s[12:15], s6 offen offset:0 nt
    buffer_load_dwordx4 a[236:239], v1, s[12:15], s6 offen offset:1024 nt
    s_waitcnt vmcnt(26)
    ds_write_b128 v2, a[144:147] offset:0
    ds_write_b128 v3, a[148:151] offset:0
    ds_write_b128 v4, a[152:155] offset:0
    ds_write_b128 v2, a[156:159] offset:3328
    ds_write_b128 v3, a[160:163] offset:3328
    ds_write_b128 v4, a[164:167] offset:3328
    ds_read_b128 a[144:147], v5 offset:0
    ds_read_b128 a[148:151], v5 offset:64
    ds_read_b128 a[152:155], v5 offset:128
    ds_read_b128 a[156:159], v5 offset:192
    ds_read_b128 a[160:163], v5 offset:256
    ds_read_b128 a[164:167], v5 offset:320
    s_add_u32 s77, s3, 1376256
    s_add_u32 s78, s3, 1380352
    s_add_u32 s79, s3, 4096
    buffer_load_dwordx4 v[64:67], v11, s[16:19], s77 offen sc1
    buffer_load_dwordx4 v[68:71], v11, s[16:19], s78 offen sc1
    buffer_load_dwordx4 v[72:75], v11, s[16:19], s3 offen sc1
    buffer_load_dwordx4 v[76:79], v11, s[16:19], s79 offen sc1
    s_add_u32 s6, s73, 196608
    buffer_load_dwordx4 v[112:115], v1, s[12:15], s6 offen offset:0 nt
    buffer_load_dwordx4 v[116:119], v1, s[12:15], s6 offen offset:1024 nt
    buffer_load_dwordx4 v[120:123], v1, s[12:15], s6 offen offset:2048 nt
    buffer_load_dwordx4 v[124:127], v1, s[12:15], s6 offen offset:3072 nt
    s_add_u32 s6, s6, 4096
    buffer_load_dwordx4 v[128:131], v1, s[12:15], s6 offen offset:0 nt
    buffer_load_dwordx4 v[132:135], v1, s[12:15], s6 offen offset:1024 nt
    s_waitcnt vmcnt(30)
    ds_write_b128 v2, a[168:171] offset:0
    ds_write_b128 v3, a[172:175] offset:0
    ds_write_b128 v4, a[176:179] offset:0
    ds_write_b128 v2, a[180:183] offset:3328
    ds_write_b128 v3, a[184:187] offset:3328
    ds_write_b128 v4, a[188:191] offset:3328
    ds_read_b128 a[168:171], v5 offset:0
    ds_read_b128 a[172:175], v5 offset:64
    ds_read_b128 a[176:179], v5 offset:128
    ds_read_b128 a[180:183], v5 offset:192
    ds_read_b128 a[184:187], v5 offset:256
    ds_read_b128 a[188:191], v5 offset:320
    v_and_b32 v25, 15, v0
    v_lshrrev_b32 v26, 4, v0
    v_add_u32 v27, 4, v26
    v_mul_u32_u24 v20, 1280, v26
    v_add_u32 v20, 665600, v20
    s_mul_i32 s7, s68, 81920
    s_add_u32 s7, s7, 78080
    v_mov_b32 v28, s7
    v_cmp_eq_u32 vcc, s68, v26
    s_nop 1
    v_cndmask_b32 v20, v20, v28, vcc
    v_mul_u32_u24 v21, 1280, v27
    v_add_u32 v21, 665600, v21
    s_mul_i32 s7, s68, 81920
    s_add_u32 s7, s7, 78080
    v_mov_b32 v28, s7
    v_cmp_eq_u32 vcc, s68, v27
    s_nop 1
    v_cndmask_b32 v21, v21, v28, vcc
    s_min_u32 s7, s69, 19
    s_lshl_b32 s7, s7, 6
    v_lshl_add_u32 v25, v25, 2, s7
    v_add_u32 v20, v20, v25
    v_add_u32 v21, v21, v25
    v_and_b32 v25, 15, v0
    v_bfe_u32 v27, v0, 2, 2
    v_and_b32 v28, 3, v0
    s_mul_i32 s7, s72, 12288
    s_add_u32 s7, s7, 57344
    v_lshl_add_u32 v29, v26, 3, v27
    v_lshlrev_b32 v29, 6, v29
    v_lshl_add_u32 v29, v28, 3, v29
    v_add_u32 v29, s7, v29
    v_accvgpr_write_b32 a246, v29
    s_mul_i32 s7, s72, 3072
    s_add_u32 s7, s7, 32768
    v_lshl_add_u32 v29, v25, 4, s7
    v_lshl_add_u32 v29, v26, 7, v29
    v_accvgpr_write_b32 a247, v29
    s_lshl_b32 s7, s72, 6
    s_add_u32 s7, s7, 45056
    v_and_b32 v29, 1, v26
    v_lshl_add_u32 v29, v29, 5, s7
    v_accvgpr_write_b32 a248, v29
    s_lshl_b32 s7, s72, 8
    s_add_u32 s7, s7, 122368
    v_lshl_add_u32 v29, v0, 2, s7
    v_accvgpr_write_b32 a249, v29
    s_lshl_b32 s81, s69, 6
    s_mul_i32 s80, s68, 1280
    s_add_u32 s80, s80, s81
    s_add_u32 s80, s80, 655360
    s_add_u32 s81, s81, s3
    s_add_u32 s81, s81, 76800
    s_add_u32 s6, s73, 393216
    buffer_load_dwordx4 v[136:139], v1, s[12:15], s6 offen offset:0 nt
    buffer_load_dwordx4 v[140:143], v1, s[12:15], s6 offen offset:1024 nt
    buffer_load_dwordx4 v[144:147], v1, s[12:15], s6 offen offset:2048 nt
    buffer_load_dwordx4 v[148:151], v1, s[12:15], s6 offen offset:3072 nt
    s_add_u32 s6, s6, 4096
    buffer_load_dwordx4 v[152:155], v1, s[12:15], s6 offen offset:0 nt
    buffer_load_dwordx4 v[156:159], v1, s[12:15], s6 offen offset:1024 nt
    s_waitcnt vmcnt(16)
    ds_write_b128 v2, a[216:219] offset:0
    ds_write_b128 v3, a[220:223] offset:0
    ds_write_b128 v4, a[224:227] offset:0
    ds_write_b128 v2, a[228:231] offset:3328
    ds_write_b128 v3, a[232:235] offset:3328
    ds_write_b128 v4, a[236:239] offset:3328
    ds_read_b64_tr_b16 a[192:193], v6 offset:0
    ds_read_b64_tr_b16 a[196:197], v6 offset:32
    ds_read_b64_tr_b16 a[200:201], v6 offset:64
    ds_read_b64_tr_b16 a[204:205], v6 offset:96
    ds_read_b64_tr_b16 a[208:209], v6 offset:128
    ds_read_b64_tr_b16 a[212:213], v6 offset:160
    ds_read_b64_tr_b16 a[216:217], v6 offset:192
    ds_read_b64_tr_b16 a[220:221], v6 offset:224
    ds_read_b64_tr_b16 a[224:225], v6 offset:256
    ds_read_b64_tr_b16 a[228:229], v6 offset:288
    ds_read_b64_tr_b16 a[232:233], v6 offset:320
    ds_read_b64_tr_b16 a[236:237], v6 offset:352
    s_waitcnt vmcnt(12)
    v_max3_u32 v24, v64, v65, v66
    v_max3_u32 v24, v24, v67, v68
    v_max3_u32 v24, v24, v69, v70
    v_max3_u32 v24, v24, v71, v72
    v_max3_u32 v24, v24, v73, v74
    v_max3_u32 v24, v24, v75, v76
    v_max3_u32 v24, v24, v77, v78
    v_max_u32 v24, v24, v79
    v_cmp_eq_u32 vcc, -1, v24
    s_cbranch_vccnz RETRY4
OK4:
    v_add_f32 v64, v64, v68
    v_add_f32 v65, v65, v69
    v_add_f32 v66, v66, v70
    v_add_f32 v67, v67, v71
    s_nop 0
    v_permlane32_swap_b32 v64, v66
    v_permlane32_swap_b32 v65, v67
    v_add_f32 v64, v64, v66
    v_add_f32 v65, v65, v67
    s_nop 1
    v_permlane16_swap_b32 v64, v65
    v_add_f32 v64, v64, v65
    v_add_f32 v72, v72, v76
    v_add_f32 v73, v73, v77
    v_add_f32 v74, v74, v78
    v_add_f32 v75, v75, v79
    s_nop 0
    v_permlane32_swap_b32 v72, v74
    v_permlane32_swap_b32 v73, v75
    v_add_f32 v72, v72, v74
    v_add_f32 v73, v73, v75
    s_nop 1
    v_permlane16_swap_b32 v72, v73
    v_add_f32 v72, v72, v73
    v_mul_f32 v7, 0x3acccccd, v64
    v_mov_b32 v24, v72
    v_mov_b32 v40, 0
    v_mov_b32 v41, 0
    v_mov_b32 v44, 0
    v_mov_b32 v45, 0
    v_mov_b32 v48, 0
    v_mov_b32 v49, 0
    v_mov_b32 v52, 0
    v_mov_b32 v53, 0
    v_mov_b32 v56, 0
    v_mov_b32 v57, 0
    v_mov_b32 v60, 0
    v_mov_b32 v61, 0
    v_mov_b32 v64, 0
    v_mov_b32 v65, 0
    v_mov_b32 v68, 0
    v_mov_b32 v69, 0
    v_mov_b32 v72, 0
    v_mov_b32 v73, 0
    v_mov_b32 v74, 0
    v_mov_b32 v75, 0
    v_mov_b32 v76, 0
    v_mov_b32 v77, 0
    v_mov_b32 v78, 0
    v_mov_b32 v79, 0
    v_mov_b32 v80, 0
    v_mov_b32 v81, 0
    v_mov_b32 v82, 0
    v_mov_b32 v83, 0
    v_mov_b32 v84, 0
    v_mov_b32 v85, 0
    v_mov_b32 v86, 0
    v_mov_b32 v87, 0
    v_readlane_b32 s77, v24, 15
    s_mov_b32 vcc_lo, 0x70007000
    s_mov_b32 vcc_hi, 0x70007000
    v_fma_f32 v25, -s77, v7, v24
    v_cvt_pk_bf16_f32 v25, v25, v25
    ds_write_b16 v12, v25
    v_cndmask_b32 v26, 0, v24, vcc
    s_nop 1
    v_add_f32_dpp v26, v26, v26 quad_perm:[1,0,3,2] row_mask:0xf bank_mask:0xf
    s_nop 1
    v_add_f32_dpp v26, v26, v26 quad_perm:[2,3,0,1] row_mask:0xf bank_mask:0xf
    v_mov_b32 v27, v26
    s_nop 1
    v_permlane32_swap_b32 v26, v27
    v_add_f32 v26, v26, v27
    s_add_u32 s6, s73, 589824
    buffer_load_dwordx4 v[160:163], v1, s[12:15], s6 offen offset:0 nt
    buffer_load_dwordx4 v[164:167], v1, s[12:15], s6 offen offset:1024 nt
    buffer_load_dwordx4 v[168:171], v1, s[12:15], s6 offen offset:2048 nt
    buffer_load_dwordx4 v[172:175], v1, s[12:15], s6 offen offset:3072 nt
    s_add_u32 s6, s6, 4096
    buffer_load_dwordx4 v[176:179], v1, s[12:15], s6 offen offset:0 nt
    buffer_load_dwordx4 v[180:183], v1, s[12:15], s6 offen offset:1024 nt
    s_waitcnt lgkmcnt(0)
    s_barrier
    ds_read_b128 v[28:31], v13 offset:0
    ds_read_b128 v[32:35], v13 offset:128
    ds_read_b128 v[36:39], v13 offset:256
    v_mov_b32 v27, v26
    v_mov_b32 v25, s77
    v_subrev_f32 v25, 0x44200000, v25
    v_permlane16_swap_b32 v26, v27
    v_add_f32 v26, v26, v27
    v_mul_f32 v24, 0x3acccccd, v25
    v_readlane_b32 s77, v26, 15
    v_mul_f32 v24, v24, v24
    s_mov_b32 s78, 0x3acccccd
    v_sub_f32 v26, s77, v25
    v_fma_f32 v26, v26, s78, -v24
    v_max_f32 v26, 0, v26
    v_add_f32 v26, 0x3727c5ac, v26
    v_rsq_f32 v26, v26
    s_nop 0
    v_mul_f32 v18, 0x3dd53b94, v26
    s_waitcnt lgkmcnt(2)
    v_smfmac_f32_16x16x64_bf16 v[40:43], v[28:31], a[0:7], v14
    v_smfmac_f32_16x16x64_bf16 v[56:59], v[28:31], a[96:103], v14
    v_smfmac_f32_16x16x64_bf16 v[44:47], v[28:31], a[24:31], v14
    v_smfmac_f32_16x16x64_bf16 v[60:63], v[28:31], a[120:127], v14
    v_smfmac_f32_16x16x64_bf16 v[48:51], v[28:31], a[48:55], v14
    v_smfmac_f32_16x16x64_bf16 v[64:67], v[28:31], a[144:151], v14
    v_smfmac_f32_16x16x64_bf16 v[52:55], v[28:31], a[72:79], v14
    v_smfmac_f32_16x16x64_bf16 v[68:71], v[28:31], a[168:175], v14
    s_waitcnt lgkmcnt(1)
    v_smfmac_f32_16x16x64_bf16 v[40:43], v[32:35], a[8:15], v14
    v_smfmac_f32_16x16x64_bf16 v[56:59], v[32:35], a[104:111], v14
    v_smfmac_f32_16x16x64_bf16 v[44:47], v[32:35], a[32:39], v14
    v_smfmac_f32_16x16x64_bf16 v[60:63], v[32:35], a[128:135], v14
    v_smfmac_f32_16x16x64_bf16 v[48:51], v[32:35], a[56:63], v14
    v_smfmac_f32_16x16x64_bf16 v[64:67], v[32:35], a[152:159], v14
    v_smfmac_f32_16x16x64_bf16 v[52:55], v[32:35], a[80:87], v14
    v_smfmac_f32_16x16x64_bf16 v[68:71], v[32:35], a[176:183], v14
    s_waitcnt lgkmcnt(0)
    v_smfmac_f32_16x16x64_bf16 v[40:43], v[36:39], a[16:23], v14
    v_smfmac_f32_16x16x64_bf16 v[56:59], v[36:39], a[112:119], v14
    v_smfmac_f32_16x16x64_bf16 v[44:47], v[36:39], a[40:47], v14
    v_smfmac_f32_16x16x64_bf16 v[60:63], v[36:39], a[136:143], v14
    v_smfmac_f32_16x16x64_bf16 v[48:51], v[36:39], a[64:71], v14
    v_smfmac_f32_16x16x64_bf16 v[64:67], v[36:39], a[160:167], v14
    v_smfmac_f32_16x16x64_bf16 v[52:55], v[36:39], a[88:95], v14
    v_smfmac_f32_16x16x64_bf16 v[68:71], v[36:39], a[184:191], v14
    s_lshl_b32 s78, s72, 8
    v_add_f32_dpp v24, v40, v41 quad_perm:[0,1,2,3] row_mask:0x1 bank_mask:0xf
    v_add_f32_dpp v25, v56, v57 quad_perm:[0,1,2,3] row_mask:0x1 bank_mask:0xf
    v_bfe_u32 v27, v0, 4, 1
    v_add_f32_dpp v24, v44, v45 quad_perm:[0,1,2,3] row_mask:0x2 bank_mask:0xf
    v_add_f32_dpp v25, v60, v61 quad_perm:[0,1,2,3] row_mask:0x2 bank_mask:0xf
    v_bfe_u32 v28, v0, 2, 1
    v_add_f32_dpp v24, v48, v49 quad_perm:[0,1,2,3] row_mask:0x4 bank_mask:0xf
    v_add_f32_dpp v25, v64, v65 quad_perm:[0,1,2,3] row_mask:0x4 bank_mask:0xf
    s_add_u32 s78, s78, 124416
    v_add_f32_dpp v24, v52, v53 quad_perm:[0,1,2,3] row_mask:0x8 bank_mask:0xf
    v_add_f32_dpp v25, v68, v69 quad_perm:[0,1,2,3] row_mask:0x8 bank_mask:0xf
    v_max_f32 v26, v24, v25
    v_lshl_add_u32 v27, v27, 5, s78
    v_lshl_add_u32 v27, v28, 4, v27
    v_max_f32_dpp v26, v26, v26 row_ror:8 row_mask:0xf bank_mask:0xf
    s_nop 1
    v_max_f32_dpp v26, v26, v26 row_ror:4 row_mask:0xf bank_mask:0xf
    s_nop 1
    v_max_f32_dpp v26, v26, v26 row_ror:2 row_mask:0xf bank_mask:0xf
    s_nop 1
    v_max_f32_dpp v26, v26, v26 row_ror:1 row_mask:0xf bank_mask:0xf
    v_mov_b32 v28, v26
    s_nop 1
    v_permlane32_swap_b32 v26, v28
    v_max_f32 v26, v26, v28
    v_mov_b32 v28, v26
    s_nop 1
    v_permlane16_swap_b32 v26, v28
    v_max_f32 v26, v26, v28
    v_mul_f32 v26, v26, v18
    v_fma_f32 v24, v24, v18, -v26
    v_fma_f32 v25, v25, v18, -v26
    v_exp_f32 v24, v24
    v_exp_f32 v25, v25
    s_nop 0
    v_cvt_pk_bf16_f32 v28, v24, v25
    ds_write_b16 v19, v28
    ds_write_b16_d16_hi v19, v28 offset:128
    s_mov_b32 exec_lo, 0xff00ff
    s_mov_b32 exec_hi, 0xff00ff00
    ds_read_b128 v[72:75], v27 offset:0
    ds_read_b128 v[76:79], v27 offset:64
    ds_read_b128 v[80:83], v27 offset:128
    ds_read_b128 v[84:87], v27 offset:192
    s_mov_b64 exec, -1
    v_add_f32 v27, v24, v25
    v_mov_b32 v40, 0
    v_mov_b32 v44, 0
    v_add_f32_dpp v27, v27, v27 row_ror:8 row_mask:0xf bank_mask:0xf
    v_mov_b32 v48, 0
    v_mov_b32 v52, 0
    v_add_f32_dpp v27, v27, v27 row_ror:4 row_mask:0xf bank_mask:0xf
    v_mov_b32 v56, 0
    v_mov_b32 v60, 0
    v_add_f32_dpp v27, v27, v27 row_ror:2 row_mask:0xf bank_mask:0xf
    s_lshl_b32 s78, s72, 3
    s_add_u32 s78, s78, 125440
    v_add_f32_dpp v27, v27, v27 row_ror:1 row_mask:0xf bank_mask:0xf
    v_mov_b32 v28, v27
    s_nop 1
    v_permlane32_swap_b32 v27, v28
    v_add_f32 v27, v27, v28
    v_mov_b32 v28, v27
    s_nop 1
    v_permlane16_swap_b32 v27, v28
    v_add_f32 v27, v27, v28
    v_mov_b32 v28, s78
    ds_write_b64 v28, v[26:27]
    s_add_u32 s6, s73, 786432
    buffer_load_dwordx4 v[184:187], v1, s[12:15], s6 offen offset:0 nt
    buffer_load_dwordx4 v[188:191], v1, s[12:15], s6 offen offset:1024 nt
    buffer_load_dwordx4 v[192:195], v1, s[12:15], s6 offen offset:2048 nt
    buffer_load_dwordx4 v[196:199], v1, s[12:15], s6 offen offset:3072 nt
    s_add_u32 s6, s6, 4096
    buffer_load_dwordx4 v[200:203], v1, s[12:15], s6 offen offset:0 nt
    buffer_load_dwordx4 v[204:207], v1, s[12:15], s6 offen offset:1024 nt
    s_waitcnt vmcnt(18)
    ds_write_b128 v2, v[112:115] offset:0
    ds_write_b128 v3, v[116:119] offset:0
    ds_write_b128 v4, v[120:123] offset:0
    ds_write_b128 v2, v[124:127] offset:3328
    ds_write_b128 v3, v[128:131] offset:3328
    ds_write_b128 v4, v[132:135] offset:3328
    ds_read_b64_tr_b16 a[194:195], v6 offset:0
    ds_read_b64_tr_b16 a[198:199], v6 offset:32
    ds_read_b64_tr_b16 a[202:203], v6 offset:64
    ds_read_b64_tr_b16 a[206:207], v6 offset:96
    ds_read_b64_tr_b16 a[210:211], v6 offset:128
    ds_read_b64_tr_b16 a[214:215], v6 offset:160
    ds_read_b64_tr_b16 a[218:219], v6 offset:192
    ds_read_b64_tr_b16 a[222:223], v6 offset:224
    ds_read_b64_tr_b16 a[226:227], v6 offset:256
    ds_read_b64_tr_b16 a[230:231], v6 offset:288
    ds_read_b64_tr_b16 a[234:235], v6 offset:320
    ds_read_b64_tr_b16 a[238:239], v6 offset:352
    s_waitcnt lgkmcnt(0)
    v_smfmac_f32_16x16x64_bf16 v[40:43], v[72:75], a[192:199], v14 abid:1
    v_smfmac_f32_16x16x64_bf16 v[44:47], v[72:75], a[200:207], v14 abid:1
    v_smfmac_f32_16x16x64_bf16 v[48:51], v[72:75], a[208:215], v14 abid:1
    v_smfmac_f32_16x16x64_bf16 v[52:55], v[72:75], a[216:223], v14 abid:1
    v_smfmac_f32_16x16x64_bf16 v[56:59], v[72:75], a[224:231], v14 abid:1
    v_smfmac_f32_16x16x64_bf16 v[60:63], v[72:75], a[232:239], v14 abid:1
    s_add_u32 s6, s73, 983040
    buffer_load_dwordx4 v[208:211], v1, s[12:15], s6 offen offset:0 nt
    buffer_load_dwordx4 v[212:215], v1, s[12:15], s6 offen offset:1024 nt
    buffer_load_dwordx4 v[216:219], v1, s[12:15], s6 offen offset:2048 nt
    buffer_load_dwordx4 v[220:223], v1, s[12:15], s6 offen offset:3072 nt
    s_add_u32 s6, s6, 4096
    buffer_load_dwordx4 v[224:227], v1, s[12:15], s6 offen offset:0 nt
    buffer_load_dwordx4 v[228:231], v1, s[12:15], s6 offen offset:1024 nt
    s_waitcnt vmcnt(18)
    ds_write_b128 v2, v[136:139] offset:0
    ds_write_b128 v3, v[140:143] offset:0
    ds_write_b128 v4, v[144:147] offset:0
    ds_write_b128 v2, v[148:151] offset:3328
    ds_write_b128 v3, v[152:155] offset:3328
    ds_write_b128 v4, v[156:159] offset:3328
    ds_read_b64_tr_b16 v[112:113], v6 offset:0
    ds_read_b64_tr_b16 v[116:117], v6 offset:32
    ds_read_b64_tr_b16 v[120:121], v6 offset:64
    ds_read_b64_tr_b16 v[124:125], v6 offset:96
    ds_read_b64_tr_b16 v[128:129], v6 offset:128
    ds_read_b64_tr_b16 v[132:133], v6 offset:160
    ds_read_b64_tr_b16 v[136:137], v6 offset:192
    ds_read_b64_tr_b16 v[140:141], v6 offset:224
    ds_read_b64_tr_b16 v[144:145], v6 offset:256
    ds_read_b64_tr_b16 v[148:149], v6 offset:288
    ds_read_b64_tr_b16 v[152:153], v6 offset:320
    ds_read_b64_tr_b16 v[156:157], v6 offset:352
    s_waitcnt vmcnt(12)
    ds_write_b128 v2, v[160:163] offset:0
    ds_write_b128 v3, v[164:167] offset:0
    ds_write_b128 v4, v[168:171] offset:0
    ds_write_b128 v2, v[172:175] offset:3328
    ds_write_b128 v3, v[176:179] offset:3328
    ds_write_b128 v4, v[180:183] offset:3328
    ds_read_b64_tr_b16 v[114:115], v6 offset:0
    ds_read_b64_tr_b16 v[118:119], v6 offset:32
    ds_read_b64_tr_b16 v[122:123], v6 offset:64
    ds_read_b64_tr_b16 v[126:127], v6 offset:96
    ds_read_b64_tr_b16 v[130:131], v6 offset:128
    ds_read_b64_tr_b16 v[134:135], v6 offset:160
    ds_read_b64_tr_b16 v[138:139], v6 offset:192
    ds_read_b64_tr_b16 v[142:143], v6 offset:224
    ds_read_b64_tr_b16 v[146:147], v6 offset:256
    ds_read_b64_tr_b16 v[150:151], v6 offset:288
    ds_read_b64_tr_b16 v[154:155], v6 offset:320
    ds_read_b64_tr_b16 v[158:159], v6 offset:352
    s_add_u32 s6, s73, 1179648
    buffer_load_dwordx4 v[232:235], v1, s[12:15], s6 offen offset:0 nt
    buffer_load_dwordx4 v[236:239], v1, s[12:15], s6 offen offset:1024 nt
    buffer_load_dwordx4 v[240:243], v1, s[12:15], s6 offen offset:2048 nt
    buffer_load_dwordx4 v[244:247], v1, s[12:15], s6 offen offset:3072 nt
    s_add_u32 s6, s6, 4096
    buffer_load_dwordx4 v[248:251], v1, s[12:15], s6 offen offset:0 nt
    buffer_load_dwordx4 v[252:255], v1, s[12:15], s6 offen offset:1024 nt
    s_waitcnt lgkmcnt(0)
    v_smfmac_f32_16x16x64_bf16 v[40:43], v[76:79], v[112:119], v14 abid:1
    v_smfmac_f32_16x16x64_bf16 v[44:47], v[76:79], v[120:127], v14 abid:1
    v_smfmac_f32_16x16x64_bf16 v[48:51], v[76:79], v[128:135], v14 abid:1
    v_smfmac_f32_16x16x64_bf16 v[52:55], v[76:79], v[136:143], v14 abid:1
    v_smfmac_f32_16x16x64_bf16 v[56:59], v[76:79], v[144:151], v14 abid:1
    v_smfmac_f32_16x16x64_bf16 v[60:63], v[76:79], v[152:159], v14 abid:1
    s_waitcnt vmcnt(12)
    ds_write_b128 v2, v[184:187] offset:0
    ds_write_b128 v3, v[188:191] offset:0
    ds_write_b128 v4, v[192:195] offset:0
    ds_write_b128 v2, v[196:199] offset:3328
    ds_write_b128 v3, v[200:203] offset:3328
    ds_write_b128 v4, v[204:207] offset:3328
    ds_read_b64_tr_b16 v[160:161], v6 offset:0
    ds_read_b64_tr_b16 v[164:165], v6 offset:32
    ds_read_b64_tr_b16 v[168:169], v6 offset:64
    ds_read_b64_tr_b16 v[172:173], v6 offset:96
    ds_read_b64_tr_b16 v[176:177], v6 offset:128
    ds_read_b64_tr_b16 v[180:181], v6 offset:160
    ds_read_b64_tr_b16 v[184:185], v6 offset:192
    ds_read_b64_tr_b16 v[188:189], v6 offset:224
    ds_read_b64_tr_b16 v[192:193], v6 offset:256
    ds_read_b64_tr_b16 v[196:197], v6 offset:288
    ds_read_b64_tr_b16 v[200:201], v6 offset:320
    ds_read_b64_tr_b16 v[204:205], v6 offset:352
    s_add_u32 s6, s73, 1376256
    buffer_load_dwordx4 v[88:91], v1, s[12:15], s6 offen offset:0 nt
    buffer_load_dwordx4 v[92:95], v1, s[12:15], s6 offen offset:1024 nt
    buffer_load_dwordx4 v[96:99], v1, s[12:15], s6 offen offset:2048 nt
    buffer_load_dwordx4 v[100:103], v1, s[12:15], s6 offen offset:3072 nt
    s_add_u32 s6, s6, 4096
    buffer_load_dwordx4 v[104:107], v1, s[12:15], s6 offen offset:0 nt
    buffer_load_dwordx4 v[108:111], v1, s[12:15], s6 offen offset:1024 nt
    s_waitcnt vmcnt(12)
    ds_write_b128 v2, v[208:211] offset:0
    ds_write_b128 v3, v[212:215] offset:0
    ds_write_b128 v4, v[216:219] offset:0
    ds_write_b128 v2, v[220:223] offset:3328
    ds_write_b128 v3, v[224:227] offset:3328
    ds_write_b128 v4, v[228:231] offset:3328
    ds_read_b64_tr_b16 v[162:163], v6 offset:0
    ds_read_b64_tr_b16 v[166:167], v6 offset:32
    ds_read_b64_tr_b16 v[170:171], v6 offset:64
    ds_read_b64_tr_b16 v[174:175], v6 offset:96
    ds_read_b64_tr_b16 v[178:179], v6 offset:128
    ds_read_b64_tr_b16 v[182:183], v6 offset:160
    ds_read_b64_tr_b16 v[186:187], v6 offset:192
    ds_read_b64_tr_b16 v[190:191], v6 offset:224
    ds_read_b64_tr_b16 v[194:195], v6 offset:256
    ds_read_b64_tr_b16 v[198:199], v6 offset:288
    ds_read_b64_tr_b16 v[202:203], v6 offset:320
    ds_read_b64_tr_b16 v[206:207], v6 offset:352
    s_waitcnt lgkmcnt(0)
    v_smfmac_f32_16x16x64_bf16 v[40:43], v[80:83], v[160:167], v14 abid:1
    v_smfmac_f32_16x16x64_bf16 v[44:47], v[80:83], v[168:175], v14 abid:1
    v_smfmac_f32_16x16x64_bf16 v[48:51], v[80:83], v[176:183], v14 abid:1
    v_smfmac_f32_16x16x64_bf16 v[52:55], v[80:83], v[184:191], v14 abid:1
    v_smfmac_f32_16x16x64_bf16 v[56:59], v[80:83], v[192:199], v14 abid:1
    v_smfmac_f32_16x16x64_bf16 v[60:63], v[80:83], v[200:207], v14 abid:1
    s_waitcnt vmcnt(6)
    ds_write_b128 v2, v[232:235] offset:0
    ds_write_b128 v3, v[236:239] offset:0
    ds_write_b128 v4, v[240:243] offset:0
    ds_write_b128 v2, v[244:247] offset:3328
    ds_write_b128 v3, v[248:251] offset:3328
    ds_write_b128 v4, v[252:255] offset:3328
    ds_read_b64_tr_b16 v[208:209], v6 offset:0
    ds_read_b64_tr_b16 v[212:213], v6 offset:32
    ds_read_b64_tr_b16 v[216:217], v6 offset:64
    ds_read_b64_tr_b16 v[220:221], v6 offset:96
    ds_read_b64_tr_b16 v[224:225], v6 offset:128
    ds_read_b64_tr_b16 v[228:229], v6 offset:160
    ds_read_b64_tr_b16 v[232:233], v6 offset:192
    ds_read_b64_tr_b16 v[236:237], v6 offset:224
    ds_read_b64_tr_b16 v[240:241], v6 offset:256
    ds_read_b64_tr_b16 v[244:245], v6 offset:288
    ds_read_b64_tr_b16 v[248:249], v6 offset:320
    ds_read_b64_tr_b16 v[252:253], v6 offset:352
    s_waitcnt vmcnt(0)
    ds_write_b128 v2, v[88:91] offset:0
    ds_write_b128 v3, v[92:95] offset:0
    ds_write_b128 v4, v[96:99] offset:0
    ds_write_b128 v2, v[100:103] offset:3328
    ds_write_b128 v3, v[104:107] offset:3328
    ds_write_b128 v4, v[108:111] offset:3328
    ds_read_b64_tr_b16 v[210:211], v6 offset:0
    ds_read_b64_tr_b16 v[214:215], v6 offset:32
    ds_read_b64_tr_b16 v[218:219], v6 offset:64
    ds_read_b64_tr_b16 v[222:223], v6 offset:96
    ds_read_b64_tr_b16 v[226:227], v6 offset:128
    ds_read_b64_tr_b16 v[230:231], v6 offset:160
    ds_read_b64_tr_b16 v[234:235], v6 offset:192
    ds_read_b64_tr_b16 v[238:239], v6 offset:224
    ds_read_b64_tr_b16 v[242:243], v6 offset:256
    ds_read_b64_tr_b16 v[246:247], v6 offset:288
    ds_read_b64_tr_b16 v[250:251], v6 offset:320
    ds_read_b64_tr_b16 v[254:255], v6 offset:352
    s_waitcnt lgkmcnt(0)
    s_branch ATT_LAST
LOOP:
    ds_read_b64_tr_b16 v[40:41], v16 offset:0
    ds_read_b64_tr_b16 v[42:43], v16 offset:1536
    ds_read_b64_tr_b16 v[44:45], v16 offset:12288
    ds_read_b64_tr_b16 v[46:47], v16 offset:13824
    ds_read_b64_tr_b16 v[48:49], v17 offset:24576
    ds_read_b64_tr_b16 v[50:51], v16 offset:32
    ds_read_b64_tr_b16 v[52:53], v16 offset:1568
    ds_read_b64_tr_b16 v[54:55], v16 offset:12320
    ds_read_b64_tr_b16 v[56:57], v16 offset:13856
    ds_read_b64_tr_b16 v[58:59], v17 offset:24608
    ds_read_b64_tr_b16 v[60:61], v16 offset:64
    ds_read_b64_tr_b16 v[62:63], v16 offset:1600
    ds_read_b64_tr_b16 v[64:65], v16 offset:12352
    ds_read_b64_tr_b16 v[66:67], v16 offset:13888
    ds_read_b64_tr_b16 v[68:69], v17 offset:24640
    v_and_b32 v25, 15, v0
    v_cmp_eq_u32 vcc, 12, v25
    v_mov_b32 v36, 0x3f803f80
    s_nop 0
    v_cndmask_b32 v70, 0, v36, vcc
    v_mov_b32 v71, v70
    v_mov_b32 v72, v70
    v_mov_b32 v73, v70
    v_mov_b32 v74, v70
    v_mov_b32 v75, v70
    v_mov_b32 v76, v70
    v_mov_b32 v77, v70
    v_mov_b32 v78, v70
    v_mov_b32 v79, v70
    s_add_u32 s79, s3, 4096
    s_mul_i32 s77, s72, 6656
    v_mul_u32_u24 v26, 103, v0
    v_lshrrev_b32 v26, 10, v26
    v_lshl_add_u32 v26, v26, 4, v1
    v_add_u32 v26, s77, v26
    v_mul_u32_u24 v27, 176, v25
    v_add_u32 v27, s77, v27
    v_lshrrev_b32 v28, 4, v0
    v_lshl_add_u32 v29, v28, 3, v27
    v_lshl_add_u32 v27, v28, 4, v27
    s_mul_i32 s77, s71, 160
    s_add_u32 s77, s77, s3
    s_sub_u32 s77, s77, 610048
    s_waitcnt lgkmcnt(0)
    s_mov_b32 exec_lo, 0x3ff
    s_mov_b32 exec_hi, 0x0
    s_mov_b32 s76, 1
POLL5:
    buffer_load_dword v24, v1, s[16:19], s77 offen sc1
POLLW5:
    s_waitcnt vmcnt(0)
    v_cmp_eq_u32 vcc, -1, v24
    s_cbranch_vccnz AGAIN5
POLLX5:
    s_mov_b32 exec_lo, 0xffffffff
    s_mov_b32 exec_hi, 0xfffffff
    s_mov_b32 s76, 1
POLL6:
    buffer_load_dwordx4 v[80:83], v8, s[16:19], 0 offen sc1
    buffer_load_dwordx4 v[84:87], v9, s[16:19], 0 offen sc1
POLLW6:
    s_waitcnt vmcnt(0)
    v_max_u32 v24, v80, v84
    v_cmp_eq_u32 vcc, -1, v24
    s_cbranch_vccnz AGAIN6
POLLX6:
    ds_write_b128 v26, v[80:83]
    ds_write_b128 v26, v[84:87] offset:1056
    s_mov_b32 exec_lo, 0x1ff01ff
    s_mov_b32 exec_hi, 0x1ff01ff
    ds_read_b128 v[70:73], v27
    ds_read_b128 v[74:77], v27 offset:64
    ds_read_b64 v[78:79], v29 offset:128
    s_mov_b64 exec, -1
    buffer_load_dword a244, v20, s[16:19], 0 offen sc1
    buffer_load_dword a245, v21, s[16:19], 0 offen sc1
    s_waitcnt lgkmcnt(2)
    v_mfma_f32_16x16x32_bf16 v[24:27], v[70:73], v[40:43], 0
    v_mfma_f32_16x16x32_bf16 v[32:35], v[70:73], v[60:63], 0
    s_waitcnt lgkmcnt(0)
    v_mfma_f32_16x16x32_bf16 v[24:27], v[74:77], v[44:47], v[24:27]
    v_mfma_f32_16x16x32_bf16 v[32:35], v[74:77], v[64:67], v[32:35]
    v_mfma_f32_16x16x16_bf16 v[24:27], v[78:79], v[48:49], v[24:27]
    v_mfma_f32_16x16x16_bf16 v[32:35], v[78:79], v[68:69], v[32:35]
    v_mfma_f32_16x16x32_bf16 v[28:31], v[70:73], v[50:53], 0
    v_mfma_f32_16x16x32_bf16 v[36:39], v[70:73], v[70:73], 0
    v_mfma_f32_16x16x32_bf16 v[28:31], v[74:77], v[54:57], v[28:31]
    v_mfma_f32_16x16x32_bf16 v[36:39], v[74:77], v[74:77], v[36:39]
    v_mfma_f32_16x16x16_bf16 v[28:31], v[78:79], v[58:59], v[28:31]
    v_mfma_f32_16x16x16_bf16 v[36:39], v[78:79], v[78:79], v[36:39]
    s_nop 0
    v_add_f32 v24, v24, v25
    v_add_f32 v26, v26, v27
    v_add_f32 v24, v24, v26
    v_add_f32 v32, v32, v33
    v_add_f32 v34, v34, v35
    v_add_f32 v32, v32, v34
    s_nop 1
    v_permlane32_swap_b32 v24, v32
    v_add_f32 v28, v28, v29
    v_add_f32 v30, v30, v31
    v_add_f32 v36, v36, v37
    v_add_f32 v38, v38, v39
    v_add_f32 v24, v24, v32
    v_add_f32 v28, v28, v30
    v_add_f32 v36, v36, v38
    s_nop 1
    v_permlane32_swap_b32 v28, v36
    v_add_f32 v28, v28, v36
    s_nop 1
    v_permlane16_swap_b32 v24, v28
    v_add_f32 v24, v24, v28
    s_cmp_eq_u32 s75, 1
    s_cbranch_scc0 SLOW7
    buffer_store_dword v24, v10, s[16:19], s3 offen
BACK7:
    v_mov_b32 v40, 0
    v_mov_b32 v41, 0
    v_mov_b32 v44, 0
    v_mov_b32 v45, 0
    v_mov_b32 v48, 0
    v_mov_b32 v49, 0
    v_mov_b32 v52, 0
    v_mov_b32 v53, 0
    v_mov_b32 v56, 0
    v_mov_b32 v57, 0
    v_mov_b32 v60, 0
    v_mov_b32 v61, 0
    v_mov_b32 v64, 0
    v_mov_b32 v65, 0
    v_mov_b32 v68, 0
    v_mov_b32 v69, 0
    v_mov_b32 v72, 0
    v_mov_b32 v73, 0
    v_mov_b32 v74, 0
    v_mov_b32 v75, 0
    v_mov_b32 v76, 0
    v_mov_b32 v77, 0
    v_mov_b32 v78, 0
    v_mov_b32 v79, 0
    v_mov_b32 v80, 0
    v_mov_b32 v81, 0
    v_mov_b32 v82, 0
    v_mov_b32 v83, 0
    v_mov_b32 v84, 0
    v_mov_b32 v85, 0
    v_mov_b32 v86, 0
    v_mov_b32 v87, 0
    s_mov_b32 s76, 1
POLL8:
    buffer_load_dwordx4 v[24:27], v11, s[16:19], s3 offen sc1
    buffer_load_dwordx4 v[28:31], v11, s[16:19], s79 offen sc1
POLLW8:
    s_waitcnt vmcnt(0)
    v_max3_u32 v32, v24, v25, v26
    v_max3_u32 v32, v32, v27, v28
    v_max3_u32 v32, v32, v29, v30
    v_max_u32 v32, v32, v31
    v_cmp_eq_u32 vcc, -1, v32
    s_cbranch_vccnz AGAIN8
POLLX8:
    v_add_f32 v24, v24, v28
    v_add_f32 v25, v25, v29
    v_add_f32 v26, v26, v30
    v_add_f32 v27, v27, v31
    s_nop 0
    v_permlane32_swap_b32 v24, v26
    v_permlane32_swap_b32 v25, v27
    v_add_f32 v24, v24, v26
    v_add_f32 v25, v25, v27
    s_nop 1
    v_permlane16_swap_b32 v24, v25
    v_add_f32 v24, v24, v25
    s_nop 0
    v_readlane_b32 s77, v24, 15
    s_mov_b32 vcc_lo, 0x70007000
    s_mov_b32 vcc_hi, 0x70007000
    v_fma_f32 v25, -s77, v7, v24
    v_cvt_pk_bf16_f32 v25, v25, v25
    ds_write_b16 v12, v25
    v_cndmask_b32 v26, 0, v24, vcc
    s_nop 1
    v_add_f32_dpp v26, v26, v26 quad_perm:[1,0,3,2] row_mask:0xf bank_mask:0xf
    s_nop 1
    v_add_f32_dpp v26, v26, v26 quad_perm:[2,3,0,1] row_mask:0xf bank_mask:0xf
    v_mov_b32 v27, v26
    s_nop 1
    v_permlane32_swap_b32 v26, v27
    v_add_f32 v26, v26, v27
    s_waitcnt lgkmcnt(0)
    s_barrier
    ds_read_b128 v[28:31], v13 offset:0
    ds_read_b128 v[32:35], v13 offset:128
    ds_read_b128 v[36:39], v13 offset:256
    v_mov_b32 v27, v26
    v_mov_b32 v25, s77
    v_subrev_f32 v25, 0x44200000, v25
    v_permlane16_swap_b32 v26, v27
    v_add_f32 v26, v26, v27
    v_mul_f32 v24, 0x3acccccd, v25
    v_readlane_b32 s77, v26, 15
    v_mul_f32 v24, v24, v24
    s_mov_b32 s78, 0x3acccccd
    v_sub_f32 v26, s77, v25
    v_fma_f32 v26, v26, s78, -v24
    v_max_f32 v26, 0, v26
    v_add_f32 v26, 0x3727c5ac, v26
    v_rsq_f32 v26, v26
    s_nop 0
    v_mul_f32 v18, 0x3dd53b94, v26
    s_waitcnt lgkmcnt(2)
    v_smfmac_f32_16x16x64_bf16 v[40:43], v[28:31], a[0:7], v14
    v_smfmac_f32_16x16x64_bf16 v[56:59], v[28:31], a[96:103], v14
    v_smfmac_f32_16x16x64_bf16 v[44:47], v[28:31], a[24:31], v14
    v_smfmac_f32_16x16x64_bf16 v[60:63], v[28:31], a[120:127], v14
    v_smfmac_f32_16x16x64_bf16 v[48:51], v[28:31], a[48:55], v14
    v_smfmac_f32_16x16x64_bf16 v[64:67], v[28:31], a[144:151], v14
    v_smfmac_f32_16x16x64_bf16 v[52:55], v[28:31], a[72:79], v14
    v_smfmac_f32_16x16x64_bf16 v[68:71], v[28:31], a[168:175], v14
    s_waitcnt lgkmcnt(1)
    v_smfmac_f32_16x16x64_bf16 v[40:43], v[32:35], a[8:15], v14
    v_smfmac_f32_16x16x64_bf16 v[56:59], v[32:35], a[104:111], v14
    v_smfmac_f32_16x16x64_bf16 v[44:47], v[32:35], a[32:39], v14
    v_smfmac_f32_16x16x64_bf16 v[60:63], v[32:35], a[128:135], v14
    v_smfmac_f32_16x16x64_bf16 v[48:51], v[32:35], a[56:63], v14
    v_smfmac_f32_16x16x64_bf16 v[64:67], v[32:35], a[152:159], v14
    v_smfmac_f32_16x16x64_bf16 v[52:55], v[32:35], a[80:87], v14
    v_smfmac_f32_16x16x64_bf16 v[68:71], v[32:35], a[176:183], v14
    s_waitcnt lgkmcnt(0)
    v_smfmac_f32_16x16x64_bf16 v[40:43], v[36:39], a[16:23], v14
    v_smfmac_f32_16x16x64_bf16 v[56:59], v[36:39], a[112:119], v14
    v_smfmac_f32_16x16x64_bf16 v[44:47], v[36:39], a[40:47], v14
    v_smfmac_f32_16x16x64_bf16 v[60:63], v[36:39], a[136:143], v14
    v_smfmac_f32_16x16x64_bf16 v[48:51], v[36:39], a[64:71], v14
    v_smfmac_f32_16x16x64_bf16 v[64:67], v[36:39], a[160:167], v14
    v_smfmac_f32_16x16x64_bf16 v[52:55], v[36:39], a[88:95], v14
    v_smfmac_f32_16x16x64_bf16 v[68:71], v[36:39], a[184:191], v14
    s_lshl_b32 s78, s72, 8
    v_add_f32_dpp v24, v40, v41 quad_perm:[0,1,2,3] row_mask:0x1 bank_mask:0xf
    v_add_f32_dpp v25, v56, v57 quad_perm:[0,1,2,3] row_mask:0x1 bank_mask:0xf
    v_bfe_u32 v27, v0, 4, 1
    v_add_f32_dpp v24, v44, v45 quad_perm:[0,1,2,3] row_mask:0x2 bank_mask:0xf
    v_add_f32_dpp v25, v60, v61 quad_perm:[0,1,2,3] row_mask:0x2 bank_mask:0xf
    v_bfe_u32 v28, v0, 2, 1
    v_add_f32_dpp v24, v48, v49 quad_perm:[0,1,2,3] row_mask:0x4 bank_mask:0xf
    v_add_f32_dpp v25, v64, v65 quad_perm:[0,1,2,3] row_mask:0x4 bank_mask:0xf
    s_add_u32 s78, s78, 124416
    v_add_f32_dpp v24, v52, v53 quad_perm:[0,1,2,3] row_mask:0x8 bank_mask:0xf
    v_add_f32_dpp v25, v68, v69 quad_perm:[0,1,2,3] row_mask:0x8 bank_mask:0xf
    v_max_f32 v26, v24, v25
    v_lshl_add_u32 v27, v27, 5, s78
    v_lshl_add_u32 v27, v28, 4, v27
    v_max_f32_dpp v26, v26, v26 row_ror:8 row_mask:0xf bank_mask:0xf
    s_nop 1
    v_max_f32_dpp v26, v26, v26 row_ror:4 row_mask:0xf bank_mask:0xf
    s_nop 1
    v_max_f32_dpp v26, v26, v26 row_ror:2 row_mask:0xf bank_mask:0xf
    s_nop 1
    v_max_f32_dpp v26, v26, v26 row_ror:1 row_mask:0xf bank_mask:0xf
    v_mov_b32 v28, v26
    s_nop 1
    v_permlane32_swap_b32 v26, v28
    v_max_f32 v26, v26, v28
    v_mov_b32 v28, v26
    s_nop 1
    v_permlane16_swap_b32 v26, v28
    v_max_f32 v26, v26, v28
    v_mul_f32 v26, v26, v18
    v_fma_f32 v24, v24, v18, -v26
    v_fma_f32 v25, v25, v18, -v26
    v_exp_f32 v24, v24
    v_exp_f32 v25, v25
    s_nop 0
    v_cvt_pk_bf16_f32 v28, v24, v25
    ds_write_b16 v19, v28
    ds_write_b16_d16_hi v19, v28 offset:128
    s_mov_b32 exec_lo, 0xff00ff
    s_mov_b32 exec_hi, 0xff00ff00
    ds_read_b128 v[72:75], v27 offset:0
    ds_read_b128 v[76:79], v27 offset:64
    ds_read_b128 v[80:83], v27 offset:128
    ds_read_b128 v[84:87], v27 offset:192
    s_mov_b64 exec, -1
    v_add_f32 v27, v24, v25
    v_mov_b32 v40, 0
    v_mov_b32 v44, 0
    v_add_f32_dpp v27, v27, v27 row_ror:8 row_mask:0xf bank_mask:0xf
    v_mov_b32 v48, 0
    v_mov_b32 v52, 0
    v_add_f32_dpp v27, v27, v27 row_ror:4 row_mask:0xf bank_mask:0xf
    v_mov_b32 v56, 0
    v_mov_b32 v60, 0
    v_add_f32_dpp v27, v27, v27 row_ror:2 row_mask:0xf bank_mask:0xf
    s_lshl_b32 s78, s72, 3
    s_add_u32 s78, s78, 125440
    v_add_f32_dpp v27, v27, v27 row_ror:1 row_mask:0xf bank_mask:0xf
    v_mov_b32 v28, v27
    s_nop 1
    v_permlane32_swap_b32 v27, v28
    v_add_f32 v27, v27, v28
    v_mov_b32 v28, v27
    s_nop 1
    v_permlane16_swap_b32 v27, v28
    v_add_f32 v27, v27, v28
    v_mov_b32 v28, s78
    ds_write_b64 v28, v[26:27]
    s_waitcnt lgkmcnt(4)
    v_smfmac_f32_16x16x64_bf16 v[40:43], v[72:75], a[192:199], v14 abid:1
    v_smfmac_f32_16x16x64_bf16 v[44:47], v[72:75], a[200:207], v14 abid:1
    v_smfmac_f32_16x16x64_bf16 v[48:51], v[72:75], a[208:215], v14 abid:1
    v_smfmac_f32_16x16x64_bf16 v[52:55], v[72:75], a[216:223], v14 abid:1
    v_smfmac_f32_16x16x64_bf16 v[56:59], v[72:75], a[224:231], v14 abid:1
    v_smfmac_f32_16x16x64_bf16 v[60:63], v[72:75], a[232:239], v14 abid:1
    s_waitcnt lgkmcnt(3)
    v_smfmac_f32_16x16x64_bf16 v[40:43], v[76:79], v[112:119], v14 abid:1
    v_smfmac_f32_16x16x64_bf16 v[44:47], v[76:79], v[120:127], v14 abid:1
    v_smfmac_f32_16x16x64_bf16 v[48:51], v[76:79], v[128:135], v14 abid:1
    v_smfmac_f32_16x16x64_bf16 v[52:55], v[76:79], v[136:143], v14 abid:1
    v_smfmac_f32_16x16x64_bf16 v[56:59], v[76:79], v[144:151], v14 abid:1
    v_smfmac_f32_16x16x64_bf16 v[60:63], v[76:79], v[152:159], v14 abid:1
    s_waitcnt lgkmcnt(2)
    v_smfmac_f32_16x16x64_bf16 v[40:43], v[80:83], v[160:167], v14 abid:1
    v_smfmac_f32_16x16x64_bf16 v[44:47], v[80:83], v[168:175], v14 abid:1
    v_smfmac_f32_16x16x64_bf16 v[48:51], v[80:83], v[176:183], v14 abid:1
    v_smfmac_f32_16x16x64_bf16 v[52:55], v[80:83], v[184:191], v14 abid:1
    v_smfmac_f32_16x16x64_bf16 v[56:59], v[80:83], v[192:199], v14 abid:1
    v_smfmac_f32_16x16x64_bf16 v[60:63], v[80:83], v[200:207], v14 abid:1
ATT_LAST:
    s_waitcnt lgkmcnt(0)
    v_smfmac_f32_16x16x64_bf16 v[40:43], v[84:87], v[208:215], v14 abid:1
    v_smfmac_f32_16x16x64_bf16 v[44:47], v[84:87], v[216:223], v14 abid:1
    v_smfmac_f32_16x16x64_bf16 v[48:51], v[84:87], v[224:231], v14 abid:1
    v_smfmac_f32_16x16x64_bf16 v[52:55], v[84:87], v[232:239], v14 abid:1
    v_smfmac_f32_16x16x64_bf16 v[56:59], v[84:87], v[240:247], v14 abid:1
    v_smfmac_f32_16x16x64_bf16 v[60:63], v[84:87], v[248:255], v14 abid:1
    v_add_u32 v24, 119296, v1
    v_mov_b32 v25, 125440
    v_lshlrev_b32 v39, 6, v0
    s_nop 0
    v_permlane16_swap_b32 v40, v44
    v_add_f32 v40, v40, v44
    ds_write_b32 v15, v40 offset:0
    v_permlane16_swap_b32 v48, v52
    v_add_f32 v48, v48, v52
    ds_write_b32 v15, v48 offset:256
    v_permlane16_swap_b32 v56, v60
    v_add_f32 v56, v56, v60
    ds_write_b32 v15, v56 offset:512
    s_cmp_lg_u32 s72, 0
    s_waitcnt lgkmcnt(0)
    s_barrier
    s_cbranch_scc1 ODONE
    ds_read_b128 v[64:67], v25
    ds_read_b128 v[68:71], v25 offset:16
    ds_read_b128 v[40:43], v24 offset:0
    ds_read_b128 v[44:47], v24 offset:768
    ds_read_b128 v[48:51], v24 offset:1536
    ds_read_b128 v[52:55], v24 offset:2304
    s_mul_i32 s77, s70, 3072
    s_lshl_b32 s78, s71, 4
    s_add_u32 s77, s77, s78
    s_add_u32 s77, s77, s3
    s_add_u32 s77, s77, 32768
    s_lshl_b32 s78, s69, 3
    s_add_u32 s78, s78, s3
    s_add_u32 s78, s78, 45056
    s_waitcnt lgkmcnt(4)
    v_max3_f32 v32, v64, v66, v68
    v_max_f32 v32, v32, v70
    v_sub_f32 v64, v64, v32
    v_sub_f32 v66, v66, v32
    v_sub_f32 v68, v68, v32
    v_sub_f32 v70, v70, v32
    v_exp_f32 v64, v64
    v_exp_f32 v66, v66
    v_exp_f32 v68, v68
    v_exp_f32 v70, v70
    s_waitcnt lgkmcnt(0)
    v_mul_f32 v28, v64, v40
    v_mul_f32 v29, v64, v41
    v_mul_f32 v30, v64, v42
    v_mul_f32 v31, v64, v43
    v_fmac_f32 v28, v66, v44
    v_fmac_f32 v29, v66, v45
    v_fmac_f32 v30, v66, v46
    v_fmac_f32 v31, v66, v47
    v_fmac_f32 v28, v68, v48
    v_fmac_f32 v29, v68, v49
    v_fmac_f32 v30, v68, v50
    v_fmac_f32 v31, v68, v51
    v_fmac_f32 v28, v70, v52
    v_fmac_f32 v29, v70, v53
    v_fmac_f32 v30, v70, v54
    v_fmac_f32 v31, v70, v55
    v_cvt_pk_bf16_f32 v28, v28, v29
    v_cvt_pk_bf16_f32 v29, v30, v31
    s_nop 0
    v_mov_b32_dpp v30, v28 quad_perm:[1,1,3,3] row_mask:0xf bank_mask:0xf
    v_mov_b32_dpp v31, v29 quad_perm:[1,1,3,3] row_mask:0xf bank_mask:0xf
    s_mov_b32 exec_lo, 0x55555555
    s_mov_b32 exec_hi, 0x5555
    s_cmp_eq_u32 s75, 1
    s_cbranch_scc0 SLOW9
    buffer_store_dwordx4 v[28:31], v39, s[16:19], s77 offen
BACK9:
    v_mul_f32 v33, v64, v65
    v_fmac_f32 v33, v66, v67
    v_fmac_f32 v33, v68, v69
    v_fmac_f32 v33, v70, v71
    s_mov_b64 exec, 1
    s_cmp_eq_u32 s75, 1
    s_cbranch_scc0 SLOW10
    buffer_store_dwordx2 v[32:33], v39, s[16:19], s78 offen
BACK10:
    s_mov_b64 exec, -1
ODONE:
    s_cmp_ge_u32 s69, 20
    s_cbranch_scc1 ROLEF
    v_accvgpr_read_b32 v2, a246
    v_accvgpr_read_b32 v3, a247
    v_accvgpr_read_b32 v4, a248
    v_mov_b32 v88, 0
    v_mov_b32 v92, 0
    v_mov_b32 v96, 0
    v_mov_b32 v100, 0
    v_mov_b32 v104, 0
    v_mov_b32 v108, 0
    ds_read_b64_tr_b16 v[40:41], v2 offset:0
    ds_read_b64_tr_b16 v[42:43], v2 offset:256
    ds_read_b64_tr_b16 v[64:65], v2 offset:32
    ds_read_b64_tr_b16 v[66:67], v2 offset:288
    ds_read_b64_tr_b16 v[44:45], v2 offset:2048
    ds_read_b64_tr_b16 v[46:47], v2 offset:2304
    ds_read_b64_tr_b16 v[68:69], v2 offset:2080
    ds_read_b64_tr_b16 v[70:71], v2 offset:2336
    ds_read_b64_tr_b16 v[48:49], v2 offset:4096
    ds_read_b64_tr_b16 v[50:51], v2 offset:4352
    s_cmp_lg_u32 s72, 1
    s_cbranch_scc1 NOOWN0
    s_cmp_eq_u32 s74, 0
    s_cbranch_scc1 NOOWN0
    v_accvgpr_read_b32 v28, a244
    v_accvgpr_read_b32 v29, a245
    v_max_u32 v30, v28, v29
    v_cmp_eq_u32 vcc, -1, v30
    s_cbranch_vccnz RETRY11
OK11:
    v_lshlrev_b32 v30, 16, v28
    v_and_b32 v28, 0xffff0000, v28
    v_lshlrev_b32 v31, 16, v29
    v_and_b32 v29, 0xffff0000, v29
    v_add_f32 v30, v30, v31
    v_add_f32 v28, v28, v29
    v_mov_b32 v31, v30
    v_mov_b32 v29, v28
    s_nop 0
    v_permlane32_swap_b32 v30, v31
    v_permlane32_swap_b32 v28, v29
    v_add_f32 v30, v30, v31
    v_add_f32 v28, v28, v29
    v_mov_b32 v31, v30
    v_mov_b32 v29, v28
    s_nop 0
    v_permlane16_swap_b32 v30, v31
    v_permlane16_swap_b32 v28, v29
    v_add_f32 v30, v30, v31
    v_add_f32 v28, v28, v29
    v_add_f32 v22, v22, v30
    v_add_f32 v23, v23, v28
    v_cvt_pk_bf16_f32 v28, v22, v23
    s_lshl_b32 s77, s69, 6
    s_add_u32 s77, s77, s3
    s_add_u32 s77, s77, 79360
    v_lshlrev_b32 v37, 2, v0
    v_mov_b32_dpp v29, v28 quad_perm:[1,1,1,1] row_mask:0xf bank_mask:0xf
    v_mov_b32_dpp v30, v28 quad_perm:[2,2,2,2] row_mask:0xf bank_mask:0xf
    v_mov_b32_dpp v31, v28 quad_perm:[3,3,3,3] row_mask:0xf bank_mask:0xf
    s_mov_b32 exec_lo, 0x1111
    s_mov_b32 exec_hi, 0x0
    s_cmp_eq_u32 s75, 1
    s_cbranch_scc0 SLOW12
    buffer_store_dwordx4 v[28:31], v37, s[16:19], s77 offen
BACK12:
    s_mov_b64 exec, -1
NOOWN0:
    s_mov_b32 s76, 1
    s_mov_b32 exec_lo, 0x00ff00ff
    s_mov_b32 exec_hi, 0x00ff00ff
    buffer_load_dwordx4 v[88:91], v3, s[16:19], s3 offen offset:0 sc1
    buffer_load_dwordx4 v[92:95], v3, s[16:19], s3 offen offset:512 sc1
    buffer_load_dwordx4 v[96:99], v3, s[16:19], s3 offen offset:1024 sc1
    buffer_load_dwordx4 v[100:103], v3, s[16:19], s3 offen offset:1536 sc1
    buffer_load_dwordx4 v[104:107], v3, s[16:19], s3 offen offset:2048 sc1
    buffer_load_dwordx4 v[108:111], v3, s[16:19], s3 offen offset:2560 sc1
    s_mov_b64 exec, -1
    buffer_load_dwordx4 v[24:27], v4, s[16:19], s3 offen offset:0 sc1
    buffer_load_dwordx4 v[36:39], v4, s[16:19], s3 offen offset:16 sc1
    ds_read_b64_tr_b16 v[72:73], v2 offset:4128
    ds_read_b64_tr_b16 v[74:75], v2 offset:4384
    ds_read_b64_tr_b16 v[52:53], v2 offset:6144
    ds_read_b64_tr_b16 v[54:55], v2 offset:6400
    ds_read_b64_tr_b16 v[76:77], v2 offset:6176
    ds_read_b64_tr_b16 v[78:79], v2 offset:6432
    ds_read_b64_tr_b16 v[56:57], v2 offset:8192
    ds_read_b64_tr_b16 v[58:59], v2 offset:8448
    ds_read_b64_tr_b16 v[80:81], v2 offset:8224
    ds_read_b64_tr_b16 v[82:83], v2 offset:8480
    ds_read_b64_tr_b16 v[60:61], v2 offset:10240
    ds_read_b64_tr_b16 v[62:63], v2 offset:10496
    ds_read_b64_tr_b16 v[84:85], v2 offset:10272
    ds_read_b64_tr_b16 v[86:87], v2 offset:10528
    v_accvgpr_read_b32 v5, a249
    v_add_u32 v6, 119296, v1
    v_lshrrev_b32 v18, 1, v1
    s_branch POLLW13
POLL13:
    s_mov_b32 exec_lo, 0x00ff00ff
    s_mov_b32 exec_hi, 0x00ff00ff
    buffer_load_dwordx4 v[88:91], v3, s[16:19], s3 offen offset:0 sc1
    buffer_load_dwordx4 v[92:95], v3, s[16:19], s3 offen offset:512 sc1
    buffer_load_dwordx4 v[96:99], v3, s[16:19], s3 offen offset:1024 sc1
    buffer_load_dwordx4 v[100:103], v3, s[16:19], s3 offen offset:1536 sc1
    buffer_load_dwordx4 v[104:107], v3, s[16:19], s3 offen offset:2048 sc1
    buffer_load_dwordx4 v[108:111], v3, s[16:19], s3 offen offset:2560 sc1
    s_mov_b64 exec, -1
    buffer_load_dwordx4 v[24:27], v4, s[16:19], s3 offen offset:0 sc1
    buffer_load_dwordx4 v[36:39], v4, s[16:19], s3 offen offset:16 sc1
POLLW13:
    s_waitcnt vmcnt(0)
    v_max3_u32 v28, v88, v92, v96
    v_max3_u32 v28, v28, v100, v104
    v_max3_u32 v28, v28, v108, v25
    v_max3_u32 v28, v28, v27, v37
    v_max_u32 v28, v28, v39
    v_cmp_eq_u32 vcc, -1, v28
    s_cbranch_vccnz AGAIN13
POLLX13:
    s_waitcnt lgkmcnt(0)
    v_mfma_f32_16x16x32_bf16 v[28:31], v[88:91], v[40:43], 0
    v_mfma_f32_16x16x32_bf16 v[32:35], v[88:91], v[64:67], 0
    v_max3_f32 v88, v24, v26, v36
    v_max_f32 v88, v88, v38
    v_mfma_f32_16x16x32_bf16 v[28:31], v[92:95], v[44:47], v[28:31]
    v_mov_b32 v89, v88
    v_mfma_f32_16x16x32_bf16 v[32:35], v[92:95], v[68:71], v[32:35]
    s_nop 0
    v_permlane16_swap_b32 v88, v89
    v_max_f32 v88, v88, v89
    v_mfma_f32_16x16x32_bf16 v[28:31], v[96:99], v[48:51], v[28:31]
    v_sub_f32 v24, v24, v88
    v_sub_f32 v26, v26, v88
    v_mfma_f32_16x16x32_bf16 v[32:35], v[96:99], v[72:75], v[32:35]
    v_sub_f32 v36, v36, v88
    v_sub_f32 v38, v38, v88
    v_mfma_f32_16x16x32_bf16 v[28:31], v[100:103], v[52:55], v[28:31]
    v_exp_f32 v24, v24
    v_mfma_f32_16x16x32_bf16 v[32:35], v[100:103], v[76:79], v[32:35]
    v_exp_f32 v26, v26
    v_mfma_f32_16x16x32_bf16 v[28:31], v[104:107], v[56:59], v[28:31]
    v_exp_f32 v36, v36
    v_mfma_f32_16x16x32_bf16 v[32:35], v[104:107], v[80:83], v[32:35]
    v_exp_f32 v38, v38
    v_mfma_f32_16x16x32_bf16 v[28:31], v[108:111], v[60:63], v[28:31]
    v_mul_f32 v90, v24, v25
    v_fmac_f32 v90, v26, v27
    v_mfma_f32_16x16x32_bf16 v[32:35], v[108:111], v[84:87], v[32:35]
    v_fmac_f32 v90, v36, v37
    v_fmac_f32 v90, v38, v39
    v_mov_b32 v89, v90
    s_cmp_lg_u32 s72, 0
    s_nop 0
    v_permlane16_swap_b32 v90, v89
    v_add_f32 v90, v90, v89
    v_rcp_f32 v90, v90
    v_mul_f32 v28, v24, v28
    v_mul_f32 v32, v24, v32
    v_fmac_f32 v28, v26, v29
    v_fmac_f32 v32, v26, v33
    v_fmac_f32 v28, v36, v30
    v_fmac_f32 v32, v36, v34
    v_fmac_f32 v28, v38, v31
    v_fmac_f32 v32, v38, v35
    s_nop 1
    v_permlane16_swap_b32 v28, v32
    v_add_f32 v28, v28, v32
    v_mul_f32 v28, v28, v90
    ds_write_b32 v5, v28
    s_waitcnt lgkmcnt(0)
    s_barrier
    s_cbranch_scc1 WNOT0
    ds_read_b128 v[40:43], v6 offset:3072
    ds_read_b128 v[44:47], v6 offset:3328
    ds_read_b128 v[48:51], v6 offset:3584
    ds_read_b128 v[52:55], v6 offset:3840
    s_waitcnt lgkmcnt(2)
    v_add_f32 v28, v40, v44
    v_add_f32 v29, v41, v45
    v_add_f32 v30, v42, v46
    v_add_f32 v31, v43, v47
    s_waitcnt lgkmcnt(0)
    v_add_f32 v32, v48, v52
    v_add_f32 v33, v49, v53
    v_add_f32 v34, v50, v54
    v_add_f32 v35, v51, v55
    v_add_f32 v28, v28, v32
    v_add_f32 v29, v29, v33
    v_add_f32 v30, v30, v34
    v_add_f32 v31, v31, v35
    v_cvt_pk_bf16_f32 v28, v28, v29
    v_cvt_pk_bf16_f32 v29, v30, v31
    s_nop 0
    v_mov_b32_dpp v30, v28 quad_perm:[1,1,3,3] row_mask:0xf bank_mask:0xf
    v_mov_b32_dpp v31, v29 quad_perm:[1,1,3,3] row_mask:0xf bank_mask:0xf
    s_mov_b32 exec_lo, 0x55
    s_mov_b32 exec_hi, 0x0
    buffer_store_dwordx4 v[28:31], v18, s[16:19], s80 offen sc1
    s_cmp_eq_u32 s75, 1
    s_cbranch_scc0 SLOW14
    buffer_store_dwordx4 v[28:31], v18, s[16:19], s81 offen
BACK14:
    s_mov_b64 exec, -1
    v_lshrrev_b32 v37, 5, v0
    v_mul_u32_u24 v37, 2560, v37
    v_and_b32 v38, 31, v0
    v_lshl_add_u32 v37, v38, 2, v37
    v_add_u32 v41, 5120, v37
    v_add_u32 v42, 10240, v37
    v_add_u32 v43, 15360, v37
    v_add_u32 v44, 20480, v37
    v_add_u32 v45, 25600, v37
    s_lshl_b32 s79, s69, 7
    s_add_u32 s79, s79, s3
    s_add_u32 s79, s79, 46080
    s_add_u32 s96, s80, 10240
    s_add_u32 s97, s81, 1280
    v_lshlrev_b32 v39, 1, v0
    s_mov_b32 s76, 1
POLL15:
    buffer_load_dword v28, v37, s[16:19], s79 offen sc1
    buffer_load_dword v29, v41, s[16:19], s79 offen sc1
    buffer_load_dword v30, v42, s[16:19], s79 offen sc1
    buffer_load_dword v31, v43, s[16:19], s79 offen sc1
    buffer_load_dword v32, v44, s[16:19], s79 offen sc1
    buffer_load_dword v33, v45, s[16:19], s79 offen sc1
POLLW15:
    s_waitcnt vmcnt(0)
    v_max3_u32 v36, v28, v29, v30
    v_max3_u32 v36, v36, v31, v32
    v_max_u32 v36, v36, v33
    v_cmp_eq_u32 vcc, -1, v36
    s_cbranch_vccnz AGAIN15
POLLX15:
    v_add_f32 v28, v28, v29
    v_add_f32 v30, v30, v31
    v_add_f32 v32, v32, v33
    v_add_f32 v28, v28, v30
    v_add_f32 v28, v28, v32
    v_mov_b32 v29, v28
    s_nop 1
    v_permlane32_swap_b32 v28, v29
    v_add_f32 v28, v28, v29
    s_nop 1
    v_mov_b32_dpp v29, v28 row_shl:1 row_mask:0xf bank_mask:0xf
    v_cvt_pk_bf16_f32 v28, v28, v29
    s_nop 1
    v_mov_b32_dpp v29, v28 row_shl:2 row_mask:0xf bank_mask:0xf
    v_mov_b32_dpp v30, v28 row_shl:4 row_mask:0xf bank_mask:0xf
    v_mov_b32_dpp v31, v28 row_shl:6 row_mask:0xf bank_mask:0xf
    s_mov_b32 exec_lo, 0x1010101
    s_mov_b32 exec_hi, 0x0
    buffer_store_dwordx4 v[28:31], v39, s[16:19], s96 offen sc1
    s_cmp_eq_u32 s75, 1
    s_cbranch_scc0 SLOW16
    buffer_store_dwordx4 v[28:31], v39, s[16:19], s97 offen
BACK16:
    s_mov_b64 exec, -1
    s_branch NEXT
AGAIN5:
    s_add_u32 s76, s76, 1
    s_cmp_lt_u32 s76, 32768
    s_cbranch_scc1 POLL5
    s_branch POLLX5
AGAIN6:
    s_add_u32 s76, s76, 1
    s_cmp_lt_u32 s76, 32768
    s_cbranch_scc1 POLL6
    s_branch POLLX6
AGAIN8:
    s_add_u32 s76, s76, 1
    s_cmp_lt_u32 s76, 32768
    s_cbranch_scc1 POLL8
    s_branch POLLX8
AGAIN13:
    s_add_u32 s76, s76, 1
    s_cmp_lt_u32 s76, 32768
    s_cbranch_scc1 POLL13
    s_branch POLLX13
AGAIN15:
    s_add_u32 s76, s76, 1
    s_cmp_lt_u32 s76, 32768
    s_cbranch_scc1 POLL15
    s_branch POLLX15
WNOT0:
    s_cmp_lg_u32 s72, 1
    s_cbranch_scc1 NEXT
    v_and_b32 v25, 15, v0
    v_lshrrev_b32 v26, 4, v0
    v_mul_u32_u24 v37, 1280, v26
    v_add_u32 v37, 655360, v37
    s_mul_i32 s7, s68, 81920
    s_add_u32 s7, s7, 76800
    v_mov_b32 v38, s7
    v_cmp_eq_u32 vcc, s68, v26
    s_nop 1
    v_cndmask_b32 v37, v37, v38, vcc
    v_add_u32 v39, 4, v26
    v_mul_u32_u24 v38, 1280, v39
    v_add_u32 v38, 655360, v38
    s_mul_i32 s7, s68, 81920
    s_add_u32 s7, s7, 76800
    v_mov_b32 v28, s7
    v_cmp_eq_u32 vcc, s68, v39
    s_nop 1
    v_cndmask_b32 v38, v38, v28, vcc
    s_lshl_b32 s77, s69, 6
    s_add_u32 s77, s77, s74
    v_lshl_add_u32 v37, v25, 2, v37
    v_lshl_add_u32 v38, v25, 2, v38
    s_sleep 16
    s_mov_b32 s76, 1
POLL17:
    buffer_load_dword v28, v37, s[16:19], s77 offen sc1
    buffer_load_dword v29, v38, s[16:19], s77 offen sc1
POLLW17:
    s_waitcnt vmcnt(0)
    v_max_u32 v30, v28, v29
    v_cmp_eq_u32 vcc, -1, v30
    s_cbranch_vccnz AGAIN17
POLLX17:
    v_lshlrev_b32 v30, 16, v28
    v_and_b32 v28, 0xffff0000, v28
    v_lshlrev_b32 v31, 16, v29
    v_and_b32 v29, 0xffff0000, v29
    v_add_f32 v30, v30, v31
    v_add_f32 v28, v28, v29
    v_mov_b32 v31, v30
    v_mov_b32 v29, v28
    s_nop 0
    v_permlane32_swap_b32 v30, v31
    v_permlane32_swap_b32 v28, v29
    v_add_f32 v30, v30, v31
    v_add_f32 v28, v28, v29
    v_mov_b32 v31, v30
    v_mov_b32 v29, v28
    s_nop 0
    v_permlane16_swap_b32 v30, v31
    v_permlane16_swap_b32 v28, v29
    v_add_f32 v30, v30, v31
    v_add_f32 v28, v28, v29
    v_add_f32 v22, v22, v30
    v_add_f32 v23, v23, v28
    v_cvt_pk_bf16_f32 v28, v22, v23
    s_cmp_lg_u32 s74, 0
    s_cbranch_scc1 FINAL
    s_lshl_b32 s77, s69, 6
    s_add_u32 s77, s77, s3
    s_add_u32 s77, s77, 80640
    v_lshlrev_b32 v37, 2, v0
    v_mov_b32_dpp v29, v28 quad_perm:[1,1,1,1] row_mask:0xf bank_mask:0xf
    v_mov_b32_dpp v30, v28 quad_perm:[2,2,2,2] row_mask:0xf bank_mask:0xf
    v_mov_b32_dpp v31, v28 quad_perm:[3,3,3,3] row_mask:0xf bank_mask:0xf
    s_mov_b32 exec_lo, 0x1111
    s_mov_b32 exec_hi, 0x0
    s_cmp_eq_u32 s75, 1
    s_cbranch_scc0 SLOW18
    buffer_store_dwordx4 v[28:31], v37, s[16:19], s77 offen
BACK18:
    s_mov_b64 exec, -1
    s_branch NEXT
FINAL:
    s_cmp_lg_u32 s68, 0
    s_cbranch_scc1 DONE
    s_lshl_b32 s77, s69, 6
    v_lshlrev_b32 v37, 2, v0
    s_add_u32 s79, s77, s3
    s_add_u32 s79, s79, 78080
    s_mov_b64 exec, 15
    s_mov_b32 s76, 1
POLL19:
    buffer_load_dword v28, v1, s[16:19], s79 offen sc1
POLLW19:
    s_waitcnt vmcnt(0)
    v_cmp_eq_u32 vcc, -1, v28
    s_cbranch_vccnz AGAIN19
POLLX19:
    s_mov_b64 exec, -1
    s_mov_b32 s76, 1
POLL20:
    buffer_load_dword v28, v20, s[16:19], s74 offen sc1
    buffer_load_dword v29, v21, s[16:19], s74 offen sc1
POLLW20:
    s_waitcnt vmcnt(0)
    v_max_u32 v30, v28, v29
    v_cmp_eq_u32 vcc, -1, v30
    s_cbranch_vccnz AGAIN20
POLLX20:
    v_lshlrev_b32 v30, 16, v28
    v_and_b32 v28, 0xffff0000, v28
    v_lshlrev_b32 v31, 16, v29
    v_and_b32 v29, 0xffff0000, v29
    v_add_f32 v30, v30, v31
    v_add_f32 v28, v28, v29
    v_mov_b32 v31, v30
    v_mov_b32 v29, v28
    s_nop 0
    v_permlane32_swap_b32 v30, v31
    v_permlane32_swap_b32 v28, v29
    v_add_f32 v30, v30, v31
    v_add_f32 v28, v28, v29
    v_mov_b32 v31, v30
    v_mov_b32 v29, v28
    s_nop 0
    v_permlane16_swap_b32 v30, v31
    v_permlane16_swap_b32 v28, v29
    v_add_f32 v30, v30, v31
    v_add_f32 v28, v28, v29
    v_add_f32 v22, v22, v30
    v_add_f32 v23, v23, v28
    v_cvt_pk_bf16_f32 v28, v22, v23
    s_mov_b32 exec_lo, 0xffff
    s_mov_b32 exec_hi, 0x0
    buffer_store_dword v28, v37, s[40:43], s77 offen
    s_mov_b64 exec, -1
    s_endpgm
AGAIN17:
    s_sleep 4
    s_add_u32 s76, s76, 1
    s_cmp_lt_u32 s76, 32768
    s_cbranch_scc1 POLL17
    s_branch POLLX17
AGAIN19:
    s_add_u32 s76, s76, 1
    s_cmp_lt_u32 s76, 32768
    s_cbranch_scc1 POLL19
    s_branch POLLX19
AGAIN20:
    s_add_u32 s76, s76, 1
    s_cmp_lt_u32 s76, 32768
    s_cbranch_scc1 POLL20
    s_branch POLLX20
ROLEF:
    v_and_b32 v25, 15, v0
    v_lshrrev_b32 v26, 4, v0
    v_bfe_u32 v27, v0, 2, 2
    v_and_b32 v36, 3, v0
    s_mov_b32 s4, 1
    s_cmp_lg_u32 s74, 0
    s_cbranch_scc1 FW
    s_mov_b32 s4, 0
    v_mov_b32 v86, v25
    v_lshrrev_b32 v24, 1, v0
    v_mul_u32_u24 v24, 3072, v24
    v_and_b32 v25, 1, v0
    v_lshl_add_u32 v24, v25, 4, v24
    s_mul_i32 s79, s68, 12
    s_add_u32 s79, s79, s69
    s_sub_u32 s79, s79, 20
    s_mul_i32 s77, s72, 491520
    s_lshl_b32 s78, s79, 5
    s_add_u32 s77, s77, s78
    s_mul_i32 s78, s72, 5120
    s_add_u32 m0, s78, 57344
    s_nop 0
    buffer_load_dwordx4 v24, s[24:27], s77 offen  lds
    s_add_u32 m0, s78, 77824
    s_nop 0
    buffer_load_dwordx4 v24, s[28:31], s77 offen  lds
    s_add_u32 s77, s77, 98304
    s_add_u32 m0, s78, 58368
    s_nop 0
    buffer_load_dwordx4 v24, s[24:27], s77 offen  lds
    s_add_u32 m0, s78, 78848
    s_nop 0
    buffer_load_dwordx4 v24, s[28:31], s77 offen  lds
    s_add_u32 s77, s77, 98304
    s_add_u32 m0, s78, 59392
    s_nop 0
    buffer_load_dwordx4 v24, s[24:27], s77 offen  lds
    s_add_u32 m0, s78, 79872
    s_nop 0
    buffer_load_dwordx4 v24, s[28:31], s77 offen  lds
    s_add_u32 s77, s77, 98304
    s_add_u32 m0, s78, 60416
    s_nop 0
    buffer_load_dwordx4 v24, s[24:27], s77 offen  lds
    s_add_u32 m0, s78, 80896
    s_nop 0
    buffer_load_dwordx4 v24, s[28:31], s77 offen  lds
    s_add_u32 s77, s77, 98304
    s_add_u32 m0, s78, 61440
    s_nop 0
    buffer_load_dwordx4 v24, s[24:27], s77 offen  lds
    s_add_u32 m0, s78, 81920
    s_nop 0
    buffer_load_dwordx4 v24, s[28:31], s77 offen  lds
    s_mul_i32 s77, s79, 20480
    s_add_u32 s77, s77, s78
    s_add_u32 m0, s78, 98304
    s_nop 0
    buffer_load_dwordx4 v1, s[32:35], s77 offen nt lds
    s_add_u32 s77, s77, 1024
    s_add_u32 m0, s78, 99328
    s_nop 0
    buffer_load_dwordx4 v1, s[32:35], s77 offen nt lds
    s_add_u32 s77, s77, 1024
    s_add_u32 m0, s78, 100352
    s_nop 0
    buffer_load_dwordx4 v1, s[32:35], s77 offen nt lds
    s_add_u32 s77, s77, 1024
    s_add_u32 m0, s78, 101376
    s_nop 0
    buffer_load_dwordx4 v1, s[32:35], s77 offen nt lds
    s_add_u32 s77, s77, 1024
    s_add_u32 m0, s78, 102400
    s_nop 0
    buffer_load_dwordx4 v1, s[32:35], s77 offen nt lds
    v_mov_b32 v25, v86
    s_waitcnt vmcnt(0)
FW:
    s_mul_i32 s77, s72, 5120
    s_add_u32 s77, s77, 57344
    v_lshl_add_u32 v37, v26, 3, v27
    v_lshlrev_b32 v37, 5, v37
    v_lshl_add_u32 v37, v36, 3, v37
    v_add_u32 v37, s77, v37
    ds_read_b64_tr_b16 v[40:41], v37 offset:0
    ds_read_b64_tr_b16 v[42:43], v37 offset:128
    ds_read_b64_tr_b16 v[44:45], v37 offset:1024
    ds_read_b64_tr_b16 v[46:47], v37 offset:1152
    ds_read_b64_tr_b16 v[48:49], v37 offset:2048
    ds_read_b64_tr_b16 v[50:51], v37 offset:2176
    ds_read_b64_tr_b16 v[52:53], v37 offset:3072
    ds_read_b64_tr_b16 v[54:55], v37 offset:3200
    ds_read_b64_tr_b16 v[56:57], v37 offset:4096
    ds_read_b64_tr_b16 v[58:59], v37 offset:4224
    ds_read_b64_tr_b16 v[60:61], v37 offset:20480
    ds_read_b64_tr_b16 v[62:63], v37 offset:20608
    ds_read_b64_tr_b16 v[64:65], v37 offset:21504
    ds_read_b64_tr_b16 v[66:67], v37 offset:21632
    ds_read_b64_tr_b16 v[68:69], v37 offset:22528
    ds_read_b64_tr_b16 v[70:71], v37 offset:22656
    ds_read_b64_tr_b16 v[72:73], v37 offset:23552
    ds_read_b64_tr_b16 v[74:75], v37 offset:23680
    ds_read_b64_tr_b16 v[76:77], v37 offset:24576
    ds_read_b64_tr_b16 v[78:79], v37 offset:24704
    s_mul_i32 s77, s72, 320
    s_add_u32 s77, s77, 98304
    v_lshrrev_b32 v80, 2, v0
    v_mul_u32_u24 v80, 1280, v80
    v_lshl_add_u32 v80, v36, 3, v80
    v_add_u32 v80, s77, v80
    s_lshl_b32 s79, s72, 2
    s_add_u32 s79, s79, 123392
    v_add_u32 v81, s79, v1
    v_lshl_add_u32 v82, v26, 2, v36
    v_lshlrev_b32 v82, 4, v82
    v_add_u32 v82, 123392, v82
    v_cmp_eq_u32 vcc, 12, v25
    v_mov_b32 v38, 13
    s_nop 0
    v_cndmask_b32 v83, v25, v38, vcc
    v_lshlrev_b32 v83, 4, v83
    v_add_u32 v83, 123904, v83
    v_mov_b32 v85, 124096
    v_lshlrev_b32 v84, 6, v25
    v_lshl_add_u32 v84, v26, 4, v84
    v_mov_b32 v38, 0x3f803f80
    v_cndmask_b32 v88, 0, v38, vcc
    v_mov_b32 v89, v88
    v_mov_b32 v90, v88
    v_mov_b32 v91, v88
    v_mov_b32 v92, v88
    v_mov_b32 v93, v88
    v_mov_b32 v94, v88
    v_mov_b32 v95, v88
    v_mov_b32 v96, v88
    v_mov_b32 v97, v88
    v_mov_b32 v98, v88
    v_mov_b32 v99, v88
    v_mov_b32 v100, v88
    v_mov_b32 v101, v88
    v_mov_b32 v102, v88
    v_mov_b32 v103, v88
    v_mov_b32 v104, v88
    v_mov_b32 v105, v88
    v_mov_b32 v106, v88
    v_mov_b32 v107, v88
    s_mul_i32 s77, s72, 6656
    v_mul_u32_u24 v6, 336, v25
    v_lshl_add_u32 v6, v26, 4, v6
    v_add_u32 v6, s77, v6
    v_mul_u32_u24 v37, 52, v0
    v_lshrrev_b32 v37, 10, v37
    v_lshl_add_u32 v87, v37, 4, v1
    v_add_u32 v87, s77, v87
    v_mul_u32_u24 v27, 320, v37
    v_sub_u32 v27, v1, v27
    v_mul_u32_u24 v86, 1280, v37
    v_add_u32 v86, 655360, v86
    s_mul_i32 s7, s68, 81920
    s_add_u32 s7, s7, 76800
    v_mov_b32 v38, s7
    v_cmp_eq_u32 vcc, s68, v37
    s_nop 1
    v_cndmask_b32 v86, v86, v38, vcc
    v_add_u32 v38, 2560, v38
    v_cmp_le_u32 vcc, 8, v37
    s_nop 1
    v_cndmask_b32 v86, v86, v38, vcc
    v_add_u32 v86, v86, v27
    v_add_u32 v37, 3, v37
    v_mul_u32_u24 v18, 1280, v37
    v_add_u32 v18, 655360, v18
    s_mul_i32 s7, s68, 81920
    s_add_u32 s7, s7, 76800
    v_mov_b32 v38, s7
    v_cmp_eq_u32 vcc, s68, v37
    s_nop 1
    v_cndmask_b32 v18, v18, v38, vcc
    v_add_u32 v38, 2560, v38
    v_cmp_le_u32 vcc, 8, v37
    s_nop 1
    v_cndmask_b32 v18, v18, v38, vcc
    v_add_u32 v18, v18, v27
    v_add_u32 v37, 3, v37
    v_mul_u32_u24 v20, 1280, v37
    v_add_u32 v20, 655360, v20
    s_mul_i32 s7, s68, 81920
    s_add_u32 s7, s7, 76800
    v_mov_b32 v38, s7
    v_cmp_eq_u32 vcc, s68, v37
    s_nop 1
    v_cndmask_b32 v20, v20, v38, vcc
    v_add_u32 v38, 2560, v38
    v_cmp_le_u32 vcc, 8, v37
    s_nop 1
    v_cndmask_b32 v20, v20, v38, vcc
    v_add_u32 v20, v20, v27
    s_mul_i32 s77, s72, 320
    s_add_u32 s77, s77, s74
    s_sub_u32 s78, s69, 20
    s_mul_i32 s78, s78, 2560
    s_mul_i32 s7, s72, 640
    s_add_u32 s78, s78, s7
    s_add_u32 s78, s78, s3
    s_add_u32 s78, s78, 46080
    s_waitcnt lgkmcnt(0)
    s_cmp_eq_u32 s4, 0
    s_cbranch_scc1 FMM
FPOLL:
    ds_read_b64_tr_b16 a[240:241], v80 offset:0
    ds_read_b64_tr_b16 a[242:243], v80 offset:32
    ds_read_b64_tr_b16 a[244:245], v80 offset:64
    ds_read_b64_tr_b16 a[246:247], v80 offset:96
    ds_read_b64_tr_b16 a[248:249], v80 offset:128
    ds_read_b64_tr_b16 a[250:251], v80 offset:160
    ds_read_b64_tr_b16 v[108:109], v80 offset:192
    ds_read_b64_tr_b16 v[110:111], v80 offset:224
    ds_read_b64_tr_b16 v[2:3], v80 offset:256
    ds_read_b64_tr_b16 v[4:5], v80 offset:288
    s_waitcnt lgkmcnt(0)
    s_mul_i32 s79, s72, 320
    s_add_u32 s79, s79, s3
    s_add_u32 s79, s79, 76800
    s_mov_b32 exec_lo, 0xfffff
    s_mov_b32 exec_hi, 0x0
    s_mov_b32 s76, 1
POLL21:
    buffer_load_dword v36, v1, s[16:19], s79 offen sc1
POLLW21:
    s_waitcnt vmcnt(0)
    v_cmp_eq_u32 vcc, -1, v36
    s_cbranch_vccnz AGAIN21
POLLX21:
    s_mov_b32 exec_lo, 0xffffffff
    s_mov_b32 exec_hi, 0xfffffff
    s_mov_b32 s76, 1
POLL22:
    buffer_load_dwordx4 v[24:27], v86, s[16:19], s77 offen sc1
    buffer_load_dwordx4 v[28:31], v18, s[16:19], s77 offen sc1
    buffer_load_dwordx4 v[32:35], v20, s[16:19], s77 offen sc1
POLLW22:
    s_waitcnt vmcnt(0)
    v_max3_u32 v36, v24, v28, v32
    v_cmp_eq_u32 vcc, -1, v36
    s_cbranch_vccnz AGAIN22
POLLX22:
    ds_write_b128 v87, v[24:27] offset:0
    ds_write_b128 v87, v[28:31] offset:1008
    ds_write_b128 v87, v[32:35] offset:2016
    s_mov_b32 exec_lo, 0x1ff01ff
    s_mov_b32 exec_hi, 0x1ff01ff
    ds_read_b128 v[88:91], v6 offset:0
    ds_read_b128 v[92:95], v6 offset:64
    ds_read_b128 v[96:99], v6 offset:128
    ds_read_b128 v[100:103], v6 offset:192
    ds_read_b128 v[104:107], v6 offset:256
    s_mov_b64 exec, -1
FMM:
    s_waitcnt lgkmcnt(4)
    v_mfma_f32_16x16x32_bf16 v[24:27], v[88:91], v[40:43], 0
    v_mfma_f32_16x16x32_bf16 v[28:31], v[88:91], v[60:63], 0
    v_mfma_f32_16x16x32_bf16 v[32:35], v[88:91], v[88:91], 0
    s_waitcnt lgkmcnt(3)
    v_mfma_f32_16x16x32_bf16 v[24:27], v[92:95], v[44:47], v[24:27]
    v_mfma_f32_16x16x32_bf16 v[28:31], v[92:95], v[64:67], v[28:31]
    v_mfma_f32_16x16x32_bf16 v[32:35], v[92:95], v[92:95], v[32:35]
    s_waitcnt lgkmcnt(2)
    v_mfma_f32_16x16x32_bf16 v[24:27], v[96:99], v[48:51], v[24:27]
    v_mfma_f32_16x16x32_bf16 v[28:31], v[96:99], v[68:71], v[28:31]
    v_mfma_f32_16x16x32_bf16 v[32:35], v[96:99], v[96:99], v[32:35]
    s_waitcnt lgkmcnt(1)
    v_mfma_f32_16x16x32_bf16 v[24:27], v[100:103], v[52:55], v[24:27]
    v_mfma_f32_16x16x32_bf16 v[28:31], v[100:103], v[72:75], v[28:31]
    v_mfma_f32_16x16x32_bf16 v[32:35], v[100:103], v[100:103], v[32:35]
    s_waitcnt lgkmcnt(0)
    v_mfma_f32_16x16x32_bf16 v[24:27], v[104:107], v[56:59], v[24:27]
    v_mfma_f32_16x16x32_bf16 v[28:31], v[104:107], v[76:79], v[28:31]
    v_mfma_f32_16x16x32_bf16 v[32:35], v[104:107], v[104:107], v[32:35]
    s_nop 5
    v_add_f32 v24, v24, v25
    v_add_f32 v26, v26, v27
    v_add_f32 v28, v28, v29
    v_add_f32 v30, v30, v31
    v_add_f32 v32, v32, v33
    v_add_f32 v34, v34, v35
    v_add_f32 v24, v24, v26
    v_add_f32 v28, v28, v30
    v_add_f32 v32, v32, v34
    s_nop 1
    v_permlane32_swap_b32 v24, v32
    v_permlane32_swap_b32 v28, v25
    v_add_f32 v24, v24, v32
    v_add_f32 v28, v28, v25
    s_nop 1
    v_permlane16_swap_b32 v24, v28
    v_add_f32 v24, v24, v28
    ds_write_b32 v81, v24
    s_cmp_eq_u32 s4, 0
    s_waitcnt lgkmcnt(0)
    s_barrier
    ds_read_b128 v[24:27], v83
    ds_read_b128 v[28:31], v85
    ds_read_b128 v[32:35], v82
    ds_read_b128 v[36:39], v82 offset:256
    s_cbranch_scc1 FCS
    s_waitcnt lgkmcnt(3)
    v_add_f32 v24, v24, v25
    v_add_f32 v26, v26, v27
    v_add_f32 v24, v24, v26
    s_waitcnt lgkmcnt(2)
    v_add_f32 v28, v28, v29
    v_add_f32_dpp v24, v24, v24 row_ror:8 row_mask:0xf bank_mask:0xf
    v_add_f32 v30, v30, v31
    v_add_f32 v28, v28, v30
    v_add_f32_dpp v24, v24, v24 row_ror:4 row_mask:0xf bank_mask:0xf
    s_waitcnt lgkmcnt(0)
    v_subrev_f32 v29, 0x44200000, v28
    v_add_f32_dpp v24, v24, v24 row_ror:2 row_mask:0xf bank_mask:0xf
    v_add_f32 v32, v32, v33
    v_mul_f32 v30, 0x3acccccd, v29
    v_add_f32_dpp v24, v24, v24 row_ror:1 row_mask:0xf bank_mask:0xf
    v_add_f32 v34, v34, v35
    v_sub_f32 v24, v24, v29
    v_add_f32 v32, v32, v34
    v_mul_f32 v24, 0x3acccccd, v24
    v_add_f32 v36, v36, v37
    v_fma_f32 v24, -v30, v30, v24
    v_add_f32 v38, v38, v39
    v_max_f32 v24, 0, v24
    v_fma_f32 v32, -v28, v22, v32
    v_add_f32 v24, 0x3727c5ac, v24
    v_add_f32 v36, v36, v38
    v_rsq_f32 v24, v24
    v_fma_f32 v36, -v28, v23, v36
    v_mul_f32 v33, 0xbfb8aa3b, v32
    v_mul_f32 v33, v33, v24
    v_mul_f32 v36, v36, v32
    v_exp_f32 v33, v33
    v_mul_f32 v36, v36, v24
    v_add_f32 v33, 1.0, v33
    v_mul_f32 v36, v36, v24
    v_rcp_f32 v33, v33
    s_nop 0
    v_mul_f32 v36, v36, v33
    s_nop 1
    v_mov_b32_dpp v28, v36 quad_perm:[0,0,0,0] row_mask:0xf bank_mask:0xf
    v_mov_b32_dpp v29, v36 quad_perm:[1,1,1,1] row_mask:0xf bank_mask:0xf
    v_mov_b32_dpp v30, v36 quad_perm:[2,2,2,2] row_mask:0xf bank_mask:0xf
    v_mov_b32_dpp v31, v36 quad_perm:[3,3,3,3] row_mask:0xf bank_mask:0xf
    v_cvt_pk_bf16_f32 v28, v28, v29
    v_cvt_pk_bf16_f32 v29, v30, v31
    v_cndmask_b32 v60, 0, v28, s[44:45]
    v_cndmask_b32 v61, 0, v29, s[44:45]
    v_cndmask_b32 v62, 0, v28, s[46:47]
    v_cndmask_b32 v63, 0, v29, s[46:47]
    v_cndmask_b32 v64, 0, v28, s[48:49]
    v_cndmask_b32 v65, 0, v29, s[48:49]
    v_mfma_f32_16x16x32_bf16 v[24:27], a[240:243], v[60:63], 0
    v_cndmask_b32 v66, 0, v28, s[50:51]
    v_cndmask_b32 v67, 0, v29, s[50:51]
    v_cndmask_b32 v68, 0, v28, s[52:53]
    v_cndmask_b32 v69, 0, v29, s[52:53]
    v_mfma_f32_16x16x32_bf16 v[24:27], a[244:247], v[64:67], v[24:27]
    v_cndmask_b32 v70, 0, v28, s[54:55]
    v_cndmask_b32 v71, 0, v29, s[54:55]
    v_cndmask_b32 v72, 0, v28, s[56:57]
    v_cndmask_b32 v73, 0, v29, s[56:57]
    v_mfma_f32_16x16x32_bf16 v[24:27], a[248:251], v[68:71], v[24:27]
    v_cndmask_b32 v74, 0, v28, s[58:59]
    v_cndmask_b32 v75, 0, v29, s[58:59]
    v_cndmask_b32 v76, 0, v28, s[60:61]
    v_cndmask_b32 v77, 0, v29, s[60:61]
    v_mfma_f32_16x16x32_bf16 v[24:27], v[108:111], v[72:75], v[24:27]
    v_cndmask_b32 v78, 0, v28, s[62:63]
    v_cndmask_b32 v79, 0, v29, s[62:63]
    s_nop 1
    v_mfma_f32_16x16x32_bf16 v[24:27], v[2:5], v[76:79], v[24:27]
    s_mov_b32 exec_lo, 0x3ff03ff
    s_mov_b32 exec_hi, 0x3ff03ff
    s_cmp_eq_u32 s75, 1
    s_cbranch_scc0 SLOW23
    s_nop 3
    buffer_store_dwordx4 v[24:27], v84, s[16:19], s78 offen
BACK23:
    s_mov_b64 exec, -1
NEXT:
    s_cmp_lg_u32 s74, 0
    s_cbranch_scc1 DONE
    s_mov_b32 s74, 688128
    s_add_u32 s3, s3, 688128
    s_add_u32 s80, s80, 688128
    s_add_u32 s81, s81, 688128
    s_branch LOOP
AGAIN21:
    s_add_u32 s76, s76, 1
    s_cmp_lt_u32 s76, 32768
    s_cbranch_scc1 POLL21
    s_branch POLLX21
AGAIN22:
    s_add_u32 s76, s76, 1
    s_cmp_lt_u32 s76, 32768
    s_cbranch_scc1 POLL22
    s_branch POLLX22
DONE:
    s_endpgm
RDYLOOP:
    s_mov_b32 s76, 0
RDYL2:
    s_sleep 8
    global_load_dword v99, v98, s[64:65] sc1
    s_waitcnt vmcnt(0)
    v_sad_u8 v100, v99, 0, 0
    s_nop 1
    v_add_u32_dpp v100, v100, v100 quad_perm:[1,0,3,2] row_mask:0xf bank_mask:0xf
    s_nop 1
    v_add_u32_dpp v100, v100, v100 quad_perm:[2,3,0,1] row_mask:0xf bank_mask:0xf
    v_cmp_gt_u32 vcc, 32, v100
    s_mov_b32 vcc_hi, 0
    s_cmp_eq_u64 vcc, 0
    s_cbranch_scc1 RDYOK
    s_add_u32 s76, s76, 1
    s_cmp_lt_u32 s76, 32768
    s_cbranch_scc1 RDYL2
    s_branch RDYOK
SLOW1:
    buffer_store_dword v24, v10, s[16:19], s79 offen sc1
    s_branch BACK1
SLOW2:
    buffer_store_dword v24, v10, s[16:19], s3 offen sc1
    s_branch BACK2
SLOW3:
    buffer_store_dwordx4 v[28:31], v27, s[16:19], s77 offen sc1
    s_branch BACK3
DMAF:
    s_sub_u32 s77, s69, 20
    s_lshl_b32 s77, s77, 1
    s_and_b32 s78, s72, 1
    s_add_u32 s77, s77, s78
    s_mul_i32 s77, s77, 640
    v_add_u32 v36, s77, v0
    s_mul_i32 s78, s68, 384
    v_mul_u32_u24 v37, 43691, v36
    v_lshrrev_b32 v37, 20, v37
    v_mul_u32_u24 v37, 2688, v37
    v_lshl_add_u32 v37, v36, 4, v37
    buffer_load_dwordx4 a[240:243], v37, s[36:39], s78 offen
    v_add_u32 v36, 64, v36
    v_mul_u32_u24 v37, 43691, v36
    v_lshrrev_b32 v37, 20, v37
    v_mul_u32_u24 v37, 2688, v37
    v_lshl_add_u32 v37, v36, 4, v37
    buffer_load_dwordx4 a[240:243], v37, s[36:39], s78 offen
    v_add_u32 v36, 64, v36
    v_mul_u32_u24 v37, 43691, v36
    v_lshrrev_b32 v37, 20, v37
    v_mul_u32_u24 v37, 2688, v37
    v_lshl_add_u32 v37, v36, 4, v37
    buffer_load_dwordx4 a[240:243], v37, s[36:39], s78 offen
    v_add_u32 v36, 64, v36
    v_mul_u32_u24 v37, 43691, v36
    v_lshrrev_b32 v37, 20, v37
    v_mul_u32_u24 v37, 2688, v37
    v_lshl_add_u32 v37, v36, 4, v37
    buffer_load_dwordx4 a[240:243], v37, s[36:39], s78 offen
    v_add_u32 v36, 64, v36
    v_mul_u32_u24 v37, 43691, v36
    v_lshrrev_b32 v37, 20, v37
    v_mul_u32_u24 v37, 2688, v37
    v_lshl_add_u32 v37, v36, 4, v37
    buffer_load_dwordx4 a[240:243], v37, s[36:39], s78 offen
    v_add_u32 v36, 64, v36
    v_mul_u32_u24 v37, 43691, v36
    v_lshrrev_b32 v37, 20, v37
    v_mul_u32_u24 v37, 2688, v37
    v_lshl_add_u32 v37, v36, 4, v37
    buffer_load_dwordx4 a[240:243], v37, s[36:39], s78 offen
    v_add_u32 v36, 64, v36
    v_mul_u32_u24 v37, 43691, v36
    v_lshrrev_b32 v37, 20, v37
    v_mul_u32_u24 v37, 2688, v37
    v_lshl_add_u32 v37, v36, 4, v37
    buffer_load_dwordx4 a[240:243], v37, s[36:39], s78 offen
    v_add_u32 v36, 64, v36
    v_mul_u32_u24 v37, 43691, v36
    v_lshrrev_b32 v37, 20, v37
    v_mul_u32_u24 v37, 2688, v37
    v_lshl_add_u32 v37, v36, 4, v37
    buffer_load_dwordx4 a[240:243], v37, s[36:39], s78 offen
    v_add_u32 v36, 64, v36
    v_mul_u32_u24 v37, 43691, v36
    v_lshrrev_b32 v37, 20, v37
    v_mul_u32_u24 v37, 2688, v37
    v_lshl_add_u32 v37, v36, 4, v37
    buffer_load_dwordx4 a[240:243], v37, s[36:39], s78 offen
    v_add_u32 v36, 64, v36
    v_mul_u32_u24 v37, 43691, v36
    v_lshrrev_b32 v37, 20, v37
    v_mul_u32_u24 v37, 2688, v37
    v_lshl_add_u32 v37, v36, 4, v37
    buffer_load_dwordx4 a[240:243], v37, s[36:39], s78 offen
    s_branch DMAX
RETRY4:
    s_add_u32 s77, s3, 1376256
    s_add_u32 s78, s3, 1380352
    s_add_u32 s79, s3, 4096
    s_mov_b32 s76, 1
POLL24:
    buffer_load_dwordx4 v[64:67], v11, s[16:19], s77 offen sc1
    buffer_load_dwordx4 v[68:71], v11, s[16:19], s78 offen sc1
    buffer_load_dwordx4 v[72:75], v11, s[16:19], s3 offen sc1
    buffer_load_dwordx4 v[76:79], v11, s[16:19], s79 offen sc1
POLLW24:
    s_waitcnt vmcnt(0)
    v_max3_u32 v24, v64, v65, v66
    v_max3_u32 v24, v24, v67, v68
    v_max3_u32 v24, v24, v69, v70
    v_max3_u32 v24, v24, v71, v72
    v_max3_u32 v24, v24, v73, v74
    v_max3_u32 v24, v24, v75, v76
    v_max3_u32 v24, v24, v77, v78
    v_max_u32 v24, v24, v79
    v_cmp_eq_u32 vcc, -1, v24
    s_cbranch_vccnz AGAIN24
POLLX24:
    s_branch OK4
AGAIN24:
    s_add_u32 s76, s76, 1
    s_cmp_lt_u32 s76, 32768
    s_cbranch_scc1 POLL24
    s_branch POLLX24
SLOW7:
    buffer_store_dword v24, v10, s[16:19], s3 offen sc1
    s_branch BACK7
SLOW9:
    buffer_store_dwordx4 v[28:31], v39, s[16:19], s77 offen sc1
    s_branch BACK9
SLOW10:
    buffer_store_dwordx2 v[32:33], v39, s[16:19], s78 offen sc1
    s_branch BACK10
RETRY11:
    s_mov_b32 s76, 1
POLL25:
    buffer_load_dword v28, v20, s[16:19], 0 offen sc1
    buffer_load_dword v29, v21, s[16:19], 0 offen sc1
POLLW25:
    s_waitcnt vmcnt(0)
    v_max_u32 v30, v28, v29
    v_cmp_eq_u32 vcc, -1, v30
    s_cbranch_vccnz AGAIN25
POLLX25:
    s_branch OK11
AGAIN25:
    s_add_u32 s76, s76, 1
    s_cmp_lt_u32 s76, 32768
    s_cbranch_scc1 POLL25
    s_branch POLLX25
SLOW12:
    buffer_store_dwordx4 v[28:31], v37, s[16:19], s77 offen sc1
    s_branch BACK12
SLOW14:
    buffer_store_dwordx4 v[28:31], v18, s[16:19], s81 offen sc1
    s_branch BACK14
SLOW16:
    buffer_store_dwordx4 v[28:31], v39, s[16:19], s97 offen sc1
    s_branch BACK16
SLOW18:
    buffer_store_dwordx4 v[28:31], v37, s[16:19], s77 offen sc1
    s_branch BACK18
SLOW23:
    s_nop 3
    buffer_store_dwordx4 v[24:27], v84, s[16:19], s78 offen sc1
    s_branch BACK23
FCS:
    s_waitcnt lgkmcnt(0)
    v_add_f32 v32, v32, v33
    v_add_f32 v34, v34, v35
    v_add_f32 v32, v32, v34
    v_add_f32 v36, v36, v37
    v_add_f32 v38, v38, v39
    v_add_f32 v36, v36, v38
    v_mul_f32 v22, 0x3acccccd, v32
    v_mul_f32 v23, 0x3acccccd, v36
    s_mov_b32 s4, 1
    s_barrier
    s_branch FPOLL
CODE_END:
    s_endpgm
.section .rodata,"a"
.p2align 6
.amdhsa_kernel interleave_layers__sliding_block_cached__glu_gated_swiglu__decode_kernel
  .amdhsa_next_free_vgpr 512
  .amdhsa_next_free_sgpr 102
  .amdhsa_accum_offset 256
  .amdhsa_group_segment_fixed_size 0
  .amdhsa_kernarg_size 96
  .amdhsa_user_sgpr_count 2
  .amdhsa_user_sgpr_kernarg_segment_ptr 1
  .amdhsa_system_sgpr_workgroup_id_x 1
.end_amdhsa_kernel
```

```asm
; @launch grid=(256,1,1) block=(256,1,1) lds=125568
.amdgcn_target "amdgcn-amd-amdhsa--gfx950"
.text
.globl interleave_layers__sliding_block_cached__glu_gated_swiglu__decode_kernel
.p2align 8
.type interleave_layers__sliding_block_cached__glu_gated_swiglu__decode_kernel,@function
interleave_layers__sliding_block_cached__glu_gated_swiglu__decode_kernel:
    s_load_dwordx16 s[44:59], s[0:1], 0
    s_load_dwordx8 s[60:67], s[0:1], 64
    s_cmp_ge_u32 s2, 256
    s_cbranch_scc1 CODE_END
    v_lshrrev_b32 v2, 6, v0
    v_and_b32 v24, 63, v0
    v_readfirstlane_b32 s72, v2
    s_and_b32 s68, s2, 7
    s_lshr_b32 s69, s2, 3
    s_lshr_b32 s70, s69, 3
    s_and_b32 s71, s69, 7
    v_lshlrev_b32 v1, 4, v24
    s_lshl_b32 s77, s70, 3
    s_add_u32 s77, s77, s68
    s_mul_i32 s73, s77, 12582912
    s_lshl_b32 s78, s71, 2
    s_add_u32 s78, s78, s72
    s_mul_i32 s78, s78, 6144
    s_add_u32 s73, s73, s78
    s_add_u32 s73, s73, 11010048
    v_add_u32 v23, 4096, v1
    s_mov_b32 s10, 402653184
    s_mov_b32 s11, 0x20000
    s_getpc_b64 s[100:101]
PCREF:
    s_sub_u32 s100, s100, PCREF-interleave_layers__sliding_block_cached__glu_gated_swiglu__decode_kernel
    s_subb_u32 s101, s101, 0
    s_lshl_b32 s78, s71, 12
    v_lshl_add_u32 v25, v0, 4, s78
    v_cmp_gt_u32 vcc, CODE_END-interleave_layers__sliding_block_cached__glu_gated_swiglu__decode_kernel-16, v25
    s_nop 0
    s_and_saveexec_b64 s[98:99], vcc
    s_cbranch_execz NOCPF
    global_load_dwordx4 a[240:243], v25, s[100:101]
NOCPF:
    s_mov_b64 exec, -1
    s_waitcnt lgkmcnt(0)
    s_mov_b32 s8, s46
    s_and_b32 s9, s47, 0xffff
    buffer_load_dwordx4 a[0:3], v1, s[8:11], s73 offen offset:0 nt
    buffer_load_dwordx4 a[4:7], v1, s[8:11], s73 offen offset:1024 nt
    buffer_load_dwordx4 a[8:11], v1, s[8:11], s73 offen offset:2048 nt
    buffer_load_dwordx4 a[12:15], v1, s[8:11], s73 offen offset:3072 nt
    buffer_load_dwordx4 a[16:19], v23, s[8:11], s73 offen offset:0 nt
    buffer_load_dwordx4 a[20:23], v23, s[8:11], s73 offen offset:1024 nt
    v_mov_b32 v110, 125504
    v_mov_b32 v111, 1
    v_mov_b32 v28, 0
    v_mov_b32 v29, 0
    v_mov_b32 v30, 0
    v_mov_b32 v31, 0
    ds_write_b128 v110, v[28:31]
    s_add_u32 s83, s73, 196608
    buffer_load_dwordx4 a[24:27], v1, s[8:11], s83 offen offset:0 nt
    buffer_load_dwordx4 a[28:31], v1, s[8:11], s83 offen offset:1024 nt
    s_mul_i32 s79, s77, 384
    s_mov_b32 s74, 0
    s_mul_i32 s3, s68, 81920
    s_mov_b32 s75, 0
    v_mov_b32 v32, -1
    v_mov_b32 v33, -1
    v_mov_b32 v34, -1
    v_mov_b32 v35, -1
    s_mul_i32 s77, s69, 2560
    s_add_u32 s77, s77, s3
    v_lshl_add_u32 v20, v0, 4, s77
    v_cmp_le_u32 vcc, 160, v0
    v_add_u32 v25, 685568, v20
    s_nop 0
    v_cndmask_b32 v20, v20, v25, vcc
    s_add_u32 s77, s77, 689664
    s_lshl_b32 s78, s69, 10
    s_add_u32 s78, s78, s3
    s_add_u32 s78, s78, 1376256
    s_cmp_eq_u32 s72, 0
    s_cselect_b32 s4, s77, s78
    s_mul_i32 s77, s2, 80
    s_add_u32 s77, s77, 655360
    s_cmp_ge_u32 s72, 2
    s_cselect_b32 s4, s77, s4
    v_add_u32 v25, 688048, v1
    v_cmp_le_u32 vcc, 133, v0
    s_nop 1
    v_cndmask_b32 v21, v1, v25, vcc
    v_mov_b32 v25, 1879048176
    v_cmp_le_u32 vcc, 138, v0
    s_nop 1
    v_cndmask_b32 v21, v21, v25, vcc
    s_waitcnt lgkmcnt(0)
    s_barrier
    s_mov_b32 s16, s66
    s_and_b32 s17, s67, 0xffff
    s_mov_b32 s18, 1610612736
    s_mov_b32 s19, 0x20000
    buffer_store_dwordx4 v[32:35], v20, s[16:19], 0 offen sc1
    buffer_store_dwordx4 v[32:35], v21, s[16:19], s4 offen sc1
    buffer_load_dwordx4 a[32:35], v1, s[8:11], s83 offen offset:2048 nt
    buffer_load_dwordx4 a[36:39], v1, s[8:11], s83 offen offset:3072 nt
    buffer_load_dwordx4 a[40:43], v23, s[8:11], s83 offen offset:0 nt
    buffer_load_dwordx4 a[44:47], v23, s[8:11], s83 offen offset:1024 nt
    s_mov_b32 s12, s48
    s_and_b32 s13, s49, 0xffff
    s_mov_b32 s14, 402653184
    s_mov_b32 s15, 0x20000
    s_mov_b32 s20, s50
    s_and_b32 s21, s51, 0xffff
    s_mov_b32 s22, 7864320
    s_mov_b32 s23, 0x20000
    s_mov_b32 s36, s44
    s_and_b32 s37, s45, 0xffff
    s_mov_b32 s38, 1280
    s_mov_b32 s39, 0x20000
    s_mov_b32 s40, s62
    s_and_b32 s41, s63, 0xffff
    s_mov_b32 s42, 1280
    s_mov_b32 s43, 0x20000
    s_mov_b32 s28, s58
    s_and_b32 s29, s59, 0xffff
    s_mov_b32 s30, 1966080
    s_mov_b32 s31, 0x20000
    s_mov_b32 s32, s60
    s_and_b32 s33, s61, 0xffff
    s_mov_b32 s34, 1966080
    s_mov_b32 s35, 0x20000
    s_cmp_lt_u32 s69, 20
    s_cselect_b32 s24, s52, s56
    s_cselect_b32 s25, s53, s57
    s_cselect_b32 s26, s22, s30
    s_and_b32 s25, s25, 0xffff
    s_mov_b32 s27, 0x20000
    s_add_u32 s84, s83, 196608
    s_add_u32 s85, s84, 196608
    s_add_u32 s86, s85, 196608
    s_add_u32 s87, s86, 196608
    s_add_u32 s88, s87, 196608
    s_add_u32 s89, s88, 196608
    v_mov_b32 v0, v24
    s_mul_i32 s77, s72, 6656
    v_add_u32 v25, 0, v0
    v_mul_u32_u24 v26, 171, v25
    v_lshrrev_b32 v26, 12, v26
    v_mul_u32_u24 v27, 24, v26
    v_sub_u32 v27, v25, v27
    v_lshlrev_b32 v27, 4, v27
    v_mul_u32_u24 v25, 416, v26
    v_add3_u32 v2, v25, v27, s77
    v_mul_u32_u24 v25, 12288, v26
    v_add_u32 v40, v25, v27
    v_mul_u32_u24 v25, 3072, v26
    v_add_u32 v101, v25, v27
    v_add_u32 v25, 64, v0
    v_mul_u32_u24 v26, 171, v25
    v_lshrrev_b32 v26, 12, v26
    v_mul_u32_u24 v27, 24, v26
    v_sub_u32 v27, v25, v27
    v_lshlrev_b32 v27, 4, v27
    v_mul_u32_u24 v25, 416, v26
    v_add3_u32 v3, v25, v27, s77
    v_mul_u32_u24 v25, 12288, v26
    v_add_u32 v41, v25, v27
    v_mul_u32_u24 v25, 3072, v26
    v_add_u32 v102, v25, v27
    v_add_u32 v25, 128, v0
    v_mul_u32_u24 v26, 171, v25
    v_lshrrev_b32 v26, 12, v26
    v_mul_u32_u24 v27, 24, v26
    v_sub_u32 v27, v25, v27
    v_lshlrev_b32 v27, 4, v27
    v_mul_u32_u24 v25, 416, v26
    v_add3_u32 v4, v25, v27, s77
    v_mul_u32_u24 v25, 12288, v26
    v_add_u32 v42, v25, v27
    v_mul_u32_u24 v25, 3072, v26
    v_add_u32 v103, v25, v27
    s_mul_i32 s78, s71, 983040
    s_add_u32 s79, s79, s78
    s_mul_i32 s78, s72, 98304
    s_add_u32 s79, s79, s78
    s_mul_i32 s78, s72, 3072
    s_add_u32 s78, s78, 26624
    s_add_u32 m0, s78, 0
    s_nop 0
    buffer_load_dwordx4 v40, s[20:23], s79 offen nt lds
    s_add_u32 m0, s78, 1024
    s_nop 0
    buffer_load_dwordx4 v41, s[20:23], s79 offen nt lds
    s_add_u32 m0, s78, 2048
    s_nop 0
    buffer_load_dwordx4 v42, s[20:23], s79 offen nt lds
    s_add_u32 s79, s79, 393216
    s_add_u32 m0, s78, 12288
    s_nop 0
    buffer_load_dwordx4 v40, s[20:23], s79 offen nt lds
    s_add_u32 m0, s78, 13312
    s_nop 0
    buffer_load_dwordx4 v41, s[20:23], s79 offen nt lds
    s_add_u32 m0, s78, 14336
    s_nop 0
    buffer_load_dwordx4 v42, s[20:23], s79 offen nt lds
    s_add_u32 s79, s79, 393216
    s_cmp_ge_u32 s72, 2
    s_cbranch_scc1 NOWQ3
    s_add_u32 m0, s78, 24576
    s_nop 0
    buffer_load_dwordx4 v40, s[20:23], s79 offen nt lds
    s_add_u32 m0, s78, 25600
    s_nop 0
    buffer_load_dwordx4 v41, s[20:23], s79 offen nt lds
    s_add_u32 m0, s78, 26624
    s_nop 0
    buffer_load_dwordx4 v42, s[20:23], s79 offen nt lds
NOWQ3:
    v_and_b32 v25, 15, v0
    v_lshrrev_b32 v26, 4, v0
    v_bfe_u32 v27, v0, 2, 2
    v_and_b32 v28, 3, v0
    v_cmp_eq_u32 vcc, 12, v25
    v_mov_b32 v36, 0x3f803f80
    s_nop 0
    v_cndmask_b32 v70, 0, v36, vcc
    v_mov_b32 v71, v70
    v_mov_b32 v72, v70
    v_mov_b32 v73, v70
    v_mov_b32 v74, v70
    v_mov_b32 v75, v70
    v_mov_b32 v76, v70
    v_mov_b32 v77, v70
    v_mov_b32 v78, v70
    v_mov_b32 v79, v70
    v_mov_b32 v88, v70
    v_mov_b32 v89, v70
    v_mov_b32 v90, v70
    v_mov_b32 v91, v70
    v_mov_b32 v92, v70
    v_mov_b32 v93, v70
    v_mov_b32 v94, v70
    v_mov_b32 v95, v70
    v_mov_b32 v96, v70
    v_mov_b32 v97, v70
    s_mul_i32 s78, s71, 160
    v_lshlrev_b32 v36, 4, v26
    v_lshlrev_b32 v37, 3, v26
    s_mov_b32 exec_lo, 0x1000100
    s_mov_b32 exec_hi, 0x1000100
    buffer_load_dwordx4 v[88:91], v36, s[36:39], s78 offen
    buffer_load_dwordx4 v[92:95], v36, s[36:39], s78 offen offset:64
    buffer_load_dwordx2 v[96:97], v37, s[36:39], s78 offen offset:128
    s_mov_b64 exec, -1
    s_lshl_b32 s79, s69, 6
    v_lshlrev_b32 v38, 2, v25
    buffer_load_dword v22, v38, s[36:39], s79 offen
    s_mov_b32 s20, s52
    s_and_b32 s21, s53, 0xffff
    s_mov_b32 s22, 7864320
    s_mov_b32 s23, 0x20000
    s_cmp_lt_u32 s72, 2
    s_cselect_b32 s36, s56, s58
    s_cselect_b32 s37, s57, s59
    s_and_b32 s37, s37, 0xffff
    s_mov_b32 s38, 1966080
    s_lshl_b32 s90, s70, 3
    s_add_u32 s90, s90, s68
    s_lshl_b32 s90, s90, 3
    s_add_u32 s90, s90, s71
    s_mul_i32 s90, s90, 30720
    s_mul_i32 s79, s72, 6144
    s_add_u32 s90, s90, s79
    s_cmp_eq_u32 s72, 3
    s_cselect_b32 s79, 3072, 0
    s_add_u32 s90, s90, s79
    s_cmp_lt_u32 s72, 2
    s_cselect_b32 s79, 1879048176, 0
    v_add_u32 v108, s79, v23
    v_add_u32 v109, 4096, v108
    s_and_b32 s91, s72, 1
    s_lshl_b32 s79, s69, 1
    s_add_u32 s91, s91, s79
    s_mul_i32 s79, s91, 0
    s_add_u32 s79, s79, 640
    s_mul_i32 s91, s91, 16
    s_cmp_lt_u32 s69, 20
    s_cselect_b32 s91, s91, s79
    s_mov_b32 s7, 49152
    s_cselect_b32 s7, s7, 0
    s_mul_i32 s91, s91, 3072
    s_mul_i32 s79, s68, 384
    s_add_u32 s91, s91, s79
    v_mov_b32 v29, 1879048176
    v_add_u32 v104, 24576, v101
    v_add_u32 v105, 24576, v102
    v_add_u32 v106, 24576, v103
    v_cmp_gt_u32 vcc, s7, v101
    s_nop 1
    v_cndmask_b32 v101, v29, v101, vcc
    v_cmp_gt_u32 vcc, s7, v102
    s_nop 1
    v_cndmask_b32 v102, v29, v102, vcc
    v_cmp_gt_u32 vcc, s7, v103
    s_nop 1
    v_cndmask_b32 v103, v29, v103, vcc
    v_cmp_gt_u32 vcc, s7, v104
    s_nop 1
    v_cndmask_b32 v104, v29, v104, vcc
    v_cmp_gt_u32 vcc, s7, v105
    s_nop 1
    v_cndmask_b32 v105, v29, v105, vcc
    v_cmp_gt_u32 vcc, s7, v106
    s_nop 1
    v_cndmask_b32 v106, v29, v106, vcc
    buffer_load_dwordx4 a[48:51], v1, s[8:11], s84 offen offset:0 nt
    buffer_load_dwordx4 a[52:55], v1, s[8:11], s84 offen offset:1024 nt
    buffer_load_dwordx4 a[56:59], v1, s[8:11], s84 offen offset:2048 nt
    s_waitcnt vmcnt(17)
    s_mov_b64 exec, 1
    ds_add_rtn_u32 v36, v110, v111
    s_mov_b64 exec, -1
    s_getreg_b32 s5, hwreg(HW_REG_XCC_ID, 0, 4)
    s_lshr_b32 s92, s5, 2
    s_lshl_b32 s93, s68, 2
    s_add_u32 s92, s92, s93
    s_and_b32 s93, s5, 3
    s_lshl_b32 s93, s93, 3
    s_lshl_b32 s94, 1, s93
    s_lshl_b32 s96, 32, s93
    s_mov_b32 s5, s92
    s_waitcnt lgkmcnt(0)
    v_readfirstlane_b32 s93, v36
    s_nop 0
    s_cmp_lg_u32 s93, 3
    s_cbranch_scc1 NOATOM
    s_lshl_b32 s92, s92, 2
    v_mov_b32 v36, s92
    v_mov_b32 v37, s94
    s_mov_b64 exec, 1
    global_atomic_add v36, v37, s[64:65] sc1
    s_mov_b64 exec, -1
NOATOM:
    v_mul_u32_u24 v29, 416, v25
    v_lshl_add_u32 v29, v26, 4, v29
    v_add_u32 v5, s77, v29
    v_lshrrev_b32 v29, 2, v0
    v_mul_u32_u24 v29, 416, v29
    v_lshl_add_u32 v29, v28, 3, v29
    v_add_u32 v6, s77, v29
    s_mul_i32 s79, s72, 96
    s_add_u32 s79, s79, 26624
    v_lshl_add_u32 v29, v26, 3, v27
    v_mul_u32_u24 v29, 384, v29
    v_lshl_add_u32 v29, v28, 3, v29
    v_add_u32 v16, s79, v29
    v_lshl_add_u32 v29, v26, 2, v27
    v_mul_u32_u24 v29, 384, v29
    v_lshl_add_u32 v29, v28, 3, v29
    v_add_u32 v17, s79, v29
    buffer_load_dwordx4 a[60:63], v1, s[8:11], s84 offen offset:3072 nt
    v_mul_u32_u24 v31, 103, v0
    v_lshrrev_b32 v31, 10, v31
    v_mul_u32_u24 v30, 10, v31
    v_sub_u32 v30, v0, v30
    v_lshl_add_u32 v29, v30, 4, s78
    v_mul_u32_u24 v8, 1280, v31
    v_add_u32 v8, 665600, v8
    s_mul_i32 s7, s68, 81920
    s_add_u32 s7, s7, 78080
    v_mov_b32 v30, s7
    v_cmp_eq_u32 vcc, s68, v31
    s_nop 1
    v_cndmask_b32 v8, v8, v30, vcc
    v_add_u32 v30, 2560, v30
    v_cmp_le_u32 vcc, 8, v31
    s_nop 1
    v_cndmask_b32 v8, v8, v30, vcc
    v_add_u32 v8, v8, v29
    v_add_u32 v31, 6, v31
    v_mul_u32_u24 v9, 1280, v31
    v_add_u32 v9, 665600, v9
    s_mul_i32 s7, s68, 81920
    s_add_u32 s7, s7, 78080
    v_mov_b32 v30, s7
    v_cmp_eq_u32 vcc, s68, v31
    s_nop 1
    v_cndmask_b32 v9, v9, v30, vcc
    v_add_u32 v30, 2560, v30
    v_cmp_le_u32 vcc, 8, v31
    s_nop 1
    v_cndmask_b32 v9, v9, v30, vcc
    v_add_u32 v9, v9, v29
    v_mov_b32 v30, 2147483632
    v_cmp_le_u32 vcc, 30, v0
    s_nop 1
    v_cndmask_b32 v9, v9, v30, vcc
    s_lshl_b32 s78, s69, 10
    s_lshl_b32 s79, s72, 8
    s_add_u32 s78, s78, s79
    v_lshl_add_u32 v10, v0, 2, s78
    s_lshl_b32 s78, s70, 13
    s_add_u32 s78, s78, s79
    v_lshlrev_b32 v29, 10, v26
    v_lshl_add_u32 v29, v25, 4, v29
    v_add_u32 v11, s78, v29
    buffer_load_dwordx4 a[64:67], v23, s[8:11], s84 offen offset:0 nt
    s_mul_i32 s78, s72, 96
    s_add_u32 s78, s78, 118784
    v_lshl_add_u32 v29, v27, 5, s78
    v_lshl_add_u32 v29, v28, 2, v29
    v_lshrrev_b32 v30, 1, v26
    v_lshl_add_u32 v29, v30, 4, v29
    v_and_b32 v30, 1, v26
    v_lshl_add_u32 v29, v30, 1, v29
    v_mov_b32 v30, 119168
    v_cmp_le_u32 vcc, 12, v25
    s_nop 1
    v_cndmask_b32 v12, v29, v30, vcc
    v_and_b32 v30, 1, v0
    v_lshlrev_b32 v29, 5, v26
    v_lshl_add_u32 v29, v30, 4, v29
    v_add_u32 v13, 118784, v29
    v_mul_u32_u24 v30, 0xaaaa, v30
    v_and_b32 v29, 1, v27
    v_mul_u32_u24 v29, 0xaaaa, v29
    v_lshl_or_b32 v29, v29, 16, v30
    v_add_u32 v14, 0x44444444, v29
    buffer_load_dwordx4 a[68:71], v23, s[8:11], s84 offen offset:1024 nt
    s_barrier
    s_lshl_b32 s78, s72, 8
    s_add_u32 s78, s78, 124416
    v_lshrrev_b32 v29, 5, v0
    v_lshl_add_u32 v29, v29, 6, s78
    v_bfe_u32 v30, v0, 3, 1
    v_lshl_add_u32 v29, v30, 5, v29
    v_bfe_u32 v30, v0, 1, 1
    v_lshl_add_u32 v29, v30, 4, v29
    v_bfe_u32 v30, v0, 2, 1
    v_lshl_add_u32 v29, v30, 3, v29
    v_bfe_u32 v30, v0, 4, 1
    v_lshl_add_u32 v29, v30, 2, v29
    v_bfe_u32 v30, v0, 0, 1
    v_lshl_add_u32 v29, v30, 1, v29
    v_mov_b32 v19, v29
    s_mul_i32 s78, s72, 768
    s_add_u32 s78, s78, 119296
    v_lshl_add_u32 v29, v25, 2, s78
    v_bfe_u32 v30, v0, 4, 1
    v_lshl_add_u32 v29, v30, 7, v29
    v_lshrrev_b32 v30, 5, v0
    v_lshl_add_u32 v15, v30, 6, v29
    s_mov_b32 s44, 0x10001
    s_mov_b32 s45, 0x10001
    s_mov_b32 s46, 0x20002
    s_mov_b32 s47, 0x20002
    s_mov_b32 s48, 0x40004
    s_mov_b32 s49, 0x40004
    s_mov_b32 s50, 0x80008
    s_mov_b32 s51, 0x80008
    s_mov_b32 s52, 0x100010
    s_mov_b32 s53, 0x100010
    s_mov_b32 s54, 0x200020
    s_mov_b32 s55, 0x200020
    s_mov_b32 s56, 0x400040
    s_mov_b32 s57, 0x400040
    s_mov_b32 s58, 0x800080
    s_mov_b32 s59, 0x800080
    s_mov_b32 s60, 0x1000100
    s_mov_b32 s61, 0x1000100
    s_mov_b32 s62, 0x2000200
    s_mov_b32 s63, 0x2000200
    ds_write_b128 v2, a[0:3] offset:0
    ds_write_b128 v3, a[4:7] offset:0
    ds_write_b128 v4, a[8:11] offset:0
    ds_write_b128 v2, a[12:15] offset:3328
    ds_write_b128 v3, a[16:19] offset:3328
    ds_write_b128 v4, a[20:23] offset:3328
    ds_read_b128 a[0:3], v5 offset:0
    ds_read_b128 a[4:7], v5 offset:64
    ds_read_b128 a[8:11], v5 offset:128
    ds_read_b128 a[12:15], v5 offset:192
    ds_read_b128 a[16:19], v5 offset:256
    ds_read_b128 a[20:23], v5 offset:320
    buffer_load_dwordx4 a[72:75], v1, s[8:11], s85 offen offset:0 nt
    buffer_load_dwordx4 a[76:79], v1, s[8:11], s85 offen offset:1024 nt
    buffer_load_dwordx4 a[80:83], v1, s[8:11], s85 offen offset:2048 nt
    buffer_load_dwordx4 a[84:87], v1, s[8:11], s85 offen offset:3072 nt
    buffer_load_dwordx4 a[88:91], v23, s[8:11], s85 offen offset:0 nt
    buffer_load_dwordx4 a[92:95], v23, s[8:11], s85 offen offset:1024 nt
    s_barrier
    s_waitcnt vmcnt(22)
    ds_write_b128 v2, a[24:27] offset:0
    ds_write_b128 v3, a[28:31] offset:0
    ds_write_b128 v4, a[32:35] offset:0
    ds_write_b128 v2, a[36:39] offset:3328
    ds_write_b128 v3, a[40:43] offset:3328
    ds_write_b128 v4, a[44:47] offset:3328
    ds_read_b128 a[24:27], v5 offset:0
    ds_read_b128 a[28:31], v5 offset:64
    ds_read_b128 a[32:35], v5 offset:128
    ds_read_b128 a[36:39], v5 offset:192
    ds_read_b128 a[40:43], v5 offset:256
    ds_read_b128 a[44:47], v5 offset:320
    buffer_load_dwordx4 a[240:243], v101, s[36:39], s91 offen
    buffer_load_dwordx4 a[240:243], v102, s[36:39], s91 offen
    buffer_load_dwordx4 a[240:243], v103, s[36:39], s91 offen
    buffer_load_dwordx4 a[240:243], v104, s[36:39], s91 offen
    buffer_load_dwordx4 a[240:243], v105, s[36:39], s91 offen
    buffer_load_dwordx4 a[240:243], v106, s[36:39], s91 offen
    s_barrier
    s_waitcnt vmcnt(12)
    ds_write_b128 v2, a[48:51] offset:0
    ds_write_b128 v3, a[52:55] offset:0
    ds_write_b128 v4, a[56:59] offset:0
    ds_write_b128 v2, a[60:63] offset:3328
    ds_write_b128 v3, a[64:67] offset:3328
    ds_write_b128 v4, a[68:71] offset:3328
    ds_read_b128 a[48:51], v5 offset:0
    ds_read_b128 a[52:55], v5 offset:64
    ds_read_b128 a[56:59], v5 offset:128
    ds_read_b128 a[60:63], v5 offset:192
    ds_read_b128 a[64:67], v5 offset:256
    ds_read_b128 a[68:71], v5 offset:320
    s_mov_b64 exec, 1
    ds_add_u32 v110, v111 offset:4
    s_mov_b64 exec, -1
    buffer_load_dwordx4 a[240:243], v1, s[20:23], s90 offen offset:0
    buffer_load_dwordx4 a[240:243], v1, s[20:23], s90 offen offset:1024
    buffer_load_dwordx4 a[240:243], v1, s[20:23], s90 offen offset:2048
    buffer_load_dwordx4 a[240:243], v1, s[20:23], s90 offen offset:3072
    buffer_load_dwordx4 a[240:243], v23, s[20:23], s90 offen offset:0
    buffer_load_dwordx4 a[240:243], v23, s[20:23], s90 offen offset:1024
    s_barrier
    buffer_load_dwordx4 a[240:243], v108, s[20:23], s90 offen offset:2048
    buffer_load_dwordx4 a[240:243], v108, s[20:23], s90 offen offset:3072
    buffer_load_dwordx4 a[240:243], v109, s[20:23], s90 offen offset:0
    s_waitcnt vmcnt(15)
    ds_write_b128 v2, a[72:75] offset:0
    ds_write_b128 v3, a[76:79] offset:0
    ds_write_b128 v4, a[80:83] offset:0
    ds_write_b128 v2, a[84:87] offset:3328
    ds_write_b128 v3, a[88:91] offset:3328
    ds_write_b128 v4, a[92:95] offset:3328
    ds_read_b128 a[72:75], v5 offset:0
    ds_read_b128 a[76:79], v5 offset:64
    ds_read_b128 a[80:83], v5 offset:128
    ds_read_b128 a[84:87], v5 offset:192
    ds_read_b128 a[88:91], v5 offset:256
    ds_read_b128 a[92:95], v5 offset:320
    v_lshlrev_b32 v98, 2, v0
    global_load_dword v99, v98, s[64:65] sc1
    buffer_load_dwordx4 a[96:99], v1, s[8:11], s86 offen offset:0 nt
    buffer_load_dwordx4 a[100:103], v1, s[8:11], s86 offen offset:1024 nt
    buffer_load_dwordx4 a[104:107], v1, s[8:11], s86 offen offset:2048 nt
    s_barrier
    buffer_load_dwordx4 a[108:111], v1, s[8:11], s86 offen offset:3072 nt
    buffer_load_dwordx4 a[112:115], v23, s[8:11], s86 offen offset:0 nt
    buffer_load_dwordx4 a[116:119], v23, s[8:11], s86 offen offset:1024 nt
    buffer_load_dwordx4 a[120:123], v1, s[8:11], s87 offen offset:0 nt
    buffer_load_dwordx4 a[124:127], v1, s[8:11], s87 offen offset:1024 nt
    buffer_load_dwordx4 a[128:131], v1, s[8:11], s87 offen offset:2048 nt
    s_barrier
AW1:
    ds_read_b32 v24, v110 offset:4
    s_waitcnt lgkmcnt(0)
    v_cmp_gt_u32 vcc, 4, v24
    s_cbranch_vccnz AW1
    ds_read_b64_tr_b16 v[40:41], v16 offset:0
    ds_read_b64_tr_b16 v[42:43], v16 offset:1536
    ds_read_b64_tr_b16 v[44:45], v16 offset:12288
    ds_read_b64_tr_b16 v[46:47], v16 offset:13824
    ds_read_b64_tr_b16 v[48:49], v17 offset:24576
    ds_read_b64_tr_b16 v[50:51], v16 offset:32
    ds_read_b64_tr_b16 v[52:53], v16 offset:1568
    ds_read_b64_tr_b16 v[54:55], v16 offset:12320
    ds_read_b64_tr_b16 v[56:57], v16 offset:13856
    ds_read_b64_tr_b16 v[58:59], v17 offset:24608
    ds_read_b64_tr_b16 v[60:61], v16 offset:64
    ds_read_b64_tr_b16 v[62:63], v16 offset:1600
    ds_read_b64_tr_b16 v[64:65], v16 offset:12352
    ds_read_b64_tr_b16 v[66:67], v16 offset:13888
    ds_read_b64_tr_b16 v[68:69], v17 offset:24640
    buffer_load_dwordx4 a[132:135], v1, s[8:11], s87 offen offset:3072 nt
    buffer_load_dwordx4 a[136:139], v23, s[8:11], s87 offen offset:0 nt
    buffer_load_dwordx4 a[140:143], v23, s[8:11], s87 offen offset:1024 nt
    buffer_load_dwordx4 a[144:147], v1, s[8:11], s88 offen offset:0 nt
    buffer_load_dwordx4 a[148:151], v1, s[8:11], s88 offen offset:1024 nt
    buffer_load_dwordx4 a[152:155], v1, s[8:11], s88 offen offset:2048 nt
    s_barrier
    s_waitcnt vmcnt(15)
    v_sad_u8 v100, v99, 0, 0
    s_nop 1
    v_add_u32_dpp v100, v100, v100 quad_perm:[1,0,3,2] row_mask:0xf bank_mask:0xf
    s_nop 1
    v_add_u32_dpp v100, v100, v100 quad_perm:[2,3,0,1] row_mask:0xf bank_mask:0xf
    v_cmp_gt_u32 vcc, 32, v100
    s_mov_b32 vcc_hi, 0
    s_cmp_eq_u64 vcc, 0
    s_cbranch_scc0 RDYLOOP
RDYOK:
    v_readlane_b32 s77, v99, s5
    s_nop 0
    s_cmp_eq_u32 s77, s96
    s_cselect_b32 s75, 1, 0
    buffer_load_dwordx4 a[240:243], v20, s[16:19], 0 offen sc1
    buffer_load_dwordx4 a[240:243], v21, s[16:19], s4 offen sc1
    s_waitcnt lgkmcnt(0)
    s_add_u32 s79, s3, 1376256
    v_mfma_f32_16x16x32_bf16 v[24:27], v[70:73], v[40:43], 0
    v_mfma_f32_16x16x32_bf16 v[32:35], v[70:73], v[60:63], 0
    v_mfma_f32_16x16x32_bf16 v[24:27], v[74:77], v[44:47], v[24:27]
    v_mfma_f32_16x16x32_bf16 v[32:35], v[74:77], v[64:67], v[32:35]
    v_mfma_f32_16x16x16_bf16 v[24:27], v[78:79], v[48:49], v[24:27]
    v_mfma_f32_16x16x16_bf16 v[32:35], v[78:79], v[68:69], v[32:35]
    v_mfma_f32_16x16x32_bf16 v[28:31], v[70:73], v[50:53], 0
    v_mfma_f32_16x16x32_bf16 v[36:39], v[70:73], v[70:73], 0
    v_mfma_f32_16x16x32_bf16 v[28:31], v[74:77], v[54:57], v[28:31]
    v_mfma_f32_16x16x32_bf16 v[36:39], v[74:77], v[74:77], v[36:39]
    v_mfma_f32_16x16x16_bf16 v[28:31], v[78:79], v[58:59], v[28:31]
    v_mfma_f32_16x16x16_bf16 v[36:39], v[78:79], v[78:79], v[36:39]
    buffer_load_dwordx4 a[156:159], v1, s[8:11], s88 offen offset:3072 nt
    v_add_f32 v24, v24, v25
    v_add_f32 v26, v26, v27
    v_add_f32 v24, v24, v26
    v_add_f32 v32, v32, v33
    v_add_f32 v34, v34, v35
    v_add_f32 v32, v32, v34
    s_nop 1
    v_permlane32_swap_b32 v24, v32
    v_add_f32 v28, v28, v29
    v_add_f32 v30, v30, v31
    v_add_f32 v36, v36, v37
    v_add_f32 v38, v38, v39
    v_add_f32 v24, v24, v32
    v_add_f32 v28, v28, v30
    v_add_f32 v36, v36, v38
    s_nop 1
    v_permlane32_swap_b32 v28, v36
    v_add_f32 v28, v28, v36
    s_nop 1
    v_permlane16_swap_b32 v24, v28
    v_add_f32 v24, v24, v28
    s_cmp_eq_u32 s75, 1
    s_cbranch_scc0 SLOW2
    buffer_store_dword v24, v10, s[16:19], s79 offen
BACK2:
    buffer_load_dwordx4 a[160:163], v23, s[8:11], s88 offen offset:0 nt
    v_mfma_f32_16x16x32_bf16 v[24:27], v[88:91], v[40:43], 0
    v_mfma_f32_16x16x32_bf16 v[32:35], v[88:91], v[60:63], 0
    v_mfma_f32_16x16x32_bf16 v[24:27], v[92:95], v[44:47], v[24:27]
    v_mfma_f32_16x16x32_bf16 v[32:35], v[92:95], v[64:67], v[32:35]
    v_mfma_f32_16x16x16_bf16 v[24:27], v[96:97], v[48:49], v[24:27]
    v_mfma_f32_16x16x16_bf16 v[32:35], v[96:97], v[68:69], v[32:35]
    v_mfma_f32_16x16x32_bf16 v[28:31], v[88:91], v[50:53], 0
    v_mfma_f32_16x16x32_bf16 v[36:39], v[88:91], v[88:91], 0
    v_mfma_f32_16x16x32_bf16 v[28:31], v[92:95], v[54:57], v[28:31]
    v_mfma_f32_16x16x32_bf16 v[36:39], v[92:95], v[92:95], v[36:39]
    v_mfma_f32_16x16x16_bf16 v[28:31], v[96:97], v[58:59], v[28:31]
    v_mfma_f32_16x16x16_bf16 v[36:39], v[96:97], v[96:97], v[36:39]
    buffer_load_dwordx4 a[164:167], v23, s[8:11], s88 offen offset:1024 nt
    v_add_f32 v24, v24, v25
    v_add_f32 v26, v26, v27
    v_add_f32 v24, v24, v26
    v_add_f32 v32, v32, v33
    v_add_f32 v34, v34, v35
    v_add_f32 v32, v32, v34
    s_nop 1
    v_permlane32_swap_b32 v24, v32
    v_add_f32 v28, v28, v29
    v_add_f32 v30, v30, v31
    v_add_f32 v36, v36, v37
    v_add_f32 v38, v38, v39
    v_add_f32 v24, v24, v32
    v_add_f32 v28, v28, v30
    v_add_f32 v36, v36, v38
    s_nop 1
    v_permlane32_swap_b32 v28, v36
    v_add_f32 v28, v28, v36
    s_nop 1
    v_permlane16_swap_b32 v24, v28
    v_add_f32 v24, v24, v28
    s_cmp_eq_u32 s75, 1
    s_cbranch_scc0 SLOW3
    buffer_store_dword v24, v10, s[16:19], s3 offen
BACK3:
    s_cmp_lg_u32 s72, 1
    s_cbranch_scc1 NOBASE0
    s_cmp_ge_u32 s69, 20
    s_cbranch_scc1 NOBASE0
    v_mov_b32 v28, v22
    s_lshl_b32 s77, s69, 6
    s_add_u32 s77, s77, s3
    s_add_u32 s77, s77, 79360
    v_lshlrev_b32 v27, 2, v0
    v_mov_b32_dpp v29, v28 quad_perm:[1,1,1,1] row_mask:0xf bank_mask:0xf
    v_mov_b32_dpp v30, v28 quad_perm:[2,2,2,2] row_mask:0xf bank_mask:0xf
    v_mov_b32_dpp v31, v28 quad_perm:[3,3,3,3] row_mask:0xf bank_mask:0xf
    s_mov_b32 exec_lo, 0x1111
    s_mov_b32 exec_hi, 0x0
    s_cmp_eq_u32 s75, 1
    s_cbranch_scc0 SLOW4
    buffer_store_dwordx4 v[28:31], v27, s[16:19], s77 offen
BACK4:
    s_mov_b64 exec, -1
NOBASE0:
    s_waitcnt vmcnt(16)
    ds_write_b128 v2, a[96:99] offset:0
    ds_write_b128 v3, a[100:103] offset:0
    ds_write_b128 v4, a[104:107] offset:0
    ds_write_b128 v2, a[108:111] offset:3328
    ds_write_b128 v3, a[112:115] offset:3328
    ds_write_b128 v4, a[116:119] offset:3328
    ds_read_b128 a[96:99], v5 offset:0
    ds_read_b128 a[100:103], v5 offset:64
    ds_read_b128 a[104:107], v5 offset:128
    ds_read_b128 a[108:111], v5 offset:192
    ds_read_b128 a[112:115], v5 offset:256
    ds_read_b128 a[116:119], v5 offset:320
    buffer_load_dwordx4 a[168:171], v1, s[8:11], s89 offen offset:0 nt
    buffer_load_dwordx4 a[172:175], v1, s[8:11], s89 offen offset:1024 nt
    buffer_load_dwordx4 a[176:179], v1, s[8:11], s89 offen offset:2048 nt
    s_barrier
    buffer_load_dwordx4 a[180:183], v1, s[8:11], s89 offen offset:3072 nt
    buffer_load_dwordx4 a[184:187], v23, s[8:11], s89 offen offset:0 nt
    buffer_load_dwordx4 a[188:191], v23, s[8:11], s89 offen offset:1024 nt
    s_waitcnt vmcnt(16)
    ds_write_b128 v2, a[120:123] offset:0
    ds_write_b128 v3, a[124:127] offset:0
    ds_write_b128 v4, a[128:131] offset:0
    ds_write_b128 v2, a[132:135] offset:3328
    ds_write_b128 v3, a[136:139] offset:3328
    ds_write_b128 v4, a[140:143] offset:3328
    ds_read_b128 a[120:123], v5 offset:0
    ds_read_b128 a[124:127], v5 offset:64
    ds_read_b128 a[128:131], v5 offset:128
    ds_read_b128 a[132:135], v5 offset:192
    ds_read_b128 a[136:139], v5 offset:256
    ds_read_b128 a[140:143], v5 offset:320
    s_cmp_ge_u32 s69, 20
    s_cbranch_scc1 DMAF
    v_lshrrev_b32 v38, 2, v0
    v_mul_u32_u24 v38, 1280, v38
    v_and_b32 v39, 3, v0
    v_lshl_add_u32 v38, v39, 4, v38
    s_lshl_b32 s77, s72, 3
    s_add_u32 s77, s77, s68
    s_mul_i32 s77, s77, 245760
    s_lshl_b32 s78, s69, 6
    s_add_u32 s77, s77, s78
    s_mul_i32 s78, s72, 12288
    s_add_u32 m0, s78, 57344
    s_nop 0
    buffer_load_dwordx4 v38, s[24:27], s77 offen  lds
    s_add_u32 m0, m0, 1024
    s_add_u32 s77, s77, 20480
    buffer_load_dwordx4 v38, s[24:27], s77 offen  lds
    s_add_u32 m0, m0, 1024
    s_add_u32 s77, s77, 20480
    buffer_load_dwordx4 v38, s[24:27], s77 offen  lds
    s_add_u32 m0, m0, 1024
    s_add_u32 s77, s77, 20480
    buffer_load_dwordx4 v38, s[24:27], s77 offen  lds
    s_add_u32 m0, m0, 1024
    s_add_u32 s77, s77, 20480
    buffer_load_dwordx4 v38, s[24:27], s77 offen  lds
    s_add_u32 m0, m0, 1024
    s_add_u32 s77, s77, 20480
    buffer_load_dwordx4 v38, s[24:27], s77 offen  lds
    s_add_u32 m0, m0, 1024
    s_add_u32 s77, s77, 20480
    buffer_load_dwordx4 v38, s[24:27], s77 offen  lds
    s_add_u32 m0, m0, 1024
    s_add_u32 s77, s77, 20480
    buffer_load_dwordx4 v38, s[24:27], s77 offen  lds
    s_add_u32 m0, m0, 1024
    s_add_u32 s77, s77, 20480
    buffer_load_dwordx4 v38, s[24:27], s77 offen  lds
    s_add_u32 m0, m0, 1024
    s_add_u32 s77, s77, 20480
    buffer_load_dwordx4 v38, s[24:27], s77 offen  lds
    s_add_u32 m0, m0, 1024
    s_add_u32 s77, s77, 20480
    buffer_load_dwordx4 v38, s[24:27], s77 offen  lds
    s_add_u32 m0, m0, 1024
    s_add_u32 s77, s77, 20480
    buffer_load_dwordx4 v38, s[24:27], s77 offen  lds
DMAX:
    s_waitcnt vmcnt(17)
    ds_write_b128 v2, a[144:147] offset:0
    ds_write_b128 v3, a[148:151] offset:0
    ds_write_b128 v4, a[152:155] offset:0
    ds_write_b128 v2, a[156:159] offset:3328
    ds_write_b128 v3, a[160:163] offset:3328
    ds_write_b128 v4, a[164:167] offset:3328
    ds_read_b128 a[144:147], v5 offset:0
    ds_read_b128 a[148:151], v5 offset:64
    ds_read_b128 a[152:155], v5 offset:128
    ds_read_b128 a[156:159], v5 offset:192
    ds_read_b128 a[160:163], v5 offset:256
    ds_read_b128 a[164:167], v5 offset:320
    s_add_u32 s77, s3, 1376256
    s_add_u32 s78, s3, 1380352
    s_add_u32 s79, s3, 4096
    buffer_load_dwordx4 v[64:67], v11, s[16:19], s77 offen sc1
    buffer_load_dwordx4 v[68:71], v11, s[16:19], s78 offen sc1
    buffer_load_dwordx4 v[72:75], v11, s[16:19], s3 offen sc1
    buffer_load_dwordx4 v[76:79], v11, s[16:19], s79 offen sc1
    buffer_load_dwordx4 a[216:219], v1, s[12:15], s73 offen offset:0 nt
    buffer_load_dwordx4 a[220:223], v1, s[12:15], s73 offen offset:1024 nt
    buffer_load_dwordx4 a[224:227], v1, s[12:15], s73 offen offset:2048 nt
    s_barrier
    v_and_b32 v25, 15, v0
    v_lshrrev_b32 v26, 4, v0
    v_add_u32 v27, 4, v26
    v_mul_u32_u24 v20, 1280, v26
    v_add_u32 v20, 665600, v20
    s_mul_i32 s7, s68, 81920
    s_add_u32 s7, s7, 78080
    v_mov_b32 v28, s7
    v_cmp_eq_u32 vcc, s68, v26
    s_nop 1
    v_cndmask_b32 v20, v20, v28, vcc
    v_mul_u32_u24 v21, 1280, v27
    v_add_u32 v21, 665600, v21
    s_mul_i32 s7, s68, 81920
    s_add_u32 s7, s7, 78080
    v_mov_b32 v28, s7
    v_cmp_eq_u32 vcc, s68, v27
    s_nop 1
    v_cndmask_b32 v21, v21, v28, vcc
    s_min_u32 s7, s69, 19
    s_lshl_b32 s7, s7, 6
    v_lshl_add_u32 v25, v25, 2, s7
    v_add_u32 v20, v20, v25
    v_add_u32 v21, v21, v25
    buffer_load_dwordx4 a[228:231], v1, s[12:15], s73 offen offset:3072 nt
    v_and_b32 v25, 15, v0
    v_bfe_u32 v27, v0, 2, 2
    v_and_b32 v28, 3, v0
    s_mul_i32 s7, s72, 12288
    s_add_u32 s7, s7, 57344
    v_lshl_add_u32 v29, v26, 3, v27
    v_lshlrev_b32 v29, 6, v29
    v_lshl_add_u32 v29, v28, 3, v29
    v_add_u32 v29, s7, v29
    v_accvgpr_write_b32 a246, v29
    s_mul_i32 s7, s72, 3072
    s_add_u32 s7, s7, 32768
    v_lshl_add_u32 v29, v25, 4, s7
    v_lshl_add_u32 v29, v26, 7, v29
    v_accvgpr_write_b32 a247, v29
    s_lshl_b32 s7, s72, 6
    s_add_u32 s7, s7, 45056
    v_and_b32 v29, 1, v26
    v_lshl_add_u32 v29, v29, 5, s7
    v_accvgpr_write_b32 a248, v29
    s_lshl_b32 s7, s72, 8
    s_add_u32 s7, s7, 122368
    v_lshl_add_u32 v29, v0, 2, s7
    v_accvgpr_write_b32 a249, v29
    s_lshl_b32 s81, s69, 6
    s_mul_i32 s80, s68, 1280
    s_add_u32 s80, s80, s81
    s_add_u32 s80, s80, 655360
    s_add_u32 s81, s81, s3
    s_add_u32 s81, s81, 76800
    buffer_load_dwordx4 a[232:235], v23, s[12:15], s73 offen offset:0 nt
    buffer_load_dwordx4 a[236:239], v23, s[12:15], s73 offen offset:1024 nt
    s_waitcnt vmcnt(20)
    ds_write_b128 v2, a[168:171] offset:0
    ds_write_b128 v3, a[172:175] offset:0
    ds_write_b128 v4, a[176:179] offset:0
    ds_write_b128 v2, a[180:183] offset:3328
    ds_write_b128 v3, a[184:187] offset:3328
    ds_write_b128 v4, a[188:191] offset:3328
    ds_read_b128 a[168:171], v5 offset:0
    ds_read_b128 a[172:175], v5 offset:64
    ds_read_b128 a[176:179], v5 offset:128
    ds_read_b128 a[180:183], v5 offset:192
    ds_read_b128 a[184:187], v5 offset:256
    ds_read_b128 a[188:191], v5 offset:320
    buffer_load_dwordx4 v[112:115], v1, s[12:15], s83 offen offset:0 nt
    buffer_load_dwordx4 v[116:119], v1, s[12:15], s83 offen offset:1024 nt
    buffer_load_dwordx4 v[120:123], v1, s[12:15], s83 offen offset:2048 nt
    s_barrier
    buffer_load_dwordx4 v[124:127], v1, s[12:15], s83 offen offset:3072 nt
    buffer_load_dwordx4 v[128:131], v23, s[12:15], s83 offen offset:0 nt
    buffer_load_dwordx4 v[132:135], v23, s[12:15], s83 offen offset:1024 nt
    s_waitcnt vmcnt(12)
    v_max3_u32 v24, v64, v65, v66
    v_max3_u32 v24, v24, v67, v68
    v_max3_u32 v24, v24, v69, v70
    v_max3_u32 v24, v24, v71, v72
    v_max3_u32 v24, v24, v73, v74
    v_max3_u32 v24, v24, v75, v76
    v_max3_u32 v24, v24, v77, v78
    v_max_u32 v24, v24, v79
    v_cmp_eq_u32 vcc, -1, v24
    s_cbranch_vccnz RETRY5
OK5:
    v_add_f32 v64, v64, v68
    v_add_f32 v65, v65, v69
    v_add_f32 v66, v66, v70
    v_add_f32 v67, v67, v71
    s_nop 0
    v_permlane32_swap_b32 v64, v66
    v_permlane32_swap_b32 v65, v67
    v_add_f32 v64, v64, v66
    v_add_f32 v65, v65, v67
    s_nop 1
    v_permlane16_swap_b32 v64, v65
    v_add_f32 v64, v64, v65
    v_add_f32 v72, v72, v76
    v_add_f32 v73, v73, v77
    v_add_f32 v74, v74, v78
    v_add_f32 v75, v75, v79
    s_nop 0
    v_permlane32_swap_b32 v72, v74
    v_permlane32_swap_b32 v73, v75
    v_add_f32 v72, v72, v74
    v_add_f32 v73, v73, v75
    s_nop 1
    v_permlane16_swap_b32 v72, v73
    v_add_f32 v72, v72, v73
    v_mul_f32 v7, 0x3acccccd, v64
    v_mov_b32 v24, v72
    buffer_load_dwordx4 v[136:139], v1, s[12:15], s84 offen offset:0 nt
    v_mov_b32 v40, 0
    v_mov_b32 v41, 0
    v_mov_b32 v44, 0
    v_mov_b32 v45, 0
    v_mov_b32 v48, 0
    v_mov_b32 v49, 0
    v_mov_b32 v52, 0
    v_mov_b32 v53, 0
    v_mov_b32 v56, 0
    v_mov_b32 v57, 0
    v_mov_b32 v60, 0
    v_mov_b32 v61, 0
    v_mov_b32 v64, 0
    v_mov_b32 v65, 0
    v_mov_b32 v68, 0
    v_mov_b32 v69, 0
    v_mov_b32 v72, 0
    v_mov_b32 v73, 0
    v_mov_b32 v74, 0
    v_mov_b32 v75, 0
    v_mov_b32 v76, 0
    v_mov_b32 v77, 0
    v_mov_b32 v78, 0
    v_mov_b32 v79, 0
    v_mov_b32 v80, 0
    v_mov_b32 v81, 0
    v_mov_b32 v82, 0
    v_mov_b32 v83, 0
    v_mov_b32 v84, 0
    v_mov_b32 v85, 0
    v_mov_b32 v86, 0
    v_mov_b32 v87, 0
    v_readlane_b32 s77, v24, 15
    s_mov_b32 vcc_lo, 0x70007000
    s_mov_b32 vcc_hi, 0x70007000
    v_fma_f32 v25, -s77, v7, v24
    v_cvt_pk_bf16_f32 v25, v25, v25
    ds_write_b16 v12, v25
    v_cndmask_b32 v26, 0, v24, vcc
    s_nop 1
    v_add_f32_dpp v26, v26, v26 quad_perm:[1,0,3,2] row_mask:0xf bank_mask:0xf
    s_nop 1
    v_add_f32_dpp v26, v26, v26 quad_perm:[2,3,0,1] row_mask:0xf bank_mask:0xf
    v_mov_b32 v27, v26
    s_nop 1
    v_permlane32_swap_b32 v26, v27
    v_add_f32 v26, v26, v27
    s_mov_b64 exec, 1
    ds_add_u32 v110, v111 offset:8
    s_mov_b64 exec, -1
    buffer_load_dwordx4 v[140:143], v1, s[12:15], s84 offen offset:1024 nt
    buffer_load_dwordx4 v[144:147], v1, s[12:15], s84 offen offset:2048 nt
    s_barrier
    buffer_load_dwordx4 v[148:151], v1, s[12:15], s84 offen offset:3072 nt
    buffer_load_dwordx4 v[152:155], v23, s[12:15], s84 offen offset:0 nt
    buffer_load_dwordx4 v[156:159], v23, s[12:15], s84 offen offset:1024 nt
    s_waitcnt vmcnt(12)
    ds_write_b128 v2, a[216:219] offset:0
    ds_write_b128 v3, a[220:223] offset:0
    ds_write_b128 v4, a[224:227] offset:0
    ds_write_b128 v2, a[228:231] offset:3328
    ds_write_b128 v3, a[232:235] offset:3328
    ds_write_b128 v4, a[236:239] offset:3328
    ds_read_b64_tr_b16 a[192:193], v6 offset:0
    ds_read_b64_tr_b16 a[196:197], v6 offset:32
    ds_read_b64_tr_b16 a[200:201], v6 offset:64
    ds_read_b64_tr_b16 a[204:205], v6 offset:96
    ds_read_b64_tr_b16 a[208:209], v6 offset:128
    ds_read_b64_tr_b16 a[212:213], v6 offset:160
    ds_read_b64_tr_b16 a[216:217], v6 offset:192
    ds_read_b64_tr_b16 a[220:221], v6 offset:224
    ds_read_b64_tr_b16 a[224:225], v6 offset:256
    ds_read_b64_tr_b16 a[228:229], v6 offset:288
    ds_read_b64_tr_b16 a[232:233], v6 offset:320
    ds_read_b64_tr_b16 a[236:237], v6 offset:352
    buffer_load_dwordx4 v[160:163], v1, s[12:15], s85 offen offset:0 nt
    buffer_load_dwordx4 v[164:167], v1, s[12:15], s85 offen offset:1024 nt
    buffer_load_dwordx4 v[168:171], v1, s[12:15], s85 offen offset:2048 nt
    s_barrier
    buffer_load_dwordx4 v[172:175], v1, s[12:15], s85 offen offset:3072 nt
    buffer_load_dwordx4 v[176:179], v23, s[12:15], s85 offen offset:0 nt
    buffer_load_dwordx4 v[180:183], v23, s[12:15], s85 offen offset:1024 nt
    s_waitcnt vmcnt(12)
    ds_write_b128 v2, v[112:115] offset:0
    ds_write_b128 v3, v[116:119] offset:0
    ds_write_b128 v4, v[120:123] offset:0
    ds_write_b128 v2, v[124:127] offset:3328
    ds_write_b128 v3, v[128:131] offset:3328
    ds_write_b128 v4, v[132:135] offset:3328
    ds_read_b64_tr_b16 a[194:195], v6 offset:0
    ds_read_b64_tr_b16 a[198:199], v6 offset:32
    ds_read_b64_tr_b16 a[202:203], v6 offset:64
    ds_read_b64_tr_b16 a[206:207], v6 offset:96
    ds_read_b64_tr_b16 a[210:211], v6 offset:128
    ds_read_b64_tr_b16 a[214:215], v6 offset:160
    ds_read_b64_tr_b16 a[218:219], v6 offset:192
    ds_read_b64_tr_b16 a[222:223], v6 offset:224
    ds_read_b64_tr_b16 a[226:227], v6 offset:256
    ds_read_b64_tr_b16 a[230:231], v6 offset:288
    ds_read_b64_tr_b16 a[234:235], v6 offset:320
    ds_read_b64_tr_b16 a[238:239], v6 offset:352
    buffer_load_dwordx4 v[184:187], v1, s[12:15], s86 offen offset:0 nt
    buffer_load_dwordx4 v[188:191], v1, s[12:15], s86 offen offset:1024 nt
AW6:
    ds_read_b32 v28, v110 offset:8
    s_waitcnt lgkmcnt(0)
    v_cmp_gt_u32 vcc, 4, v28
    s_cbranch_vccnz AW6
    ds_read_b128 v[28:31], v13 offset:0
    ds_read_b128 v[32:35], v13 offset:128
    ds_read_b128 v[36:39], v13 offset:256
    v_mov_b32 v27, v26
    v_mov_b32 v25, s77
    v_subrev_f32 v25, 0x44200000, v25
    v_permlane16_swap_b32 v26, v27
    v_add_f32 v26, v26, v27
    v_mul_f32 v24, 0x3acccccd, v25
    v_readlane_b32 s77, v26, 15
    v_mul_f32 v24, v24, v24
    s_mov_b32 s78, 0x3acccccd
    v_sub_f32 v26, s77, v25
    v_fma_f32 v26, v26, s78, -v24
    v_max_f32 v26, 0, v26
    v_add_f32 v26, 0x3727c5ac, v26
    v_rsq_f32 v26, v26
    s_nop 0
    v_mul_f32 v18, 0x3dd53b94, v26
    s_waitcnt lgkmcnt(2)
    v_smfmac_f32_16x16x64_bf16 v[40:43], v[28:31], a[0:7], v14
    v_smfmac_f32_16x16x64_bf16 v[56:59], v[28:31], a[96:103], v14
    v_smfmac_f32_16x16x64_bf16 v[44:47], v[28:31], a[24:31], v14
    v_smfmac_f32_16x16x64_bf16 v[60:63], v[28:31], a[120:127], v14
    v_smfmac_f32_16x16x64_bf16 v[48:51], v[28:31], a[48:55], v14
    v_smfmac_f32_16x16x64_bf16 v[64:67], v[28:31], a[144:151], v14
    v_smfmac_f32_16x16x64_bf16 v[52:55], v[28:31], a[72:79], v14
    v_smfmac_f32_16x16x64_bf16 v[68:71], v[28:31], a[168:175], v14
    buffer_load_dwordx4 v[192:195], v1, s[12:15], s86 offen offset:2048 nt
    s_barrier
    s_waitcnt lgkmcnt(1)
    v_smfmac_f32_16x16x64_bf16 v[40:43], v[32:35], a[8:15], v14
    v_smfmac_f32_16x16x64_bf16 v[56:59], v[32:35], a[104:111], v14
    v_smfmac_f32_16x16x64_bf16 v[44:47], v[32:35], a[32:39], v14
    v_smfmac_f32_16x16x64_bf16 v[60:63], v[32:35], a[128:135], v14
    v_smfmac_f32_16x16x64_bf16 v[48:51], v[32:35], a[56:63], v14
    v_smfmac_f32_16x16x64_bf16 v[64:67], v[32:35], a[152:159], v14
    v_smfmac_f32_16x16x64_bf16 v[52:55], v[32:35], a[80:87], v14
    v_smfmac_f32_16x16x64_bf16 v[68:71], v[32:35], a[176:183], v14
    s_waitcnt lgkmcnt(0)
    v_smfmac_f32_16x16x64_bf16 v[40:43], v[36:39], a[16:23], v14
    v_smfmac_f32_16x16x64_bf16 v[56:59], v[36:39], a[112:119], v14
    v_smfmac_f32_16x16x64_bf16 v[44:47], v[36:39], a[40:47], v14
    v_smfmac_f32_16x16x64_bf16 v[60:63], v[36:39], a[136:143], v14
    v_smfmac_f32_16x16x64_bf16 v[48:51], v[36:39], a[64:71], v14
    v_smfmac_f32_16x16x64_bf16 v[64:67], v[36:39], a[160:167], v14
    v_smfmac_f32_16x16x64_bf16 v[52:55], v[36:39], a[88:95], v14
    v_smfmac_f32_16x16x64_bf16 v[68:71], v[36:39], a[184:191], v14
    buffer_load_dwordx4 v[196:199], v1, s[12:15], s86 offen offset:3072 nt
    s_lshl_b32 s78, s72, 8
    v_add_f32_dpp v24, v40, v41 quad_perm:[0,1,2,3] row_mask:0x1 bank_mask:0xf
    v_add_f32_dpp v25, v56, v57 quad_perm:[0,1,2,3] row_mask:0x1 bank_mask:0xf
    v_bfe_u32 v27, v0, 4, 1
    v_add_f32_dpp v24, v44, v45 quad_perm:[0,1,2,3] row_mask:0x2 bank_mask:0xf
    v_add_f32_dpp v25, v60, v61 quad_perm:[0,1,2,3] row_mask:0x2 bank_mask:0xf
    v_bfe_u32 v28, v0, 2, 1
    v_add_f32_dpp v24, v48, v49 quad_perm:[0,1,2,3] row_mask:0x4 bank_mask:0xf
    v_add_f32_dpp v25, v64, v65 quad_perm:[0,1,2,3] row_mask:0x4 bank_mask:0xf
    s_add_u32 s78, s78, 124416
    v_add_f32_dpp v24, v52, v53 quad_perm:[0,1,2,3] row_mask:0x8 bank_mask:0xf
    v_add_f32_dpp v25, v68, v69 quad_perm:[0,1,2,3] row_mask:0x8 bank_mask:0xf
    v_max_f32 v26, v24, v25
    v_lshl_add_u32 v27, v27, 5, s78
    v_lshl_add_u32 v27, v28, 4, v27
    v_max_f32_dpp v26, v26, v26 row_ror:8 row_mask:0xf bank_mask:0xf
    s_nop 1
    v_max_f32_dpp v26, v26, v26 row_ror:4 row_mask:0xf bank_mask:0xf
    s_nop 1
    v_max_f32_dpp v26, v26, v26 row_ror:2 row_mask:0xf bank_mask:0xf
    s_nop 1
    v_max_f32_dpp v26, v26, v26 row_ror:1 row_mask:0xf bank_mask:0xf
    v_mov_b32 v28, v26
    s_nop 1
    v_permlane32_swap_b32 v26, v28
    v_max_f32 v26, v26, v28
    v_mov_b32 v28, v26
    s_nop 1
    v_permlane16_swap_b32 v26, v28
    v_max_f32 v26, v26, v28
    buffer_load_dwordx4 v[200:203], v23, s[12:15], s86 offen offset:0 nt
    v_mul_f32 v26, v26, v18
    v_fma_f32 v24, v24, v18, -v26
    v_fma_f32 v25, v25, v18, -v26
    v_exp_f32 v24, v24
    v_exp_f32 v25, v25
    s_nop 0
    v_cvt_pk_bf16_f32 v28, v24, v25
    ds_write_b16 v19, v28
    ds_write_b16_d16_hi v19, v28 offset:128
    s_mov_b32 exec_lo, 0xff00ff
    s_mov_b32 exec_hi, 0xff00ff00
    ds_read_b128 v[72:75], v27 offset:0
    ds_read_b128 v[76:79], v27 offset:64
    ds_read_b128 v[80:83], v27 offset:128
    ds_read_b128 v[84:87], v27 offset:192
    s_mov_b64 exec, -1
    v_add_f32 v27, v24, v25
    v_mov_b32 v40, 0
    v_mov_b32 v44, 0
    v_add_f32_dpp v27, v27, v27 row_ror:8 row_mask:0xf bank_mask:0xf
    v_mov_b32 v48, 0
    v_mov_b32 v52, 0
    v_add_f32_dpp v27, v27, v27 row_ror:4 row_mask:0xf bank_mask:0xf
    v_mov_b32 v56, 0
    v_mov_b32 v60, 0
    v_add_f32_dpp v27, v27, v27 row_ror:2 row_mask:0xf bank_mask:0xf
    s_lshl_b32 s78, s72, 3
    s_add_u32 s78, s78, 125440
    v_add_f32_dpp v27, v27, v27 row_ror:1 row_mask:0xf bank_mask:0xf
    v_mov_b32 v28, v27
    s_nop 1
    v_permlane32_swap_b32 v27, v28
    v_add_f32 v27, v27, v28
    v_mov_b32 v28, v27
    s_nop 1
    v_permlane16_swap_b32 v27, v28
    v_add_f32 v27, v27, v28
    v_mov_b32 v28, s78
    ds_write_b64 v28, v[26:27]
    buffer_load_dwordx4 v[204:207], v23, s[12:15], s86 offen offset:1024 nt
    s_waitcnt vmcnt(12)
    ds_write_b128 v2, v[136:139] offset:0
    ds_write_b128 v3, v[140:143] offset:0
    ds_write_b128 v4, v[144:147] offset:0
    ds_write_b128 v2, v[148:151] offset:3328
    ds_write_b128 v3, v[152:155] offset:3328
    ds_write_b128 v4, v[156:159] offset:3328
    ds_read_b64_tr_b16 v[112:113], v6 offset:0
    ds_read_b64_tr_b16 v[116:117], v6 offset:32
    ds_read_b64_tr_b16 v[120:121], v6 offset:64
    ds_read_b64_tr_b16 v[124:125], v6 offset:96
    ds_read_b64_tr_b16 v[128:129], v6 offset:128
    ds_read_b64_tr_b16 v[132:133], v6 offset:160
    ds_read_b64_tr_b16 v[136:137], v6 offset:192
    ds_read_b64_tr_b16 v[140:141], v6 offset:224
    ds_read_b64_tr_b16 v[144:145], v6 offset:256
    ds_read_b64_tr_b16 v[148:149], v6 offset:288
    ds_read_b64_tr_b16 v[152:153], v6 offset:320
    ds_read_b64_tr_b16 v[156:157], v6 offset:352
    s_waitcnt lgkmcnt(0)
    v_smfmac_f32_16x16x64_bf16 v[40:43], v[72:75], a[192:199], v14 abid:1
    v_smfmac_f32_16x16x64_bf16 v[44:47], v[72:75], a[200:207], v14 abid:1
    v_smfmac_f32_16x16x64_bf16 v[48:51], v[72:75], a[208:215], v14 abid:1
    v_smfmac_f32_16x16x64_bf16 v[52:55], v[72:75], a[216:223], v14 abid:1
    v_smfmac_f32_16x16x64_bf16 v[56:59], v[72:75], a[224:231], v14 abid:1
    v_smfmac_f32_16x16x64_bf16 v[60:63], v[72:75], a[232:239], v14 abid:1
    buffer_load_dwordx4 v[208:211], v1, s[12:15], s87 offen offset:0 nt
    buffer_load_dwordx4 v[212:215], v1, s[12:15], s87 offen offset:1024 nt
    buffer_load_dwordx4 v[216:219], v1, s[12:15], s87 offen offset:2048 nt
    s_barrier
    buffer_load_dwordx4 v[220:223], v1, s[12:15], s87 offen offset:3072 nt
    buffer_load_dwordx4 v[224:227], v23, s[12:15], s87 offen offset:0 nt
    buffer_load_dwordx4 v[228:231], v23, s[12:15], s87 offen offset:1024 nt
    s_waitcnt vmcnt(12)
    ds_write_b128 v2, v[160:163] offset:0
    ds_write_b128 v3, v[164:167] offset:0
    ds_write_b128 v4, v[168:171] offset:0
    ds_write_b128 v2, v[172:175] offset:3328
    ds_write_b128 v3, v[176:179] offset:3328
    ds_write_b128 v4, v[180:183] offset:3328
    ds_read_b64_tr_b16 v[114:115], v6 offset:0
    ds_read_b64_tr_b16 v[118:119], v6 offset:32
    ds_read_b64_tr_b16 v[122:123], v6 offset:64
    ds_read_b64_tr_b16 v[126:127], v6 offset:96
    ds_read_b64_tr_b16 v[130:131], v6 offset:128
    ds_read_b64_tr_b16 v[134:135], v6 offset:160
    ds_read_b64_tr_b16 v[138:139], v6 offset:192
    ds_read_b64_tr_b16 v[142:143], v6 offset:224
    ds_read_b64_tr_b16 v[146:147], v6 offset:256
    ds_read_b64_tr_b16 v[150:151], v6 offset:288
    ds_read_b64_tr_b16 v[154:155], v6 offset:320
    ds_read_b64_tr_b16 v[158:159], v6 offset:352
    buffer_load_dwordx4 v[232:235], v1, s[12:15], s88 offen offset:0 nt
    buffer_load_dwordx4 v[236:239], v1, s[12:15], s88 offen offset:1024 nt
    buffer_load_dwordx4 v[240:243], v1, s[12:15], s88 offen offset:2048 nt
    s_barrier
    buffer_load_dwordx4 v[244:247], v1, s[12:15], s88 offen offset:3072 nt
    buffer_load_dwordx4 v[248:251], v23, s[12:15], s88 offen offset:0 nt
    buffer_load_dwordx4 v[252:255], v23, s[12:15], s88 offen offset:1024 nt
    s_waitcnt lgkmcnt(0)
    v_smfmac_f32_16x16x64_bf16 v[40:43], v[76:79], v[112:119], v14 abid:1
    v_smfmac_f32_16x16x64_bf16 v[44:47], v[76:79], v[120:127], v14 abid:1
    v_smfmac_f32_16x16x64_bf16 v[48:51], v[76:79], v[128:135], v14 abid:1
    v_smfmac_f32_16x16x64_bf16 v[52:55], v[76:79], v[136:143], v14 abid:1
    v_smfmac_f32_16x16x64_bf16 v[56:59], v[76:79], v[144:151], v14 abid:1
    v_smfmac_f32_16x16x64_bf16 v[60:63], v[76:79], v[152:159], v14 abid:1
    s_waitcnt vmcnt(12)
    ds_write_b128 v2, v[184:187] offset:0
    ds_write_b128 v3, v[188:191] offset:0
    ds_write_b128 v4, v[192:195] offset:0
    ds_write_b128 v2, v[196:199] offset:3328
    ds_write_b128 v3, v[200:203] offset:3328
    ds_write_b128 v4, v[204:207] offset:3328
    ds_read_b64_tr_b16 v[160:161], v6 offset:0
    ds_read_b64_tr_b16 v[164:165], v6 offset:32
    ds_read_b64_tr_b16 v[168:169], v6 offset:64
    ds_read_b64_tr_b16 v[172:173], v6 offset:96
    ds_read_b64_tr_b16 v[176:177], v6 offset:128
    ds_read_b64_tr_b16 v[180:181], v6 offset:160
    ds_read_b64_tr_b16 v[184:185], v6 offset:192
    ds_read_b64_tr_b16 v[188:189], v6 offset:224
    ds_read_b64_tr_b16 v[192:193], v6 offset:256
    ds_read_b64_tr_b16 v[196:197], v6 offset:288
    ds_read_b64_tr_b16 v[200:201], v6 offset:320
    ds_read_b64_tr_b16 v[204:205], v6 offset:352
    buffer_load_dwordx4 v[88:91], v1, s[12:15], s89 offen offset:0 nt
    buffer_load_dwordx4 v[92:95], v1, s[12:15], s89 offen offset:1024 nt
    buffer_load_dwordx4 v[96:99], v1, s[12:15], s89 offen offset:2048 nt
    s_barrier
    buffer_load_dwordx4 v[100:103], v1, s[12:15], s89 offen offset:3072 nt
    buffer_load_dwordx4 v[104:107], v23, s[12:15], s89 offen offset:0 nt
    buffer_load_dwordx4 v[108:111], v23, s[12:15], s89 offen offset:1024 nt
    s_waitcnt vmcnt(12)
    ds_write_b128 v2, v[208:211] offset:0
    ds_write_b128 v3, v[212:215] offset:0
    ds_write_b128 v4, v[216:219] offset:0
    ds_write_b128 v2, v[220:223] offset:3328
    ds_write_b128 v3, v[224:227] offset:3328
    ds_write_b128 v4, v[228:231] offset:3328
    ds_read_b64_tr_b16 v[162:163], v6 offset:0
    ds_read_b64_tr_b16 v[166:167], v6 offset:32
    ds_read_b64_tr_b16 v[170:171], v6 offset:64
    ds_read_b64_tr_b16 v[174:175], v6 offset:96
    ds_read_b64_tr_b16 v[178:179], v6 offset:128
    ds_read_b64_tr_b16 v[182:183], v6 offset:160
    ds_read_b64_tr_b16 v[186:187], v6 offset:192
    ds_read_b64_tr_b16 v[190:191], v6 offset:224
    ds_read_b64_tr_b16 v[194:195], v6 offset:256
    ds_read_b64_tr_b16 v[198:199], v6 offset:288
    ds_read_b64_tr_b16 v[202:203], v6 offset:320
    ds_read_b64_tr_b16 v[206:207], v6 offset:352
    v_and_b32 v23, 0xffff0000, v22
    v_lshlrev_b32 v22, 16, v22
    s_waitcnt lgkmcnt(0)
    v_smfmac_f32_16x16x64_bf16 v[40:43], v[80:83], v[160:167], v14 abid:1
    v_smfmac_f32_16x16x64_bf16 v[44:47], v[80:83], v[168:175], v14 abid:1
    v_smfmac_f32_16x16x64_bf16 v[48:51], v[80:83], v[176:183], v14 abid:1
    v_smfmac_f32_16x16x64_bf16 v[52:55], v[80:83], v[184:191], v14 abid:1
    v_smfmac_f32_16x16x64_bf16 v[56:59], v[80:83], v[192:199], v14 abid:1
    v_smfmac_f32_16x16x64_bf16 v[60:63], v[80:83], v[200:207], v14 abid:1
    s_waitcnt vmcnt(6)
    ds_write_b128 v2, v[232:235] offset:0
    ds_write_b128 v3, v[236:239] offset:0
    ds_write_b128 v4, v[240:243] offset:0
    ds_write_b128 v2, v[244:247] offset:3328
    ds_write_b128 v3, v[248:251] offset:3328
    ds_write_b128 v4, v[252:255] offset:3328
    ds_read_b64_tr_b16 v[208:209], v6 offset:0
    ds_read_b64_tr_b16 v[212:213], v6 offset:32
    ds_read_b64_tr_b16 v[216:217], v6 offset:64
    ds_read_b64_tr_b16 v[220:221], v6 offset:96
    ds_read_b64_tr_b16 v[224:225], v6 offset:128
    ds_read_b64_tr_b16 v[228:229], v6 offset:160
    ds_read_b64_tr_b16 v[232:233], v6 offset:192
    ds_read_b64_tr_b16 v[236:237], v6 offset:224
    ds_read_b64_tr_b16 v[240:241], v6 offset:256
    ds_read_b64_tr_b16 v[244:245], v6 offset:288
    ds_read_b64_tr_b16 v[248:249], v6 offset:320
    ds_read_b64_tr_b16 v[252:253], v6 offset:352
    s_waitcnt vmcnt(5)
    ds_write_b128 v2, v[88:91] offset:0
    s_waitcnt vmcnt(4)
    ds_write_b128 v3, v[92:95] offset:0
    s_waitcnt vmcnt(3)
    ds_write_b128 v4, v[96:99] offset:0
    s_waitcnt vmcnt(2)
    ds_write_b128 v2, v[100:103] offset:3328
    s_waitcnt vmcnt(1)
    ds_write_b128 v3, v[104:107] offset:3328
    s_waitcnt vmcnt(0)
    ds_write_b128 v4, v[108:111] offset:3328
    ds_read_b64_tr_b16 v[210:211], v6 offset:0
    ds_read_b64_tr_b16 v[214:215], v6 offset:32
    ds_read_b64_tr_b16 v[218:219], v6 offset:64
    ds_read_b64_tr_b16 v[222:223], v6 offset:96
    ds_read_b64_tr_b16 v[226:227], v6 offset:128
    ds_read_b64_tr_b16 v[230:231], v6 offset:160
    ds_read_b64_tr_b16 v[234:235], v6 offset:192
    ds_read_b64_tr_b16 v[238:239], v6 offset:224
    ds_read_b64_tr_b16 v[242:243], v6 offset:256
    ds_read_b64_tr_b16 v[246:247], v6 offset:288
    ds_read_b64_tr_b16 v[250:251], v6 offset:320
    ds_read_b64_tr_b16 v[254:255], v6 offset:352
    s_branch ATT_LAST
LOOP:
    ds_read_b64_tr_b16 v[40:41], v16 offset:0
    ds_read_b64_tr_b16 v[42:43], v16 offset:1536
    ds_read_b64_tr_b16 v[44:45], v16 offset:12288
    ds_read_b64_tr_b16 v[46:47], v16 offset:13824
    ds_read_b64_tr_b16 v[48:49], v17 offset:24576
    ds_read_b64_tr_b16 v[50:51], v16 offset:32
    ds_read_b64_tr_b16 v[52:53], v16 offset:1568
    ds_read_b64_tr_b16 v[54:55], v16 offset:12320
    ds_read_b64_tr_b16 v[56:57], v16 offset:13856
    ds_read_b64_tr_b16 v[58:59], v17 offset:24608
    ds_read_b64_tr_b16 v[60:61], v16 offset:64
    ds_read_b64_tr_b16 v[62:63], v16 offset:1600
    ds_read_b64_tr_b16 v[64:65], v16 offset:12352
    ds_read_b64_tr_b16 v[66:67], v16 offset:13888
    ds_read_b64_tr_b16 v[68:69], v17 offset:24640
    v_and_b32 v25, 15, v0
    v_cmp_eq_u32 vcc, 12, v25
    v_mov_b32 v36, 0x3f803f80
    s_nop 0
    v_cndmask_b32 v70, 0, v36, vcc
    v_mov_b32 v71, v70
    v_mov_b32 v72, v70
    v_mov_b32 v73, v70
    v_mov_b32 v74, v70
    v_mov_b32 v75, v70
    v_mov_b32 v76, v70
    v_mov_b32 v77, v70
    v_mov_b32 v78, v70
    v_mov_b32 v79, v70
    s_add_u32 s79, s3, 4096
    s_mul_i32 s77, s72, 6656
    v_mul_u32_u24 v26, 103, v0
    v_lshrrev_b32 v26, 10, v26
    v_lshl_add_u32 v26, v26, 4, v1
    v_add_u32 v26, s77, v26
    v_mul_u32_u24 v27, 176, v25
    v_add_u32 v27, s77, v27
    v_lshrrev_b32 v28, 4, v0
    v_lshl_add_u32 v29, v28, 3, v27
    v_lshl_add_u32 v27, v28, 4, v27
    s_mul_i32 s77, s71, 160
    s_add_u32 s77, s77, s3
    s_sub_u32 s77, s77, 610048
    s_waitcnt lgkmcnt(0)
    s_mov_b32 exec_lo, 0x3ff
    s_mov_b32 exec_hi, 0x0
    s_mov_b32 s76, 1
POLL7:
    buffer_load_dword v24, v1, s[16:19], s77 offen sc1
POLLW7:
    s_waitcnt vmcnt(0)
    v_cmp_eq_u32 vcc, -1, v24
    s_cbranch_vccnz AGAIN7
POLLX7:
    s_mov_b32 exec_lo, 0xffffffff
    s_mov_b32 exec_hi, 0xfffffff
    s_mov_b32 s76, 1
POLL8:
    buffer_load_dwordx4 v[80:83], v8, s[16:19], 0 offen sc1
    buffer_load_dwordx4 v[84:87], v9, s[16:19], 0 offen sc1
POLLW8:
    s_waitcnt vmcnt(0)
    v_max_u32 v24, v80, v84
    v_cmp_eq_u32 vcc, -1, v24
    s_cbranch_vccnz AGAIN8
POLLX8:
    ds_write_b128 v26, v[80:83]
    ds_write_b128 v26, v[84:87] offset:1056
    s_mov_b32 exec_lo, 0x1ff01ff
    s_mov_b32 exec_hi, 0x1ff01ff
    ds_read_b128 v[70:73], v27
    ds_read_b128 v[74:77], v27 offset:64
    ds_read_b64 v[78:79], v29 offset:128
    s_mov_b64 exec, -1
    buffer_load_dword a244, v20, s[16:19], 0 offen sc1
    buffer_load_dword a245, v21, s[16:19], 0 offen sc1
    s_waitcnt lgkmcnt(2)
    v_mfma_f32_16x16x32_bf16 v[24:27], v[70:73], v[40:43], 0
    v_mfma_f32_16x16x32_bf16 v[32:35], v[70:73], v[60:63], 0
    s_waitcnt lgkmcnt(0)
    v_mfma_f32_16x16x32_bf16 v[24:27], v[74:77], v[44:47], v[24:27]
    v_mfma_f32_16x16x32_bf16 v[32:35], v[74:77], v[64:67], v[32:35]
    v_mfma_f32_16x16x16_bf16 v[24:27], v[78:79], v[48:49], v[24:27]
    v_mfma_f32_16x16x16_bf16 v[32:35], v[78:79], v[68:69], v[32:35]
    v_mfma_f32_16x16x32_bf16 v[28:31], v[70:73], v[50:53], 0
    v_mfma_f32_16x16x32_bf16 v[36:39], v[70:73], v[70:73], 0
    v_mfma_f32_16x16x32_bf16 v[28:31], v[74:77], v[54:57], v[28:31]
    v_mfma_f32_16x16x32_bf16 v[36:39], v[74:77], v[74:77], v[36:39]
    v_mfma_f32_16x16x16_bf16 v[28:31], v[78:79], v[58:59], v[28:31]
    v_mfma_f32_16x16x16_bf16 v[36:39], v[78:79], v[78:79], v[36:39]
    s_nop 0
    v_add_f32 v24, v24, v25
    v_add_f32 v26, v26, v27
    v_add_f32 v24, v24, v26
    v_add_f32 v32, v32, v33
    v_add_f32 v34, v34, v35
    v_add_f32 v32, v32, v34
    s_nop 1
    v_permlane32_swap_b32 v24, v32
    v_add_f32 v28, v28, v29
    v_add_f32 v30, v30, v31
    v_add_f32 v36, v36, v37
    v_add_f32 v38, v38, v39
    v_add_f32 v24, v24, v32
    v_add_f32 v28, v28, v30
    v_add_f32 v36, v36, v38
    s_nop 1
    v_permlane32_swap_b32 v28, v36
    v_add_f32 v28, v28, v36
    s_nop 1
    v_permlane16_swap_b32 v24, v28
    v_add_f32 v24, v24, v28
    s_cmp_eq_u32 s75, 1
    s_cbranch_scc0 SLOW9
    buffer_store_dword v24, v10, s[16:19], s3 offen
BACK9:
    v_mov_b32 v40, 0
    v_mov_b32 v41, 0
    v_mov_b32 v44, 0
    v_mov_b32 v45, 0
    v_mov_b32 v48, 0
    v_mov_b32 v49, 0
    v_mov_b32 v52, 0
    v_mov_b32 v53, 0
    v_mov_b32 v56, 0
    v_mov_b32 v57, 0
    v_mov_b32 v60, 0
    v_mov_b32 v61, 0
    v_mov_b32 v64, 0
    v_mov_b32 v65, 0
    v_mov_b32 v68, 0
    v_mov_b32 v69, 0
    v_mov_b32 v72, 0
    v_mov_b32 v73, 0
    v_mov_b32 v74, 0
    v_mov_b32 v75, 0
    v_mov_b32 v76, 0
    v_mov_b32 v77, 0
    v_mov_b32 v78, 0
    v_mov_b32 v79, 0
    v_mov_b32 v80, 0
    v_mov_b32 v81, 0
    v_mov_b32 v82, 0
    v_mov_b32 v83, 0
    v_mov_b32 v84, 0
    v_mov_b32 v85, 0
    v_mov_b32 v86, 0
    v_mov_b32 v87, 0
    s_mov_b32 s76, 1
POLL10:
    buffer_load_dwordx4 v[24:27], v11, s[16:19], s3 offen sc1
    buffer_load_dwordx4 v[28:31], v11, s[16:19], s79 offen sc1
POLLW10:
    s_waitcnt vmcnt(0)
    v_max3_u32 v32, v24, v25, v26
    v_max3_u32 v32, v32, v27, v28
    v_max3_u32 v32, v32, v29, v30
    v_max_u32 v32, v32, v31
    v_cmp_eq_u32 vcc, -1, v32
    s_cbranch_vccnz AGAIN10
POLLX10:
    v_add_f32 v24, v24, v28
    v_add_f32 v25, v25, v29
    v_add_f32 v26, v26, v30
    v_add_f32 v27, v27, v31
    s_nop 0
    v_permlane32_swap_b32 v24, v26
    v_permlane32_swap_b32 v25, v27
    v_add_f32 v24, v24, v26
    v_add_f32 v25, v25, v27
    s_nop 1
    v_permlane16_swap_b32 v24, v25
    v_add_f32 v24, v24, v25
    s_nop 0
    v_readlane_b32 s77, v24, 15
    s_mov_b32 vcc_lo, 0x70007000
    s_mov_b32 vcc_hi, 0x70007000
    v_fma_f32 v25, -s77, v7, v24
    v_cvt_pk_bf16_f32 v25, v25, v25
    ds_write_b16 v12, v25
    v_cndmask_b32 v26, 0, v24, vcc
    s_nop 1
    v_add_f32_dpp v26, v26, v26 quad_perm:[1,0,3,2] row_mask:0xf bank_mask:0xf
    s_nop 1
    v_add_f32_dpp v26, v26, v26 quad_perm:[2,3,0,1] row_mask:0xf bank_mask:0xf
    v_mov_b32 v27, v26
    s_nop 1
    v_permlane32_swap_b32 v26, v27
    v_add_f32 v26, v26, v27
    s_waitcnt lgkmcnt(0)
    s_barrier
    ds_read_b128 v[28:31], v13 offset:0
    ds_read_b128 v[32:35], v13 offset:128
    ds_read_b128 v[36:39], v13 offset:256
    v_mov_b32 v27, v26
    v_mov_b32 v25, s77
    v_subrev_f32 v25, 0x44200000, v25
    v_permlane16_swap_b32 v26, v27
    v_add_f32 v26, v26, v27
    v_mul_f32 v24, 0x3acccccd, v25
    v_readlane_b32 s77, v26, 15
    v_mul_f32 v24, v24, v24
    s_mov_b32 s78, 0x3acccccd
    v_sub_f32 v26, s77, v25
    v_fma_f32 v26, v26, s78, -v24
    v_max_f32 v26, 0, v26
    v_add_f32 v26, 0x3727c5ac, v26
    v_rsq_f32 v26, v26
    s_nop 0
    v_mul_f32 v18, 0x3dd53b94, v26
    s_waitcnt lgkmcnt(2)
    v_smfmac_f32_16x16x64_bf16 v[40:43], v[28:31], a[0:7], v14
    v_smfmac_f32_16x16x64_bf16 v[56:59], v[28:31], a[96:103], v14
    v_smfmac_f32_16x16x64_bf16 v[44:47], v[28:31], a[24:31], v14
    v_smfmac_f32_16x16x64_bf16 v[60:63], v[28:31], a[120:127], v14
    v_smfmac_f32_16x16x64_bf16 v[48:51], v[28:31], a[48:55], v14
    v_smfmac_f32_16x16x64_bf16 v[64:67], v[28:31], a[144:151], v14
    v_smfmac_f32_16x16x64_bf16 v[52:55], v[28:31], a[72:79], v14
    v_smfmac_f32_16x16x64_bf16 v[68:71], v[28:31], a[168:175], v14
    s_waitcnt lgkmcnt(1)
    v_smfmac_f32_16x16x64_bf16 v[40:43], v[32:35], a[8:15], v14
    v_smfmac_f32_16x16x64_bf16 v[56:59], v[32:35], a[104:111], v14
    v_smfmac_f32_16x16x64_bf16 v[44:47], v[32:35], a[32:39], v14
    v_smfmac_f32_16x16x64_bf16 v[60:63], v[32:35], a[128:135], v14
    v_smfmac_f32_16x16x64_bf16 v[48:51], v[32:35], a[56:63], v14
    v_smfmac_f32_16x16x64_bf16 v[64:67], v[32:35], a[152:159], v14
    v_smfmac_f32_16x16x64_bf16 v[52:55], v[32:35], a[80:87], v14
    v_smfmac_f32_16x16x64_bf16 v[68:71], v[32:35], a[176:183], v14
    s_waitcnt lgkmcnt(0)
    v_smfmac_f32_16x16x64_bf16 v[40:43], v[36:39], a[16:23], v14
    v_smfmac_f32_16x16x64_bf16 v[56:59], v[36:39], a[112:119], v14
    v_smfmac_f32_16x16x64_bf16 v[44:47], v[36:39], a[40:47], v14
    v_smfmac_f32_16x16x64_bf16 v[60:63], v[36:39], a[136:143], v14
    v_smfmac_f32_16x16x64_bf16 v[48:51], v[36:39], a[64:71], v14
    v_smfmac_f32_16x16x64_bf16 v[64:67], v[36:39], a[160:167], v14
    v_smfmac_f32_16x16x64_bf16 v[52:55], v[36:39], a[88:95], v14
    v_smfmac_f32_16x16x64_bf16 v[68:71], v[36:39], a[184:191], v14
    s_lshl_b32 s78, s72, 8
    v_add_f32_dpp v24, v40, v41 quad_perm:[0,1,2,3] row_mask:0x1 bank_mask:0xf
    v_add_f32_dpp v25, v56, v57 quad_perm:[0,1,2,3] row_mask:0x1 bank_mask:0xf
    v_bfe_u32 v27, v0, 4, 1
    v_add_f32_dpp v24, v44, v45 quad_perm:[0,1,2,3] row_mask:0x2 bank_mask:0xf
    v_add_f32_dpp v25, v60, v61 quad_perm:[0,1,2,3] row_mask:0x2 bank_mask:0xf
    v_bfe_u32 v28, v0, 2, 1
    v_add_f32_dpp v24, v48, v49 quad_perm:[0,1,2,3] row_mask:0x4 bank_mask:0xf
    v_add_f32_dpp v25, v64, v65 quad_perm:[0,1,2,3] row_mask:0x4 bank_mask:0xf
    s_add_u32 s78, s78, 124416
    v_add_f32_dpp v24, v52, v53 quad_perm:[0,1,2,3] row_mask:0x8 bank_mask:0xf
    v_add_f32_dpp v25, v68, v69 quad_perm:[0,1,2,3] row_mask:0x8 bank_mask:0xf
    v_max_f32 v26, v24, v25
    v_lshl_add_u32 v27, v27, 5, s78
    v_lshl_add_u32 v27, v28, 4, v27
    v_max_f32_dpp v26, v26, v26 row_ror:8 row_mask:0xf bank_mask:0xf
    s_nop 1
    v_max_f32_dpp v26, v26, v26 row_ror:4 row_mask:0xf bank_mask:0xf
    s_nop 1
    v_max_f32_dpp v26, v26, v26 row_ror:2 row_mask:0xf bank_mask:0xf
    s_nop 1
    v_max_f32_dpp v26, v26, v26 row_ror:1 row_mask:0xf bank_mask:0xf
    v_mov_b32 v28, v26
    s_nop 1
    v_permlane32_swap_b32 v26, v28
    v_max_f32 v26, v26, v28
    v_mov_b32 v28, v26
    s_nop 1
    v_permlane16_swap_b32 v26, v28
    v_max_f32 v26, v26, v28
    v_mul_f32 v26, v26, v18
    v_fma_f32 v24, v24, v18, -v26
    v_fma_f32 v25, v25, v18, -v26
    v_exp_f32 v24, v24
    v_exp_f32 v25, v25
    s_nop 0
    v_cvt_pk_bf16_f32 v28, v24, v25
    ds_write_b16 v19, v28
    ds_write_b16_d16_hi v19, v28 offset:128
    s_mov_b32 exec_lo, 0xff00ff
    s_mov_b32 exec_hi, 0xff00ff00
    ds_read_b128 v[72:75], v27 offset:0
    ds_read_b128 v[76:79], v27 offset:64
    ds_read_b128 v[80:83], v27 offset:128
    ds_read_b128 v[84:87], v27 offset:192
    s_mov_b64 exec, -1
    v_add_f32 v27, v24, v25
    v_mov_b32 v40, 0
    v_mov_b32 v44, 0
    v_add_f32_dpp v27, v27, v27 row_ror:8 row_mask:0xf bank_mask:0xf
    v_mov_b32 v48, 0
    v_mov_b32 v52, 0
    v_add_f32_dpp v27, v27, v27 row_ror:4 row_mask:0xf bank_mask:0xf
    v_mov_b32 v56, 0
    v_mov_b32 v60, 0
    v_add_f32_dpp v27, v27, v27 row_ror:2 row_mask:0xf bank_mask:0xf
    s_lshl_b32 s78, s72, 3
    s_add_u32 s78, s78, 125440
    v_add_f32_dpp v27, v27, v27 row_ror:1 row_mask:0xf bank_mask:0xf
    v_mov_b32 v28, v27
    s_nop 1
    v_permlane32_swap_b32 v27, v28
    v_add_f32 v27, v27, v28
    v_mov_b32 v28, v27
    s_nop 1
    v_permlane16_swap_b32 v27, v28
    v_add_f32 v27, v27, v28
    v_mov_b32 v28, s78
    ds_write_b64 v28, v[26:27]
    s_waitcnt lgkmcnt(4)
    v_smfmac_f32_16x16x64_bf16 v[40:43], v[72:75], a[192:199], v14 abid:1
    v_smfmac_f32_16x16x64_bf16 v[44:47], v[72:75], a[200:207], v14 abid:1
    v_smfmac_f32_16x16x64_bf16 v[48:51], v[72:75], a[208:215], v14 abid:1
    v_smfmac_f32_16x16x64_bf16 v[52:55], v[72:75], a[216:223], v14 abid:1
    v_smfmac_f32_16x16x64_bf16 v[56:59], v[72:75], a[224:231], v14 abid:1
    v_smfmac_f32_16x16x64_bf16 v[60:63], v[72:75], a[232:239], v14 abid:1
    s_waitcnt lgkmcnt(3)
    v_smfmac_f32_16x16x64_bf16 v[40:43], v[76:79], v[112:119], v14 abid:1
    v_smfmac_f32_16x16x64_bf16 v[44:47], v[76:79], v[120:127], v14 abid:1
    v_smfmac_f32_16x16x64_bf16 v[48:51], v[76:79], v[128:135], v14 abid:1
    v_smfmac_f32_16x16x64_bf16 v[52:55], v[76:79], v[136:143], v14 abid:1
    v_smfmac_f32_16x16x64_bf16 v[56:59], v[76:79], v[144:151], v14 abid:1
    v_smfmac_f32_16x16x64_bf16 v[60:63], v[76:79], v[152:159], v14 abid:1
    s_waitcnt lgkmcnt(2)
    v_smfmac_f32_16x16x64_bf16 v[40:43], v[80:83], v[160:167], v14 abid:1
    v_smfmac_f32_16x16x64_bf16 v[44:47], v[80:83], v[168:175], v14 abid:1
    v_smfmac_f32_16x16x64_bf16 v[48:51], v[80:83], v[176:183], v14 abid:1
    v_smfmac_f32_16x16x64_bf16 v[52:55], v[80:83], v[184:191], v14 abid:1
    v_smfmac_f32_16x16x64_bf16 v[56:59], v[80:83], v[192:199], v14 abid:1
    v_smfmac_f32_16x16x64_bf16 v[60:63], v[80:83], v[200:207], v14 abid:1
    s_waitcnt lgkmcnt(0)
ATT_LAST:
    s_waitcnt lgkmcnt(8)
    v_smfmac_f32_16x16x64_bf16 v[40:43], v[84:87], v[208:215], v14 abid:1
    v_smfmac_f32_16x16x64_bf16 v[44:47], v[84:87], v[216:223], v14 abid:1
    s_waitcnt lgkmcnt(4)
    v_smfmac_f32_16x16x64_bf16 v[48:51], v[84:87], v[224:231], v14 abid:1
    v_smfmac_f32_16x16x64_bf16 v[52:55], v[84:87], v[232:239], v14 abid:1
    s_waitcnt lgkmcnt(0)
    v_smfmac_f32_16x16x64_bf16 v[56:59], v[84:87], v[240:247], v14 abid:1
    v_smfmac_f32_16x16x64_bf16 v[60:63], v[84:87], v[248:255], v14 abid:1
    v_add_u32 v24, 119296, v1
    v_mov_b32 v25, 125440
    v_lshlrev_b32 v39, 6, v0
    v_permlane16_swap_b32 v40, v44
    v_add_f32 v40, v40, v44
    ds_write_b32 v15, v40 offset:0
    v_permlane16_swap_b32 v48, v52
    v_add_f32 v48, v48, v52
    ds_write_b32 v15, v48 offset:256
    v_permlane16_swap_b32 v56, v60
    v_add_f32 v56, v56, v60
    ds_write_b32 v15, v56 offset:512
    s_cmp_lg_u32 s72, 0
    s_waitcnt lgkmcnt(0)
    s_barrier
    s_cbranch_scc1 ODONE
    ds_read_b128 v[64:67], v25
    ds_read_b128 v[68:71], v25 offset:16
    ds_read_b128 v[40:43], v24 offset:0
    ds_read_b128 v[44:47], v24 offset:768
    ds_read_b128 v[48:51], v24 offset:1536
    ds_read_b128 v[52:55], v24 offset:2304
    s_mul_i32 s77, s70, 3072
    s_lshl_b32 s78, s71, 4
    s_add_u32 s77, s77, s78
    s_add_u32 s77, s77, s3
    s_add_u32 s77, s77, 32768
    s_lshl_b32 s78, s69, 3
    s_add_u32 s78, s78, s3
    s_add_u32 s78, s78, 45056
    s_waitcnt lgkmcnt(4)
    v_max3_f32 v32, v64, v66, v68
    v_max_f32 v32, v32, v70
    v_sub_f32 v64, v64, v32
    v_sub_f32 v66, v66, v32
    v_sub_f32 v68, v68, v32
    v_sub_f32 v70, v70, v32
    v_exp_f32 v64, v64
    v_exp_f32 v66, v66
    v_exp_f32 v68, v68
    v_exp_f32 v70, v70
    s_waitcnt lgkmcnt(0)
    v_mul_f32 v28, v64, v40
    v_mul_f32 v29, v64, v41
    v_mul_f32 v30, v64, v42
    v_mul_f32 v31, v64, v43
    v_fmac_f32 v28, v66, v44
    v_fmac_f32 v29, v66, v45
    v_fmac_f32 v30, v66, v46
    v_fmac_f32 v31, v66, v47
    v_fmac_f32 v28, v68, v48
    v_fmac_f32 v29, v68, v49
    v_fmac_f32 v30, v68, v50
    v_fmac_f32 v31, v68, v51
    v_fmac_f32 v28, v70, v52
    v_fmac_f32 v29, v70, v53
    v_fmac_f32 v30, v70, v54
    v_fmac_f32 v31, v70, v55
    v_cvt_pk_bf16_f32 v28, v28, v29
    v_cvt_pk_bf16_f32 v29, v30, v31
    s_nop 0
    v_mov_b32_dpp v30, v28 quad_perm:[1,1,3,3] row_mask:0xf bank_mask:0xf
    v_mov_b32_dpp v31, v29 quad_perm:[1,1,3,3] row_mask:0xf bank_mask:0xf
    s_mov_b32 exec_lo, 0x55555555
    s_mov_b32 exec_hi, 0x5555
    s_cmp_eq_u32 s75, 1
    s_cbranch_scc0 SLOW11
    buffer_store_dwordx4 v[28:31], v39, s[16:19], s77 offen
BACK11:
    v_mul_f32 v33, v64, v65
    v_fmac_f32 v33, v66, v67
    v_fmac_f32 v33, v68, v69
    v_fmac_f32 v33, v70, v71
    s_mov_b64 exec, 1
    s_cmp_eq_u32 s75, 1
    s_cbranch_scc0 SLOW12
    buffer_store_dwordx2 v[32:33], v39, s[16:19], s78 offen
BACK12:
    s_mov_b64 exec, -1
ODONE:
    s_cmp_ge_u32 s69, 20
    s_cbranch_scc1 ROLEF
    v_accvgpr_read_b32 v2, a246
    v_accvgpr_read_b32 v3, a247
    v_accvgpr_read_b32 v4, a248
    v_mov_b32 v88, 0
    v_mov_b32 v92, 0
    v_mov_b32 v96, 0
    v_mov_b32 v100, 0
    v_mov_b32 v104, 0
    v_mov_b32 v108, 0
    ds_read_b64_tr_b16 v[40:41], v2 offset:0
    ds_read_b64_tr_b16 v[42:43], v2 offset:256
    ds_read_b64_tr_b16 v[64:65], v2 offset:32
    ds_read_b64_tr_b16 v[66:67], v2 offset:288
    ds_read_b64_tr_b16 v[44:45], v2 offset:2048
    ds_read_b64_tr_b16 v[46:47], v2 offset:2304
    ds_read_b64_tr_b16 v[68:69], v2 offset:2080
    ds_read_b64_tr_b16 v[70:71], v2 offset:2336
    ds_read_b64_tr_b16 v[48:49], v2 offset:4096
    ds_read_b64_tr_b16 v[50:51], v2 offset:4352
    s_cmp_lg_u32 s72, 1
    s_cbranch_scc1 NOOWN0
    s_cmp_eq_u32 s74, 0
    s_cbranch_scc1 NOOWN0
    v_accvgpr_read_b32 v28, a244
    v_accvgpr_read_b32 v29, a245
    v_max_u32 v30, v28, v29
    v_cmp_eq_u32 vcc, -1, v30
    s_cbranch_vccnz RETRY13
OK13:
    v_lshlrev_b32 v30, 16, v28
    v_and_b32 v28, 0xffff0000, v28
    v_lshlrev_b32 v31, 16, v29
    v_and_b32 v29, 0xffff0000, v29
    v_add_f32 v30, v30, v31
    v_add_f32 v28, v28, v29
    v_mov_b32 v31, v30
    v_mov_b32 v29, v28
    s_nop 0
    v_permlane32_swap_b32 v30, v31
    v_permlane32_swap_b32 v28, v29
    v_add_f32 v30, v30, v31
    v_add_f32 v28, v28, v29
    v_mov_b32 v31, v30
    v_mov_b32 v29, v28
    s_nop 0
    v_permlane16_swap_b32 v30, v31
    v_permlane16_swap_b32 v28, v29
    v_add_f32 v30, v30, v31
    v_add_f32 v28, v28, v29
    v_add_f32 v22, v22, v30
    v_add_f32 v23, v23, v28
    v_cvt_pk_bf16_f32 v28, v22, v23
    s_lshl_b32 s77, s69, 6
    s_add_u32 s77, s77, s3
    s_add_u32 s77, s77, 79360
    v_lshlrev_b32 v37, 2, v0
    v_mov_b32_dpp v29, v28 quad_perm:[1,1,1,1] row_mask:0xf bank_mask:0xf
    v_mov_b32_dpp v30, v28 quad_perm:[2,2,2,2] row_mask:0xf bank_mask:0xf
    v_mov_b32_dpp v31, v28 quad_perm:[3,3,3,3] row_mask:0xf bank_mask:0xf
    s_mov_b32 exec_lo, 0x1111
    s_mov_b32 exec_hi, 0x0
    s_cmp_eq_u32 s75, 1
    s_cbranch_scc0 SLOW14
    buffer_store_dwordx4 v[28:31], v37, s[16:19], s77 offen
BACK14:
    s_mov_b64 exec, -1
NOOWN0:
    v_mov_b32 v25, 0
    v_mov_b32 v27, 0
    v_mov_b32 v37, 0
    v_mov_b32 v39, 0
    s_mov_b32 s76, 1
    s_mov_b32 exec_lo, 0x00ff00ff
    s_mov_b32 exec_hi, 0x00ff00ff
    buffer_load_dwordx4 v[88:91], v3, s[16:19], s3 offen offset:0 sc1
    buffer_load_dwordx4 v[92:95], v3, s[16:19], s3 offen offset:512 sc1
    buffer_load_dwordx4 v[96:99], v3, s[16:19], s3 offen offset:1024 sc1
    buffer_load_dwordx4 v[100:103], v3, s[16:19], s3 offen offset:1536 sc1
    buffer_load_dwordx4 v[104:107], v3, s[16:19], s3 offen offset:2048 sc1
    buffer_load_dwordx4 v[108:111], v3, s[16:19], s3 offen offset:2560 sc1
    s_mov_b32 exec_lo, -1
    s_mov_b32 exec_hi, 0
    buffer_load_dwordx4 v[24:27], v4, s[16:19], s3 offen offset:0 sc1
    buffer_load_dwordx4 v[36:39], v4, s[16:19], s3 offen offset:16 sc1
    s_mov_b64 exec, -1
    ds_read_b64_tr_b16 v[72:73], v2 offset:4128
    ds_read_b64_tr_b16 v[74:75], v2 offset:4384
    ds_read_b64_tr_b16 v[52:53], v2 offset:6144
    ds_read_b64_tr_b16 v[54:55], v2 offset:6400
    ds_read_b64_tr_b16 v[76:77], v2 offset:6176
    ds_read_b64_tr_b16 v[78:79], v2 offset:6432
    ds_read_b64_tr_b16 v[56:57], v2 offset:8192
    ds_read_b64_tr_b16 v[58:59], v2 offset:8448
    ds_read_b64_tr_b16 v[80:81], v2 offset:8224
    ds_read_b64_tr_b16 v[82:83], v2 offset:8480
    ds_read_b64_tr_b16 v[60:61], v2 offset:10240
    ds_read_b64_tr_b16 v[62:63], v2 offset:10496
    ds_read_b64_tr_b16 v[84:85], v2 offset:10272
    ds_read_b64_tr_b16 v[86:87], v2 offset:10528
    v_accvgpr_read_b32 v5, a249
    v_add_u32 v6, 119296, v1
    v_lshrrev_b32 v18, 1, v1
    s_branch POLLW15
POLL15:
    s_mov_b32 exec_lo, 0x00ff00ff
    s_mov_b32 exec_hi, 0x00ff00ff
    buffer_load_dwordx4 v[88:91], v3, s[16:19], s3 offen offset:0 sc1
    buffer_load_dwordx4 v[92:95], v3, s[16:19], s3 offen offset:512 sc1
    buffer_load_dwordx4 v[96:99], v3, s[16:19], s3 offen offset:1024 sc1
    buffer_load_dwordx4 v[100:103], v3, s[16:19], s3 offen offset:1536 sc1
    buffer_load_dwordx4 v[104:107], v3, s[16:19], s3 offen offset:2048 sc1
    buffer_load_dwordx4 v[108:111], v3, s[16:19], s3 offen offset:2560 sc1
    s_mov_b32 exec_lo, -1
    s_mov_b32 exec_hi, 0
    buffer_load_dwordx4 v[24:27], v4, s[16:19], s3 offen offset:0 sc1
    buffer_load_dwordx4 v[36:39], v4, s[16:19], s3 offen offset:16 sc1
    s_mov_b64 exec, -1
POLLW15:
    s_waitcnt vmcnt(0)
    v_max3_u32 v28, v88, v92, v96
    v_max3_u32 v28, v28, v100, v104
    v_max3_u32 v28, v28, v108, v25
    v_max3_u32 v28, v28, v27, v37
    v_max_u32 v28, v28, v39
    v_cmp_eq_u32 vcc, -1, v28
    s_cbranch_vccnz AGAIN15
POLLX15:
    s_waitcnt lgkmcnt(0)
    v_mfma_f32_16x16x32_bf16 v[28:31], v[88:91], v[40:43], 0
    v_mfma_f32_16x16x32_bf16 v[32:35], v[88:91], v[64:67], 0
    v_max3_f32 v88, v24, v26, v36
    v_max_f32 v88, v88, v38
    v_mfma_f32_16x16x32_bf16 v[28:31], v[92:95], v[44:47], v[28:31]
    v_mov_b32 v89, v88
    v_mfma_f32_16x16x32_bf16 v[32:35], v[92:95], v[68:71], v[32:35]
    s_nop 0
    v_permlane16_swap_b32 v88, v89
    v_max_f32 v88, v88, v89
    v_mfma_f32_16x16x32_bf16 v[28:31], v[96:99], v[48:51], v[28:31]
    v_sub_f32 v24, v24, v88
    v_sub_f32 v26, v26, v88
    v_mfma_f32_16x16x32_bf16 v[32:35], v[96:99], v[72:75], v[32:35]
    v_sub_f32 v36, v36, v88
    v_sub_f32 v38, v38, v88
    v_mfma_f32_16x16x32_bf16 v[28:31], v[100:103], v[52:55], v[28:31]
    v_exp_f32 v24, v24
    v_mfma_f32_16x16x32_bf16 v[32:35], v[100:103], v[76:79], v[32:35]
    v_exp_f32 v26, v26
    v_mfma_f32_16x16x32_bf16 v[28:31], v[104:107], v[56:59], v[28:31]
    v_exp_f32 v36, v36
    v_mfma_f32_16x16x32_bf16 v[32:35], v[104:107], v[80:83], v[32:35]
    v_exp_f32 v38, v38
    v_mfma_f32_16x16x32_bf16 v[28:31], v[108:111], v[60:63], v[28:31]
    v_mul_f32 v90, v24, v25
    v_fmac_f32 v90, v26, v27
    v_mfma_f32_16x16x32_bf16 v[32:35], v[108:111], v[84:87], v[32:35]
    v_fmac_f32 v90, v36, v37
    v_fmac_f32 v90, v38, v39
    v_mov_b32 v89, v90
    s_cmp_lg_u32 s72, 0
    s_nop 0
    v_permlane16_swap_b32 v90, v89
    v_add_f32 v90, v90, v89
    v_rcp_f32 v90, v90
    v_mul_f32 v28, v24, v28
    v_mul_f32 v32, v24, v32
    v_fmac_f32 v28, v26, v29
    v_fmac_f32 v32, v26, v33
    v_fmac_f32 v28, v36, v30
    v_fmac_f32 v32, v36, v34
    v_fmac_f32 v28, v38, v31
    v_fmac_f32 v32, v38, v35
    s_nop 1
    v_permlane16_swap_b32 v28, v32
    v_add_f32 v28, v28, v32
    v_mul_f32 v28, v28, v90
    ds_write_b32 v5, v28
    s_waitcnt lgkmcnt(0)
    s_barrier
    s_cbranch_scc1 WNOT0
    ds_read_b128 v[40:43], v6 offset:3072
    ds_read_b128 v[44:47], v6 offset:3328
    ds_read_b128 v[48:51], v6 offset:3584
    ds_read_b128 v[52:55], v6 offset:3840
    s_waitcnt lgkmcnt(2)
    v_add_f32 v28, v40, v44
    v_add_f32 v29, v41, v45
    v_add_f32 v30, v42, v46
    v_add_f32 v31, v43, v47
    s_waitcnt lgkmcnt(0)
    v_add_f32 v32, v48, v52
    v_add_f32 v33, v49, v53
    v_add_f32 v34, v50, v54
    v_add_f32 v35, v51, v55
    v_add_f32 v28, v28, v32
    v_add_f32 v29, v29, v33
    v_add_f32 v30, v30, v34
    v_add_f32 v31, v31, v35
    v_cvt_pk_bf16_f32 v28, v28, v29
    v_cvt_pk_bf16_f32 v29, v30, v31
    s_nop 0
    v_mov_b32_dpp v30, v28 quad_perm:[1,1,3,3] row_mask:0xf bank_mask:0xf
    v_mov_b32_dpp v31, v29 quad_perm:[1,1,3,3] row_mask:0xf bank_mask:0xf
    s_mov_b32 exec_lo, 0x55
    s_mov_b32 exec_hi, 0x0
    buffer_store_dwordx4 v[28:31], v18, s[16:19], s80 offen sc1
    s_cmp_eq_u32 s75, 1
    s_cbranch_scc0 SLOW16
    buffer_store_dwordx4 v[28:31], v18, s[16:19], s81 offen
BACK16:
    s_mov_b64 exec, -1
    v_lshrrev_b32 v37, 5, v0
    v_mul_u32_u24 v37, 2560, v37
    v_and_b32 v38, 31, v0
    v_lshl_add_u32 v37, v38, 2, v37
    v_add_u32 v41, 5120, v37
    v_add_u32 v42, 10240, v37
    v_add_u32 v43, 15360, v37
    v_add_u32 v44, 20480, v37
    v_add_u32 v45, 25600, v37
    s_lshl_b32 s79, s69, 7
    s_add_u32 s79, s79, s3
    s_add_u32 s79, s79, 46080
    s_add_u32 s96, s80, 10240
    s_add_u32 s97, s81, 1280
    v_lshlrev_b32 v39, 1, v0
    s_mov_b32 s76, 1
POLL17:
    buffer_load_dword v28, v37, s[16:19], s79 offen sc1
    buffer_load_dword v29, v41, s[16:19], s79 offen sc1
    buffer_load_dword v30, v42, s[16:19], s79 offen sc1
    buffer_load_dword v31, v43, s[16:19], s79 offen sc1
    buffer_load_dword v32, v44, s[16:19], s79 offen sc1
    buffer_load_dword v33, v45, s[16:19], s79 offen sc1
POLLW17:
    s_waitcnt vmcnt(0)
    v_max3_u32 v36, v28, v29, v30
    v_max3_u32 v36, v36, v31, v32
    v_max_u32 v36, v36, v33
    v_cmp_eq_u32 vcc, -1, v36
    s_cbranch_vccnz AGAIN17
POLLX17:
    v_add_f32 v28, v28, v29
    v_add_f32 v30, v30, v31
    v_add_f32 v32, v32, v33
    v_add_f32 v28, v28, v30
    v_add_f32 v28, v28, v32
    v_mov_b32 v29, v28
    s_nop 1
    v_permlane32_swap_b32 v28, v29
    v_add_f32 v28, v28, v29
    s_nop 1
    v_mov_b32_dpp v29, v28 row_shl:1 row_mask:0xf bank_mask:0xf
    v_cvt_pk_bf16_f32 v28, v28, v29
    s_nop 1
    v_mov_b32_dpp v29, v28 row_shl:2 row_mask:0xf bank_mask:0xf
    v_mov_b32_dpp v30, v28 row_shl:4 row_mask:0xf bank_mask:0xf
    v_mov_b32_dpp v31, v28 row_shl:6 row_mask:0xf bank_mask:0xf
    s_mov_b32 exec_lo, 0x1010101
    s_mov_b32 exec_hi, 0x0
    buffer_store_dwordx4 v[28:31], v39, s[16:19], s96 offen sc1
    s_cmp_eq_u32 s75, 1
    s_cbranch_scc0 SLOW18
    buffer_store_dwordx4 v[28:31], v39, s[16:19], s97 offen
BACK18:
    s_mov_b64 exec, -1
    s_branch NEXT
AGAIN7:
    s_add_u32 s76, s76, 1
    s_cmp_lt_u32 s76, 32768
    s_cbranch_scc1 POLL7
    s_branch POLLX7
AGAIN8:
    s_add_u32 s76, s76, 1
    s_cmp_lt_u32 s76, 32768
    s_cbranch_scc1 POLL8
    s_branch POLLX8
AGAIN10:
    s_add_u32 s76, s76, 1
    s_cmp_lt_u32 s76, 32768
    s_cbranch_scc1 POLL10
    s_branch POLLX10
AGAIN15:
    s_add_u32 s76, s76, 1
    s_cmp_lt_u32 s76, 32768
    s_cbranch_scc1 POLL15
    s_branch POLLX15
AGAIN17:
    s_add_u32 s76, s76, 1
    s_cmp_lt_u32 s76, 32768
    s_cbranch_scc1 POLL17
    s_branch POLLX17
WNOT0:
    s_cmp_lg_u32 s72, 1
    s_cbranch_scc1 NEXT
    v_and_b32 v25, 15, v0
    v_lshrrev_b32 v26, 4, v0
    v_mul_u32_u24 v37, 1280, v26
    v_add_u32 v37, 655360, v37
    s_mul_i32 s7, s68, 81920
    s_add_u32 s7, s7, 76800
    v_mov_b32 v38, s7
    v_cmp_eq_u32 vcc, s68, v26
    s_nop 1
    v_cndmask_b32 v37, v37, v38, vcc
    v_add_u32 v39, 4, v26
    v_mul_u32_u24 v38, 1280, v39
    v_add_u32 v38, 655360, v38
    s_mul_i32 s7, s68, 81920
    s_add_u32 s7, s7, 76800
    v_mov_b32 v28, s7
    v_cmp_eq_u32 vcc, s68, v39
    s_nop 1
    v_cndmask_b32 v38, v38, v28, vcc
    s_lshl_b32 s77, s69, 6
    s_add_u32 s77, s77, s74
    v_lshl_add_u32 v37, v25, 2, v37
    v_lshl_add_u32 v38, v25, 2, v38
    s_sleep 16
    s_mov_b32 s76, 1
POLL19:
    buffer_load_dword v28, v37, s[16:19], s77 offen sc1
    buffer_load_dword v29, v38, s[16:19], s77 offen sc1
POLLW19:
    s_waitcnt vmcnt(0)
    v_max_u32 v30, v28, v29
    v_cmp_eq_u32 vcc, -1, v30
    s_cbranch_vccnz AGAIN19
POLLX19:
    v_lshlrev_b32 v30, 16, v28
    v_and_b32 v28, 0xffff0000, v28
    v_lshlrev_b32 v31, 16, v29
    v_and_b32 v29, 0xffff0000, v29
    v_add_f32 v30, v30, v31
    v_add_f32 v28, v28, v29
    v_mov_b32 v31, v30
    v_mov_b32 v29, v28
    s_nop 0
    v_permlane32_swap_b32 v30, v31
    v_permlane32_swap_b32 v28, v29
    v_add_f32 v30, v30, v31
    v_add_f32 v28, v28, v29
    v_mov_b32 v31, v30
    v_mov_b32 v29, v28
    s_nop 0
    v_permlane16_swap_b32 v30, v31
    v_permlane16_swap_b32 v28, v29
    v_add_f32 v30, v30, v31
    v_add_f32 v28, v28, v29
    v_add_f32 v22, v22, v30
    v_add_f32 v23, v23, v28
    v_cvt_pk_bf16_f32 v28, v22, v23
    s_cmp_lg_u32 s74, 0
    s_cbranch_scc1 FINAL
    s_lshl_b32 s77, s69, 6
    s_add_u32 s77, s77, s3
    s_add_u32 s77, s77, 80640
    v_lshlrev_b32 v37, 2, v0
    v_mov_b32_dpp v29, v28 quad_perm:[1,1,1,1] row_mask:0xf bank_mask:0xf
    v_mov_b32_dpp v30, v28 quad_perm:[2,2,2,2] row_mask:0xf bank_mask:0xf
    v_mov_b32_dpp v31, v28 quad_perm:[3,3,3,3] row_mask:0xf bank_mask:0xf
    s_mov_b32 exec_lo, 0x1111
    s_mov_b32 exec_hi, 0x0
    s_cmp_eq_u32 s75, 1
    s_cbranch_scc0 SLOW20
    buffer_store_dwordx4 v[28:31], v37, s[16:19], s77 offen
BACK20:
    s_mov_b64 exec, -1
    s_branch NEXT
FINAL:
    s_cmp_lg_u32 s68, 0
    s_cbranch_scc1 DONE
    s_lshl_b32 s77, s69, 6
    v_lshlrev_b32 v37, 2, v0
    s_add_u32 s79, s77, s3
    s_add_u32 s79, s79, 78080
    s_mov_b64 exec, 15
    s_mov_b32 s76, 1
POLL21:
    buffer_load_dword v28, v1, s[16:19], s79 offen sc1
POLLW21:
    s_waitcnt vmcnt(0)
    v_cmp_eq_u32 vcc, -1, v28
    s_cbranch_vccnz AGAIN21
POLLX21:
    s_mov_b64 exec, -1
    s_mov_b32 s76, 1
POLL22:
    buffer_load_dword v28, v20, s[16:19], s74 offen sc1
    buffer_load_dword v29, v21, s[16:19], s74 offen sc1
POLLW22:
    s_waitcnt vmcnt(0)
    v_max_u32 v30, v28, v29
    v_cmp_eq_u32 vcc, -1, v30
    s_cbranch_vccnz AGAIN22
POLLX22:
    v_lshlrev_b32 v30, 16, v28
    v_and_b32 v28, 0xffff0000, v28
    v_lshlrev_b32 v31, 16, v29
    v_and_b32 v29, 0xffff0000, v29
    v_add_f32 v30, v30, v31
    v_add_f32 v28, v28, v29
    v_mov_b32 v31, v30
    v_mov_b32 v29, v28
    s_nop 0
    v_permlane32_swap_b32 v30, v31
    v_permlane32_swap_b32 v28, v29
    v_add_f32 v30, v30, v31
    v_add_f32 v28, v28, v29
    v_mov_b32 v31, v30
    v_mov_b32 v29, v28
    s_nop 0
    v_permlane16_swap_b32 v30, v31
    v_permlane16_swap_b32 v28, v29
    v_add_f32 v30, v30, v31
    v_add_f32 v28, v28, v29
    v_add_f32 v22, v22, v30
    v_add_f32 v23, v23, v28
    v_cvt_pk_bf16_f32 v28, v22, v23
    s_mov_b32 exec_lo, 0xffff
    s_mov_b32 exec_hi, 0x0
    buffer_store_dword v28, v37, s[40:43], s77 offen
    s_mov_b64 exec, -1
    s_endpgm
AGAIN19:
    s_sleep 4
    s_add_u32 s76, s76, 1
    s_cmp_lt_u32 s76, 32768
    s_cbranch_scc1 POLL19
    s_branch POLLX19
AGAIN21:
    s_add_u32 s76, s76, 1
    s_cmp_lt_u32 s76, 32768
    s_cbranch_scc1 POLL21
    s_branch POLLX21
AGAIN22:
    s_add_u32 s76, s76, 1
    s_cmp_lt_u32 s76, 32768
    s_cbranch_scc1 POLL22
    s_branch POLLX22
ROLEF:
    v_and_b32 v25, 15, v0
    v_lshrrev_b32 v26, 4, v0
    v_bfe_u32 v27, v0, 2, 2
    v_and_b32 v36, 3, v0
    s_mov_b32 s4, 1
    s_cmp_lg_u32 s74, 0
    s_cbranch_scc1 FW
    s_mov_b32 s4, 0
FW:
    s_mul_i32 s77, s72, 5120
    s_add_u32 s77, s77, 57344
    v_lshl_add_u32 v37, v26, 3, v27
    v_lshlrev_b32 v37, 5, v37
    v_lshl_add_u32 v37, v36, 3, v37
    v_add_u32 v37, s77, v37
    ds_read_b64_tr_b16 v[40:41], v37 offset:0
    ds_read_b64_tr_b16 v[42:43], v37 offset:128
    ds_read_b64_tr_b16 v[44:45], v37 offset:1024
    ds_read_b64_tr_b16 v[46:47], v37 offset:1152
    ds_read_b64_tr_b16 v[48:49], v37 offset:2048
    ds_read_b64_tr_b16 v[50:51], v37 offset:2176
    ds_read_b64_tr_b16 v[52:53], v37 offset:3072
    ds_read_b64_tr_b16 v[54:55], v37 offset:3200
    ds_read_b64_tr_b16 v[56:57], v37 offset:4096
    ds_read_b64_tr_b16 v[58:59], v37 offset:4224
    ds_read_b64_tr_b16 v[60:61], v37 offset:20480
    ds_read_b64_tr_b16 v[62:63], v37 offset:20608
    ds_read_b64_tr_b16 v[64:65], v37 offset:21504
    ds_read_b64_tr_b16 v[66:67], v37 offset:21632
    ds_read_b64_tr_b16 v[68:69], v37 offset:22528
    ds_read_b64_tr_b16 v[70:71], v37 offset:22656
    ds_read_b64_tr_b16 v[72:73], v37 offset:23552
    ds_read_b64_tr_b16 v[74:75], v37 offset:23680
    ds_read_b64_tr_b16 v[76:77], v37 offset:24576
    ds_read_b64_tr_b16 v[78:79], v37 offset:24704
    s_mul_i32 s77, s72, 320
    s_add_u32 s77, s77, 98304
    v_lshrrev_b32 v80, 2, v0
    v_mul_u32_u24 v80, 1280, v80
    v_lshl_add_u32 v80, v36, 3, v80
    v_add_u32 v80, s77, v80
    s_lshl_b32 s79, s72, 2
    s_add_u32 s79, s79, 123392
    v_add_u32 v81, s79, v1
    v_lshl_add_u32 v82, v26, 2, v36
    v_lshlrev_b32 v82, 4, v82
    v_add_u32 v82, 123392, v82
    v_cmp_eq_u32 vcc, 12, v25
    v_mov_b32 v38, 13
    s_nop 0
    v_cndmask_b32 v83, v25, v38, vcc
    v_lshlrev_b32 v83, 4, v83
    v_add_u32 v83, 123904, v83
    v_mov_b32 v85, 124096
    v_lshlrev_b32 v84, 6, v25
    v_lshl_add_u32 v84, v26, 4, v84
    v_mov_b32 v38, 0x3f803f80
    v_cndmask_b32 v88, 0, v38, vcc
    v_mov_b32 v89, v88
    v_mov_b32 v90, v88
    v_mov_b32 v91, v88
    v_mov_b32 v92, v88
    v_mov_b32 v93, v88
    v_mov_b32 v94, v88
    v_mov_b32 v95, v88
    v_mov_b32 v96, v88
    v_mov_b32 v97, v88
    v_mov_b32 v98, v88
    v_mov_b32 v99, v88
    v_mov_b32 v100, v88
    v_mov_b32 v101, v88
    v_mov_b32 v102, v88
    v_mov_b32 v103, v88
    v_mov_b32 v104, v88
    v_mov_b32 v105, v88
    v_mov_b32 v106, v88
    v_mov_b32 v107, v88
    s_mul_i32 s77, s72, 6656
    v_mul_u32_u24 v6, 336, v25
    v_lshl_add_u32 v6, v26, 4, v6
    v_add_u32 v6, s77, v6
    v_mul_u32_u24 v37, 52, v0
    v_lshrrev_b32 v37, 10, v37
    v_lshl_add_u32 v87, v37, 4, v1
    v_add_u32 v87, s77, v87
    v_mul_u32_u24 v27, 320, v37
    v_sub_u32 v27, v1, v27
    v_mul_u32_u24 v86, 1280, v37
    v_add_u32 v86, 655360, v86
    s_mul_i32 s7, s68, 81920
    s_add_u32 s7, s7, 76800
    v_mov_b32 v38, s7
    v_cmp_eq_u32 vcc, s68, v37
    s_nop 1
    v_cndmask_b32 v86, v86, v38, vcc
    v_add_u32 v38, 2560, v38
    v_cmp_le_u32 vcc, 8, v37
    s_nop 1
    v_cndmask_b32 v86, v86, v38, vcc
    v_add_u32 v86, v86, v27
    v_add_u32 v37, 3, v37
    v_mul_u32_u24 v18, 1280, v37
    v_add_u32 v18, 655360, v18
    s_mul_i32 s7, s68, 81920
    s_add_u32 s7, s7, 76800
    v_mov_b32 v38, s7
    v_cmp_eq_u32 vcc, s68, v37
    s_nop 1
    v_cndmask_b32 v18, v18, v38, vcc
    v_add_u32 v38, 2560, v38
    v_cmp_le_u32 vcc, 8, v37
    s_nop 1
    v_cndmask_b32 v18, v18, v38, vcc
    v_add_u32 v18, v18, v27
    v_add_u32 v37, 3, v37
    v_mul_u32_u24 v20, 1280, v37
    v_add_u32 v20, 655360, v20
    s_mul_i32 s7, s68, 81920
    s_add_u32 s7, s7, 76800
    v_mov_b32 v38, s7
    v_cmp_eq_u32 vcc, s68, v37
    s_nop 1
    v_cndmask_b32 v20, v20, v38, vcc
    v_add_u32 v38, 2560, v38
    v_cmp_le_u32 vcc, 8, v37
    s_nop 1
    v_cndmask_b32 v20, v20, v38, vcc
    v_add_u32 v20, v20, v27
    s_mul_i32 s77, s72, 320
    s_add_u32 s77, s77, s74
    s_sub_u32 s78, s69, 20
    s_mul_i32 s78, s78, 2560
    s_mul_i32 s7, s72, 640
    s_add_u32 s78, s78, s7
    s_add_u32 s78, s78, s3
    s_add_u32 s78, s78, 46080
    s_waitcnt lgkmcnt(0)
    s_cmp_eq_u32 s4, 0
    s_cbranch_scc1 FW2
FPOLL:
    ds_read_b64_tr_b16 a[240:241], v80 offset:0
    ds_read_b64_tr_b16 a[242:243], v80 offset:32
    ds_read_b64_tr_b16 a[244:245], v80 offset:64
    ds_read_b64_tr_b16 a[246:247], v80 offset:96
    ds_read_b64_tr_b16 a[248:249], v80 offset:128
    ds_read_b64_tr_b16 a[250:251], v80 offset:160
    ds_read_b64_tr_b16 v[108:109], v80 offset:192
    ds_read_b64_tr_b16 v[110:111], v80 offset:224
    ds_read_b64_tr_b16 v[2:3], v80 offset:256
    ds_read_b64_tr_b16 v[4:5], v80 offset:288
    s_waitcnt lgkmcnt(0)
    s_mul_i32 s79, s72, 320
    s_add_u32 s79, s79, s3
    s_add_u32 s79, s79, 76800
    s_mov_b32 exec_lo, 0xfffff
    s_mov_b32 exec_hi, 0x0
    s_mov_b32 s76, 1
POLL23:
    buffer_load_dword v36, v1, s[16:19], s79 offen sc1
POLLW23:
    s_waitcnt vmcnt(0)
    v_cmp_eq_u32 vcc, -1, v36
    s_cbranch_vccnz AGAIN23
POLLX23:
    s_mov_b32 exec_lo, 0xffffffff
    s_mov_b32 exec_hi, 0xfffffff
    s_mov_b32 s76, 1
POLL24:
    buffer_load_dwordx4 v[24:27], v86, s[16:19], s77 offen sc1
    buffer_load_dwordx4 v[28:31], v18, s[16:19], s77 offen sc1
    buffer_load_dwordx4 v[32:35], v20, s[16:19], s77 offen sc1
POLLW24:
    s_waitcnt vmcnt(0)
    v_max3_u32 v36, v24, v28, v32
    v_cmp_eq_u32 vcc, -1, v36
    s_cbranch_vccnz AGAIN24
POLLX24:
    ds_write_b128 v87, v[24:27] offset:0
    ds_write_b128 v87, v[28:31] offset:1008
    ds_write_b128 v87, v[32:35] offset:2016
    s_mov_b32 exec_lo, 0x1ff01ff
    s_mov_b32 exec_hi, 0x1ff01ff
    ds_read_b128 v[88:91], v6 offset:0
    ds_read_b128 v[92:95], v6 offset:64
    ds_read_b128 v[96:99], v6 offset:128
    ds_read_b128 v[100:103], v6 offset:192
    ds_read_b128 v[104:107], v6 offset:256
    s_mov_b64 exec, -1
FMM:
    s_waitcnt lgkmcnt(4)
    v_mfma_f32_16x16x32_bf16 v[24:27], v[88:91], v[40:43], 0
    v_mfma_f32_16x16x32_bf16 v[28:31], v[88:91], v[60:63], 0
    v_mfma_f32_16x16x32_bf16 v[32:35], v[88:91], v[88:91], 0
    s_waitcnt lgkmcnt(3)
    v_mfma_f32_16x16x32_bf16 v[24:27], v[92:95], v[44:47], v[24:27]
    v_mfma_f32_16x16x32_bf16 v[28:31], v[92:95], v[64:67], v[28:31]
    v_mfma_f32_16x16x32_bf16 v[32:35], v[92:95], v[92:95], v[32:35]
    s_waitcnt lgkmcnt(2)
    v_mfma_f32_16x16x32_bf16 v[24:27], v[96:99], v[48:51], v[24:27]
    v_mfma_f32_16x16x32_bf16 v[28:31], v[96:99], v[68:71], v[28:31]
    v_mfma_f32_16x16x32_bf16 v[32:35], v[96:99], v[96:99], v[32:35]
    s_waitcnt lgkmcnt(1)
    v_mfma_f32_16x16x32_bf16 v[24:27], v[100:103], v[52:55], v[24:27]
    v_mfma_f32_16x16x32_bf16 v[28:31], v[100:103], v[72:75], v[28:31]
    v_mfma_f32_16x16x32_bf16 v[32:35], v[100:103], v[100:103], v[32:35]
    s_waitcnt lgkmcnt(0)
    v_mfma_f32_16x16x32_bf16 v[24:27], v[104:107], v[56:59], v[24:27]
    v_mfma_f32_16x16x32_bf16 v[28:31], v[104:107], v[76:79], v[28:31]
    v_mfma_f32_16x16x32_bf16 v[32:35], v[104:107], v[104:107], v[32:35]
    s_nop 5
    v_add_f32 v24, v24, v25
    v_add_f32 v26, v26, v27
    v_add_f32 v28, v28, v29
    v_add_f32 v30, v30, v31
    v_add_f32 v32, v32, v33
    v_add_f32 v34, v34, v35
    v_add_f32 v24, v24, v26
    v_add_f32 v28, v28, v30
    v_add_f32 v32, v32, v34
    s_nop 1
    v_permlane32_swap_b32 v24, v32
    v_permlane32_swap_b32 v28, v25
    v_add_f32 v24, v24, v32
    v_add_f32 v28, v28, v25
    s_nop 1
    v_permlane16_swap_b32 v24, v28
    v_add_f32 v24, v24, v28
    ds_write_b32 v81, v24
    s_cmp_eq_u32 s4, 0
    s_waitcnt lgkmcnt(0)
    s_barrier
    ds_read_b128 v[24:27], v83
    ds_read_b128 v[28:31], v85
    ds_read_b128 v[32:35], v82
    ds_read_b128 v[36:39], v82 offset:256
    s_cbranch_scc1 FCS
    s_waitcnt lgkmcnt(3)
    v_add_f32 v24, v24, v25
    v_add_f32 v26, v26, v27
    v_add_f32 v24, v24, v26
    s_waitcnt lgkmcnt(2)
    v_add_f32 v28, v28, v29
    v_add_f32_dpp v24, v24, v24 row_ror:8 row_mask:0xf bank_mask:0xf
    v_add_f32 v30, v30, v31
    v_add_f32 v28, v28, v30
    v_add_f32_dpp v24, v24, v24 row_ror:4 row_mask:0xf bank_mask:0xf
    s_waitcnt lgkmcnt(0)
    v_subrev_f32 v29, 0x44200000, v28
    v_add_f32_dpp v24, v24, v24 row_ror:2 row_mask:0xf bank_mask:0xf
    v_add_f32 v32, v32, v33
    v_mul_f32 v30, 0x3acccccd, v29
    v_add_f32_dpp v24, v24, v24 row_ror:1 row_mask:0xf bank_mask:0xf
    v_add_f32 v34, v34, v35
    v_sub_f32 v24, v24, v29
    v_add_f32 v32, v32, v34
    v_mul_f32 v24, 0x3acccccd, v24
    v_add_f32 v36, v36, v37
    v_fma_f32 v24, -v30, v30, v24
    v_add_f32 v38, v38, v39
    v_max_f32 v24, 0, v24
    v_fma_f32 v32, -v28, v22, v32
    v_add_f32 v24, 0x3727c5ac, v24
    v_add_f32 v36, v36, v38
    v_rsq_f32 v24, v24
    v_fma_f32 v36, -v28, v23, v36
    v_mul_f32 v33, 0xbfb8aa3b, v32
    v_mul_f32 v33, v33, v24
    v_mul_f32 v36, v36, v32
    v_exp_f32 v33, v33
    v_mul_f32 v36, v36, v24
    v_add_f32 v33, 1.0, v33
    v_mul_f32 v36, v36, v24
    v_rcp_f32 v33, v33
    s_nop 0
    v_mul_f32 v36, v36, v33
    s_nop 1
    v_mov_b32_dpp v28, v36 quad_perm:[0,0,0,0] row_mask:0xf bank_mask:0xf
    v_mov_b32_dpp v29, v36 quad_perm:[1,1,1,1] row_mask:0xf bank_mask:0xf
    v_mov_b32_dpp v30, v36 quad_perm:[2,2,2,2] row_mask:0xf bank_mask:0xf
    v_mov_b32_dpp v31, v36 quad_perm:[3,3,3,3] row_mask:0xf bank_mask:0xf
    v_cvt_pk_bf16_f32 v28, v28, v29
    v_cvt_pk_bf16_f32 v29, v30, v31
    v_cndmask_b32 v60, 0, v28, s[44:45]
    v_cndmask_b32 v61, 0, v29, s[44:45]
    v_cndmask_b32 v62, 0, v28, s[46:47]
    v_cndmask_b32 v63, 0, v29, s[46:47]
    v_cndmask_b32 v64, 0, v28, s[48:49]
    v_cndmask_b32 v65, 0, v29, s[48:49]
    v_mfma_f32_16x16x32_bf16 v[24:27], a[240:243], v[60:63], 0
    v_cndmask_b32 v66, 0, v28, s[50:51]
    v_cndmask_b32 v67, 0, v29, s[50:51]
    v_cndmask_b32 v68, 0, v28, s[52:53]
    v_cndmask_b32 v69, 0, v29, s[52:53]
    v_mfma_f32_16x16x32_bf16 v[24:27], a[244:247], v[64:67], v[24:27]
    v_cndmask_b32 v70, 0, v28, s[54:55]
    v_cndmask_b32 v71, 0, v29, s[54:55]
    v_cndmask_b32 v72, 0, v28, s[56:57]
    v_cndmask_b32 v73, 0, v29, s[56:57]
    v_mfma_f32_16x16x32_bf16 v[24:27], a[248:251], v[68:71], v[24:27]
    v_cndmask_b32 v74, 0, v28, s[58:59]
    v_cndmask_b32 v75, 0, v29, s[58:59]
    v_cndmask_b32 v76, 0, v28, s[60:61]
    v_cndmask_b32 v77, 0, v29, s[60:61]
    v_mfma_f32_16x16x32_bf16 v[24:27], v[108:111], v[72:75], v[24:27]
    v_cndmask_b32 v78, 0, v28, s[62:63]
    v_cndmask_b32 v79, 0, v29, s[62:63]
    s_nop 1
    v_mfma_f32_16x16x32_bf16 v[24:27], v[2:5], v[76:79], v[24:27]
    s_mov_b32 exec_lo, 0x3ff03ff
    s_mov_b32 exec_hi, 0x3ff03ff
    s_cmp_eq_u32 s75, 1
    s_cbranch_scc0 SLOW25
    s_nop 3
    buffer_store_dwordx4 v[24:27], v84, s[16:19], s78 offen
BACK25:
    s_mov_b64 exec, -1
NEXT:
    s_cmp_lg_u32 s74, 0
    s_cbranch_scc1 DONE
    s_mov_b32 s74, 688128
    s_add_u32 s3, s3, 688128
    s_add_u32 s80, s80, 688128
    s_add_u32 s81, s81, 688128
    s_branch LOOP
AGAIN23:
    s_add_u32 s76, s76, 1
    s_cmp_lt_u32 s76, 32768
    s_cbranch_scc1 POLL23
    s_branch POLLX23
AGAIN24:
    s_add_u32 s76, s76, 1
    s_cmp_lt_u32 s76, 32768
    s_cbranch_scc1 POLL24
    s_branch POLLX24
DONE:
    s_endpgm
RDYLOOP:
    s_mov_b32 s76, 0
RDYL2:
    s_sleep 8
    global_load_dword v99, v98, s[64:65] sc1
    s_waitcnt vmcnt(0)
    v_sad_u8 v100, v99, 0, 0
    s_nop 1
    v_add_u32_dpp v100, v100, v100 quad_perm:[1,0,3,2] row_mask:0xf bank_mask:0xf
    s_nop 1
    v_add_u32_dpp v100, v100, v100 quad_perm:[2,3,0,1] row_mask:0xf bank_mask:0xf
    v_cmp_gt_u32 vcc, 32, v100
    s_mov_b32 vcc_hi, 0
    s_cmp_eq_u64 vcc, 0
    s_cbranch_scc1 RDYOK
    s_add_u32 s76, s76, 1
    s_cmp_lt_u32 s76, 32768
    s_cbranch_scc1 RDYL2
    s_branch RDYOK
SLOW2:
    buffer_store_dword v24, v10, s[16:19], s79 offen sc1
    s_branch BACK2
SLOW3:
    buffer_store_dword v24, v10, s[16:19], s3 offen sc1
    s_branch BACK3
SLOW4:
    buffer_store_dwordx4 v[28:31], v27, s[16:19], s77 offen sc1
    s_branch BACK4
DMAF:
    v_lshrrev_b32 v38, 1, v0
    v_mul_u32_u24 v38, 3072, v38
    v_and_b32 v39, 1, v0
    v_lshl_add_u32 v38, v39, 4, v38
    s_mul_i32 s79, s68, 12
    s_add_u32 s79, s79, s69
    s_sub_u32 s79, s79, 20
    s_mul_i32 s77, s72, 491520
    s_lshl_b32 s78, s79, 5
    s_add_u32 s77, s77, s78
    s_mul_i32 s78, s72, 5120
    s_add_u32 m0, s78, 57344
    s_nop 0
    buffer_load_dwordx4 v38, s[24:27], s77 offen  lds
    s_add_u32 m0, s78, 77824
    s_nop 0
    buffer_load_dwordx4 v38, s[28:31], s77 offen  lds
    s_add_u32 s77, s77, 98304
    s_add_u32 m0, s78, 58368
    s_nop 0
    buffer_load_dwordx4 v38, s[24:27], s77 offen  lds
    s_add_u32 m0, s78, 78848
    s_nop 0
    buffer_load_dwordx4 v38, s[28:31], s77 offen  lds
    s_add_u32 s77, s77, 98304
    s_add_u32 m0, s78, 59392
    s_nop 0
    buffer_load_dwordx4 v38, s[24:27], s77 offen  lds
    s_add_u32 m0, s78, 79872
    s_nop 0
    buffer_load_dwordx4 v38, s[28:31], s77 offen  lds
    s_add_u32 s77, s77, 98304
    s_add_u32 m0, s78, 60416
    s_nop 0
    buffer_load_dwordx4 v38, s[24:27], s77 offen  lds
    s_add_u32 m0, s78, 80896
    s_nop 0
    buffer_load_dwordx4 v38, s[28:31], s77 offen  lds
    s_add_u32 s77, s77, 98304
    s_add_u32 m0, s78, 61440
    s_nop 0
    buffer_load_dwordx4 v38, s[24:27], s77 offen  lds
    s_add_u32 m0, s78, 81920
    s_nop 0
    buffer_load_dwordx4 v38, s[28:31], s77 offen  lds
    s_branch DMAX
RETRY5:
    s_add_u32 s77, s3, 1376256
    s_add_u32 s78, s3, 1380352
    s_add_u32 s79, s3, 4096
    s_mov_b32 s76, 1
POLL26:
    buffer_load_dwordx4 v[64:67], v11, s[16:19], s77 offen sc1
    buffer_load_dwordx4 v[68:71], v11, s[16:19], s78 offen sc1
    buffer_load_dwordx4 v[72:75], v11, s[16:19], s3 offen sc1
    buffer_load_dwordx4 v[76:79], v11, s[16:19], s79 offen sc1
POLLW26:
    s_waitcnt vmcnt(0)
    v_max3_u32 v24, v64, v65, v66
    v_max3_u32 v24, v24, v67, v68
    v_max3_u32 v24, v24, v69, v70
    v_max3_u32 v24, v24, v71, v72
    v_max3_u32 v24, v24, v73, v74
    v_max3_u32 v24, v24, v75, v76
    v_max3_u32 v24, v24, v77, v78
    v_max_u32 v24, v24, v79
    v_cmp_eq_u32 vcc, -1, v24
    s_cbranch_vccnz AGAIN26
POLLX26:
    s_branch OK5
AGAIN26:
    s_add_u32 s76, s76, 1
    s_cmp_lt_u32 s76, 32768
    s_cbranch_scc1 POLL26
    s_branch POLLX26
SLOW9:
    buffer_store_dword v24, v10, s[16:19], s3 offen sc1
    s_branch BACK9
SLOW11:
    buffer_store_dwordx4 v[28:31], v39, s[16:19], s77 offen sc1
    s_branch BACK11
SLOW12:
    buffer_store_dwordx2 v[32:33], v39, s[16:19], s78 offen sc1
    s_branch BACK12
RETRY13:
    s_mov_b32 s76, 1
POLL27:
    buffer_load_dword v28, v20, s[16:19], 0 offen sc1
    buffer_load_dword v29, v21, s[16:19], 0 offen sc1
POLLW27:
    s_waitcnt vmcnt(0)
    v_max_u32 v30, v28, v29
    v_cmp_eq_u32 vcc, -1, v30
    s_cbranch_vccnz AGAIN27
POLLX27:
    s_branch OK13
AGAIN27:
    s_add_u32 s76, s76, 1
    s_cmp_lt_u32 s76, 32768
    s_cbranch_scc1 POLL27
    s_branch POLLX27
SLOW14:
    buffer_store_dwordx4 v[28:31], v37, s[16:19], s77 offen sc1
    s_branch BACK14
SLOW16:
    buffer_store_dwordx4 v[28:31], v18, s[16:19], s81 offen sc1
    s_branch BACK16
SLOW18:
    buffer_store_dwordx4 v[28:31], v39, s[16:19], s97 offen sc1
    s_branch BACK18
SLOW20:
    buffer_store_dwordx4 v[28:31], v37, s[16:19], s77 offen sc1
    s_branch BACK20
FW2:
    s_mul_i32 s79, s68, 12
    s_add_u32 s79, s79, s69
    s_sub_u32 s79, s79, 20
    s_mul_i32 s97, s72, 5120
    s_mul_i32 s96, s79, 20480
    s_add_u32 s96, s96, s97
    s_add_u32 m0, s97, 98304
    s_nop 0
    buffer_load_dwordx4 v1, s[32:35], s96 offen nt lds
    s_add_u32 s96, s96, 1024
    s_add_u32 m0, s97, 99328
    s_nop 0
    buffer_load_dwordx4 v1, s[32:35], s96 offen nt lds
    s_add_u32 s96, s96, 1024
    s_add_u32 m0, s97, 100352
    s_nop 0
    buffer_load_dwordx4 v1, s[32:35], s96 offen nt lds
    s_add_u32 s96, s96, 1024
    s_add_u32 m0, s97, 101376
    s_nop 0
    buffer_load_dwordx4 v1, s[32:35], s96 offen nt lds
    s_add_u32 s96, s96, 1024
    s_add_u32 m0, s97, 102400
    s_nop 0
    buffer_load_dwordx4 v1, s[32:35], s96 offen nt lds
    s_branch FMM
SLOW25:
    s_nop 3
    buffer_store_dwordx4 v[24:27], v84, s[16:19], s78 offen sc1
    s_branch BACK25
FCS:
    s_waitcnt lgkmcnt(0)
    v_add_f32 v32, v32, v33
    v_add_f32 v34, v34, v35
    v_add_f32 v32, v32, v34
    v_add_f32 v36, v36, v37
    v_add_f32 v38, v38, v39
    v_add_f32 v36, v36, v38
    v_mul_f32 v22, 0x3acccccd, v32
    v_mul_f32 v23, 0x3acccccd, v36
    s_mov_b32 s4, 1
    s_waitcnt vmcnt(0)
    s_barrier
    s_branch FPOLL
CODE_END:
    s_endpgm
.section .rodata,"a"
.p2align 6
.amdhsa_kernel interleave_layers__sliding_block_cached__glu_gated_swiglu__decode_kernel
  .amdhsa_next_free_vgpr 512
  .amdhsa_next_free_sgpr 102
  .amdhsa_accum_offset 256
  .amdhsa_group_segment_fixed_size 0
  .amdhsa_kernarg_size 96
  .amdhsa_user_sgpr_count 2
  .amdhsa_user_sgpr_kernarg_segment_ptr 1
  .amdhsa_system_sgpr_workgroup_id_x 1
.end_amdhsa_kernel
```

```asm
; @launch grid=(256,1,1) block=(256,1,1) lds=125568
.amdgcn_target "amdgcn-amd-amdhsa--gfx950"
.text
.globl interleave_layers__sliding_block_cached__glu_gated_swiglu__decode_kernel
.p2align 8
.type interleave_layers__sliding_block_cached__glu_gated_swiglu__decode_kernel,@function
interleave_layers__sliding_block_cached__glu_gated_swiglu__decode_kernel:
    s_load_dwordx16 s[44:59], s[0:1], 0
    s_load_dwordx8 s[60:67], s[0:1], 64
    s_cmp_ge_u32 s2, 256
    s_cbranch_scc1 CODE_END
    v_lshrrev_b32 v2, 6, v0
    v_and_b32 v24, 63, v0
    v_readfirstlane_b32 s72, v2
    s_and_b32 s68, s2, 7
    s_lshr_b32 s69, s2, 3
    s_lshr_b32 s70, s69, 3
    s_and_b32 s71, s69, 7
    v_lshlrev_b32 v1, 4, v24
    s_lshl_b32 s77, s70, 3
    s_add_u32 s77, s77, s68
    s_mul_i32 s73, s77, 12582912
    s_lshl_b32 s78, s71, 2
    s_add_u32 s78, s78, s72
    s_mul_i32 s78, s78, 6144
    s_add_u32 s73, s73, s78
    s_add_u32 s73, s73, 11010048
    v_add_u32 v23, 4096, v1
    s_mov_b32 s10, 402653184
    s_mov_b32 s11, 0x20000
    s_getpc_b64 s[100:101]
PCREF:
    s_sub_u32 s100, s100, PCREF-interleave_layers__sliding_block_cached__glu_gated_swiglu__decode_kernel
    s_subb_u32 s101, s101, 0
    s_lshl_b32 s78, s71, 12
    v_lshl_add_u32 v25, v0, 4, s78
    v_cmp_gt_u32 vcc, CODE_END-interleave_layers__sliding_block_cached__glu_gated_swiglu__decode_kernel-16, v25
    s_nop 0
    s_and_saveexec_b64 s[98:99], vcc
    s_cbranch_execz NOCPF
    global_load_dwordx4 a[240:243], v25, s[100:101]
NOCPF:
    s_mov_b64 exec, -1
    s_mul_i32 s79, s77, 384
    s_mov_b32 s74, 0
    s_mul_i32 s3, s68, 81920
    s_mov_b32 s75, 0
    v_mov_b32 v32, -1
    v_mov_b32 v33, -1
    v_mov_b32 v34, -1
    v_mov_b32 v35, -1
    s_mul_i32 s77, s69, 576
    s_add_u32 s77, s77, s3
    s_add_u32 s77, s77, 32768
    v_add_u32 v20, s77, v1
    s_mul_i32 s77, s2, 80
    s_add_u32 s77, s77, 654784
    v_add_u32 v25, s77, v1
    v_cmp_le_u32 vcc, 36, v0
    s_nop 1
    v_cndmask_b32 v21, v20, v25, vcc
    v_mov_b32 v25, 2147483632
    v_cndmask_b32 v20, v20, v25, vcc
    v_cmp_le_u32 vcc, 41, v0
    s_nop 1
    v_cndmask_b32 v21, v21, v25, vcc
    s_mov_b32 s18, 1610612736
    s_mov_b32 s19, 0x20000
    s_waitcnt lgkmcnt(0)
    s_mov_b32 s8, s46
    s_and_b32 s9, s47, 0xffff
    s_mov_b32 s16, s66
    s_and_b32 s17, s67, 0xffff
    buffer_store_dwordx4 v[32:35], v21, s[16:19], 0 offen sc1
    buffer_load_dwordx4 a[0:3], v1, s[8:11], s73 offen offset:0 nt
    buffer_load_dwordx4 a[4:7], v1, s[8:11], s73 offen offset:1024 nt
    buffer_load_dwordx4 a[8:11], v1, s[8:11], s73 offen offset:2048 nt
    buffer_load_dwordx4 a[12:15], v1, s[8:11], s73 offen offset:3072 nt
    buffer_load_dwordx4 a[16:19], v23, s[8:11], s73 offen offset:0 nt
    buffer_load_dwordx4 a[20:23], v23, s[8:11], s73 offen offset:1024 nt
    s_add_u32 s83, s73, 196608
    buffer_load_dwordx4 a[24:27], v1, s[8:11], s83 offen offset:0 nt
    buffer_load_dwordx4 a[28:31], v1, s[8:11], s83 offen offset:1024 nt
    buffer_load_dwordx4 a[32:35], v1, s[8:11], s83 offen offset:2048 nt
    buffer_load_dwordx4 a[36:39], v1, s[8:11], s83 offen offset:3072 nt
    buffer_load_dwordx4 a[40:43], v23, s[8:11], s83 offen offset:0 nt
    buffer_load_dwordx4 a[44:47], v23, s[8:11], s83 offen offset:1024 nt
    s_mov_b32 s12, s48
    s_and_b32 s13, s49, 0xffff
    s_mov_b32 s14, 402653184
    s_mov_b32 s15, 0x20000
    s_mov_b32 s20, s50
    s_and_b32 s21, s51, 0xffff
    s_mov_b32 s22, 7864320
    s_mov_b32 s23, 0x20000
    s_mov_b32 s36, s44
    s_and_b32 s37, s45, 0xffff
    s_mov_b32 s38, 1280
    s_mov_b32 s39, 0x20000
    s_mov_b32 s40, s62
    s_and_b32 s41, s63, 0xffff
    s_mov_b32 s42, 1280
    s_mov_b32 s43, 0x20000
    s_mov_b32 s28, s58
    s_and_b32 s29, s59, 0xffff
    s_mov_b32 s30, 1966080
    s_mov_b32 s31, 0x20000
    s_mov_b32 s32, s60
    s_and_b32 s33, s61, 0xffff
    s_mov_b32 s34, 1966080
    s_mov_b32 s35, 0x20000
    s_cmp_lt_u32 s69, 20
    s_cselect_b32 s24, s52, s56
    s_cselect_b32 s25, s53, s57
    s_cselect_b32 s26, s22, s30
    s_and_b32 s25, s25, 0xffff
    s_mov_b32 s27, 0x20000
    s_add_u32 s84, s83, 196608
    s_add_u32 s85, s84, 196608
    s_add_u32 s86, s85, 196608
    s_add_u32 s87, s86, 196608
    s_add_u32 s88, s87, 196608
    s_add_u32 s89, s88, 196608
    v_mov_b32 v0, v24
    s_mul_i32 s77, s72, 6656
    v_add_u32 v25, 0, v0
    v_mul_u32_u24 v26, 171, v25
    v_lshrrev_b32 v26, 12, v26
    v_mul_u32_u24 v27, 24, v26
    v_sub_u32 v27, v25, v27
    v_lshlrev_b32 v27, 4, v27
    v_mul_u32_u24 v25, 416, v26
    v_add3_u32 v2, v25, v27, s77
    v_mul_u32_u24 v25, 12288, v26
    v_add_u32 v40, v25, v27
    v_mul_u32_u24 v25, 3072, v26
    v_add_u32 v101, v25, v27
    v_add_u32 v25, 64, v0
    v_mul_u32_u24 v26, 171, v25
    v_lshrrev_b32 v26, 12, v26
    v_mul_u32_u24 v27, 24, v26
    v_sub_u32 v27, v25, v27
    v_lshlrev_b32 v27, 4, v27
    v_mul_u32_u24 v25, 416, v26
    v_add3_u32 v3, v25, v27, s77
    v_mul_u32_u24 v25, 12288, v26
    v_add_u32 v41, v25, v27
    v_mul_u32_u24 v25, 3072, v26
    v_add_u32 v102, v25, v27
    v_add_u32 v25, 128, v0
    v_mul_u32_u24 v26, 171, v25
    v_lshrrev_b32 v26, 12, v26
    v_mul_u32_u24 v27, 24, v26
    v_sub_u32 v27, v25, v27
    v_lshlrev_b32 v27, 4, v27
    v_mul_u32_u24 v25, 416, v26
    v_add3_u32 v4, v25, v27, s77
    v_mul_u32_u24 v25, 12288, v26
    v_add_u32 v42, v25, v27
    v_mul_u32_u24 v25, 3072, v26
    v_add_u32 v103, v25, v27
    s_getreg_b32 s5, hwreg(HW_REG_XCC_ID, 0, 4)
    s_lshr_b32 s92, s5, 2
    s_lshl_b32 s93, s68, 2
    s_add_u32 s92, s92, s93
    s_and_b32 s93, s5, 3
    s_lshl_b32 s93, s93, 3
    s_lshl_b32 s94, 1, s93
    s_lshl_b32 s96, 32, s93
    s_mov_b32 s5, s92
    s_cmp_lg_u32 s72, 0
    s_cbranch_scc1 NOATOM
    s_waitcnt vmcnt(12)
    s_lshl_b32 s92, s92, 2
    v_mov_b32 v36, s92
    v_mov_b32 v37, s94
    s_mov_b64 exec, 1
    global_atomic_add v36, v37, s[64:65] sc1
    s_mov_b64 exec, -1
NOATOM:
    s_mul_i32 s78, s71, 983040
    s_add_u32 s79, s79, s78
    s_mul_i32 s78, s72, 98304
    s_add_u32 s79, s79, s78
    s_mul_i32 s78, s72, 3072
    s_add_u32 s78, s78, 26624
    s_add_u32 m0, s78, 0
    s_nop 0
    buffer_load_dwordx4 v40, s[20:23], s79 offen nt lds
    s_add_u32 m0, s78, 1024
    s_nop 0
    buffer_load_dwordx4 v41, s[20:23], s79 offen nt lds
    s_add_u32 m0, s78, 2048
    s_nop 0
    buffer_load_dwordx4 v42, s[20:23], s79 offen nt lds
    s_add_u32 s79, s79, 393216
    s_add_u32 m0, s78, 12288
    s_nop 0
    buffer_load_dwordx4 v40, s[20:23], s79 offen nt lds
    s_add_u32 m0, s78, 13312
    s_nop 0
    buffer_load_dwordx4 v41, s[20:23], s79 offen nt lds
    s_add_u32 m0, s78, 14336
    s_nop 0
    buffer_load_dwordx4 v42, s[20:23], s79 offen nt lds
    s_add_u32 s79, s79, 393216
    s_cmp_ge_u32 s72, 2
    s_cbranch_scc1 NOWQ3
    s_add_u32 m0, s78, 24576
    s_nop 0
    buffer_load_dwordx4 v40, s[20:23], s79 offen nt lds
    s_add_u32 m0, s78, 25600
    s_nop 0
    buffer_load_dwordx4 v41, s[20:23], s79 offen nt lds
    s_add_u32 m0, s78, 26624
    s_nop 0
    buffer_load_dwordx4 v42, s[20:23], s79 offen nt lds
NOWQ3:
    v_and_b32 v25, 15, v0
    v_lshrrev_b32 v26, 4, v0
    v_bfe_u32 v27, v0, 2, 2
    v_and_b32 v28, 3, v0
    v_cmp_eq_u32 vcc, 12, v25
    v_mov_b32 v36, 0x3f803f80
    s_nop 0
    v_cndmask_b32 v70, 0, v36, vcc
    v_mov_b32 v71, v70
    v_mov_b32 v72, v70
    v_mov_b32 v73, v70
    v_mov_b32 v74, v70
    v_mov_b32 v75, v70
    v_mov_b32 v76, v70
    v_mov_b32 v77, v70
    v_mov_b32 v78, v70
    v_mov_b32 v79, v70
    v_mov_b32 v88, v70
    v_mov_b32 v89, v70
    v_mov_b32 v90, v70
    v_mov_b32 v91, v70
    v_mov_b32 v92, v70
    v_mov_b32 v93, v70
    v_mov_b32 v94, v70
    v_mov_b32 v95, v70
    v_mov_b32 v96, v70
    v_mov_b32 v97, v70
    s_mul_i32 s78, s71, 160
    v_lshlrev_b32 v36, 4, v26
    v_lshlrev_b32 v37, 3, v26
    s_mov_b32 exec_lo, 0x1000100
    s_mov_b32 exec_hi, 0x1000100
    buffer_load_dwordx4 v[88:91], v36, s[36:39], s78 offen
    buffer_load_dwordx4 v[92:95], v36, s[36:39], s78 offen offset:64
    buffer_load_dwordx2 v[96:97], v37, s[36:39], s78 offen offset:128
    s_mov_b64 exec, -1
    s_lshl_b32 s79, s69, 6
    v_lshlrev_b32 v38, 2, v25
    buffer_load_dword v22, v38, s[36:39], s79 offen
    s_mov_b32 s20, s52
    s_and_b32 s21, s53, 0xffff
    s_mov_b32 s22, 7864320
    s_mov_b32 s23, 0x20000
    s_cmp_lt_u32 s72, 2
    s_cselect_b32 s36, s56, s58
    s_cselect_b32 s37, s57, s59
    s_and_b32 s37, s37, 0xffff
    s_mov_b32 s38, 1966080
    s_lshl_b32 s90, s70, 3
    s_add_u32 s90, s90, s68
    s_lshl_b32 s90, s90, 3
    s_add_u32 s90, s90, s71
    s_mul_i32 s90, s90, 30720
    s_mul_i32 s79, s72, 6144
    s_add_u32 s90, s90, s79
    s_cmp_eq_u32 s72, 3
    s_cselect_b32 s79, 3072, 0
    s_add_u32 s90, s90, s79
    s_cmp_lt_u32 s72, 2
    s_cselect_b32 s79, 1879048176, 0
    v_add_u32 v108, s79, v23
    v_add_u32 v109, 4096, v108
    s_and_b32 s91, s72, 1
    s_lshl_b32 s79, s69, 1
    s_add_u32 s91, s91, s79
    s_mul_i32 s79, s91, 0
    s_add_u32 s79, s79, 640
    s_mul_i32 s91, s91, 16
    s_cmp_lt_u32 s69, 20
    s_cselect_b32 s91, s91, s79
    s_mov_b32 s7, 49152
    s_cselect_b32 s7, s7, 0
    s_mul_i32 s91, s91, 3072
    s_mul_i32 s79, s68, 384
    s_add_u32 s91, s91, s79
    v_mov_b32 v29, 1879048176
    v_add_u32 v104, 24576, v101
    v_add_u32 v105, 24576, v102
    v_add_u32 v106, 24576, v103
    v_cmp_gt_u32 vcc, s7, v101
    s_nop 1
    v_cndmask_b32 v101, v29, v101, vcc
    v_cmp_gt_u32 vcc, s7, v102
    s_nop 1
    v_cndmask_b32 v102, v29, v102, vcc
    v_cmp_gt_u32 vcc, s7, v103
    s_nop 1
    v_cndmask_b32 v103, v29, v103, vcc
    v_cmp_gt_u32 vcc, s7, v104
    s_nop 1
    v_cndmask_b32 v104, v29, v104, vcc
    v_cmp_gt_u32 vcc, s7, v105
    s_nop 1
    v_cndmask_b32 v105, v29, v105, vcc
    v_cmp_gt_u32 vcc, s7, v106
    s_nop 1
    v_cndmask_b32 v106, v29, v106, vcc
    buffer_load_dwordx4 a[48:51], v1, s[8:11], s84 offen offset:0 nt
    buffer_load_dwordx4 a[52:55], v1, s[8:11], s84 offen offset:1024 nt
    buffer_load_dwordx4 a[56:59], v1, s[8:11], s84 offen offset:2048 nt
    v_mul_u32_u24 v29, 416, v25
    v_lshl_add_u32 v29, v26, 4, v29
    v_add_u32 v5, s77, v29
    v_lshrrev_b32 v29, 2, v0
    v_mul_u32_u24 v29, 416, v29
    v_lshl_add_u32 v29, v28, 3, v29
    v_add_u32 v6, s77, v29
    s_mul_i32 s79, s72, 96
    s_add_u32 s79, s79, 26624
    v_lshl_add_u32 v29, v26, 3, v27
    v_mul_u32_u24 v29, 384, v29
    v_lshl_add_u32 v29, v28, 3, v29
    v_add_u32 v16, s79, v29
    v_lshl_add_u32 v29, v26, 2, v27
    v_mul_u32_u24 v29, 384, v29
    v_lshl_add_u32 v29, v28, 3, v29
    v_add_u32 v17, s79, v29
    buffer_load_dwordx4 a[60:63], v1, s[8:11], s84 offen offset:3072 nt
    v_mul_u32_u24 v31, 103, v0
    v_lshrrev_b32 v31, 10, v31
    v_mul_u32_u24 v30, 10, v31
    v_sub_u32 v30, v0, v30
    v_lshl_add_u32 v29, v30, 4, s78
    v_mul_u32_u24 v8, 1280, v31
    v_add_u32 v8, 665600, v8
    s_mul_i32 s7, s68, 81920
    s_add_u32 s7, s7, 47360
    v_mov_b32 v30, s7
    v_cmp_eq_u32 vcc, s68, v31
    s_nop 1
    v_cndmask_b32 v8, v8, v30, vcc
    v_add_u32 v30, 2560, v30
    v_cmp_le_u32 vcc, 8, v31
    s_nop 1
    v_cndmask_b32 v8, v8, v30, vcc
    v_add_u32 v8, v8, v29
    v_add_u32 v31, 6, v31
    v_mul_u32_u24 v9, 1280, v31
    v_add_u32 v9, 665600, v9
    s_mul_i32 s7, s68, 81920
    s_add_u32 s7, s7, 47360
    v_mov_b32 v30, s7
    v_cmp_eq_u32 vcc, s68, v31
    s_nop 1
    v_cndmask_b32 v9, v9, v30, vcc
    v_add_u32 v30, 2560, v30
    v_cmp_le_u32 vcc, 8, v31
    s_nop 1
    v_cndmask_b32 v9, v9, v30, vcc
    v_add_u32 v9, v9, v29
    v_mov_b32 v30, 2147483632
    v_cmp_le_u32 vcc, 30, v0
    s_nop 1
    v_cndmask_b32 v9, v9, v30, vcc
    s_lshl_b32 s78, s69, 10
    s_lshl_b32 s79, s72, 8
    s_add_u32 s78, s78, s79
    v_lshl_add_u32 v10, v0, 2, s78
    s_lshl_b32 s78, s70, 13
    s_add_u32 s78, s78, s79
    v_lshlrev_b32 v29, 10, v26
    v_lshl_add_u32 v29, v25, 4, v29
    v_add_u32 v11, s78, v29
    buffer_load_dwordx4 a[64:67], v23, s[8:11], s84 offen offset:0 nt
    s_mul_i32 s78, s72, 96
    s_add_u32 s78, s78, 118784
    v_lshl_add_u32 v29, v27, 5, s78
    v_lshl_add_u32 v29, v28, 2, v29
    v_lshrrev_b32 v30, 1, v26
    v_lshl_add_u32 v29, v30, 4, v29
    v_and_b32 v30, 1, v26
    v_lshl_add_u32 v29, v30, 1, v29
    v_mov_b32 v30, 119168
    v_cmp_le_u32 vcc, 12, v25
    s_nop 1
    v_cndmask_b32 v12, v29, v30, vcc
    v_and_b32 v30, 1, v0
    v_lshlrev_b32 v29, 5, v26
    v_lshl_add_u32 v29, v30, 4, v29
    v_add_u32 v13, 118784, v29
    v_mul_u32_u24 v30, 0xaaaa, v30
    v_and_b32 v29, 1, v27
    v_mul_u32_u24 v29, 0xaaaa, v29
    v_lshl_or_b32 v29, v29, 16, v30
    v_add_u32 v14, 0x44444444, v29
    buffer_load_dwordx4 a[68:71], v23, s[8:11], s84 offen offset:1024 nt
    s_barrier
    s_lshl_b32 s78, s72, 8
    s_add_u32 s78, s78, 124416
    v_lshrrev_b32 v29, 5, v0
    v_lshl_add_u32 v29, v29, 6, s78
    v_bfe_u32 v30, v0, 3, 1
    v_lshl_add_u32 v29, v30, 5, v29
    v_bfe_u32 v30, v0, 1, 1
    v_lshl_add_u32 v29, v30, 4, v29
    v_bfe_u32 v30, v0, 2, 1
    v_lshl_add_u32 v29, v30, 3, v29
    v_bfe_u32 v30, v0, 4, 1
    v_lshl_add_u32 v29, v30, 2, v29
    v_bfe_u32 v30, v0, 0, 1
    v_lshl_add_u32 v29, v30, 1, v29
    v_mov_b32 v19, v29
    s_mul_i32 s78, s72, 768
    s_add_u32 s78, s78, 119296
    v_lshl_add_u32 v29, v25, 2, s78
    v_bfe_u32 v30, v0, 4, 1
    v_lshl_add_u32 v29, v30, 7, v29
    v_lshrrev_b32 v30, 5, v0
    v_lshl_add_u32 v15, v30, 6, v29
    s_mov_b32 s44, 0x10001
    s_mov_b32 s45, 0x10001
    s_mov_b32 s46, 0x20002
    s_mov_b32 s47, 0x20002
    s_mov_b32 s48, 0x40004
    s_mov_b32 s49, 0x40004
    s_mov_b32 s50, 0x80008
    s_mov_b32 s51, 0x80008
    s_mov_b32 s52, 0x100010
    s_mov_b32 s53, 0x100010
    s_mov_b32 s54, 0x200020
    s_mov_b32 s55, 0x200020
    s_mov_b32 s56, 0x400040
    s_mov_b32 s57, 0x400040
    s_mov_b32 s58, 0x800080
    s_mov_b32 s59, 0x800080
    s_mov_b32 s60, 0x1000100
    s_mov_b32 s61, 0x1000100
    s_mov_b32 s62, 0x2000200
    s_mov_b32 s63, 0x2000200
    s_waitcnt vmcnt(22)
    ds_write_b128 v2, a[0:3] offset:0
    ds_write_b128 v3, a[4:7] offset:0
    ds_write_b128 v4, a[8:11] offset:0
    ds_write_b128 v2, a[12:15] offset:3328
    ds_write_b128 v3, a[16:19] offset:3328
    ds_write_b128 v4, a[20:23] offset:3328
    ds_read_b128 a[0:3], v5 offset:0
    ds_read_b128 a[4:7], v5 offset:64
    ds_read_b128 a[8:11], v5 offset:128
    ds_read_b128 a[12:15], v5 offset:192
    ds_read_b128 a[16:19], v5 offset:256
    ds_read_b128 a[20:23], v5 offset:320
    buffer_load_dwordx4 a[72:75], v1, s[8:11], s85 offen offset:0 nt
    buffer_load_dwordx4 a[76:79], v1, s[8:11], s85 offen offset:1024 nt
    buffer_load_dwordx4 a[80:83], v1, s[8:11], s85 offen offset:2048 nt
    buffer_load_dwordx4 a[84:87], v1, s[8:11], s85 offen offset:3072 nt
    buffer_load_dwordx4 a[88:91], v23, s[8:11], s85 offen offset:0 nt
    buffer_load_dwordx4 a[92:95], v23, s[8:11], s85 offen offset:1024 nt
    s_barrier
    s_waitcnt vmcnt(22)
    ds_write_b128 v2, a[24:27] offset:0
    ds_write_b128 v3, a[28:31] offset:0
    ds_write_b128 v4, a[32:35] offset:0
    ds_write_b128 v2, a[36:39] offset:3328
    ds_write_b128 v3, a[40:43] offset:3328
    ds_write_b128 v4, a[44:47] offset:3328
    ds_read_b128 a[24:27], v5 offset:0
    ds_read_b128 a[28:31], v5 offset:64
    ds_read_b128 a[32:35], v5 offset:128
    ds_read_b128 a[36:39], v5 offset:192
    ds_read_b128 a[40:43], v5 offset:256
    ds_read_b128 a[44:47], v5 offset:320
    buffer_load_dwordx4 a[240:243], v101, s[36:39], s91 offen
    buffer_load_dwordx4 a[240:243], v102, s[36:39], s91 offen
    buffer_load_dwordx4 a[240:243], v103, s[36:39], s91 offen
    buffer_load_dwordx4 a[240:243], v104, s[36:39], s91 offen
    buffer_load_dwordx4 a[240:243], v105, s[36:39], s91 offen
    buffer_load_dwordx4 a[240:243], v106, s[36:39], s91 offen
    s_barrier
    s_waitcnt vmcnt(12)
    ds_write_b128 v2, a[48:51] offset:0
    ds_write_b128 v3, a[52:55] offset:0
    ds_write_b128 v4, a[56:59] offset:0
    ds_write_b128 v2, a[60:63] offset:3328
    ds_write_b128 v3, a[64:67] offset:3328
    ds_write_b128 v4, a[68:71] offset:3328
    ds_read_b128 a[48:51], v5 offset:0
    ds_read_b128 a[52:55], v5 offset:64
    ds_read_b128 a[56:59], v5 offset:128
    ds_read_b128 a[60:63], v5 offset:192
    ds_read_b128 a[64:67], v5 offset:256
    ds_read_b128 a[68:71], v5 offset:320
    buffer_load_dwordx4 a[240:243], v1, s[20:23], s90 offen offset:0
    buffer_load_dwordx4 a[240:243], v1, s[20:23], s90 offen offset:1024
    buffer_load_dwordx4 a[240:243], v1, s[20:23], s90 offen offset:2048
    buffer_load_dwordx4 a[240:243], v1, s[20:23], s90 offen offset:3072
    buffer_load_dwordx4 a[240:243], v23, s[20:23], s90 offen offset:0
    buffer_load_dwordx4 a[240:243], v23, s[20:23], s90 offen offset:1024
    s_barrier
    buffer_load_dwordx4 a[240:243], v108, s[20:23], s90 offen offset:2048
    buffer_load_dwordx4 a[240:243], v108, s[20:23], s90 offen offset:3072
    buffer_load_dwordx4 a[240:243], v109, s[20:23], s90 offen offset:0
    v_lshlrev_b32 v98, 2, v0
    global_load_dword v99, v98, s[64:65] sc1
    s_barrier
    ds_read_b64_tr_b16 v[40:41], v16 offset:0
    ds_read_b64_tr_b16 v[42:43], v16 offset:1536
    ds_read_b64_tr_b16 v[44:45], v16 offset:12288
    ds_read_b64_tr_b16 v[46:47], v16 offset:13824
    ds_read_b64_tr_b16 v[48:49], v17 offset:24576
    ds_read_b64_tr_b16 v[50:51], v16 offset:32
    ds_read_b64_tr_b16 v[52:53], v16 offset:1568
    ds_read_b64_tr_b16 v[54:55], v16 offset:12320
    ds_read_b64_tr_b16 v[56:57], v16 offset:13856
    ds_read_b64_tr_b16 v[58:59], v17 offset:24608
    ds_read_b64_tr_b16 v[60:61], v16 offset:64
    ds_read_b64_tr_b16 v[62:63], v16 offset:1600
    ds_read_b64_tr_b16 v[64:65], v16 offset:12352
    ds_read_b64_tr_b16 v[66:67], v16 offset:13888
    ds_read_b64_tr_b16 v[68:69], v17 offset:24640
    s_waitcnt vmcnt(16)
    ds_write_b128 v2, a[72:75] offset:0
    ds_write_b128 v3, a[76:79] offset:0
    ds_write_b128 v4, a[80:83] offset:0
    ds_write_b128 v2, a[84:87] offset:3328
    ds_write_b128 v3, a[88:91] offset:3328
    ds_write_b128 v4, a[92:95] offset:3328
    ds_read_b128 a[72:75], v5 offset:0
    ds_read_b128 a[76:79], v5 offset:64
    ds_read_b128 a[80:83], v5 offset:128
    ds_read_b128 a[84:87], v5 offset:192
    ds_read_b128 a[88:91], v5 offset:256
    ds_read_b128 a[92:95], v5 offset:320
    buffer_load_dwordx4 a[96:99], v1, s[8:11], s86 offen offset:0 nt
    buffer_load_dwordx4 a[100:103], v1, s[8:11], s86 offen offset:1024 nt
    buffer_load_dwordx4 a[104:107], v1, s[8:11], s86 offen offset:2048 nt
    s_barrier
    buffer_load_dwordx4 a[108:111], v1, s[8:11], s86 offen offset:3072 nt
    buffer_load_dwordx4 a[112:115], v23, s[8:11], s86 offen offset:0 nt
    buffer_load_dwordx4 a[116:119], v23, s[8:11], s86 offen offset:1024 nt
    buffer_load_dwordx4 a[120:123], v1, s[8:11], s87 offen offset:0 nt
    buffer_load_dwordx4 a[124:127], v1, s[8:11], s87 offen offset:1024 nt
    buffer_load_dwordx4 a[128:131], v1, s[8:11], s87 offen offset:2048 nt
    s_barrier
    buffer_load_dwordx4 a[132:135], v1, s[8:11], s87 offen offset:3072 nt
    buffer_load_dwordx4 a[136:139], v23, s[8:11], s87 offen offset:0 nt
    buffer_load_dwordx4 a[140:143], v23, s[8:11], s87 offen offset:1024 nt
    s_waitcnt vmcnt(12)
    s_mov_b32 s76, -1
    v_sad_u8 v100, v99, 0, 0
    s_nop 1
    v_add_u32_dpp v100, v100, v100 quad_perm:[1,0,3,2] row_mask:0xf bank_mask:0xf
    s_nop 1
    v_add_u32_dpp v100, v100, v100 quad_perm:[2,3,0,1] row_mask:0xf bank_mask:0xf
    v_cmp_gt_u32 vcc, 32, v100
    s_mov_b32 vcc_hi, 0
    s_cmp_eq_u64 vcc, 0
    s_cbranch_scc0 RDYLOOP
RDYOK:
    v_readlane_b32 s77, v99, s5
    s_nop 0
    s_cmp_eq_u32 s77, s96
    s_cselect_b32 s75, 1, 0
    buffer_load_dwordx4 a[240:243], v20, s[16:19], 0 offen sc1
    v_lshrrev_b32 v106, 3, v0
    v_mul_u32_u24 v106, 2560, v106
    v_and_b32 v107, 7, v0
    v_lshl_add_u32 v106, v107, 4, v106
    s_lshl_b32 s77, s69, 7
    s_add_u32 s77, s77, s3
    s_add_u32 s77, s77, 51200
    s_cmp_lt_u32 s69, 20
    s_cselect_b32 s77, s77, 1879048176
    s_cmp_eq_u32 s72, 0
    s_cselect_b32 s77, s77, 1879048176
    v_add_u32 v106, s77, v106
    v_add_u32 v107, 20480, v106
    v_mov_b32 v108, 2147483632
    v_cmp_le_u32 vcc, 32, v0
    s_nop 1
    v_cndmask_b32 v107, v107, v108, vcc
    buffer_load_dwordx4 a[240:243], v106, s[16:19], 0 offen sc1
    buffer_load_dwordx4 a[240:243], v107, s[16:19], 0 offen sc1
    s_waitcnt lgkmcnt(0)
    s_add_u32 s79, s3, 1376256
    v_mfma_f32_16x16x32_bf16 v[24:27], v[70:73], v[40:43], 0
    v_mfma_f32_16x16x32_bf16 v[32:35], v[70:73], v[60:63], 0
    v_mfma_f32_16x16x32_bf16 v[24:27], v[74:77], v[44:47], v[24:27]
    v_mfma_f32_16x16x32_bf16 v[32:35], v[74:77], v[64:67], v[32:35]
    v_mfma_f32_16x16x16_bf16 v[24:27], v[78:79], v[48:49], v[24:27]
    v_mfma_f32_16x16x16_bf16 v[32:35], v[78:79], v[68:69], v[32:35]
    v_mfma_f32_16x16x32_bf16 v[28:31], v[70:73], v[50:53], 0
    v_mfma_f32_16x16x32_bf16 v[36:39], v[70:73], v[70:73], 0
    v_mfma_f32_16x16x32_bf16 v[28:31], v[74:77], v[54:57], v[28:31]
    v_mfma_f32_16x16x32_bf16 v[36:39], v[74:77], v[74:77], v[36:39]
    v_mfma_f32_16x16x16_bf16 v[28:31], v[78:79], v[58:59], v[28:31]
    v_mfma_f32_16x16x16_bf16 v[36:39], v[78:79], v[78:79], v[36:39]
    buffer_load_dwordx4 a[144:147], v1, s[8:11], s88 offen offset:0 nt
    v_add_f32 v24, v24, v25
    v_add_f32 v26, v26, v27
    v_add_f32 v24, v24, v26
    v_add_f32 v32, v32, v33
    v_add_f32 v34, v34, v35
    v_add_f32 v32, v32, v34
    s_nop 1
    v_permlane32_swap_b32 v24, v32
    v_add_f32 v28, v28, v29
    v_add_f32 v30, v30, v31
    v_add_f32 v36, v36, v37
    v_add_f32 v38, v38, v39
    v_add_f32 v24, v24, v32
    v_add_f32 v28, v28, v30
    v_add_f32 v36, v36, v38
    s_nop 1
    v_permlane32_swap_b32 v28, v36
    v_add_f32 v28, v28, v36
    s_nop 1
    v_permlane16_swap_b32 v24, v28
    v_add_f32 v24, v24, v28
    s_cmp_eq_u32 s75, 1
    s_cbranch_scc0 SLOW1
    buffer_store_dword v24, v10, s[16:19], s79 offen
BACK1:
    buffer_load_dwordx4 a[148:151], v1, s[8:11], s88 offen offset:1024 nt
    v_mfma_f32_16x16x32_bf16 v[24:27], v[88:91], v[40:43], 0
    v_mfma_f32_16x16x32_bf16 v[32:35], v[88:91], v[60:63], 0
    v_mfma_f32_16x16x32_bf16 v[24:27], v[92:95], v[44:47], v[24:27]
    v_mfma_f32_16x16x32_bf16 v[32:35], v[92:95], v[64:67], v[32:35]
    v_mfma_f32_16x16x16_bf16 v[24:27], v[96:97], v[48:49], v[24:27]
    v_mfma_f32_16x16x16_bf16 v[32:35], v[96:97], v[68:69], v[32:35]
    v_mfma_f32_16x16x32_bf16 v[28:31], v[88:91], v[50:53], 0
    v_mfma_f32_16x16x32_bf16 v[36:39], v[88:91], v[88:91], 0
    v_mfma_f32_16x16x32_bf16 v[28:31], v[92:95], v[54:57], v[28:31]
    v_mfma_f32_16x16x32_bf16 v[36:39], v[92:95], v[92:95], v[36:39]
    v_mfma_f32_16x16x16_bf16 v[28:31], v[96:97], v[58:59], v[28:31]
    v_mfma_f32_16x16x16_bf16 v[36:39], v[96:97], v[96:97], v[36:39]
    buffer_load_dwordx4 a[152:155], v1, s[8:11], s88 offen offset:2048 nt
    s_barrier
    v_add_f32 v24, v24, v25
    v_add_f32 v26, v26, v27
    v_add_f32 v24, v24, v26
    v_add_f32 v32, v32, v33
    v_add_f32 v34, v34, v35
    v_add_f32 v32, v32, v34
    s_nop 1
    v_permlane32_swap_b32 v24, v32
    v_add_f32 v28, v28, v29
    v_add_f32 v30, v30, v31
    v_add_f32 v36, v36, v37
    v_add_f32 v38, v38, v39
    v_add_f32 v24, v24, v32
    v_add_f32 v28, v28, v30
    v_add_f32 v36, v36, v38
    s_nop 1
    v_permlane32_swap_b32 v28, v36
    v_add_f32 v28, v28, v36
    s_nop 1
    v_permlane16_swap_b32 v24, v28
    v_add_f32 v24, v24, v28
    s_cmp_eq_u32 s75, 1
    s_cbranch_scc0 SLOW2
    buffer_store_dword v24, v10, s[16:19], s3 offen
BACK2:
    s_cmp_lg_u32 s72, 1
    s_cbranch_scc1 NOBASE0
    s_cmp_ge_u32 s69, 20
    s_cbranch_scc1 NOBASE0
    v_mov_b32 v28, v22
    s_lshl_b32 s77, s69, 6
    s_add_u32 s77, s77, s3
    s_add_u32 s77, s77, 48640
    v_lshlrev_b32 v27, 2, v0
    v_mov_b32_dpp v29, v28 quad_perm:[1,1,1,1] row_mask:0xf bank_mask:0xf
    v_mov_b32_dpp v30, v28 quad_perm:[2,2,2,2] row_mask:0xf bank_mask:0xf
    v_mov_b32_dpp v31, v28 quad_perm:[3,3,3,3] row_mask:0xf bank_mask:0xf
    s_mov_b32 exec_lo, 0x1111
    s_mov_b32 exec_hi, 0x0
    s_cmp_eq_u32 s75, 1
    s_cbranch_scc0 SLOW3
    buffer_store_dwordx4 v[28:31], v27, s[16:19], s77 offen
BACK3:
    s_mov_b64 exec, -1
NOBASE0:
    s_waitcnt vmcnt(14)
    ds_write_b128 v2, a[96:99] offset:0
    ds_write_b128 v3, a[100:103] offset:0
    ds_write_b128 v4, a[104:107] offset:0
    ds_write_b128 v2, a[108:111] offset:3328
    ds_write_b128 v3, a[112:115] offset:3328
    ds_write_b128 v4, a[116:119] offset:3328
    ds_read_b128 a[96:99], v5 offset:0
    ds_read_b128 a[100:103], v5 offset:64
    ds_read_b128 a[104:107], v5 offset:128
    ds_read_b128 a[108:111], v5 offset:192
    ds_read_b128 a[112:115], v5 offset:256
    ds_read_b128 a[116:119], v5 offset:320
    buffer_load_dwordx4 a[156:159], v1, s[8:11], s88 offen offset:3072 nt
    buffer_load_dwordx4 a[160:163], v23, s[8:11], s88 offen offset:0 nt
    buffer_load_dwordx4 a[164:167], v23, s[8:11], s88 offen offset:1024 nt
    buffer_load_dwordx4 a[168:171], v1, s[8:11], s89 offen offset:0 nt
    buffer_load_dwordx4 a[172:175], v1, s[8:11], s89 offen offset:1024 nt
    buffer_load_dwordx4 a[176:179], v1, s[8:11], s89 offen offset:2048 nt
    s_barrier
    buffer_load_dwordx4 a[180:183], v1, s[8:11], s89 offen offset:3072 nt
    buffer_load_dwordx4 a[184:187], v23, s[8:11], s89 offen offset:0 nt
    buffer_load_dwordx4 a[188:191], v23, s[8:11], s89 offen offset:1024 nt
    buffer_load_dwordx4 a[216:219], v1, s[12:15], s73 offen offset:0 nt
    buffer_load_dwordx4 a[220:223], v1, s[12:15], s73 offen offset:1024 nt
    buffer_load_dwordx4 a[224:227], v1, s[12:15], s73 offen offset:2048 nt
    s_barrier
    s_waitcnt vmcnt(12)
    v_mov_b32 v24, -1
    v_mov_b32 v25, -1
    v_mov_b32 v26, -1
    v_mov_b32 v27, -1
    s_cmp_eq_u32 s75, 1
    s_cbranch_scc0 SLOW4
    buffer_store_dwordx4 v[24:27], v106, s[16:19], 0 offen
BACK4:
    s_cmp_eq_u32 s75, 1
    s_cbranch_scc0 SLOW5
    buffer_store_dwordx4 v[24:27], v107, s[16:19], 0 offen
BACK5:
    s_lshl_b32 s77, s70, 7
    s_lshl_b32 s78, s72, 5
    s_add_u32 s77, s77, s78
    s_add_u32 s77, s77, s3
    s_add_u32 s4, s77, 45312
    s_lshl_b32 s78, s71, 2
    s_add_u32 s78, s78, s4
    s_mov_b64 exec, 1
    s_cmp_eq_u32 s75, 1
    s_cbranch_scc0 SLOW6
    buffer_store_dword v1, v1, s[16:19], s78 offen
BACK6:
    s_mov_b64 exec, -1
    ds_write_b128 v2, a[120:123] offset:0
    ds_write_b128 v3, a[124:127] offset:0
    ds_write_b128 v4, a[128:131] offset:0
    ds_write_b128 v2, a[132:135] offset:3328
    ds_write_b128 v3, a[136:139] offset:3328
    ds_write_b128 v4, a[140:143] offset:3328
    ds_read_b128 a[120:123], v5 offset:0
    ds_read_b128 a[124:127], v5 offset:64
    ds_read_b128 a[128:131], v5 offset:128
    ds_read_b128 a[132:135], v5 offset:192
    ds_read_b128 a[136:139], v5 offset:256
    ds_read_b128 a[140:143], v5 offset:320
    s_cmp_ge_u32 s69, 20
    s_cbranch_scc1 DMAF
    v_lshrrev_b32 v38, 2, v0
    v_mul_u32_u24 v38, 1280, v38
    v_and_b32 v39, 3, v0
    v_lshl_add_u32 v38, v39, 4, v38
    s_lshl_b32 s77, s72, 3
    s_add_u32 s77, s77, s68
    s_mul_i32 s77, s77, 245760
    s_lshl_b32 s78, s69, 6
    s_add_u32 s77, s77, s78
    s_mul_i32 s78, s72, 12288
    s_add_u32 m0, s78, 57344
    s_nop 0
    buffer_load_dwordx4 v38, s[24:27], s77 offen  lds
    s_add_u32 m0, m0, 1024
    s_add_u32 s77, s77, 20480
    buffer_load_dwordx4 v38, s[24:27], s77 offen  lds
    s_add_u32 m0, m0, 1024
    s_add_u32 s77, s77, 20480
    buffer_load_dwordx4 v38, s[24:27], s77 offen  lds
    s_add_u32 m0, m0, 1024
    s_add_u32 s77, s77, 20480
    buffer_load_dwordx4 v38, s[24:27], s77 offen  lds
    s_add_u32 m0, m0, 1024
    s_add_u32 s77, s77, 20480
    buffer_load_dwordx4 v38, s[24:27], s77 offen  lds
    s_add_u32 m0, m0, 1024
    s_add_u32 s77, s77, 20480
    buffer_load_dwordx4 v38, s[24:27], s77 offen  lds
    s_add_u32 m0, m0, 1024
    s_add_u32 s77, s77, 20480
    buffer_load_dwordx4 v38, s[24:27], s77 offen  lds
    s_add_u32 m0, m0, 1024
    s_add_u32 s77, s77, 20480
    buffer_load_dwordx4 v38, s[24:27], s77 offen  lds
    s_add_u32 m0, m0, 1024
    s_add_u32 s77, s77, 20480
    buffer_load_dwordx4 v38, s[24:27], s77 offen  lds
    s_add_u32 m0, m0, 1024
    s_add_u32 s77, s77, 20480
    buffer_load_dwordx4 v38, s[24:27], s77 offen  lds
    s_add_u32 m0, m0, 1024
    s_add_u32 s77, s77, 20480
    buffer_load_dwordx4 v38, s[24:27], s77 offen  lds
    s_add_u32 m0, m0, 1024
    s_add_u32 s77, s77, 20480
    buffer_load_dwordx4 v38, s[24:27], s77 offen  lds
DMAX:
    v_and_b32 v98, 7, v0
    v_lshlrev_b32 v98, 2, v98
    buffer_load_dword v99, v98, s[16:19], s4 offen sc1
    s_waitcnt vmcnt(23)
    ds_write_b128 v2, a[144:147] offset:0
    ds_write_b128 v3, a[148:151] offset:0
    ds_write_b128 v4, a[152:155] offset:0
    ds_write_b128 v2, a[156:159] offset:3328
    ds_write_b128 v3, a[160:163] offset:3328
    ds_write_b128 v4, a[164:167] offset:3328
    ds_read_b128 a[144:147], v5 offset:0
    ds_read_b128 a[148:151], v5 offset:64
    ds_read_b128 a[152:155], v5 offset:128
    ds_read_b128 a[156:159], v5 offset:192
    ds_read_b128 a[160:163], v5 offset:256
    ds_read_b128 a[164:167], v5 offset:320
    buffer_load_dwordx4 a[228:231], v1, s[12:15], s73 offen offset:3072 nt
    buffer_load_dwordx4 a[232:235], v23, s[12:15], s73 offen offset:0 nt
    buffer_load_dwordx4 a[236:239], v23, s[12:15], s73 offen offset:1024 nt
    v_and_b32 v25, 15, v0
    v_lshrrev_b32 v26, 4, v0
    v_add_u32 v27, 4, v26
    v_mul_u32_u24 v20, 1280, v26
    v_add_u32 v20, 665600, v20
    s_mul_i32 s7, s68, 81920
    s_add_u32 s7, s7, 47360
    v_mov_b32 v28, s7
    v_cmp_eq_u32 vcc, s68, v26
    s_nop 1
    v_cndmask_b32 v20, v20, v28, vcc
    v_mul_u32_u24 v21, 1280, v27
    v_add_u32 v21, 665600, v21
    s_mul_i32 s7, s68, 81920
    s_add_u32 s7, s7, 47360
    v_mov_b32 v28, s7
    v_cmp_eq_u32 vcc, s68, v27
    s_nop 1
    v_cndmask_b32 v21, v21, v28, vcc
    s_min_u32 s7, s69, 19
    s_lshl_b32 s7, s7, 6
    v_lshl_add_u32 v25, v25, 2, s7
    v_add_u32 v20, v20, v25
    v_add_u32 v21, v21, v25
    buffer_load_dwordx4 v[112:115], v1, s[12:15], s83 offen offset:0 nt
    v_and_b32 v25, 15, v0
    v_bfe_u32 v27, v0, 2, 2
    v_and_b32 v28, 3, v0
    s_mul_i32 s7, s72, 12288
    s_add_u32 s7, s7, 57344
    v_lshl_add_u32 v29, v26, 3, v27
    v_lshlrev_b32 v29, 6, v29
    v_lshl_add_u32 v29, v28, 3, v29
    v_add_u32 v29, s7, v29
    v_accvgpr_write_b32 a246, v29
    s_mul_i32 s7, s72, 3072
    s_add_u32 s7, s7, 32768
    v_lshl_add_u32 v29, v25, 4, s7
    v_lshl_add_u32 v29, v26, 7, v29
    v_accvgpr_write_b32 a247, v29
    s_lshl_b32 s7, s72, 6
    s_add_u32 s7, s7, 45056
    v_and_b32 v29, 1, v26
    v_lshl_add_u32 v29, v29, 5, s7
    v_accvgpr_write_b32 a248, v29
    s_lshl_b32 s7, s72, 8
    s_add_u32 s7, s7, 122368
    v_lshl_add_u32 v29, v0, 2, s7
    v_accvgpr_write_b32 a249, v29
    s_lshl_b32 s81, s69, 6
    s_mul_i32 s80, s68, 1280
    s_add_u32 s80, s80, s81
    s_add_u32 s80, s80, 655360
    s_add_u32 s81, s81, s3
    s_add_u32 s81, s81, 46080
    s_waitcnt vmcnt(21)
    ds_write_b128 v2, a[168:171] offset:0
    ds_write_b128 v3, a[172:175] offset:0
    ds_write_b128 v4, a[176:179] offset:0
    ds_write_b128 v2, a[180:183] offset:3328
    ds_write_b128 v3, a[184:187] offset:3328
    ds_write_b128 v4, a[188:191] offset:3328
    ds_read_b128 a[168:171], v5 offset:0
    ds_read_b128 a[172:175], v5 offset:64
    ds_read_b128 a[176:179], v5 offset:128
    ds_read_b128 a[180:183], v5 offset:192
    ds_read_b128 a[184:187], v5 offset:256
    ds_read_b128 a[188:191], v5 offset:320
    buffer_load_dwordx4 v[116:119], v1, s[12:15], s83 offen offset:1024 nt
    buffer_load_dwordx4 v[120:123], v1, s[12:15], s83 offen offset:2048 nt
    s_barrier
    buffer_load_dwordx4 v[124:127], v1, s[12:15], s83 offen offset:3072 nt
    buffer_load_dwordx4 v[128:131], v23, s[12:15], s83 offen offset:0 nt
    buffer_load_dwordx4 v[132:135], v23, s[12:15], s83 offen offset:1024 nt
    buffer_load_dwordx4 v[136:139], v1, s[12:15], s84 offen offset:0 nt
    buffer_load_dwordx4 v[140:143], v1, s[12:15], s84 offen offset:1024 nt
    buffer_load_dwordx4 v[144:147], v1, s[12:15], s84 offen offset:2048 nt
    s_barrier
    s_waitcnt vmcnt(12)
    v_cmp_eq_u32 vcc, -1, v99
    s_cbranch_vccnz RETRY7
OK7:
    s_add_u32 s77, s3, 1376256
    s_add_u32 s78, s3, 1380352
    s_add_u32 s79, s3, 4096
    buffer_load_dwordx4 v[64:67], v11, s[16:19], s77 offen sc1
    buffer_load_dwordx4 v[68:71], v11, s[16:19], s78 offen sc1
    buffer_load_dwordx4 v[72:75], v11, s[16:19], s3 offen sc1
    buffer_load_dwordx4 v[76:79], v11, s[16:19], s79 offen sc1
    buffer_load_dwordx4 v[148:151], v1, s[12:15], s84 offen offset:3072 nt
    buffer_load_dwordx4 v[152:155], v23, s[12:15], s84 offen offset:0 nt
    buffer_load_dwordx4 v[156:159], v23, s[12:15], s84 offen offset:1024 nt
    s_waitcnt vmcnt(16)
    ds_write_b128 v2, a[216:219] offset:0
    ds_write_b128 v3, a[220:223] offset:0
    ds_write_b128 v4, a[224:227] offset:0
    ds_write_b128 v2, a[228:231] offset:3328
    ds_write_b128 v3, a[232:235] offset:3328
    ds_write_b128 v4, a[236:239] offset:3328
    ds_read_b64_tr_b16 a[192:193], v6 offset:0
    ds_read_b64_tr_b16 a[196:197], v6 offset:32
    ds_read_b64_tr_b16 a[200:201], v6 offset:64
    ds_read_b64_tr_b16 a[204:205], v6 offset:96
    ds_read_b64_tr_b16 a[208:209], v6 offset:128
    ds_read_b64_tr_b16 a[212:213], v6 offset:160
    ds_read_b64_tr_b16 a[216:217], v6 offset:192
    ds_read_b64_tr_b16 a[220:221], v6 offset:224
    ds_read_b64_tr_b16 a[224:225], v6 offset:256
    ds_read_b64_tr_b16 a[228:229], v6 offset:288
    ds_read_b64_tr_b16 a[232:233], v6 offset:320
    ds_read_b64_tr_b16 a[236:237], v6 offset:352
    buffer_load_dwordx4 v[160:163], v1, s[12:15], s85 offen offset:0 nt
    buffer_load_dwordx4 v[164:167], v1, s[12:15], s85 offen offset:1024 nt
    buffer_load_dwordx4 v[168:171], v1, s[12:15], s85 offen offset:2048 nt
    s_barrier
    buffer_load_dwordx4 v[172:175], v1, s[12:15], s85 offen offset:3072 nt
    buffer_load_dwordx4 v[176:179], v23, s[12:15], s85 offen offset:0 nt
    buffer_load_dwordx4 v[180:183], v23, s[12:15], s85 offen offset:1024 nt
    s_waitcnt vmcnt(16)
    ds_write_b128 v2, v[112:115] offset:0
    ds_write_b128 v3, v[116:119] offset:0
    ds_write_b128 v4, v[120:123] offset:0
    ds_write_b128 v2, v[124:127] offset:3328
    ds_write_b128 v3, v[128:131] offset:3328
    ds_write_b128 v4, v[132:135] offset:3328
    ds_read_b64_tr_b16 a[194:195], v6 offset:0
    ds_read_b64_tr_b16 a[198:199], v6 offset:32
    ds_read_b64_tr_b16 a[202:203], v6 offset:64
    ds_read_b64_tr_b16 a[206:207], v6 offset:96
    ds_read_b64_tr_b16 a[210:211], v6 offset:128
    ds_read_b64_tr_b16 a[214:215], v6 offset:160
    ds_read_b64_tr_b16 a[218:219], v6 offset:192
    ds_read_b64_tr_b16 a[222:223], v6 offset:224
    ds_read_b64_tr_b16 a[226:227], v6 offset:256
    ds_read_b64_tr_b16 a[230:231], v6 offset:288
    ds_read_b64_tr_b16 a[234:235], v6 offset:320
    ds_read_b64_tr_b16 a[238:239], v6 offset:352
    buffer_load_dwordx4 v[184:187], v1, s[12:15], s86 offen offset:0 nt
    buffer_load_dwordx4 v[188:191], v1, s[12:15], s86 offen offset:1024 nt
    buffer_load_dwordx4 v[192:195], v1, s[12:15], s86 offen offset:2048 nt
    s_barrier
    s_waitcnt vmcnt(12)
    v_add_f32 v64, v64, v68
    v_add_f32 v65, v65, v69
    v_add_f32 v66, v66, v70
    v_add_f32 v67, v67, v71
    s_nop 0
    v_permlane32_swap_b32 v64, v66
    v_permlane32_swap_b32 v65, v67
    v_add_f32 v64, v64, v66
    v_add_f32 v65, v65, v67
    s_nop 1
    v_permlane16_swap_b32 v64, v65
    v_add_f32 v64, v64, v65
    v_add_f32 v72, v72, v76
    v_add_f32 v73, v73, v77
    v_add_f32 v74, v74, v78
    v_add_f32 v75, v75, v79
    s_nop 0
    v_permlane32_swap_b32 v72, v74
    v_permlane32_swap_b32 v73, v75
    v_add_f32 v72, v72, v74
    v_add_f32 v73, v73, v75
    s_nop 1
    v_permlane16_swap_b32 v72, v73
    v_add_f32 v72, v72, v73
    v_mul_f32 v7, 0x3acccccd, v64
    v_mov_b32 v24, v72
    buffer_load_dwordx4 v[196:199], v1, s[12:15], s86 offen offset:3072 nt
    v_mov_b32 v40, 0
    v_mov_b32 v41, 0
    v_mov_b32 v44, 0
    v_mov_b32 v45, 0
    v_mov_b32 v48, 0
    v_mov_b32 v49, 0
    v_mov_b32 v52, 0
    v_mov_b32 v53, 0
    v_mov_b32 v56, 0
    v_mov_b32 v57, 0
    v_mov_b32 v60, 0
    v_mov_b32 v61, 0
    v_mov_b32 v64, 0
    v_mov_b32 v65, 0
    v_mov_b32 v68, 0
    v_mov_b32 v69, 0
    v_mov_b32 v72, 0
    v_mov_b32 v73, 0
    v_mov_b32 v74, 0
    v_mov_b32 v75, 0
    v_mov_b32 v76, 0
    v_mov_b32 v77, 0
    v_mov_b32 v78, 0
    v_mov_b32 v79, 0
    v_mov_b32 v80, 0
    v_mov_b32 v81, 0
    v_mov_b32 v82, 0
    v_mov_b32 v83, 0
    v_mov_b32 v84, 0
    v_mov_b32 v85, 0
    v_mov_b32 v86, 0
    v_mov_b32 v87, 0
    v_readlane_b32 s77, v24, 15
    s_mov_b32 vcc_lo, 0x70007000
    s_mov_b32 vcc_hi, 0x70007000
    v_fma_f32 v25, -s77, v7, v24
    v_cvt_pk_bf16_f32 v25, v25, v25
    ds_write_b16 v12, v25
    v_cndmask_b32 v26, 0, v24, vcc
    s_nop 1
    v_add_f32_dpp v26, v26, v26 quad_perm:[1,0,3,2] row_mask:0xf bank_mask:0xf
    s_nop 1
    v_add_f32_dpp v26, v26, v26 quad_perm:[2,3,0,1] row_mask:0xf bank_mask:0xf
    v_mov_b32 v27, v26
    s_nop 1
    v_permlane32_swap_b32 v26, v27
    v_add_f32 v26, v26, v27
    buffer_load_dwordx4 v[200:203], v23, s[12:15], s86 offen offset:0 nt
    buffer_load_dwordx4 v[204:207], v23, s[12:15], s86 offen offset:1024 nt
    s_waitcnt lgkmcnt(0)
    s_barrier
    ds_read_b128 v[28:31], v13 offset:0
    ds_read_b128 v[32:35], v13 offset:128
    ds_read_b128 v[36:39], v13 offset:256
    v_mov_b32 v27, v26
    v_mov_b32 v25, s77
    v_subrev_f32 v25, 0x44200000, v25
    v_permlane16_swap_b32 v26, v27
    v_add_f32 v26, v26, v27
    v_mul_f32 v24, 0x3acccccd, v25
    v_readlane_b32 s77, v26, 15
    v_mul_f32 v24, v24, v24
    s_mov_b32 s78, 0x3acccccd
    v_sub_f32 v26, s77, v25
    v_fma_f32 v26, v26, s78, -v24
    v_max_f32 v26, 0, v26
    v_add_f32 v26, 0x3727c5ac, v26
    v_rsq_f32 v26, v26
    s_nop 0
    v_mul_f32 v18, 0x3dd53b94, v26
    s_waitcnt lgkmcnt(2)
    v_smfmac_f32_16x16x64_bf16 v[40:43], v[28:31], a[0:7], v14
    v_smfmac_f32_16x16x64_bf16 v[56:59], v[28:31], a[96:103], v14
    v_smfmac_f32_16x16x64_bf16 v[44:47], v[28:31], a[24:31], v14
    v_smfmac_f32_16x16x64_bf16 v[60:63], v[28:31], a[120:127], v14
    v_smfmac_f32_16x16x64_bf16 v[48:51], v[28:31], a[48:55], v14
    v_smfmac_f32_16x16x64_bf16 v[64:67], v[28:31], a[144:151], v14
    v_smfmac_f32_16x16x64_bf16 v[52:55], v[28:31], a[72:79], v14
    v_smfmac_f32_16x16x64_bf16 v[68:71], v[28:31], a[168:175], v14
    buffer_load_dwordx4 v[208:211], v1, s[12:15], s87 offen offset:0 nt
    s_waitcnt lgkmcnt(1)
    v_smfmac_f32_16x16x64_bf16 v[40:43], v[32:35], a[8:15], v14
    v_smfmac_f32_16x16x64_bf16 v[56:59], v[32:35], a[104:111], v14
    v_smfmac_f32_16x16x64_bf16 v[44:47], v[32:35], a[32:39], v14
    v_smfmac_f32_16x16x64_bf16 v[60:63], v[32:35], a[128:135], v14
    v_smfmac_f32_16x16x64_bf16 v[48:51], v[32:35], a[56:63], v14
    v_smfmac_f32_16x16x64_bf16 v[64:67], v[32:35], a[152:159], v14
    v_smfmac_f32_16x16x64_bf16 v[52:55], v[32:35], a[80:87], v14
    v_smfmac_f32_16x16x64_bf16 v[68:71], v[32:35], a[176:183], v14
    s_waitcnt lgkmcnt(0)
    v_smfmac_f32_16x16x64_bf16 v[40:43], v[36:39], a[16:23], v14
    v_smfmac_f32_16x16x64_bf16 v[56:59], v[36:39], a[112:119], v14
    v_smfmac_f32_16x16x64_bf16 v[44:47], v[36:39], a[40:47], v14
    v_smfmac_f32_16x16x64_bf16 v[60:63], v[36:39], a[136:143], v14
    v_smfmac_f32_16x16x64_bf16 v[48:51], v[36:39], a[64:71], v14
    v_smfmac_f32_16x16x64_bf16 v[64:67], v[36:39], a[160:167], v14
    v_smfmac_f32_16x16x64_bf16 v[52:55], v[36:39], a[88:95], v14
    v_smfmac_f32_16x16x64_bf16 v[68:71], v[36:39], a[184:191], v14
    buffer_load_dwordx4 v[212:215], v1, s[12:15], s87 offen offset:1024 nt
    s_lshl_b32 s78, s72, 8
    v_add_f32_dpp v24, v40, v41 quad_perm:[0,1,2,3] row_mask:0x1 bank_mask:0xf
    v_add_f32_dpp v25, v56, v57 quad_perm:[0,1,2,3] row_mask:0x1 bank_mask:0xf
    v_bfe_u32 v27, v0, 4, 1
    v_add_f32_dpp v24, v44, v45 quad_perm:[0,1,2,3] row_mask:0x2 bank_mask:0xf
    v_add_f32_dpp v25, v60, v61 quad_perm:[0,1,2,3] row_mask:0x2 bank_mask:0xf
    v_bfe_u32 v28, v0, 2, 1
    v_add_f32_dpp v24, v48, v49 quad_perm:[0,1,2,3] row_mask:0x4 bank_mask:0xf
    v_add_f32_dpp v25, v64, v65 quad_perm:[0,1,2,3] row_mask:0x4 bank_mask:0xf
    s_add_u32 s78, s78, 124416
    v_add_f32_dpp v24, v52, v53 quad_perm:[0,1,2,3] row_mask:0x8 bank_mask:0xf
    v_add_f32_dpp v25, v68, v69 quad_perm:[0,1,2,3] row_mask:0x8 bank_mask:0xf
    v_max_f32 v26, v24, v25
    v_lshl_add_u32 v27, v27, 5, s78
    v_lshl_add_u32 v27, v28, 4, v27
    v_max_f32_dpp v26, v26, v26 row_ror:8 row_mask:0xf bank_mask:0xf
    s_nop 1
    v_max_f32_dpp v26, v26, v26 row_ror:4 row_mask:0xf bank_mask:0xf
    s_nop 1
    v_max_f32_dpp v26, v26, v26 row_ror:2 row_mask:0xf bank_mask:0xf
    s_nop 1
    v_max_f32_dpp v26, v26, v26 row_ror:1 row_mask:0xf bank_mask:0xf
    v_mov_b32 v28, v26
    s_nop 1
    v_permlane32_swap_b32 v26, v28
    v_max_f32 v26, v26, v28
    v_mov_b32 v28, v26
    s_nop 1
    v_permlane16_swap_b32 v26, v28
    v_max_f32 v26, v26, v28
    buffer_load_dwordx4 v[216:219], v1, s[12:15], s87 offen offset:2048 nt
    s_barrier
    v_mul_f32 v26, v26, v18
    v_fma_f32 v24, v24, v18, -v26
    v_fma_f32 v25, v25, v18, -v26
    v_exp_f32 v24, v24
    v_exp_f32 v25, v25
    s_nop 0
    v_cvt_pk_bf16_f32 v28, v24, v25
    ds_write_b16 v19, v28
    ds_write_b16_d16_hi v19, v28 offset:128
    s_mov_b32 exec_lo, 0xff00ff
    s_mov_b32 exec_hi, 0xff00ff00
    ds_read_b128 v[72:75], v27 offset:0
    ds_read_b128 v[76:79], v27 offset:64
    ds_read_b128 v[80:83], v27 offset:128
    ds_read_b128 v[84:87], v27 offset:192
    s_mov_b64 exec, -1
    v_add_f32 v27, v24, v25
    v_mov_b32 v40, 0
    v_mov_b32 v44, 0
    v_add_f32_dpp v27, v27, v27 row_ror:8 row_mask:0xf bank_mask:0xf
    v_mov_b32 v48, 0
    v_mov_b32 v52, 0
    v_add_f32_dpp v27, v27, v27 row_ror:4 row_mask:0xf bank_mask:0xf
    v_mov_b32 v56, 0
    v_mov_b32 v60, 0
    v_add_f32_dpp v27, v27, v27 row_ror:2 row_mask:0xf bank_mask:0xf
    s_lshl_b32 s78, s72, 3
    s_add_u32 s78, s78, 125440
    v_add_f32_dpp v27, v27, v27 row_ror:1 row_mask:0xf bank_mask:0xf
    v_mov_b32 v28, v27
    s_nop 1
    v_permlane32_swap_b32 v27, v28
    v_add_f32 v27, v27, v28
    v_mov_b32 v28, v27
    s_nop 1
    v_permlane16_swap_b32 v27, v28
    v_add_f32 v27, v27, v28
    v_mov_b32 v28, s78
    ds_write_b64 v28, v[26:27]
    s_waitcnt vmcnt(15)
    ds_write_b128 v2, v[136:139] offset:0
    ds_write_b128 v3, v[140:143] offset:0
    ds_write_b128 v4, v[144:147] offset:0
    ds_write_b128 v2, v[148:151] offset:3328
    ds_write_b128 v3, v[152:155] offset:3328
    ds_write_b128 v4, v[156:159] offset:3328
    ds_read_b64_tr_b16 v[112:113], v6 offset:0
    ds_read_b64_tr_b16 v[116:117], v6 offset:32
    ds_read_b64_tr_b16 v[120:121], v6 offset:64
    ds_read_b64_tr_b16 v[124:125], v6 offset:96
    ds_read_b64_tr_b16 v[128:129], v6 offset:128
    ds_read_b64_tr_b16 v[132:133], v6 offset:160
    ds_read_b64_tr_b16 v[136:137], v6 offset:192
    ds_read_b64_tr_b16 v[140:141], v6 offset:224
    ds_read_b64_tr_b16 v[144:145], v6 offset:256
    ds_read_b64_tr_b16 v[148:149], v6 offset:288
    ds_read_b64_tr_b16 v[152:153], v6 offset:320
    ds_read_b64_tr_b16 v[156:157], v6 offset:352
    s_waitcnt lgkmcnt(0)
    v_smfmac_f32_16x16x64_bf16 v[40:43], v[72:75], a[192:199], v14 abid:1
    v_smfmac_f32_16x16x64_bf16 v[44:47], v[72:75], a[200:207], v14 abid:1
    v_smfmac_f32_16x16x64_bf16 v[48:51], v[72:75], a[208:215], v14 abid:1
    v_smfmac_f32_16x16x64_bf16 v[52:55], v[72:75], a[216:223], v14 abid:1
    v_smfmac_f32_16x16x64_bf16 v[56:59], v[72:75], a[224:231], v14 abid:1
    v_smfmac_f32_16x16x64_bf16 v[60:63], v[72:75], a[232:239], v14 abid:1
    buffer_load_dwordx4 v[220:223], v1, s[12:15], s87 offen offset:3072 nt
    buffer_load_dwordx4 v[224:227], v23, s[12:15], s87 offen offset:0 nt
    buffer_load_dwordx4 v[228:231], v23, s[12:15], s87 offen offset:1024 nt
    s_waitcnt vmcnt(12)
    ds_write_b128 v2, v[160:163] offset:0
    ds_write_b128 v3, v[164:167] offset:0
    ds_write_b128 v4, v[168:171] offset:0
    ds_write_b128 v2, v[172:175] offset:3328
    ds_write_b128 v3, v[176:179] offset:3328
    ds_write_b128 v4, v[180:183] offset:3328
    ds_read_b64_tr_b16 v[114:115], v6 offset:0
    ds_read_b64_tr_b16 v[118:119], v6 offset:32
    ds_read_b64_tr_b16 v[122:123], v6 offset:64
    ds_read_b64_tr_b16 v[126:127], v6 offset:96
    ds_read_b64_tr_b16 v[130:131], v6 offset:128
    ds_read_b64_tr_b16 v[134:135], v6 offset:160
    ds_read_b64_tr_b16 v[138:139], v6 offset:192
    ds_read_b64_tr_b16 v[142:143], v6 offset:224
    ds_read_b64_tr_b16 v[146:147], v6 offset:256
    ds_read_b64_tr_b16 v[150:151], v6 offset:288
    ds_read_b64_tr_b16 v[154:155], v6 offset:320
    ds_read_b64_tr_b16 v[158:159], v6 offset:352
    buffer_load_dwordx4 v[232:235], v1, s[12:15], s88 offen offset:0 nt
    buffer_load_dwordx4 v[236:239], v1, s[12:15], s88 offen offset:1024 nt
    buffer_load_dwordx4 v[240:243], v1, s[12:15], s88 offen offset:2048 nt
    s_barrier
    buffer_load_dwordx4 v[244:247], v1, s[12:15], s88 offen offset:3072 nt
    buffer_load_dwordx4 v[248:251], v23, s[12:15], s88 offen offset:0 nt
    buffer_load_dwordx4 v[252:255], v23, s[12:15], s88 offen offset:1024 nt
    s_waitcnt lgkmcnt(0)
    v_smfmac_f32_16x16x64_bf16 v[40:43], v[76:79], v[112:119], v14 abid:1
    v_smfmac_f32_16x16x64_bf16 v[44:47], v[76:79], v[120:127], v14 abid:1
    v_smfmac_f32_16x16x64_bf16 v[48:51], v[76:79], v[128:135], v14 abid:1
    v_smfmac_f32_16x16x64_bf16 v[52:55], v[76:79], v[136:143], v14 abid:1
    v_smfmac_f32_16x16x64_bf16 v[56:59], v[76:79], v[144:151], v14 abid:1
    v_smfmac_f32_16x16x64_bf16 v[60:63], v[76:79], v[152:159], v14 abid:1
    s_waitcnt vmcnt(12)
    ds_write_b128 v2, v[184:187] offset:0
    ds_write_b128 v3, v[188:191] offset:0
    ds_write_b128 v4, v[192:195] offset:0
    ds_write_b128 v2, v[196:199] offset:3328
    ds_write_b128 v3, v[200:203] offset:3328
    ds_write_b128 v4, v[204:207] offset:3328
    ds_read_b64_tr_b16 v[160:161], v6 offset:0
    ds_read_b64_tr_b16 v[164:165], v6 offset:32
    ds_read_b64_tr_b16 v[168:169], v6 offset:64
    ds_read_b64_tr_b16 v[172:173], v6 offset:96
    ds_read_b64_tr_b16 v[176:177], v6 offset:128
    ds_read_b64_tr_b16 v[180:181], v6 offset:160
    ds_read_b64_tr_b16 v[184:185], v6 offset:192
    ds_read_b64_tr_b16 v[188:189], v6 offset:224
    ds_read_b64_tr_b16 v[192:193], v6 offset:256
    ds_read_b64_tr_b16 v[196:197], v6 offset:288
    ds_read_b64_tr_b16 v[200:201], v6 offset:320
    ds_read_b64_tr_b16 v[204:205], v6 offset:352
    buffer_load_dwordx4 v[88:91], v1, s[12:15], s89 offen offset:0 nt
    buffer_load_dwordx4 v[92:95], v1, s[12:15], s89 offen offset:1024 nt
    buffer_load_dwordx4 v[96:99], v1, s[12:15], s89 offen offset:2048 nt
    s_barrier
    buffer_load_dwordx4 v[100:103], v1, s[12:15], s89 offen offset:3072 nt
    buffer_load_dwordx4 v[104:107], v23, s[12:15], s89 offen offset:0 nt
    buffer_load_dwordx4 v[108:111], v23, s[12:15], s89 offen offset:1024 nt
    s_waitcnt vmcnt(12)
    ds_write_b128 v2, v[208:211] offset:0
    ds_write_b128 v3, v[212:215] offset:0
    ds_write_b128 v4, v[216:219] offset:0
    ds_write_b128 v2, v[220:223] offset:3328
    ds_write_b128 v3, v[224:227] offset:3328
    ds_write_b128 v4, v[228:231] offset:3328
    ds_read_b64_tr_b16 v[162:163], v6 offset:0
    ds_read_b64_tr_b16 v[166:167], v6 offset:32
    ds_read_b64_tr_b16 v[170:171], v6 offset:64
    ds_read_b64_tr_b16 v[174:175], v6 offset:96
    ds_read_b64_tr_b16 v[178:179], v6 offset:128
    ds_read_b64_tr_b16 v[182:183], v6 offset:160
    ds_read_b64_tr_b16 v[186:187], v6 offset:192
    ds_read_b64_tr_b16 v[190:191], v6 offset:224
    ds_read_b64_tr_b16 v[194:195], v6 offset:256
    ds_read_b64_tr_b16 v[198:199], v6 offset:288
    ds_read_b64_tr_b16 v[202:203], v6 offset:320
    ds_read_b64_tr_b16 v[206:207], v6 offset:352
    v_and_b32 v23, 0xffff0000, v22
    v_lshlrev_b32 v22, 16, v22
    s_waitcnt lgkmcnt(0)
    v_smfmac_f32_16x16x64_bf16 v[40:43], v[80:83], v[160:167], v14 abid:1
    v_smfmac_f32_16x16x64_bf16 v[44:47], v[80:83], v[168:175], v14 abid:1
    v_smfmac_f32_16x16x64_bf16 v[48:51], v[80:83], v[176:183], v14 abid:1
    v_smfmac_f32_16x16x64_bf16 v[52:55], v[80:83], v[184:191], v14 abid:1
    v_smfmac_f32_16x16x64_bf16 v[56:59], v[80:83], v[192:199], v14 abid:1
    v_smfmac_f32_16x16x64_bf16 v[60:63], v[80:83], v[200:207], v14 abid:1
    s_waitcnt vmcnt(6)
    ds_write_b128 v2, v[232:235] offset:0
    ds_write_b128 v3, v[236:239] offset:0
    ds_write_b128 v4, v[240:243] offset:0
    ds_write_b128 v2, v[244:247] offset:3328
    ds_write_b128 v3, v[248:251] offset:3328
    ds_write_b128 v4, v[252:255] offset:3328
    ds_read_b64_tr_b16 v[208:209], v6 offset:0
    ds_read_b64_tr_b16 v[212:213], v6 offset:32
    ds_read_b64_tr_b16 v[216:217], v6 offset:64
    ds_read_b64_tr_b16 v[220:221], v6 offset:96
    ds_read_b64_tr_b16 v[224:225], v6 offset:128
    ds_read_b64_tr_b16 v[228:229], v6 offset:160
    ds_read_b64_tr_b16 v[232:233], v6 offset:192
    ds_read_b64_tr_b16 v[236:237], v6 offset:224
    ds_read_b64_tr_b16 v[240:241], v6 offset:256
    ds_read_b64_tr_b16 v[244:245], v6 offset:288
    ds_read_b64_tr_b16 v[248:249], v6 offset:320
    ds_read_b64_tr_b16 v[252:253], v6 offset:352
    s_waitcnt vmcnt(5)
    ds_write_b128 v2, v[88:91] offset:0
    s_waitcnt vmcnt(4)
    ds_write_b128 v3, v[92:95] offset:0
    s_waitcnt vmcnt(3)
    ds_write_b128 v4, v[96:99] offset:0
    s_waitcnt vmcnt(2)
    ds_write_b128 v2, v[100:103] offset:3328
    s_waitcnt vmcnt(1)
    ds_write_b128 v3, v[104:107] offset:3328
    s_waitcnt vmcnt(0)
    ds_write_b128 v4, v[108:111] offset:3328
    ds_read_b64_tr_b16 v[210:211], v6 offset:0
    ds_read_b64_tr_b16 v[214:215], v6 offset:32
    ds_read_b64_tr_b16 v[218:219], v6 offset:64
    ds_read_b64_tr_b16 v[222:223], v6 offset:96
    ds_read_b64_tr_b16 v[226:227], v6 offset:128
    ds_read_b64_tr_b16 v[230:231], v6 offset:160
    ds_read_b64_tr_b16 v[234:235], v6 offset:192
    ds_read_b64_tr_b16 v[238:239], v6 offset:224
    ds_read_b64_tr_b16 v[242:243], v6 offset:256
    ds_read_b64_tr_b16 v[246:247], v6 offset:288
    ds_read_b64_tr_b16 v[250:251], v6 offset:320
    ds_read_b64_tr_b16 v[254:255], v6 offset:352
    s_branch ATT_LAST
LOOP:
    ds_read_b64_tr_b16 v[40:41], v16 offset:0
    ds_read_b64_tr_b16 v[42:43], v16 offset:1536
    ds_read_b64_tr_b16 v[44:45], v16 offset:12288
    ds_read_b64_tr_b16 v[46:47], v16 offset:13824
    ds_read_b64_tr_b16 v[48:49], v17 offset:24576
    ds_read_b64_tr_b16 v[50:51], v16 offset:32
    ds_read_b64_tr_b16 v[52:53], v16 offset:1568
    ds_read_b64_tr_b16 v[54:55], v16 offset:12320
    ds_read_b64_tr_b16 v[56:57], v16 offset:13856
    ds_read_b64_tr_b16 v[58:59], v17 offset:24608
    ds_read_b64_tr_b16 v[60:61], v16 offset:64
    ds_read_b64_tr_b16 v[62:63], v16 offset:1600
    ds_read_b64_tr_b16 v[64:65], v16 offset:12352
    ds_read_b64_tr_b16 v[66:67], v16 offset:13888
    ds_read_b64_tr_b16 v[68:69], v17 offset:24640
    v_and_b32 v25, 15, v0
    v_cmp_eq_u32 vcc, 12, v25
    v_mov_b32 v36, 0x3f803f80
    s_nop 0
    v_cndmask_b32 v70, 0, v36, vcc
    v_mov_b32 v71, v70
    v_mov_b32 v72, v70
    v_mov_b32 v73, v70
    v_mov_b32 v74, v70
    v_mov_b32 v75, v70
    v_mov_b32 v76, v70
    v_mov_b32 v77, v70
    v_mov_b32 v78, v70
    v_mov_b32 v79, v70
    s_cmp_lt_u32 s69, 20
    s_cselect_b32 s5, s72, 0
    s_add_u32 s79, s3, 4096
    s_mul_i32 s77, s72, 6656
    v_mul_u32_u24 v26, 103, v0
    v_lshrrev_b32 v26, 10, v26
    v_lshl_add_u32 v26, v26, 4, v1
    v_add_u32 v26, s77, v26
    v_mul_u32_u24 v27, 176, v25
    v_add_u32 v27, s77, v27
    v_lshrrev_b32 v28, 4, v0
    v_lshl_add_u32 v29, v28, 3, v27
    v_lshl_add_u32 v27, v28, 4, v27
    s_mul_i32 s77, s71, 160
    s_add_u32 s77, s77, s3
    s_sub_u32 s77, s77, 640768
    s_waitcnt lgkmcnt(0)
    s_mov_b32 exec_lo, 0x3ff
    s_mov_b32 exec_hi, 0x0
    s_mov_b32 s76, 1
POLL8:
    buffer_load_dword v24, v1, s[16:19], s77 offen sc1
POLLW8:
    s_waitcnt vmcnt(0)
    v_cmp_eq_u32 vcc, -1, v24
    s_cbranch_vccnz AGAIN8
POLLX8:
    s_mov_b32 exec_lo, 0xffffffff
    s_mov_b32 exec_hi, 0xfffffff
    buffer_load_dwordx4 v[80:83], v8, s[16:19], 0 offen sc1
    buffer_load_dwordx4 v[84:87], v9, s[16:19], 0 offen sc1
    s_waitcnt vmcnt(0)
    v_max_u32 v24, v80, v84
    v_cmp_eq_u32 vcc, -1, v24
    s_cbranch_vccnz AGAIN9
POLLX9:
    ds_write_b128 v26, v[80:83]
    ds_write_b128 v26, v[84:87] offset:1056
    s_mov_b32 exec_lo, 0x1ff01ff
    s_mov_b32 exec_hi, 0x1ff01ff
    ds_read_b128 v[70:73], v27
    ds_read_b128 v[74:77], v27 offset:64
    ds_read_b64 v[78:79], v29 offset:128
    s_mov_b64 exec, -1
    s_cmp_lg_u32 s5, 1
    s_cbranch_scc1 NOOWL
    buffer_load_dword a244, v20, s[16:19], 0 offen sc1
    buffer_load_dword a245, v21, s[16:19], 0 offen sc1
NOOWL:
    s_waitcnt lgkmcnt(2)
    v_mfma_f32_16x16x32_bf16 v[24:27], v[70:73], v[40:43], 0
    v_mfma_f32_16x16x32_bf16 v[32:35], v[70:73], v[60:63], 0
    s_waitcnt lgkmcnt(0)
    v_mfma_f32_16x16x32_bf16 v[24:27], v[74:77], v[44:47], v[24:27]
    v_mfma_f32_16x16x32_bf16 v[32:35], v[74:77], v[64:67], v[32:35]
    v_mfma_f32_16x16x16_bf16 v[24:27], v[78:79], v[48:49], v[24:27]
    v_mfma_f32_16x16x16_bf16 v[32:35], v[78:79], v[68:69], v[32:35]
    v_mfma_f32_16x16x32_bf16 v[28:31], v[70:73], v[50:53], 0
    v_mfma_f32_16x16x32_bf16 v[36:39], v[70:73], v[70:73], 0
    v_mfma_f32_16x16x32_bf16 v[28:31], v[74:77], v[54:57], v[28:31]
    v_mfma_f32_16x16x32_bf16 v[36:39], v[74:77], v[74:77], v[36:39]
    v_mfma_f32_16x16x16_bf16 v[28:31], v[78:79], v[58:59], v[28:31]
    v_mfma_f32_16x16x16_bf16 v[36:39], v[78:79], v[78:79], v[36:39]
    s_nop 0
    v_add_f32 v24, v24, v25
    v_add_f32 v26, v26, v27
    v_add_f32 v24, v24, v26
    v_add_f32 v32, v32, v33
    v_add_f32 v34, v34, v35
    v_add_f32 v32, v32, v34
    s_nop 1
    v_permlane32_swap_b32 v24, v32
    v_add_f32 v28, v28, v29
    v_add_f32 v30, v30, v31
    v_add_f32 v36, v36, v37
    v_add_f32 v38, v38, v39
    v_add_f32 v24, v24, v32
    v_add_f32 v28, v28, v30
    v_add_f32 v36, v36, v38
    s_nop 1
    v_permlane32_swap_b32 v28, v36
    v_add_f32 v28, v28, v36
    s_nop 1
    v_permlane16_swap_b32 v24, v28
    v_add_f32 v24, v24, v28
    s_cmp_eq_u32 s75, 1
    s_cbranch_scc0 SLOW10
    buffer_store_dword v24, v10, s[16:19], s3 offen
BACK10:
    v_mov_b32 v40, 0
    v_mov_b32 v41, 0
    v_mov_b32 v44, 0
    v_mov_b32 v45, 0
    v_mov_b32 v48, 0
    v_mov_b32 v49, 0
    v_mov_b32 v52, 0
    v_mov_b32 v53, 0
    v_mov_b32 v56, 0
    v_mov_b32 v57, 0
    v_mov_b32 v60, 0
    v_mov_b32 v61, 0
    v_mov_b32 v64, 0
    v_mov_b32 v65, 0
    v_mov_b32 v68, 0
    v_mov_b32 v69, 0
    v_mov_b32 v72, 0
    v_mov_b32 v73, 0
    v_mov_b32 v74, 0
    v_mov_b32 v75, 0
    v_mov_b32 v76, 0
    v_mov_b32 v77, 0
    v_mov_b32 v78, 0
    v_mov_b32 v79, 0
    v_mov_b32 v80, 0
    v_mov_b32 v81, 0
    v_mov_b32 v82, 0
    v_mov_b32 v83, 0
    v_mov_b32 v84, 0
    v_mov_b32 v85, 0
    v_mov_b32 v86, 0
    v_mov_b32 v87, 0
    s_mov_b32 s76, 1
POLL11:
    buffer_load_dwordx4 v[24:27], v11, s[16:19], s3 offen sc1
    buffer_load_dwordx4 v[28:31], v11, s[16:19], s79 offen sc1
POLLW11:
    s_waitcnt vmcnt(0)
    v_max3_u32 v32, v24, v25, v26
    v_max3_u32 v32, v32, v27, v28
    v_max3_u32 v32, v32, v29, v30
    v_max_u32 v32, v32, v31
    v_cmp_eq_u32 vcc, -1, v32
    s_cbranch_vccnz AGAIN11
POLLX11:
    v_add_f32 v24, v24, v28
    v_add_f32 v25, v25, v29
    v_add_f32 v26, v26, v30
    v_add_f32 v27, v27, v31
    s_nop 0
    v_permlane32_swap_b32 v24, v26
    v_permlane32_swap_b32 v25, v27
    v_add_f32 v24, v24, v26
    v_add_f32 v25, v25, v27
    s_nop 1
    v_permlane16_swap_b32 v24, v25
    v_add_f32 v24, v24, v25
    s_nop 0
    v_readlane_b32 s77, v24, 15
    s_mov_b32 vcc_lo, 0x70007000
    s_mov_b32 vcc_hi, 0x70007000
    v_fma_f32 v25, -s77, v7, v24
    v_cvt_pk_bf16_f32 v25, v25, v25
    ds_write_b16 v12, v25
    v_cndmask_b32 v26, 0, v24, vcc
    s_nop 1
    v_add_f32_dpp v26, v26, v26 quad_perm:[1,0,3,2] row_mask:0xf bank_mask:0xf
    s_nop 1
    v_add_f32_dpp v26, v26, v26 quad_perm:[2,3,0,1] row_mask:0xf bank_mask:0xf
    v_mov_b32 v27, v26
    s_nop 1
    v_permlane32_swap_b32 v26, v27
    v_add_f32 v26, v26, v27
    s_waitcnt lgkmcnt(0)
    s_barrier
    ds_read_b128 v[28:31], v13 offset:0
    ds_read_b128 v[32:35], v13 offset:128
    ds_read_b128 v[36:39], v13 offset:256
    v_mov_b32 v27, v26
    v_mov_b32 v25, s77
    v_subrev_f32 v25, 0x44200000, v25
    v_permlane16_swap_b32 v26, v27
    v_add_f32 v26, v26, v27
    v_mul_f32 v24, 0x3acccccd, v25
    v_readlane_b32 s77, v26, 15
    v_mul_f32 v24, v24, v24
    s_mov_b32 s78, 0x3acccccd
    v_sub_f32 v26, s77, v25
    v_fma_f32 v26, v26, s78, -v24
    v_max_f32 v26, 0, v26
    v_add_f32 v26, 0x3727c5ac, v26
    v_rsq_f32 v26, v26
    s_nop 0
    v_mul_f32 v18, 0x3dd53b94, v26
    s_waitcnt lgkmcnt(2)
    v_smfmac_f32_16x16x64_bf16 v[40:43], v[28:31], a[0:7], v14
    v_smfmac_f32_16x16x64_bf16 v[56:59], v[28:31], a[96:103], v14
    v_smfmac_f32_16x16x64_bf16 v[44:47], v[28:31], a[24:31], v14
    v_smfmac_f32_16x16x64_bf16 v[60:63], v[28:31], a[120:127], v14
    v_smfmac_f32_16x16x64_bf16 v[48:51], v[28:31], a[48:55], v14
    v_smfmac_f32_16x16x64_bf16 v[64:67], v[28:31], a[144:151], v14
    v_smfmac_f32_16x16x64_bf16 v[52:55], v[28:31], a[72:79], v14
    v_smfmac_f32_16x16x64_bf16 v[68:71], v[28:31], a[168:175], v14
    s_waitcnt lgkmcnt(1)
    v_smfmac_f32_16x16x64_bf16 v[40:43], v[32:35], a[8:15], v14
    v_smfmac_f32_16x16x64_bf16 v[56:59], v[32:35], a[104:111], v14
    v_smfmac_f32_16x16x64_bf16 v[44:47], v[32:35], a[32:39], v14
    v_smfmac_f32_16x16x64_bf16 v[60:63], v[32:35], a[128:135], v14
    v_smfmac_f32_16x16x64_bf16 v[48:51], v[32:35], a[56:63], v14
    v_smfmac_f32_16x16x64_bf16 v[64:67], v[32:35], a[152:159], v14
    v_smfmac_f32_16x16x64_bf16 v[52:55], v[32:35], a[80:87], v14
    v_smfmac_f32_16x16x64_bf16 v[68:71], v[32:35], a[176:183], v14
    s_waitcnt lgkmcnt(0)
    v_smfmac_f32_16x16x64_bf16 v[40:43], v[36:39], a[16:23], v14
    v_smfmac_f32_16x16x64_bf16 v[56:59], v[36:39], a[112:119], v14
    v_smfmac_f32_16x16x64_bf16 v[44:47], v[36:39], a[40:47], v14
    v_smfmac_f32_16x16x64_bf16 v[60:63], v[36:39], a[136:143], v14
    v_smfmac_f32_16x16x64_bf16 v[48:51], v[36:39], a[64:71], v14
    v_smfmac_f32_16x16x64_bf16 v[64:67], v[36:39], a[160:167], v14
    v_smfmac_f32_16x16x64_bf16 v[52:55], v[36:39], a[88:95], v14
    v_smfmac_f32_16x16x64_bf16 v[68:71], v[36:39], a[184:191], v14
    s_lshl_b32 s78, s72, 8
    v_add_f32_dpp v24, v40, v41 quad_perm:[0,1,2,3] row_mask:0x1 bank_mask:0xf
    v_add_f32_dpp v25, v56, v57 quad_perm:[0,1,2,3] row_mask:0x1 bank_mask:0xf
    v_bfe_u32 v27, v0, 4, 1
    v_add_f32_dpp v24, v44, v45 quad_perm:[0,1,2,3] row_mask:0x2 bank_mask:0xf
    v_add_f32_dpp v25, v60, v61 quad_perm:[0,1,2,3] row_mask:0x2 bank_mask:0xf
    v_bfe_u32 v28, v0, 2, 1
    v_add_f32_dpp v24, v48, v49 quad_perm:[0,1,2,3] row_mask:0x4 bank_mask:0xf
    v_add_f32_dpp v25, v64, v65 quad_perm:[0,1,2,3] row_mask:0x4 bank_mask:0xf
    s_add_u32 s78, s78, 124416
    v_add_f32_dpp v24, v52, v53 quad_perm:[0,1,2,3] row_mask:0x8 bank_mask:0xf
    v_add_f32_dpp v25, v68, v69 quad_perm:[0,1,2,3] row_mask:0x8 bank_mask:0xf
    v_max_f32 v26, v24, v25
    v_lshl_add_u32 v27, v27, 5, s78
    v_lshl_add_u32 v27, v28, 4, v27
    v_max_f32_dpp v26, v26, v26 row_ror:8 row_mask:0xf bank_mask:0xf
    s_nop 1
    v_max_f32_dpp v26, v26, v26 row_ror:4 row_mask:0xf bank_mask:0xf
    s_nop 1
    v_max_f32_dpp v26, v26, v26 row_ror:2 row_mask:0xf bank_mask:0xf
    s_nop 1
    v_max_f32_dpp v26, v26, v26 row_ror:1 row_mask:0xf bank_mask:0xf
    v_mov_b32 v28, v26
    s_nop 1
    v_permlane32_swap_b32 v26, v28
    v_max_f32 v26, v26, v28
    v_mov_b32 v28, v26
    s_nop 1
    v_permlane16_swap_b32 v26, v28
    v_max_f32 v26, v26, v28
    v_mul_f32 v26, v26, v18
    v_fma_f32 v24, v24, v18, -v26
    v_fma_f32 v25, v25, v18, -v26
    v_exp_f32 v24, v24
    v_exp_f32 v25, v25
    s_nop 0
    v_cvt_pk_bf16_f32 v28, v24, v25
    ds_write_b16 v19, v28
    ds_write_b16_d16_hi v19, v28 offset:128
    s_mov_b32 exec_lo, 0xff00ff
    s_mov_b32 exec_hi, 0xff00ff00
    ds_read_b128 v[72:75], v27 offset:0
    ds_read_b128 v[76:79], v27 offset:64
    ds_read_b128 v[80:83], v27 offset:128
    ds_read_b128 v[84:87], v27 offset:192
    s_mov_b64 exec, -1
    v_add_f32 v27, v24, v25
    v_mov_b32 v40, 0
    v_mov_b32 v44, 0
    v_add_f32_dpp v27, v27, v27 row_ror:8 row_mask:0xf bank_mask:0xf
    v_mov_b32 v48, 0
    v_mov_b32 v52, 0
    v_add_f32_dpp v27, v27, v27 row_ror:4 row_mask:0xf bank_mask:0xf
    v_mov_b32 v56, 0
    v_mov_b32 v60, 0
    v_add_f32_dpp v27, v27, v27 row_ror:2 row_mask:0xf bank_mask:0xf
    s_lshl_b32 s78, s72, 3
    s_add_u32 s78, s78, 125440
    v_add_f32_dpp v27, v27, v27 row_ror:1 row_mask:0xf bank_mask:0xf
    v_mov_b32 v28, v27
    s_nop 1
    v_permlane32_swap_b32 v27, v28
    v_add_f32 v27, v27, v28
    v_mov_b32 v28, v27
    s_nop 1
    v_permlane16_swap_b32 v27, v28
    v_add_f32 v27, v27, v28
    v_mov_b32 v28, s78
    ds_write_b64 v28, v[26:27]
    s_waitcnt lgkmcnt(4)
    v_smfmac_f32_16x16x64_bf16 v[40:43], v[72:75], a[192:199], v14 abid:1
    v_smfmac_f32_16x16x64_bf16 v[44:47], v[72:75], a[200:207], v14 abid:1
    v_smfmac_f32_16x16x64_bf16 v[48:51], v[72:75], a[208:215], v14 abid:1
    v_smfmac_f32_16x16x64_bf16 v[52:55], v[72:75], a[216:223], v14 abid:1
    v_smfmac_f32_16x16x64_bf16 v[56:59], v[72:75], a[224:231], v14 abid:1
    v_smfmac_f32_16x16x64_bf16 v[60:63], v[72:75], a[232:239], v14 abid:1
    s_waitcnt lgkmcnt(3)
    v_smfmac_f32_16x16x64_bf16 v[40:43], v[76:79], v[112:119], v14 abid:1
    v_smfmac_f32_16x16x64_bf16 v[44:47], v[76:79], v[120:127], v14 abid:1
    v_smfmac_f32_16x16x64_bf16 v[48:51], v[76:79], v[128:135], v14 abid:1
    v_smfmac_f32_16x16x64_bf16 v[52:55], v[76:79], v[136:143], v14 abid:1
    v_smfmac_f32_16x16x64_bf16 v[56:59], v[76:79], v[144:151], v14 abid:1
    v_smfmac_f32_16x16x64_bf16 v[60:63], v[76:79], v[152:159], v14 abid:1
    s_waitcnt lgkmcnt(2)
    v_smfmac_f32_16x16x64_bf16 v[40:43], v[80:83], v[160:167], v14 abid:1
    v_smfmac_f32_16x16x64_bf16 v[44:47], v[80:83], v[168:175], v14 abid:1
    v_smfmac_f32_16x16x64_bf16 v[48:51], v[80:83], v[176:183], v14 abid:1
    v_smfmac_f32_16x16x64_bf16 v[52:55], v[80:83], v[184:191], v14 abid:1
    v_smfmac_f32_16x16x64_bf16 v[56:59], v[80:83], v[192:199], v14 abid:1
    v_smfmac_f32_16x16x64_bf16 v[60:63], v[80:83], v[200:207], v14 abid:1
    s_waitcnt lgkmcnt(0)
ATT_LAST:
    s_waitcnt lgkmcnt(8)
    v_smfmac_f32_16x16x64_bf16 v[40:43], v[84:87], v[208:215], v14 abid:1
    v_smfmac_f32_16x16x64_bf16 v[44:47], v[84:87], v[216:223], v14 abid:1
    s_waitcnt lgkmcnt(4)
    v_smfmac_f32_16x16x64_bf16 v[48:51], v[84:87], v[224:231], v14 abid:1
    v_smfmac_f32_16x16x64_bf16 v[52:55], v[84:87], v[232:239], v14 abid:1
    s_waitcnt lgkmcnt(0)
    v_smfmac_f32_16x16x64_bf16 v[56:59], v[84:87], v[240:247], v14 abid:1
    v_smfmac_f32_16x16x64_bf16 v[60:63], v[84:87], v[248:255], v14 abid:1
    v_add_u32 v24, 119296, v1
    v_mov_b32 v25, 125440
    v_lshlrev_b32 v39, 6, v0
    v_permlane16_swap_b32 v40, v44
    v_add_f32 v40, v40, v44
    ds_write_b32 v15, v40 offset:0
    v_permlane16_swap_b32 v48, v52
    v_add_f32 v48, v48, v52
    ds_write_b32 v15, v48 offset:256
    v_permlane16_swap_b32 v56, v60
    v_add_f32 v56, v56, v60
    ds_write_b32 v15, v56 offset:512
    s_cmp_lg_u32 s72, 0
    s_waitcnt lgkmcnt(0)
    s_barrier
    s_cbranch_scc1 ODONE
    ds_read_b128 v[64:67], v25
    ds_read_b128 v[68:71], v25 offset:16
    ds_read_b128 v[40:43], v24 offset:0
    ds_read_b128 v[44:47], v24 offset:768
    ds_read_b128 v[48:51], v24 offset:1536
    ds_read_b128 v[52:55], v24 offset:2304
    s_mul_i32 s77, s70, 3072
    s_lshl_b32 s78, s71, 4
    s_add_u32 s77, s77, s78
    s_add_u32 s77, s77, s3
    s_add_u32 s77, s77, 32768
    s_lshl_b32 s78, s69, 3
    s_add_u32 s78, s78, s3
    s_add_u32 s78, s78, 45056
    s_waitcnt lgkmcnt(4)
    v_max3_f32 v32, v64, v66, v68
    v_max_f32 v32, v32, v70
    v_sub_f32 v64, v64, v32
    v_sub_f32 v66, v66, v32
    v_sub_f32 v68, v68, v32
    v_sub_f32 v70, v70, v32
    v_exp_f32 v64, v64
    v_exp_f32 v66, v66
    v_exp_f32 v68, v68
    v_exp_f32 v70, v70
    s_waitcnt lgkmcnt(0)
    v_mul_f32 v28, v64, v40
    v_mul_f32 v29, v64, v41
    v_mul_f32 v30, v64, v42
    v_mul_f32 v31, v64, v43
    v_fmac_f32 v28, v66, v44
    v_fmac_f32 v29, v66, v45
    v_fmac_f32 v30, v66, v46
    v_fmac_f32 v31, v66, v47
    v_fmac_f32 v28, v68, v48
    v_fmac_f32 v29, v68, v49
    v_fmac_f32 v30, v68, v50
    v_fmac_f32 v31, v68, v51
    v_fmac_f32 v28, v70, v52
    v_fmac_f32 v29, v70, v53
    v_fmac_f32 v30, v70, v54
    v_fmac_f32 v31, v70, v55
    v_cvt_pk_bf16_f32 v28, v28, v29
    v_cvt_pk_bf16_f32 v29, v30, v31
    s_nop 0
    v_mov_b32_dpp v30, v28 quad_perm:[1,1,3,3] row_mask:0xf bank_mask:0xf
    v_mov_b32_dpp v31, v29 quad_perm:[1,1,3,3] row_mask:0xf bank_mask:0xf
    s_mov_b32 exec_lo, 0x55555555
    s_mov_b32 exec_hi, 0x5555
    s_cmp_eq_u32 s75, 1
    s_cbranch_scc0 SLOW12
    buffer_store_dwordx4 v[28:31], v39, s[16:19], s77 offen
BACK12:
    v_mul_f32 v33, v64, v65
    v_fmac_f32 v33, v66, v67
    v_fmac_f32 v33, v68, v69
    v_fmac_f32 v33, v70, v71
    s_mov_b64 exec, 1
    s_cmp_eq_u32 s75, 1
    s_cbranch_scc0 SLOW13
    buffer_store_dwordx2 v[32:33], v39, s[16:19], s78 offen
BACK13:
    s_mov_b64 exec, -1
ODONE:
    s_cmp_ge_u32 s69, 20
    s_cbranch_scc1 ROLEF
    v_accvgpr_read_b32 v2, a246
    v_accvgpr_read_b32 v3, a247
    v_accvgpr_read_b32 v4, a248
    v_mov_b32 v88, 0
    v_mov_b32 v92, 0
    v_mov_b32 v96, 0
    v_mov_b32 v100, 0
    v_mov_b32 v104, 0
    v_mov_b32 v108, 0
    ds_read_b64_tr_b16 v[40:41], v2 offset:0
    ds_read_b64_tr_b16 v[42:43], v2 offset:256
    ds_read_b64_tr_b16 v[64:65], v2 offset:32
    ds_read_b64_tr_b16 v[66:67], v2 offset:288
    ds_read_b64_tr_b16 v[44:45], v2 offset:2048
    ds_read_b64_tr_b16 v[46:47], v2 offset:2304
    ds_read_b64_tr_b16 v[68:69], v2 offset:2080
    ds_read_b64_tr_b16 v[70:71], v2 offset:2336
    ds_read_b64_tr_b16 v[48:49], v2 offset:4096
    ds_read_b64_tr_b16 v[50:51], v2 offset:4352
    s_cmp_lg_u32 s72, 1
    s_cbranch_scc1 NOOWN0
    s_cmp_eq_u32 s74, 0
    s_cbranch_scc1 NOOWN0
    v_accvgpr_read_b32 v28, a244
    v_accvgpr_read_b32 v29, a245
    v_max_u32 v30, v28, v29
    v_cmp_eq_u32 vcc, -1, v30
    s_cbranch_vccnz RETRY14
OK14:
    v_lshlrev_b32 v30, 16, v28
    v_and_b32 v28, 0xffff0000, v28
    v_lshlrev_b32 v31, 16, v29
    v_and_b32 v29, 0xffff0000, v29
    v_add_f32 v30, v30, v31
    v_add_f32 v28, v28, v29
    v_mov_b32 v31, v30
    v_mov_b32 v29, v28
    s_nop 0
    v_permlane32_swap_b32 v30, v31
    v_permlane32_swap_b32 v28, v29
    v_add_f32 v30, v30, v31
    v_add_f32 v28, v28, v29
    v_mov_b32 v31, v30
    v_mov_b32 v29, v28
    s_nop 0
    v_permlane16_swap_b32 v30, v31
    v_permlane16_swap_b32 v28, v29
    v_add_f32 v30, v30, v31
    v_add_f32 v28, v28, v29
    v_add_f32 v22, v22, v30
    v_add_f32 v23, v23, v28
    v_cvt_pk_bf16_f32 v28, v22, v23
    s_lshl_b32 s77, s69, 6
    s_add_u32 s77, s77, s3
    s_add_u32 s77, s77, 48640
    v_lshlrev_b32 v37, 2, v0
    v_mov_b32_dpp v29, v28 quad_perm:[1,1,1,1] row_mask:0xf bank_mask:0xf
    v_mov_b32_dpp v30, v28 quad_perm:[2,2,2,2] row_mask:0xf bank_mask:0xf
    v_mov_b32_dpp v31, v28 quad_perm:[3,3,3,3] row_mask:0xf bank_mask:0xf
    s_mov_b32 exec_lo, 0x1111
    s_mov_b32 exec_hi, 0x0
    s_cmp_eq_u32 s75, 1
    s_cbranch_scc0 SLOW15
    buffer_store_dwordx4 v[28:31], v37, s[16:19], s77 offen
BACK15:
    s_mov_b64 exec, -1
NOOWN0:
    v_mov_b32 v25, 0
    v_mov_b32 v27, 0
    v_mov_b32 v37, 0
    v_mov_b32 v39, 0
    s_mov_b32 exec_lo, 0x00ff00ff
    s_mov_b32 exec_hi, 0x00ff00ff
    buffer_load_dwordx4 v[88:91], v3, s[16:19], s3 offen offset:0 sc1
    buffer_load_dwordx4 v[92:95], v3, s[16:19], s3 offen offset:512 sc1
    buffer_load_dwordx4 v[96:99], v3, s[16:19], s3 offen offset:1024 sc1
    buffer_load_dwordx4 v[100:103], v3, s[16:19], s3 offen offset:1536 sc1
    buffer_load_dwordx4 v[104:107], v3, s[16:19], s3 offen offset:2048 sc1
    buffer_load_dwordx4 v[108:111], v3, s[16:19], s3 offen offset:2560 sc1
    s_mov_b32 exec_lo, -1
    s_mov_b32 exec_hi, 0
    buffer_load_dwordx4 v[24:27], v4, s[16:19], s3 offen offset:0 sc1
    buffer_load_dwordx4 v[36:39], v4, s[16:19], s3 offen offset:16 sc1
    s_mov_b64 exec, -1
    ds_read_b64_tr_b16 v[72:73], v2 offset:4128
    ds_read_b64_tr_b16 v[74:75], v2 offset:4384
    ds_read_b64_tr_b16 v[52:53], v2 offset:6144
    ds_read_b64_tr_b16 v[54:55], v2 offset:6400
    ds_read_b64_tr_b16 v[76:77], v2 offset:6176
    ds_read_b64_tr_b16 v[78:79], v2 offset:6432
    ds_read_b64_tr_b16 v[56:57], v2 offset:8192
    ds_read_b64_tr_b16 v[58:59], v2 offset:8448
    ds_read_b64_tr_b16 v[80:81], v2 offset:8224
    ds_read_b64_tr_b16 v[82:83], v2 offset:8480
    ds_read_b64_tr_b16 v[60:61], v2 offset:10240
    ds_read_b64_tr_b16 v[62:63], v2 offset:10496
    ds_read_b64_tr_b16 v[84:85], v2 offset:10272
    ds_read_b64_tr_b16 v[86:87], v2 offset:10528
    v_accvgpr_read_b32 v5, a249
    v_add_u32 v6, 119296, v1
    v_lshrrev_b32 v18, 1, v1
    s_waitcnt vmcnt(0)
    v_max3_u32 v28, v88, v92, v96
    v_max3_u32 v28, v28, v100, v104
    v_max3_u32 v28, v28, v108, v25
    v_max3_u32 v28, v28, v27, v37
    v_max_u32 v28, v28, v39
    v_cmp_eq_u32 vcc, -1, v28
    s_cbranch_vccnz AGAIN16
POLLX16:
    s_waitcnt lgkmcnt(0)
    v_mfma_f32_16x16x32_bf16 v[28:31], v[88:91], v[40:43], 0
    v_mfma_f32_16x16x32_bf16 v[32:35], v[88:91], v[64:67], 0
    v_max3_f32 v88, v24, v26, v36
    v_max_f32 v88, v88, v38
    v_mfma_f32_16x16x32_bf16 v[28:31], v[92:95], v[44:47], v[28:31]
    v_mov_b32 v89, v88
    v_mfma_f32_16x16x32_bf16 v[32:35], v[92:95], v[68:71], v[32:35]
    s_nop 0
    v_permlane16_swap_b32 v88, v89
    v_max_f32 v88, v88, v89
    v_mfma_f32_16x16x32_bf16 v[28:31], v[96:99], v[48:51], v[28:31]
    v_sub_f32 v24, v24, v88
    v_sub_f32 v26, v26, v88
    v_mfma_f32_16x16x32_bf16 v[32:35], v[96:99], v[72:75], v[32:35]
    v_sub_f32 v36, v36, v88
    v_sub_f32 v38, v38, v88
    v_mfma_f32_16x16x32_bf16 v[28:31], v[100:103], v[52:55], v[28:31]
    v_exp_f32 v24, v24
    v_mfma_f32_16x16x32_bf16 v[32:35], v[100:103], v[76:79], v[32:35]
    v_exp_f32 v26, v26
    v_mfma_f32_16x16x32_bf16 v[28:31], v[104:107], v[56:59], v[28:31]
    v_exp_f32 v36, v36
    v_mfma_f32_16x16x32_bf16 v[32:35], v[104:107], v[80:83], v[32:35]
    v_exp_f32 v38, v38
    v_mfma_f32_16x16x32_bf16 v[28:31], v[108:111], v[60:63], v[28:31]
    v_mul_f32 v90, v24, v25
    v_fmac_f32 v90, v26, v27
    v_mfma_f32_16x16x32_bf16 v[32:35], v[108:111], v[84:87], v[32:35]
    v_fmac_f32 v90, v36, v37
    v_fmac_f32 v90, v38, v39
    v_mov_b32 v89, v90
    s_cmp_lg_u32 s72, 0
    s_nop 0
    v_permlane16_swap_b32 v90, v89
    v_add_f32 v90, v90, v89
    v_rcp_f32 v90, v90
    v_mul_f32 v28, v24, v28
    v_mul_f32 v32, v24, v32
    v_fmac_f32 v28, v26, v29
    v_fmac_f32 v32, v26, v33
    v_fmac_f32 v28, v36, v30
    v_fmac_f32 v32, v36, v34
    v_fmac_f32 v28, v38, v31
    v_fmac_f32 v32, v38, v35
    s_nop 1
    v_permlane16_swap_b32 v28, v32
    v_add_f32 v28, v28, v32
    v_mul_f32 v28, v28, v90
    ds_write_b32 v5, v28
    s_waitcnt lgkmcnt(0)
    s_barrier
    s_cbranch_scc1 WNOT0
    ds_read_b128 v[40:43], v6 offset:3072
    ds_read_b128 v[44:47], v6 offset:3328
    ds_read_b128 v[48:51], v6 offset:3584
    ds_read_b128 v[52:55], v6 offset:3840
    s_waitcnt lgkmcnt(2)
    v_add_f32 v28, v40, v44
    v_add_f32 v29, v41, v45
    v_add_f32 v30, v42, v46
    v_add_f32 v31, v43, v47
    s_waitcnt lgkmcnt(0)
    v_add_f32 v32, v48, v52
    v_add_f32 v33, v49, v53
    v_add_f32 v34, v50, v54
    v_add_f32 v35, v51, v55
    v_add_f32 v28, v28, v32
    v_add_f32 v29, v29, v33
    v_add_f32 v30, v30, v34
    v_add_f32 v31, v31, v35
    v_cvt_pk_bf16_f32 v28, v28, v29
    v_cvt_pk_bf16_f32 v29, v30, v31
    s_nop 0
    v_mov_b32_dpp v30, v28 quad_perm:[1,1,3,3] row_mask:0xf bank_mask:0xf
    v_mov_b32_dpp v31, v29 quad_perm:[1,1,3,3] row_mask:0xf bank_mask:0xf
    s_mov_b32 exec_lo, 0x55
    s_mov_b32 exec_hi, 0x0
    buffer_store_dwordx4 v[28:31], v18, s[16:19], s80 offen sc1
    s_cmp_eq_u32 s75, 1
    s_cbranch_scc0 SLOW17
    buffer_store_dwordx4 v[28:31], v18, s[16:19], s81 offen
BACK17:
    s_mov_b64 exec, -1
    v_lshrrev_b32 v37, 5, v0
    v_mul_u32_u24 v37, 2560, v37
    v_and_b32 v38, 31, v0
    v_lshl_add_u32 v37, v38, 2, v37
    v_add_u32 v41, 5120, v37
    v_add_u32 v42, 10240, v37
    v_add_u32 v43, 15360, v37
    v_add_u32 v44, 20480, v37
    v_add_u32 v45, 25600, v37
    s_lshl_b32 s79, s69, 7
    s_add_u32 s79, s79, s3
    s_add_u32 s79, s79, 51200
    s_add_u32 s96, s80, 10240
    s_add_u32 s97, s81, 1280
    v_lshlrev_b32 v39, 1, v0
    s_cmp_lg_u32 s74, 0
    s_cbranch_scc1 NOLC
    s_mul_i32 s77, s69, 2464
    s_add_u32 s78, s3, 720896
    v_add_u32 v48, s77, v1
    v_min_u32 v48, 49136, v48
    s_add_u32 s77, s77, 1024
    v_add_u32 v49, s77, v1
    v_min_u32 v49, 49136, v49
    s_add_u32 s77, s77, 1024
    v_add_u32 v50, s77, v1
    v_min_u32 v50, 49136, v50
    s_add_u32 s77, s77, 1024
    buffer_load_dwordx4 a[240:243], v48, s[16:19], s78 offen sc1
    buffer_load_dwordx4 a[240:243], v49, s[16:19], s78 offen sc1
    buffer_load_dwordx4 a[240:243], v50, s[16:19], s78 offen sc1
    v_mov_b32 v52, -1
    v_mov_b32 v53, -1
    v_mov_b32 v54, -1
    v_mov_b32 v55, -1
    s_add_u32 s77, s80, 688128
    s_add_u32 s7, s96, 688128
    s_waitcnt vmcnt(0)
    s_cmp_eq_u32 s75, 1
    s_cbranch_scc0 SLOW18
    buffer_store_dwordx4 v[52:55], v48, s[16:19], s78 offen
BACK18:
    s_cmp_eq_u32 s75, 1
    s_cbranch_scc0 SLOW19
    buffer_store_dwordx4 v[52:55], v49, s[16:19], s78 offen
BACK19:
    s_cmp_eq_u32 s75, 1
    s_cbranch_scc0 SLOW20
    buffer_store_dwordx4 v[52:55], v50, s[16:19], s78 offen
BACK20:
    s_mov_b64 exec, 15
    buffer_store_dwordx4 v[52:55], v1, s[16:19], s77 offen sc1
    buffer_store_dwordx4 v[52:55], v1, s[16:19], s7 offen sc1
    s_mov_b64 exec, -1
NOLC:
    s_mov_b32 s76, 1
POLL21:
    buffer_load_dword v28, v37, s[16:19], s79 offen sc1
    buffer_load_dword v29, v41, s[16:19], s79 offen sc1
    buffer_load_dword v30, v42, s[16:19], s79 offen sc1
    buffer_load_dword v31, v43, s[16:19], s79 offen sc1
    buffer_load_dword v32, v44, s[16:19], s79 offen sc1
    buffer_load_dword v33, v45, s[16:19], s79 offen sc1
POLLW21:
    s_waitcnt vmcnt(0)
    v_max3_u32 v36, v28, v29, v30
    v_max3_u32 v36, v36, v31, v32
    v_max_u32 v36, v36, v33
    v_cmp_eq_u32 vcc, -1, v36
    s_cbranch_vccnz AGAIN21
POLLX21:
    v_add_f32 v28, v28, v29
    v_add_f32 v30, v30, v31
    v_add_f32 v32, v32, v33
    v_add_f32 v28, v28, v30
    v_add_f32 v28, v28, v32
    v_mov_b32 v29, v28
    s_nop 1
    v_permlane32_swap_b32 v28, v29
    v_add_f32 v28, v28, v29
    s_nop 1
    v_mov_b32_dpp v29, v28 row_shl:1 row_mask:0xf bank_mask:0xf
    v_cvt_pk_bf16_f32 v28, v28, v29
    s_nop 1
    v_mov_b32_dpp v29, v28 row_shl:2 row_mask:0xf bank_mask:0xf
    v_mov_b32_dpp v30, v28 row_shl:4 row_mask:0xf bank_mask:0xf
    v_mov_b32_dpp v31, v28 row_shl:6 row_mask:0xf bank_mask:0xf
    s_mov_b32 exec_lo, 0x1010101
    s_mov_b32 exec_hi, 0x0
    buffer_store_dwordx4 v[28:31], v39, s[16:19], s96 offen sc1
    s_cmp_eq_u32 s75, 1
    s_cbranch_scc0 SLOW22
    buffer_store_dwordx4 v[28:31], v39, s[16:19], s97 offen
BACK22:
    s_mov_b64 exec, -1
    s_branch NEXT
AGAIN8:
    s_add_u32 s76, s76, 1
    s_cmp_lt_u32 s76, 32768
    s_cbranch_scc1 POLL8
    s_branch POLLX8
AGAIN9:
    s_mov_b64 s[94:95], exec
    s_mov_b32 s76, 1
AG29:
    v_cmp_eq_u32 vcc, -1, v80
    s_nop 0
    s_mov_b64 exec, vcc
    s_cbranch_execz AG39_0
    buffer_load_dwordx4 v[80:83], v8, s[16:19], 0 offen sc1
AG39_0:
    s_mov_b64 exec, s[94:95]
    v_cmp_eq_u32 vcc, -1, v84
    s_nop 0
    s_mov_b64 exec, vcc
    s_cbranch_execz AG39_1
    buffer_load_dwordx4 v[84:87], v9, s[16:19], 0 offen sc1
AG39_1:
    s_mov_b64 exec, s[94:95]
    s_add_u32 s76, s76, 1
    s_cmp_ge_u32 s76, 32768
    s_waitcnt vmcnt(0)
    v_max_u32 v24, v80, v84
    v_cmp_eq_u32 vcc, -1, v24
    s_cbranch_vccz POLLX9
    s_cbranch_scc0 AG29
    s_branch POLLX9
AGAIN11:
    s_add_u32 s76, s76, 1
    s_cmp_lt_u32 s76, 32768
    s_cbranch_scc1 POLL11
    s_branch POLLX11
AGAIN16:
    s_mov_b64 s[94:95], exec
    s_mov_b32 s76, 1
AG216:
    v_max3_u32 v28, v88, v92, v96
    v_max3_u32 v28, v28, v100, v104
    v_max_u32 v28, v28, v108
    v_cmp_eq_u32 vcc, -1, v28
    s_nop 0
    s_mov_b64 exec, vcc
    s_cbranch_execz AG316_0
    buffer_load_dwordx4 v[88:91], v3, s[16:19], s3 offen offset:0 sc1
    buffer_load_dwordx4 v[92:95], v3, s[16:19], s3 offen offset:512 sc1
    buffer_load_dwordx4 v[96:99], v3, s[16:19], s3 offen offset:1024 sc1
    buffer_load_dwordx4 v[100:103], v3, s[16:19], s3 offen offset:1536 sc1
    buffer_load_dwordx4 v[104:107], v3, s[16:19], s3 offen offset:2048 sc1
    buffer_load_dwordx4 v[108:111], v3, s[16:19], s3 offen offset:2560 sc1
AG316_0:
    s_mov_b64 exec, s[94:95]
    v_max3_u32 v28, v25, v27, v37
    v_max_u32 v28, v28, v39
    v_cmp_eq_u32 vcc, -1, v28
    s_nop 0
    s_mov_b64 exec, vcc
    s_cbranch_execz AG316_1
    buffer_load_dwordx4 v[24:27], v4, s[16:19], s3 offen offset:0 sc1
    buffer_load_dwordx4 v[36:39], v4, s[16:19], s3 offen offset:16 sc1
AG316_1:
    s_mov_b64 exec, s[94:95]
    s_add_u32 s76, s76, 1
    s_cmp_ge_u32 s76, 32768
    s_waitcnt vmcnt(0)
    v_max3_u32 v28, v88, v92, v96
    v_max3_u32 v28, v28, v100, v104
    v_max3_u32 v28, v28, v108, v25
    v_max3_u32 v28, v28, v27, v37
    v_max_u32 v28, v28, v39
    v_cmp_eq_u32 vcc, -1, v28
    s_cbranch_vccz POLLX16
    s_cbranch_scc0 AG216
    s_branch POLLX16
AGAIN21:
    s_add_u32 s76, s76, 1
    s_cmp_lt_u32 s76, 32768
    s_cbranch_scc1 POLL21
    s_branch POLLX21
WNOT0:
    s_cmp_lg_u32 s72, 1
    s_cbranch_scc1 NEXT
    v_and_b32 v25, 15, v0
    v_lshrrev_b32 v26, 4, v0
    v_mul_u32_u24 v37, 1280, v26
    v_add_u32 v37, 655360, v37
    s_mul_i32 s7, s68, 81920
    s_add_u32 s7, s7, 46080
    v_mov_b32 v38, s7
    v_cmp_eq_u32 vcc, s68, v26
    s_nop 1
    v_cndmask_b32 v37, v37, v38, vcc
    v_add_u32 v39, 4, v26
    v_mul_u32_u24 v38, 1280, v39
    v_add_u32 v38, 655360, v38
    s_mul_i32 s7, s68, 81920
    s_add_u32 s7, s7, 46080
    v_mov_b32 v28, s7
    v_cmp_eq_u32 vcc, s68, v39
    s_nop 1
    v_cndmask_b32 v38, v38, v28, vcc
    s_lshl_b32 s77, s69, 6
    s_add_u32 s77, s77, s74
    v_lshl_add_u32 v37, v25, 2, v37
    v_lshl_add_u32 v38, v25, 2, v38
    s_sleep 16
    s_mov_b32 s76, 1
POLL23:
    buffer_load_dword v28, v37, s[16:19], s77 offen sc1
    buffer_load_dword v29, v38, s[16:19], s77 offen sc1
POLLW23:
    s_waitcnt vmcnt(0)
    v_max_u32 v30, v28, v29
    v_cmp_eq_u32 vcc, -1, v30
    s_cbranch_vccnz AGAIN23
POLLX23:
    v_lshlrev_b32 v30, 16, v28
    v_and_b32 v28, 0xffff0000, v28
    v_lshlrev_b32 v31, 16, v29
    v_and_b32 v29, 0xffff0000, v29
    v_add_f32 v30, v30, v31
    v_add_f32 v28, v28, v29
    v_mov_b32 v31, v30
    v_mov_b32 v29, v28
    s_nop 0
    v_permlane32_swap_b32 v30, v31
    v_permlane32_swap_b32 v28, v29
    v_add_f32 v30, v30, v31
    v_add_f32 v28, v28, v29
    v_mov_b32 v31, v30
    v_mov_b32 v29, v28
    s_nop 0
    v_permlane16_swap_b32 v30, v31
    v_permlane16_swap_b32 v28, v29
    v_add_f32 v30, v30, v31
    v_add_f32 v28, v28, v29
    v_add_f32 v22, v22, v30
    v_add_f32 v23, v23, v28
    v_cvt_pk_bf16_f32 v28, v22, v23
    s_cmp_lg_u32 s74, 0
    s_cbranch_scc1 FINAL
    s_lshl_b32 s77, s69, 6
    s_add_u32 s77, s77, s3
    s_add_u32 s77, s77, 49920
    v_lshlrev_b32 v37, 2, v0
    v_mov_b32_dpp v29, v28 quad_perm:[1,1,1,1] row_mask:0xf bank_mask:0xf
    v_mov_b32_dpp v30, v28 quad_perm:[2,2,2,2] row_mask:0xf bank_mask:0xf
    v_mov_b32_dpp v31, v28 quad_perm:[3,3,3,3] row_mask:0xf bank_mask:0xf
    s_mov_b32 exec_lo, 0x1111
    s_mov_b32 exec_hi, 0x0
    s_cmp_eq_u32 s75, 1
    s_cbranch_scc0 SLOW24
    buffer_store_dwordx4 v[28:31], v37, s[16:19], s77 offen
BACK24:
    s_mov_b64 exec, -1
    s_branch NEXT
FINAL:
    s_cmp_lg_u32 s68, 0
    s_cbranch_scc1 DONE
    s_lshl_b32 s77, s69, 6
    v_lshlrev_b32 v37, 2, v0
    s_add_u32 s79, s77, s3
    s_add_u32 s79, s79, 47360
    s_mov_b64 exec, 15
    s_mov_b32 s76, 1
POLL25:
    buffer_load_dword v28, v1, s[16:19], s79 offen sc1
POLLW25:
    s_waitcnt vmcnt(0)
    v_cmp_eq_u32 vcc, -1, v28
    s_cbranch_vccnz AGAIN25
POLLX25:
    s_mov_b64 exec, -1
    s_mov_b32 s76, 1
POLL26:
    buffer_load_dword v28, v20, s[16:19], s74 offen sc1
    buffer_load_dword v29, v21, s[16:19], s74 offen sc1
POLLW26:
    s_waitcnt vmcnt(0)
    v_max_u32 v30, v28, v29
    v_cmp_eq_u32 vcc, -1, v30
    s_cbranch_vccnz AGAIN26
POLLX26:
    v_lshlrev_b32 v30, 16, v28
    v_and_b32 v28, 0xffff0000, v28
    v_lshlrev_b32 v31, 16, v29
    v_and_b32 v29, 0xffff0000, v29
    v_add_f32 v30, v30, v31
    v_add_f32 v28, v28, v29
    v_mov_b32 v31, v30
    v_mov_b32 v29, v28
    s_nop 0
    v_permlane32_swap_b32 v30, v31
    v_permlane32_swap_b32 v28, v29
    v_add_f32 v30, v30, v31
    v_add_f32 v28, v28, v29
    v_mov_b32 v31, v30
    v_mov_b32 v29, v28
    s_nop 0
    v_permlane16_swap_b32 v30, v31
    v_permlane16_swap_b32 v28, v29
    v_add_f32 v30, v30, v31
    v_add_f32 v28, v28, v29
    v_add_f32 v22, v22, v30
    v_add_f32 v23, v23, v28
    v_cvt_pk_bf16_f32 v28, v22, v23
    s_mov_b32 exec_lo, 0xffff
    s_mov_b32 exec_hi, 0x0
    buffer_store_dword v28, v37, s[40:43], s77 offen
    s_mov_b64 exec, -1
    s_endpgm
AGAIN23:
    s_sleep 4
    s_add_u32 s76, s76, 1
    s_cmp_lt_u32 s76, 32768
    s_cbranch_scc1 POLL23
    s_branch POLLX23
AGAIN25:
    s_add_u32 s76, s76, 1
    s_cmp_lt_u32 s76, 32768
    s_cbranch_scc1 POLL25
    s_branch POLLX25
AGAIN26:
    s_add_u32 s76, s76, 1
    s_cmp_lt_u32 s76, 32768
    s_cbranch_scc1 POLL26
    s_branch POLLX26
ROLEF:
    v_and_b32 v25, 15, v0
    v_lshrrev_b32 v26, 4, v0
    v_bfe_u32 v27, v0, 2, 2
    v_and_b32 v36, 3, v0
    s_mov_b32 s4, 1
    s_cmp_lg_u32 s74, 0
    s_cbranch_scc1 FW
    s_mov_b32 s4, 0
FW:
    s_mul_i32 s77, s72, 5120
    s_add_u32 s77, s77, 57344
    v_lshl_add_u32 v37, v26, 3, v27
    v_lshlrev_b32 v37, 5, v37
    v_lshl_add_u32 v37, v36, 3, v37
    v_add_u32 v37, s77, v37
    ds_read_b64_tr_b16 v[40:41], v37 offset:0
    ds_read_b64_tr_b16 v[42:43], v37 offset:128
    ds_read_b64_tr_b16 v[44:45], v37 offset:1024
    ds_read_b64_tr_b16 v[46:47], v37 offset:1152
    ds_read_b64_tr_b16 v[48:49], v37 offset:2048
    ds_read_b64_tr_b16 v[50:51], v37 offset:2176
    ds_read_b64_tr_b16 v[52:53], v37 offset:3072
    ds_read_b64_tr_b16 v[54:55], v37 offset:3200
    ds_read_b64_tr_b16 v[56:57], v37 offset:4096
    ds_read_b64_tr_b16 v[58:59], v37 offset:4224
    ds_read_b64_tr_b16 v[60:61], v37 offset:20480
    ds_read_b64_tr_b16 v[62:63], v37 offset:20608
    ds_read_b64_tr_b16 v[64:65], v37 offset:21504
    ds_read_b64_tr_b16 v[66:67], v37 offset:21632
    ds_read_b64_tr_b16 v[68:69], v37 offset:22528
    ds_read_b64_tr_b16 v[70:71], v37 offset:22656
    ds_read_b64_tr_b16 v[72:73], v37 offset:23552
    ds_read_b64_tr_b16 v[74:75], v37 offset:23680
    ds_read_b64_tr_b16 v[76:77], v37 offset:24576
    ds_read_b64_tr_b16 v[78:79], v37 offset:24704
    s_mul_i32 s77, s72, 320
    s_add_u32 s77, s77, 98304
    v_lshrrev_b32 v80, 2, v0
    v_mul_u32_u24 v80, 1280, v80
    v_lshl_add_u32 v80, v36, 3, v80
    v_add_u32 v80, s77, v80
    s_lshl_b32 s79, s72, 2
    s_add_u32 s79, s79, 123392
    v_add_u32 v81, s79, v1
    v_lshl_add_u32 v82, v26, 2, v36
    v_lshlrev_b32 v82, 4, v82
    v_add_u32 v82, 123392, v82
    v_cmp_eq_u32 vcc, 12, v25
    v_mov_b32 v38, 13
    s_nop 0
    v_cndmask_b32 v83, v25, v38, vcc
    v_lshlrev_b32 v83, 4, v83
    v_add_u32 v83, 123904, v83
    v_mov_b32 v85, 124096
    v_lshlrev_b32 v84, 6, v25
    v_lshl_add_u32 v84, v26, 4, v84
    v_mov_b32 v38, 0x3f803f80
    v_cndmask_b32 v88, 0, v38, vcc
    v_mov_b32 v89, v88
    v_mov_b32 v90, v88
    v_mov_b32 v91, v88
    v_mov_b32 v92, v88
    v_mov_b32 v93, v88
    v_mov_b32 v94, v88
    v_mov_b32 v95, v88
    v_mov_b32 v96, v88
    v_mov_b32 v97, v88
    v_mov_b32 v98, v88
    v_mov_b32 v99, v88
    v_mov_b32 v100, v88
    v_mov_b32 v101, v88
    v_mov_b32 v102, v88
    v_mov_b32 v103, v88
    v_mov_b32 v104, v88
    v_mov_b32 v105, v88
    v_mov_b32 v106, v88
    v_mov_b32 v107, v88
    s_mul_i32 s77, s72, 6656
    v_mul_u32_u24 v6, 336, v25
    v_lshl_add_u32 v6, v26, 4, v6
    v_add_u32 v6, s77, v6
    v_mul_u32_u24 v37, 52, v0
    v_lshrrev_b32 v37, 10, v37
    v_lshl_add_u32 v87, v37, 4, v1
    v_add_u32 v87, s77, v87
    v_mul_u32_u24 v27, 320, v37
    v_sub_u32 v27, v1, v27
    v_mul_u32_u24 v86, 1280, v37
    v_add_u32 v86, 655360, v86
    s_mul_i32 s7, s68, 81920
    s_add_u32 s7, s7, 46080
    v_mov_b32 v38, s7
    v_cmp_eq_u32 vcc, s68, v37
    s_nop 1
    v_cndmask_b32 v86, v86, v38, vcc
    v_add_u32 v38, 2560, v38
    v_cmp_le_u32 vcc, 8, v37
    s_nop 1
    v_cndmask_b32 v86, v86, v38, vcc
    v_add_u32 v86, v86, v27
    v_add_u32 v37, 3, v37
    v_mul_u32_u24 v18, 1280, v37
    v_add_u32 v18, 655360, v18
    s_mul_i32 s7, s68, 81920
    s_add_u32 s7, s7, 46080
    v_mov_b32 v38, s7
    v_cmp_eq_u32 vcc, s68, v37
    s_nop 1
    v_cndmask_b32 v18, v18, v38, vcc
    v_add_u32 v38, 2560, v38
    v_cmp_le_u32 vcc, 8, v37
    s_nop 1
    v_cndmask_b32 v18, v18, v38, vcc
    v_add_u32 v18, v18, v27
    v_add_u32 v37, 3, v37
    v_mul_u32_u24 v20, 1280, v37
    v_add_u32 v20, 655360, v20
    s_mul_i32 s7, s68, 81920
    s_add_u32 s7, s7, 46080
    v_mov_b32 v38, s7
    v_cmp_eq_u32 vcc, s68, v37
    s_nop 1
    v_cndmask_b32 v20, v20, v38, vcc
    v_add_u32 v38, 2560, v38
    v_cmp_le_u32 vcc, 8, v37
    s_nop 1
    v_cndmask_b32 v20, v20, v38, vcc
    v_add_u32 v20, v20, v27
    s_mul_i32 s77, s72, 320
    s_add_u32 s77, s77, s74
    s_sub_u32 s78, s69, 20
    s_mul_i32 s78, s78, 2560
    s_mul_i32 s7, s72, 640
    s_add_u32 s78, s78, s7
    s_add_u32 s78, s78, s3
    s_add_u32 s78, s78, 51200
    s_waitcnt lgkmcnt(0)
    s_cmp_eq_u32 s4, 0
    s_cbranch_scc1 FW2
FPOLL:
    ds_read_b64_tr_b16 a[240:241], v80 offset:0
    ds_read_b64_tr_b16 a[242:243], v80 offset:32
    ds_read_b64_tr_b16 a[244:245], v80 offset:64
    ds_read_b64_tr_b16 a[246:247], v80 offset:96
    ds_read_b64_tr_b16 a[248:249], v80 offset:128
    ds_read_b64_tr_b16 a[250:251], v80 offset:160
    ds_read_b64_tr_b16 v[108:109], v80 offset:192
    ds_read_b64_tr_b16 v[110:111], v80 offset:224
    ds_read_b64_tr_b16 v[2:3], v80 offset:256
    ds_read_b64_tr_b16 v[4:5], v80 offset:288
    s_waitcnt lgkmcnt(0)
    s_mul_i32 s79, s72, 320
    s_add_u32 s79, s79, s3
    s_add_u32 s79, s79, 46080
    s_mov_b32 exec_lo, 0xfffff
    s_mov_b32 exec_hi, 0x0
    s_mov_b32 s76, 1
POLL27:
    buffer_load_dword v36, v1, s[16:19], s79 offen sc1
POLLW27:
    s_waitcnt vmcnt(0)
    v_cmp_eq_u32 vcc, -1, v36
    s_cbranch_vccnz AGAIN27
POLLX27:
    s_mov_b32 exec_lo, 0xffffffff
    s_mov_b32 exec_hi, 0xfffffff
    buffer_load_dwordx4 v[24:27], v86, s[16:19], s77 offen sc1
    buffer_load_dwordx4 v[28:31], v18, s[16:19], s77 offen sc1
    buffer_load_dwordx4 v[32:35], v20, s[16:19], s77 offen sc1
    s_waitcnt vmcnt(0)
    v_max3_u32 v36, v24, v28, v32
    v_cmp_eq_u32 vcc, -1, v36
    s_cbranch_vccnz AGAIN28
POLLX28:
    ds_write_b128 v87, v[24:27] offset:0
    ds_write_b128 v87, v[28:31] offset:1008
    ds_write_b128 v87, v[32:35] offset:2016
    s_mov_b32 exec_lo, 0x1ff01ff
    s_mov_b32 exec_hi, 0x1ff01ff
    ds_read_b128 v[88:91], v6 offset:0
    ds_read_b128 v[92:95], v6 offset:64
    ds_read_b128 v[96:99], v6 offset:128
    ds_read_b128 v[100:103], v6 offset:192
    ds_read_b128 v[104:107], v6 offset:256
    s_mov_b64 exec, -1
FMM:
    s_waitcnt lgkmcnt(4)
    v_mfma_f32_16x16x32_bf16 v[24:27], v[88:91], v[40:43], 0
    v_mfma_f32_16x16x32_bf16 v[28:31], v[88:91], v[60:63], 0
    v_mfma_f32_16x16x32_bf16 v[32:35], v[88:91], v[88:91], 0
    s_waitcnt lgkmcnt(3)
    v_mfma_f32_16x16x32_bf16 v[24:27], v[92:95], v[44:47], v[24:27]
    v_mfma_f32_16x16x32_bf16 v[28:31], v[92:95], v[64:67], v[28:31]
    v_mfma_f32_16x16x32_bf16 v[32:35], v[92:95], v[92:95], v[32:35]
    s_waitcnt lgkmcnt(2)
    v_mfma_f32_16x16x32_bf16 v[24:27], v[96:99], v[48:51], v[24:27]
    v_mfma_f32_16x16x32_bf16 v[28:31], v[96:99], v[68:71], v[28:31]
    v_mfma_f32_16x16x32_bf16 v[32:35], v[96:99], v[96:99], v[32:35]
    s_waitcnt lgkmcnt(1)
    v_mfma_f32_16x16x32_bf16 v[24:27], v[100:103], v[52:55], v[24:27]
    v_mfma_f32_16x16x32_bf16 v[28:31], v[100:103], v[72:75], v[28:31]
    v_mfma_f32_16x16x32_bf16 v[32:35], v[100:103], v[100:103], v[32:35]
    s_waitcnt lgkmcnt(0)
    v_mfma_f32_16x16x32_bf16 v[24:27], v[104:107], v[56:59], v[24:27]
    v_mfma_f32_16x16x32_bf16 v[28:31], v[104:107], v[76:79], v[28:31]
    v_mfma_f32_16x16x32_bf16 v[32:35], v[104:107], v[104:107], v[32:35]
    s_nop 5
    v_add_f32 v24, v24, v25
    v_add_f32 v26, v26, v27
    v_add_f32 v28, v28, v29
    v_add_f32 v30, v30, v31
    v_add_f32 v32, v32, v33
    v_add_f32 v34, v34, v35
    v_add_f32 v24, v24, v26
    v_add_f32 v28, v28, v30
    v_add_f32 v32, v32, v34
    s_nop 1
    v_permlane32_swap_b32 v24, v32
    v_permlane32_swap_b32 v28, v25
    v_add_f32 v24, v24, v32
    v_add_f32 v28, v28, v25
    s_nop 1
    v_permlane16_swap_b32 v24, v28
    v_add_f32 v24, v24, v28
    ds_write_b32 v81, v24
    s_cmp_eq_u32 s4, 0
    s_waitcnt lgkmcnt(0)
    s_barrier
    ds_read_b128 v[24:27], v83
    ds_read_b128 v[28:31], v85
    ds_read_b128 v[32:35], v82
    ds_read_b128 v[36:39], v82 offset:256
    s_cbranch_scc1 FCS
    s_waitcnt lgkmcnt(3)
    v_add_f32 v24, v24, v25
    v_add_f32 v26, v26, v27
    v_add_f32 v24, v24, v26
    s_waitcnt lgkmcnt(2)
    v_add_f32 v28, v28, v29
    v_add_f32_dpp v24, v24, v24 row_ror:8 row_mask:0xf bank_mask:0xf
    v_add_f32 v30, v30, v31
    v_add_f32 v28, v28, v30
    v_add_f32_dpp v24, v24, v24 row_ror:4 row_mask:0xf bank_mask:0xf
    s_waitcnt lgkmcnt(0)
    v_subrev_f32 v29, 0x44200000, v28
    v_add_f32_dpp v24, v24, v24 row_ror:2 row_mask:0xf bank_mask:0xf
    v_add_f32 v32, v32, v33
    v_mul_f32 v30, 0x3acccccd, v29
    v_add_f32_dpp v24, v24, v24 row_ror:1 row_mask:0xf bank_mask:0xf
    v_add_f32 v34, v34, v35
    v_sub_f32 v24, v24, v29
    v_add_f32 v32, v32, v34
    v_mul_f32 v24, 0x3acccccd, v24
    v_add_f32 v36, v36, v37
    v_fma_f32 v24, -v30, v30, v24
    v_add_f32 v38, v38, v39
    v_max_f32 v24, 0, v24
    v_fma_f32 v32, -v28, v22, v32
    v_add_f32 v24, 0x3727c5ac, v24
    v_add_f32 v36, v36, v38
    v_rsq_f32 v24, v24
    v_fma_f32 v36, -v28, v23, v36
    v_mul_f32 v33, 0xbfb8aa3b, v32
    v_mul_f32 v33, v33, v24
    v_mul_f32 v36, v36, v32
    v_exp_f32 v33, v33
    v_mul_f32 v36, v36, v24
    v_add_f32 v33, 1.0, v33
    v_mul_f32 v36, v36, v24
    v_rcp_f32 v33, v33
    s_nop 0
    v_mul_f32 v36, v36, v33
    s_nop 1
    v_mov_b32_dpp v28, v36 quad_perm:[0,0,0,0] row_mask:0xf bank_mask:0xf
    v_mov_b32_dpp v29, v36 quad_perm:[1,1,1,1] row_mask:0xf bank_mask:0xf
    v_mov_b32_dpp v30, v36 quad_perm:[2,2,2,2] row_mask:0xf bank_mask:0xf
    v_mov_b32_dpp v31, v36 quad_perm:[3,3,3,3] row_mask:0xf bank_mask:0xf
    v_cvt_pk_bf16_f32 v28, v28, v29
    v_cvt_pk_bf16_f32 v29, v30, v31
    v_cndmask_b32 v60, 0, v28, s[44:45]
    v_cndmask_b32 v61, 0, v29, s[44:45]
    v_cndmask_b32 v62, 0, v28, s[46:47]
    v_cndmask_b32 v63, 0, v29, s[46:47]
    v_cndmask_b32 v64, 0, v28, s[48:49]
    v_cndmask_b32 v65, 0, v29, s[48:49]
    v_mfma_f32_16x16x32_bf16 v[24:27], a[240:243], v[60:63], 0
    v_cndmask_b32 v66, 0, v28, s[50:51]
    v_cndmask_b32 v67, 0, v29, s[50:51]
    v_cndmask_b32 v68, 0, v28, s[52:53]
    v_cndmask_b32 v69, 0, v29, s[52:53]
    v_mfma_f32_16x16x32_bf16 v[24:27], a[244:247], v[64:67], v[24:27]
    v_cndmask_b32 v70, 0, v28, s[54:55]
    v_cndmask_b32 v71, 0, v29, s[54:55]
    v_cndmask_b32 v72, 0, v28, s[56:57]
    v_cndmask_b32 v73, 0, v29, s[56:57]
    v_mfma_f32_16x16x32_bf16 v[24:27], a[248:251], v[68:71], v[24:27]
    v_cndmask_b32 v74, 0, v28, s[58:59]
    v_cndmask_b32 v75, 0, v29, s[58:59]
    v_cndmask_b32 v76, 0, v28, s[60:61]
    v_cndmask_b32 v77, 0, v29, s[60:61]
    v_mfma_f32_16x16x32_bf16 v[24:27], v[108:111], v[72:75], v[24:27]
    v_cndmask_b32 v78, 0, v28, s[62:63]
    v_cndmask_b32 v79, 0, v29, s[62:63]
    s_nop 1
    v_mfma_f32_16x16x32_bf16 v[24:27], v[2:5], v[76:79], v[24:27]
    s_mov_b32 exec_lo, 0x3ff03ff
    s_mov_b32 exec_hi, 0x3ff03ff
    s_cmp_eq_u32 s75, 1
    s_cbranch_scc0 SLOW29
    s_nop 3
    buffer_store_dwordx4 v[24:27], v84, s[16:19], s78 offen
BACK29:
    s_mov_b64 exec, -1
NEXT:
    s_cmp_lg_u32 s74, 0
    s_cbranch_scc1 DONE
    s_mov_b32 s74, 688128
    s_add_u32 s3, s3, 688128
    s_add_u32 s80, s80, 688128
    s_add_u32 s81, s81, 688128
    s_branch LOOP
AGAIN27:
    s_add_u32 s76, s76, 1
    s_cmp_lt_u32 s76, 32768
    s_cbranch_scc1 POLL27
    s_branch POLLX27
AGAIN28:
    s_mov_b64 s[94:95], exec
    s_mov_b32 s76, 1
AG228:
    v_cmp_eq_u32 vcc, -1, v24
    s_nop 0
    s_mov_b64 exec, vcc
    s_cbranch_execz AG328_0
    buffer_load_dwordx4 v[24:27], v86, s[16:19], s77 offen sc1
AG328_0:
    s_mov_b64 exec, s[94:95]
    v_cmp_eq_u32 vcc, -1, v28
    s_nop 0
    s_mov_b64 exec, vcc
    s_cbranch_execz AG328_1
    buffer_load_dwordx4 v[28:31], v18, s[16:19], s77 offen sc1
AG328_1:
    s_mov_b64 exec, s[94:95]
    v_cmp_eq_u32 vcc, -1, v32
    s_nop 0
    s_mov_b64 exec, vcc
    s_cbranch_execz AG328_2
    buffer_load_dwordx4 v[32:35], v20, s[16:19], s77 offen sc1
AG328_2:
    s_mov_b64 exec, s[94:95]
    s_add_u32 s76, s76, 1
    s_cmp_ge_u32 s76, 32768
    s_waitcnt vmcnt(0)
    v_max3_u32 v36, v24, v28, v32
    v_cmp_eq_u32 vcc, -1, v36
    s_cbranch_vccz POLLX28
    s_cbranch_scc0 AG228
    s_branch POLLX28
DONE:
    s_endpgm
RDYLOOP:
    s_mov_b32 s76, 0
RDYL2:
    s_sleep 24
    global_load_dword v99, v98, s[64:65] sc1
    s_waitcnt vmcnt(0)
    v_sad_u8 v100, v99, 0, 0
    s_nop 1
    v_add_u32_dpp v100, v100, v100 quad_perm:[1,0,3,2] row_mask:0xf bank_mask:0xf
    s_nop 1
    v_add_u32_dpp v100, v100, v100 quad_perm:[2,3,0,1] row_mask:0xf bank_mask:0xf
    v_cmp_gt_u32 vcc, 32, v100
    s_mov_b32 vcc_hi, 0
    s_cmp_eq_u64 vcc, 0
    s_cbranch_scc1 RDYOK
    s_add_u32 s76, s76, 1
    s_cmp_lt_u32 s76, 32768
    s_cbranch_scc1 RDYL2
    s_branch RDYOK
SLOW1:
    buffer_store_dword v24, v10, s[16:19], s79 offen sc1
    s_branch BACK1
SLOW2:
    buffer_store_dword v24, v10, s[16:19], s3 offen sc1
    s_branch BACK2
SLOW3:
    buffer_store_dwordx4 v[28:31], v27, s[16:19], s77 offen sc1
    s_branch BACK3
SLOW4:
    buffer_store_dwordx4 v[24:27], v106, s[16:19], 0 offen sc1
    s_branch BACK4
SLOW5:
    buffer_store_dwordx4 v[24:27], v107, s[16:19], 0 offen sc1
    s_branch BACK5
SLOW6:
    buffer_store_dword v1, v1, s[16:19], s78 offen sc1
    s_branch BACK6
DMAF:
    v_lshrrev_b32 v38, 1, v0
    v_mul_u32_u24 v38, 3072, v38
    v_and_b32 v39, 1, v0
    v_lshl_add_u32 v38, v39, 4, v38
    s_mul_i32 s79, s68, 12
    s_add_u32 s79, s79, s69
    s_sub_u32 s79, s79, 20
    s_mul_i32 s77, s72, 491520
    s_lshl_b32 s78, s79, 5
    s_add_u32 s77, s77, s78
    s_mul_i32 s78, s72, 5120
    s_add_u32 m0, s78, 57344
    s_nop 0
    buffer_load_dwordx4 v38, s[24:27], s77 offen  lds
    s_add_u32 m0, s78, 77824
    s_nop 0
    buffer_load_dwordx4 v38, s[28:31], s77 offen  lds
    s_add_u32 s77, s77, 98304
    s_add_u32 m0, s78, 58368
    s_nop 0
    buffer_load_dwordx4 v38, s[24:27], s77 offen  lds
    s_add_u32 m0, s78, 78848
    s_nop 0
    buffer_load_dwordx4 v38, s[28:31], s77 offen  lds
    s_add_u32 s77, s77, 98304
    s_add_u32 m0, s78, 59392
    s_nop 0
    buffer_load_dwordx4 v38, s[24:27], s77 offen  lds
    s_add_u32 m0, s78, 79872
    s_nop 0
    buffer_load_dwordx4 v38, s[28:31], s77 offen  lds
    s_add_u32 s77, s77, 98304
    s_add_u32 m0, s78, 60416
    s_nop 0
    buffer_load_dwordx4 v38, s[24:27], s77 offen  lds
    s_add_u32 m0, s78, 80896
    s_nop 0
    buffer_load_dwordx4 v38, s[28:31], s77 offen  lds
    s_add_u32 s77, s77, 98304
    s_add_u32 m0, s78, 61440
    s_nop 0
    buffer_load_dwordx4 v38, s[24:27], s77 offen  lds
    s_add_u32 m0, s78, 81920
    s_nop 0
    buffer_load_dwordx4 v38, s[28:31], s77 offen  lds
    s_branch DMAX
RETRY7:
    s_mov_b32 s76, 1
POLL30:
    buffer_load_dword v99, v98, s[16:19], s4 offen sc1
POLLW30:
    s_waitcnt vmcnt(0)
    v_cmp_eq_u32 vcc, -1, v99
    s_cbranch_vccnz AGAIN30
POLLX30:
    s_branch OK7
AGAIN30:
    s_add_u32 s76, s76, 1
    s_cmp_lt_u32 s76, 32768
    s_cbranch_scc1 POLL30
    s_branch POLLX30
SLOW10:
    buffer_store_dword v24, v10, s[16:19], s3 offen sc1
    s_branch BACK10
SLOW12:
    buffer_store_dwordx4 v[28:31], v39, s[16:19], s77 offen sc1
    s_branch BACK12
SLOW13:
    buffer_store_dwordx2 v[32:33], v39, s[16:19], s78 offen sc1
    s_branch BACK13
RETRY14:
    s_mov_b32 s76, 1
POLL31:
    buffer_load_dword v28, v20, s[16:19], 0 offen sc1
    buffer_load_dword v29, v21, s[16:19], 0 offen sc1
POLLW31:
    s_waitcnt vmcnt(0)
    v_max_u32 v30, v28, v29
    v_cmp_eq_u32 vcc, -1, v30
    s_cbranch_vccnz AGAIN31
POLLX31:
    s_branch OK14
AGAIN31:
    s_add_u32 s76, s76, 1
    s_cmp_lt_u32 s76, 32768
    s_cbranch_scc1 POLL31
    s_branch POLLX31
SLOW15:
    buffer_store_dwordx4 v[28:31], v37, s[16:19], s77 offen sc1
    s_branch BACK15
SLOW17:
    buffer_store_dwordx4 v[28:31], v18, s[16:19], s81 offen sc1
    s_branch BACK17
SLOW18:
    buffer_store_dwordx4 v[52:55], v48, s[16:19], s78 offen sc1
    s_branch BACK18
SLOW19:
    buffer_store_dwordx4 v[52:55], v49, s[16:19], s78 offen sc1
    s_branch BACK19
SLOW20:
    buffer_store_dwordx4 v[52:55], v50, s[16:19], s78 offen sc1
    s_branch BACK20
SLOW22:
    buffer_store_dwordx4 v[28:31], v39, s[16:19], s97 offen sc1
    s_branch BACK22
SLOW24:
    buffer_store_dwordx4 v[28:31], v37, s[16:19], s77 offen sc1
    s_branch BACK24
FW2:
    s_mul_i32 s79, s68, 12
    s_add_u32 s79, s79, s69
    s_sub_u32 s79, s79, 20
    s_mul_i32 s97, s72, 5120
    s_mul_i32 s96, s79, 20480
    s_add_u32 s96, s96, s97
    s_add_u32 m0, s97, 98304
    s_nop 0
    buffer_load_dwordx4 v1, s[32:35], s96 offen nt lds
    s_add_u32 s96, s96, 1024
    s_add_u32 m0, s97, 99328
    s_nop 0
    buffer_load_dwordx4 v1, s[32:35], s96 offen nt lds
    s_add_u32 s96, s96, 1024
    s_add_u32 m0, s97, 100352
    s_nop 0
    buffer_load_dwordx4 v1, s[32:35], s96 offen nt lds
    s_add_u32 s96, s96, 1024
    s_add_u32 m0, s97, 101376
    s_nop 0
    buffer_load_dwordx4 v1, s[32:35], s96 offen nt lds
    s_add_u32 s96, s96, 1024
    s_add_u32 m0, s97, 102400
    s_nop 0
    buffer_load_dwordx4 v1, s[32:35], s96 offen nt lds
    s_sub_u32 s96, s69, 20
    s_lshl_b32 s96, s96, 2
    s_add_u32 s96, s96, s72
    s_mul_i32 s96, s96, 688
    v_add_u32 v21, s96, v1
    v_min_u32 v21, 32752, v21
    s_add_u32 s97, s3, 688128
    buffer_load_dwordx4 a[240:243], v21, s[16:19], s97 offen sc1
    s_branch FMM
SLOW29:
    s_nop 3
    buffer_store_dwordx4 v[24:27], v84, s[16:19], s78 offen sc1
    s_branch BACK29
FCS:
    s_waitcnt lgkmcnt(0)
    v_add_f32 v32, v32, v33
    v_add_f32 v34, v34, v35
    v_add_f32 v32, v32, v34
    v_add_f32 v36, v36, v37
    v_add_f32 v38, v38, v39
    v_add_f32 v36, v36, v38
    v_mul_f32 v22, 0x3acccccd, v32
    v_mul_f32 v23, 0x3acccccd, v36
    s_mov_b32 s4, 1
    s_waitcnt vmcnt(0)
    v_mov_b32 v24, -1
    v_mov_b32 v25, -1
    v_mov_b32 v26, -1
    v_mov_b32 v27, -1
    s_cmp_eq_u32 s75, 1
    s_cbranch_scc0 SLOW32
    buffer_store_dwordx4 v[24:27], v21, s[16:19], s97 offen
BACK32:
    s_barrier
    s_branch FPOLL
SLOW32:
    buffer_store_dwordx4 v[24:27], v21, s[16:19], s97 offen sc1
    s_branch BACK32
CODE_END:
    s_endpgm
.section .rodata,"a"
.p2align 6
.amdhsa_kernel interleave_layers__sliding_block_cached__glu_gated_swiglu__decode_kernel
  .amdhsa_next_free_vgpr 512
  .amdhsa_next_free_sgpr 102
  .amdhsa_accum_offset 256
  .amdhsa_group_segment_fixed_size 0
  .amdhsa_kernarg_size 96
  .amdhsa_user_sgpr_count 2
  .amdhsa_user_sgpr_kernarg_segment_ptr 1
  .amdhsa_system_sgpr_workgroup_id_x 1
.end_amdhsa_kernel
```

```asm
; @launch grid=(256,1,1) block=(256,1,1) lds=125568
.amdgcn_target "amdgcn-amd-amdhsa--gfx950"
.text
.globl interleave_layers__sliding_block_cached__glu_gated_swiglu__decode_kernel
.p2align 8
.type interleave_layers__sliding_block_cached__glu_gated_swiglu__decode_kernel,@function
interleave_layers__sliding_block_cached__glu_gated_swiglu__decode_kernel:
    s_load_dwordx16 s[44:59], s[0:1], 0
    s_load_dwordx8 s[60:67], s[0:1], 64
    s_cmp_ge_u32 s2, 256
    s_cbranch_scc1 CODE_END
    v_lshrrev_b32 v2, 6, v0
    v_and_b32 v24, 63, v0
    v_readfirstlane_b32 s72, v2
    s_and_b32 s68, s2, 7
    s_lshr_b32 s69, s2, 3
    s_lshr_b32 s70, s69, 3
    s_and_b32 s71, s69, 7
    v_lshlrev_b32 v1, 4, v24
    s_lshl_b32 s77, s70, 3
    s_add_u32 s77, s77, s68
    s_mul_i32 s73, s77, 12582912
    s_lshl_b32 s78, s71, 2
    s_add_u32 s78, s78, s72
    s_mul_i32 s78, s78, 6144
    s_add_u32 s73, s73, s78
    s_add_u32 s73, s73, 11010048
    v_add_u32 v23, 4096, v1
    s_mov_b32 s10, 402653184
    s_mov_b32 s11, 0x20000
    s_getpc_b64 s[100:101]
PCREF:
    s_sub_u32 s100, s100, PCREF-interleave_layers__sliding_block_cached__glu_gated_swiglu__decode_kernel
    s_subb_u32 s101, s101, 0
    s_lshl_b32 s78, s71, 12
    v_lshl_add_u32 v25, v0, 4, s78
    v_cmp_gt_u32 vcc, CODE_END-interleave_layers__sliding_block_cached__glu_gated_swiglu__decode_kernel-16, v25
    s_nop 0
    s_and_saveexec_b64 s[98:99], vcc
    s_cbranch_execz NOCPF
    global_load_dwordx4 a[240:243], v25, s[100:101]
NOCPF:
    s_mov_b64 exec, -1
    s_mul_i32 s79, s77, 384
    s_mov_b32 s74, 0
    s_mul_i32 s3, s68, 81920
    s_mov_b32 s75, 0
    v_mov_b32 v32, -1
    v_mov_b32 v33, -1
    v_mov_b32 v34, -1
    v_mov_b32 v35, -1
    s_mul_i32 s77, s69, 576
    s_add_u32 s77, s77, s3
    s_add_u32 s77, s77, 32768
    v_add_u32 v20, s77, v1
    s_mul_i32 s77, s2, 80
    s_add_u32 s77, s77, 654784
    v_add_u32 v25, s77, v1
    v_cmp_le_u32 vcc, 36, v0
    s_nop 1
    v_cndmask_b32 v21, v20, v25, vcc
    v_mov_b32 v25, 2147483632
    v_cndmask_b32 v20, v20, v25, vcc
    v_cmp_le_u32 vcc, 41, v0
    s_nop 1
    v_cndmask_b32 v21, v21, v25, vcc
    s_mov_b32 s18, 1610612736
    s_mov_b32 s19, 0x20000
    s_waitcnt lgkmcnt(0)
    s_mov_b32 s8, s46
    s_and_b32 s9, s47, 0xffff
    s_mov_b32 s16, s66
    s_and_b32 s17, s67, 0xffff
    buffer_store_dwordx4 v[32:35], v21, s[16:19], 0 offen sc1
    buffer_load_dwordx4 a[0:3], v1, s[8:11], s73 offen offset:0 nt
    buffer_load_dwordx4 a[4:7], v1, s[8:11], s73 offen offset:1024 nt
    s_add_u32 s83, s73, 196608
    s_mov_b32 s12, s48
    s_and_b32 s13, s49, 0xffff
    s_mov_b32 s14, 402653184
    s_mov_b32 s15, 0x20000
    s_mov_b32 s20, s50
    s_and_b32 s21, s51, 0xffff
    s_mov_b32 s22, 7864320
    s_mov_b32 s23, 0x20000
    s_mov_b32 s36, s44
    s_and_b32 s37, s45, 0xffff
    s_mov_b32 s38, 1280
    s_mov_b32 s39, 0x20000
    s_mov_b32 s40, s62
    s_and_b32 s41, s63, 0xffff
    s_mov_b32 s42, 1280
    s_mov_b32 s43, 0x20000
    s_mov_b32 s28, s58
    s_and_b32 s29, s59, 0xffff
    s_mov_b32 s30, 1966080
    s_mov_b32 s31, 0x20000
    s_mov_b32 s32, s60
    s_and_b32 s33, s61, 0xffff
    s_mov_b32 s34, 1966080
    s_mov_b32 s35, 0x20000
    s_cmp_lt_u32 s69, 20
    s_cselect_b32 s24, s52, s56
    s_cselect_b32 s25, s53, s57
    s_cselect_b32 s26, s22, s30
    s_and_b32 s25, s25, 0xffff
    s_mov_b32 s27, 0x20000
    s_add_u32 s84, s83, 196608
    s_add_u32 s85, s84, 196608
    s_add_u32 s86, s85, 196608
    s_add_u32 s87, s86, 196608
    s_add_u32 s88, s87, 196608
    s_add_u32 s89, s88, 196608
    v_mov_b32 v0, v24
    s_mul_i32 s77, s72, 6656
    v_add_u32 v25, 0, v0
    v_mul_u32_u24 v26, 171, v25
    v_lshrrev_b32 v26, 12, v26
    v_mul_u32_u24 v27, 24, v26
    v_sub_u32 v27, v25, v27
    v_lshlrev_b32 v27, 4, v27
    v_mul_u32_u24 v25, 416, v26
    v_add3_u32 v2, v25, v27, s77
    v_mul_u32_u24 v25, 12288, v26
    v_add_u32 v40, v25, v27
    v_mul_u32_u24 v25, 3072, v26
    v_add_u32 v101, v25, v27
    v_add_u32 v25, 64, v0
    v_mul_u32_u24 v26, 171, v25
    v_lshrrev_b32 v26, 12, v26
    v_mul_u32_u24 v27, 24, v26
    v_sub_u32 v27, v25, v27
    v_lshlrev_b32 v27, 4, v27
    v_mul_u32_u24 v25, 416, v26
    v_add3_u32 v3, v25, v27, s77
    v_mul_u32_u24 v25, 12288, v26
    v_add_u32 v41, v25, v27
    v_mul_u32_u24 v25, 3072, v26
    v_add_u32 v102, v25, v27
    v_add_u32 v25, 128, v0
    v_mul_u32_u24 v26, 171, v25
    v_lshrrev_b32 v26, 12, v26
    v_mul_u32_u24 v27, 24, v26
    v_sub_u32 v27, v25, v27
    v_lshlrev_b32 v27, 4, v27
    v_mul_u32_u24 v25, 416, v26
    v_add3_u32 v4, v25, v27, s77
    v_mul_u32_u24 v25, 12288, v26
    v_add_u32 v42, v25, v27
    v_mul_u32_u24 v25, 3072, v26
    v_add_u32 v103, v25, v27
    s_mul_i32 s78, s71, 983040
    s_add_u32 s79, s79, s78
    s_mul_i32 s78, s72, 98304
    s_add_u32 s79, s79, s78
    s_mul_i32 s78, s72, 3072
    s_add_u32 s78, s78, 26624
    s_add_u32 m0, s78, 0
    s_nop 0
    buffer_load_dwordx4 v40, s[20:23], s79 offen nt lds
    s_add_u32 m0, s78, 1024
    s_nop 0
    buffer_load_dwordx4 v41, s[20:23], s79 offen nt lds
    s_add_u32 m0, s78, 2048
    s_nop 0
    buffer_load_dwordx4 v42, s[20:23], s79 offen nt lds
    s_add_u32 s79, s79, 393216
    s_add_u32 m0, s78, 12288
    s_nop 0
    buffer_load_dwordx4 v40, s[20:23], s79 offen nt lds
    s_add_u32 m0, s78, 13312
    s_nop 0
    buffer_load_dwordx4 v41, s[20:23], s79 offen nt lds
    s_add_u32 m0, s78, 14336
    s_nop 0
    buffer_load_dwordx4 v42, s[20:23], s79 offen nt lds
    s_add_u32 s79, s79, 393216
    s_cmp_ge_u32 s72, 2
    s_cbranch_scc1 NOWQ3
    s_add_u32 m0, s78, 24576
    s_nop 0
    buffer_load_dwordx4 v40, s[20:23], s79 offen nt lds
    s_add_u32 m0, s78, 25600
    s_nop 0
    buffer_load_dwordx4 v41, s[20:23], s79 offen nt lds
    s_add_u32 m0, s78, 26624
    s_nop 0
    buffer_load_dwordx4 v42, s[20:23], s79 offen nt lds
NOWQ3:
    v_and_b32 v25, 15, v0
    v_lshrrev_b32 v26, 4, v0
    v_bfe_u32 v27, v0, 2, 2
    v_and_b32 v28, 3, v0
    v_cmp_eq_u32 vcc, 12, v25
    v_mov_b32 v36, 0x3f803f80
    s_nop 0
    v_cndmask_b32 v70, 0, v36, vcc
    v_mov_b32 v71, v70
    v_mov_b32 v72, v70
    v_mov_b32 v73, v70
    v_mov_b32 v74, v70
    v_mov_b32 v75, v70
    v_mov_b32 v76, v70
    v_mov_b32 v77, v70
    v_mov_b32 v78, v70
    v_mov_b32 v79, v70
    v_mov_b32 v88, v70
    v_mov_b32 v89, v70
    v_mov_b32 v90, v70
    v_mov_b32 v91, v70
    v_mov_b32 v92, v70
    v_mov_b32 v93, v70
    v_mov_b32 v94, v70
    v_mov_b32 v95, v70
    v_mov_b32 v96, v70
    v_mov_b32 v97, v70
    s_mul_i32 s78, s71, 160
    v_lshlrev_b32 v36, 4, v26
    v_lshlrev_b32 v37, 3, v26
    s_mov_b32 exec_lo, 0x1000100
    s_mov_b32 exec_hi, 0x1000100
    buffer_load_dwordx4 v[88:91], v36, s[36:39], s78 offen
    buffer_load_dwordx4 v[92:95], v36, s[36:39], s78 offen offset:64
    buffer_load_dwordx2 v[96:97], v37, s[36:39], s78 offen offset:128
    s_mov_b64 exec, -1
    s_lshl_b32 s79, s69, 6
    v_lshlrev_b32 v38, 2, v25
    buffer_load_dword v22, v38, s[36:39], s79 offen
    s_mov_b32 s20, s52
    s_and_b32 s21, s53, 0xffff
    s_mov_b32 s22, 7864320
    s_mov_b32 s23, 0x20000
    s_cmp_lt_u32 s72, 2
    s_cselect_b32 s36, s56, s58
    s_cselect_b32 s37, s57, s59
    s_and_b32 s37, s37, 0xffff
    s_mov_b32 s38, 1966080
    s_lshl_b32 s90, s70, 3
    s_add_u32 s90, s90, s68
    s_lshl_b32 s90, s90, 3
    s_add_u32 s90, s90, s71
    s_mul_i32 s90, s90, 30720
    s_mul_i32 s79, s72, 6144
    s_add_u32 s90, s90, s79
    s_cmp_eq_u32 s72, 3
    s_cselect_b32 s79, 3072, 0
    s_add_u32 s90, s90, s79
    s_cmp_lt_u32 s72, 2
    s_cselect_b32 s79, 1879048176, 0
    v_add_u32 v108, s79, v23
    v_add_u32 v109, 4096, v108
    s_and_b32 s91, s72, 1
    s_lshl_b32 s79, s69, 1
    s_add_u32 s91, s91, s79
    s_mul_i32 s79, s91, 0
    s_add_u32 s79, s79, 640
    s_mul_i32 s91, s91, 16
    s_cmp_lt_u32 s69, 20
    s_cselect_b32 s91, s91, s79
    s_mov_b32 s7, 49152
    s_cselect_b32 s7, s7, 0
    s_mul_i32 s91, s91, 3072
    s_mul_i32 s79, s68, 384
    s_add_u32 s91, s91, s79
    v_mov_b32 v29, 1879048176
    v_add_u32 v104, 24576, v101
    v_add_u32 v105, 24576, v102
    v_add_u32 v106, 24576, v103
    v_cmp_gt_u32 vcc, s7, v101
    s_nop 1
    v_cndmask_b32 v101, v29, v101, vcc
    v_cmp_gt_u32 vcc, s7, v102
    s_nop 1
    v_cndmask_b32 v102, v29, v102, vcc
    v_cmp_gt_u32 vcc, s7, v103
    s_nop 1
    v_cndmask_b32 v103, v29, v103, vcc
    v_cmp_gt_u32 vcc, s7, v104
    s_nop 1
    v_cndmask_b32 v104, v29, v104, vcc
    v_cmp_gt_u32 vcc, s7, v105
    s_nop 1
    v_cndmask_b32 v105, v29, v105, vcc
    v_cmp_gt_u32 vcc, s7, v106
    s_nop 1
    v_cndmask_b32 v106, v29, v106, vcc
    buffer_load_dwordx4 a[8:11], v1, s[8:11], s73 offen offset:2048 nt
    buffer_load_dwordx4 a[12:15], v1, s[8:11], s73 offen offset:3072 nt
    buffer_load_dwordx4 a[16:19], v23, s[8:11], s73 offen offset:0 nt
    v_mul_u32_u24 v29, 416, v25
    v_lshl_add_u32 v29, v26, 4, v29
    v_add_u32 v5, s77, v29
    v_lshrrev_b32 v29, 2, v0
    v_mul_u32_u24 v29, 416, v29
    v_lshl_add_u32 v29, v28, 3, v29
    v_add_u32 v6, s77, v29
    s_mul_i32 s79, s72, 96
    s_add_u32 s79, s79, 26624
    v_lshl_add_u32 v29, v26, 3, v27
    v_mul_u32_u24 v29, 384, v29
    v_lshl_add_u32 v29, v28, 3, v29
    v_add_u32 v16, s79, v29
    v_lshl_add_u32 v29, v26, 2, v27
    v_mul_u32_u24 v29, 384, v29
    v_lshl_add_u32 v29, v28, 3, v29
    v_add_u32 v17, s79, v29
    buffer_load_dwordx4 a[20:23], v23, s[8:11], s73 offen offset:1024 nt
    v_mul_u32_u24 v31, 103, v0
    v_lshrrev_b32 v31, 10, v31
    v_mul_u32_u24 v30, 10, v31
    v_sub_u32 v30, v0, v30
    v_lshl_add_u32 v29, v30, 4, s78
    v_mul_u32_u24 v8, 1280, v31
    v_add_u32 v8, 665600, v8
    s_mul_i32 s7, s68, 81920
    s_add_u32 s7, s7, 47360
    v_mov_b32 v30, s7
    v_cmp_eq_u32 vcc, s68, v31
    s_nop 1
    v_cndmask_b32 v8, v8, v30, vcc
    v_add_u32 v30, 2560, v30
    v_cmp_le_u32 vcc, 8, v31
    s_nop 1
    v_cndmask_b32 v8, v8, v30, vcc
    v_add_u32 v8, v8, v29
    v_add_u32 v31, 6, v31
    v_mul_u32_u24 v9, 1280, v31
    v_add_u32 v9, 665600, v9
    s_mul_i32 s7, s68, 81920
    s_add_u32 s7, s7, 47360
    v_mov_b32 v30, s7
    v_cmp_eq_u32 vcc, s68, v31
    s_nop 1
    v_cndmask_b32 v9, v9, v30, vcc
    v_add_u32 v30, 2560, v30
    v_cmp_le_u32 vcc, 8, v31
    s_nop 1
    v_cndmask_b32 v9, v9, v30, vcc
    v_add_u32 v9, v9, v29
    v_mov_b32 v30, 2147483632
    v_cmp_le_u32 vcc, 30, v0
    s_nop 1
    v_cndmask_b32 v9, v9, v30, vcc
    s_lshl_b32 s78, s69, 10
    s_lshl_b32 s79, s72, 8
    s_add_u32 s78, s78, s79
    v_lshl_add_u32 v10, v0, 2, s78
    s_lshl_b32 s78, s70, 13
    s_add_u32 s78, s78, s79
    v_lshlrev_b32 v29, 10, v26
    v_lshl_add_u32 v29, v25, 4, v29
    v_add_u32 v11, s78, v29
    buffer_load_dwordx4 a[24:27], v1, s[8:11], s83 offen offset:0 nt
    s_mul_i32 s78, s72, 96
    s_add_u32 s78, s78, 118784
    v_lshl_add_u32 v29, v27, 5, s78
    v_lshl_add_u32 v29, v28, 2, v29
    v_lshrrev_b32 v30, 1, v26
    v_lshl_add_u32 v29, v30, 4, v29
    v_and_b32 v30, 1, v26
    v_lshl_add_u32 v29, v30, 1, v29
    v_mov_b32 v30, 119168
    v_cmp_le_u32 vcc, 12, v25
    s_nop 1
    v_cndmask_b32 v12, v29, v30, vcc
    v_and_b32 v30, 1, v0
    v_lshlrev_b32 v29, 5, v26
    v_lshl_add_u32 v29, v30, 4, v29
    v_add_u32 v13, 118784, v29
    v_mul_u32_u24 v30, 0xaaaa, v30
    v_and_b32 v29, 1, v27
    v_mul_u32_u24 v29, 0xaaaa, v29
    v_lshl_or_b32 v29, v29, 16, v30
    v_add_u32 v14, 0x44444444, v29
    buffer_load_dwordx4 a[28:31], v1, s[8:11], s83 offen offset:1024 nt
    s_lshl_b32 s78, s72, 8
    s_add_u32 s78, s78, 124416
    v_lshrrev_b32 v29, 5, v0
    v_lshl_add_u32 v29, v29, 6, s78
    v_bfe_u32 v30, v0, 3, 1
    v_lshl_add_u32 v29, v30, 5, v29
    v_bfe_u32 v30, v0, 1, 1
    v_lshl_add_u32 v29, v30, 4, v29
    v_bfe_u32 v30, v0, 2, 1
    v_lshl_add_u32 v29, v30, 3, v29
    v_bfe_u32 v30, v0, 4, 1
    v_lshl_add_u32 v29, v30, 2, v29
    v_bfe_u32 v30, v0, 0, 1
    v_lshl_add_u32 v29, v30, 1, v29
    v_mov_b32 v19, v29
    s_mul_i32 s78, s72, 768
    s_add_u32 s78, s78, 119296
    v_lshl_add_u32 v29, v25, 2, s78
    v_bfe_u32 v30, v0, 4, 1
    v_lshl_add_u32 v29, v30, 7, v29
    v_lshrrev_b32 v30, 5, v0
    v_lshl_add_u32 v15, v30, 6, v29
    s_mov_b32 s44, 0x10001
    s_mov_b32 s45, 0x10001
    s_mov_b32 s46, 0x20002
    s_mov_b32 s47, 0x20002
    s_mov_b32 s48, 0x40004
    s_mov_b32 s49, 0x40004
    s_mov_b32 s50, 0x80008
    s_mov_b32 s51, 0x80008
    s_mov_b32 s52, 0x100010
    s_mov_b32 s53, 0x100010
    s_mov_b32 s54, 0x200020
    s_mov_b32 s55, 0x200020
    s_mov_b32 s56, 0x400040
    s_mov_b32 s57, 0x400040
    s_mov_b32 s58, 0x800080
    s_mov_b32 s59, 0x800080
    s_mov_b32 s60, 0x1000100
    s_mov_b32 s61, 0x1000100
    s_mov_b32 s62, 0x2000200
    s_mov_b32 s63, 0x2000200
    s_waitcnt vmcnt(6)
    s_barrier
    ds_read_b64_tr_b16 v[40:41], v16 offset:0
    ds_read_b64_tr_b16 v[42:43], v16 offset:1536
    ds_read_b64_tr_b16 v[44:45], v16 offset:12288
    ds_read_b64_tr_b16 v[46:47], v16 offset:13824
    ds_read_b64_tr_b16 v[48:49], v17 offset:24576
    ds_read_b64_tr_b16 v[50:51], v16 offset:32
    ds_read_b64_tr_b16 v[52:53], v16 offset:1568
    ds_read_b64_tr_b16 v[54:55], v16 offset:12320
    ds_read_b64_tr_b16 v[56:57], v16 offset:13856
    ds_read_b64_tr_b16 v[58:59], v17 offset:24608
    ds_read_b64_tr_b16 v[60:61], v16 offset:64
    ds_read_b64_tr_b16 v[62:63], v16 offset:1600
    ds_read_b64_tr_b16 v[64:65], v16 offset:12352
    ds_read_b64_tr_b16 v[66:67], v16 offset:13888
    ds_read_b64_tr_b16 v[68:69], v17 offset:24640
    buffer_load_dwordx4 a[32:35], v1, s[8:11], s83 offen offset:2048 nt
    buffer_load_dwordx4 a[36:39], v1, s[8:11], s83 offen offset:3072 nt
    s_waitcnt lgkmcnt(0)
    s_add_u32 s79, s3, 1376256
    v_mfma_f32_16x16x32_bf16 v[24:27], v[70:73], v[40:43], 0
    v_mfma_f32_16x16x32_bf16 v[32:35], v[70:73], v[60:63], 0
    v_mfma_f32_16x16x32_bf16 v[24:27], v[74:77], v[44:47], v[24:27]
    v_mfma_f32_16x16x32_bf16 v[32:35], v[74:77], v[64:67], v[32:35]
    v_mfma_f32_16x16x16_bf16 v[24:27], v[78:79], v[48:49], v[24:27]
    v_mfma_f32_16x16x16_bf16 v[32:35], v[78:79], v[68:69], v[32:35]
    v_mfma_f32_16x16x32_bf16 v[28:31], v[70:73], v[50:53], 0
    v_mfma_f32_16x16x32_bf16 v[36:39], v[70:73], v[70:73], 0
    v_mfma_f32_16x16x32_bf16 v[28:31], v[74:77], v[54:57], v[28:31]
    v_mfma_f32_16x16x32_bf16 v[36:39], v[74:77], v[74:77], v[36:39]
    v_mfma_f32_16x16x16_bf16 v[28:31], v[78:79], v[58:59], v[28:31]
    v_mfma_f32_16x16x16_bf16 v[36:39], v[78:79], v[78:79], v[36:39]
    buffer_load_dwordx4 a[40:43], v23, s[8:11], s83 offen offset:0 nt
    v_add_f32 v24, v24, v25
    v_add_f32 v26, v26, v27
    v_add_f32 v24, v24, v26
    v_add_f32 v32, v32, v33
    v_add_f32 v34, v34, v35
    v_add_f32 v32, v32, v34
    s_nop 1
    v_permlane32_swap_b32 v24, v32
    v_add_f32 v28, v28, v29
    v_add_f32 v30, v30, v31
    v_add_f32 v36, v36, v37
    v_add_f32 v38, v38, v39
    v_add_f32 v24, v24, v32
    v_add_f32 v28, v28, v30
    v_add_f32 v36, v36, v38
    s_nop 1
    v_permlane32_swap_b32 v28, v36
    v_add_f32 v28, v28, v36
    s_nop 1
    v_permlane16_swap_b32 v24, v28
    v_add_f32 v24, v24, v28
    s_nop 1
    v_mov_b32_dpp v25, v24 quad_perm:[1,1,1,1] row_mask:0xf bank_mask:0xf
    v_mov_b32_dpp v26, v24 quad_perm:[2,2,2,2] row_mask:0xf bank_mask:0xf
    v_mov_b32_dpp v27, v24 quad_perm:[3,3,3,3] row_mask:0xf bank_mask:0xf
    s_mov_b32 exec_lo, 0x11111111
    s_mov_b32 exec_hi, 0x11111111
    buffer_store_dwordx4 v[24:27], v10, s[16:19], s79 offen sc1
    s_mov_b64 exec, -1
    buffer_load_dwordx4 a[44:47], v23, s[8:11], s83 offen offset:1024 nt
    v_mfma_f32_16x16x32_bf16 v[24:27], v[88:91], v[40:43], 0
    v_mfma_f32_16x16x32_bf16 v[32:35], v[88:91], v[60:63], 0
    v_mfma_f32_16x16x32_bf16 v[24:27], v[92:95], v[44:47], v[24:27]
    v_mfma_f32_16x16x32_bf16 v[32:35], v[92:95], v[64:67], v[32:35]
    v_mfma_f32_16x16x16_bf16 v[24:27], v[96:97], v[48:49], v[24:27]
    v_mfma_f32_16x16x16_bf16 v[32:35], v[96:97], v[68:69], v[32:35]
    v_mfma_f32_16x16x32_bf16 v[28:31], v[88:91], v[50:53], 0
    v_mfma_f32_16x16x32_bf16 v[36:39], v[88:91], v[88:91], 0
    v_mfma_f32_16x16x32_bf16 v[28:31], v[92:95], v[54:57], v[28:31]
    v_mfma_f32_16x16x32_bf16 v[36:39], v[92:95], v[92:95], v[36:39]
    v_mfma_f32_16x16x16_bf16 v[28:31], v[96:97], v[58:59], v[28:31]
    v_mfma_f32_16x16x16_bf16 v[36:39], v[96:97], v[96:97], v[36:39]
    buffer_load_dwordx4 a[48:51], v1, s[8:11], s84 offen offset:0 nt
    v_add_f32 v24, v24, v25
    v_add_f32 v26, v26, v27
    v_add_f32 v24, v24, v26
    v_add_f32 v32, v32, v33
    v_add_f32 v34, v34, v35
    v_add_f32 v32, v32, v34
    s_nop 1
    v_permlane32_swap_b32 v24, v32
    v_add_f32 v28, v28, v29
    v_add_f32 v30, v30, v31
    v_add_f32 v36, v36, v37
    v_add_f32 v38, v38, v39
    v_add_f32 v24, v24, v32
    v_add_f32 v28, v28, v30
    v_add_f32 v36, v36, v38
    s_nop 1
    v_permlane32_swap_b32 v28, v36
    v_add_f32 v28, v28, v36
    s_nop 1
    v_permlane16_swap_b32 v24, v28
    v_add_f32 v24, v24, v28
    s_nop 1
    v_mov_b32_dpp v25, v24 quad_perm:[1,1,1,1] row_mask:0xf bank_mask:0xf
    v_mov_b32_dpp v26, v24 quad_perm:[2,2,2,2] row_mask:0xf bank_mask:0xf
    v_mov_b32_dpp v27, v24 quad_perm:[3,3,3,3] row_mask:0xf bank_mask:0xf
    s_mov_b32 exec_lo, 0x11111111
    s_mov_b32 exec_hi, 0x11111111
    buffer_store_dwordx4 v[24:27], v10, s[16:19], s3 offen sc1
    s_mov_b64 exec, -1
    buffer_load_dwordx4 a[52:55], v1, s[8:11], s84 offen offset:1024 nt
    buffer_load_dwordx4 a[56:59], v1, s[8:11], s84 offen offset:2048 nt
    buffer_load_dwordx4 a[60:63], v1, s[8:11], s84 offen offset:3072 nt
    s_waitcnt vmcnt(12)
    ds_write_b128 v2, a[0:3] offset:0
    ds_write_b128 v3, a[4:7] offset:0
    ds_write_b128 v4, a[8:11] offset:0
    ds_write_b128 v2, a[12:15] offset:3328
    ds_write_b128 v3, a[16:19] offset:3328
    ds_write_b128 v4, a[20:23] offset:3328
    ds_read_b128 a[0:3], v5 offset:0
    ds_read_b128 a[4:7], v5 offset:64
    ds_read_b128 a[8:11], v5 offset:128
    ds_read_b128 a[12:15], v5 offset:192
    ds_read_b128 a[16:19], v5 offset:256
    ds_read_b128 a[20:23], v5 offset:320
    buffer_load_dwordx4 a[64:67], v23, s[8:11], s84 offen offset:0 nt
    buffer_load_dwordx4 a[68:71], v23, s[8:11], s84 offen offset:1024 nt
    s_barrier
    buffer_load_dwordx4 a[72:75], v1, s[8:11], s85 offen offset:0 nt
    s_waitcnt vmcnt(6)
    s_barrier
    s_getreg_b32 s5, hwreg(HW_REG_XCC_ID, 0, 4)
    s_lshr_b32 s92, s5, 2
    s_lshl_b32 s93, s68, 2
    s_add_u32 s92, s92, s93
    s_and_b32 s93, s5, 3
    s_lshl_b32 s93, s93, 3
    s_lshl_b32 s94, 1, s93
    s_lshl_b32 s96, 32, s93
    s_mov_b32 s5, s92
    s_cmp_lg_u32 s72, 0
    s_cbranch_scc1 NOATOM
    s_lshl_b32 s92, s92, 2
    v_mov_b32 v36, s92
    v_mov_b32 v37, s94
    s_mov_b64 exec, 1
    global_atomic_add v36, v37, s[64:65] sc1
    s_mov_b64 exec, -1
NOATOM:
    ds_write_b128 v2, a[24:27] offset:0
    ds_write_b128 v3, a[28:31] offset:0
    ds_write_b128 v4, a[32:35] offset:0
    ds_write_b128 v2, a[36:39] offset:3328
    ds_write_b128 v3, a[40:43] offset:3328
    ds_write_b128 v4, a[44:47] offset:3328
    ds_read_b128 a[24:27], v5 offset:0
    ds_read_b128 a[28:31], v5 offset:64
    ds_read_b128 a[32:35], v5 offset:128
    ds_read_b128 a[36:39], v5 offset:192
    ds_read_b128 a[40:43], v5 offset:256
    ds_read_b128 a[44:47], v5 offset:320
    buffer_load_dwordx4 a[76:79], v1, s[8:11], s85 offen offset:1024 nt
    buffer_load_dwordx4 a[80:83], v1, s[8:11], s85 offen offset:2048 nt
    buffer_load_dwordx4 a[84:87], v1, s[8:11], s85 offen offset:3072 nt
    buffer_load_dwordx4 a[88:91], v23, s[8:11], s85 offen offset:0 nt
    buffer_load_dwordx4 a[92:95], v23, s[8:11], s85 offen offset:1024 nt
    s_barrier
    buffer_load_dwordx4 a[240:243], v101, s[36:39], s91 offen
    buffer_load_dwordx4 a[240:243], v102, s[36:39], s91 offen
    buffer_load_dwordx4 a[240:243], v103, s[36:39], s91 offen
    buffer_load_dwordx4 a[240:243], v104, s[36:39], s91 offen
    buffer_load_dwordx4 a[240:243], v105, s[36:39], s91 offen
    buffer_load_dwordx4 a[240:243], v106, s[36:39], s91 offen
    s_barrier
    s_waitcnt vmcnt(12)
    ds_write_b128 v2, a[48:51] offset:0
    ds_write_b128 v3, a[52:55] offset:0
    ds_write_b128 v4, a[56:59] offset:0
    ds_write_b128 v2, a[60:63] offset:3328
    ds_write_b128 v3, a[64:67] offset:3328
    ds_write_b128 v4, a[68:71] offset:3328
    ds_read_b128 a[48:51], v5 offset:0
    ds_read_b128 a[52:55], v5 offset:64
    ds_read_b128 a[56:59], v5 offset:128
    ds_read_b128 a[60:63], v5 offset:192
    ds_read_b128 a[64:67], v5 offset:256
    ds_read_b128 a[68:71], v5 offset:320
    v_lshlrev_b32 v98, 2, v0
    buffer_load_dwordx4 a[96:99], v1, s[8:11], s86 offen offset:0 nt
    buffer_load_dwordx4 a[100:103], v1, s[8:11], s86 offen offset:1024 nt
    buffer_load_dwordx4 a[104:107], v1, s[8:11], s86 offen offset:2048 nt
    buffer_load_dwordx4 a[108:111], v1, s[8:11], s86 offen offset:3072 nt
    buffer_load_dwordx4 a[112:115], v23, s[8:11], s86 offen offset:0 nt
    buffer_load_dwordx4 a[116:119], v23, s[8:11], s86 offen offset:1024 nt
    s_barrier
    buffer_load_dwordx4 a[120:123], v1, s[8:11], s87 offen offset:0 nt
    buffer_load_dwordx4 a[124:127], v1, s[8:11], s87 offen offset:1024 nt
    buffer_load_dwordx4 a[128:131], v1, s[8:11], s87 offen offset:2048 nt
    buffer_load_dwordx4 a[132:135], v1, s[8:11], s87 offen offset:3072 nt
    buffer_load_dwordx4 a[136:139], v23, s[8:11], s87 offen offset:0 nt
    buffer_load_dwordx4 a[140:143], v23, s[8:11], s87 offen offset:1024 nt
    s_barrier
    s_waitcnt vmcnt(18)
    ds_write_b128 v2, a[72:75] offset:0
    ds_write_b128 v3, a[76:79] offset:0
    ds_write_b128 v4, a[80:83] offset:0
    ds_write_b128 v2, a[84:87] offset:3328
    ds_write_b128 v3, a[88:91] offset:3328
    ds_write_b128 v4, a[92:95] offset:3328
    ds_read_b128 a[72:75], v5 offset:0
    ds_read_b128 a[76:79], v5 offset:64
    ds_read_b128 a[80:83], v5 offset:128
    ds_read_b128 a[84:87], v5 offset:192
    ds_read_b128 a[88:91], v5 offset:256
    ds_read_b128 a[92:95], v5 offset:320
    buffer_load_dwordx4 a[144:147], v1, s[8:11], s88 offen offset:0 nt
    buffer_load_dwordx4 a[148:151], v1, s[8:11], s88 offen offset:1024 nt
    buffer_load_dwordx4 a[152:155], v1, s[8:11], s88 offen offset:2048 nt
    buffer_load_dwordx4 a[156:159], v1, s[8:11], s88 offen offset:3072 nt
    buffer_load_dwordx4 a[160:163], v23, s[8:11], s88 offen offset:0 nt
    buffer_load_dwordx4 a[164:167], v23, s[8:11], s88 offen offset:1024 nt
    s_barrier
    s_waitcnt vmcnt(12)
    ds_write_b128 v2, a[96:99] offset:0
    ds_write_b128 v3, a[100:103] offset:0
    ds_write_b128 v4, a[104:107] offset:0
    ds_write_b128 v2, a[108:111] offset:3328
    ds_write_b128 v3, a[112:115] offset:3328
    ds_write_b128 v4, a[116:119] offset:3328
    ds_read_b128 a[96:99], v5 offset:0
    ds_read_b128 a[100:103], v5 offset:64
    ds_read_b128 a[104:107], v5 offset:128
    ds_read_b128 a[108:111], v5 offset:192
    ds_read_b128 a[112:115], v5 offset:256
    ds_read_b128 a[116:119], v5 offset:320
    buffer_load_dwordx4 a[168:171], v1, s[8:11], s89 offen offset:0 nt
    buffer_load_dwordx4 a[172:175], v1, s[8:11], s89 offen offset:1024 nt
    buffer_load_dwordx4 a[176:179], v1, s[8:11], s89 offen offset:2048 nt
    buffer_load_dwordx4 a[180:183], v1, s[8:11], s89 offen offset:3072 nt
    buffer_load_dwordx4 a[184:187], v23, s[8:11], s89 offen offset:0 nt
    buffer_load_dwordx4 a[188:191], v23, s[8:11], s89 offen offset:1024 nt
    s_barrier
    s_cmp_ge_u32 s69, 20
    s_cbranch_scc1 DMAF
    s_lshl_b32 s66, s72, 3
    s_add_u32 s66, s66, s68
    s_mul_i32 s66, s66, 245760
    s_lshl_b32 s78, s69, 6
    s_add_u32 s66, s66, s78
    s_mul_i32 s67, s72, 12288
    s_add_u32 s67, s67, 57344
DMAX:
    v_mov_b32 v109, v20
    v_and_b32 v25, 15, v0
    v_lshrrev_b32 v26, 4, v0
    v_add_u32 v27, 4, v26
    v_mul_u32_u24 v20, 1280, v26
    v_add_u32 v20, 665600, v20
    s_mul_i32 s7, s68, 81920
    s_add_u32 s7, s7, 47360
    v_mov_b32 v28, s7
    v_cmp_eq_u32 vcc, s68, v26
    s_nop 1
    v_cndmask_b32 v20, v20, v28, vcc
    v_mul_u32_u24 v21, 1280, v27
    v_add_u32 v21, 665600, v21
    s_mul_i32 s7, s68, 81920
    s_add_u32 s7, s7, 47360
    v_mov_b32 v28, s7
    v_cmp_eq_u32 vcc, s68, v27
    s_nop 1
    v_cndmask_b32 v21, v21, v28, vcc
    s_min_u32 s7, s69, 19
    s_lshl_b32 s7, s7, 6
    v_lshl_add_u32 v25, v25, 2, s7
    v_add_u32 v20, v20, v25
    v_add_u32 v21, v21, v25
    buffer_load_dwordx4 a[216:219], v1, s[12:15], s73 offen offset:0 nt
    v_and_b32 v25, 15, v0
    v_bfe_u32 v27, v0, 2, 2
    v_and_b32 v28, 3, v0
    s_mul_i32 s7, s72, 12288
    s_add_u32 s7, s7, 57344
    v_lshl_add_u32 v29, v26, 3, v27
    v_lshlrev_b32 v29, 6, v29
    v_lshl_add_u32 v29, v28, 3, v29
    v_add_u32 v29, s7, v29
    v_accvgpr_write_b32 a246, v29
    s_mul_i32 s7, s72, 3072
    s_add_u32 s7, s7, 32768
    v_lshl_add_u32 v29, v25, 4, s7
    v_lshl_add_u32 v29, v26, 7, v29
    v_accvgpr_write_b32 a247, v29
    s_lshl_b32 s7, s72, 6
    s_add_u32 s7, s7, 45056
    v_and_b32 v29, 1, v26
    v_lshl_add_u32 v29, v29, 5, s7
    v_accvgpr_write_b32 a248, v29
    s_lshl_b32 s7, s72, 8
    s_add_u32 s7, s7, 122368
    v_lshl_add_u32 v29, v0, 2, s7
    v_accvgpr_write_b32 a249, v29
    s_lshl_b32 s81, s69, 6
    s_mul_i32 s80, s68, 1280
    s_add_u32 s80, s80, s81
    s_add_u32 s80, s80, 655360
    s_add_u32 s81, s81, s3
    s_add_u32 s81, s81, 46080
    s_waitcnt vmcnt(13)
    ds_write_b128 v2, a[120:123] offset:0
    ds_write_b128 v3, a[124:127] offset:0
    ds_write_b128 v4, a[128:131] offset:0
    ds_write_b128 v2, a[132:135] offset:3328
    ds_write_b128 v3, a[136:139] offset:3328
    ds_write_b128 v4, a[140:143] offset:3328
    ds_read_b128 a[120:123], v5 offset:0
    ds_read_b128 a[124:127], v5 offset:64
    ds_read_b128 a[128:131], v5 offset:128
    ds_read_b128 a[132:135], v5 offset:192
    ds_read_b128 a[136:139], v5 offset:256
    ds_read_b128 a[140:143], v5 offset:320
    buffer_load_dwordx4 a[220:223], v1, s[12:15], s73 offen offset:1024 nt
    buffer_load_dwordx4 a[224:227], v1, s[12:15], s73 offen offset:2048 nt
    buffer_load_dwordx4 a[228:231], v1, s[12:15], s73 offen offset:3072 nt
    buffer_load_dwordx4 a[232:235], v23, s[12:15], s73 offen offset:0 nt
    buffer_load_dwordx4 a[236:239], v23, s[12:15], s73 offen offset:1024 nt
    s_barrier
    global_load_dword v99, v98, s[64:65] sc1
    s_waitcnt vmcnt(13)
    ds_write_b128 v2, a[144:147] offset:0
    ds_write_b128 v3, a[148:151] offset:0
    ds_write_b128 v4, a[152:155] offset:0
    ds_write_b128 v2, a[156:159] offset:3328
    ds_write_b128 v3, a[160:163] offset:3328
    ds_write_b128 v4, a[164:167] offset:3328
    ds_read_b128 a[144:147], v5 offset:0
    ds_read_b128 a[148:151], v5 offset:64
    ds_read_b128 a[152:155], v5 offset:128
    ds_read_b128 a[156:159], v5 offset:192
    ds_read_b128 a[160:163], v5 offset:256
    ds_read_b128 a[164:167], v5 offset:320
    buffer_load_dwordx4 v[112:115], v1, s[12:15], s83 offen offset:0 nt
    buffer_load_dwordx4 v[116:119], v1, s[12:15], s83 offen offset:1024 nt
    buffer_load_dwordx4 v[120:123], v1, s[12:15], s83 offen offset:2048 nt
    buffer_load_dwordx4 v[124:127], v1, s[12:15], s83 offen offset:3072 nt
    buffer_load_dwordx4 v[128:131], v23, s[12:15], s83 offen offset:0 nt
    buffer_load_dwordx4 v[132:135], v23, s[12:15], s83 offen offset:1024 nt
    s_barrier
    s_waitcnt vmcnt(13)
    ds_write_b128 v2, a[168:171] offset:0
    ds_write_b128 v3, a[172:175] offset:0
    ds_write_b128 v4, a[176:179] offset:0
    ds_write_b128 v2, a[180:183] offset:3328
    ds_write_b128 v3, a[184:187] offset:3328
    ds_write_b128 v4, a[188:191] offset:3328
    ds_read_b128 a[168:171], v5 offset:0
    ds_read_b128 a[172:175], v5 offset:64
    ds_read_b128 a[176:179], v5 offset:128
    ds_read_b128 a[180:183], v5 offset:192
    ds_read_b128 a[184:187], v5 offset:256
    ds_read_b128 a[188:191], v5 offset:320
    buffer_load_dwordx4 v[136:139], v1, s[12:15], s84 offen offset:0 nt
    buffer_load_dwordx4 v[140:143], v1, s[12:15], s84 offen offset:1024 nt
    buffer_load_dwordx4 v[144:147], v1, s[12:15], s84 offen offset:2048 nt
    buffer_load_dwordx4 v[148:151], v1, s[12:15], s84 offen offset:3072 nt
    buffer_load_dwordx4 v[152:155], v23, s[12:15], s84 offen offset:0 nt
    buffer_load_dwordx4 v[156:159], v23, s[12:15], s84 offen offset:1024 nt
    s_barrier
    s_waitcnt vmcnt(12)
    s_mov_b32 s76, -1
    v_sad_u8 v100, v99, 0, 0
    s_nop 1
    v_add_u32_dpp v100, v100, v100 quad_perm:[1,0,3,2] row_mask:0xf bank_mask:0xf
    s_nop 1
    v_add_u32_dpp v100, v100, v100 quad_perm:[2,3,0,1] row_mask:0xf bank_mask:0xf
    v_cmp_gt_u32 vcc, 32, v100
    s_mov_b32 vcc_hi, 0
    s_cmp_eq_u64 vcc, 0
    s_cbranch_scc0 RDYLOOP
RDYOK:
    v_readlane_b32 s77, v99, s5
    s_nop 0
    s_cmp_eq_u32 s77, s96
    s_cselect_b32 s75, 1, 0
    buffer_load_dwordx4 a[240:243], v109, s[16:19], 0 offen sc1
    v_lshrrev_b32 v106, 3, v0
    v_mul_u32_u24 v106, 2560, v106
    v_and_b32 v107, 7, v0
    v_lshl_add_u32 v106, v107, 4, v106
    s_lshl_b32 s77, s69, 7
    s_add_u32 s77, s77, s3
    s_add_u32 s77, s77, 51200
    s_cmp_lt_u32 s69, 20
    s_cselect_b32 s77, s77, 1879048176
    s_cmp_eq_u32 s72, 0
    s_cselect_b32 s77, s77, 1879048176
    v_add_u32 v106, s77, v106
    v_add_u32 v107, 20480, v106
    v_mov_b32 v108, 2147483632
    v_cmp_le_u32 vcc, 32, v0
    s_nop 1
    v_cndmask_b32 v107, v107, v108, vcc
    buffer_load_dwordx4 a[240:243], v106, s[16:19], 0 offen sc1
    buffer_load_dwordx4 a[240:243], v107, s[16:19], 0 offen sc1
    s_add_u32 s77, s3, 1376256
    s_add_u32 s78, s3, 1380352
    s_add_u32 s79, s3, 4096
    buffer_load_dwordx4 v[64:67], v11, s[16:19], s77 offen sc1
    buffer_load_dwordx4 v[68:71], v11, s[16:19], s78 offen sc1
    buffer_load_dwordx4 v[72:75], v11, s[16:19], s3 offen sc1
    buffer_load_dwordx4 v[76:79], v11, s[16:19], s79 offen sc1
    s_cmp_lg_u32 s72, 1
    s_cbranch_scc1 NOBASE0
    s_cmp_ge_u32 s69, 20
    s_cbranch_scc1 NOBASE0
    v_mov_b32 v28, v22
    s_lshl_b32 s77, s69, 6
    s_add_u32 s77, s77, s3
    s_add_u32 s77, s77, 48640
    v_lshlrev_b32 v27, 2, v0
    v_mov_b32_dpp v29, v28 quad_perm:[1,1,1,1] row_mask:0xf bank_mask:0xf
    v_mov_b32_dpp v30, v28 quad_perm:[2,2,2,2] row_mask:0xf bank_mask:0xf
    v_mov_b32_dpp v31, v28 quad_perm:[3,3,3,3] row_mask:0xf bank_mask:0xf
    s_mov_b32 exec_lo, 0x1111
    s_mov_b32 exec_hi, 0x0
    s_cmp_eq_u32 s75, 1
    s_cbranch_scc0 SLOW1
    buffer_store_dwordx4 v[28:31], v27, s[16:19], s77 offen
BACK1:
    s_mov_b64 exec, -1
NOBASE0:
    ds_write_b128 v2, a[216:219] offset:0
    ds_write_b128 v3, a[220:223] offset:0
    ds_write_b128 v4, a[224:227] offset:0
    ds_write_b128 v2, a[228:231] offset:3328
    ds_write_b128 v3, a[232:235] offset:3328
    ds_write_b128 v4, a[236:239] offset:3328
    ds_read_b64_tr_b16 a[192:193], v6 offset:0
    ds_read_b64_tr_b16 a[196:197], v6 offset:32
    ds_read_b64_tr_b16 a[200:201], v6 offset:64
    ds_read_b64_tr_b16 a[204:205], v6 offset:96
    ds_read_b64_tr_b16 a[208:209], v6 offset:128
    ds_read_b64_tr_b16 a[212:213], v6 offset:160
    ds_read_b64_tr_b16 a[216:217], v6 offset:192
    ds_read_b64_tr_b16 a[220:221], v6 offset:224
    ds_read_b64_tr_b16 a[224:225], v6 offset:256
    ds_read_b64_tr_b16 a[228:229], v6 offset:288
    ds_read_b64_tr_b16 a[232:233], v6 offset:320
    ds_read_b64_tr_b16 a[236:237], v6 offset:352
    s_waitcnt vmcnt(13)
    ds_write_b128 v2, v[112:115] offset:0
    ds_write_b128 v3, v[116:119] offset:0
    ds_write_b128 v4, v[120:123] offset:0
    ds_write_b128 v2, v[124:127] offset:3328
    ds_write_b128 v3, v[128:131] offset:3328
    ds_write_b128 v4, v[132:135] offset:3328
    ds_read_b64_tr_b16 a[194:195], v6 offset:0
    ds_read_b64_tr_b16 a[198:199], v6 offset:32
    ds_read_b64_tr_b16 a[202:203], v6 offset:64
    ds_read_b64_tr_b16 a[206:207], v6 offset:96
    ds_read_b64_tr_b16 a[210:211], v6 offset:128
    ds_read_b64_tr_b16 a[214:215], v6 offset:160
    ds_read_b64_tr_b16 a[218:219], v6 offset:192
    ds_read_b64_tr_b16 a[222:223], v6 offset:224
    ds_read_b64_tr_b16 a[226:227], v6 offset:256
    ds_read_b64_tr_b16 a[230:231], v6 offset:288
    ds_read_b64_tr_b16 a[234:235], v6 offset:320
    ds_read_b64_tr_b16 a[238:239], v6 offset:352
    buffer_load_dwordx4 v[160:163], v1, s[12:15], s85 offen offset:0 nt
    buffer_load_dwordx4 v[164:167], v1, s[12:15], s85 offen offset:1024 nt
    buffer_load_dwordx4 v[168:171], v1, s[12:15], s85 offen offset:2048 nt
    buffer_load_dwordx4 v[172:175], v1, s[12:15], s85 offen offset:3072 nt
    buffer_load_dwordx4 v[176:179], v23, s[12:15], s85 offen offset:0 nt
    s_waitcnt vmcnt(12)
    ds_write_b128 v2, v[136:139] offset:0
    ds_write_b128 v3, v[140:143] offset:0
    ds_write_b128 v4, v[144:147] offset:0
    ds_write_b128 v2, v[148:151] offset:3328
    ds_write_b128 v3, v[152:155] offset:3328
    ds_write_b128 v4, v[156:159] offset:3328
    ds_read_b64_tr_b16 v[112:113], v6 offset:0
    ds_read_b64_tr_b16 v[116:117], v6 offset:32
    ds_read_b64_tr_b16 v[120:121], v6 offset:64
    ds_read_b64_tr_b16 v[124:125], v6 offset:96
    ds_read_b64_tr_b16 v[128:129], v6 offset:128
    ds_read_b64_tr_b16 v[132:133], v6 offset:160
    ds_read_b64_tr_b16 v[136:137], v6 offset:192
    ds_read_b64_tr_b16 v[140:141], v6 offset:224
    ds_read_b64_tr_b16 v[144:145], v6 offset:256
    ds_read_b64_tr_b16 v[148:149], v6 offset:288
    ds_read_b64_tr_b16 v[152:153], v6 offset:320
    ds_read_b64_tr_b16 v[156:157], v6 offset:352
    buffer_load_dwordx4 v[180:183], v23, s[12:15], s85 offen offset:1024 nt
    s_barrier
    buffer_load_dwordx4 v[184:187], v1, s[12:15], s86 offen offset:0 nt
    buffer_load_dwordx4 v[188:191], v1, s[12:15], s86 offen offset:1024 nt
    buffer_load_dwordx4 v[192:195], v1, s[12:15], s86 offen offset:2048 nt
    buffer_load_dwordx4 v[196:199], v1, s[12:15], s86 offen offset:3072 nt
    buffer_load_dwordx4 v[200:203], v23, s[12:15], s86 offen offset:0 nt
    buffer_load_dwordx4 v[204:207], v23, s[12:15], s86 offen offset:1024 nt
    s_barrier
    s_waitcnt vmcnt(12)
    v_mov_b32 v24, -1
    v_mov_b32 v25, -1
    v_mov_b32 v26, -1
    v_mov_b32 v27, -1
    s_cmp_eq_u32 s75, 1
    s_cbranch_scc0 SLOW2
    buffer_store_dwordx4 v[24:27], v106, s[16:19], 0 offen
BACK2:
    s_cmp_eq_u32 s75, 1
    s_cbranch_scc0 SLOW3
    buffer_store_dwordx4 v[24:27], v107, s[16:19], 0 offen
BACK3:
    v_add_f32 v64, v64, v68
    v_add_f32 v65, v65, v69
    v_add_f32 v66, v66, v70
    v_add_f32 v67, v67, v71
    s_nop 0
    v_permlane32_swap_b32 v64, v66
    v_permlane32_swap_b32 v65, v67
    v_add_f32 v64, v64, v66
    v_add_f32 v65, v65, v67
    s_nop 1
    v_permlane16_swap_b32 v64, v65
    v_add_f32 v64, v64, v65
    v_add_f32 v72, v72, v76
    v_add_f32 v73, v73, v77
    v_add_f32 v74, v74, v78
    v_add_f32 v75, v75, v79
    s_nop 0
    v_permlane32_swap_b32 v72, v74
    v_permlane32_swap_b32 v73, v75
    v_add_f32 v72, v72, v74
    v_add_f32 v73, v73, v75
    s_nop 1
    v_permlane16_swap_b32 v72, v73
    v_add_f32 v72, v72, v73
    v_mul_f32 v7, 0x3acccccd, v64
    v_mov_b32 v24, v72
    buffer_load_dwordx4 v[208:211], v1, s[12:15], s87 offen offset:0 nt
    v_mov_b32 v40, 0
    v_mov_b32 v41, 0
    v_mov_b32 v44, 0
    v_mov_b32 v45, 0
    v_mov_b32 v48, 0
    v_mov_b32 v49, 0
    v_mov_b32 v52, 0
    v_mov_b32 v53, 0
    v_mov_b32 v56, 0
    v_mov_b32 v57, 0
    v_mov_b32 v60, 0
    v_mov_b32 v61, 0
    v_mov_b32 v64, 0
    v_mov_b32 v65, 0
    v_mov_b32 v68, 0
    v_mov_b32 v69, 0
    v_mov_b32 v72, 0
    v_mov_b32 v73, 0
    v_mov_b32 v74, 0
    v_mov_b32 v75, 0
    v_mov_b32 v76, 0
    v_mov_b32 v77, 0
    v_mov_b32 v78, 0
    v_mov_b32 v79, 0
    v_mov_b32 v80, 0
    v_mov_b32 v81, 0
    v_mov_b32 v82, 0
    v_mov_b32 v83, 0
    v_mov_b32 v84, 0
    v_mov_b32 v85, 0
    v_mov_b32 v86, 0
    v_mov_b32 v87, 0
    v_readlane_b32 s77, v24, 15
    s_mov_b32 vcc_lo, 0x70007000
    s_mov_b32 vcc_hi, 0x70007000
    v_fma_f32 v25, -s77, v7, v24
    v_cvt_pk_bf16_f32 v25, v25, v25
    ds_write_b16 v12, v25
    v_cndmask_b32 v26, 0, v24, vcc
    s_nop 1
    v_add_f32_dpp v26, v26, v26 quad_perm:[1,0,3,2] row_mask:0xf bank_mask:0xf
    s_nop 1
    v_add_f32_dpp v26, v26, v26 quad_perm:[2,3,0,1] row_mask:0xf bank_mask:0xf
    v_mov_b32 v27, v26
    s_nop 1
    v_permlane32_swap_b32 v26, v27
    v_add_f32 v26, v26, v27
    buffer_load_dwordx4 v[212:215], v1, s[12:15], s87 offen offset:1024 nt
    buffer_load_dwordx4 v[216:219], v1, s[12:15], s87 offen offset:2048 nt
    s_waitcnt lgkmcnt(0)
    s_barrier
    ds_read_b128 v[28:31], v13 offset:0
    ds_read_b128 v[32:35], v13 offset:128
    ds_read_b128 v[36:39], v13 offset:256
    v_mov_b32 v27, v26
    v_mov_b32 v25, s77
    v_subrev_f32 v25, 0x44200000, v25
    v_permlane16_swap_b32 v26, v27
    v_add_f32 v26, v26, v27
    v_mul_f32 v24, 0x3acccccd, v25
    v_readlane_b32 s77, v26, 15
    v_mul_f32 v24, v24, v24
    s_mov_b32 s78, 0x3acccccd
    v_sub_f32 v26, s77, v25
    v_fma_f32 v26, v26, s78, -v24
    v_max_f32 v26, 0, v26
    v_add_f32 v26, 0x3727c5ac, v26
    v_rsq_f32 v26, v26
    s_nop 0
    v_mul_f32 v18, 0x3dd53b94, v26
    s_waitcnt lgkmcnt(2)
    v_smfmac_f32_16x16x64_bf16 v[40:43], v[28:31], a[0:7], v14
    v_smfmac_f32_16x16x64_bf16 v[56:59], v[28:31], a[96:103], v14
    v_smfmac_f32_16x16x64_bf16 v[44:47], v[28:31], a[24:31], v14
    v_smfmac_f32_16x16x64_bf16 v[60:63], v[28:31], a[120:127], v14
    v_smfmac_f32_16x16x64_bf16 v[48:51], v[28:31], a[48:55], v14
    v_smfmac_f32_16x16x64_bf16 v[64:67], v[28:31], a[144:151], v14
    v_smfmac_f32_16x16x64_bf16 v[52:55], v[28:31], a[72:79], v14
    v_smfmac_f32_16x16x64_bf16 v[68:71], v[28:31], a[168:175], v14
    buffer_load_dwordx4 v[220:223], v1, s[12:15], s87 offen offset:3072 nt
    s_waitcnt lgkmcnt(1)
    v_smfmac_f32_16x16x64_bf16 v[40:43], v[32:35], a[8:15], v14
    v_smfmac_f32_16x16x64_bf16 v[56:59], v[32:35], a[104:111], v14
    v_smfmac_f32_16x16x64_bf16 v[44:47], v[32:35], a[32:39], v14
    v_smfmac_f32_16x16x64_bf16 v[60:63], v[32:35], a[128:135], v14
    v_smfmac_f32_16x16x64_bf16 v[48:51], v[32:35], a[56:63], v14
    v_smfmac_f32_16x16x64_bf16 v[64:67], v[32:35], a[152:159], v14
    v_smfmac_f32_16x16x64_bf16 v[52:55], v[32:35], a[80:87], v14
    v_smfmac_f32_16x16x64_bf16 v[68:71], v[32:35], a[176:183], v14
    s_waitcnt lgkmcnt(0)
    v_smfmac_f32_16x16x64_bf16 v[40:43], v[36:39], a[16:23], v14
    v_smfmac_f32_16x16x64_bf16 v[56:59], v[36:39], a[112:119], v14
    v_smfmac_f32_16x16x64_bf16 v[44:47], v[36:39], a[40:47], v14
    v_smfmac_f32_16x16x64_bf16 v[60:63], v[36:39], a[136:143], v14
    v_smfmac_f32_16x16x64_bf16 v[48:51], v[36:39], a[64:71], v14
    v_smfmac_f32_16x16x64_bf16 v[64:67], v[36:39], a[160:167], v14
    v_smfmac_f32_16x16x64_bf16 v[52:55], v[36:39], a[88:95], v14
    v_smfmac_f32_16x16x64_bf16 v[68:71], v[36:39], a[184:191], v14
    buffer_load_dwordx4 v[224:227], v23, s[12:15], s87 offen offset:0 nt
    s_lshl_b32 s78, s72, 8
    v_add_f32_dpp v24, v40, v41 quad_perm:[0,1,2,3] row_mask:0x1 bank_mask:0xf
    v_add_f32_dpp v25, v56, v57 quad_perm:[0,1,2,3] row_mask:0x1 bank_mask:0xf
    v_bfe_u32 v27, v0, 4, 1
    v_add_f32_dpp v24, v44, v45 quad_perm:[0,1,2,3] row_mask:0x2 bank_mask:0xf
    v_add_f32_dpp v25, v60, v61 quad_perm:[0,1,2,3] row_mask:0x2 bank_mask:0xf
    v_bfe_u32 v28, v0, 2, 1
    v_add_f32_dpp v24, v48, v49 quad_perm:[0,1,2,3] row_mask:0x4 bank_mask:0xf
    v_add_f32_dpp v25, v64, v65 quad_perm:[0,1,2,3] row_mask:0x4 bank_mask:0xf
    s_add_u32 s78, s78, 124416
    v_add_f32_dpp v24, v52, v53 quad_perm:[0,1,2,3] row_mask:0x8 bank_mask:0xf
    v_add_f32_dpp v25, v68, v69 quad_perm:[0,1,2,3] row_mask:0x8 bank_mask:0xf
    v_max_f32 v26, v24, v25
    v_lshl_add_u32 v27, v27, 5, s78
    v_lshl_add_u32 v27, v28, 4, v27
    v_max_f32_dpp v26, v26, v26 row_ror:8 row_mask:0xf bank_mask:0xf
    s_nop 1
    v_max_f32_dpp v26, v26, v26 row_ror:4 row_mask:0xf bank_mask:0xf
    s_nop 1
    v_max_f32_dpp v26, v26, v26 row_ror:2 row_mask:0xf bank_mask:0xf
    s_nop 1
    v_max_f32_dpp v26, v26, v26 row_ror:1 row_mask:0xf bank_mask:0xf
    v_mov_b32 v28, v26
    s_nop 1
    v_permlane32_swap_b32 v26, v28
    v_max_f32 v26, v26, v28
    v_mov_b32 v28, v26
    s_nop 1
    v_permlane16_swap_b32 v26, v28
    v_max_f32 v26, v26, v28
    buffer_load_dwordx4 v[228:231], v23, s[12:15], s87 offen offset:1024 nt
    s_barrier
    v_mul_f32 v26, v26, v18
    v_fma_f32 v24, v24, v18, -v26
    v_fma_f32 v25, v25, v18, -v26
    v_exp_f32 v24, v24
    v_exp_f32 v25, v25
    s_nop 0
    v_cvt_pk_bf16_f32 v28, v24, v25
    ds_write_b16 v19, v28
    ds_write_b16_d16_hi v19, v28 offset:128
    s_mov_b32 exec_lo, 0xff00ff
    s_mov_b32 exec_hi, 0xff00ff00
    ds_read_b128 v[72:75], v27 offset:0
    ds_read_b128 v[76:79], v27 offset:64
    ds_read_b128 v[80:83], v27 offset:128
    ds_read_b128 v[84:87], v27 offset:192
    s_mov_b64 exec, -1
    v_add_f32 v27, v24, v25
    v_mov_b32 v40, 0
    v_mov_b32 v44, 0
    v_add_f32_dpp v27, v27, v27 row_ror:8 row_mask:0xf bank_mask:0xf
    v_mov_b32 v48, 0
    v_mov_b32 v52, 0
    v_add_f32_dpp v27, v27, v27 row_ror:4 row_mask:0xf bank_mask:0xf
    v_mov_b32 v56, 0
    v_mov_b32 v60, 0
    v_add_f32_dpp v27, v27, v27 row_ror:2 row_mask:0xf bank_mask:0xf
    s_lshl_b32 s78, s72, 3
    s_add_u32 s78, s78, 125440
    v_add_f32_dpp v27, v27, v27 row_ror:1 row_mask:0xf bank_mask:0xf
    v_mov_b32 v28, v27
    s_nop 1
    v_permlane32_swap_b32 v27, v28
    v_add_f32 v27, v27, v28
    v_mov_b32 v28, v27
    s_nop 1
    v_permlane16_swap_b32 v27, v28
    v_add_f32 v27, v27, v28
    v_mov_b32 v28, s78
    ds_write_b64 v28, v[26:27]
    s_waitcnt vmcnt(14)
    ds_write_b128 v2, v[160:163] offset:0
    ds_write_b128 v3, v[164:167] offset:0
    ds_write_b128 v4, v[168:171] offset:0
    ds_write_b128 v2, v[172:175] offset:3328
    ds_write_b128 v3, v[176:179] offset:3328
    ds_write_b128 v4, v[180:183] offset:3328
    ds_read_b64_tr_b16 v[114:115], v6 offset:0
    ds_read_b64_tr_b16 v[118:119], v6 offset:32
    ds_read_b64_tr_b16 v[122:123], v6 offset:64
    ds_read_b64_tr_b16 v[126:127], v6 offset:96
    ds_read_b64_tr_b16 v[130:131], v6 offset:128
    ds_read_b64_tr_b16 v[134:135], v6 offset:160
    ds_read_b64_tr_b16 v[138:139], v6 offset:192
    ds_read_b64_tr_b16 v[142:143], v6 offset:224
    ds_read_b64_tr_b16 v[146:147], v6 offset:256
    ds_read_b64_tr_b16 v[150:151], v6 offset:288
    ds_read_b64_tr_b16 v[154:155], v6 offset:320
    ds_read_b64_tr_b16 v[158:159], v6 offset:352
    buffer_load_dwordx4 v[232:235], v1, s[12:15], s88 offen offset:0 nt
    buffer_load_dwordx4 v[236:239], v1, s[12:15], s88 offen offset:1024 nt
    s_waitcnt lgkmcnt(0)
    v_smfmac_f32_16x16x64_bf16 v[40:43], v[72:75], a[192:199], v14 abid:1
    v_smfmac_f32_16x16x64_bf16 v[44:47], v[72:75], a[200:207], v14 abid:1
    v_smfmac_f32_16x16x64_bf16 v[48:51], v[72:75], a[208:215], v14 abid:1
    v_smfmac_f32_16x16x64_bf16 v[52:55], v[72:75], a[216:223], v14 abid:1
    v_smfmac_f32_16x16x64_bf16 v[56:59], v[72:75], a[224:231], v14 abid:1
    v_smfmac_f32_16x16x64_bf16 v[60:63], v[72:75], a[232:239], v14 abid:1
    buffer_load_dwordx4 v[240:243], v1, s[12:15], s88 offen offset:2048 nt
    v_smfmac_f32_16x16x64_bf16 v[40:43], v[76:79], v[112:119], v14 abid:1
    v_smfmac_f32_16x16x64_bf16 v[44:47], v[76:79], v[120:127], v14 abid:1
    v_smfmac_f32_16x16x64_bf16 v[48:51], v[76:79], v[128:135], v14 abid:1
    v_smfmac_f32_16x16x64_bf16 v[52:55], v[76:79], v[136:143], v14 abid:1
    v_smfmac_f32_16x16x64_bf16 v[56:59], v[76:79], v[144:151], v14 abid:1
    v_smfmac_f32_16x16x64_bf16 v[60:63], v[76:79], v[152:159], v14 abid:1
    buffer_load_dwordx4 v[244:247], v1, s[12:15], s88 offen offset:3072 nt
    s_waitcnt vmcnt(12)
    ds_write_b128 v2, v[184:187] offset:0
    ds_write_b128 v3, v[188:191] offset:0
    ds_write_b128 v4, v[192:195] offset:0
    ds_write_b128 v2, v[196:199] offset:3328
    ds_write_b128 v3, v[200:203] offset:3328
    ds_write_b128 v4, v[204:207] offset:3328
    ds_read_b64_tr_b16 v[160:161], v6 offset:0
    ds_read_b64_tr_b16 v[164:165], v6 offset:32
    ds_read_b64_tr_b16 v[168:169], v6 offset:64
    ds_read_b64_tr_b16 v[172:173], v6 offset:96
    ds_read_b64_tr_b16 v[176:177], v6 offset:128
    ds_read_b64_tr_b16 v[180:181], v6 offset:160
    ds_read_b64_tr_b16 v[184:185], v6 offset:192
    ds_read_b64_tr_b16 v[188:189], v6 offset:224
    ds_read_b64_tr_b16 v[192:193], v6 offset:256
    ds_read_b64_tr_b16 v[196:197], v6 offset:288
    ds_read_b64_tr_b16 v[200:201], v6 offset:320
    ds_read_b64_tr_b16 v[204:205], v6 offset:352
    buffer_load_dwordx4 v[248:251], v23, s[12:15], s88 offen offset:0 nt
    buffer_load_dwordx4 v[252:255], v23, s[12:15], s88 offen offset:1024 nt
    s_barrier
    buffer_load_dwordx4 v[88:91], v1, s[12:15], s89 offen offset:0 nt
    buffer_load_dwordx4 v[92:95], v1, s[12:15], s89 offen offset:1024 nt
    buffer_load_dwordx4 v[96:99], v1, s[12:15], s89 offen offset:2048 nt
    buffer_load_dwordx4 v[100:103], v1, s[12:15], s89 offen offset:3072 nt
    buffer_load_dwordx4 v[104:107], v23, s[12:15], s89 offen offset:0 nt
    buffer_load_dwordx4 v[108:111], v23, s[12:15], s89 offen offset:1024 nt
    s_waitcnt vmcnt(12)
    ds_write_b128 v2, v[208:211] offset:0
    ds_write_b128 v3, v[212:215] offset:0
    ds_write_b128 v4, v[216:219] offset:0
    ds_write_b128 v2, v[220:223] offset:3328
    ds_write_b128 v3, v[224:227] offset:3328
    ds_write_b128 v4, v[228:231] offset:3328
    ds_read_b64_tr_b16 v[162:163], v6 offset:0
    ds_read_b64_tr_b16 v[166:167], v6 offset:32
    ds_read_b64_tr_b16 v[170:171], v6 offset:64
    ds_read_b64_tr_b16 v[174:175], v6 offset:96
    ds_read_b64_tr_b16 v[178:179], v6 offset:128
    ds_read_b64_tr_b16 v[182:183], v6 offset:160
    ds_read_b64_tr_b16 v[186:187], v6 offset:192
    ds_read_b64_tr_b16 v[190:191], v6 offset:224
    ds_read_b64_tr_b16 v[194:195], v6 offset:256
    ds_read_b64_tr_b16 v[198:199], v6 offset:288
    ds_read_b64_tr_b16 v[202:203], v6 offset:320
    ds_read_b64_tr_b16 v[206:207], v6 offset:352
    v_and_b32 v23, 0xffff0000, v22
    v_lshlrev_b32 v22, 16, v22
    s_cmp_ge_u32 s69, 20
    s_cbranch_scc1 TAILF
    v_lshrrev_b32 v38, 2, v0
    v_mul_u32_u24 v38, 1280, v38
    v_and_b32 v39, 3, v0
    v_lshl_add_u32 v39, v39, 4, v38
    s_mov_b32 m0, s67
    s_add_u32 s67, s67, 1024
    buffer_load_dwordx4 v39, s[24:27], s66 offen  lds
    s_add_u32 s66, s66, 20480
    s_mov_b32 m0, s67
    s_add_u32 s67, s67, 1024
    buffer_load_dwordx4 v39, s[24:27], s66 offen  lds
    s_add_u32 s66, s66, 20480
    s_mov_b32 m0, s67
    s_add_u32 s67, s67, 1024
    buffer_load_dwordx4 v39, s[24:27], s66 offen  lds
    s_add_u32 s66, s66, 20480
    s_waitcnt lgkmcnt(0)
    v_smfmac_f32_16x16x64_bf16 v[40:43], v[80:83], v[160:167], v14 abid:1
    v_smfmac_f32_16x16x64_bf16 v[44:47], v[80:83], v[168:175], v14 abid:1
    v_smfmac_f32_16x16x64_bf16 v[48:51], v[80:83], v[176:183], v14 abid:1
    v_smfmac_f32_16x16x64_bf16 v[52:55], v[80:83], v[184:191], v14 abid:1
    v_smfmac_f32_16x16x64_bf16 v[56:59], v[80:83], v[192:199], v14 abid:1
    v_smfmac_f32_16x16x64_bf16 v[60:63], v[80:83], v[200:207], v14 abid:1
    s_waitcnt vmcnt(9)
    ds_write_b128 v2, v[232:235] offset:0
    ds_write_b128 v3, v[236:239] offset:0
    ds_write_b128 v4, v[240:243] offset:0
    ds_write_b128 v2, v[244:247] offset:3328
    ds_write_b128 v3, v[248:251] offset:3328
    ds_write_b128 v4, v[252:255] offset:3328
    ds_read_b64_tr_b16 v[208:209], v6 offset:0
    ds_read_b64_tr_b16 v[212:213], v6 offset:32
    ds_read_b64_tr_b16 v[216:217], v6 offset:64
    ds_read_b64_tr_b16 v[220:221], v6 offset:96
    ds_read_b64_tr_b16 v[224:225], v6 offset:128
    ds_read_b64_tr_b16 v[228:229], v6 offset:160
    ds_read_b64_tr_b16 v[232:233], v6 offset:192
    ds_read_b64_tr_b16 v[236:237], v6 offset:224
    ds_read_b64_tr_b16 v[240:241], v6 offset:256
    ds_read_b64_tr_b16 v[244:245], v6 offset:288
    ds_read_b64_tr_b16 v[248:249], v6 offset:320
    ds_read_b64_tr_b16 v[252:253], v6 offset:352
    s_mov_b32 m0, s67
    s_add_u32 s67, s67, 1024
    buffer_load_dwordx4 v39, s[24:27], s66 offen  lds
    s_add_u32 s66, s66, 20480
    s_mov_b32 m0, s67
    s_add_u32 s67, s67, 1024
    buffer_load_dwordx4 v39, s[24:27], s66 offen  lds
    s_add_u32 s66, s66, 20480
    s_mov_b32 m0, s67
    s_add_u32 s67, s67, 1024
    buffer_load_dwordx4 v39, s[24:27], s66 offen  lds
    s_add_u32 s66, s66, 20480
    s_waitcnt vmcnt(11)
    ds_write_b128 v2, v[88:91] offset:0
    s_waitcnt vmcnt(10)
    ds_write_b128 v3, v[92:95] offset:0
    s_waitcnt vmcnt(9)
    ds_write_b128 v4, v[96:99] offset:0
    s_waitcnt vmcnt(8)
    ds_write_b128 v2, v[100:103] offset:3328
    s_waitcnt vmcnt(7)
    ds_write_b128 v3, v[104:107] offset:3328
    s_waitcnt vmcnt(6)
    ds_write_b128 v4, v[108:111] offset:3328
    ds_read_b64_tr_b16 v[210:211], v6 offset:0
    ds_read_b64_tr_b16 v[214:215], v6 offset:32
    ds_read_b64_tr_b16 v[218:219], v6 offset:64
    ds_read_b64_tr_b16 v[222:223], v6 offset:96
    ds_read_b64_tr_b16 v[226:227], v6 offset:128
    ds_read_b64_tr_b16 v[230:231], v6 offset:160
    ds_read_b64_tr_b16 v[234:235], v6 offset:192
    ds_read_b64_tr_b16 v[238:239], v6 offset:224
    ds_read_b64_tr_b16 v[242:243], v6 offset:256
    ds_read_b64_tr_b16 v[246:247], v6 offset:288
    ds_read_b64_tr_b16 v[250:251], v6 offset:320
    ds_read_b64_tr_b16 v[254:255], v6 offset:352
    s_mov_b32 m0, s67
    s_add_u32 s67, s67, 1024
    buffer_load_dwordx4 v39, s[24:27], s66 offen  lds
    s_add_u32 s66, s66, 20480
    s_mov_b32 m0, s67
    s_add_u32 s67, s67, 1024
    buffer_load_dwordx4 v39, s[24:27], s66 offen  lds
    s_add_u32 s66, s66, 20480
    s_mov_b32 m0, s67
    s_add_u32 s67, s67, 1024
    buffer_load_dwordx4 v39, s[24:27], s66 offen  lds
    s_add_u32 s66, s66, 20480
    s_mov_b32 m0, s67
    s_add_u32 s67, s67, 1024
    buffer_load_dwordx4 v39, s[24:27], s66 offen  lds
    s_add_u32 s66, s66, 20480
    s_mov_b32 m0, s67
    s_add_u32 s67, s67, 1024
    buffer_load_dwordx4 v39, s[24:27], s66 offen  lds
    s_add_u32 s66, s66, 20480
    s_mov_b32 m0, s67
    s_add_u32 s67, s67, 1024
    buffer_load_dwordx4 v39, s[24:27], s66 offen  lds
    s_add_u32 s66, s66, 20480
    s_branch ATT_LAST
TAILF:
    s_lshl_b32 s90, s72, 3
    s_add_u32 s90, s90, s68
    s_mul_i32 s90, s90, 24
    s_add_u32 s90, s90, s69
    s_sub_u32 s90, s90, 8
    s_mul_i32 s90, s90, 10240
    buffer_load_dwordx4 a[240:243], v1, s[20:23], s90 offen offset:0
    buffer_load_dwordx4 a[240:243], v1, s[20:23], s90 offen offset:1024
    buffer_load_dwordx4 a[240:243], v1, s[20:23], s90 offen offset:2048
    buffer_load_dwordx4 a[240:243], v1, s[20:23], s90 offen offset:3072
    s_add_u32 s90, s90, 4096
    buffer_load_dwordx4 a[240:243], v1, s[20:23], s90 offen offset:0
    buffer_load_dwordx4 a[240:243], v1, s[20:23], s90 offen offset:1024
    buffer_load_dwordx4 a[240:243], v1, s[20:23], s90 offen offset:2048
    s_waitcnt lgkmcnt(0)
    v_smfmac_f32_16x16x64_bf16 v[40:43], v[80:83], v[160:167], v14 abid:1
    v_smfmac_f32_16x16x64_bf16 v[44:47], v[80:83], v[168:175], v14 abid:1
    v_smfmac_f32_16x16x64_bf16 v[48:51], v[80:83], v[176:183], v14 abid:1
    v_smfmac_f32_16x16x64_bf16 v[52:55], v[80:83], v[184:191], v14 abid:1
    v_smfmac_f32_16x16x64_bf16 v[56:59], v[80:83], v[192:199], v14 abid:1
    v_smfmac_f32_16x16x64_bf16 v[60:63], v[80:83], v[200:207], v14 abid:1
    s_waitcnt vmcnt(13)
    ds_write_b128 v2, v[232:235] offset:0
    ds_write_b128 v3, v[236:239] offset:0
    ds_write_b128 v4, v[240:243] offset:0
    ds_write_b128 v2, v[244:247] offset:3328
    ds_write_b128 v3, v[248:251] offset:3328
    ds_write_b128 v4, v[252:255] offset:3328
    ds_read_b64_tr_b16 v[208:209], v6 offset:0
    ds_read_b64_tr_b16 v[212:213], v6 offset:32
    ds_read_b64_tr_b16 v[216:217], v6 offset:64
    ds_read_b64_tr_b16 v[220:221], v6 offset:96
    ds_read_b64_tr_b16 v[224:225], v6 offset:128
    ds_read_b64_tr_b16 v[228:229], v6 offset:160
    ds_read_b64_tr_b16 v[232:233], v6 offset:192
    ds_read_b64_tr_b16 v[236:237], v6 offset:224
    ds_read_b64_tr_b16 v[240:241], v6 offset:256
    ds_read_b64_tr_b16 v[244:245], v6 offset:288
    ds_read_b64_tr_b16 v[248:249], v6 offset:320
    ds_read_b64_tr_b16 v[252:253], v6 offset:352
    buffer_load_dwordx4 a[240:243], v1, s[20:23], s90 offen offset:3072
    s_add_u32 s90, s90, 4096
    buffer_load_dwordx4 a[240:243], v1, s[20:23], s90 offen offset:0
    buffer_load_dwordx4 a[240:243], v1, s[20:23], s90 offen offset:1024
    s_waitcnt vmcnt(15)
    ds_write_b128 v2, v[88:91] offset:0
    s_waitcnt vmcnt(14)
    ds_write_b128 v3, v[92:95] offset:0
    s_waitcnt vmcnt(13)
    ds_write_b128 v4, v[96:99] offset:0
    s_waitcnt vmcnt(12)
    ds_write_b128 v2, v[100:103] offset:3328
    s_waitcnt vmcnt(11)
    ds_write_b128 v3, v[104:107] offset:3328
    s_waitcnt vmcnt(10)
    ds_write_b128 v4, v[108:111] offset:3328
    ds_read_b64_tr_b16 v[210:211], v6 offset:0
    ds_read_b64_tr_b16 v[214:215], v6 offset:32
    ds_read_b64_tr_b16 v[218:219], v6 offset:64
    ds_read_b64_tr_b16 v[222:223], v6 offset:96
    ds_read_b64_tr_b16 v[226:227], v6 offset:128
    ds_read_b64_tr_b16 v[230:231], v6 offset:160
    ds_read_b64_tr_b16 v[234:235], v6 offset:192
    ds_read_b64_tr_b16 v[238:239], v6 offset:224
    ds_read_b64_tr_b16 v[242:243], v6 offset:256
    ds_read_b64_tr_b16 v[246:247], v6 offset:288
    ds_read_b64_tr_b16 v[250:251], v6 offset:320
    ds_read_b64_tr_b16 v[254:255], v6 offset:352
    s_branch ATT_LAST
LOOP:
    ds_read_b64_tr_b16 v[40:41], v16 offset:0
    ds_read_b64_tr_b16 v[42:43], v16 offset:1536
    ds_read_b64_tr_b16 v[44:45], v16 offset:12288
    ds_read_b64_tr_b16 v[46:47], v16 offset:13824
    ds_read_b64_tr_b16 v[48:49], v17 offset:24576
    ds_read_b64_tr_b16 v[50:51], v16 offset:32
    ds_read_b64_tr_b16 v[52:53], v16 offset:1568
    ds_read_b64_tr_b16 v[54:55], v16 offset:12320
    ds_read_b64_tr_b16 v[56:57], v16 offset:13856
    ds_read_b64_tr_b16 v[58:59], v17 offset:24608
    ds_read_b64_tr_b16 v[60:61], v16 offset:64
    ds_read_b64_tr_b16 v[62:63], v16 offset:1600
    ds_read_b64_tr_b16 v[64:65], v16 offset:12352
    ds_read_b64_tr_b16 v[66:67], v16 offset:13888
    ds_read_b64_tr_b16 v[68:69], v17 offset:24640
    v_and_b32 v25, 15, v0
    v_cmp_eq_u32 vcc, 12, v25
    v_mov_b32 v36, 0x3f803f80
    s_nop 0
    v_cndmask_b32 v70, 0, v36, vcc
    v_mov_b32 v71, v70
    v_mov_b32 v72, v70
    v_mov_b32 v73, v70
    v_mov_b32 v74, v70
    v_mov_b32 v75, v70
    v_mov_b32 v76, v70
    v_mov_b32 v77, v70
    v_mov_b32 v78, v70
    v_mov_b32 v79, v70
    s_cmp_lt_u32 s69, 20
    s_cselect_b32 s5, s72, 0
    s_add_u32 s79, s3, 4096
    s_mul_i32 s77, s72, 6656
    v_mul_u32_u24 v26, 103, v0
    v_lshrrev_b32 v26, 10, v26
    v_lshl_add_u32 v26, v26, 4, v1
    v_add_u32 v26, s77, v26
    v_mul_u32_u24 v27, 176, v25
    v_add_u32 v27, s77, v27
    v_lshrrev_b32 v28, 4, v0
    v_lshl_add_u32 v29, v28, 3, v27
    v_lshl_add_u32 v27, v28, 4, v27
    s_mul_i32 s77, s71, 160
    s_add_u32 s77, s77, s3
    s_sub_u32 s77, s77, 640768
    s_waitcnt lgkmcnt(0)
    s_mov_b32 exec_lo, 0x3ff
    s_mov_b32 exec_hi, 0x0
    s_mov_b32 s76, 1
POLL4:
    buffer_load_dword v24, v1, s[16:19], s77 offen sc1
POLLW4:
    s_waitcnt vmcnt(0)
    v_cmp_eq_u32 vcc, -1, v24
    s_cbranch_vccnz AGAIN4
POLLX4:
    s_mov_b32 exec_lo, 0xffffffff
    s_mov_b32 exec_hi, 0xfffffff
    buffer_load_dwordx4 v[80:83], v8, s[16:19], 0 offen sc1
    buffer_load_dwordx4 v[84:87], v9, s[16:19], 0 offen sc1
    s_waitcnt vmcnt(0)
    v_max_u32 v24, v80, v84
    v_cmp_eq_u32 vcc, -1, v24
    s_cbranch_vccnz AGAIN5
POLLX5:
    ds_write_b128 v26, v[80:83]
    ds_write_b128 v26, v[84:87] offset:1056
    s_mov_b32 exec_lo, 0x1ff01ff
    s_mov_b32 exec_hi, 0x1ff01ff
    ds_read_b128 v[70:73], v27
    ds_read_b128 v[74:77], v27 offset:64
    ds_read_b64 v[78:79], v29 offset:128
    s_mov_b64 exec, -1
    s_cmp_lg_u32 s5, 1
    s_cbranch_scc1 NOOWL
    buffer_load_dword a244, v20, s[16:19], 0 offen sc1
    buffer_load_dword a245, v21, s[16:19], 0 offen sc1
NOOWL:
    s_waitcnt lgkmcnt(2)
    v_mfma_f32_16x16x32_bf16 v[24:27], v[70:73], v[40:43], 0
    v_mfma_f32_16x16x32_bf16 v[32:35], v[70:73], v[60:63], 0
    s_waitcnt lgkmcnt(0)
    v_mfma_f32_16x16x32_bf16 v[24:27], v[74:77], v[44:47], v[24:27]
    v_mfma_f32_16x16x32_bf16 v[32:35], v[74:77], v[64:67], v[32:35]
    v_mfma_f32_16x16x16_bf16 v[24:27], v[78:79], v[48:49], v[24:27]
    v_mfma_f32_16x16x16_bf16 v[32:35], v[78:79], v[68:69], v[32:35]
    v_mfma_f32_16x16x32_bf16 v[28:31], v[70:73], v[50:53], 0
    v_mfma_f32_16x16x32_bf16 v[36:39], v[70:73], v[70:73], 0
    v_mfma_f32_16x16x32_bf16 v[28:31], v[74:77], v[54:57], v[28:31]
    v_mfma_f32_16x16x32_bf16 v[36:39], v[74:77], v[74:77], v[36:39]
    v_mfma_f32_16x16x16_bf16 v[28:31], v[78:79], v[58:59], v[28:31]
    v_mfma_f32_16x16x16_bf16 v[36:39], v[78:79], v[78:79], v[36:39]
    s_nop 0
    v_add_f32 v24, v24, v25
    v_add_f32 v26, v26, v27
    v_add_f32 v24, v24, v26
    v_add_f32 v32, v32, v33
    v_add_f32 v34, v34, v35
    v_add_f32 v32, v32, v34
    s_nop 1
    v_permlane32_swap_b32 v24, v32
    v_add_f32 v28, v28, v29
    v_add_f32 v30, v30, v31
    v_add_f32 v36, v36, v37
    v_add_f32 v38, v38, v39
    v_add_f32 v24, v24, v32
    v_add_f32 v28, v28, v30
    v_add_f32 v36, v36, v38
    s_nop 1
    v_permlane32_swap_b32 v28, v36
    v_add_f32 v28, v28, v36
    s_nop 1
    v_permlane16_swap_b32 v24, v28
    v_add_f32 v24, v24, v28
    s_cmp_eq_u32 s75, 1
    s_cbranch_scc0 SLOW6
    buffer_store_dword v24, v10, s[16:19], s3 offen
BACK6:
    v_mov_b32 v40, 0
    v_mov_b32 v41, 0
    v_mov_b32 v44, 0
    v_mov_b32 v45, 0
    v_mov_b32 v48, 0
    v_mov_b32 v49, 0
    v_mov_b32 v52, 0
    v_mov_b32 v53, 0
    v_mov_b32 v56, 0
    v_mov_b32 v57, 0
    v_mov_b32 v60, 0
    v_mov_b32 v61, 0
    v_mov_b32 v64, 0
    v_mov_b32 v65, 0
    v_mov_b32 v68, 0
    v_mov_b32 v69, 0
    v_mov_b32 v72, 0
    v_mov_b32 v73, 0
    v_mov_b32 v74, 0
    v_mov_b32 v75, 0
    v_mov_b32 v76, 0
    v_mov_b32 v77, 0
    v_mov_b32 v78, 0
    v_mov_b32 v79, 0
    v_mov_b32 v80, 0
    v_mov_b32 v81, 0
    v_mov_b32 v82, 0
    v_mov_b32 v83, 0
    v_mov_b32 v84, 0
    v_mov_b32 v85, 0
    v_mov_b32 v86, 0
    v_mov_b32 v87, 0
    s_mov_b32 s76, 1
POLL7:
    buffer_load_dwordx4 v[24:27], v11, s[16:19], s3 offen sc1
    buffer_load_dwordx4 v[28:31], v11, s[16:19], s79 offen sc1
POLLW7:
    s_waitcnt vmcnt(0)
    v_max3_u32 v32, v24, v25, v26
    v_max3_u32 v32, v32, v27, v28
    v_max3_u32 v32, v32, v29, v30
    v_max_u32 v32, v32, v31
    v_cmp_eq_u32 vcc, -1, v32
    s_cbranch_vccnz AGAIN7
POLLX7:
    v_add_f32 v24, v24, v28
    v_add_f32 v25, v25, v29
    v_add_f32 v26, v26, v30
    v_add_f32 v27, v27, v31
    s_nop 0
    v_permlane32_swap_b32 v24, v26
    v_permlane32_swap_b32 v25, v27
    v_add_f32 v24, v24, v26
    v_add_f32 v25, v25, v27
    s_nop 1
    v_permlane16_swap_b32 v24, v25
    v_add_f32 v24, v24, v25
    s_nop 0
    v_readlane_b32 s77, v24, 15
    s_mov_b32 vcc_lo, 0x70007000
    s_mov_b32 vcc_hi, 0x70007000
    v_fma_f32 v25, -s77, v7, v24
    v_cvt_pk_bf16_f32 v25, v25, v25
    ds_write_b16 v12, v25
    v_cndmask_b32 v26, 0, v24, vcc
    s_nop 1
    v_add_f32_dpp v26, v26, v26 quad_perm:[1,0,3,2] row_mask:0xf bank_mask:0xf
    s_nop 1
    v_add_f32_dpp v26, v26, v26 quad_perm:[2,3,0,1] row_mask:0xf bank_mask:0xf
    v_mov_b32 v27, v26
    s_nop 1
    v_permlane32_swap_b32 v26, v27
    v_add_f32 v26, v26, v27
    s_waitcnt lgkmcnt(0)
    s_barrier
    ds_read_b128 v[28:31], v13 offset:0
    ds_read_b128 v[32:35], v13 offset:128
    ds_read_b128 v[36:39], v13 offset:256
    v_mov_b32 v27, v26
    v_mov_b32 v25, s77
    v_subrev_f32 v25, 0x44200000, v25
    v_permlane16_swap_b32 v26, v27
    v_add_f32 v26, v26, v27
    v_mul_f32 v24, 0x3acccccd, v25
    v_readlane_b32 s77, v26, 15
    v_mul_f32 v24, v24, v24
    s_mov_b32 s78, 0x3acccccd
    v_sub_f32 v26, s77, v25
    v_fma_f32 v26, v26, s78, -v24
    v_max_f32 v26, 0, v26
    v_add_f32 v26, 0x3727c5ac, v26
    v_rsq_f32 v26, v26
    s_nop 0
    v_mul_f32 v18, 0x3dd53b94, v26
    s_waitcnt lgkmcnt(2)
    v_smfmac_f32_16x16x64_bf16 v[40:43], v[28:31], a[0:7], v14
    v_smfmac_f32_16x16x64_bf16 v[56:59], v[28:31], a[96:103], v14
    v_smfmac_f32_16x16x64_bf16 v[44:47], v[28:31], a[24:31], v14
    v_smfmac_f32_16x16x64_bf16 v[60:63], v[28:31], a[120:127], v14
    v_smfmac_f32_16x16x64_bf16 v[48:51], v[28:31], a[48:55], v14
    v_smfmac_f32_16x16x64_bf16 v[64:67], v[28:31], a[144:151], v14
    v_smfmac_f32_16x16x64_bf16 v[52:55], v[28:31], a[72:79], v14
    v_smfmac_f32_16x16x64_bf16 v[68:71], v[28:31], a[168:175], v14
    s_waitcnt lgkmcnt(1)
    v_smfmac_f32_16x16x64_bf16 v[40:43], v[32:35], a[8:15], v14
    v_smfmac_f32_16x16x64_bf16 v[56:59], v[32:35], a[104:111], v14
    v_smfmac_f32_16x16x64_bf16 v[44:47], v[32:35], a[32:39], v14
    v_smfmac_f32_16x16x64_bf16 v[60:63], v[32:35], a[128:135], v14
    v_smfmac_f32_16x16x64_bf16 v[48:51], v[32:35], a[56:63], v14
    v_smfmac_f32_16x16x64_bf16 v[64:67], v[32:35], a[152:159], v14
    v_smfmac_f32_16x16x64_bf16 v[52:55], v[32:35], a[80:87], v14
    v_smfmac_f32_16x16x64_bf16 v[68:71], v[32:35], a[176:183], v14
    s_waitcnt lgkmcnt(0)
    v_smfmac_f32_16x16x64_bf16 v[40:43], v[36:39], a[16:23], v14
    v_smfmac_f32_16x16x64_bf16 v[56:59], v[36:39], a[112:119], v14
    v_smfmac_f32_16x16x64_bf16 v[44:47], v[36:39], a[40:47], v14
    v_smfmac_f32_16x16x64_bf16 v[60:63], v[36:39], a[136:143], v14
    v_smfmac_f32_16x16x64_bf16 v[48:51], v[36:39], a[64:71], v14
    v_smfmac_f32_16x16x64_bf16 v[64:67], v[36:39], a[160:167], v14
    v_smfmac_f32_16x16x64_bf16 v[52:55], v[36:39], a[88:95], v14
    v_smfmac_f32_16x16x64_bf16 v[68:71], v[36:39], a[184:191], v14
    s_lshl_b32 s78, s72, 8
    v_add_f32_dpp v24, v40, v41 quad_perm:[0,1,2,3] row_mask:0x1 bank_mask:0xf
    v_add_f32_dpp v25, v56, v57 quad_perm:[0,1,2,3] row_mask:0x1 bank_mask:0xf
    v_bfe_u32 v27, v0, 4, 1
    v_add_f32_dpp v24, v44, v45 quad_perm:[0,1,2,3] row_mask:0x2 bank_mask:0xf
    v_add_f32_dpp v25, v60, v61 quad_perm:[0,1,2,3] row_mask:0x2 bank_mask:0xf
    v_bfe_u32 v28, v0, 2, 1
    v_add_f32_dpp v24, v48, v49 quad_perm:[0,1,2,3] row_mask:0x4 bank_mask:0xf
    v_add_f32_dpp v25, v64, v65 quad_perm:[0,1,2,3] row_mask:0x4 bank_mask:0xf
    s_add_u32 s78, s78, 124416
    v_add_f32_dpp v24, v52, v53 quad_perm:[0,1,2,3] row_mask:0x8 bank_mask:0xf
    v_add_f32_dpp v25, v68, v69 quad_perm:[0,1,2,3] row_mask:0x8 bank_mask:0xf
    v_max_f32 v26, v24, v25
    v_lshl_add_u32 v27, v27, 5, s78
    v_lshl_add_u32 v27, v28, 4, v27
    v_max_f32_dpp v26, v26, v26 row_ror:8 row_mask:0xf bank_mask:0xf
    s_nop 1
    v_max_f32_dpp v26, v26, v26 row_ror:4 row_mask:0xf bank_mask:0xf
    s_nop 1
    v_max_f32_dpp v26, v26, v26 row_ror:2 row_mask:0xf bank_mask:0xf
    s_nop 1
    v_max_f32_dpp v26, v26, v26 row_ror:1 row_mask:0xf bank_mask:0xf
    v_mov_b32 v28, v26
    s_nop 1
    v_permlane32_swap_b32 v26, v28
    v_max_f32 v26, v26, v28
    v_mov_b32 v28, v26
    s_nop 1
    v_permlane16_swap_b32 v26, v28
    v_max_f32 v26, v26, v28
    v_mul_f32 v26, v26, v18
    v_fma_f32 v24, v24, v18, -v26
    v_fma_f32 v25, v25, v18, -v26
    v_exp_f32 v24, v24
    v_exp_f32 v25, v25
    s_nop 0
    v_cvt_pk_bf16_f32 v28, v24, v25
    ds_write_b16 v19, v28
    ds_write_b16_d16_hi v19, v28 offset:128
    s_mov_b32 exec_lo, 0xff00ff
    s_mov_b32 exec_hi, 0xff00ff00
    ds_read_b128 v[72:75], v27 offset:0
    ds_read_b128 v[76:79], v27 offset:64
    ds_read_b128 v[80:83], v27 offset:128
    ds_read_b128 v[84:87], v27 offset:192
    s_mov_b64 exec, -1
    v_add_f32 v27, v24, v25
    v_mov_b32 v40, 0
    v_mov_b32 v44, 0
    v_add_f32_dpp v27, v27, v27 row_ror:8 row_mask:0xf bank_mask:0xf
    v_mov_b32 v48, 0
    v_mov_b32 v52, 0
    v_add_f32_dpp v27, v27, v27 row_ror:4 row_mask:0xf bank_mask:0xf
    v_mov_b32 v56, 0
    v_mov_b32 v60, 0
    v_add_f32_dpp v27, v27, v27 row_ror:2 row_mask:0xf bank_mask:0xf
    s_lshl_b32 s78, s72, 3
    s_add_u32 s78, s78, 125440
    v_add_f32_dpp v27, v27, v27 row_ror:1 row_mask:0xf bank_mask:0xf
    v_mov_b32 v28, v27
    s_nop 1
    v_permlane32_swap_b32 v27, v28
    v_add_f32 v27, v27, v28
    v_mov_b32 v28, v27
    s_nop 1
    v_permlane16_swap_b32 v27, v28
    v_add_f32 v27, v27, v28
    v_mov_b32 v28, s78
    ds_write_b64 v28, v[26:27]
    s_waitcnt lgkmcnt(4)
    v_smfmac_f32_16x16x64_bf16 v[40:43], v[72:75], a[192:199], v14 abid:1
    v_smfmac_f32_16x16x64_bf16 v[44:47], v[72:75], a[200:207], v14 abid:1
    v_smfmac_f32_16x16x64_bf16 v[48:51], v[72:75], a[208:215], v14 abid:1
    v_smfmac_f32_16x16x64_bf16 v[52:55], v[72:75], a[216:223], v14 abid:1
    v_smfmac_f32_16x16x64_bf16 v[56:59], v[72:75], a[224:231], v14 abid:1
    v_smfmac_f32_16x16x64_bf16 v[60:63], v[72:75], a[232:239], v14 abid:1
    s_waitcnt lgkmcnt(3)
    v_smfmac_f32_16x16x64_bf16 v[40:43], v[76:79], v[112:119], v14 abid:1
    v_smfmac_f32_16x16x64_bf16 v[44:47], v[76:79], v[120:127], v14 abid:1
    v_smfmac_f32_16x16x64_bf16 v[48:51], v[76:79], v[128:135], v14 abid:1
    v_smfmac_f32_16x16x64_bf16 v[52:55], v[76:79], v[136:143], v14 abid:1
    v_smfmac_f32_16x16x64_bf16 v[56:59], v[76:79], v[144:151], v14 abid:1
    v_smfmac_f32_16x16x64_bf16 v[60:63], v[76:79], v[152:159], v14 abid:1
    s_waitcnt lgkmcnt(2)
    v_smfmac_f32_16x16x64_bf16 v[40:43], v[80:83], v[160:167], v14 abid:1
    v_smfmac_f32_16x16x64_bf16 v[44:47], v[80:83], v[168:175], v14 abid:1
    v_smfmac_f32_16x16x64_bf16 v[48:51], v[80:83], v[176:183], v14 abid:1
    v_smfmac_f32_16x16x64_bf16 v[52:55], v[80:83], v[184:191], v14 abid:1
    v_smfmac_f32_16x16x64_bf16 v[56:59], v[80:83], v[192:199], v14 abid:1
    v_smfmac_f32_16x16x64_bf16 v[60:63], v[80:83], v[200:207], v14 abid:1
    s_waitcnt lgkmcnt(0)
ATT_LAST:
    s_waitcnt lgkmcnt(8)
    v_smfmac_f32_16x16x64_bf16 v[40:43], v[84:87], v[208:215], v14 abid:1
    v_smfmac_f32_16x16x64_bf16 v[44:47], v[84:87], v[216:223], v14 abid:1
    s_waitcnt lgkmcnt(4)
    v_smfmac_f32_16x16x64_bf16 v[48:51], v[84:87], v[224:231], v14 abid:1
    v_smfmac_f32_16x16x64_bf16 v[52:55], v[84:87], v[232:239], v14 abid:1
    s_waitcnt lgkmcnt(0)
    v_smfmac_f32_16x16x64_bf16 v[56:59], v[84:87], v[240:247], v14 abid:1
    v_smfmac_f32_16x16x64_bf16 v[60:63], v[84:87], v[248:255], v14 abid:1
    v_add_u32 v24, 119296, v1
    v_mov_b32 v25, 125440
    v_lshlrev_b32 v39, 6, v0
    v_permlane16_swap_b32 v40, v44
    v_add_f32 v40, v40, v44
    ds_write_b32 v15, v40 offset:0
    v_permlane16_swap_b32 v48, v52
    v_add_f32 v48, v48, v52
    ds_write_b32 v15, v48 offset:256
    v_permlane16_swap_b32 v56, v60
    v_add_f32 v56, v56, v60
    ds_write_b32 v15, v56 offset:512
    s_cmp_lg_u32 s72, 0
    s_waitcnt lgkmcnt(0)
    s_barrier
    s_cbranch_scc1 ONOT0
    ds_read_b128 v[64:67], v25
    ds_read_b128 v[68:71], v25 offset:16
    ds_read_b128 v[40:43], v24 offset:0
    ds_read_b128 v[44:47], v24 offset:768
    ds_read_b128 v[48:51], v24 offset:1536
    ds_read_b128 v[52:55], v24 offset:2304
    s_mul_i32 s77, s70, 3072
    s_lshl_b32 s78, s71, 4
    s_add_u32 s77, s77, s78
    s_add_u32 s77, s77, s3
    s_add_u32 s77, s77, 32768
    s_lshl_b32 s78, s69, 3
    s_add_u32 s78, s78, s3
    s_add_u32 s78, s78, 45056
    s_waitcnt lgkmcnt(4)
    v_max3_f32 v32, v64, v66, v68
    v_max_f32 v32, v32, v70
    v_sub_f32 v64, v64, v32
    v_sub_f32 v66, v66, v32
    v_sub_f32 v68, v68, v32
    v_sub_f32 v70, v70, v32
    v_exp_f32 v64, v64
    v_exp_f32 v66, v66
    v_exp_f32 v68, v68
    v_exp_f32 v70, v70
    s_waitcnt lgkmcnt(0)
    v_mul_f32 v28, v64, v40
    v_mul_f32 v29, v64, v41
    v_mul_f32 v30, v64, v42
    v_mul_f32 v31, v64, v43
    v_fmac_f32 v28, v66, v44
    v_fmac_f32 v29, v66, v45
    v_fmac_f32 v30, v66, v46
    v_fmac_f32 v31, v66, v47
    v_fmac_f32 v28, v68, v48
    v_fmac_f32 v29, v68, v49
    v_fmac_f32 v30, v68, v50
    v_fmac_f32 v31, v68, v51
    v_fmac_f32 v28, v70, v52
    v_fmac_f32 v29, v70, v53
    v_fmac_f32 v30, v70, v54
    v_fmac_f32 v31, v70, v55
    v_cvt_pk_bf16_f32 v28, v28, v29
    v_cvt_pk_bf16_f32 v29, v30, v31
    s_nop 0
    v_mov_b32_dpp v30, v28 quad_perm:[1,1,3,3] row_mask:0xf bank_mask:0xf
    v_mov_b32_dpp v31, v29 quad_perm:[1,1,3,3] row_mask:0xf bank_mask:0xf
    s_mov_b32 exec_lo, 0x55555555
    s_mov_b32 exec_hi, 0x5555
    s_cmp_eq_u32 s75, 1
    s_cbranch_scc0 SLOW8
    buffer_store_dwordx4 v[28:31], v39, s[16:19], s77 offen
BACK8:
    v_mul_f32 v33, v64, v65
    v_fmac_f32 v33, v66, v67
    v_fmac_f32 v33, v68, v69
    v_fmac_f32 v33, v70, v71
    s_mov_b64 exec, 1
    s_cmp_eq_u32 s75, 1
    s_cbranch_scc0 SLOW9
    buffer_store_dwordx2 v[32:33], v39, s[16:19], s78 offen
BACK9:
    s_mov_b64 exec, -1
    s_waitcnt vmcnt(2)
ODONE:
    s_cmp_ge_u32 s69, 20
    s_cbranch_scc1 ROLEF
    v_accvgpr_read_b32 v2, a246
    v_accvgpr_read_b32 v3, a247
    v_accvgpr_read_b32 v4, a248
    v_mov_b32 v88, 0
    v_mov_b32 v92, 0
    v_mov_b32 v96, 0
    v_mov_b32 v100, 0
    v_mov_b32 v104, 0
    v_mov_b32 v108, 0
    ds_read_b64_tr_b16 v[40:41], v2 offset:0
    ds_read_b64_tr_b16 v[42:43], v2 offset:256
    ds_read_b64_tr_b16 v[64:65], v2 offset:32
    ds_read_b64_tr_b16 v[66:67], v2 offset:288
    ds_read_b64_tr_b16 v[44:45], v2 offset:2048
    ds_read_b64_tr_b16 v[46:47], v2 offset:2304
    ds_read_b64_tr_b16 v[68:69], v2 offset:2080
    ds_read_b64_tr_b16 v[70:71], v2 offset:2336
    ds_read_b64_tr_b16 v[48:49], v2 offset:4096
    ds_read_b64_tr_b16 v[50:51], v2 offset:4352
    s_cmp_lg_u32 s72, 1
    s_cbranch_scc1 NOOWN0
    s_cmp_eq_u32 s74, 0
    s_cbranch_scc1 NOOWN0
    v_accvgpr_read_b32 v28, a244
    v_accvgpr_read_b32 v29, a245
    v_max_u32 v30, v28, v29
    v_cmp_eq_u32 vcc, -1, v30
    s_cbranch_vccnz RETRY10
OK10:
    v_lshlrev_b32 v30, 16, v28
    v_and_b32 v28, 0xffff0000, v28
    v_lshlrev_b32 v31, 16, v29
    v_and_b32 v29, 0xffff0000, v29
    v_add_f32 v30, v30, v31
    v_add_f32 v28, v28, v29
    v_mov_b32 v31, v30
    v_mov_b32 v29, v28
    s_nop 0
    v_permlane32_swap_b32 v30, v31
    v_permlane32_swap_b32 v28, v29
    v_add_f32 v30, v30, v31
    v_add_f32 v28, v28, v29
    v_mov_b32 v31, v30
    v_mov_b32 v29, v28
    s_nop 0
    v_permlane16_swap_b32 v30, v31
    v_permlane16_swap_b32 v28, v29
    v_add_f32 v30, v30, v31
    v_add_f32 v28, v28, v29
    v_add_f32 v22, v22, v30
    v_add_f32 v23, v23, v28
    v_cvt_pk_bf16_f32 v28, v22, v23
    s_lshl_b32 s77, s69, 6
    s_add_u32 s77, s77, s3
    s_add_u32 s77, s77, 48640
    v_lshlrev_b32 v37, 2, v0
    v_mov_b32_dpp v29, v28 quad_perm:[1,1,1,1] row_mask:0xf bank_mask:0xf
    v_mov_b32_dpp v30, v28 quad_perm:[2,2,2,2] row_mask:0xf bank_mask:0xf
    v_mov_b32_dpp v31, v28 quad_perm:[3,3,3,3] row_mask:0xf bank_mask:0xf
    s_mov_b32 exec_lo, 0x1111
    s_mov_b32 exec_hi, 0x0
    s_cmp_eq_u32 s75, 1
    s_cbranch_scc0 SLOW11
    buffer_store_dwordx4 v[28:31], v37, s[16:19], s77 offen
BACK11:
    s_mov_b64 exec, -1
NOOWN0:
    v_mov_b32 v25, 0
    v_mov_b32 v27, 0
    v_mov_b32 v37, 0
    v_mov_b32 v39, 0
    s_mov_b32 exec_lo, 0x00ff00ff
    s_mov_b32 exec_hi, 0x00ff00ff
    buffer_load_dwordx4 v[88:91], v3, s[16:19], s3 offen offset:0 sc1
    buffer_load_dwordx4 v[92:95], v3, s[16:19], s3 offen offset:512 sc1
    buffer_load_dwordx4 v[96:99], v3, s[16:19], s3 offen offset:1024 sc1
    buffer_load_dwordx4 v[100:103], v3, s[16:19], s3 offen offset:1536 sc1
    buffer_load_dwordx4 v[104:107], v3, s[16:19], s3 offen offset:2048 sc1
    buffer_load_dwordx4 v[108:111], v3, s[16:19], s3 offen offset:2560 sc1
    s_mov_b32 exec_lo, -1
    s_mov_b32 exec_hi, 0
    buffer_load_dwordx4 v[24:27], v4, s[16:19], s3 offen offset:0 sc1
    buffer_load_dwordx4 v[36:39], v4, s[16:19], s3 offen offset:16 sc1
    s_mov_b64 exec, -1
    ds_read_b64_tr_b16 v[72:73], v2 offset:4128
    ds_read_b64_tr_b16 v[74:75], v2 offset:4384
    ds_read_b64_tr_b16 v[52:53], v2 offset:6144
    ds_read_b64_tr_b16 v[54:55], v2 offset:6400
    ds_read_b64_tr_b16 v[76:77], v2 offset:6176
    ds_read_b64_tr_b16 v[78:79], v2 offset:6432
    ds_read_b64_tr_b16 v[56:57], v2 offset:8192
    ds_read_b64_tr_b16 v[58:59], v2 offset:8448
    ds_read_b64_tr_b16 v[80:81], v2 offset:8224
    ds_read_b64_tr_b16 v[82:83], v2 offset:8480
    ds_read_b64_tr_b16 v[60:61], v2 offset:10240
    ds_read_b64_tr_b16 v[62:63], v2 offset:10496
    ds_read_b64_tr_b16 v[84:85], v2 offset:10272
    ds_read_b64_tr_b16 v[86:87], v2 offset:10528
    v_accvgpr_read_b32 v5, a249
    v_add_u32 v6, 119296, v1
    v_lshrrev_b32 v18, 1, v1
    s_waitcnt vmcnt(0)
    v_max3_u32 v28, v88, v92, v96
    v_max3_u32 v28, v28, v100, v104
    v_max3_u32 v28, v28, v108, v25
    v_max3_u32 v28, v28, v27, v37
    v_max_u32 v28, v28, v39
    v_cmp_eq_u32 vcc, -1, v28
    s_cbranch_vccnz AGAIN12
POLLX12:
    s_waitcnt lgkmcnt(0)
    v_mfma_f32_16x16x32_bf16 v[28:31], v[88:91], v[40:43], 0
    v_mfma_f32_16x16x32_bf16 v[32:35], v[88:91], v[64:67], 0
    v_max3_f32 v88, v24, v26, v36
    v_max_f32 v88, v88, v38
    v_mfma_f32_16x16x32_bf16 v[28:31], v[92:95], v[44:47], v[28:31]
    v_mov_b32 v89, v88
    v_mfma_f32_16x16x32_bf16 v[32:35], v[92:95], v[68:71], v[32:35]
    s_nop 0
    v_permlane16_swap_b32 v88, v89
    v_max_f32 v88, v88, v89
    v_mfma_f32_16x16x32_bf16 v[28:31], v[96:99], v[48:51], v[28:31]
    v_sub_f32 v24, v24, v88
    v_sub_f32 v26, v26, v88
    v_mfma_f32_16x16x32_bf16 v[32:35], v[96:99], v[72:75], v[32:35]
    v_sub_f32 v36, v36, v88
    v_sub_f32 v38, v38, v88
    v_mfma_f32_16x16x32_bf16 v[28:31], v[100:103], v[52:55], v[28:31]
    v_exp_f32 v24, v24
    v_mfma_f32_16x16x32_bf16 v[32:35], v[100:103], v[76:79], v[32:35]
    v_exp_f32 v26, v26
    v_mfma_f32_16x16x32_bf16 v[28:31], v[104:107], v[56:59], v[28:31]
    v_exp_f32 v36, v36
    v_mfma_f32_16x16x32_bf16 v[32:35], v[104:107], v[80:83], v[32:35]
    v_exp_f32 v38, v38
    v_mfma_f32_16x16x32_bf16 v[28:31], v[108:111], v[60:63], v[28:31]
    v_mul_f32 v90, v24, v25
    v_fmac_f32 v90, v26, v27
    v_mfma_f32_16x16x32_bf16 v[32:35], v[108:111], v[84:87], v[32:35]
    v_fmac_f32 v90, v36, v37
    v_fmac_f32 v90, v38, v39
    v_mov_b32 v89, v90
    s_cmp_lg_u32 s72, 0
    s_nop 0
    v_permlane16_swap_b32 v90, v89
    v_add_f32 v90, v90, v89
    v_rcp_f32 v90, v90
    v_mul_f32 v28, v24, v28
    v_mul_f32 v32, v24, v32
    v_fmac_f32 v28, v26, v29
    v_fmac_f32 v32, v26, v33
    v_fmac_f32 v28, v36, v30
    v_fmac_f32 v32, v36, v34
    v_fmac_f32 v28, v38, v31
    v_fmac_f32 v32, v38, v35
    s_nop 1
    v_permlane16_swap_b32 v28, v32
    v_add_f32 v28, v28, v32
    v_mul_f32 v28, v28, v90
    ds_write_b32 v5, v28
    s_waitcnt lgkmcnt(0)
    s_barrier
    s_cbranch_scc1 WNOT0
    ds_read_b128 v[40:43], v6 offset:3072
    ds_read_b128 v[44:47], v6 offset:3328
    ds_read_b128 v[48:51], v6 offset:3584
    ds_read_b128 v[52:55], v6 offset:3840
    s_waitcnt lgkmcnt(2)
    v_add_f32 v28, v40, v44
    v_add_f32 v29, v41, v45
    v_add_f32 v30, v42, v46
    v_add_f32 v31, v43, v47
    s_waitcnt lgkmcnt(0)
    v_add_f32 v32, v48, v52
    v_add_f32 v33, v49, v53
    v_add_f32 v34, v50, v54
    v_add_f32 v35, v51, v55
    v_add_f32 v28, v28, v32
    v_add_f32 v29, v29, v33
    v_add_f32 v30, v30, v34
    v_add_f32 v31, v31, v35
    v_cvt_pk_bf16_f32 v28, v28, v29
    v_cvt_pk_bf16_f32 v29, v30, v31
    s_nop 0
    v_mov_b32_dpp v30, v28 quad_perm:[1,1,3,3] row_mask:0xf bank_mask:0xf
    v_mov_b32_dpp v31, v29 quad_perm:[1,1,3,3] row_mask:0xf bank_mask:0xf
    s_mov_b32 exec_lo, 0x55
    s_mov_b32 exec_hi, 0x0
    buffer_store_dwordx4 v[28:31], v18, s[16:19], s80 offen sc1
    s_cmp_eq_u32 s75, 1
    s_cbranch_scc0 SLOW13
    buffer_store_dwordx4 v[28:31], v18, s[16:19], s81 offen
BACK13:
    s_mov_b64 exec, -1
    v_lshrrev_b32 v37, 5, v0
    v_mul_u32_u24 v37, 2560, v37
    v_and_b32 v38, 31, v0
    v_lshl_add_u32 v37, v38, 2, v37
    v_add_u32 v41, 5120, v37
    v_add_u32 v42, 10240, v37
    v_add_u32 v43, 15360, v37
    v_add_u32 v44, 20480, v37
    v_add_u32 v45, 25600, v37
    s_lshl_b32 s79, s69, 7
    s_add_u32 s79, s79, s3
    s_add_u32 s79, s79, 51200
    s_add_u32 s96, s80, 10240
    s_add_u32 s97, s81, 1280
    v_lshlrev_b32 v39, 1, v0
    s_cmp_lg_u32 s74, 0
    s_cbranch_scc1 NOLC
    s_mul_i32 s77, s69, 2464
    s_add_u32 s78, s3, 720896
    v_add_u32 v48, s77, v1
    v_min_u32 v48, 49136, v48
    s_add_u32 s77, s77, 1024
    v_add_u32 v49, s77, v1
    v_min_u32 v49, 49136, v49
    s_add_u32 s77, s77, 1024
    v_add_u32 v50, s77, v1
    v_min_u32 v50, 49136, v50
    s_add_u32 s77, s77, 1024
    buffer_load_dwordx4 a[240:243], v48, s[16:19], s78 offen sc1
    buffer_load_dwordx4 a[240:243], v49, s[16:19], s78 offen sc1
    buffer_load_dwordx4 a[240:243], v50, s[16:19], s78 offen sc1
    v_mov_b32 v52, -1
    v_mov_b32 v53, -1
    v_mov_b32 v54, -1
    v_mov_b32 v55, -1
    s_add_u32 s77, s80, 688128
    s_add_u32 s7, s96, 688128
    s_waitcnt vmcnt(0)
    s_cmp_eq_u32 s75, 1
    s_cbranch_scc0 SLOW14
    buffer_store_dwordx4 v[52:55], v48, s[16:19], s78 offen
BACK14:
    s_cmp_eq_u32 s75, 1
    s_cbranch_scc0 SLOW15
    buffer_store_dwordx4 v[52:55], v49, s[16:19], s78 offen
BACK15:
    s_cmp_eq_u32 s75, 1
    s_cbranch_scc0 SLOW16
    buffer_store_dwordx4 v[52:55], v50, s[16:19], s78 offen
BACK16:
    s_mov_b64 exec, 15
    buffer_store_dwordx4 v[52:55], v1, s[16:19], s77 offen sc1
    buffer_store_dwordx4 v[52:55], v1, s[16:19], s7 offen sc1
    s_mov_b64 exec, -1
NOLC:
    s_mov_b32 s76, 1
POLL17:
    buffer_load_dword v28, v37, s[16:19], s79 offen sc1
    buffer_load_dword v29, v41, s[16:19], s79 offen sc1
    buffer_load_dword v30, v42, s[16:19], s79 offen sc1
    buffer_load_dword v31, v43, s[16:19], s79 offen sc1
    buffer_load_dword v32, v44, s[16:19], s79 offen sc1
    buffer_load_dword v33, v45, s[16:19], s79 offen sc1
POLLW17:
    s_waitcnt vmcnt(0)
    v_max3_u32 v36, v28, v29, v30
    v_max3_u32 v36, v36, v31, v32
    v_max_u32 v36, v36, v33
    v_cmp_eq_u32 vcc, -1, v36
    s_cbranch_vccnz AGAIN17
POLLX17:
    v_add_f32 v28, v28, v29
    v_add_f32 v30, v30, v31
    v_add_f32 v32, v32, v33
    v_add_f32 v28, v28, v30
    v_add_f32 v28, v28, v32
    v_mov_b32 v29, v28
    s_nop 1
    v_permlane32_swap_b32 v28, v29
    v_add_f32 v28, v28, v29
    s_nop 1
    v_mov_b32_dpp v29, v28 row_shl:1 row_mask:0xf bank_mask:0xf
    v_cvt_pk_bf16_f32 v28, v28, v29
    s_nop 1
    v_mov_b32_dpp v29, v28 row_shl:2 row_mask:0xf bank_mask:0xf
    v_mov_b32_dpp v30, v28 row_shl:4 row_mask:0xf bank_mask:0xf
    v_mov_b32_dpp v31, v28 row_shl:6 row_mask:0xf bank_mask:0xf
    s_mov_b32 exec_lo, 0x1010101
    s_mov_b32 exec_hi, 0x0
    buffer_store_dwordx4 v[28:31], v39, s[16:19], s96 offen sc1
    s_cmp_eq_u32 s75, 1
    s_cbranch_scc0 SLOW18
    buffer_store_dwordx4 v[28:31], v39, s[16:19], s97 offen
BACK18:
    s_mov_b64 exec, -1
    s_branch NEXT
AGAIN4:
    s_add_u32 s76, s76, 1
    s_cmp_lt_u32 s76, 32768
    s_cbranch_scc1 POLL4
    s_branch POLLX4
AGAIN5:
    s_mov_b64 s[94:95], exec
    s_mov_b32 s76, 1
AG25:
    v_cmp_eq_u32 vcc, -1, v80
    s_nop 0
    s_mov_b64 exec, vcc
    s_cbranch_execz AG35_0
    buffer_load_dwordx4 v[80:83], v8, s[16:19], 0 offen sc1
AG35_0:
    s_mov_b64 exec, s[94:95]
    v_cmp_eq_u32 vcc, -1, v84
    s_nop 0
    s_mov_b64 exec, vcc
    s_cbranch_execz AG35_1
    buffer_load_dwordx4 v[84:87], v9, s[16:19], 0 offen sc1
AG35_1:
    s_mov_b64 exec, s[94:95]
    s_add_u32 s76, s76, 1
    s_cmp_ge_u32 s76, 32768
    s_waitcnt vmcnt(0)
    v_max_u32 v24, v80, v84
    v_cmp_eq_u32 vcc, -1, v24
    s_cbranch_vccz POLLX5
    s_cbranch_scc0 AG25
    s_branch POLLX5
AGAIN7:
    s_add_u32 s76, s76, 1
    s_cmp_lt_u32 s76, 32768
    s_cbranch_scc1 POLL7
    s_branch POLLX7
ONOT0:
    s_waitcnt vmcnt(0)
    s_branch ODONE
AGAIN12:
    s_mov_b64 s[94:95], exec
    s_mov_b32 s76, 1
AG212:
    v_max3_u32 v28, v88, v92, v96
    v_max3_u32 v28, v28, v100, v104
    v_max_u32 v28, v28, v108
    v_cmp_eq_u32 vcc, -1, v28
    s_nop 0
    s_mov_b64 exec, vcc
    s_cbranch_execz AG312_0
    buffer_load_dwordx4 v[88:91], v3, s[16:19], s3 offen offset:0 sc1
    buffer_load_dwordx4 v[92:95], v3, s[16:19], s3 offen offset:512 sc1
    buffer_load_dwordx4 v[96:99], v3, s[16:19], s3 offen offset:1024 sc1
    buffer_load_dwordx4 v[100:103], v3, s[16:19], s3 offen offset:1536 sc1
    buffer_load_dwordx4 v[104:107], v3, s[16:19], s3 offen offset:2048 sc1
    buffer_load_dwordx4 v[108:111], v3, s[16:19], s3 offen offset:2560 sc1
AG312_0:
    s_mov_b64 exec, s[94:95]
    v_max3_u32 v28, v25, v27, v37
    v_max_u32 v28, v28, v39
    v_cmp_eq_u32 vcc, -1, v28
    s_nop 0
    s_mov_b64 exec, vcc
    s_cbranch_execz AG312_1
    buffer_load_dwordx4 v[24:27], v4, s[16:19], s3 offen offset:0 sc1
    buffer_load_dwordx4 v[36:39], v4, s[16:19], s3 offen offset:16 sc1
AG312_1:
    s_mov_b64 exec, s[94:95]
    s_add_u32 s76, s76, 1
    s_cmp_ge_u32 s76, 32768
    s_waitcnt vmcnt(0)
    v_max3_u32 v28, v88, v92, v96
    v_max3_u32 v28, v28, v100, v104
    v_max3_u32 v28, v28, v108, v25
    v_max3_u32 v28, v28, v27, v37
    v_max_u32 v28, v28, v39
    v_cmp_eq_u32 vcc, -1, v28
    s_cbranch_vccz POLLX12
    s_cbranch_scc0 AG212
    s_branch POLLX12
AGAIN17:
    s_add_u32 s76, s76, 1
    s_cmp_lt_u32 s76, 32768
    s_cbranch_scc1 POLL17
    s_branch POLLX17
WNOT0:
    s_cmp_lg_u32 s72, 1
    s_cbranch_scc1 NEXT
    v_and_b32 v25, 15, v0
    v_lshrrev_b32 v26, 4, v0
    v_mul_u32_u24 v37, 1280, v26
    v_add_u32 v37, 655360, v37
    s_mul_i32 s7, s68, 81920
    s_add_u32 s7, s7, 46080
    v_mov_b32 v38, s7
    v_cmp_eq_u32 vcc, s68, v26
    s_nop 1
    v_cndmask_b32 v37, v37, v38, vcc
    v_add_u32 v39, 4, v26
    v_mul_u32_u24 v38, 1280, v39
    v_add_u32 v38, 655360, v38
    s_mul_i32 s7, s68, 81920
    s_add_u32 s7, s7, 46080
    v_mov_b32 v28, s7
    v_cmp_eq_u32 vcc, s68, v39
    s_nop 1
    v_cndmask_b32 v38, v38, v28, vcc
    s_lshl_b32 s77, s69, 6
    s_add_u32 s77, s77, s74
    v_lshl_add_u32 v37, v25, 2, v37
    v_lshl_add_u32 v38, v25, 2, v38
    s_sleep 16
    s_mov_b32 s76, 1
POLL19:
    buffer_load_dword v28, v37, s[16:19], s77 offen sc1
    buffer_load_dword v29, v38, s[16:19], s77 offen sc1
POLLW19:
    s_waitcnt vmcnt(0)
    v_max_u32 v30, v28, v29
    v_cmp_eq_u32 vcc, -1, v30
    s_cbranch_vccnz AGAIN19
POLLX19:
    v_lshlrev_b32 v30, 16, v28
    v_and_b32 v28, 0xffff0000, v28
    v_lshlrev_b32 v31, 16, v29
    v_and_b32 v29, 0xffff0000, v29
    v_add_f32 v30, v30, v31
    v_add_f32 v28, v28, v29
    v_mov_b32 v31, v30
    v_mov_b32 v29, v28
    s_nop 0
    v_permlane32_swap_b32 v30, v31
    v_permlane32_swap_b32 v28, v29
    v_add_f32 v30, v30, v31
    v_add_f32 v28, v28, v29
    v_mov_b32 v31, v30
    v_mov_b32 v29, v28
    s_nop 0
    v_permlane16_swap_b32 v30, v31
    v_permlane16_swap_b32 v28, v29
    v_add_f32 v30, v30, v31
    v_add_f32 v28, v28, v29
    v_add_f32 v22, v22, v30
    v_add_f32 v23, v23, v28
    v_cvt_pk_bf16_f32 v28, v22, v23
    s_cmp_lg_u32 s74, 0
    s_cbranch_scc1 FINAL
    s_lshl_b32 s77, s69, 6
    s_add_u32 s77, s77, s3
    s_add_u32 s77, s77, 49920
    v_lshlrev_b32 v37, 2, v0
    v_mov_b32_dpp v29, v28 quad_perm:[1,1,1,1] row_mask:0xf bank_mask:0xf
    v_mov_b32_dpp v30, v28 quad_perm:[2,2,2,2] row_mask:0xf bank_mask:0xf
    v_mov_b32_dpp v31, v28 quad_perm:[3,3,3,3] row_mask:0xf bank_mask:0xf
    s_mov_b32 exec_lo, 0x1111
    s_mov_b32 exec_hi, 0x0
    s_cmp_eq_u32 s75, 1
    s_cbranch_scc0 SLOW20
    buffer_store_dwordx4 v[28:31], v37, s[16:19], s77 offen
BACK20:
    s_mov_b64 exec, -1
    s_branch NEXT
FINAL:
    s_cmp_lg_u32 s68, 0
    s_cbranch_scc1 DONE
    s_lshl_b32 s77, s69, 6
    v_lshlrev_b32 v37, 2, v0
    s_add_u32 s79, s77, s3
    s_add_u32 s79, s79, 47360
    s_mov_b64 exec, 15
    s_mov_b32 s76, 1
POLL21:
    buffer_load_dword v28, v1, s[16:19], s79 offen sc1
POLLW21:
    s_waitcnt vmcnt(0)
    v_cmp_eq_u32 vcc, -1, v28
    s_cbranch_vccnz AGAIN21
POLLX21:
    s_mov_b64 exec, -1
    s_mov_b32 s76, 1
POLL22:
    buffer_load_dword v28, v20, s[16:19], s74 offen sc1
    buffer_load_dword v29, v21, s[16:19], s74 offen sc1
POLLW22:
    s_waitcnt vmcnt(0)
    v_max_u32 v30, v28, v29
    v_cmp_eq_u32 vcc, -1, v30
    s_cbranch_vccnz AGAIN22
POLLX22:
    v_lshlrev_b32 v30, 16, v28
    v_and_b32 v28, 0xffff0000, v28
    v_lshlrev_b32 v31, 16, v29
    v_and_b32 v29, 0xffff0000, v29
    v_add_f32 v30, v30, v31
    v_add_f32 v28, v28, v29
    v_mov_b32 v31, v30
    v_mov_b32 v29, v28
    s_nop 0
    v_permlane32_swap_b32 v30, v31
    v_permlane32_swap_b32 v28, v29
    v_add_f32 v30, v30, v31
    v_add_f32 v28, v28, v29
    v_mov_b32 v31, v30
    v_mov_b32 v29, v28
    s_nop 0
    v_permlane16_swap_b32 v30, v31
    v_permlane16_swap_b32 v28, v29
    v_add_f32 v30, v30, v31
    v_add_f32 v28, v28, v29
    v_add_f32 v22, v22, v30
    v_add_f32 v23, v23, v28
    v_cvt_pk_bf16_f32 v28, v22, v23
    s_mov_b32 exec_lo, 0xffff
    s_mov_b32 exec_hi, 0x0
    buffer_store_dword v28, v37, s[40:43], s77 offen
    s_mov_b64 exec, -1
    s_endpgm
AGAIN19:
    s_sleep 4
    s_add_u32 s76, s76, 1
    s_cmp_lt_u32 s76, 32768
    s_cbranch_scc1 POLL19
    s_branch POLLX19
AGAIN21:
    s_add_u32 s76, s76, 1
    s_cmp_lt_u32 s76, 32768
    s_cbranch_scc1 POLL21
    s_branch POLLX21
AGAIN22:
    s_add_u32 s76, s76, 1
    s_cmp_lt_u32 s76, 32768
    s_cbranch_scc1 POLL22
    s_branch POLLX22
ROLEF:
    v_and_b32 v25, 15, v0
    v_lshrrev_b32 v26, 4, v0
    v_bfe_u32 v27, v0, 2, 2
    v_and_b32 v36, 3, v0
    s_mov_b32 s4, 1
    s_cmp_lg_u32 s74, 0
    s_cbranch_scc1 FW
    s_mov_b32 s4, 0
FW:
    s_mul_i32 s77, s72, 5120
    s_add_u32 s77, s77, 57344
    v_lshl_add_u32 v37, v26, 3, v27
    v_lshlrev_b32 v37, 5, v37
    v_lshl_add_u32 v37, v36, 3, v37
    v_add_u32 v37, s77, v37
    ds_read_b64_tr_b16 v[40:41], v37 offset:0
    ds_read_b64_tr_b16 v[42:43], v37 offset:128
    ds_read_b64_tr_b16 v[44:45], v37 offset:1024
    ds_read_b64_tr_b16 v[46:47], v37 offset:1152
    ds_read_b64_tr_b16 v[48:49], v37 offset:2048
    ds_read_b64_tr_b16 v[50:51], v37 offset:2176
    ds_read_b64_tr_b16 v[52:53], v37 offset:3072
    ds_read_b64_tr_b16 v[54:55], v37 offset:3200
    ds_read_b64_tr_b16 v[56:57], v37 offset:4096
    ds_read_b64_tr_b16 v[58:59], v37 offset:4224
    ds_read_b64_tr_b16 v[60:61], v37 offset:20480
    ds_read_b64_tr_b16 v[62:63], v37 offset:20608
    ds_read_b64_tr_b16 v[64:65], v37 offset:21504
    ds_read_b64_tr_b16 v[66:67], v37 offset:21632
    ds_read_b64_tr_b16 v[68:69], v37 offset:22528
    ds_read_b64_tr_b16 v[70:71], v37 offset:22656
    ds_read_b64_tr_b16 v[72:73], v37 offset:23552
    ds_read_b64_tr_b16 v[74:75], v37 offset:23680
    ds_read_b64_tr_b16 v[76:77], v37 offset:24576
    ds_read_b64_tr_b16 v[78:79], v37 offset:24704
    s_mul_i32 s77, s72, 320
    s_add_u32 s77, s77, 98304
    v_lshrrev_b32 v80, 2, v0
    v_mul_u32_u24 v80, 1280, v80
    v_lshl_add_u32 v80, v36, 3, v80
    v_add_u32 v80, s77, v80
    s_lshl_b32 s79, s72, 2
    s_add_u32 s79, s79, 123392
    v_add_u32 v81, s79, v1
    v_lshl_add_u32 v82, v26, 2, v36
    v_lshlrev_b32 v82, 4, v82
    v_add_u32 v82, 123392, v82
    v_cmp_eq_u32 vcc, 12, v25
    v_mov_b32 v38, 13
    s_nop 0
    v_cndmask_b32 v83, v25, v38, vcc
    v_lshlrev_b32 v83, 4, v83
    v_add_u32 v83, 123904, v83
    v_mov_b32 v85, 124096
    v_lshlrev_b32 v84, 6, v25
    v_lshl_add_u32 v84, v26, 4, v84
    v_mov_b32 v38, 0x3f803f80
    v_cndmask_b32 v88, 0, v38, vcc
    v_mov_b32 v89, v88
    v_mov_b32 v90, v88
    v_mov_b32 v91, v88
    v_mov_b32 v92, v88
    v_mov_b32 v93, v88
    v_mov_b32 v94, v88
    v_mov_b32 v95, v88
    v_mov_b32 v96, v88
    v_mov_b32 v97, v88
    v_mov_b32 v98, v88
    v_mov_b32 v99, v88
    v_mov_b32 v100, v88
    v_mov_b32 v101, v88
    v_mov_b32 v102, v88
    v_mov_b32 v103, v88
    v_mov_b32 v104, v88
    v_mov_b32 v105, v88
    v_mov_b32 v106, v88
    v_mov_b32 v107, v88
    s_mul_i32 s77, s72, 6656
    v_mul_u32_u24 v6, 336, v25
    v_lshl_add_u32 v6, v26, 4, v6
    v_add_u32 v6, s77, v6
    v_mul_u32_u24 v37, 52, v0
    v_lshrrev_b32 v37, 10, v37
    v_lshl_add_u32 v87, v37, 4, v1
    v_add_u32 v87, s77, v87
    v_mul_u32_u24 v27, 320, v37
    v_sub_u32 v27, v1, v27
    v_mul_u32_u24 v86, 1280, v37
    v_add_u32 v86, 655360, v86
    s_mul_i32 s7, s68, 81920
    s_add_u32 s7, s7, 46080
    v_mov_b32 v38, s7
    v_cmp_eq_u32 vcc, s68, v37
    s_nop 1
    v_cndmask_b32 v86, v86, v38, vcc
    v_add_u32 v38, 2560, v38
    v_cmp_le_u32 vcc, 8, v37
    s_nop 1
    v_cndmask_b32 v86, v86, v38, vcc
    v_add_u32 v86, v86, v27
    v_add_u32 v37, 3, v37
    v_mul_u32_u24 v18, 1280, v37
    v_add_u32 v18, 655360, v18
    s_mul_i32 s7, s68, 81920
    s_add_u32 s7, s7, 46080
    v_mov_b32 v38, s7
    v_cmp_eq_u32 vcc, s68, v37
    s_nop 1
    v_cndmask_b32 v18, v18, v38, vcc
    v_add_u32 v38, 2560, v38
    v_cmp_le_u32 vcc, 8, v37
    s_nop 1
    v_cndmask_b32 v18, v18, v38, vcc
    v_add_u32 v18, v18, v27
    v_add_u32 v37, 3, v37
    v_mul_u32_u24 v20, 1280, v37
    v_add_u32 v20, 655360, v20
    s_mul_i32 s7, s68, 81920
    s_add_u32 s7, s7, 46080
    v_mov_b32 v38, s7
    v_cmp_eq_u32 vcc, s68, v37
    s_nop 1
    v_cndmask_b32 v20, v20, v38, vcc
    v_add_u32 v38, 2560, v38
    v_cmp_le_u32 vcc, 8, v37
    s_nop 1
    v_cndmask_b32 v20, v20, v38, vcc
    v_add_u32 v20, v20, v27
    s_mul_i32 s77, s72, 320
    s_add_u32 s77, s77, s74
    s_sub_u32 s78, s69, 20
    s_mul_i32 s78, s78, 2560
    s_mul_i32 s7, s72, 640
    s_add_u32 s78, s78, s7
    s_add_u32 s78, s78, s3
    s_add_u32 s78, s78, 51200
    s_waitcnt lgkmcnt(0)
    s_cmp_eq_u32 s4, 0
    s_cbranch_scc1 FW2
FPOLL:
    ds_read_b64_tr_b16 a[240:241], v80 offset:0
    ds_read_b64_tr_b16 a[242:243], v80 offset:32
    ds_read_b64_tr_b16 a[244:245], v80 offset:64
    ds_read_b64_tr_b16 a[246:247], v80 offset:96
    ds_read_b64_tr_b16 a[248:249], v80 offset:128
    ds_read_b64_tr_b16 a[250:251], v80 offset:160
    ds_read_b64_tr_b16 v[108:109], v80 offset:192
    ds_read_b64_tr_b16 v[110:111], v80 offset:224
    ds_read_b64_tr_b16 v[2:3], v80 offset:256
    ds_read_b64_tr_b16 v[4:5], v80 offset:288
    s_waitcnt lgkmcnt(0)
    s_mul_i32 s79, s72, 320
    s_add_u32 s79, s79, s3
    s_add_u32 s79, s79, 46080
    s_mov_b32 exec_lo, 0xfffff
    s_mov_b32 exec_hi, 0x0
    s_mov_b32 s76, 1
POLL23:
    buffer_load_dword v36, v1, s[16:19], s79 offen sc1
POLLW23:
    s_waitcnt vmcnt(0)
    v_cmp_eq_u32 vcc, -1, v36
    s_cbranch_vccnz AGAIN23
POLLX23:
    s_mov_b32 exec_lo, 0xffffffff
    s_mov_b32 exec_hi, 0xfffffff
    buffer_load_dwordx4 v[24:27], v86, s[16:19], s77 offen sc1
    buffer_load_dwordx4 v[28:31], v18, s[16:19], s77 offen sc1
    buffer_load_dwordx4 v[32:35], v20, s[16:19], s77 offen sc1
    s_waitcnt vmcnt(0)
    v_max3_u32 v36, v24, v28, v32
    v_cmp_eq_u32 vcc, -1, v36
    s_cbranch_vccnz AGAIN24
POLLX24:
    ds_write_b128 v87, v[24:27] offset:0
    ds_write_b128 v87, v[28:31] offset:1008
    ds_write_b128 v87, v[32:35] offset:2016
    s_mov_b32 exec_lo, 0x1ff01ff
    s_mov_b32 exec_hi, 0x1ff01ff
    ds_read_b128 v[88:91], v6 offset:0
    ds_read_b128 v[92:95], v6 offset:64
    ds_read_b128 v[96:99], v6 offset:128
    ds_read_b128 v[100:103], v6 offset:192
    ds_read_b128 v[104:107], v6 offset:256
    s_mov_b64 exec, -1
FMM:
    s_waitcnt lgkmcnt(4)
    v_mfma_f32_16x16x32_bf16 v[24:27], v[88:91], v[40:43], 0
    v_mfma_f32_16x16x32_bf16 v[28:31], v[88:91], v[60:63], 0
    v_mfma_f32_16x16x32_bf16 v[32:35], v[88:91], v[88:91], 0
    s_waitcnt lgkmcnt(3)
    v_mfma_f32_16x16x32_bf16 v[24:27], v[92:95], v[44:47], v[24:27]
    v_mfma_f32_16x16x32_bf16 v[28:31], v[92:95], v[64:67], v[28:31]
    v_mfma_f32_16x16x32_bf16 v[32:35], v[92:95], v[92:95], v[32:35]
    s_waitcnt lgkmcnt(2)
    v_mfma_f32_16x16x32_bf16 v[24:27], v[96:99], v[48:51], v[24:27]
    v_mfma_f32_16x16x32_bf16 v[28:31], v[96:99], v[68:71], v[28:31]
    v_mfma_f32_16x16x32_bf16 v[32:35], v[96:99], v[96:99], v[32:35]
    s_waitcnt lgkmcnt(1)
    v_mfma_f32_16x16x32_bf16 v[24:27], v[100:103], v[52:55], v[24:27]
    v_mfma_f32_16x16x32_bf16 v[28:31], v[100:103], v[72:75], v[28:31]
    v_mfma_f32_16x16x32_bf16 v[32:35], v[100:103], v[100:103], v[32:35]
    s_waitcnt lgkmcnt(0)
    v_mfma_f32_16x16x32_bf16 v[24:27], v[104:107], v[56:59], v[24:27]
    v_mfma_f32_16x16x32_bf16 v[28:31], v[104:107], v[76:79], v[28:31]
    v_mfma_f32_16x16x32_bf16 v[32:35], v[104:107], v[104:107], v[32:35]
    s_nop 5
    v_add_f32 v24, v24, v25
    v_add_f32 v26, v26, v27
    v_add_f32 v28, v28, v29
    v_add_f32 v30, v30, v31
    v_add_f32 v32, v32, v33
    v_add_f32 v34, v34, v35
    v_add_f32 v24, v24, v26
    v_add_f32 v28, v28, v30
    v_add_f32 v32, v32, v34
    s_nop 1
    v_permlane32_swap_b32 v24, v32
    v_permlane32_swap_b32 v28, v25
    v_add_f32 v24, v24, v32
    v_add_f32 v28, v28, v25
    s_nop 1
    v_permlane16_swap_b32 v24, v28
    v_add_f32 v24, v24, v28
    ds_write_b32 v81, v24
    s_cmp_eq_u32 s4, 0
    s_waitcnt lgkmcnt(0)
    s_barrier
    ds_read_b128 v[24:27], v83
    ds_read_b128 v[28:31], v85
    ds_read_b128 v[32:35], v82
    ds_read_b128 v[36:39], v82 offset:256
    s_cbranch_scc1 FCS
    s_waitcnt lgkmcnt(3)
    v_add_f32 v24, v24, v25
    v_add_f32 v26, v26, v27
    v_add_f32 v24, v24, v26
    s_waitcnt lgkmcnt(2)
    v_add_f32 v28, v28, v29
    v_add_f32_dpp v24, v24, v24 row_ror:8 row_mask:0xf bank_mask:0xf
    v_add_f32 v30, v30, v31
    v_add_f32 v28, v28, v30
    v_add_f32_dpp v24, v24, v24 row_ror:4 row_mask:0xf bank_mask:0xf
    s_waitcnt lgkmcnt(0)
    v_subrev_f32 v29, 0x44200000, v28
    v_add_f32_dpp v24, v24, v24 row_ror:2 row_mask:0xf bank_mask:0xf
    v_add_f32 v32, v32, v33
    v_mul_f32 v30, 0x3acccccd, v29
    v_add_f32_dpp v24, v24, v24 row_ror:1 row_mask:0xf bank_mask:0xf
    v_add_f32 v34, v34, v35
    v_sub_f32 v24, v24, v29
    v_add_f32 v32, v32, v34
    v_mul_f32 v24, 0x3acccccd, v24
    v_add_f32 v36, v36, v37
    v_fma_f32 v24, -v30, v30, v24
    v_add_f32 v38, v38, v39
    v_max_f32 v24, 0, v24
    v_fma_f32 v32, -v28, v22, v32
    v_add_f32 v24, 0x3727c5ac, v24
    v_add_f32 v36, v36, v38
    v_rsq_f32 v24, v24
    v_fma_f32 v36, -v28, v23, v36
    v_mul_f32 v33, 0xbfb8aa3b, v32
    v_mul_f32 v33, v33, v24
    v_mul_f32 v36, v36, v32
    v_exp_f32 v33, v33
    v_mul_f32 v36, v36, v24
    v_add_f32 v33, 1.0, v33
    v_mul_f32 v36, v36, v24
    v_rcp_f32 v33, v33
    s_nop 0
    v_mul_f32 v36, v36, v33
    s_nop 1
    v_mov_b32_dpp v28, v36 quad_perm:[0,0,0,0] row_mask:0xf bank_mask:0xf
    v_mov_b32_dpp v29, v36 quad_perm:[1,1,1,1] row_mask:0xf bank_mask:0xf
    v_mov_b32_dpp v30, v36 quad_perm:[2,2,2,2] row_mask:0xf bank_mask:0xf
    v_mov_b32_dpp v31, v36 quad_perm:[3,3,3,3] row_mask:0xf bank_mask:0xf
    v_cvt_pk_bf16_f32 v28, v28, v29
    v_cvt_pk_bf16_f32 v29, v30, v31
    v_cndmask_b32 v60, 0, v28, s[44:45]
    v_cndmask_b32 v61, 0, v29, s[44:45]
    v_cndmask_b32 v62, 0, v28, s[46:47]
    v_cndmask_b32 v63, 0, v29, s[46:47]
    v_cndmask_b32 v64, 0, v28, s[48:49]
    v_cndmask_b32 v65, 0, v29, s[48:49]
    v_mfma_f32_16x16x32_bf16 v[24:27], a[240:243], v[60:63], 0
    v_cndmask_b32 v66, 0, v28, s[50:51]
    v_cndmask_b32 v67, 0, v29, s[50:51]
    v_cndmask_b32 v68, 0, v28, s[52:53]
    v_cndmask_b32 v69, 0, v29, s[52:53]
    v_mfma_f32_16x16x32_bf16 v[24:27], a[244:247], v[64:67], v[24:27]
    v_cndmask_b32 v70, 0, v28, s[54:55]
    v_cndmask_b32 v71, 0, v29, s[54:55]
    v_cndmask_b32 v72, 0, v28, s[56:57]
    v_cndmask_b32 v73, 0, v29, s[56:57]
    v_mfma_f32_16x16x32_bf16 v[24:27], a[248:251], v[68:71], v[24:27]
    v_cndmask_b32 v74, 0, v28, s[58:59]
    v_cndmask_b32 v75, 0, v29, s[58:59]
    v_cndmask_b32 v76, 0, v28, s[60:61]
    v_cndmask_b32 v77, 0, v29, s[60:61]
    v_mfma_f32_16x16x32_bf16 v[24:27], v[108:111], v[72:75], v[24:27]
    v_cndmask_b32 v78, 0, v28, s[62:63]
    v_cndmask_b32 v79, 0, v29, s[62:63]
    s_nop 1
    v_mfma_f32_16x16x32_bf16 v[24:27], v[2:5], v[76:79], v[24:27]
    s_mov_b32 exec_lo, 0x3ff03ff
    s_mov_b32 exec_hi, 0x3ff03ff
    s_cmp_eq_u32 s75, 1
    s_cbranch_scc0 SLOW25
    s_nop 3
    buffer_store_dwordx4 v[24:27], v84, s[16:19], s78 offen
BACK25:
    s_mov_b64 exec, -1
NEXT:
    s_cmp_lg_u32 s74, 0
    s_cbranch_scc1 DONE
    s_mov_b32 s74, 688128
    s_add_u32 s3, s3, 688128
    s_add_u32 s80, s80, 688128
    s_add_u32 s81, s81, 688128
    s_branch LOOP
AGAIN23:
    s_add_u32 s76, s76, 1
    s_cmp_lt_u32 s76, 32768
    s_cbranch_scc1 POLL23
    s_branch POLLX23
AGAIN24:
    s_mov_b64 s[94:95], exec
    s_mov_b32 s76, 1
AG224:
    v_cmp_eq_u32 vcc, -1, v24
    s_nop 0
    s_mov_b64 exec, vcc
    s_cbranch_execz AG324_0
    buffer_load_dwordx4 v[24:27], v86, s[16:19], s77 offen sc1
AG324_0:
    s_mov_b64 exec, s[94:95]
    v_cmp_eq_u32 vcc, -1, v28
    s_nop 0
    s_mov_b64 exec, vcc
    s_cbranch_execz AG324_1
    buffer_load_dwordx4 v[28:31], v18, s[16:19], s77 offen sc1
AG324_1:
    s_mov_b64 exec, s[94:95]
    v_cmp_eq_u32 vcc, -1, v32
    s_nop 0
    s_mov_b64 exec, vcc
    s_cbranch_execz AG324_2
    buffer_load_dwordx4 v[32:35], v20, s[16:19], s77 offen sc1
AG324_2:
    s_mov_b64 exec, s[94:95]
    s_add_u32 s76, s76, 1
    s_cmp_ge_u32 s76, 32768
    s_waitcnt vmcnt(0)
    v_max3_u32 v36, v24, v28, v32
    v_cmp_eq_u32 vcc, -1, v36
    s_cbranch_vccz POLLX24
    s_cbranch_scc0 AG224
    s_branch POLLX24
DONE:
    s_endpgm
DMAF:
    v_lshrrev_b32 v38, 1, v0
    v_mul_u32_u24 v38, 3072, v38
    v_and_b32 v39, 1, v0
    v_lshl_add_u32 v38, v39, 4, v38
    s_mul_i32 s79, s68, 12
    s_add_u32 s79, s79, s69
    s_sub_u32 s79, s79, 20
    s_mul_i32 s77, s72, 491520
    s_lshl_b32 s78, s79, 5
    s_add_u32 s77, s77, s78
    s_mul_i32 s78, s72, 5120
    s_add_u32 m0, s78, 57344
    s_nop 0
    buffer_load_dwordx4 v38, s[24:27], s77 offen  lds
    s_add_u32 m0, s78, 77824
    s_nop 0
    buffer_load_dwordx4 v38, s[28:31], s77 offen  lds
    s_add_u32 s77, s77, 98304
    s_add_u32 m0, s78, 58368
    s_nop 0
    buffer_load_dwordx4 v38, s[24:27], s77 offen  lds
    s_add_u32 m0, s78, 78848
    s_nop 0
    buffer_load_dwordx4 v38, s[28:31], s77 offen  lds
    s_add_u32 s77, s77, 98304
    s_add_u32 m0, s78, 59392
    s_nop 0
    buffer_load_dwordx4 v38, s[24:27], s77 offen  lds
    s_add_u32 m0, s78, 79872
    s_nop 0
    buffer_load_dwordx4 v38, s[28:31], s77 offen  lds
    s_add_u32 s77, s77, 98304
    s_add_u32 m0, s78, 60416
    s_nop 0
    buffer_load_dwordx4 v38, s[24:27], s77 offen  lds
    s_add_u32 m0, s78, 80896
    s_nop 0
    buffer_load_dwordx4 v38, s[28:31], s77 offen  lds
    s_add_u32 s77, s77, 98304
    s_add_u32 m0, s78, 61440
    s_nop 0
    buffer_load_dwordx4 v38, s[24:27], s77 offen  lds
    s_add_u32 m0, s78, 81920
    s_nop 0
    buffer_load_dwordx4 v38, s[28:31], s77 offen  lds
    s_branch DMAX
RDYLOOP:
    s_mov_b32 s76, 0
RDYL2:
    s_sleep 24
    global_load_dword v99, v98, s[64:65] sc1
    s_waitcnt vmcnt(0)
    v_sad_u8 v100, v99, 0, 0
    s_nop 1
    v_add_u32_dpp v100, v100, v100 quad_perm:[1,0,3,2] row_mask:0xf bank_mask:0xf
    s_nop 1
    v_add_u32_dpp v100, v100, v100 quad_perm:[2,3,0,1] row_mask:0xf bank_mask:0xf
    v_cmp_gt_u32 vcc, 32, v100
    s_mov_b32 vcc_hi, 0
    s_cmp_eq_u64 vcc, 0
    s_cbranch_scc1 RDYOK
    s_add_u32 s76, s76, 1
    s_cmp_lt_u32 s76, 32768
    s_cbranch_scc1 RDYL2
    s_branch RDYOK
SLOW1:
    buffer_store_dwordx4 v[28:31], v27, s[16:19], s77 offen sc1
    s_branch BACK1
SLOW2:
    buffer_store_dwordx4 v[24:27], v106, s[16:19], 0 offen sc1
    s_branch BACK2
SLOW3:
    buffer_store_dwordx4 v[24:27], v107, s[16:19], 0 offen sc1
    s_branch BACK3
SLOW6:
    buffer_store_dword v24, v10, s[16:19], s3 offen sc1
    s_branch BACK6
SLOW8:
    buffer_store_dwordx4 v[28:31], v39, s[16:19], s77 offen sc1
    s_branch BACK8
SLOW9:
    buffer_store_dwordx2 v[32:33], v39, s[16:19], s78 offen sc1
    s_branch BACK9
RETRY10:
    s_mov_b32 s76, 1
POLL26:
    buffer_load_dword v28, v20, s[16:19], 0 offen sc1
    buffer_load_dword v29, v21, s[16:19], 0 offen sc1
POLLW26:
    s_waitcnt vmcnt(0)
    v_max_u32 v30, v28, v29
    v_cmp_eq_u32 vcc, -1, v30
    s_cbranch_vccnz AGAIN26
POLLX26:
    s_branch OK10
AGAIN26:
    s_add_u32 s76, s76, 1
    s_cmp_lt_u32 s76, 32768
    s_cbranch_scc1 POLL26
    s_branch POLLX26
SLOW11:
    buffer_store_dwordx4 v[28:31], v37, s[16:19], s77 offen sc1
    s_branch BACK11
SLOW13:
    buffer_store_dwordx4 v[28:31], v18, s[16:19], s81 offen sc1
    s_branch BACK13
SLOW14:
    buffer_store_dwordx4 v[52:55], v48, s[16:19], s78 offen sc1
    s_branch BACK14
SLOW15:
    buffer_store_dwordx4 v[52:55], v49, s[16:19], s78 offen sc1
    s_branch BACK15
SLOW16:
    buffer_store_dwordx4 v[52:55], v50, s[16:19], s78 offen sc1
    s_branch BACK16
SLOW18:
    buffer_store_dwordx4 v[28:31], v39, s[16:19], s97 offen sc1
    s_branch BACK18
SLOW20:
    buffer_store_dwordx4 v[28:31], v37, s[16:19], s77 offen sc1
    s_branch BACK20
FW2:
    s_mul_i32 s79, s68, 12
    s_add_u32 s79, s79, s69
    s_sub_u32 s79, s79, 20
    s_mul_i32 s97, s72, 5120
    s_mul_i32 s96, s79, 20480
    s_add_u32 s96, s96, s97
    s_add_u32 m0, s97, 98304
    s_nop 0
    buffer_load_dwordx4 v1, s[32:35], s96 offen nt lds
    s_add_u32 s96, s96, 1024
    s_add_u32 m0, s97, 99328
    s_nop 0
    buffer_load_dwordx4 v1, s[32:35], s96 offen nt lds
    s_add_u32 s96, s96, 1024
    s_add_u32 m0, s97, 100352
    s_nop 0
    buffer_load_dwordx4 v1, s[32:35], s96 offen nt lds
    s_add_u32 s96, s96, 1024
    s_add_u32 m0, s97, 101376
    s_nop 0
    buffer_load_dwordx4 v1, s[32:35], s96 offen nt lds
    s_add_u32 s96, s96, 1024
    s_add_u32 m0, s97, 102400
    s_nop 0
    buffer_load_dwordx4 v1, s[32:35], s96 offen nt lds
    s_sub_u32 s96, s69, 20
    s_lshl_b32 s96, s96, 2
    s_add_u32 s96, s96, s72
    s_mul_i32 s96, s96, 688
    v_add_u32 v21, s96, v1
    v_min_u32 v21, 32752, v21
    s_add_u32 s97, s3, 688128
    buffer_load_dwordx4 a[240:243], v21, s[16:19], s97 offen sc1
    s_branch FMM
SLOW25:
    s_nop 3
    buffer_store_dwordx4 v[24:27], v84, s[16:19], s78 offen sc1
    s_branch BACK25
FCS:
    s_waitcnt lgkmcnt(0)
    v_add_f32 v32, v32, v33
    v_add_f32 v34, v34, v35
    v_add_f32 v32, v32, v34
    v_add_f32 v36, v36, v37
    v_add_f32 v38, v38, v39
    v_add_f32 v36, v36, v38
    v_mul_f32 v22, 0x3acccccd, v32
    v_mul_f32 v23, 0x3acccccd, v36
    s_mov_b32 s4, 1
    s_waitcnt vmcnt(0)
    v_mov_b32 v24, -1
    v_mov_b32 v25, -1
    v_mov_b32 v26, -1
    v_mov_b32 v27, -1
    s_cmp_eq_u32 s75, 1
    s_cbranch_scc0 SLOW27
    buffer_store_dwordx4 v[24:27], v21, s[16:19], s97 offen
BACK27:
    s_barrier
    s_branch FPOLL
SLOW27:
    buffer_store_dwordx4 v[24:27], v21, s[16:19], s97 offen sc1
    s_branch BACK27
CODE_END:
    s_endpgm
.section .rodata,"a"
.p2align 6
.amdhsa_kernel interleave_layers__sliding_block_cached__glu_gated_swiglu__decode_kernel
  .amdhsa_next_free_vgpr 512
  .amdhsa_next_free_sgpr 102
  .amdhsa_accum_offset 256
  .amdhsa_group_segment_fixed_size 0
  .amdhsa_kernarg_size 96
  .amdhsa_user_sgpr_count 2
  .amdhsa_user_sgpr_kernarg_segment_ptr 1
  .amdhsa_system_sgpr_workgroup_id_x 1
.end_amdhsa_kernel
```

```asm
; @launch grid=(256,1,1) block=(256,1,1) lds=125568
.amdgcn_target "amdgcn-amd-amdhsa--gfx950"
.text
.globl interleave_layers__sliding_block_cached__glu_gated_swiglu__decode_kernel
.p2align 8
.type interleave_layers__sliding_block_cached__glu_gated_swiglu__decode_kernel,@function
interleave_layers__sliding_block_cached__glu_gated_swiglu__decode_kernel:
    s_load_dwordx16 s[44:59], s[0:1], 0
    s_load_dwordx8 s[60:67], s[0:1], 64
    s_cmp_ge_u32 s2, 256
    s_cbranch_scc1 CODE_END
    v_lshrrev_b32 v2, 6, v0
    v_and_b32 v24, 63, v0
    v_readfirstlane_b32 s72, v2
    s_and_b32 s68, s2, 7
    s_lshr_b32 s69, s2, 3
    s_lshr_b32 s70, s69, 3
    s_and_b32 s71, s69, 7
    v_lshlrev_b32 v1, 4, v24
    s_lshl_b32 s77, s70, 3
    s_add_u32 s77, s77, s68
    s_mul_i32 s73, s77, 12582912
    s_lshl_b32 s78, s71, 2
    s_add_u32 s78, s78, s72
    s_mul_i32 s78, s78, 6144
    s_add_u32 s73, s73, s78
    s_add_u32 s73, s73, 11010048
    v_add_u32 v23, 4096, v1
    s_mov_b32 s10, 402653184
    s_mov_b32 s11, 0x20000
    s_getpc_b64 s[100:101]
PCREF:
    s_sub_u32 s100, s100, PCREF-interleave_layers__sliding_block_cached__glu_gated_swiglu__decode_kernel
    s_subb_u32 s101, s101, 0
    s_lshl_b32 s78, s71, 12
    v_lshl_add_u32 v25, v0, 4, s78
    v_cmp_gt_u32 vcc, CODE_END-interleave_layers__sliding_block_cached__glu_gated_swiglu__decode_kernel-16, v25
    s_nop 0
    s_and_saveexec_b64 s[98:99], vcc
    s_cbranch_execz NOCPF
    global_load_dwordx4 a[240:243], v25, s[100:101]
NOCPF:
    s_mov_b64 exec, -1
    s_mul_i32 s79, s77, 384
    s_mov_b32 s74, 0
    s_mul_i32 s3, s68, 81920
    s_mov_b32 s75, 0
    v_mov_b32 v32, -1
    v_mov_b32 v33, -1
    v_mov_b32 v34, -1
    v_mov_b32 v35, -1
    s_mul_i32 s77, s69, 576
    s_add_u32 s77, s77, s3
    s_add_u32 s77, s77, 32768
    v_add_u32 v20, s77, v1
    s_mul_i32 s77, s2, 80
    s_add_u32 s77, s77, 654784
    v_add_u32 v25, s77, v1
    v_cmp_le_u32 vcc, 36, v0
    s_nop 1
    v_cndmask_b32 v21, v20, v25, vcc
    v_mov_b32 v25, 2147483632
    v_cndmask_b32 v20, v20, v25, vcc
    v_cmp_le_u32 vcc, 41, v0
    s_nop 1
    v_cndmask_b32 v21, v21, v25, vcc
    s_mov_b32 s18, 1610612736
    s_mov_b32 s19, 0x20000
    s_waitcnt lgkmcnt(0)
    s_mov_b32 s8, s46
    s_and_b32 s9, s47, 0xffff
    s_mov_b32 s16, s66
    s_and_b32 s17, s67, 0xffff
    buffer_store_dwordx4 v[32:35], v21, s[16:19], 0 offen sc1
    buffer_load_dwordx4 a[0:3], v1, s[8:11], s73 offen offset:0 nt
    buffer_load_dwordx4 a[4:7], v1, s[8:11], s73 offen offset:1024 nt
    s_add_u32 s83, s73, 196608
    s_mov_b32 s12, s48
    s_and_b32 s13, s49, 0xffff
    s_mov_b32 s14, 402653184
    s_mov_b32 s15, 0x20000
    s_mov_b32 s20, s50
    s_and_b32 s21, s51, 0xffff
    s_mov_b32 s22, 7864320
    s_mov_b32 s23, 0x20000
    s_mov_b32 s36, s44
    s_and_b32 s37, s45, 0xffff
    s_mov_b32 s38, 1280
    s_mov_b32 s39, 0x20000
    s_mov_b32 s40, s62
    s_and_b32 s41, s63, 0xffff
    s_mov_b32 s42, 1280
    s_mov_b32 s43, 0x20000
    s_mov_b32 s28, s58
    s_and_b32 s29, s59, 0xffff
    s_mov_b32 s30, 1966080
    s_mov_b32 s31, 0x20000
    s_mov_b32 s32, s60
    s_and_b32 s33, s61, 0xffff
    s_mov_b32 s34, 1966080
    s_mov_b32 s35, 0x20000
    s_cmp_lt_u32 s69, 20
    s_cselect_b32 s24, s52, s56
    s_cselect_b32 s25, s53, s57
    s_cselect_b32 s26, s22, s30
    s_and_b32 s25, s25, 0xffff
    s_mov_b32 s27, 0x20000
    s_add_u32 s84, s83, 196608
    s_add_u32 s85, s84, 196608
    s_add_u32 s86, s85, 196608
    s_add_u32 s87, s86, 196608
    s_add_u32 s88, s87, 196608
    s_add_u32 s89, s88, 196608
    v_mov_b32 v0, v24
    s_mul_i32 s77, s72, 6656
    v_add_u32 v25, 0, v0
    v_mul_u32_u24 v26, 171, v25
    v_lshrrev_b32 v26, 12, v26
    v_mul_u32_u24 v27, 24, v26
    v_sub_u32 v27, v25, v27
    v_lshlrev_b32 v27, 4, v27
    v_mul_u32_u24 v25, 416, v26
    v_add3_u32 v2, v25, v27, s77
    v_mul_u32_u24 v25, 12288, v26
    v_add_u32 v40, v25, v27
    v_mul_u32_u24 v25, 3072, v26
    v_add_u32 v101, v25, v27
    v_add_u32 v25, 64, v0
    v_mul_u32_u24 v26, 171, v25
    v_lshrrev_b32 v26, 12, v26
    v_mul_u32_u24 v27, 24, v26
    v_sub_u32 v27, v25, v27
    v_lshlrev_b32 v27, 4, v27
    v_mul_u32_u24 v25, 416, v26
    v_add3_u32 v3, v25, v27, s77
    v_mul_u32_u24 v25, 12288, v26
    v_add_u32 v41, v25, v27
    v_mul_u32_u24 v25, 3072, v26
    v_add_u32 v102, v25, v27
    v_add_u32 v25, 128, v0
    v_mul_u32_u24 v26, 171, v25
    v_lshrrev_b32 v26, 12, v26
    v_mul_u32_u24 v27, 24, v26
    v_sub_u32 v27, v25, v27
    v_lshlrev_b32 v27, 4, v27
    v_mul_u32_u24 v25, 416, v26
    v_add3_u32 v4, v25, v27, s77
    v_mul_u32_u24 v25, 12288, v26
    v_add_u32 v42, v25, v27
    v_mul_u32_u24 v25, 3072, v26
    v_add_u32 v103, v25, v27
    s_mul_i32 s78, s71, 983040
    s_add_u32 s79, s79, s78
    s_mul_i32 s78, s72, 98304
    s_add_u32 s79, s79, s78
    s_mul_i32 s78, s72, 3072
    s_add_u32 s78, s78, 26624
    s_add_u32 m0, s78, 0
    s_nop 0
    buffer_load_dwordx4 v40, s[20:23], s79 offen nt lds
    s_add_u32 m0, s78, 1024
    s_nop 0
    buffer_load_dwordx4 v41, s[20:23], s79 offen nt lds
    s_add_u32 m0, s78, 2048
    s_nop 0
    buffer_load_dwordx4 v42, s[20:23], s79 offen nt lds
    s_add_u32 s79, s79, 393216
    s_add_u32 m0, s78, 12288
    s_nop 0
    buffer_load_dwordx4 v40, s[20:23], s79 offen nt lds
    s_add_u32 m0, s78, 13312
    s_nop 0
    buffer_load_dwordx4 v41, s[20:23], s79 offen nt lds
    s_add_u32 m0, s78, 14336
    s_nop 0
    buffer_load_dwordx4 v42, s[20:23], s79 offen nt lds
    s_add_u32 s79, s79, 393216
    s_cmp_ge_u32 s72, 2
    s_cbranch_scc1 NOWQ3
    s_add_u32 m0, s78, 24576
    s_nop 0
    buffer_load_dwordx4 v40, s[20:23], s79 offen nt lds
    s_add_u32 m0, s78, 25600
    s_nop 0
    buffer_load_dwordx4 v41, s[20:23], s79 offen nt lds
    s_add_u32 m0, s78, 26624
    s_nop 0
    buffer_load_dwordx4 v42, s[20:23], s79 offen nt lds
NOWQ3:
    v_and_b32 v25, 15, v0
    v_lshrrev_b32 v26, 4, v0
    v_bfe_u32 v27, v0, 2, 2
    v_and_b32 v28, 3, v0
    v_cmp_eq_u32 vcc, 12, v25
    v_mov_b32 v36, 0x3f803f80
    s_nop 0
    v_cndmask_b32 v70, 0, v36, vcc
    v_mov_b32 v71, v70
    v_mov_b32 v72, v70
    v_mov_b32 v73, v70
    v_mov_b32 v74, v70
    v_mov_b32 v75, v70
    v_mov_b32 v76, v70
    v_mov_b32 v77, v70
    v_mov_b32 v78, v70
    v_mov_b32 v79, v70
    v_mov_b32 v88, v70
    v_mov_b32 v89, v70
    v_mov_b32 v90, v70
    v_mov_b32 v91, v70
    v_mov_b32 v92, v70
    v_mov_b32 v93, v70
    v_mov_b32 v94, v70
    v_mov_b32 v95, v70
    v_mov_b32 v96, v70
    v_mov_b32 v97, v70
    s_mul_i32 s78, s71, 160
    v_lshlrev_b32 v36, 4, v26
    v_lshlrev_b32 v37, 3, v26
    s_mov_b32 exec_lo, 0x1000100
    s_mov_b32 exec_hi, 0x1000100
    buffer_load_dwordx4 v[88:91], v36, s[36:39], s78 offen
    buffer_load_dwordx4 v[92:95], v36, s[36:39], s78 offen offset:64
    buffer_load_dwordx2 v[96:97], v37, s[36:39], s78 offen offset:128
    s_mov_b64 exec, -1
    s_lshl_b32 s79, s69, 6
    v_lshlrev_b32 v38, 2, v25
    buffer_load_dword v22, v38, s[36:39], s79 offen
    s_mov_b32 s20, s52
    s_and_b32 s21, s53, 0xffff
    s_mov_b32 s22, 7864320
    s_mov_b32 s23, 0x20000
    s_cmp_lt_u32 s72, 2
    s_cselect_b32 s36, s56, s58
    s_cselect_b32 s37, s57, s59
    s_and_b32 s37, s37, 0xffff
    s_mov_b32 s38, 1966080
    s_lshl_b32 s90, s70, 3
    s_add_u32 s90, s90, s68
    s_lshl_b32 s90, s90, 3
    s_add_u32 s90, s90, s71
    s_mul_i32 s90, s90, 30720
    s_mul_i32 s79, s72, 6144
    s_add_u32 s90, s90, s79
    s_cmp_eq_u32 s72, 3
    s_cselect_b32 s79, 3072, 0
    s_add_u32 s90, s90, s79
    s_cmp_lt_u32 s72, 2
    s_cselect_b32 s79, 1879048176, 0
    v_add_u32 v108, s79, v23
    v_add_u32 v109, 4096, v108
    s_and_b32 s91, s72, 1
    s_lshl_b32 s79, s69, 1
    s_add_u32 s91, s91, s79
    s_mul_i32 s79, s91, 0
    s_add_u32 s79, s79, 640
    s_mul_i32 s91, s91, 16
    s_cmp_lt_u32 s69, 20
    s_cselect_b32 s91, s91, s79
    s_mov_b32 s7, 49152
    s_cselect_b32 s7, s7, 0
    s_mul_i32 s91, s91, 3072
    s_mul_i32 s79, s68, 384
    s_add_u32 s91, s91, s79
    v_mov_b32 v29, 1879048176
    v_add_u32 v104, 24576, v101
    v_add_u32 v105, 24576, v102
    v_add_u32 v106, 24576, v103
    v_cmp_gt_u32 vcc, s7, v101
    s_nop 1
    v_cndmask_b32 v101, v29, v101, vcc
    v_cmp_gt_u32 vcc, s7, v102
    s_nop 1
    v_cndmask_b32 v102, v29, v102, vcc
    v_cmp_gt_u32 vcc, s7, v103
    s_nop 1
    v_cndmask_b32 v103, v29, v103, vcc
    v_cmp_gt_u32 vcc, s7, v104
    s_nop 1
    v_cndmask_b32 v104, v29, v104, vcc
    v_cmp_gt_u32 vcc, s7, v105
    s_nop 1
    v_cndmask_b32 v105, v29, v105, vcc
    v_cmp_gt_u32 vcc, s7, v106
    s_nop 1
    v_cndmask_b32 v106, v29, v106, vcc
    buffer_load_dwordx4 a[8:11], v1, s[8:11], s73 offen offset:2048 nt
    buffer_load_dwordx4 a[12:15], v1, s[8:11], s73 offen offset:3072 nt
    buffer_load_dwordx4 a[16:19], v23, s[8:11], s73 offen offset:0 nt
    v_mul_u32_u24 v29, 416, v25
    v_lshl_add_u32 v29, v26, 4, v29
    v_add_u32 v5, s77, v29
    v_lshrrev_b32 v29, 2, v0
    v_mul_u32_u24 v29, 416, v29
    v_lshl_add_u32 v29, v28, 3, v29
    v_add_u32 v6, s77, v29
    s_mul_i32 s79, s72, 96
    s_add_u32 s79, s79, 26624
    v_lshl_add_u32 v29, v26, 3, v27
    v_mul_u32_u24 v29, 384, v29
    v_lshl_add_u32 v29, v28, 3, v29
    v_add_u32 v16, s79, v29
    v_lshl_add_u32 v29, v26, 2, v27
    v_mul_u32_u24 v29, 384, v29
    v_lshl_add_u32 v29, v28, 3, v29
    v_add_u32 v17, s79, v29
    buffer_load_dwordx4 a[20:23], v23, s[8:11], s73 offen offset:1024 nt
    v_mul_u32_u24 v31, 103, v0
    v_lshrrev_b32 v31, 10, v31
    v_mul_u32_u24 v30, 10, v31
    v_sub_u32 v30, v0, v30
    v_lshl_add_u32 v29, v30, 4, s78
    v_mul_u32_u24 v8, 1280, v31
    v_add_u32 v8, 665600, v8
    s_mul_i32 s7, s68, 81920
    s_add_u32 s7, s7, 47360
    v_mov_b32 v30, s7
    v_cmp_eq_u32 vcc, s68, v31
    s_nop 1
    v_cndmask_b32 v8, v8, v30, vcc
    v_add_u32 v30, 2560, v30
    v_cmp_le_u32 vcc, 8, v31
    s_nop 1
    v_cndmask_b32 v8, v8, v30, vcc
    v_add_u32 v8, v8, v29
    v_add_u32 v31, 6, v31
    v_mul_u32_u24 v9, 1280, v31
    v_add_u32 v9, 665600, v9
    s_mul_i32 s7, s68, 81920
    s_add_u32 s7, s7, 47360
    v_mov_b32 v30, s7
    v_cmp_eq_u32 vcc, s68, v31
    s_nop 1
    v_cndmask_b32 v9, v9, v30, vcc
    v_add_u32 v30, 2560, v30
    v_cmp_le_u32 vcc, 8, v31
    s_nop 1
    v_cndmask_b32 v9, v9, v30, vcc
    v_add_u32 v9, v9, v29
    v_mov_b32 v30, 2147483632
    v_cmp_le_u32 vcc, 30, v0
    s_nop 1
    v_cndmask_b32 v9, v9, v30, vcc
    s_lshl_b32 s78, s69, 10
    s_lshl_b32 s79, s72, 8
    s_add_u32 s78, s78, s79
    v_lshl_add_u32 v10, v0, 2, s78
    s_lshl_b32 s78, s70, 13
    s_add_u32 s78, s78, s79
    v_lshlrev_b32 v29, 10, v26
    v_lshl_add_u32 v29, v25, 4, v29
    v_add_u32 v11, s78, v29
    buffer_load_dwordx4 a[24:27], v1, s[8:11], s83 offen offset:0 nt
    s_mul_i32 s78, s72, 96
    s_add_u32 s78, s78, 118784
    v_lshl_add_u32 v29, v27, 5, s78
    v_lshl_add_u32 v29, v28, 2, v29
    v_lshrrev_b32 v30, 1, v26
    v_lshl_add_u32 v29, v30, 4, v29
    v_and_b32 v30, 1, v26
    v_lshl_add_u32 v29, v30, 1, v29
    v_mov_b32 v30, 119168
    v_cmp_le_u32 vcc, 12, v25
    s_nop 1
    v_cndmask_b32 v12, v29, v30, vcc
    v_and_b32 v30, 1, v0
    v_lshlrev_b32 v29, 5, v26
    v_lshl_add_u32 v29, v30, 4, v29
    v_add_u32 v13, 118784, v29
    v_mul_u32_u24 v30, 0xaaaa, v30
    v_and_b32 v29, 1, v27
    v_mul_u32_u24 v29, 0xaaaa, v29
    v_lshl_or_b32 v29, v29, 16, v30
    v_add_u32 v14, 0x44444444, v29
    buffer_load_dwordx4 a[28:31], v1, s[8:11], s83 offen offset:1024 nt
    s_lshl_b32 s78, s72, 8
    s_add_u32 s78, s78, 124416
    v_lshrrev_b32 v29, 5, v0
    v_lshl_add_u32 v29, v29, 6, s78
    v_bfe_u32 v30, v0, 3, 1
    v_lshl_add_u32 v29, v30, 5, v29
    v_bfe_u32 v30, v0, 1, 1
    v_lshl_add_u32 v29, v30, 4, v29
    v_bfe_u32 v30, v0, 2, 1
    v_lshl_add_u32 v29, v30, 3, v29
    v_bfe_u32 v30, v0, 4, 1
    v_lshl_add_u32 v29, v30, 2, v29
    v_bfe_u32 v30, v0, 0, 1
    v_lshl_add_u32 v29, v30, 1, v29
    v_mov_b32 v19, v29
    s_mul_i32 s78, s72, 768
    s_add_u32 s78, s78, 119296
    v_lshl_add_u32 v29, v25, 2, s78
    v_bfe_u32 v30, v0, 4, 1
    v_lshl_add_u32 v29, v30, 7, v29
    v_lshrrev_b32 v30, 5, v0
    v_lshl_add_u32 v15, v30, 6, v29
    s_mov_b32 s44, 0x10001
    s_mov_b32 s45, 0x10001
    s_mov_b32 s46, 0x20002
    s_mov_b32 s47, 0x20002
    s_mov_b32 s48, 0x40004
    s_mov_b32 s49, 0x40004
    s_mov_b32 s50, 0x80008
    s_mov_b32 s51, 0x80008
    s_mov_b32 s52, 0x100010
    s_mov_b32 s53, 0x100010
    s_mov_b32 s54, 0x200020
    s_mov_b32 s55, 0x200020
    s_mov_b32 s56, 0x400040
    s_mov_b32 s57, 0x400040
    s_mov_b32 s58, 0x800080
    s_mov_b32 s59, 0x800080
    s_mov_b32 s60, 0x1000100
    s_mov_b32 s61, 0x1000100
    s_mov_b32 s62, 0x2000200
    s_mov_b32 s63, 0x2000200
    s_waitcnt vmcnt(6)
    s_barrier
    ds_read_b64_tr_b16 v[40:41], v16 offset:0
    ds_read_b64_tr_b16 v[42:43], v16 offset:1536
    ds_read_b64_tr_b16 v[44:45], v16 offset:12288
    ds_read_b64_tr_b16 v[46:47], v16 offset:13824
    ds_read_b64_tr_b16 v[48:49], v17 offset:24576
    ds_read_b64_tr_b16 v[50:51], v16 offset:32
    ds_read_b64_tr_b16 v[52:53], v16 offset:1568
    ds_read_b64_tr_b16 v[54:55], v16 offset:12320
    ds_read_b64_tr_b16 v[56:57], v16 offset:13856
    ds_read_b64_tr_b16 v[58:59], v17 offset:24608
    ds_read_b64_tr_b16 v[60:61], v16 offset:64
    ds_read_b64_tr_b16 v[62:63], v16 offset:1600
    ds_read_b64_tr_b16 v[64:65], v16 offset:12352
    ds_read_b64_tr_b16 v[66:67], v16 offset:13888
    ds_read_b64_tr_b16 v[68:69], v17 offset:24640
    buffer_load_dwordx4 a[32:35], v1, s[8:11], s83 offen offset:2048 nt
    buffer_load_dwordx4 a[36:39], v1, s[8:11], s83 offen offset:3072 nt
    s_waitcnt lgkmcnt(0)
    s_add_u32 s79, s3, 1376256
    v_mfma_f32_16x16x32_bf16 v[24:27], v[70:73], v[40:43], 0
    v_mfma_f32_16x16x32_bf16 v[32:35], v[70:73], v[60:63], 0
    v_mfma_f32_16x16x32_bf16 v[24:27], v[74:77], v[44:47], v[24:27]
    v_mfma_f32_16x16x32_bf16 v[32:35], v[74:77], v[64:67], v[32:35]
    v_mfma_f32_16x16x16_bf16 v[24:27], v[78:79], v[48:49], v[24:27]
    v_mfma_f32_16x16x16_bf16 v[32:35], v[78:79], v[68:69], v[32:35]
    v_mfma_f32_16x16x32_bf16 v[28:31], v[70:73], v[50:53], 0
    v_mfma_f32_16x16x32_bf16 v[36:39], v[70:73], v[70:73], 0
    v_mfma_f32_16x16x32_bf16 v[28:31], v[74:77], v[54:57], v[28:31]
    v_mfma_f32_16x16x32_bf16 v[36:39], v[74:77], v[74:77], v[36:39]
    v_mfma_f32_16x16x16_bf16 v[28:31], v[78:79], v[58:59], v[28:31]
    v_mfma_f32_16x16x16_bf16 v[36:39], v[78:79], v[78:79], v[36:39]
    buffer_load_dwordx4 a[40:43], v23, s[8:11], s83 offen offset:0 nt
    v_add_f32 v24, v24, v25
    v_add_f32 v26, v26, v27
    v_add_f32 v24, v24, v26
    v_add_f32 v32, v32, v33
    v_add_f32 v34, v34, v35
    v_add_f32 v32, v32, v34
    s_nop 1
    v_permlane32_swap_b32 v24, v32
    v_add_f32 v28, v28, v29
    v_add_f32 v30, v30, v31
    v_add_f32 v36, v36, v37
    v_add_f32 v38, v38, v39
    v_add_f32 v24, v24, v32
    v_add_f32 v28, v28, v30
    v_add_f32 v36, v36, v38
    s_nop 1
    v_permlane32_swap_b32 v28, v36
    v_add_f32 v28, v28, v36
    s_nop 1
    v_permlane16_swap_b32 v24, v28
    v_add_f32 v24, v24, v28
    s_nop 1
    v_mov_b32_dpp v25, v24 quad_perm:[1,1,1,1] row_mask:0xf bank_mask:0xf
    v_mov_b32_dpp v26, v24 quad_perm:[2,2,2,2] row_mask:0xf bank_mask:0xf
    v_mov_b32_dpp v27, v24 quad_perm:[3,3,3,3] row_mask:0xf bank_mask:0xf
    s_mov_b32 exec_lo, 0x11111111
    s_mov_b32 exec_hi, 0x11111111
    buffer_store_dwordx4 v[24:27], v10, s[16:19], s79 offen sc1
    s_mov_b64 exec, -1
    buffer_load_dwordx4 a[44:47], v23, s[8:11], s83 offen offset:1024 nt
    v_mfma_f32_16x16x32_bf16 v[24:27], v[88:91], v[40:43], 0
    v_mfma_f32_16x16x32_bf16 v[32:35], v[88:91], v[60:63], 0
    v_mfma_f32_16x16x32_bf16 v[24:27], v[92:95], v[44:47], v[24:27]
    v_mfma_f32_16x16x32_bf16 v[32:35], v[92:95], v[64:67], v[32:35]
    v_mfma_f32_16x16x16_bf16 v[24:27], v[96:97], v[48:49], v[24:27]
    v_mfma_f32_16x16x16_bf16 v[32:35], v[96:97], v[68:69], v[32:35]
    v_mfma_f32_16x16x32_bf16 v[28:31], v[88:91], v[50:53], 0
    v_mfma_f32_16x16x32_bf16 v[36:39], v[88:91], v[88:91], 0
    v_mfma_f32_16x16x32_bf16 v[28:31], v[92:95], v[54:57], v[28:31]
    v_mfma_f32_16x16x32_bf16 v[36:39], v[92:95], v[92:95], v[36:39]
    v_mfma_f32_16x16x16_bf16 v[28:31], v[96:97], v[58:59], v[28:31]
    v_mfma_f32_16x16x16_bf16 v[36:39], v[96:97], v[96:97], v[36:39]
    buffer_load_dwordx4 a[48:51], v1, s[8:11], s84 offen offset:0 nt
    v_add_f32 v24, v24, v25
    v_add_f32 v26, v26, v27
    v_add_f32 v24, v24, v26
    v_add_f32 v32, v32, v33
    v_add_f32 v34, v34, v35
    v_add_f32 v32, v32, v34
    s_nop 1
    v_permlane32_swap_b32 v24, v32
    v_add_f32 v28, v28, v29
    v_add_f32 v30, v30, v31
    v_add_f32 v36, v36, v37
    v_add_f32 v38, v38, v39
    v_add_f32 v24, v24, v32
    v_add_f32 v28, v28, v30
    v_add_f32 v36, v36, v38
    s_nop 1
    v_permlane32_swap_b32 v28, v36
    v_add_f32 v28, v28, v36
    s_nop 1
    v_permlane16_swap_b32 v24, v28
    v_add_f32 v24, v24, v28
    s_nop 1
    v_mov_b32_dpp v25, v24 quad_perm:[1,1,1,1] row_mask:0xf bank_mask:0xf
    v_mov_b32_dpp v26, v24 quad_perm:[2,2,2,2] row_mask:0xf bank_mask:0xf
    v_mov_b32_dpp v27, v24 quad_perm:[3,3,3,3] row_mask:0xf bank_mask:0xf
    s_mov_b32 exec_lo, 0x11111111
    s_mov_b32 exec_hi, 0x11111111
    buffer_store_dwordx4 v[24:27], v10, s[16:19], s3 offen sc1
    s_mov_b64 exec, -1
    buffer_load_dwordx4 a[52:55], v1, s[8:11], s84 offen offset:1024 nt
    buffer_load_dwordx4 a[56:59], v1, s[8:11], s84 offen offset:2048 nt
    buffer_load_dwordx4 a[60:63], v1, s[8:11], s84 offen offset:3072 nt
    s_waitcnt vmcnt(12)
    ds_write_b128 v2, a[0:3] offset:0
    ds_write_b128 v3, a[4:7] offset:0
    ds_write_b128 v4, a[8:11] offset:0
    ds_write_b128 v2, a[12:15] offset:3328
    ds_write_b128 v3, a[16:19] offset:3328
    ds_write_b128 v4, a[20:23] offset:3328
    ds_read_b128 a[0:3], v5 offset:0
    ds_read_b128 a[4:7], v5 offset:64
    ds_read_b128 a[8:11], v5 offset:128
    ds_read_b128 a[12:15], v5 offset:192
    ds_read_b128 a[16:19], v5 offset:256
    ds_read_b128 a[20:23], v5 offset:320
    buffer_load_dwordx4 a[64:67], v23, s[8:11], s84 offen offset:0 nt
    buffer_load_dwordx4 a[68:71], v23, s[8:11], s84 offen offset:1024 nt
    s_barrier
    buffer_load_dwordx4 a[72:75], v1, s[8:11], s85 offen offset:0 nt
    s_waitcnt vmcnt(6)
    s_barrier
    s_getreg_b32 s5, hwreg(HW_REG_XCC_ID, 0, 4)
    s_lshr_b32 s92, s5, 2
    s_lshl_b32 s93, s68, 2
    s_add_u32 s92, s92, s93
    s_and_b32 s93, s5, 3
    s_lshl_b32 s93, s93, 3
    s_lshl_b32 s94, 1, s93
    s_lshl_b32 s96, 32, s93
    s_mov_b32 s5, s92
    s_cmp_lg_u32 s72, 0
    s_cbranch_scc1 NOATOM
    s_lshl_b32 s92, s92, 2
    v_mov_b32 v36, s92
    v_mov_b32 v37, s94
    s_mov_b64 exec, 1
    global_atomic_add v36, v37, s[64:65] sc1
    s_mov_b64 exec, -1
NOATOM:
    ds_write_b128 v2, a[24:27] offset:0
    ds_write_b128 v3, a[28:31] offset:0
    ds_write_b128 v4, a[32:35] offset:0
    ds_write_b128 v2, a[36:39] offset:3328
    ds_write_b128 v3, a[40:43] offset:3328
    ds_write_b128 v4, a[44:47] offset:3328
    ds_read_b128 a[24:27], v5 offset:0
    ds_read_b128 a[28:31], v5 offset:64
    ds_read_b128 a[32:35], v5 offset:128
    ds_read_b128 a[36:39], v5 offset:192
    ds_read_b128 a[40:43], v5 offset:256
    ds_read_b128 a[44:47], v5 offset:320
    buffer_load_dwordx4 a[76:79], v1, s[8:11], s85 offen offset:1024 nt
    buffer_load_dwordx4 a[80:83], v1, s[8:11], s85 offen offset:2048 nt
    buffer_load_dwordx4 a[84:87], v1, s[8:11], s85 offen offset:3072 nt
    buffer_load_dwordx4 a[88:91], v23, s[8:11], s85 offen offset:0 nt
    buffer_load_dwordx4 a[92:95], v23, s[8:11], s85 offen offset:1024 nt
    s_barrier
    buffer_load_dwordx4 a[240:243], v101, s[36:39], s91 offen
    buffer_load_dwordx4 a[240:243], v102, s[36:39], s91 offen
    buffer_load_dwordx4 a[240:243], v103, s[36:39], s91 offen
    buffer_load_dwordx4 a[240:243], v104, s[36:39], s91 offen
    buffer_load_dwordx4 a[240:243], v105, s[36:39], s91 offen
    buffer_load_dwordx4 a[240:243], v106, s[36:39], s91 offen
    s_barrier
    s_waitcnt vmcnt(12)
    ds_write_b128 v2, a[48:51] offset:0
    ds_write_b128 v3, a[52:55] offset:0
    ds_write_b128 v4, a[56:59] offset:0
    ds_write_b128 v2, a[60:63] offset:3328
    ds_write_b128 v3, a[64:67] offset:3328
    ds_write_b128 v4, a[68:71] offset:3328
    ds_read_b128 a[48:51], v5 offset:0
    ds_read_b128 a[52:55], v5 offset:64
    ds_read_b128 a[56:59], v5 offset:128
    ds_read_b128 a[60:63], v5 offset:192
    ds_read_b128 a[64:67], v5 offset:256
    ds_read_b128 a[68:71], v5 offset:320
    v_lshlrev_b32 v98, 2, v0
    buffer_load_dwordx4 a[96:99], v1, s[8:11], s86 offen offset:0 nt
    buffer_load_dwordx4 a[100:103], v1, s[8:11], s86 offen offset:1024 nt
    buffer_load_dwordx4 a[104:107], v1, s[8:11], s86 offen offset:2048 nt
    buffer_load_dwordx4 a[108:111], v1, s[8:11], s86 offen offset:3072 nt
    buffer_load_dwordx4 a[112:115], v23, s[8:11], s86 offen offset:0 nt
    buffer_load_dwordx4 a[116:119], v23, s[8:11], s86 offen offset:1024 nt
    s_barrier
    buffer_load_dwordx4 a[120:123], v1, s[8:11], s87 offen offset:0 nt
    buffer_load_dwordx4 a[124:127], v1, s[8:11], s87 offen offset:1024 nt
    buffer_load_dwordx4 a[128:131], v1, s[8:11], s87 offen offset:2048 nt
    buffer_load_dwordx4 a[132:135], v1, s[8:11], s87 offen offset:3072 nt
    buffer_load_dwordx4 a[136:139], v23, s[8:11], s87 offen offset:0 nt
    buffer_load_dwordx4 a[140:143], v23, s[8:11], s87 offen offset:1024 nt
    s_barrier
    s_waitcnt vmcnt(18)
    ds_write_b128 v2, a[72:75] offset:0
    ds_write_b128 v3, a[76:79] offset:0
    ds_write_b128 v4, a[80:83] offset:0
    ds_write_b128 v2, a[84:87] offset:3328
    ds_write_b128 v3, a[88:91] offset:3328
    ds_write_b128 v4, a[92:95] offset:3328
    ds_read_b128 a[72:75], v5 offset:0
    ds_read_b128 a[76:79], v5 offset:64
    ds_read_b128 a[80:83], v5 offset:128
    ds_read_b128 a[84:87], v5 offset:192
    ds_read_b128 a[88:91], v5 offset:256
    ds_read_b128 a[92:95], v5 offset:320
    buffer_load_dwordx4 a[144:147], v1, s[8:11], s88 offen offset:0 nt
    buffer_load_dwordx4 a[148:151], v1, s[8:11], s88 offen offset:1024 nt
    buffer_load_dwordx4 a[152:155], v1, s[8:11], s88 offen offset:2048 nt
    buffer_load_dwordx4 a[156:159], v1, s[8:11], s88 offen offset:3072 nt
    buffer_load_dwordx4 a[160:163], v23, s[8:11], s88 offen offset:0 nt
    buffer_load_dwordx4 a[164:167], v23, s[8:11], s88 offen offset:1024 nt
    s_barrier
    s_waitcnt vmcnt(12)
    ds_write_b128 v2, a[96:99] offset:0
    ds_write_b128 v3, a[100:103] offset:0
    ds_write_b128 v4, a[104:107] offset:0
    ds_write_b128 v2, a[108:111] offset:3328
    ds_write_b128 v3, a[112:115] offset:3328
    ds_write_b128 v4, a[116:119] offset:3328
    ds_read_b128 a[96:99], v5 offset:0
    ds_read_b128 a[100:103], v5 offset:64
    ds_read_b128 a[104:107], v5 offset:128
    ds_read_b128 a[108:111], v5 offset:192
    ds_read_b128 a[112:115], v5 offset:256
    ds_read_b128 a[116:119], v5 offset:320
    buffer_load_dwordx4 a[168:171], v1, s[8:11], s89 offen offset:0 nt
    buffer_load_dwordx4 a[172:175], v1, s[8:11], s89 offen offset:1024 nt
    buffer_load_dwordx4 a[176:179], v1, s[8:11], s89 offen offset:2048 nt
    buffer_load_dwordx4 a[180:183], v1, s[8:11], s89 offen offset:3072 nt
    buffer_load_dwordx4 a[184:187], v23, s[8:11], s89 offen offset:0 nt
    buffer_load_dwordx4 a[188:191], v23, s[8:11], s89 offen offset:1024 nt
    s_barrier
    s_cmp_ge_u32 s69, 20
    s_cbranch_scc1 DMAF
    s_lshl_b32 s66, s72, 3
    s_add_u32 s66, s66, s68
    s_mul_i32 s66, s66, 245760
    s_lshl_b32 s78, s69, 6
    s_add_u32 s66, s66, s78
    s_mul_i32 s67, s72, 12288
    s_add_u32 s67, s67, 57344
DMAX:
    v_mov_b32 v109, v20
    v_and_b32 v25, 15, v0
    v_lshrrev_b32 v26, 4, v0
    v_add_u32 v27, 4, v26
    v_mul_u32_u24 v20, 1280, v26
    v_add_u32 v20, 665600, v20
    s_mul_i32 s7, s68, 81920
    s_add_u32 s7, s7, 47360
    v_mov_b32 v28, s7
    v_cmp_eq_u32 vcc, s68, v26
    s_nop 1
    v_cndmask_b32 v20, v20, v28, vcc
    v_mul_u32_u24 v21, 1280, v27
    v_add_u32 v21, 665600, v21
    s_mul_i32 s7, s68, 81920
    s_add_u32 s7, s7, 47360
    v_mov_b32 v28, s7
    v_cmp_eq_u32 vcc, s68, v27
    s_nop 1
    v_cndmask_b32 v21, v21, v28, vcc
    s_min_u32 s7, s69, 19
    s_lshl_b32 s7, s7, 6
    v_lshl_add_u32 v25, v25, 2, s7
    v_add_u32 v20, v20, v25
    v_add_u32 v21, v21, v25
    buffer_load_dwordx4 a[216:219], v1, s[12:15], s73 offen offset:0 nt
    v_and_b32 v25, 15, v0
    v_bfe_u32 v27, v0, 2, 2
    v_and_b32 v28, 3, v0
    s_mul_i32 s7, s72, 12288
    s_add_u32 s7, s7, 57344
    v_lshl_add_u32 v29, v26, 3, v27
    v_lshlrev_b32 v29, 6, v29
    v_lshl_add_u32 v29, v28, 3, v29
    v_add_u32 v29, s7, v29
    v_accvgpr_write_b32 a246, v29
    s_mul_i32 s7, s72, 3072
    s_add_u32 s7, s7, 32768
    v_lshl_add_u32 v29, v25, 4, s7
    v_lshl_add_u32 v29, v26, 7, v29
    v_accvgpr_write_b32 a247, v29
    s_lshl_b32 s7, s72, 6
    s_add_u32 s7, s7, 45056
    v_and_b32 v29, 1, v26
    v_lshl_add_u32 v29, v29, 5, s7
    v_accvgpr_write_b32 a248, v29
    s_lshl_b32 s7, s72, 8
    s_add_u32 s7, s7, 122368
    v_lshl_add_u32 v29, v0, 2, s7
    v_accvgpr_write_b32 a249, v29
    s_lshl_b32 s81, s69, 6
    s_mul_i32 s80, s68, 1280
    s_add_u32 s80, s80, s81
    s_add_u32 s80, s80, 655360
    s_add_u32 s81, s81, s3
    s_add_u32 s81, s81, 46080
    s_waitcnt vmcnt(13)
    ds_write_b128 v2, a[120:123] offset:0
    ds_write_b128 v3, a[124:127] offset:0
    ds_write_b128 v4, a[128:131] offset:0
    ds_write_b128 v2, a[132:135] offset:3328
    ds_write_b128 v3, a[136:139] offset:3328
    ds_write_b128 v4, a[140:143] offset:3328
    ds_read_b128 a[120:123], v5 offset:0
    ds_read_b128 a[124:127], v5 offset:64
    ds_read_b128 a[128:131], v5 offset:128
    ds_read_b128 a[132:135], v5 offset:192
    ds_read_b128 a[136:139], v5 offset:256
    ds_read_b128 a[140:143], v5 offset:320
    buffer_load_dwordx4 a[220:223], v1, s[12:15], s73 offen offset:1024 nt
    buffer_load_dwordx4 a[224:227], v1, s[12:15], s73 offen offset:2048 nt
    buffer_load_dwordx4 a[228:231], v1, s[12:15], s73 offen offset:3072 nt
    buffer_load_dwordx4 a[232:235], v23, s[12:15], s73 offen offset:0 nt
    buffer_load_dwordx4 a[236:239], v23, s[12:15], s73 offen offset:1024 nt
    s_barrier
    global_load_dword v99, v98, s[64:65] sc1
    s_waitcnt vmcnt(13)
    ds_write_b128 v2, a[144:147] offset:0
    ds_write_b128 v3, a[148:151] offset:0
    ds_write_b128 v4, a[152:155] offset:0
    ds_write_b128 v2, a[156:159] offset:3328
    ds_write_b128 v3, a[160:163] offset:3328
    ds_write_b128 v4, a[164:167] offset:3328
    ds_read_b128 a[144:147], v5 offset:0
    ds_read_b128 a[148:151], v5 offset:64
    ds_read_b128 a[152:155], v5 offset:128
    ds_read_b128 a[156:159], v5 offset:192
    ds_read_b128 a[160:163], v5 offset:256
    ds_read_b128 a[164:167], v5 offset:320
    buffer_load_dwordx4 v[112:115], v1, s[12:15], s83 offen offset:0 nt
    buffer_load_dwordx4 v[116:119], v1, s[12:15], s83 offen offset:1024 nt
    buffer_load_dwordx4 v[120:123], v1, s[12:15], s83 offen offset:2048 nt
    buffer_load_dwordx4 v[124:127], v1, s[12:15], s83 offen offset:3072 nt
    buffer_load_dwordx4 v[128:131], v23, s[12:15], s83 offen offset:0 nt
    buffer_load_dwordx4 v[132:135], v23, s[12:15], s83 offen offset:1024 nt
    s_barrier
    s_waitcnt vmcnt(13)
    ds_write_b128 v2, a[168:171] offset:0
    ds_write_b128 v3, a[172:175] offset:0
    ds_write_b128 v4, a[176:179] offset:0
    ds_write_b128 v2, a[180:183] offset:3328
    ds_write_b128 v3, a[184:187] offset:3328
    ds_write_b128 v4, a[188:191] offset:3328
    ds_read_b128 a[168:171], v5 offset:0
    ds_read_b128 a[172:175], v5 offset:64
    ds_read_b128 a[176:179], v5 offset:128
    ds_read_b128 a[180:183], v5 offset:192
    ds_read_b128 a[184:187], v5 offset:256
    ds_read_b128 a[188:191], v5 offset:320
    buffer_load_dwordx4 v[136:139], v1, s[12:15], s84 offen offset:0 nt
    buffer_load_dwordx4 v[140:143], v1, s[12:15], s84 offen offset:1024 nt
    buffer_load_dwordx4 v[144:147], v1, s[12:15], s84 offen offset:2048 nt
    buffer_load_dwordx4 v[148:151], v1, s[12:15], s84 offen offset:3072 nt
    buffer_load_dwordx4 v[152:155], v23, s[12:15], s84 offen offset:0 nt
    buffer_load_dwordx4 v[156:159], v23, s[12:15], s84 offen offset:1024 nt
    s_barrier
    s_waitcnt vmcnt(12)
    s_mov_b32 s76, -1
    v_sad_u8 v100, v99, 0, 0
    s_nop 1
    v_add_u32_dpp v100, v100, v100 quad_perm:[1,0,3,2] row_mask:0xf bank_mask:0xf
    s_nop 1
    v_add_u32_dpp v100, v100, v100 quad_perm:[2,3,0,1] row_mask:0xf bank_mask:0xf
    v_cmp_gt_u32 vcc, 32, v100
    s_mov_b32 vcc_hi, 0
    s_cmp_eq_u64 vcc, 0
    s_cbranch_scc0 RDYLOOP
RDYOK:
    v_readlane_b32 s77, v99, s5
    s_nop 0
    s_cmp_eq_u32 s77, s96
    s_cselect_b32 s75, 1, 0
    buffer_load_dwordx4 a[240:243], v109, s[16:19], 0 offen sc1
    v_lshrrev_b32 v106, 3, v0
    v_mul_u32_u24 v106, 2560, v106
    v_and_b32 v107, 7, v0
    v_lshl_add_u32 v106, v107, 4, v106
    s_lshl_b32 s77, s69, 7
    s_add_u32 s77, s77, s3
    s_add_u32 s77, s77, 51200
    s_cmp_lt_u32 s69, 20
    s_cselect_b32 s77, s77, 1879048176
    s_cmp_eq_u32 s72, 0
    s_cselect_b32 s77, s77, 1879048176
    v_add_u32 v106, s77, v106
    v_add_u32 v107, 20480, v106
    v_mov_b32 v108, 2147483632
    v_cmp_le_u32 vcc, 32, v0
    s_nop 1
    v_cndmask_b32 v107, v107, v108, vcc
    buffer_load_dwordx4 a[240:243], v106, s[16:19], 0 offen sc1
    buffer_load_dwordx4 a[240:243], v107, s[16:19], 0 offen sc1
    s_add_u32 s77, s3, 1376256
    s_add_u32 s78, s3, 1380352
    s_add_u32 s79, s3, 4096
    buffer_load_dwordx4 v[64:67], v11, s[16:19], s77 offen sc1
    buffer_load_dwordx4 v[68:71], v11, s[16:19], s78 offen sc1
    buffer_load_dwordx4 v[72:75], v11, s[16:19], s3 offen sc1
    buffer_load_dwordx4 v[76:79], v11, s[16:19], s79 offen sc1
    s_cmp_lg_u32 s72, 1
    s_cbranch_scc1 NOBASE0
    s_cmp_ge_u32 s69, 20
    s_cbranch_scc1 NOBASE0
    v_mov_b32 v28, v22
    s_lshl_b32 s77, s69, 6
    s_add_u32 s77, s77, s3
    s_add_u32 s77, s77, 48640
    v_lshlrev_b32 v27, 2, v0
    v_mov_b32_dpp v29, v28 quad_perm:[1,1,1,1] row_mask:0xf bank_mask:0xf
    v_mov_b32_dpp v30, v28 quad_perm:[2,2,2,2] row_mask:0xf bank_mask:0xf
    v_mov_b32_dpp v31, v28 quad_perm:[3,3,3,3] row_mask:0xf bank_mask:0xf
    s_mov_b32 exec_lo, 0x1111
    s_mov_b32 exec_hi, 0x0
    s_cmp_eq_u32 s75, 1
    s_cbranch_scc0 SLOW1
    buffer_store_dwordx4 v[28:31], v27, s[16:19], s77 offen
BACK1:
    s_mov_b64 exec, -1
NOBASE0:
    ds_write_b128 v2, a[216:219] offset:0
    ds_write_b128 v3, a[220:223] offset:0
    ds_write_b128 v4, a[224:227] offset:0
    ds_write_b128 v2, a[228:231] offset:3328
    ds_write_b128 v3, a[232:235] offset:3328
    ds_write_b128 v4, a[236:239] offset:3328
    ds_read_b64_tr_b16 a[192:193], v6 offset:0
    ds_read_b64_tr_b16 a[196:197], v6 offset:32
    ds_read_b64_tr_b16 a[200:201], v6 offset:64
    ds_read_b64_tr_b16 a[204:205], v6 offset:96
    ds_read_b64_tr_b16 a[208:209], v6 offset:128
    ds_read_b64_tr_b16 a[212:213], v6 offset:160
    ds_read_b64_tr_b16 a[216:217], v6 offset:192
    ds_read_b64_tr_b16 a[220:221], v6 offset:224
    ds_read_b64_tr_b16 a[224:225], v6 offset:256
    ds_read_b64_tr_b16 a[228:229], v6 offset:288
    ds_read_b64_tr_b16 a[232:233], v6 offset:320
    ds_read_b64_tr_b16 a[236:237], v6 offset:352
    s_waitcnt vmcnt(13)
    ds_write_b128 v2, v[112:115] offset:0
    ds_write_b128 v3, v[116:119] offset:0
    ds_write_b128 v4, v[120:123] offset:0
    ds_write_b128 v2, v[124:127] offset:3328
    ds_write_b128 v3, v[128:131] offset:3328
    ds_write_b128 v4, v[132:135] offset:3328
    ds_read_b64_tr_b16 a[194:195], v6 offset:0
    ds_read_b64_tr_b16 a[198:199], v6 offset:32
    ds_read_b64_tr_b16 a[202:203], v6 offset:64
    ds_read_b64_tr_b16 a[206:207], v6 offset:96
    ds_read_b64_tr_b16 a[210:211], v6 offset:128
    ds_read_b64_tr_b16 a[214:215], v6 offset:160
    ds_read_b64_tr_b16 a[218:219], v6 offset:192
    ds_read_b64_tr_b16 a[222:223], v6 offset:224
    ds_read_b64_tr_b16 a[226:227], v6 offset:256
    ds_read_b64_tr_b16 a[230:231], v6 offset:288
    ds_read_b64_tr_b16 a[234:235], v6 offset:320
    ds_read_b64_tr_b16 a[238:239], v6 offset:352
    buffer_load_dwordx4 v[160:163], v1, s[12:15], s85 offen offset:0 nt
    buffer_load_dwordx4 v[164:167], v1, s[12:15], s85 offen offset:1024 nt
    buffer_load_dwordx4 v[168:171], v1, s[12:15], s85 offen offset:2048 nt
    buffer_load_dwordx4 v[172:175], v1, s[12:15], s85 offen offset:3072 nt
    buffer_load_dwordx4 v[176:179], v23, s[12:15], s85 offen offset:0 nt
    s_waitcnt vmcnt(12)
    ds_write_b128 v2, v[136:139] offset:0
    ds_write_b128 v3, v[140:143] offset:0
    ds_write_b128 v4, v[144:147] offset:0
    ds_write_b128 v2, v[148:151] offset:3328
    ds_write_b128 v3, v[152:155] offset:3328
    ds_write_b128 v4, v[156:159] offset:3328
    ds_read_b64_tr_b16 v[112:113], v6 offset:0
    ds_read_b64_tr_b16 v[116:117], v6 offset:32
    ds_read_b64_tr_b16 v[120:121], v6 offset:64
    ds_read_b64_tr_b16 v[124:125], v6 offset:96
    ds_read_b64_tr_b16 v[128:129], v6 offset:128
    ds_read_b64_tr_b16 v[132:133], v6 offset:160
    ds_read_b64_tr_b16 v[136:137], v6 offset:192
    ds_read_b64_tr_b16 v[140:141], v6 offset:224
    ds_read_b64_tr_b16 v[144:145], v6 offset:256
    ds_read_b64_tr_b16 v[148:149], v6 offset:288
    ds_read_b64_tr_b16 v[152:153], v6 offset:320
    ds_read_b64_tr_b16 v[156:157], v6 offset:352
    buffer_load_dwordx4 v[180:183], v23, s[12:15], s85 offen offset:1024 nt
    s_barrier
    buffer_load_dwordx4 v[184:187], v1, s[12:15], s86 offen offset:0 nt
    buffer_load_dwordx4 v[188:191], v1, s[12:15], s86 offen offset:1024 nt
    buffer_load_dwordx4 v[192:195], v1, s[12:15], s86 offen offset:2048 nt
    buffer_load_dwordx4 v[196:199], v1, s[12:15], s86 offen offset:3072 nt
    buffer_load_dwordx4 v[200:203], v23, s[12:15], s86 offen offset:0 nt
    buffer_load_dwordx4 v[204:207], v23, s[12:15], s86 offen offset:1024 nt
    s_barrier
    s_waitcnt vmcnt(12)
    v_mov_b32 v24, -1
    v_mov_b32 v25, -1
    v_mov_b32 v26, -1
    v_mov_b32 v27, -1
    s_cmp_eq_u32 s75, 1
    s_cbranch_scc0 SLOW2
    buffer_store_dwordx4 v[24:27], v106, s[16:19], 0 offen
BACK2:
    s_cmp_eq_u32 s75, 1
    s_cbranch_scc0 SLOW3
    buffer_store_dwordx4 v[24:27], v107, s[16:19], 0 offen
BACK3:
    v_add_f32 v64, v64, v68
    v_add_f32 v65, v65, v69
    v_add_f32 v66, v66, v70
    v_add_f32 v67, v67, v71
    s_nop 0
    v_permlane32_swap_b32 v64, v66
    v_permlane32_swap_b32 v65, v67
    v_add_f32 v64, v64, v66
    v_add_f32 v65, v65, v67
    s_nop 1
    v_permlane16_swap_b32 v64, v65
    v_add_f32 v64, v64, v65
    v_add_f32 v72, v72, v76
    v_add_f32 v73, v73, v77
    v_add_f32 v74, v74, v78
    v_add_f32 v75, v75, v79
    s_nop 0
    v_permlane32_swap_b32 v72, v74
    v_permlane32_swap_b32 v73, v75
    v_add_f32 v72, v72, v74
    v_add_f32 v73, v73, v75
    s_nop 1
    v_permlane16_swap_b32 v72, v73
    v_add_f32 v72, v72, v73
    v_mul_f32 v7, 0x3acccccd, v64
    v_mov_b32 v24, v72
    buffer_load_dwordx4 v[208:211], v1, s[12:15], s87 offen offset:0 nt
    v_mov_b32 v40, 0
    v_mov_b32 v41, 0
    v_mov_b32 v44, 0
    v_mov_b32 v45, 0
    v_mov_b32 v48, 0
    v_mov_b32 v49, 0
    v_mov_b32 v52, 0
    v_mov_b32 v53, 0
    v_mov_b32 v56, 0
    v_mov_b32 v57, 0
    v_mov_b32 v60, 0
    v_mov_b32 v61, 0
    v_mov_b32 v64, 0
    v_mov_b32 v65, 0
    v_mov_b32 v68, 0
    v_mov_b32 v69, 0
    v_mov_b32 v72, 0
    v_mov_b32 v73, 0
    v_mov_b32 v74, 0
    v_mov_b32 v75, 0
    v_mov_b32 v76, 0
    v_mov_b32 v77, 0
    v_mov_b32 v78, 0
    v_mov_b32 v79, 0
    v_mov_b32 v80, 0
    v_mov_b32 v81, 0
    v_mov_b32 v82, 0
    v_mov_b32 v83, 0
    v_mov_b32 v84, 0
    v_mov_b32 v85, 0
    v_mov_b32 v86, 0
    v_mov_b32 v87, 0
    v_readlane_b32 s77, v24, 15
    s_mov_b32 vcc_lo, 0x70007000
    s_mov_b32 vcc_hi, 0x70007000
    v_fma_f32 v25, -s77, v7, v24
    v_cvt_pk_bf16_f32 v25, v25, v25
    ds_write_b16 v12, v25
    v_cndmask_b32 v26, 0, v24, vcc
    s_nop 1
    v_add_f32_dpp v26, v26, v26 quad_perm:[1,0,3,2] row_mask:0xf bank_mask:0xf
    s_nop 1
    v_add_f32_dpp v26, v26, v26 quad_perm:[2,3,0,1] row_mask:0xf bank_mask:0xf
    v_mov_b32 v27, v26
    s_nop 1
    v_permlane32_swap_b32 v26, v27
    v_add_f32 v26, v26, v27
    buffer_load_dwordx4 v[212:215], v1, s[12:15], s87 offen offset:1024 nt
    buffer_load_dwordx4 v[216:219], v1, s[12:15], s87 offen offset:2048 nt
    s_waitcnt lgkmcnt(0)
    s_barrier
    ds_read_b128 v[28:31], v13 offset:0
    ds_read_b128 v[32:35], v13 offset:128
    ds_read_b128 v[36:39], v13 offset:256
    v_mov_b32 v27, v26
    v_mov_b32 v25, s77
    v_subrev_f32 v25, 0x44200000, v25
    v_permlane16_swap_b32 v26, v27
    v_add_f32 v26, v26, v27
    v_mul_f32 v24, 0x3acccccd, v25
    v_readlane_b32 s77, v26, 15
    v_mul_f32 v24, v24, v24
    s_mov_b32 s78, 0x3acccccd
    v_sub_f32 v26, s77, v25
    v_fma_f32 v26, v26, s78, -v24
    v_max_f32 v26, 0, v26
    v_add_f32 v26, 0x3727c5ac, v26
    v_rsq_f32 v26, v26
    s_nop 0
    v_mul_f32 v18, 0x3dd53b94, v26
    s_waitcnt lgkmcnt(2)
    v_smfmac_f32_16x16x64_bf16 v[40:43], v[28:31], a[0:7], v14
    v_smfmac_f32_16x16x64_bf16 v[56:59], v[28:31], a[96:103], v14
    v_smfmac_f32_16x16x64_bf16 v[44:47], v[28:31], a[24:31], v14
    v_smfmac_f32_16x16x64_bf16 v[60:63], v[28:31], a[120:127], v14
    v_smfmac_f32_16x16x64_bf16 v[48:51], v[28:31], a[48:55], v14
    v_smfmac_f32_16x16x64_bf16 v[64:67], v[28:31], a[144:151], v14
    v_smfmac_f32_16x16x64_bf16 v[52:55], v[28:31], a[72:79], v14
    v_smfmac_f32_16x16x64_bf16 v[68:71], v[28:31], a[168:175], v14
    buffer_load_dwordx4 v[220:223], v1, s[12:15], s87 offen offset:3072 nt
    s_waitcnt lgkmcnt(1)
    v_smfmac_f32_16x16x64_bf16 v[40:43], v[32:35], a[8:15], v14
    v_smfmac_f32_16x16x64_bf16 v[56:59], v[32:35], a[104:111], v14
    v_smfmac_f32_16x16x64_bf16 v[44:47], v[32:35], a[32:39], v14
    v_smfmac_f32_16x16x64_bf16 v[60:63], v[32:35], a[128:135], v14
    v_smfmac_f32_16x16x64_bf16 v[48:51], v[32:35], a[56:63], v14
    v_smfmac_f32_16x16x64_bf16 v[64:67], v[32:35], a[152:159], v14
    v_smfmac_f32_16x16x64_bf16 v[52:55], v[32:35], a[80:87], v14
    v_smfmac_f32_16x16x64_bf16 v[68:71], v[32:35], a[176:183], v14
    s_waitcnt lgkmcnt(0)
    v_smfmac_f32_16x16x64_bf16 v[40:43], v[36:39], a[16:23], v14
    v_smfmac_f32_16x16x64_bf16 v[56:59], v[36:39], a[112:119], v14
    v_smfmac_f32_16x16x64_bf16 v[44:47], v[36:39], a[40:47], v14
    v_smfmac_f32_16x16x64_bf16 v[60:63], v[36:39], a[136:143], v14
    v_smfmac_f32_16x16x64_bf16 v[48:51], v[36:39], a[64:71], v14
    v_smfmac_f32_16x16x64_bf16 v[64:67], v[36:39], a[160:167], v14
    v_smfmac_f32_16x16x64_bf16 v[52:55], v[36:39], a[88:95], v14
    v_smfmac_f32_16x16x64_bf16 v[68:71], v[36:39], a[184:191], v14
    buffer_load_dwordx4 v[224:227], v23, s[12:15], s87 offen offset:0 nt
    s_lshl_b32 s78, s72, 8
    v_add_f32_dpp v24, v40, v41 quad_perm:[0,1,2,3] row_mask:0x1 bank_mask:0xf
    v_add_f32_dpp v25, v56, v57 quad_perm:[0,1,2,3] row_mask:0x1 bank_mask:0xf
    v_bfe_u32 v27, v0, 4, 1
    v_add_f32_dpp v24, v44, v45 quad_perm:[0,1,2,3] row_mask:0x2 bank_mask:0xf
    v_add_f32_dpp v25, v60, v61 quad_perm:[0,1,2,3] row_mask:0x2 bank_mask:0xf
    v_bfe_u32 v28, v0, 2, 1
    v_add_f32_dpp v24, v48, v49 quad_perm:[0,1,2,3] row_mask:0x4 bank_mask:0xf
    v_add_f32_dpp v25, v64, v65 quad_perm:[0,1,2,3] row_mask:0x4 bank_mask:0xf
    s_add_u32 s78, s78, 124416
    v_add_f32_dpp v24, v52, v53 quad_perm:[0,1,2,3] row_mask:0x8 bank_mask:0xf
    v_add_f32_dpp v25, v68, v69 quad_perm:[0,1,2,3] row_mask:0x8 bank_mask:0xf
    v_max_f32 v26, v24, v25
    v_lshl_add_u32 v27, v27, 5, s78
    v_lshl_add_u32 v27, v28, 4, v27
    v_max_f32_dpp v26, v26, v26 row_ror:8 row_mask:0xf bank_mask:0xf
    s_nop 1
    v_max_f32_dpp v26, v26, v26 row_ror:4 row_mask:0xf bank_mask:0xf
    s_nop 1
    v_max_f32_dpp v26, v26, v26 row_ror:2 row_mask:0xf bank_mask:0xf
    s_nop 1
    v_max_f32_dpp v26, v26, v26 row_ror:1 row_mask:0xf bank_mask:0xf
    v_mov_b32 v28, v26
    s_nop 1
    v_permlane32_swap_b32 v26, v28
    v_max_f32 v26, v26, v28
    v_mov_b32 v28, v26
    s_nop 1
    v_permlane16_swap_b32 v26, v28
    v_max_f32 v26, v26, v28
    buffer_load_dwordx4 v[228:231], v23, s[12:15], s87 offen offset:1024 nt
    s_barrier
    v_mul_f32 v26, v26, v18
    v_fma_f32 v24, v24, v18, -v26
    v_fma_f32 v25, v25, v18, -v26
    v_exp_f32 v24, v24
    v_exp_f32 v25, v25
    s_nop 0
    v_cvt_pk_bf16_f32 v28, v24, v25
    ds_write_b16 v19, v28
    ds_write_b16_d16_hi v19, v28 offset:128
    s_mov_b32 exec_lo, 0xff00ff
    s_mov_b32 exec_hi, 0xff00ff00
    ds_read_b128 v[72:75], v27 offset:0
    ds_read_b128 v[76:79], v27 offset:64
    ds_read_b128 v[80:83], v27 offset:128
    ds_read_b128 v[84:87], v27 offset:192
    s_mov_b64 exec, -1
    v_add_f32 v27, v24, v25
    v_mov_b32 v40, 0
    v_mov_b32 v44, 0
    v_add_f32_dpp v27, v27, v27 row_ror:8 row_mask:0xf bank_mask:0xf
    v_mov_b32 v48, 0
    v_mov_b32 v52, 0
    v_add_f32_dpp v27, v27, v27 row_ror:4 row_mask:0xf bank_mask:0xf
    v_mov_b32 v56, 0
    v_mov_b32 v60, 0
    v_add_f32_dpp v27, v27, v27 row_ror:2 row_mask:0xf bank_mask:0xf
    s_lshl_b32 s78, s72, 3
    s_add_u32 s78, s78, 125440
    v_add_f32_dpp v27, v27, v27 row_ror:1 row_mask:0xf bank_mask:0xf
    v_mov_b32 v28, v27
    s_nop 1
    v_permlane32_swap_b32 v27, v28
    v_add_f32 v27, v27, v28
    v_mov_b32 v28, v27
    s_nop 1
    v_permlane16_swap_b32 v27, v28
    v_add_f32 v27, v27, v28
    v_mov_b32 v28, s78
    ds_write_b64 v28, v[26:27]
    s_waitcnt vmcnt(14)
    ds_write_b128 v2, v[160:163] offset:0
    ds_write_b128 v3, v[164:167] offset:0
    ds_write_b128 v4, v[168:171] offset:0
    ds_write_b128 v2, v[172:175] offset:3328
    ds_write_b128 v3, v[176:179] offset:3328
    ds_write_b128 v4, v[180:183] offset:3328
    ds_read_b64_tr_b16 v[114:115], v6 offset:0
    ds_read_b64_tr_b16 v[118:119], v6 offset:32
    ds_read_b64_tr_b16 v[122:123], v6 offset:64
    ds_read_b64_tr_b16 v[126:127], v6 offset:96
    ds_read_b64_tr_b16 v[130:131], v6 offset:128
    ds_read_b64_tr_b16 v[134:135], v6 offset:160
    ds_read_b64_tr_b16 v[138:139], v6 offset:192
    ds_read_b64_tr_b16 v[142:143], v6 offset:224
    ds_read_b64_tr_b16 v[146:147], v6 offset:256
    ds_read_b64_tr_b16 v[150:151], v6 offset:288
    ds_read_b64_tr_b16 v[154:155], v6 offset:320
    ds_read_b64_tr_b16 v[158:159], v6 offset:352
    buffer_load_dwordx4 v[232:235], v1, s[12:15], s88 offen offset:0 nt
    buffer_load_dwordx4 v[236:239], v1, s[12:15], s88 offen offset:1024 nt
    s_waitcnt lgkmcnt(0)
    v_smfmac_f32_16x16x64_bf16 v[40:43], v[72:75], a[192:199], v14 abid:1
    v_smfmac_f32_16x16x64_bf16 v[44:47], v[72:75], a[200:207], v14 abid:1
    v_smfmac_f32_16x16x64_bf16 v[48:51], v[72:75], a[208:215], v14 abid:1
    v_smfmac_f32_16x16x64_bf16 v[52:55], v[72:75], a[216:223], v14 abid:1
    v_smfmac_f32_16x16x64_bf16 v[56:59], v[72:75], a[224:231], v14 abid:1
    v_smfmac_f32_16x16x64_bf16 v[60:63], v[72:75], a[232:239], v14 abid:1
    buffer_load_dwordx4 v[240:243], v1, s[12:15], s88 offen offset:2048 nt
    v_smfmac_f32_16x16x64_bf16 v[40:43], v[76:79], v[112:119], v14 abid:1
    v_smfmac_f32_16x16x64_bf16 v[44:47], v[76:79], v[120:127], v14 abid:1
    v_smfmac_f32_16x16x64_bf16 v[48:51], v[76:79], v[128:135], v14 abid:1
    v_smfmac_f32_16x16x64_bf16 v[52:55], v[76:79], v[136:143], v14 abid:1
    v_smfmac_f32_16x16x64_bf16 v[56:59], v[76:79], v[144:151], v14 abid:1
    v_smfmac_f32_16x16x64_bf16 v[60:63], v[76:79], v[152:159], v14 abid:1
    buffer_load_dwordx4 v[244:247], v1, s[12:15], s88 offen offset:3072 nt
    s_waitcnt vmcnt(12)
    ds_write_b128 v2, v[184:187] offset:0
    ds_write_b128 v3, v[188:191] offset:0
    ds_write_b128 v4, v[192:195] offset:0
    ds_write_b128 v2, v[196:199] offset:3328
    ds_write_b128 v3, v[200:203] offset:3328
    ds_write_b128 v4, v[204:207] offset:3328
    ds_read_b64_tr_b16 v[160:161], v6 offset:0
    ds_read_b64_tr_b16 v[164:165], v6 offset:32
    ds_read_b64_tr_b16 v[168:169], v6 offset:64
    ds_read_b64_tr_b16 v[172:173], v6 offset:96
    ds_read_b64_tr_b16 v[176:177], v6 offset:128
    ds_read_b64_tr_b16 v[180:181], v6 offset:160
    ds_read_b64_tr_b16 v[184:185], v6 offset:192
    ds_read_b64_tr_b16 v[188:189], v6 offset:224
    ds_read_b64_tr_b16 v[192:193], v6 offset:256
    ds_read_b64_tr_b16 v[196:197], v6 offset:288
    ds_read_b64_tr_b16 v[200:201], v6 offset:320
    ds_read_b64_tr_b16 v[204:205], v6 offset:352
    buffer_load_dwordx4 v[248:251], v23, s[12:15], s88 offen offset:0 nt
    buffer_load_dwordx4 v[252:255], v23, s[12:15], s88 offen offset:1024 nt
    s_barrier
    buffer_load_dwordx4 v[88:91], v1, s[12:15], s89 offen offset:0 nt
    buffer_load_dwordx4 v[92:95], v1, s[12:15], s89 offen offset:1024 nt
    buffer_load_dwordx4 v[96:99], v1, s[12:15], s89 offen offset:2048 nt
    buffer_load_dwordx4 v[100:103], v1, s[12:15], s89 offen offset:3072 nt
    buffer_load_dwordx4 v[104:107], v23, s[12:15], s89 offen offset:0 nt
    buffer_load_dwordx4 v[108:111], v23, s[12:15], s89 offen offset:1024 nt
    s_waitcnt vmcnt(12)
    ds_write_b128 v2, v[208:211] offset:0
    ds_write_b128 v3, v[212:215] offset:0
    ds_write_b128 v4, v[216:219] offset:0
    ds_write_b128 v2, v[220:223] offset:3328
    ds_write_b128 v3, v[224:227] offset:3328
    ds_write_b128 v4, v[228:231] offset:3328
    ds_read_b64_tr_b16 v[162:163], v6 offset:0
    ds_read_b64_tr_b16 v[166:167], v6 offset:32
    ds_read_b64_tr_b16 v[170:171], v6 offset:64
    ds_read_b64_tr_b16 v[174:175], v6 offset:96
    ds_read_b64_tr_b16 v[178:179], v6 offset:128
    ds_read_b64_tr_b16 v[182:183], v6 offset:160
    ds_read_b64_tr_b16 v[186:187], v6 offset:192
    ds_read_b64_tr_b16 v[190:191], v6 offset:224
    ds_read_b64_tr_b16 v[194:195], v6 offset:256
    ds_read_b64_tr_b16 v[198:199], v6 offset:288
    ds_read_b64_tr_b16 v[202:203], v6 offset:320
    ds_read_b64_tr_b16 v[206:207], v6 offset:352
    v_and_b32 v23, 0xffff0000, v22
    v_lshlrev_b32 v22, 16, v22
    s_cmp_ge_u32 s69, 20
    s_cbranch_scc1 TAILF
    v_lshrrev_b32 v38, 2, v0
    v_mul_u32_u24 v38, 1280, v38
    v_and_b32 v39, 3, v0
    v_lshl_add_u32 v39, v39, 4, v38
    s_mov_b32 m0, s67
    s_add_u32 s67, s67, 1024
    buffer_load_dwordx4 v39, s[24:27], s66 offen  lds
    s_add_u32 s66, s66, 20480
    s_mov_b32 m0, s67
    s_add_u32 s67, s67, 1024
    buffer_load_dwordx4 v39, s[24:27], s66 offen  lds
    s_add_u32 s66, s66, 20480
    s_mov_b32 m0, s67
    s_add_u32 s67, s67, 1024
    buffer_load_dwordx4 v39, s[24:27], s66 offen  lds
    s_add_u32 s66, s66, 20480
    s_waitcnt lgkmcnt(0)
    v_smfmac_f32_16x16x64_bf16 v[40:43], v[80:83], v[160:167], v14 abid:1
    v_smfmac_f32_16x16x64_bf16 v[44:47], v[80:83], v[168:175], v14 abid:1
    v_smfmac_f32_16x16x64_bf16 v[48:51], v[80:83], v[176:183], v14 abid:1
    v_smfmac_f32_16x16x64_bf16 v[52:55], v[80:83], v[184:191], v14 abid:1
    v_smfmac_f32_16x16x64_bf16 v[56:59], v[80:83], v[192:199], v14 abid:1
    v_smfmac_f32_16x16x64_bf16 v[60:63], v[80:83], v[200:207], v14 abid:1
    s_waitcnt vmcnt(9)
    ds_write_b128 v2, v[232:235] offset:0
    ds_write_b128 v3, v[236:239] offset:0
    ds_write_b128 v4, v[240:243] offset:0
    ds_write_b128 v2, v[244:247] offset:3328
    ds_write_b128 v3, v[248:251] offset:3328
    ds_write_b128 v4, v[252:255] offset:3328
    ds_read_b64_tr_b16 v[208:209], v6 offset:0
    ds_read_b64_tr_b16 v[212:213], v6 offset:32
    ds_read_b64_tr_b16 v[216:217], v6 offset:64
    ds_read_b64_tr_b16 v[220:221], v6 offset:96
    ds_read_b64_tr_b16 v[224:225], v6 offset:128
    ds_read_b64_tr_b16 v[228:229], v6 offset:160
    ds_read_b64_tr_b16 v[232:233], v6 offset:192
    ds_read_b64_tr_b16 v[236:237], v6 offset:224
    ds_read_b64_tr_b16 v[240:241], v6 offset:256
    ds_read_b64_tr_b16 v[244:245], v6 offset:288
    ds_read_b64_tr_b16 v[248:249], v6 offset:320
    ds_read_b64_tr_b16 v[252:253], v6 offset:352
    s_mov_b32 m0, s67
    s_add_u32 s67, s67, 1024
    buffer_load_dwordx4 v39, s[24:27], s66 offen  lds
    s_add_u32 s66, s66, 20480
    s_mov_b32 m0, s67
    s_add_u32 s67, s67, 1024
    buffer_load_dwordx4 v39, s[24:27], s66 offen  lds
    s_add_u32 s66, s66, 20480
    s_mov_b32 m0, s67
    s_add_u32 s67, s67, 1024
    buffer_load_dwordx4 v39, s[24:27], s66 offen  lds
    s_add_u32 s66, s66, 20480
    s_waitcnt vmcnt(11)
    ds_write_b128 v2, v[88:91] offset:0
    s_waitcnt vmcnt(10)
    ds_write_b128 v3, v[92:95] offset:0
    s_waitcnt vmcnt(9)
    ds_write_b128 v4, v[96:99] offset:0
    s_waitcnt vmcnt(8)
    ds_write_b128 v2, v[100:103] offset:3328
    s_waitcnt vmcnt(7)
    ds_write_b128 v3, v[104:107] offset:3328
    s_waitcnt vmcnt(6)
    ds_write_b128 v4, v[108:111] offset:3328
    ds_read_b64_tr_b16 v[210:211], v6 offset:0
    ds_read_b64_tr_b16 v[214:215], v6 offset:32
    ds_read_b64_tr_b16 v[218:219], v6 offset:64
    ds_read_b64_tr_b16 v[222:223], v6 offset:96
    ds_read_b64_tr_b16 v[226:227], v6 offset:128
    ds_read_b64_tr_b16 v[230:231], v6 offset:160
    ds_read_b64_tr_b16 v[234:235], v6 offset:192
    ds_read_b64_tr_b16 v[238:239], v6 offset:224
    ds_read_b64_tr_b16 v[242:243], v6 offset:256
    ds_read_b64_tr_b16 v[246:247], v6 offset:288
    ds_read_b64_tr_b16 v[250:251], v6 offset:320
    ds_read_b64_tr_b16 v[254:255], v6 offset:352
    s_mov_b32 m0, s67
    s_add_u32 s67, s67, 1024
    buffer_load_dwordx4 v39, s[24:27], s66 offen  lds
    s_add_u32 s66, s66, 20480
    s_mov_b32 m0, s67
    s_add_u32 s67, s67, 1024
    buffer_load_dwordx4 v39, s[24:27], s66 offen  lds
    s_add_u32 s66, s66, 20480
    s_branch ATT_LAST
TAILF:
    s_lshl_b32 s90, s72, 3
    s_add_u32 s90, s90, s68
    s_mul_i32 s90, s90, 24
    s_add_u32 s90, s90, s69
    s_sub_u32 s90, s90, 8
    s_mul_i32 s90, s90, 10240
    buffer_load_dwordx4 a[240:243], v1, s[20:23], s90 offen offset:0
    buffer_load_dwordx4 a[240:243], v1, s[20:23], s90 offen offset:1024
    buffer_load_dwordx4 a[240:243], v1, s[20:23], s90 offen offset:2048
    buffer_load_dwordx4 a[240:243], v1, s[20:23], s90 offen offset:3072
    s_add_u32 s90, s90, 4096
    buffer_load_dwordx4 a[240:243], v1, s[20:23], s90 offen offset:0
    buffer_load_dwordx4 a[240:243], v1, s[20:23], s90 offen offset:1024
    buffer_load_dwordx4 a[240:243], v1, s[20:23], s90 offen offset:2048
    s_waitcnt lgkmcnt(0)
    v_smfmac_f32_16x16x64_bf16 v[40:43], v[80:83], v[160:167], v14 abid:1
    v_smfmac_f32_16x16x64_bf16 v[44:47], v[80:83], v[168:175], v14 abid:1
    v_smfmac_f32_16x16x64_bf16 v[48:51], v[80:83], v[176:183], v14 abid:1
    v_smfmac_f32_16x16x64_bf16 v[52:55], v[80:83], v[184:191], v14 abid:1
    v_smfmac_f32_16x16x64_bf16 v[56:59], v[80:83], v[192:199], v14 abid:1
    v_smfmac_f32_16x16x64_bf16 v[60:63], v[80:83], v[200:207], v14 abid:1
    s_waitcnt vmcnt(13)
    ds_write_b128 v2, v[232:235] offset:0
    ds_write_b128 v3, v[236:239] offset:0
    ds_write_b128 v4, v[240:243] offset:0
    ds_write_b128 v2, v[244:247] offset:3328
    ds_write_b128 v3, v[248:251] offset:3328
    ds_write_b128 v4, v[252:255] offset:3328
    ds_read_b64_tr_b16 v[208:209], v6 offset:0
    ds_read_b64_tr_b16 v[212:213], v6 offset:32
    ds_read_b64_tr_b16 v[216:217], v6 offset:64
    ds_read_b64_tr_b16 v[220:221], v6 offset:96
    ds_read_b64_tr_b16 v[224:225], v6 offset:128
    ds_read_b64_tr_b16 v[228:229], v6 offset:160
    ds_read_b64_tr_b16 v[232:233], v6 offset:192
    ds_read_b64_tr_b16 v[236:237], v6 offset:224
    ds_read_b64_tr_b16 v[240:241], v6 offset:256
    ds_read_b64_tr_b16 v[244:245], v6 offset:288
    ds_read_b64_tr_b16 v[248:249], v6 offset:320
    ds_read_b64_tr_b16 v[252:253], v6 offset:352
    buffer_load_dwordx4 a[240:243], v1, s[20:23], s90 offen offset:3072
    s_add_u32 s90, s90, 4096
    buffer_load_dwordx4 a[240:243], v1, s[20:23], s90 offen offset:0
    buffer_load_dwordx4 a[240:243], v1, s[20:23], s90 offen offset:1024
    s_waitcnt vmcnt(15)
    ds_write_b128 v2, v[88:91] offset:0
    s_waitcnt vmcnt(14)
    ds_write_b128 v3, v[92:95] offset:0
    s_waitcnt vmcnt(13)
    ds_write_b128 v4, v[96:99] offset:0
    s_waitcnt vmcnt(12)
    ds_write_b128 v2, v[100:103] offset:3328
    s_waitcnt vmcnt(11)
    ds_write_b128 v3, v[104:107] offset:3328
    s_waitcnt vmcnt(10)
    ds_write_b128 v4, v[108:111] offset:3328
    ds_read_b64_tr_b16 v[210:211], v6 offset:0
    ds_read_b64_tr_b16 v[214:215], v6 offset:32
    ds_read_b64_tr_b16 v[218:219], v6 offset:64
    ds_read_b64_tr_b16 v[222:223], v6 offset:96
    ds_read_b64_tr_b16 v[226:227], v6 offset:128
    ds_read_b64_tr_b16 v[230:231], v6 offset:160
    ds_read_b64_tr_b16 v[234:235], v6 offset:192
    ds_read_b64_tr_b16 v[238:239], v6 offset:224
    ds_read_b64_tr_b16 v[242:243], v6 offset:256
    ds_read_b64_tr_b16 v[246:247], v6 offset:288
    ds_read_b64_tr_b16 v[250:251], v6 offset:320
    ds_read_b64_tr_b16 v[254:255], v6 offset:352
    s_branch ATT_LAST
LOOP:
    ds_read_b64_tr_b16 v[40:41], v16 offset:0
    ds_read_b64_tr_b16 v[42:43], v16 offset:1536
    ds_read_b64_tr_b16 v[44:45], v16 offset:12288
    ds_read_b64_tr_b16 v[46:47], v16 offset:13824
    ds_read_b64_tr_b16 v[48:49], v17 offset:24576
    ds_read_b64_tr_b16 v[50:51], v16 offset:32
    ds_read_b64_tr_b16 v[52:53], v16 offset:1568
    ds_read_b64_tr_b16 v[54:55], v16 offset:12320
    ds_read_b64_tr_b16 v[56:57], v16 offset:13856
    ds_read_b64_tr_b16 v[58:59], v17 offset:24608
    ds_read_b64_tr_b16 v[60:61], v16 offset:64
    ds_read_b64_tr_b16 v[62:63], v16 offset:1600
    ds_read_b64_tr_b16 v[64:65], v16 offset:12352
    ds_read_b64_tr_b16 v[66:67], v16 offset:13888
    ds_read_b64_tr_b16 v[68:69], v17 offset:24640
    v_and_b32 v25, 15, v0
    v_cmp_eq_u32 vcc, 12, v25
    v_mov_b32 v36, 0x3f803f80
    s_nop 0
    v_cndmask_b32 v70, 0, v36, vcc
    v_mov_b32 v71, v70
    v_mov_b32 v72, v70
    v_mov_b32 v73, v70
    v_mov_b32 v74, v70
    v_mov_b32 v75, v70
    v_mov_b32 v76, v70
    v_mov_b32 v77, v70
    v_mov_b32 v78, v70
    v_mov_b32 v79, v70
    s_cmp_lt_u32 s69, 20
    s_cselect_b32 s5, s72, 0
    s_add_u32 s79, s3, 4096
    s_mul_i32 s77, s72, 6656
    v_mul_u32_u24 v26, 103, v0
    v_lshrrev_b32 v26, 10, v26
    v_lshl_add_u32 v26, v26, 4, v1
    v_add_u32 v26, s77, v26
    v_mul_u32_u24 v27, 176, v25
    v_add_u32 v27, s77, v27
    v_lshrrev_b32 v28, 4, v0
    v_lshl_add_u32 v29, v28, 3, v27
    v_lshl_add_u32 v27, v28, 4, v27
    s_mul_i32 s77, s71, 160
    s_add_u32 s77, s77, s3
    s_sub_u32 s77, s77, 640768
    s_waitcnt lgkmcnt(0)
    s_mov_b32 exec_lo, 0x3ff
    s_mov_b32 exec_hi, 0x0
    s_mov_b32 s76, 1
POLL4:
    buffer_load_dword v24, v1, s[16:19], s77 offen sc1
POLLW4:
    s_waitcnt vmcnt(0)
    v_cmp_eq_u32 vcc, -1, v24
    s_cbranch_vccnz AGAIN4
POLLX4:
    s_mov_b32 exec_lo, 0xffffffff
    s_mov_b32 exec_hi, 0xfffffff
    buffer_load_dwordx4 v[80:83], v8, s[16:19], 0 offen sc1
    buffer_load_dwordx4 v[84:87], v9, s[16:19], 0 offen sc1
    s_waitcnt vmcnt(0)
    v_max_u32 v24, v80, v84
    v_cmp_eq_u32 vcc, -1, v24
    s_cbranch_vccnz AGAIN5
POLLX5:
    ds_write_b128 v26, v[80:83]
    ds_write_b128 v26, v[84:87] offset:1056
    s_mov_b32 exec_lo, 0x1ff01ff
    s_mov_b32 exec_hi, 0x1ff01ff
    ds_read_b128 v[70:73], v27
    ds_read_b128 v[74:77], v27 offset:64
    ds_read_b64 v[78:79], v29 offset:128
    s_mov_b64 exec, -1
    s_cmp_lg_u32 s5, 1
    s_cbranch_scc1 NOOWL
    buffer_load_dword a244, v20, s[16:19], 0 offen sc1
    buffer_load_dword a245, v21, s[16:19], 0 offen sc1
NOOWL:
    s_waitcnt lgkmcnt(2)
    v_mfma_f32_16x16x32_bf16 v[24:27], v[70:73], v[40:43], 0
    v_mfma_f32_16x16x32_bf16 v[32:35], v[70:73], v[60:63], 0
    s_waitcnt lgkmcnt(0)
    v_mfma_f32_16x16x32_bf16 v[24:27], v[74:77], v[44:47], v[24:27]
    v_mfma_f32_16x16x32_bf16 v[32:35], v[74:77], v[64:67], v[32:35]
    v_mfma_f32_16x16x16_bf16 v[24:27], v[78:79], v[48:49], v[24:27]
    v_mfma_f32_16x16x16_bf16 v[32:35], v[78:79], v[68:69], v[32:35]
    v_mfma_f32_16x16x32_bf16 v[28:31], v[70:73], v[50:53], 0
    v_mfma_f32_16x16x32_bf16 v[36:39], v[70:73], v[70:73], 0
    v_mfma_f32_16x16x32_bf16 v[28:31], v[74:77], v[54:57], v[28:31]
    v_mfma_f32_16x16x32_bf16 v[36:39], v[74:77], v[74:77], v[36:39]
    v_mfma_f32_16x16x16_bf16 v[28:31], v[78:79], v[58:59], v[28:31]
    v_mfma_f32_16x16x16_bf16 v[36:39], v[78:79], v[78:79], v[36:39]
    s_nop 0
    v_add_f32 v24, v24, v25
    v_add_f32 v26, v26, v27
    v_add_f32 v24, v24, v26
    v_add_f32 v32, v32, v33
    v_add_f32 v34, v34, v35
    v_add_f32 v32, v32, v34
    s_nop 1
    v_permlane32_swap_b32 v24, v32
    v_add_f32 v28, v28, v29
    v_add_f32 v30, v30, v31
    v_add_f32 v36, v36, v37
    v_add_f32 v38, v38, v39
    v_add_f32 v24, v24, v32
    v_add_f32 v28, v28, v30
    v_add_f32 v36, v36, v38
    s_nop 1
    v_permlane32_swap_b32 v28, v36
    v_add_f32 v28, v28, v36
    s_nop 1
    v_permlane16_swap_b32 v24, v28
    v_add_f32 v24, v24, v28
    s_cmp_eq_u32 s75, 1
    s_cbranch_scc0 SLOW6
    buffer_store_dword v24, v10, s[16:19], s3 offen
BACK6:
    v_mov_b32 v40, 0
    v_mov_b32 v41, 0
    v_mov_b32 v44, 0
    v_mov_b32 v45, 0
    v_mov_b32 v48, 0
    v_mov_b32 v49, 0
    v_mov_b32 v52, 0
    v_mov_b32 v53, 0
    v_mov_b32 v56, 0
    v_mov_b32 v57, 0
    v_mov_b32 v60, 0
    v_mov_b32 v61, 0
    v_mov_b32 v64, 0
    v_mov_b32 v65, 0
    v_mov_b32 v68, 0
    v_mov_b32 v69, 0
    v_mov_b32 v72, 0
    v_mov_b32 v73, 0
    v_mov_b32 v74, 0
    v_mov_b32 v75, 0
    v_mov_b32 v76, 0
    v_mov_b32 v77, 0
    v_mov_b32 v78, 0
    v_mov_b32 v79, 0
    v_mov_b32 v80, 0
    v_mov_b32 v81, 0
    v_mov_b32 v82, 0
    v_mov_b32 v83, 0
    v_mov_b32 v84, 0
    v_mov_b32 v85, 0
    v_mov_b32 v86, 0
    v_mov_b32 v87, 0
    s_mov_b32 s76, 1
POLL7:
    buffer_load_dwordx4 v[24:27], v11, s[16:19], s3 offen sc1
    buffer_load_dwordx4 v[28:31], v11, s[16:19], s79 offen sc1
POLLW7:
    s_waitcnt vmcnt(0)
    v_max3_u32 v32, v24, v25, v26
    v_max3_u32 v32, v32, v27, v28
    v_max3_u32 v32, v32, v29, v30
    v_max_u32 v32, v32, v31
    v_cmp_eq_u32 vcc, -1, v32
    s_cbranch_vccnz AGAIN7
POLLX7:
    v_add_f32 v24, v24, v28
    v_add_f32 v25, v25, v29
    v_add_f32 v26, v26, v30
    v_add_f32 v27, v27, v31
    s_nop 0
    v_permlane32_swap_b32 v24, v26
    v_permlane32_swap_b32 v25, v27
    v_add_f32 v24, v24, v26
    v_add_f32 v25, v25, v27
    s_nop 1
    v_permlane16_swap_b32 v24, v25
    v_add_f32 v24, v24, v25
    s_nop 0
    v_readlane_b32 s77, v24, 15
    s_mov_b32 vcc_lo, 0x70007000
    s_mov_b32 vcc_hi, 0x70007000
    v_fma_f32 v25, -s77, v7, v24
    v_cvt_pk_bf16_f32 v25, v25, v25
    ds_write_b16 v12, v25
    v_cndmask_b32 v26, 0, v24, vcc
    s_nop 1
    v_add_f32_dpp v26, v26, v26 quad_perm:[1,0,3,2] row_mask:0xf bank_mask:0xf
    s_nop 1
    v_add_f32_dpp v26, v26, v26 quad_perm:[2,3,0,1] row_mask:0xf bank_mask:0xf
    v_mov_b32 v27, v26
    s_nop 1
    v_permlane32_swap_b32 v26, v27
    v_add_f32 v26, v26, v27
    s_waitcnt lgkmcnt(0)
    s_barrier
    ds_read_b128 v[28:31], v13 offset:0
    ds_read_b128 v[32:35], v13 offset:128
    ds_read_b128 v[36:39], v13 offset:256
    v_mov_b32 v27, v26
    v_mov_b32 v25, s77
    v_subrev_f32 v25, 0x44200000, v25
    v_permlane16_swap_b32 v26, v27
    v_add_f32 v26, v26, v27
    v_mul_f32 v24, 0x3acccccd, v25
    v_readlane_b32 s77, v26, 15
    v_mul_f32 v24, v24, v24
    s_mov_b32 s78, 0x3acccccd
    v_sub_f32 v26, s77, v25
    v_fma_f32 v26, v26, s78, -v24
    v_max_f32 v26, 0, v26
    v_add_f32 v26, 0x3727c5ac, v26
    v_rsq_f32 v26, v26
    s_nop 0
    v_mul_f32 v18, 0x3dd53b94, v26
    s_waitcnt lgkmcnt(2)
    v_smfmac_f32_16x16x64_bf16 v[40:43], v[28:31], a[0:7], v14
    v_smfmac_f32_16x16x64_bf16 v[56:59], v[28:31], a[96:103], v14
    v_smfmac_f32_16x16x64_bf16 v[44:47], v[28:31], a[24:31], v14
    v_smfmac_f32_16x16x64_bf16 v[60:63], v[28:31], a[120:127], v14
    v_smfmac_f32_16x16x64_bf16 v[48:51], v[28:31], a[48:55], v14
    v_smfmac_f32_16x16x64_bf16 v[64:67], v[28:31], a[144:151], v14
    v_smfmac_f32_16x16x64_bf16 v[52:55], v[28:31], a[72:79], v14
    v_smfmac_f32_16x16x64_bf16 v[68:71], v[28:31], a[168:175], v14
    s_waitcnt lgkmcnt(1)
    v_smfmac_f32_16x16x64_bf16 v[40:43], v[32:35], a[8:15], v14
    v_smfmac_f32_16x16x64_bf16 v[56:59], v[32:35], a[104:111], v14
    v_smfmac_f32_16x16x64_bf16 v[44:47], v[32:35], a[32:39], v14
    v_smfmac_f32_16x16x64_bf16 v[60:63], v[32:35], a[128:135], v14
    v_smfmac_f32_16x16x64_bf16 v[48:51], v[32:35], a[56:63], v14
    v_smfmac_f32_16x16x64_bf16 v[64:67], v[32:35], a[152:159], v14
    v_smfmac_f32_16x16x64_bf16 v[52:55], v[32:35], a[80:87], v14
    v_smfmac_f32_16x16x64_bf16 v[68:71], v[32:35], a[176:183], v14
    s_waitcnt lgkmcnt(0)
    v_smfmac_f32_16x16x64_bf16 v[40:43], v[36:39], a[16:23], v14
    v_smfmac_f32_16x16x64_bf16 v[56:59], v[36:39], a[112:119], v14
    v_smfmac_f32_16x16x64_bf16 v[44:47], v[36:39], a[40:47], v14
    v_smfmac_f32_16x16x64_bf16 v[60:63], v[36:39], a[136:143], v14
    v_smfmac_f32_16x16x64_bf16 v[48:51], v[36:39], a[64:71], v14
    v_smfmac_f32_16x16x64_bf16 v[64:67], v[36:39], a[160:167], v14
    v_smfmac_f32_16x16x64_bf16 v[52:55], v[36:39], a[88:95], v14
    v_smfmac_f32_16x16x64_bf16 v[68:71], v[36:39], a[184:191], v14
    s_lshl_b32 s78, s72, 8
    v_add_f32_dpp v24, v40, v41 quad_perm:[0,1,2,3] row_mask:0x1 bank_mask:0xf
    v_add_f32_dpp v25, v56, v57 quad_perm:[0,1,2,3] row_mask:0x1 bank_mask:0xf
    v_bfe_u32 v27, v0, 4, 1
    v_add_f32_dpp v24, v44, v45 quad_perm:[0,1,2,3] row_mask:0x2 bank_mask:0xf
    v_add_f32_dpp v25, v60, v61 quad_perm:[0,1,2,3] row_mask:0x2 bank_mask:0xf
    v_bfe_u32 v28, v0, 2, 1
    v_add_f32_dpp v24, v48, v49 quad_perm:[0,1,2,3] row_mask:0x4 bank_mask:0xf
    v_add_f32_dpp v25, v64, v65 quad_perm:[0,1,2,3] row_mask:0x4 bank_mask:0xf
    s_add_u32 s78, s78, 124416
    v_add_f32_dpp v24, v52, v53 quad_perm:[0,1,2,3] row_mask:0x8 bank_mask:0xf
    v_add_f32_dpp v25, v68, v69 quad_perm:[0,1,2,3] row_mask:0x8 bank_mask:0xf
    v_max_f32 v26, v24, v25
    v_lshl_add_u32 v27, v27, 5, s78
    v_lshl_add_u32 v27, v28, 4, v27
    v_max_f32_dpp v26, v26, v26 row_ror:8 row_mask:0xf bank_mask:0xf
    s_nop 1
    v_max_f32_dpp v26, v26, v26 row_ror:4 row_mask:0xf bank_mask:0xf
    s_nop 1
    v_max_f32_dpp v26, v26, v26 row_ror:2 row_mask:0xf bank_mask:0xf
    s_nop 1
    v_max_f32_dpp v26, v26, v26 row_ror:1 row_mask:0xf bank_mask:0xf
    v_mov_b32 v28, v26
    s_nop 1
    v_permlane32_swap_b32 v26, v28
    v_max_f32 v26, v26, v28
    v_mov_b32 v28, v26
    s_nop 1
    v_permlane16_swap_b32 v26, v28
    v_max_f32 v26, v26, v28
    v_mul_f32 v26, v26, v18
    v_fma_f32 v24, v24, v18, -v26
    v_fma_f32 v25, v25, v18, -v26
    v_exp_f32 v24, v24
    v_exp_f32 v25, v25
    s_nop 0
    v_cvt_pk_bf16_f32 v28, v24, v25
    ds_write_b16 v19, v28
    ds_write_b16_d16_hi v19, v28 offset:128
    s_mov_b32 exec_lo, 0xff00ff
    s_mov_b32 exec_hi, 0xff00ff00
    ds_read_b128 v[72:75], v27 offset:0
    ds_read_b128 v[76:79], v27 offset:64
    ds_read_b128 v[80:83], v27 offset:128
    ds_read_b128 v[84:87], v27 offset:192
    s_mov_b64 exec, -1
    v_add_f32 v27, v24, v25
    v_mov_b32 v40, 0
    v_mov_b32 v44, 0
    v_add_f32_dpp v27, v27, v27 row_ror:8 row_mask:0xf bank_mask:0xf
    v_mov_b32 v48, 0
    v_mov_b32 v52, 0
    v_add_f32_dpp v27, v27, v27 row_ror:4 row_mask:0xf bank_mask:0xf
    v_mov_b32 v56, 0
    v_mov_b32 v60, 0
    v_add_f32_dpp v27, v27, v27 row_ror:2 row_mask:0xf bank_mask:0xf
    s_lshl_b32 s78, s72, 3
    s_add_u32 s78, s78, 125440
    v_add_f32_dpp v27, v27, v27 row_ror:1 row_mask:0xf bank_mask:0xf
    v_mov_b32 v28, v27
    s_nop 1
    v_permlane32_swap_b32 v27, v28
    v_add_f32 v27, v27, v28
    v_mov_b32 v28, v27
    s_nop 1
    v_permlane16_swap_b32 v27, v28
    v_add_f32 v27, v27, v28
    v_mov_b32 v28, s78
    ds_write_b64 v28, v[26:27]
    s_waitcnt lgkmcnt(4)
    v_smfmac_f32_16x16x64_bf16 v[40:43], v[72:75], a[192:199], v14 abid:1
    v_smfmac_f32_16x16x64_bf16 v[44:47], v[72:75], a[200:207], v14 abid:1
    v_smfmac_f32_16x16x64_bf16 v[48:51], v[72:75], a[208:215], v14 abid:1
    v_smfmac_f32_16x16x64_bf16 v[52:55], v[72:75], a[216:223], v14 abid:1
    v_smfmac_f32_16x16x64_bf16 v[56:59], v[72:75], a[224:231], v14 abid:1
    v_smfmac_f32_16x16x64_bf16 v[60:63], v[72:75], a[232:239], v14 abid:1
    s_waitcnt lgkmcnt(3)
    v_smfmac_f32_16x16x64_bf16 v[40:43], v[76:79], v[112:119], v14 abid:1
    v_smfmac_f32_16x16x64_bf16 v[44:47], v[76:79], v[120:127], v14 abid:1
    v_smfmac_f32_16x16x64_bf16 v[48:51], v[76:79], v[128:135], v14 abid:1
    v_smfmac_f32_16x16x64_bf16 v[52:55], v[76:79], v[136:143], v14 abid:1
    v_smfmac_f32_16x16x64_bf16 v[56:59], v[76:79], v[144:151], v14 abid:1
    v_smfmac_f32_16x16x64_bf16 v[60:63], v[76:79], v[152:159], v14 abid:1
    s_waitcnt lgkmcnt(2)
    v_smfmac_f32_16x16x64_bf16 v[40:43], v[80:83], v[160:167], v14 abid:1
    v_smfmac_f32_16x16x64_bf16 v[44:47], v[80:83], v[168:175], v14 abid:1
    v_smfmac_f32_16x16x64_bf16 v[48:51], v[80:83], v[176:183], v14 abid:1
    v_smfmac_f32_16x16x64_bf16 v[52:55], v[80:83], v[184:191], v14 abid:1
    v_smfmac_f32_16x16x64_bf16 v[56:59], v[80:83], v[192:199], v14 abid:1
    v_smfmac_f32_16x16x64_bf16 v[60:63], v[80:83], v[200:207], v14 abid:1
    s_waitcnt lgkmcnt(0)
ATT_LAST:
    s_waitcnt lgkmcnt(8)
    v_smfmac_f32_16x16x64_bf16 v[40:43], v[84:87], v[208:215], v14 abid:1
    v_smfmac_f32_16x16x64_bf16 v[44:47], v[84:87], v[216:223], v14 abid:1
    s_waitcnt lgkmcnt(4)
    v_smfmac_f32_16x16x64_bf16 v[48:51], v[84:87], v[224:231], v14 abid:1
    v_smfmac_f32_16x16x64_bf16 v[52:55], v[84:87], v[232:239], v14 abid:1
    s_waitcnt lgkmcnt(0)
    v_smfmac_f32_16x16x64_bf16 v[56:59], v[84:87], v[240:247], v14 abid:1
    v_smfmac_f32_16x16x64_bf16 v[60:63], v[84:87], v[248:255], v14 abid:1
    v_add_u32 v24, 119296, v1
    v_mov_b32 v25, 125440
    v_lshlrev_b32 v39, 6, v0
    v_permlane16_swap_b32 v40, v44
    v_add_f32 v40, v40, v44
    ds_write_b32 v15, v40 offset:0
    v_permlane16_swap_b32 v48, v52
    v_add_f32 v48, v48, v52
    ds_write_b32 v15, v48 offset:256
    v_permlane16_swap_b32 v56, v60
    v_add_f32 v56, v56, v60
    ds_write_b32 v15, v56 offset:512
    s_cmp_lg_u32 s72, 0
    s_waitcnt lgkmcnt(0)
    s_barrier
    s_cbranch_scc1 ODONE
    ds_read_b128 v[64:67], v25
    ds_read_b128 v[68:71], v25 offset:16
    ds_read_b128 v[40:43], v24 offset:0
    ds_read_b128 v[44:47], v24 offset:768
    ds_read_b128 v[48:51], v24 offset:1536
    ds_read_b128 v[52:55], v24 offset:2304
    s_mul_i32 s77, s70, 3072
    s_lshl_b32 s78, s71, 4
    s_add_u32 s77, s77, s78
    s_add_u32 s77, s77, s3
    s_add_u32 s77, s77, 32768
    s_lshl_b32 s78, s69, 3
    s_add_u32 s78, s78, s3
    s_add_u32 s78, s78, 45056
    s_waitcnt lgkmcnt(4)
    v_max3_f32 v32, v64, v66, v68
    v_max_f32 v32, v32, v70
    v_sub_f32 v64, v64, v32
    v_sub_f32 v66, v66, v32
    v_sub_f32 v68, v68, v32
    v_sub_f32 v70, v70, v32
    v_exp_f32 v64, v64
    v_exp_f32 v66, v66
    v_exp_f32 v68, v68
    v_exp_f32 v70, v70
    s_waitcnt lgkmcnt(0)
    v_mul_f32 v28, v64, v40
    v_mul_f32 v29, v64, v41
    v_mul_f32 v30, v64, v42
    v_mul_f32 v31, v64, v43
    v_fmac_f32 v28, v66, v44
    v_fmac_f32 v29, v66, v45
    v_fmac_f32 v30, v66, v46
    v_fmac_f32 v31, v66, v47
    v_fmac_f32 v28, v68, v48
    v_fmac_f32 v29, v68, v49
    v_fmac_f32 v30, v68, v50
    v_fmac_f32 v31, v68, v51
    v_fmac_f32 v28, v70, v52
    v_fmac_f32 v29, v70, v53
    v_fmac_f32 v30, v70, v54
    v_fmac_f32 v31, v70, v55
    v_cvt_pk_bf16_f32 v28, v28, v29
    v_cvt_pk_bf16_f32 v29, v30, v31
    s_nop 0
    v_mov_b32_dpp v30, v28 quad_perm:[1,1,3,3] row_mask:0xf bank_mask:0xf
    v_mov_b32_dpp v31, v29 quad_perm:[1,1,3,3] row_mask:0xf bank_mask:0xf
    s_mov_b32 exec_lo, 0x55555555
    s_mov_b32 exec_hi, 0x5555
    s_cmp_eq_u32 s75, 1
    s_cbranch_scc0 SLOW8
    buffer_store_dwordx4 v[28:31], v39, s[16:19], s77 offen
BACK8:
    v_mul_f32 v33, v64, v65
    v_fmac_f32 v33, v66, v67
    v_fmac_f32 v33, v68, v69
    v_fmac_f32 v33, v70, v71
    s_mov_b64 exec, 1
    s_cmp_eq_u32 s75, 1
    s_cbranch_scc0 SLOW9
    buffer_store_dwordx2 v[32:33], v39, s[16:19], s78 offen
BACK9:
    s_mov_b64 exec, -1
ODONE:
    s_cmp_ge_u32 s69, 20
    s_cbranch_scc1 ROLEF
    s_cmp_eq_u32 s74, 0
    s_cbranch_scc1 WLATE
WGO:
    v_accvgpr_read_b32 v2, a246
    v_accvgpr_read_b32 v3, a247
    v_accvgpr_read_b32 v4, a248
    v_mov_b32 v88, 0
    v_mov_b32 v92, 0
    v_mov_b32 v96, 0
    v_mov_b32 v100, 0
    v_mov_b32 v104, 0
    v_mov_b32 v108, 0
    ds_read_b64_tr_b16 v[40:41], v2 offset:0
    ds_read_b64_tr_b16 v[42:43], v2 offset:256
    ds_read_b64_tr_b16 v[64:65], v2 offset:32
    ds_read_b64_tr_b16 v[66:67], v2 offset:288
    ds_read_b64_tr_b16 v[44:45], v2 offset:2048
    ds_read_b64_tr_b16 v[46:47], v2 offset:2304
    ds_read_b64_tr_b16 v[68:69], v2 offset:2080
    ds_read_b64_tr_b16 v[70:71], v2 offset:2336
    ds_read_b64_tr_b16 v[48:49], v2 offset:4096
    ds_read_b64_tr_b16 v[50:51], v2 offset:4352
    s_cmp_lg_u32 s72, 1
    s_cbranch_scc1 NOOWN0
    s_cmp_eq_u32 s74, 0
    s_cbranch_scc1 NOOWN0
    v_accvgpr_read_b32 v28, a244
    v_accvgpr_read_b32 v29, a245
    v_max_u32 v30, v28, v29
    v_cmp_eq_u32 vcc, -1, v30
    s_cbranch_vccnz RETRY10
OK10:
    v_lshlrev_b32 v30, 16, v28
    v_and_b32 v28, 0xffff0000, v28
    v_lshlrev_b32 v31, 16, v29
    v_and_b32 v29, 0xffff0000, v29
    v_add_f32 v30, v30, v31
    v_add_f32 v28, v28, v29
    v_mov_b32 v31, v30
    v_mov_b32 v29, v28
    s_nop 0
    v_permlane32_swap_b32 v30, v31
    v_permlane32_swap_b32 v28, v29
    v_add_f32 v30, v30, v31
    v_add_f32 v28, v28, v29
    v_mov_b32 v31, v30
    v_mov_b32 v29, v28
    s_nop 0
    v_permlane16_swap_b32 v30, v31
    v_permlane16_swap_b32 v28, v29
    v_add_f32 v30, v30, v31
    v_add_f32 v28, v28, v29
    v_add_f32 v22, v22, v30
    v_add_f32 v23, v23, v28
    v_cvt_pk_bf16_f32 v28, v22, v23
    s_lshl_b32 s77, s69, 6
    s_add_u32 s77, s77, s3
    s_add_u32 s77, s77, 48640
    v_lshlrev_b32 v37, 2, v0
    v_mov_b32_dpp v29, v28 quad_perm:[1,1,1,1] row_mask:0xf bank_mask:0xf
    v_mov_b32_dpp v30, v28 quad_perm:[2,2,2,2] row_mask:0xf bank_mask:0xf
    v_mov_b32_dpp v31, v28 quad_perm:[3,3,3,3] row_mask:0xf bank_mask:0xf
    s_mov_b32 exec_lo, 0x1111
    s_mov_b32 exec_hi, 0x0
    s_cmp_eq_u32 s75, 1
    s_cbranch_scc0 SLOW11
    buffer_store_dwordx4 v[28:31], v37, s[16:19], s77 offen
BACK11:
    s_mov_b64 exec, -1
NOOWN0:
    v_mov_b32 v25, 0
    v_mov_b32 v27, 0
    v_mov_b32 v37, 0
    v_mov_b32 v39, 0
    s_mov_b32 exec_lo, 0x00ff00ff
    s_mov_b32 exec_hi, 0x00ff00ff
    buffer_load_dwordx4 v[88:91], v3, s[16:19], s3 offen offset:0 sc1
    buffer_load_dwordx4 v[92:95], v3, s[16:19], s3 offen offset:512 sc1
    buffer_load_dwordx4 v[96:99], v3, s[16:19], s3 offen offset:1024 sc1
    buffer_load_dwordx4 v[100:103], v3, s[16:19], s3 offen offset:1536 sc1
    buffer_load_dwordx4 v[104:107], v3, s[16:19], s3 offen offset:2048 sc1
    buffer_load_dwordx4 v[108:111], v3, s[16:19], s3 offen offset:2560 sc1
    s_mov_b32 exec_lo, -1
    s_mov_b32 exec_hi, 0
    buffer_load_dwordx4 v[24:27], v4, s[16:19], s3 offen offset:0 sc1
    buffer_load_dwordx4 v[36:39], v4, s[16:19], s3 offen offset:16 sc1
    s_mov_b64 exec, -1
    ds_read_b64_tr_b16 v[72:73], v2 offset:4128
    ds_read_b64_tr_b16 v[74:75], v2 offset:4384
    ds_read_b64_tr_b16 v[52:53], v2 offset:6144
    ds_read_b64_tr_b16 v[54:55], v2 offset:6400
    ds_read_b64_tr_b16 v[76:77], v2 offset:6176
    ds_read_b64_tr_b16 v[78:79], v2 offset:6432
    ds_read_b64_tr_b16 v[56:57], v2 offset:8192
    ds_read_b64_tr_b16 v[58:59], v2 offset:8448
    ds_read_b64_tr_b16 v[80:81], v2 offset:8224
    ds_read_b64_tr_b16 v[82:83], v2 offset:8480
    ds_read_b64_tr_b16 v[60:61], v2 offset:10240
    ds_read_b64_tr_b16 v[62:63], v2 offset:10496
    ds_read_b64_tr_b16 v[84:85], v2 offset:10272
    ds_read_b64_tr_b16 v[86:87], v2 offset:10528
    v_accvgpr_read_b32 v5, a249
    v_add_u32 v6, 119296, v1
    v_lshrrev_b32 v18, 1, v1
    s_waitcnt vmcnt(0)
    v_max3_u32 v28, v88, v92, v96
    v_max3_u32 v28, v28, v100, v104
    v_max3_u32 v28, v28, v108, v25
    v_max3_u32 v28, v28, v27, v37
    v_max_u32 v28, v28, v39
    v_cmp_eq_u32 vcc, -1, v28
    s_cbranch_vccnz AGAIN12
POLLX12:
    s_waitcnt lgkmcnt(0)
    v_mfma_f32_16x16x32_bf16 v[28:31], v[88:91], v[40:43], 0
    v_mfma_f32_16x16x32_bf16 v[32:35], v[88:91], v[64:67], 0
    v_max3_f32 v88, v24, v26, v36
    v_max_f32 v88, v88, v38
    v_mfma_f32_16x16x32_bf16 v[28:31], v[92:95], v[44:47], v[28:31]
    v_mov_b32 v89, v88
    v_mfma_f32_16x16x32_bf16 v[32:35], v[92:95], v[68:71], v[32:35]
    s_nop 0
    v_permlane16_swap_b32 v88, v89
    v_max_f32 v88, v88, v89
    v_mfma_f32_16x16x32_bf16 v[28:31], v[96:99], v[48:51], v[28:31]
    v_sub_f32 v24, v24, v88
    v_sub_f32 v26, v26, v88
    v_mfma_f32_16x16x32_bf16 v[32:35], v[96:99], v[72:75], v[32:35]
    v_sub_f32 v36, v36, v88
    v_sub_f32 v38, v38, v88
    v_mfma_f32_16x16x32_bf16 v[28:31], v[100:103], v[52:55], v[28:31]
    v_exp_f32 v24, v24
    v_mfma_f32_16x16x32_bf16 v[32:35], v[100:103], v[76:79], v[32:35]
    v_exp_f32 v26, v26
    v_mfma_f32_16x16x32_bf16 v[28:31], v[104:107], v[56:59], v[28:31]
    v_exp_f32 v36, v36
    v_mfma_f32_16x16x32_bf16 v[32:35], v[104:107], v[80:83], v[32:35]
    v_exp_f32 v38, v38
    v_mfma_f32_16x16x32_bf16 v[28:31], v[108:111], v[60:63], v[28:31]
    v_mul_f32 v90, v24, v25
    v_fmac_f32 v90, v26, v27
    v_mfma_f32_16x16x32_bf16 v[32:35], v[108:111], v[84:87], v[32:35]
    v_fmac_f32 v90, v36, v37
    v_fmac_f32 v90, v38, v39
    v_mov_b32 v89, v90
    s_cmp_lg_u32 s72, 0
    s_nop 0
    v_permlane16_swap_b32 v90, v89
    v_add_f32 v90, v90, v89
    v_rcp_f32 v90, v90
    v_mul_f32 v28, v24, v28
    v_mul_f32 v32, v24, v32
    v_fmac_f32 v28, v26, v29
    v_fmac_f32 v32, v26, v33
    v_fmac_f32 v28, v36, v30
    v_fmac_f32 v32, v36, v34
    v_fmac_f32 v28, v38, v31
    v_fmac_f32 v32, v38, v35
    s_nop 1
    v_permlane16_swap_b32 v28, v32
    v_add_f32 v28, v28, v32
    v_mul_f32 v28, v28, v90
    ds_write_b32 v5, v28
    s_waitcnt lgkmcnt(0)
    s_barrier
    s_cbranch_scc1 WNOT0
    ds_read_b128 v[40:43], v6 offset:3072
    ds_read_b128 v[44:47], v6 offset:3328
    ds_read_b128 v[48:51], v6 offset:3584
    ds_read_b128 v[52:55], v6 offset:3840
    s_waitcnt lgkmcnt(2)
    v_add_f32 v28, v40, v44
    v_add_f32 v29, v41, v45
    v_add_f32 v30, v42, v46
    v_add_f32 v31, v43, v47
    s_waitcnt lgkmcnt(0)
    v_add_f32 v32, v48, v52
    v_add_f32 v33, v49, v53
    v_add_f32 v34, v50, v54
    v_add_f32 v35, v51, v55
    v_add_f32 v28, v28, v32
    v_add_f32 v29, v29, v33
    v_add_f32 v30, v30, v34
    v_add_f32 v31, v31, v35
    v_cvt_pk_bf16_f32 v28, v28, v29
    v_cvt_pk_bf16_f32 v29, v30, v31
    s_nop 0
    v_mov_b32_dpp v30, v28 quad_perm:[1,1,3,3] row_mask:0xf bank_mask:0xf
    v_mov_b32_dpp v31, v29 quad_perm:[1,1,3,3] row_mask:0xf bank_mask:0xf
    s_mov_b32 exec_lo, 0x55
    s_mov_b32 exec_hi, 0x0
    buffer_store_dwordx4 v[28:31], v18, s[16:19], s80 offen sc1
    s_cmp_eq_u32 s75, 1
    s_cbranch_scc0 SLOW13
    buffer_store_dwordx4 v[28:31], v18, s[16:19], s81 offen
BACK13:
    s_mov_b64 exec, -1
    v_lshrrev_b32 v37, 5, v0
    v_mul_u32_u24 v37, 2560, v37
    v_and_b32 v38, 31, v0
    v_lshl_add_u32 v37, v38, 2, v37
    v_add_u32 v41, 5120, v37
    v_add_u32 v42, 10240, v37
    v_add_u32 v43, 15360, v37
    v_add_u32 v44, 20480, v37
    v_add_u32 v45, 25600, v37
    s_lshl_b32 s79, s69, 7
    s_add_u32 s79, s79, s3
    s_add_u32 s79, s79, 51200
    s_add_u32 s96, s80, 10240
    s_add_u32 s97, s81, 1280
    v_lshlrev_b32 v39, 1, v0
    s_cmp_lg_u32 s74, 0
    s_cbranch_scc1 NOLC
    s_mul_i32 s77, s69, 2464
    s_add_u32 s78, s3, 720896
    v_add_u32 v48, s77, v1
    v_min_u32 v48, 49136, v48
    s_add_u32 s77, s77, 1024
    v_add_u32 v49, s77, v1
    v_min_u32 v49, 49136, v49
    s_add_u32 s77, s77, 1024
    v_add_u32 v50, s77, v1
    v_min_u32 v50, 49136, v50
    s_add_u32 s77, s77, 1024
    buffer_load_dwordx4 a[240:243], v48, s[16:19], s78 offen sc1
    buffer_load_dwordx4 a[240:243], v49, s[16:19], s78 offen sc1
    buffer_load_dwordx4 a[240:243], v50, s[16:19], s78 offen sc1
    v_mov_b32 v52, -1
    v_mov_b32 v53, -1
    v_mov_b32 v54, -1
    v_mov_b32 v55, -1
    s_add_u32 s77, s80, 688128
    s_add_u32 s7, s96, 688128
    s_waitcnt vmcnt(0)
    s_cmp_eq_u32 s75, 1
    s_cbranch_scc0 SLOW14
    buffer_store_dwordx4 v[52:55], v48, s[16:19], s78 offen
BACK14:
    s_cmp_eq_u32 s75, 1
    s_cbranch_scc0 SLOW15
    buffer_store_dwordx4 v[52:55], v49, s[16:19], s78 offen
BACK15:
    s_cmp_eq_u32 s75, 1
    s_cbranch_scc0 SLOW16
    buffer_store_dwordx4 v[52:55], v50, s[16:19], s78 offen
BACK16:
    s_mov_b64 exec, 15
    buffer_store_dwordx4 v[52:55], v1, s[16:19], s77 offen sc1
    buffer_store_dwordx4 v[52:55], v1, s[16:19], s7 offen sc1
    s_mov_b64 exec, -1
NOLC:
    s_mov_b32 s76, 1
POLL17:
    buffer_load_dword v28, v37, s[16:19], s79 offen sc1
    buffer_load_dword v29, v41, s[16:19], s79 offen sc1
    buffer_load_dword v30, v42, s[16:19], s79 offen sc1
    buffer_load_dword v31, v43, s[16:19], s79 offen sc1
    buffer_load_dword v32, v44, s[16:19], s79 offen sc1
    buffer_load_dword v33, v45, s[16:19], s79 offen sc1
POLLW17:
    s_waitcnt vmcnt(0)
    v_max3_u32 v36, v28, v29, v30
    v_max3_u32 v36, v36, v31, v32
    v_max_u32 v36, v36, v33
    v_cmp_eq_u32 vcc, -1, v36
    s_cbranch_vccnz AGAIN17
POLLX17:
    v_add_f32 v28, v28, v29
    v_add_f32 v30, v30, v31
    v_add_f32 v32, v32, v33
    v_add_f32 v28, v28, v30
    v_add_f32 v28, v28, v32
    v_mov_b32 v29, v28
    s_nop 1
    v_permlane32_swap_b32 v28, v29
    v_add_f32 v28, v28, v29
    s_nop 1
    v_mov_b32_dpp v29, v28 row_shl:1 row_mask:0xf bank_mask:0xf
    v_cvt_pk_bf16_f32 v28, v28, v29
    s_nop 1
    v_mov_b32_dpp v29, v28 row_shl:2 row_mask:0xf bank_mask:0xf
    v_mov_b32_dpp v30, v28 row_shl:4 row_mask:0xf bank_mask:0xf
    v_mov_b32_dpp v31, v28 row_shl:6 row_mask:0xf bank_mask:0xf
    s_mov_b32 exec_lo, 0x1010101
    s_mov_b32 exec_hi, 0x0
    buffer_store_dwordx4 v[28:31], v39, s[16:19], s96 offen sc1
    s_cmp_eq_u32 s75, 1
    s_cbranch_scc0 SLOW18
    buffer_store_dwordx4 v[28:31], v39, s[16:19], s97 offen
BACK18:
    s_mov_b64 exec, -1
    s_branch NEXT
AGAIN4:
    s_add_u32 s76, s76, 1
    s_cmp_lt_u32 s76, 32768
    s_cbranch_scc1 POLL4
    s_branch POLLX4
AGAIN5:
    s_mov_b64 s[94:95], exec
    s_mov_b32 s76, 1
AG25:
    v_cmp_eq_u32 vcc, -1, v80
    s_nop 0
    s_mov_b64 exec, vcc
    s_cbranch_execz AG35_0
    buffer_load_dwordx4 v[80:83], v8, s[16:19], 0 offen sc1
AG35_0:
    s_mov_b64 exec, s[94:95]
    v_cmp_eq_u32 vcc, -1, v84
    s_nop 0
    s_mov_b64 exec, vcc
    s_cbranch_execz AG35_1
    buffer_load_dwordx4 v[84:87], v9, s[16:19], 0 offen sc1
AG35_1:
    s_mov_b64 exec, s[94:95]
    s_add_u32 s76, s76, 1
    s_cmp_ge_u32 s76, 32768
    s_waitcnt vmcnt(0)
    v_max_u32 v24, v80, v84
    v_cmp_eq_u32 vcc, -1, v24
    s_cbranch_vccz POLLX5
    s_cbranch_scc0 AG25
    s_branch POLLX5
AGAIN7:
    s_add_u32 s76, s76, 1
    s_cmp_lt_u32 s76, 32768
    s_cbranch_scc1 POLL7
    s_branch POLLX7
WLATE:
    v_lshrrev_b32 v38, 2, v0
    v_mul_u32_u24 v38, 1280, v38
    v_and_b32 v39, 3, v0
    v_lshl_add_u32 v39, v39, 4, v38
    s_mov_b32 m0, s67
    s_add_u32 s67, s67, 1024
    buffer_load_dwordx4 v39, s[24:27], s66 offen  lds
    s_add_u32 s66, s66, 20480
    s_mov_b32 m0, s67
    s_add_u32 s67, s67, 1024
    buffer_load_dwordx4 v39, s[24:27], s66 offen  lds
    s_add_u32 s66, s66, 20480
    s_mov_b32 m0, s67
    s_add_u32 s67, s67, 1024
    buffer_load_dwordx4 v39, s[24:27], s66 offen  lds
    s_add_u32 s66, s66, 20480
    s_mov_b32 m0, s67
    s_add_u32 s67, s67, 1024
    buffer_load_dwordx4 v39, s[24:27], s66 offen  lds
    s_add_u32 s66, s66, 20480
    s_waitcnt vmcnt(0)
    s_branch WGO
AGAIN12:
    s_mov_b64 s[94:95], exec
    s_mov_b32 s76, 1
AG212:
    v_max3_u32 v28, v88, v92, v96
    v_max3_u32 v28, v28, v100, v104
    v_max_u32 v28, v28, v108
    v_cmp_eq_u32 vcc, -1, v28
    s_nop 0
    s_mov_b64 exec, vcc
    s_cbranch_execz AG312_0
    buffer_load_dwordx4 v[88:91], v3, s[16:19], s3 offen offset:0 sc1
    buffer_load_dwordx4 v[92:95], v3, s[16:19], s3 offen offset:512 sc1
    buffer_load_dwordx4 v[96:99], v3, s[16:19], s3 offen offset:1024 sc1
    buffer_load_dwordx4 v[100:103], v3, s[16:19], s3 offen offset:1536 sc1
    buffer_load_dwordx4 v[104:107], v3, s[16:19], s3 offen offset:2048 sc1
    buffer_load_dwordx4 v[108:111], v3, s[16:19], s3 offen offset:2560 sc1
AG312_0:
    s_mov_b64 exec, s[94:95]
    v_max3_u32 v28, v25, v27, v37
    v_max_u32 v28, v28, v39
    v_cmp_eq_u32 vcc, -1, v28
    s_nop 0
    s_mov_b64 exec, vcc
    s_cbranch_execz AG312_1
    buffer_load_dwordx4 v[24:27], v4, s[16:19], s3 offen offset:0 sc1
    buffer_load_dwordx4 v[36:39], v4, s[16:19], s3 offen offset:16 sc1
AG312_1:
    s_mov_b64 exec, s[94:95]
    s_add_u32 s76, s76, 1
    s_cmp_ge_u32 s76, 32768
    s_waitcnt vmcnt(0)
    v_max3_u32 v28, v88, v92, v96
    v_max3_u32 v28, v28, v100, v104
    v_max3_u32 v28, v28, v108, v25
    v_max3_u32 v28, v28, v27, v37
    v_max_u32 v28, v28, v39
    v_cmp_eq_u32 vcc, -1, v28
    s_cbranch_vccz POLLX12
    s_cbranch_scc0 AG212
    s_branch POLLX12
AGAIN17:
    s_add_u32 s76, s76, 1
    s_cmp_lt_u32 s76, 32768
    s_cbranch_scc1 POLL17
    s_branch POLLX17
WNOT0:
    s_cmp_lg_u32 s72, 1
    s_cbranch_scc1 NEXT
    v_and_b32 v25, 15, v0
    v_lshrrev_b32 v26, 4, v0
    v_mul_u32_u24 v37, 1280, v26
    v_add_u32 v37, 655360, v37
    s_mul_i32 s7, s68, 81920
    s_add_u32 s7, s7, 46080
    v_mov_b32 v38, s7
    v_cmp_eq_u32 vcc, s68, v26
    s_nop 1
    v_cndmask_b32 v37, v37, v38, vcc
    v_add_u32 v39, 4, v26
    v_mul_u32_u24 v38, 1280, v39
    v_add_u32 v38, 655360, v38
    s_mul_i32 s7, s68, 81920
    s_add_u32 s7, s7, 46080
    v_mov_b32 v28, s7
    v_cmp_eq_u32 vcc, s68, v39
    s_nop 1
    v_cndmask_b32 v38, v38, v28, vcc
    s_lshl_b32 s77, s69, 6
    s_add_u32 s77, s77, s74
    v_lshl_add_u32 v37, v25, 2, v37
    v_lshl_add_u32 v38, v25, 2, v38
    s_sleep 16
    s_mov_b32 s76, 1
POLL19:
    buffer_load_dword v28, v37, s[16:19], s77 offen sc1
    buffer_load_dword v29, v38, s[16:19], s77 offen sc1
POLLW19:
    s_waitcnt vmcnt(0)
    v_max_u32 v30, v28, v29
    v_cmp_eq_u32 vcc, -1, v30
    s_cbranch_vccnz AGAIN19
POLLX19:
    v_lshlrev_b32 v30, 16, v28
    v_and_b32 v28, 0xffff0000, v28
    v_lshlrev_b32 v31, 16, v29
    v_and_b32 v29, 0xffff0000, v29
    v_add_f32 v30, v30, v31
    v_add_f32 v28, v28, v29
    v_mov_b32 v31, v30
    v_mov_b32 v29, v28
    s_nop 0
    v_permlane32_swap_b32 v30, v31
    v_permlane32_swap_b32 v28, v29
    v_add_f32 v30, v30, v31
    v_add_f32 v28, v28, v29
    v_mov_b32 v31, v30
    v_mov_b32 v29, v28
    s_nop 0
    v_permlane16_swap_b32 v30, v31
    v_permlane16_swap_b32 v28, v29
    v_add_f32 v30, v30, v31
    v_add_f32 v28, v28, v29
    v_add_f32 v22, v22, v30
    v_add_f32 v23, v23, v28
    v_cvt_pk_bf16_f32 v28, v22, v23
    s_cmp_lg_u32 s74, 0
    s_cbranch_scc1 FINAL
    s_lshl_b32 s77, s69, 6
    s_add_u32 s77, s77, s3
    s_add_u32 s77, s77, 49920
    v_lshlrev_b32 v37, 2, v0
    v_mov_b32_dpp v29, v28 quad_perm:[1,1,1,1] row_mask:0xf bank_mask:0xf
    v_mov_b32_dpp v30, v28 quad_perm:[2,2,2,2] row_mask:0xf bank_mask:0xf
    v_mov_b32_dpp v31, v28 quad_perm:[3,3,3,3] row_mask:0xf bank_mask:0xf
    s_mov_b32 exec_lo, 0x1111
    s_mov_b32 exec_hi, 0x0
    s_cmp_eq_u32 s75, 1
    s_cbranch_scc0 SLOW20
    buffer_store_dwordx4 v[28:31], v37, s[16:19], s77 offen
BACK20:
    s_mov_b64 exec, -1
    s_branch NEXT
FINAL:
    s_cmp_lg_u32 s68, 0
    s_cbranch_scc1 DONE
    s_lshl_b32 s77, s69, 6
    v_lshlrev_b32 v37, 2, v0
    s_add_u32 s79, s77, s3
    s_add_u32 s79, s79, 47360
    s_mov_b64 exec, 15
    s_mov_b32 s76, 1
POLL21:
    buffer_load_dword v28, v1, s[16:19], s79 offen sc1
POLLW21:
    s_waitcnt vmcnt(0)
    v_cmp_eq_u32 vcc, -1, v28
    s_cbranch_vccnz AGAIN21
POLLX21:
    s_mov_b64 exec, -1
    s_mov_b32 s76, 1
POLL22:
    buffer_load_dword v28, v20, s[16:19], s74 offen sc1
    buffer_load_dword v29, v21, s[16:19], s74 offen sc1
POLLW22:
    s_waitcnt vmcnt(0)
    v_max_u32 v30, v28, v29
    v_cmp_eq_u32 vcc, -1, v30
    s_cbranch_vccnz AGAIN22
POLLX22:
    v_lshlrev_b32 v30, 16, v28
    v_and_b32 v28, 0xffff0000, v28
    v_lshlrev_b32 v31, 16, v29
    v_and_b32 v29, 0xffff0000, v29
    v_add_f32 v30, v30, v31
    v_add_f32 v28, v28, v29
    v_mov_b32 v31, v30
    v_mov_b32 v29, v28
    s_nop 0
    v_permlane32_swap_b32 v30, v31
    v_permlane32_swap_b32 v28, v29
    v_add_f32 v30, v30, v31
    v_add_f32 v28, v28, v29
    v_mov_b32 v31, v30
    v_mov_b32 v29, v28
    s_nop 0
    v_permlane16_swap_b32 v30, v31
    v_permlane16_swap_b32 v28, v29
    v_add_f32 v30, v30, v31
    v_add_f32 v28, v28, v29
    v_add_f32 v22, v22, v30
    v_add_f32 v23, v23, v28
    v_cvt_pk_bf16_f32 v28, v22, v23
    s_mov_b32 exec_lo, 0xffff
    s_mov_b32 exec_hi, 0x0
    buffer_store_dword v28, v37, s[40:43], s77 offen
    s_mov_b64 exec, -1
    s_endpgm
AGAIN19:
    s_sleep 4
    s_add_u32 s76, s76, 1
    s_cmp_lt_u32 s76, 32768
    s_cbranch_scc1 POLL19
    s_branch POLLX19
AGAIN21:
    s_add_u32 s76, s76, 1
    s_cmp_lt_u32 s76, 32768
    s_cbranch_scc1 POLL21
    s_branch POLLX21
AGAIN22:
    s_add_u32 s76, s76, 1
    s_cmp_lt_u32 s76, 32768
    s_cbranch_scc1 POLL22
    s_branch POLLX22
ROLEF:
    v_and_b32 v25, 15, v0
    v_lshrrev_b32 v26, 4, v0
    v_bfe_u32 v27, v0, 2, 2
    v_and_b32 v36, 3, v0
    s_mov_b32 s4, 1
    s_cmp_lg_u32 s74, 0
    s_cbranch_scc1 FW
    s_mov_b32 s4, 0
FW:
    s_mul_i32 s77, s72, 5120
    s_add_u32 s77, s77, 57344
    v_lshl_add_u32 v37, v26, 3, v27
    v_lshlrev_b32 v37, 5, v37
    v_lshl_add_u32 v37, v36, 3, v37
    v_add_u32 v37, s77, v37
    ds_read_b64_tr_b16 v[40:41], v37 offset:0
    ds_read_b64_tr_b16 v[42:43], v37 offset:128
    ds_read_b64_tr_b16 v[44:45], v37 offset:1024
    ds_read_b64_tr_b16 v[46:47], v37 offset:1152
    ds_read_b64_tr_b16 v[48:49], v37 offset:2048
    ds_read_b64_tr_b16 v[50:51], v37 offset:2176
    ds_read_b64_tr_b16 v[52:53], v37 offset:3072
    ds_read_b64_tr_b16 v[54:55], v37 offset:3200
    ds_read_b64_tr_b16 v[56:57], v37 offset:4096
    ds_read_b64_tr_b16 v[58:59], v37 offset:4224
    ds_read_b64_tr_b16 v[60:61], v37 offset:20480
    ds_read_b64_tr_b16 v[62:63], v37 offset:20608
    ds_read_b64_tr_b16 v[64:65], v37 offset:21504
    ds_read_b64_tr_b16 v[66:67], v37 offset:21632
    ds_read_b64_tr_b16 v[68:69], v37 offset:22528
    ds_read_b64_tr_b16 v[70:71], v37 offset:22656
    ds_read_b64_tr_b16 v[72:73], v37 offset:23552
    ds_read_b64_tr_b16 v[74:75], v37 offset:23680
    ds_read_b64_tr_b16 v[76:77], v37 offset:24576
    ds_read_b64_tr_b16 v[78:79], v37 offset:24704
    s_mul_i32 s77, s72, 320
    s_add_u32 s77, s77, 98304
    v_lshrrev_b32 v80, 2, v0
    v_mul_u32_u24 v80, 1280, v80
    v_lshl_add_u32 v80, v36, 3, v80
    v_add_u32 v80, s77, v80
    s_lshl_b32 s79, s72, 2
    s_add_u32 s79, s79, 123392
    v_add_u32 v81, s79, v1
    v_lshl_add_u32 v82, v26, 2, v36
    v_lshlrev_b32 v82, 4, v82
    v_add_u32 v82, 123392, v82
    v_cmp_eq_u32 vcc, 12, v25
    v_mov_b32 v38, 13
    s_nop 0
    v_cndmask_b32 v83, v25, v38, vcc
    v_lshlrev_b32 v83, 4, v83
    v_add_u32 v83, 123904, v83
    v_mov_b32 v85, 124096
    v_lshlrev_b32 v84, 6, v25
    v_lshl_add_u32 v84, v26, 4, v84
    v_mov_b32 v38, 0x3f803f80
    v_cndmask_b32 v88, 0, v38, vcc
    v_mov_b32 v89, v88
    v_mov_b32 v90, v88
    v_mov_b32 v91, v88
    v_mov_b32 v92, v88
    v_mov_b32 v93, v88
    v_mov_b32 v94, v88
    v_mov_b32 v95, v88
    v_mov_b32 v96, v88
    v_mov_b32 v97, v88
    v_mov_b32 v98, v88
    v_mov_b32 v99, v88
    v_mov_b32 v100, v88
    v_mov_b32 v101, v88
    v_mov_b32 v102, v88
    v_mov_b32 v103, v88
    v_mov_b32 v104, v88
    v_mov_b32 v105, v88
    v_mov_b32 v106, v88
    v_mov_b32 v107, v88
    s_mul_i32 s77, s72, 6656
    v_mul_u32_u24 v6, 336, v25
    v_lshl_add_u32 v6, v26, 4, v6
    v_add_u32 v6, s77, v6
    v_mul_u32_u24 v37, 52, v0
    v_lshrrev_b32 v37, 10, v37
    v_lshl_add_u32 v87, v37, 4, v1
    v_add_u32 v87, s77, v87
    v_mul_u32_u24 v27, 320, v37
    v_sub_u32 v27, v1, v27
    v_mul_u32_u24 v86, 1280, v37
    v_add_u32 v86, 655360, v86
    s_mul_i32 s7, s68, 81920
    s_add_u32 s7, s7, 46080
    v_mov_b32 v38, s7
    v_cmp_eq_u32 vcc, s68, v37
    s_nop 1
    v_cndmask_b32 v86, v86, v38, vcc
    v_add_u32 v38, 2560, v38
    v_cmp_le_u32 vcc, 8, v37
    s_nop 1
    v_cndmask_b32 v86, v86, v38, vcc
    v_add_u32 v86, v86, v27
    v_add_u32 v37, 3, v37
    v_mul_u32_u24 v18, 1280, v37
    v_add_u32 v18, 655360, v18
    s_mul_i32 s7, s68, 81920
    s_add_u32 s7, s7, 46080
    v_mov_b32 v38, s7
    v_cmp_eq_u32 vcc, s68, v37
    s_nop 1
    v_cndmask_b32 v18, v18, v38, vcc
    v_add_u32 v38, 2560, v38
    v_cmp_le_u32 vcc, 8, v37
    s_nop 1
    v_cndmask_b32 v18, v18, v38, vcc
    v_add_u32 v18, v18, v27
    v_add_u32 v37, 3, v37
    v_mul_u32_u24 v20, 1280, v37
    v_add_u32 v20, 655360, v20
    s_mul_i32 s7, s68, 81920
    s_add_u32 s7, s7, 46080
    v_mov_b32 v38, s7
    v_cmp_eq_u32 vcc, s68, v37
    s_nop 1
    v_cndmask_b32 v20, v20, v38, vcc
    v_add_u32 v38, 2560, v38
    v_cmp_le_u32 vcc, 8, v37
    s_nop 1
    v_cndmask_b32 v20, v20, v38, vcc
    v_add_u32 v20, v20, v27
    s_mul_i32 s77, s72, 320
    s_add_u32 s77, s77, s74
    s_sub_u32 s78, s69, 20
    s_mul_i32 s78, s78, 2560
    s_mul_i32 s7, s72, 640
    s_add_u32 s78, s78, s7
    s_add_u32 s78, s78, s3
    s_add_u32 s78, s78, 51200
    s_waitcnt lgkmcnt(0)
    s_cmp_eq_u32 s4, 0
    s_cbranch_scc1 FW2
FPOLL:
    ds_read_b64_tr_b16 a[240:241], v80 offset:0
    ds_read_b64_tr_b16 a[242:243], v80 offset:32
    ds_read_b64_tr_b16 a[244:245], v80 offset:64
    ds_read_b64_tr_b16 a[246:247], v80 offset:96
    ds_read_b64_tr_b16 a[248:249], v80 offset:128
    ds_read_b64_tr_b16 a[250:251], v80 offset:160
    ds_read_b64_tr_b16 v[108:109], v80 offset:192
    ds_read_b64_tr_b16 v[110:111], v80 offset:224
    ds_read_b64_tr_b16 v[2:3], v80 offset:256
    ds_read_b64_tr_b16 v[4:5], v80 offset:288
    s_waitcnt lgkmcnt(0)
    s_mul_i32 s79, s72, 320
    s_add_u32 s79, s79, s3
    s_add_u32 s79, s79, 46080
    s_mov_b32 exec_lo, 0xfffff
    s_mov_b32 exec_hi, 0x0
    s_mov_b32 s76, 1
POLL23:
    buffer_load_dword v36, v1, s[16:19], s79 offen sc1
POLLW23:
    s_waitcnt vmcnt(0)
    v_cmp_eq_u32 vcc, -1, v36
    s_cbranch_vccnz AGAIN23
POLLX23:
    s_mov_b32 exec_lo, 0xffffffff
    s_mov_b32 exec_hi, 0xfffffff
    buffer_load_dwordx4 v[24:27], v86, s[16:19], s77 offen sc1
    buffer_load_dwordx4 v[28:31], v18, s[16:19], s77 offen sc1
    buffer_load_dwordx4 v[32:35], v20, s[16:19], s77 offen sc1
    s_waitcnt vmcnt(0)
    v_max3_u32 v36, v24, v28, v32
    v_cmp_eq_u32 vcc, -1, v36
    s_cbranch_vccnz AGAIN24
POLLX24:
    ds_write_b128 v87, v[24:27] offset:0
    ds_write_b128 v87, v[28:31] offset:1008
    ds_write_b128 v87, v[32:35] offset:2016
    s_mov_b32 exec_lo, 0x1ff01ff
    s_mov_b32 exec_hi, 0x1ff01ff
    ds_read_b128 v[88:91], v6 offset:0
    ds_read_b128 v[92:95], v6 offset:64
    ds_read_b128 v[96:99], v6 offset:128
    ds_read_b128 v[100:103], v6 offset:192
    ds_read_b128 v[104:107], v6 offset:256
    s_mov_b64 exec, -1
FMM:
    s_waitcnt lgkmcnt(4)
    v_mfma_f32_16x16x32_bf16 v[24:27], v[88:91], v[40:43], 0
    v_mfma_f32_16x16x32_bf16 v[28:31], v[88:91], v[60:63], 0
    v_mfma_f32_16x16x32_bf16 v[32:35], v[88:91], v[88:91], 0
    s_waitcnt lgkmcnt(3)
    v_mfma_f32_16x16x32_bf16 v[24:27], v[92:95], v[44:47], v[24:27]
    v_mfma_f32_16x16x32_bf16 v[28:31], v[92:95], v[64:67], v[28:31]
    v_mfma_f32_16x16x32_bf16 v[32:35], v[92:95], v[92:95], v[32:35]
    s_waitcnt lgkmcnt(2)
    v_mfma_f32_16x16x32_bf16 v[24:27], v[96:99], v[48:51], v[24:27]
    v_mfma_f32_16x16x32_bf16 v[28:31], v[96:99], v[68:71], v[28:31]
    v_mfma_f32_16x16x32_bf16 v[32:35], v[96:99], v[96:99], v[32:35]
    s_waitcnt lgkmcnt(1)
    v_mfma_f32_16x16x32_bf16 v[24:27], v[100:103], v[52:55], v[24:27]
    v_mfma_f32_16x16x32_bf16 v[28:31], v[100:103], v[72:75], v[28:31]
    v_mfma_f32_16x16x32_bf16 v[32:35], v[100:103], v[100:103], v[32:35]
    s_waitcnt lgkmcnt(0)
    v_mfma_f32_16x16x32_bf16 v[24:27], v[104:107], v[56:59], v[24:27]
    v_mfma_f32_16x16x32_bf16 v[28:31], v[104:107], v[76:79], v[28:31]
    v_mfma_f32_16x16x32_bf16 v[32:35], v[104:107], v[104:107], v[32:35]
    s_nop 5
    v_add_f32 v24, v24, v25
    v_add_f32 v26, v26, v27
    v_add_f32 v28, v28, v29
    v_add_f32 v30, v30, v31
    v_add_f32 v32, v32, v33
    v_add_f32 v34, v34, v35
    v_add_f32 v24, v24, v26
    v_add_f32 v28, v28, v30
    v_add_f32 v32, v32, v34
    s_nop 1
    v_permlane32_swap_b32 v24, v32
    v_permlane32_swap_b32 v28, v25
    v_add_f32 v24, v24, v32
    v_add_f32 v28, v28, v25
    s_nop 1
    v_permlane16_swap_b32 v24, v28
    v_add_f32 v24, v24, v28
    ds_write_b32 v81, v24
    s_cmp_eq_u32 s4, 0
    s_waitcnt lgkmcnt(0)
    s_barrier
    ds_read_b128 v[24:27], v83
    ds_read_b128 v[28:31], v85
    ds_read_b128 v[32:35], v82
    ds_read_b128 v[36:39], v82 offset:256
    s_cbranch_scc1 FCS
    s_waitcnt lgkmcnt(3)
    v_add_f32 v24, v24, v25
    v_add_f32 v26, v26, v27
    v_add_f32 v24, v24, v26
    s_waitcnt lgkmcnt(2)
    v_add_f32 v28, v28, v29
    v_add_f32_dpp v24, v24, v24 row_ror:8 row_mask:0xf bank_mask:0xf
    v_add_f32 v30, v30, v31
    v_add_f32 v28, v28, v30
    v_add_f32_dpp v24, v24, v24 row_ror:4 row_mask:0xf bank_mask:0xf
    s_waitcnt lgkmcnt(0)
    v_subrev_f32 v29, 0x44200000, v28
    v_add_f32_dpp v24, v24, v24 row_ror:2 row_mask:0xf bank_mask:0xf
    v_add_f32 v32, v32, v33
    v_mul_f32 v30, 0x3acccccd, v29
    v_add_f32_dpp v24, v24, v24 row_ror:1 row_mask:0xf bank_mask:0xf
    v_add_f32 v34, v34, v35
    v_sub_f32 v24, v24, v29
    v_add_f32 v32, v32, v34
    v_mul_f32 v24, 0x3acccccd, v24
    v_add_f32 v36, v36, v37
    v_fma_f32 v24, -v30, v30, v24
    v_add_f32 v38, v38, v39
    v_max_f32 v24, 0, v24
    v_fma_f32 v32, -v28, v22, v32
    v_add_f32 v24, 0x3727c5ac, v24
    v_add_f32 v36, v36, v38
    v_rsq_f32 v24, v24
    v_fma_f32 v36, -v28, v23, v36
    v_mul_f32 v33, 0xbfb8aa3b, v32
    v_mul_f32 v33, v33, v24
    v_mul_f32 v36, v36, v32
    v_exp_f32 v33, v33
    v_mul_f32 v36, v36, v24
    v_add_f32 v33, 1.0, v33
    v_mul_f32 v36, v36, v24
    v_rcp_f32 v33, v33
    s_nop 0
    v_mul_f32 v36, v36, v33
    s_nop 1
    v_mov_b32_dpp v28, v36 quad_perm:[0,0,0,0] row_mask:0xf bank_mask:0xf
    v_mov_b32_dpp v29, v36 quad_perm:[1,1,1,1] row_mask:0xf bank_mask:0xf
    v_mov_b32_dpp v30, v36 quad_perm:[2,2,2,2] row_mask:0xf bank_mask:0xf
    v_mov_b32_dpp v31, v36 quad_perm:[3,3,3,3] row_mask:0xf bank_mask:0xf
    v_cvt_pk_bf16_f32 v28, v28, v29
    v_cvt_pk_bf16_f32 v29, v30, v31
    v_cndmask_b32 v60, 0, v28, s[44:45]
    v_cndmask_b32 v61, 0, v29, s[44:45]
    v_cndmask_b32 v62, 0, v28, s[46:47]
    v_cndmask_b32 v63, 0, v29, s[46:47]
    v_cndmask_b32 v64, 0, v28, s[48:49]
    v_cndmask_b32 v65, 0, v29, s[48:49]
    v_mfma_f32_16x16x32_bf16 v[24:27], a[240:243], v[60:63], 0
    v_cndmask_b32 v66, 0, v28, s[50:51]
    v_cndmask_b32 v67, 0, v29, s[50:51]
    v_cndmask_b32 v68, 0, v28, s[52:53]
    v_cndmask_b32 v69, 0, v29, s[52:53]
    v_mfma_f32_16x16x32_bf16 v[24:27], a[244:247], v[64:67], v[24:27]
    v_cndmask_b32 v70, 0, v28, s[54:55]
    v_cndmask_b32 v71, 0, v29, s[54:55]
    v_cndmask_b32 v72, 0, v28, s[56:57]
    v_cndmask_b32 v73, 0, v29, s[56:57]
    v_mfma_f32_16x16x32_bf16 v[24:27], a[248:251], v[68:71], v[24:27]
    v_cndmask_b32 v74, 0, v28, s[58:59]
    v_cndmask_b32 v75, 0, v29, s[58:59]
    v_cndmask_b32 v76, 0, v28, s[60:61]
    v_cndmask_b32 v77, 0, v29, s[60:61]
    v_mfma_f32_16x16x32_bf16 v[24:27], v[108:111], v[72:75], v[24:27]
    v_cndmask_b32 v78, 0, v28, s[62:63]
    v_cndmask_b32 v79, 0, v29, s[62:63]
    s_nop 1
    v_mfma_f32_16x16x32_bf16 v[24:27], v[2:5], v[76:79], v[24:27]
    s_mov_b32 exec_lo, 0x3ff03ff
    s_mov_b32 exec_hi, 0x3ff03ff
    s_cmp_eq_u32 s75, 1
    s_cbranch_scc0 SLOW25
    s_nop 3
    buffer_store_dwordx4 v[24:27], v84, s[16:19], s78 offen
BACK25:
    s_mov_b64 exec, -1
NEXT:
    s_cmp_lg_u32 s74, 0
    s_cbranch_scc1 DONE
    s_mov_b32 s74, 688128
    s_add_u32 s3, s3, 688128
    s_add_u32 s80, s80, 688128
    s_add_u32 s81, s81, 688128
    s_branch LOOP
AGAIN23:
    s_add_u32 s76, s76, 1
    s_cmp_lt_u32 s76, 32768
    s_cbranch_scc1 POLL23
    s_branch POLLX23
AGAIN24:
    s_mov_b64 s[94:95], exec
    s_mov_b32 s76, 1
AG224:
    v_cmp_eq_u32 vcc, -1, v24
    s_nop 0
    s_mov_b64 exec, vcc
    s_cbranch_execz AG324_0
    buffer_load_dwordx4 v[24:27], v86, s[16:19], s77 offen sc1
AG324_0:
    s_mov_b64 exec, s[94:95]
    v_cmp_eq_u32 vcc, -1, v28
    s_nop 0
    s_mov_b64 exec, vcc
    s_cbranch_execz AG324_1
    buffer_load_dwordx4 v[28:31], v18, s[16:19], s77 offen sc1
AG324_1:
    s_mov_b64 exec, s[94:95]
    v_cmp_eq_u32 vcc, -1, v32
    s_nop 0
    s_mov_b64 exec, vcc
    s_cbranch_execz AG324_2
    buffer_load_dwordx4 v[32:35], v20, s[16:19], s77 offen sc1
AG324_2:
    s_mov_b64 exec, s[94:95]
    s_add_u32 s76, s76, 1
    s_cmp_ge_u32 s76, 32768
    s_waitcnt vmcnt(0)
    v_max3_u32 v36, v24, v28, v32
    v_cmp_eq_u32 vcc, -1, v36
    s_cbranch_vccz POLLX24
    s_cbranch_scc0 AG224
    s_branch POLLX24
DONE:
    s_endpgm
DMAF:
    v_lshrrev_b32 v38, 1, v0
    v_mul_u32_u24 v38, 3072, v38
    v_and_b32 v39, 1, v0
    v_lshl_add_u32 v38, v39, 4, v38
    s_mul_i32 s79, s68, 12
    s_add_u32 s79, s79, s69
    s_sub_u32 s79, s79, 20
    s_mul_i32 s77, s72, 491520
    s_lshl_b32 s78, s79, 5
    s_add_u32 s77, s77, s78
    s_mul_i32 s78, s72, 5120
    s_add_u32 m0, s78, 57344
    s_nop 0
    buffer_load_dwordx4 v38, s[24:27], s77 offen  lds
    s_add_u32 m0, s78, 77824
    s_nop 0
    buffer_load_dwordx4 v38, s[28:31], s77 offen  lds
    s_add_u32 s77, s77, 98304
    s_add_u32 m0, s78, 58368
    s_nop 0
    buffer_load_dwordx4 v38, s[24:27], s77 offen  lds
    s_add_u32 m0, s78, 78848
    s_nop 0
    buffer_load_dwordx4 v38, s[28:31], s77 offen  lds
    s_add_u32 s77, s77, 98304
    s_add_u32 m0, s78, 59392
    s_nop 0
    buffer_load_dwordx4 v38, s[24:27], s77 offen  lds
    s_add_u32 m0, s78, 79872
    s_nop 0
    buffer_load_dwordx4 v38, s[28:31], s77 offen  lds
    s_add_u32 s77, s77, 98304
    s_add_u32 m0, s78, 60416
    s_nop 0
    buffer_load_dwordx4 v38, s[24:27], s77 offen  lds
    s_add_u32 m0, s78, 80896
    s_nop 0
    buffer_load_dwordx4 v38, s[28:31], s77 offen  lds
    s_add_u32 s77, s77, 98304
    s_add_u32 m0, s78, 61440
    s_nop 0
    buffer_load_dwordx4 v38, s[24:27], s77 offen  lds
    s_add_u32 m0, s78, 81920
    s_nop 0
    buffer_load_dwordx4 v38, s[28:31], s77 offen  lds
    s_branch DMAX
RDYLOOP:
    s_mov_b32 s76, 0
RDYL2:
    s_sleep 24
    global_load_dword v99, v98, s[64:65] sc1
    s_waitcnt vmcnt(0)
    v_sad_u8 v100, v99, 0, 0
    s_nop 1
    v_add_u32_dpp v100, v100, v100 quad_perm:[1,0,3,2] row_mask:0xf bank_mask:0xf
    s_nop 1
    v_add_u32_dpp v100, v100, v100 quad_perm:[2,3,0,1] row_mask:0xf bank_mask:0xf
    v_cmp_gt_u32 vcc, 32, v100
    s_mov_b32 vcc_hi, 0
    s_cmp_eq_u64 vcc, 0
    s_cbranch_scc1 RDYOK
    s_add_u32 s76, s76, 1
    s_cmp_lt_u32 s76, 32768
    s_cbranch_scc1 RDYL2
    s_branch RDYOK
SLOW1:
    buffer_store_dwordx4 v[28:31], v27, s[16:19], s77 offen sc1
    s_branch BACK1
SLOW2:
    buffer_store_dwordx4 v[24:27], v106, s[16:19], 0 offen sc1
    s_branch BACK2
SLOW3:
    buffer_store_dwordx4 v[24:27], v107, s[16:19], 0 offen sc1
    s_branch BACK3
SLOW6:
    buffer_store_dword v24, v10, s[16:19], s3 offen sc1
    s_branch BACK6
SLOW8:
    buffer_store_dwordx4 v[28:31], v39, s[16:19], s77 offen sc1
    s_branch BACK8
SLOW9:
    buffer_store_dwordx2 v[32:33], v39, s[16:19], s78 offen sc1
    s_branch BACK9
RETRY10:
    s_mov_b32 s76, 1
POLL26:
    buffer_load_dword v28, v20, s[16:19], 0 offen sc1
    buffer_load_dword v29, v21, s[16:19], 0 offen sc1
POLLW26:
    s_waitcnt vmcnt(0)
    v_max_u32 v30, v28, v29
    v_cmp_eq_u32 vcc, -1, v30
    s_cbranch_vccnz AGAIN26
POLLX26:
    s_branch OK10
AGAIN26:
    s_add_u32 s76, s76, 1
    s_cmp_lt_u32 s76, 32768
    s_cbranch_scc1 POLL26
    s_branch POLLX26
SLOW11:
    buffer_store_dwordx4 v[28:31], v37, s[16:19], s77 offen sc1
    s_branch BACK11
SLOW13:
    buffer_store_dwordx4 v[28:31], v18, s[16:19], s81 offen sc1
    s_branch BACK13
SLOW14:
    buffer_store_dwordx4 v[52:55], v48, s[16:19], s78 offen sc1
    s_branch BACK14
SLOW15:
    buffer_store_dwordx4 v[52:55], v49, s[16:19], s78 offen sc1
    s_branch BACK15
SLOW16:
    buffer_store_dwordx4 v[52:55], v50, s[16:19], s78 offen sc1
    s_branch BACK16
SLOW18:
    buffer_store_dwordx4 v[28:31], v39, s[16:19], s97 offen sc1
    s_branch BACK18
SLOW20:
    buffer_store_dwordx4 v[28:31], v37, s[16:19], s77 offen sc1
    s_branch BACK20
FW2:
    s_mul_i32 s79, s68, 12
    s_add_u32 s79, s79, s69
    s_sub_u32 s79, s79, 20
    s_mul_i32 s97, s72, 5120
    s_mul_i32 s96, s79, 20480
    s_add_u32 s96, s96, s97
    s_add_u32 m0, s97, 98304
    s_nop 0
    buffer_load_dwordx4 v1, s[32:35], s96 offen nt lds
    s_add_u32 s96, s96, 1024
    s_add_u32 m0, s97, 99328
    s_nop 0
    buffer_load_dwordx4 v1, s[32:35], s96 offen nt lds
    s_add_u32 s96, s96, 1024
    s_add_u32 m0, s97, 100352
    s_nop 0
    buffer_load_dwordx4 v1, s[32:35], s96 offen nt lds
    s_add_u32 s96, s96, 1024
    s_add_u32 m0, s97, 101376
    s_nop 0
    buffer_load_dwordx4 v1, s[32:35], s96 offen nt lds
    s_add_u32 s96, s96, 1024
    s_add_u32 m0, s97, 102400
    s_nop 0
    buffer_load_dwordx4 v1, s[32:35], s96 offen nt lds
    s_sub_u32 s96, s69, 20
    s_lshl_b32 s96, s96, 2
    s_add_u32 s96, s96, s72
    s_mul_i32 s96, s96, 688
    v_add_u32 v21, s96, v1
    v_min_u32 v21, 32752, v21
    s_add_u32 s97, s3, 688128
    buffer_load_dwordx4 a[240:243], v21, s[16:19], s97 offen sc1
    s_branch FMM
SLOW25:
    s_nop 3
    buffer_store_dwordx4 v[24:27], v84, s[16:19], s78 offen sc1
    s_branch BACK25
FCS:
    s_waitcnt lgkmcnt(0)
    v_add_f32 v32, v32, v33
    v_add_f32 v34, v34, v35
    v_add_f32 v32, v32, v34
    v_add_f32 v36, v36, v37
    v_add_f32 v38, v38, v39
    v_add_f32 v36, v36, v38
    v_mul_f32 v22, 0x3acccccd, v32
    v_mul_f32 v23, 0x3acccccd, v36
    s_mov_b32 s4, 1
    s_waitcnt vmcnt(0)
    v_mov_b32 v24, -1
    v_mov_b32 v25, -1
    v_mov_b32 v26, -1
    v_mov_b32 v27, -1
    s_cmp_eq_u32 s75, 1
    s_cbranch_scc0 SLOW27
    buffer_store_dwordx4 v[24:27], v21, s[16:19], s97 offen
BACK27:
    s_barrier
    s_branch FPOLL
SLOW27:
    buffer_store_dwordx4 v[24:27], v21, s[16:19], s97 offen sc1
    s_branch BACK27
CODE_END:
    s_endpgm
.section .rodata,"a"
.p2align 6
.amdhsa_kernel interleave_layers__sliding_block_cached__glu_gated_swiglu__decode_kernel
  .amdhsa_next_free_vgpr 512
  .amdhsa_next_free_sgpr 102
  .amdhsa_accum_offset 256
  .amdhsa_group_segment_fixed_size 0
  .amdhsa_kernarg_size 96
  .amdhsa_user_sgpr_count 2
  .amdhsa_user_sgpr_kernarg_segment_ptr 1
  .amdhsa_system_sgpr_workgroup_id_x 1
.end_amdhsa_kernel
```

```asm
; @launch grid=(256,1,1) block=(256,1,1) lds=125568
.amdgcn_target "amdgcn-amd-amdhsa--gfx950"
.text
.globl interleave_layers__sliding_block_cached__glu_gated_swiglu__decode_kernel
.p2align 8
.type interleave_layers__sliding_block_cached__glu_gated_swiglu__decode_kernel,@function
interleave_layers__sliding_block_cached__glu_gated_swiglu__decode_kernel:
    s_load_dwordx16 s[44:59], s[0:1], 0
    s_load_dwordx8 s[60:67], s[0:1], 64
    s_cmp_ge_u32 s2, 256
    s_cbranch_scc1 CODE_END
    v_lshrrev_b32 v2, 6, v0
    v_and_b32 v24, 63, v0
    v_readfirstlane_b32 s72, v2
    s_and_b32 s68, s2, 7
    s_lshr_b32 s69, s2, 3
    s_lshr_b32 s70, s69, 3
    s_and_b32 s71, s69, 7
    v_lshlrev_b32 v1, 4, v24
    s_lshl_b32 s77, s70, 3
    s_add_u32 s77, s77, s68
    s_mul_i32 s73, s77, 12582912
    s_lshl_b32 s78, s71, 2
    s_add_u32 s78, s78, s72
    s_mul_i32 s78, s78, 6144
    s_add_u32 s73, s73, s78
    s_add_u32 s73, s73, 11010048
    v_add_u32 v23, 4096, v1
    s_mov_b32 s10, 402653184
    s_mov_b32 s11, 0x20000
    s_getpc_b64 s[100:101]
PCREF:
    s_sub_u32 s100, s100, PCREF-interleave_layers__sliding_block_cached__glu_gated_swiglu__decode_kernel
    s_subb_u32 s101, s101, 0
    s_lshl_b32 s78, s71, 12
    v_lshl_add_u32 v25, v0, 4, s78
    v_cmp_gt_u32 vcc, CODE_END-interleave_layers__sliding_block_cached__glu_gated_swiglu__decode_kernel-16, v25
    s_nop 0
    s_and_saveexec_b64 s[98:99], vcc
    s_cbranch_execz NOCPF
    global_load_dwordx4 a[240:243], v25, s[100:101]
NOCPF:
    s_mov_b64 exec, -1
    s_mul_i32 s79, s77, 384
    s_mov_b32 s74, 0
    s_mul_i32 s3, s68, 81920
    s_mov_b32 s75, 0
    v_mov_b32 v32, -1
    v_mov_b32 v33, -1
    v_mov_b32 v34, -1
    v_mov_b32 v35, -1
    s_mul_i32 s77, s69, 576
    s_add_u32 s77, s77, s3
    s_add_u32 s77, s77, 32768
    v_add_u32 v20, s77, v1
    s_mul_i32 s77, s2, 80
    s_add_u32 s77, s77, 654784
    v_add_u32 v25, s77, v1
    v_cmp_le_u32 vcc, 36, v0
    s_nop 1
    v_cndmask_b32 v21, v20, v25, vcc
    v_mov_b32 v25, 2147483632
    v_cndmask_b32 v20, v20, v25, vcc
    v_cmp_le_u32 vcc, 41, v0
    s_nop 1
    v_cndmask_b32 v21, v21, v25, vcc
    s_mov_b32 s18, 1610612736
    s_mov_b32 s19, 0x20000
    s_waitcnt lgkmcnt(0)
    s_mov_b32 s8, s46
    s_and_b32 s9, s47, 0xffff
    s_mov_b32 s16, s66
    s_and_b32 s17, s67, 0xffff
    buffer_store_dwordx4 v[32:35], v21, s[16:19], 0 offen sc1
    buffer_load_dwordx4 a[0:3], v1, s[8:11], s73 offen offset:0 nt
    buffer_load_dwordx4 a[4:7], v1, s[8:11], s73 offen offset:1024 nt
    s_add_u32 s83, s73, 196608
    s_mov_b32 s12, s48
    s_and_b32 s13, s49, 0xffff
    s_mov_b32 s14, 402653184
    s_mov_b32 s15, 0x20000
    s_mov_b32 s20, s50
    s_and_b32 s21, s51, 0xffff
    s_mov_b32 s22, 7864320
    s_mov_b32 s23, 0x20000
    s_mov_b32 s36, s44
    s_and_b32 s37, s45, 0xffff
    s_mov_b32 s38, 1280
    s_mov_b32 s39, 0x20000
    s_mov_b32 s40, s62
    s_and_b32 s41, s63, 0xffff
    s_mov_b32 s42, 1280
    s_mov_b32 s43, 0x20000
    s_mov_b32 s28, s58
    s_and_b32 s29, s59, 0xffff
    s_mov_b32 s30, 1966080
    s_mov_b32 s31, 0x20000
    s_mov_b32 s32, s60
    s_and_b32 s33, s61, 0xffff
    s_mov_b32 s34, 1966080
    s_mov_b32 s35, 0x20000
    s_cmp_lt_u32 s69, 20
    s_cselect_b32 s24, s52, s56
    s_cselect_b32 s25, s53, s57
    s_cselect_b32 s26, s22, s30
    s_and_b32 s25, s25, 0xffff
    s_mov_b32 s27, 0x20000
    s_add_u32 s84, s83, 196608
    s_add_u32 s85, s84, 196608
    s_add_u32 s86, s85, 196608
    s_add_u32 s87, s86, 196608
    s_add_u32 s88, s87, 196608
    s_add_u32 s89, s88, 196608
    v_mov_b32 v0, v24
    s_mul_i32 s77, s72, 6656
    v_add_u32 v25, 0, v0
    v_mul_u32_u24 v26, 171, v25
    v_lshrrev_b32 v26, 12, v26
    v_mul_u32_u24 v27, 24, v26
    v_sub_u32 v27, v25, v27
    v_lshlrev_b32 v27, 4, v27
    v_mul_u32_u24 v25, 416, v26
    v_add3_u32 v2, v25, v27, s77
    v_mul_u32_u24 v25, 12288, v26
    v_add_u32 v40, v25, v27
    v_mul_u32_u24 v25, 3072, v26
    v_add_u32 v101, v25, v27
    v_add_u32 v25, 64, v0
    v_mul_u32_u24 v26, 171, v25
    v_lshrrev_b32 v26, 12, v26
    v_mul_u32_u24 v27, 24, v26
    v_sub_u32 v27, v25, v27
    v_lshlrev_b32 v27, 4, v27
    v_mul_u32_u24 v25, 416, v26
    v_add3_u32 v3, v25, v27, s77
    v_mul_u32_u24 v25, 12288, v26
    v_add_u32 v41, v25, v27
    v_mul_u32_u24 v25, 3072, v26
    v_add_u32 v102, v25, v27
    v_add_u32 v25, 128, v0
    v_mul_u32_u24 v26, 171, v25
    v_lshrrev_b32 v26, 12, v26
    v_mul_u32_u24 v27, 24, v26
    v_sub_u32 v27, v25, v27
    v_lshlrev_b32 v27, 4, v27
    v_mul_u32_u24 v25, 416, v26
    v_add3_u32 v4, v25, v27, s77
    v_mul_u32_u24 v25, 12288, v26
    v_add_u32 v42, v25, v27
    v_mul_u32_u24 v25, 3072, v26
    v_add_u32 v103, v25, v27
    v_and_b32 v25, 15, v0
    v_lshrrev_b32 v26, 4, v0
    v_bfe_u32 v27, v0, 2, 2
    v_and_b32 v28, 3, v0
    s_mul_i32 s78, s71, 160
    v_lshlrev_b32 v36, 4, v26
    v_lshlrev_b32 v37, 3, v26
    v_lshlrev_b32 v39, 2, v0
    buffer_load_dwordx4 v[70:73], v36, s[36:39], s78 offen
    buffer_load_dwordx4 v[74:77], v36, s[36:39], s78 offen offset:64
    buffer_load_dwordx2 v[78:79], v37, s[36:39], s78 offen offset:128
    buffer_load_dwordx4 v[80:83], v1, s[36:39], 0 offen
    buffer_load_dword v84, v39, s[36:39], 0 offen offset:1024
    s_lshl_b32 s7, s69, 6
    v_lshlrev_b32 v38, 2, v25
    buffer_load_dword v22, v38, s[36:39], s7 offen
    s_mul_i32 s78, s71, 983040
    s_add_u32 s79, s79, s78
    s_mul_i32 s78, s72, 98304
    s_add_u32 s79, s79, s78
    s_mul_i32 s78, s72, 3072
    s_add_u32 s78, s78, 26624
    s_add_u32 m0, s78, 0
    s_nop 0
    buffer_load_dwordx4 v40, s[20:23], s79 offen nt lds
    s_add_u32 m0, s78, 1024
    s_nop 0
    buffer_load_dwordx4 v41, s[20:23], s79 offen nt lds
    s_add_u32 m0, s78, 2048
    s_nop 0
    buffer_load_dwordx4 v42, s[20:23], s79 offen nt lds
    s_add_u32 s79, s79, 393216
    s_add_u32 m0, s78, 12288
    s_nop 0
    buffer_load_dwordx4 v40, s[20:23], s79 offen nt lds
    s_add_u32 m0, s78, 13312
    s_nop 0
    buffer_load_dwordx4 v41, s[20:23], s79 offen nt lds
    s_add_u32 m0, s78, 14336
    s_nop 0
    buffer_load_dwordx4 v42, s[20:23], s79 offen nt lds
    s_add_u32 s79, s79, 393216
    s_cmp_ge_u32 s72, 2
    s_cbranch_scc1 NOWQ3
    s_add_u32 m0, s78, 24576
    s_nop 0
    buffer_load_dwordx4 v40, s[20:23], s79 offen nt lds
    s_add_u32 m0, s78, 25600
    s_nop 0
    buffer_load_dwordx4 v41, s[20:23], s79 offen nt lds
    s_add_u32 m0, s78, 26624
    s_nop 0
    buffer_load_dwordx4 v42, s[20:23], s79 offen nt lds
NOWQ3:
    s_mul_i32 s78, s71, 160
    s_mov_b32 s20, s52
    s_and_b32 s21, s53, 0xffff
    s_mov_b32 s22, 7864320
    s_mov_b32 s23, 0x20000
    s_cmp_lt_u32 s72, 2
    s_cselect_b32 s36, s56, s58
    s_cselect_b32 s37, s57, s59
    s_and_b32 s37, s37, 0xffff
    s_mov_b32 s38, 1966080
    s_lshl_b32 s90, s70, 3
    s_add_u32 s90, s90, s68
    s_lshl_b32 s90, s90, 3
    s_add_u32 s90, s90, s71
    s_mul_i32 s90, s90, 30720
    s_mul_i32 s79, s72, 6144
    s_add_u32 s90, s90, s79
    s_cmp_eq_u32 s72, 3
    s_cselect_b32 s79, 3072, 0
    s_add_u32 s90, s90, s79
    s_cmp_lt_u32 s72, 2
    s_cselect_b32 s79, 1879048176, 0
    v_add_u32 v108, s79, v23
    v_add_u32 v109, 4096, v108
    s_and_b32 s91, s72, 1
    s_lshl_b32 s79, s69, 1
    s_add_u32 s91, s91, s79
    s_mul_i32 s79, s91, 0
    s_add_u32 s79, s79, 640
    s_mul_i32 s91, s91, 16
    s_cmp_lt_u32 s69, 20
    s_cselect_b32 s91, s91, s79
    s_mov_b32 s7, 49152
    s_cselect_b32 s7, s7, 0
    s_mul_i32 s91, s91, 3072
    s_mul_i32 s79, s68, 384
    s_add_u32 s91, s91, s79
    v_mov_b32 v29, 1879048176
    v_add_u32 v104, 24576, v101
    v_add_u32 v105, 24576, v102
    v_add_u32 v106, 24576, v103
    v_cmp_gt_u32 vcc, s7, v101
    s_nop 1
    v_cndmask_b32 v101, v29, v101, vcc
    v_cmp_gt_u32 vcc, s7, v102
    s_nop 1
    v_cndmask_b32 v102, v29, v102, vcc
    v_cmp_gt_u32 vcc, s7, v103
    s_nop 1
    v_cndmask_b32 v103, v29, v103, vcc
    v_cmp_gt_u32 vcc, s7, v104
    s_nop 1
    v_cndmask_b32 v104, v29, v104, vcc
    v_cmp_gt_u32 vcc, s7, v105
    s_nop 1
    v_cndmask_b32 v105, v29, v105, vcc
    v_cmp_gt_u32 vcc, s7, v106
    s_nop 1
    v_cndmask_b32 v106, v29, v106, vcc
    buffer_load_dwordx4 a[8:11], v1, s[8:11], s73 offen offset:2048 nt
    buffer_load_dwordx4 a[12:15], v1, s[8:11], s73 offen offset:3072 nt
    buffer_load_dwordx4 a[16:19], v23, s[8:11], s73 offen offset:0 nt
    v_mul_u32_u24 v29, 416, v25
    v_lshl_add_u32 v29, v26, 4, v29
    v_add_u32 v5, s77, v29
    v_lshrrev_b32 v29, 2, v0
    v_mul_u32_u24 v29, 416, v29
    v_lshl_add_u32 v29, v28, 3, v29
    v_add_u32 v6, s77, v29
    s_mul_i32 s79, s72, 96
    s_add_u32 s79, s79, 26624
    v_lshl_add_u32 v29, v26, 3, v27
    v_mul_u32_u24 v29, 384, v29
    v_lshl_add_u32 v29, v28, 3, v29
    v_add_u32 v16, s79, v29
    v_lshl_add_u32 v29, v26, 2, v27
    v_mul_u32_u24 v29, 384, v29
    v_lshl_add_u32 v29, v28, 3, v29
    v_add_u32 v17, s79, v29
    buffer_load_dwordx4 a[20:23], v23, s[8:11], s73 offen offset:1024 nt
    v_mul_u32_u24 v31, 103, v0
    v_lshrrev_b32 v31, 10, v31
    v_mul_u32_u24 v30, 10, v31
    v_sub_u32 v30, v0, v30
    v_lshl_add_u32 v29, v30, 4, s78
    v_mul_u32_u24 v8, 1280, v31
    v_add_u32 v8, 665600, v8
    s_mul_i32 s7, s68, 81920
    s_add_u32 s7, s7, 47360
    v_mov_b32 v30, s7
    v_cmp_eq_u32 vcc, s68, v31
    s_nop 1
    v_cndmask_b32 v8, v8, v30, vcc
    v_add_u32 v30, 2560, v30
    v_cmp_le_u32 vcc, 8, v31
    s_nop 1
    v_cndmask_b32 v8, v8, v30, vcc
    v_add_u32 v8, v8, v29
    v_add_u32 v31, 6, v31
    v_mul_u32_u24 v9, 1280, v31
    v_add_u32 v9, 665600, v9
    s_mul_i32 s7, s68, 81920
    s_add_u32 s7, s7, 47360
    v_mov_b32 v30, s7
    v_cmp_eq_u32 vcc, s68, v31
    s_nop 1
    v_cndmask_b32 v9, v9, v30, vcc
    v_add_u32 v30, 2560, v30
    v_cmp_le_u32 vcc, 8, v31
    s_nop 1
    v_cndmask_b32 v9, v9, v30, vcc
    v_add_u32 v9, v9, v29
    v_mov_b32 v30, 2147483632
    v_cmp_le_u32 vcc, 30, v0
    s_nop 1
    v_cndmask_b32 v9, v9, v30, vcc
    s_lshl_b32 s78, s69, 10
    s_lshl_b32 s79, s72, 8
    s_add_u32 s78, s78, s79
    v_lshl_add_u32 v10, v0, 2, s78
    s_lshl_b32 s78, s70, 13
    s_add_u32 s78, s78, s79
    v_lshlrev_b32 v29, 10, v26
    v_lshl_add_u32 v29, v25, 4, v29
    v_add_u32 v11, s78, v29
    buffer_load_dwordx4 a[24:27], v1, s[8:11], s83 offen offset:0 nt
    s_mul_i32 s78, s72, 96
    s_add_u32 s78, s78, 118784
    v_lshl_add_u32 v29, v27, 5, s78
    v_lshl_add_u32 v29, v28, 2, v29
    v_lshrrev_b32 v30, 1, v26
    v_lshl_add_u32 v29, v30, 4, v29
    v_and_b32 v30, 1, v26
    v_lshl_add_u32 v29, v30, 1, v29
    v_mov_b32 v30, 119168
    v_cmp_le_u32 vcc, 12, v25
    s_nop 1
    v_cndmask_b32 v12, v29, v30, vcc
    v_and_b32 v30, 1, v0
    v_lshlrev_b32 v29, 5, v26
    v_lshl_add_u32 v29, v30, 4, v29
    v_add_u32 v13, 118784, v29
    v_mul_u32_u24 v30, 0xaaaa, v30
    v_and_b32 v29, 1, v27
    v_mul_u32_u24 v29, 0xaaaa, v29
    v_lshl_or_b32 v29, v29, 16, v30
    v_add_u32 v14, 0x44444444, v29
    buffer_load_dwordx4 a[28:31], v1, s[8:11], s83 offen offset:1024 nt
    s_lshl_b32 s78, s72, 8
    s_add_u32 s78, s78, 124416
    v_lshrrev_b32 v29, 5, v0
    v_lshl_add_u32 v29, v29, 6, s78
    v_bfe_u32 v30, v0, 3, 1
    v_lshl_add_u32 v29, v30, 5, v29
    v_bfe_u32 v30, v0, 1, 1
    v_lshl_add_u32 v29, v30, 4, v29
    v_bfe_u32 v30, v0, 2, 1
    v_lshl_add_u32 v29, v30, 3, v29
    v_bfe_u32 v30, v0, 4, 1
    v_lshl_add_u32 v29, v30, 2, v29
    v_bfe_u32 v30, v0, 0, 1
    v_lshl_add_u32 v29, v30, 1, v29
    v_mov_b32 v19, v29
    s_mul_i32 s78, s72, 768
    s_add_u32 s78, s78, 119296
    v_lshl_add_u32 v29, v25, 2, s78
    v_bfe_u32 v30, v0, 4, 1
    v_lshl_add_u32 v29, v30, 7, v29
    v_lshrrev_b32 v30, 5, v0
    v_lshl_add_u32 v15, v30, 6, v29
    s_mov_b32 s44, 0x10001
    s_mov_b32 s45, 0x10001
    s_mov_b32 s46, 0x20002
    s_mov_b32 s47, 0x20002
    s_mov_b32 s48, 0x40004
    s_mov_b32 s49, 0x40004
    s_mov_b32 s50, 0x80008
    s_mov_b32 s51, 0x80008
    s_mov_b32 s52, 0x100010
    s_mov_b32 s53, 0x100010
    s_mov_b32 s54, 0x200020
    s_mov_b32 s55, 0x200020
    s_mov_b32 s56, 0x400040
    s_mov_b32 s57, 0x400040
    s_mov_b32 s58, 0x800080
    s_mov_b32 s59, 0x800080
    s_mov_b32 s60, 0x1000100
    s_mov_b32 s61, 0x1000100
    s_mov_b32 s62, 0x2000200
    s_mov_b32 s63, 0x2000200
    s_waitcnt vmcnt(12)
    v_lshlrev_b32 v88, 16, v80
    v_and_b32 v89, 0xffff0000, v80
    v_lshlrev_b32 v90, 16, v81
    v_and_b32 v91, 0xffff0000, v81
    v_lshlrev_b32 v92, 16, v82
    v_and_b32 v93, 0xffff0000, v82
    v_lshlrev_b32 v94, 16, v83
    v_and_b32 v95, 0xffff0000, v83
    v_lshlrev_b32 v96, 16, v84
    v_and_b32 v97, 0xffff0000, v84
    v_add_f32 v80, v88, v89
    v_add_f32 v80, v80, v90
    v_add_f32 v80, v80, v91
    v_add_f32 v80, v80, v92
    v_add_f32 v80, v80, v93
    v_add_f32 v80, v80, v94
    v_add_f32 v80, v80, v95
    v_add_f32 v80, v80, v96
    v_add_f32 v80, v80, v97
    s_nop 1
    v_add_f32_dpp v80, v80, v80 row_ror:8 row_mask:0xf bank_mask:0xf
    s_nop 1
    v_add_f32_dpp v80, v80, v80 row_ror:4 row_mask:0xf bank_mask:0xf
    s_nop 1
    v_add_f32_dpp v80, v80, v80 row_ror:2 row_mask:0xf bank_mask:0xf
    s_nop 1
    v_add_f32_dpp v80, v80, v80 row_ror:1 row_mask:0xf bank_mask:0xf
    v_mov_b32 v81, v80
    s_nop 1
    v_permlane32_swap_b32 v80, v81
    v_add_f32 v80, v80, v81
    v_mov_b32 v81, v80
    s_nop 1
    v_permlane16_swap_b32 v80, v81
    v_add_f32 v80, v80, v81
    v_mul_f32 v80, 0x3acccccd, v80
    v_sub_f32 v88, v88, v80
    v_sub_f32 v89, v89, v80
    v_sub_f32 v90, v90, v80
    v_sub_f32 v91, v91, v80
    v_sub_f32 v92, v92, v80
    v_sub_f32 v93, v93, v80
    v_sub_f32 v94, v94, v80
    v_sub_f32 v95, v95, v80
    v_sub_f32 v96, v96, v80
    v_sub_f32 v97, v97, v80
    v_mul_f32 v82, v88, v88
    v_fmac_f32 v82, v89, v89
    v_fmac_f32 v82, v90, v90
    v_fmac_f32 v82, v91, v91
    v_fmac_f32 v82, v92, v92
    v_fmac_f32 v82, v93, v93
    v_fmac_f32 v82, v94, v94
    v_fmac_f32 v82, v95, v95
    v_fmac_f32 v82, v96, v96
    v_fmac_f32 v82, v97, v97
    buffer_load_dwordx4 a[32:35], v1, s[8:11], s83 offen offset:2048 nt
    s_nop 0
    v_add_f32_dpp v82, v82, v82 row_ror:8 row_mask:0xf bank_mask:0xf
    s_nop 1
    v_add_f32_dpp v82, v82, v82 row_ror:4 row_mask:0xf bank_mask:0xf
    s_nop 1
    v_add_f32_dpp v82, v82, v82 row_ror:2 row_mask:0xf bank_mask:0xf
    s_nop 1
    v_add_f32_dpp v82, v82, v82 row_ror:1 row_mask:0xf bank_mask:0xf
    v_mov_b32 v81, v82
    s_nop 1
    v_permlane32_swap_b32 v82, v81
    v_add_f32 v82, v82, v81
    v_mov_b32 v81, v82
    s_nop 1
    v_permlane16_swap_b32 v82, v81
    v_add_f32 v82, v82, v81
    v_mul_f32 v82, 0x3acccccd, v82
    v_add_f32 v82, 0x3727c5ac, v82
    v_rsq_f32 v82, v82
    s_mov_b32 vcc_lo, 0xaaaaaaaa
    s_mov_b32 vcc_hi, 0xaaaaaaaa
    v_mov_b32 v85, 0x3f803f80
    v_lshlrev_b32 v83, 16, v70
    v_and_b32 v84, 0xffff0000, v70
    v_sub_f32 v83, v83, v80
    v_sub_f32 v84, v84, v80
    v_mul_f32 v83, v83, v82
    v_mul_f32 v84, v84, v82
    v_cvt_pk_bf16_f32 v83, v83, v84
    v_cndmask_b32 v70, v83, v85, vcc
    v_lshlrev_b32 v83, 16, v71
    v_and_b32 v84, 0xffff0000, v71
    v_sub_f32 v83, v83, v80
    v_sub_f32 v84, v84, v80
    v_mul_f32 v83, v83, v82
    v_mul_f32 v84, v84, v82
    v_cvt_pk_bf16_f32 v83, v83, v84
    v_cndmask_b32 v71, v83, v85, vcc
    v_lshlrev_b32 v83, 16, v72
    v_and_b32 v84, 0xffff0000, v72
    v_sub_f32 v83, v83, v80
    v_sub_f32 v84, v84, v80
    v_mul_f32 v83, v83, v82
    v_mul_f32 v84, v84, v82
    v_cvt_pk_bf16_f32 v83, v83, v84
    v_cndmask_b32 v72, v83, v85, vcc
    v_lshlrev_b32 v83, 16, v73
    v_and_b32 v84, 0xffff0000, v73
    v_sub_f32 v83, v83, v80
    v_sub_f32 v84, v84, v80
    v_mul_f32 v83, v83, v82
    v_mul_f32 v84, v84, v82
    v_cvt_pk_bf16_f32 v83, v83, v84
    v_cndmask_b32 v73, v83, v85, vcc
    v_lshlrev_b32 v83, 16, v74
    v_and_b32 v84, 0xffff0000, v74
    v_sub_f32 v83, v83, v80
    v_sub_f32 v84, v84, v80
    v_mul_f32 v83, v83, v82
    v_mul_f32 v84, v84, v82
    v_cvt_pk_bf16_f32 v83, v83, v84
    v_cndmask_b32 v74, v83, v85, vcc
    v_lshlrev_b32 v83, 16, v75
    v_and_b32 v84, 0xffff0000, v75
    v_sub_f32 v83, v83, v80
    v_sub_f32 v84, v84, v80
    v_mul_f32 v83, v83, v82
    v_mul_f32 v84, v84, v82
    v_cvt_pk_bf16_f32 v83, v83, v84
    v_cndmask_b32 v75, v83, v85, vcc
    buffer_load_dwordx4 a[36:39], v1, s[8:11], s83 offen offset:3072 nt
    v_lshlrev_b32 v83, 16, v76
    v_and_b32 v84, 0xffff0000, v76
    v_sub_f32 v83, v83, v80
    v_sub_f32 v84, v84, v80
    v_mul_f32 v83, v83, v82
    v_mul_f32 v84, v84, v82
    v_cvt_pk_bf16_f32 v83, v83, v84
    v_cndmask_b32 v76, v83, v85, vcc
    v_lshlrev_b32 v83, 16, v77
    v_and_b32 v84, 0xffff0000, v77
    v_sub_f32 v83, v83, v80
    v_sub_f32 v84, v84, v80
    v_mul_f32 v83, v83, v82
    v_mul_f32 v84, v84, v82
    v_cvt_pk_bf16_f32 v83, v83, v84
    v_cndmask_b32 v77, v83, v85, vcc
    v_lshlrev_b32 v83, 16, v78
    v_and_b32 v84, 0xffff0000, v78
    v_sub_f32 v83, v83, v80
    v_sub_f32 v84, v84, v80
    v_mul_f32 v83, v83, v82
    v_mul_f32 v84, v84, v82
    v_cvt_pk_bf16_f32 v83, v83, v84
    v_cndmask_b32 v78, v83, v85, vcc
    v_lshlrev_b32 v83, 16, v79
    v_and_b32 v84, 0xffff0000, v79
    v_sub_f32 v83, v83, v80
    v_sub_f32 v84, v84, v80
    v_mul_f32 v83, v83, v82
    v_mul_f32 v84, v84, v82
    v_cvt_pk_bf16_f32 v83, v83, v84
    v_cndmask_b32 v79, v83, v85, vcc
    s_waitcnt vmcnt(8)
    s_barrier
    ds_read_b64_tr_b16 v[40:41], v16 offset:0
    ds_read_b64_tr_b16 v[42:43], v16 offset:1536
    ds_read_b64_tr_b16 v[44:45], v16 offset:12288
    ds_read_b64_tr_b16 v[46:47], v16 offset:13824
    ds_read_b64_tr_b16 v[48:49], v17 offset:24576
    ds_read_b64_tr_b16 v[50:51], v16 offset:32
    ds_read_b64_tr_b16 v[52:53], v16 offset:1568
    ds_read_b64_tr_b16 v[54:55], v16 offset:12320
    ds_read_b64_tr_b16 v[56:57], v16 offset:13856
    ds_read_b64_tr_b16 v[58:59], v17 offset:24608
    ds_read_b64_tr_b16 v[60:61], v16 offset:64
    ds_read_b64_tr_b16 v[62:63], v16 offset:1600
    ds_read_b64_tr_b16 v[64:65], v16 offset:12352
    ds_read_b64_tr_b16 v[66:67], v16 offset:13888
    ds_read_b64_tr_b16 v[68:69], v17 offset:24640
    buffer_load_dwordx4 a[40:43], v23, s[8:11], s83 offen offset:0 nt
    buffer_load_dwordx4 a[44:47], v23, s[8:11], s83 offen offset:1024 nt
    s_mul_i32 s79, s72, 96
    s_add_u32 s79, s79, 119296
    v_min_u32 v36, 48, v0
    v_lshl_add_u32 v36, v36, 1, s79
    v_mov_b32 v37, 119808
    v_cmp_le_u32 vcc, 48, v0
    s_nop 1
    v_cndmask_b32 v36, v36, v37, vcc
    v_add_u32 v37, 119296, v1
    s_waitcnt lgkmcnt(0)
    v_mfma_f32_16x16x32_bf16 v[24:27], v[70:73], v[40:43], 0
    v_mfma_f32_16x16x32_bf16 v[28:31], v[70:73], v[50:53], 0
    v_mfma_f32_16x16x32_bf16 v[32:35], v[70:73], v[60:63], 0
    v_mfma_f32_16x16x32_bf16 v[24:27], v[74:77], v[44:47], v[24:27]
    v_mfma_f32_16x16x32_bf16 v[28:31], v[74:77], v[54:57], v[28:31]
    v_mfma_f32_16x16x32_bf16 v[32:35], v[74:77], v[64:67], v[32:35]
    v_mfma_f32_16x16x16_bf16 v[24:27], v[78:79], v[48:49], v[24:27]
    v_mfma_f32_16x16x16_bf16 v[28:31], v[78:79], v[58:59], v[28:31]
    v_mfma_f32_16x16x16_bf16 v[32:35], v[78:79], v[68:69], v[32:35]
    buffer_load_dwordx4 a[48:51], v1, s[8:11], s84 offen offset:0 nt
    s_nop 4
    v_mov_b32 v7, v25
    v_mov_b32_dpp v24, v28 quad_perm:[0,1,2,3] row_mask:0x2 bank_mask:0xf
    s_nop 0
    v_mov_b32_dpp v7, v29 quad_perm:[0,1,2,3] row_mask:0x2 bank_mask:0xf
    v_mov_b32_dpp v24, v32 quad_perm:[0,1,2,3] row_mask:0x4 bank_mask:0xf
    s_nop 0
    v_mov_b32_dpp v7, v33 quad_perm:[0,1,2,3] row_mask:0x4 bank_mask:0xf
    v_cvt_pk_bf16_f32 v24, v24, v24
    ds_write_b16 v36, v24
    buffer_load_dwordx4 a[52:55], v1, s[8:11], s84 offen offset:1024 nt
    buffer_load_dwordx4 a[56:59], v1, s[8:11], s84 offen offset:2048 nt
    s_waitcnt lgkmcnt(0)
    s_barrier
    ds_read_b128 v[28:31], v37
    s_mul_i32 s79, s69, 384
    s_add_u32 s79, s79, s3
    s_cmp_eq_u32 s72, 0
    s_cselect_b32 exec_lo, 0xffffff, 1
    s_mov_b32 exec_hi, 0
    s_cselect_b32 s78, 0, 1879048176
    v_add_u32 v37, s78, v1
    s_waitcnt lgkmcnt(0)
    buffer_store_dwordx4 v[28:31], v37, s[16:19], s79 offen sc1
    s_mov_b64 exec, -1
    buffer_load_dwordx4 a[60:63], v1, s[8:11], s84 offen offset:3072 nt
    buffer_load_dwordx4 a[64:67], v23, s[8:11], s84 offen offset:0 nt
    s_waitcnt vmcnt(12)
    ds_write_b128 v2, a[0:3] offset:0
    ds_write_b128 v3, a[4:7] offset:0
    ds_write_b128 v4, a[8:11] offset:0
    ds_write_b128 v2, a[12:15] offset:3328
    ds_write_b128 v3, a[16:19] offset:3328
    ds_write_b128 v4, a[20:23] offset:3328
    ds_read_b128 a[0:3], v5 offset:0
    ds_read_b128 a[4:7], v5 offset:64
    ds_read_b128 a[8:11], v5 offset:128
    ds_read_b128 a[12:15], v5 offset:192
    ds_read_b128 a[16:19], v5 offset:256
    ds_read_b128 a[20:23], v5 offset:320
    buffer_load_dwordx4 a[68:71], v23, s[8:11], s84 offen offset:1024 nt
    s_barrier
    buffer_load_dwordx4 a[72:75], v1, s[8:11], s85 offen offset:0 nt
    buffer_load_dwordx4 a[76:79], v1, s[8:11], s85 offen offset:1024 nt
    buffer_load_dwordx4 a[80:83], v1, s[8:11], s85 offen offset:2048 nt
    buffer_load_dwordx4 a[84:87], v1, s[8:11], s85 offen offset:3072 nt
    buffer_load_dwordx4 a[88:91], v23, s[8:11], s85 offen offset:0 nt
    buffer_load_dwordx4 a[92:95], v23, s[8:11], s85 offen offset:1024 nt
    s_barrier
    s_getreg_b32 s5, hwreg(HW_REG_XCC_ID, 0, 4)
    s_lshr_b32 s92, s5, 2
    s_lshl_b32 s93, s68, 2
    s_add_u32 s92, s92, s93
    s_and_b32 s93, s5, 3
    s_lshl_b32 s93, s93, 3
    s_lshl_b32 s94, 1, s93
    s_lshl_b32 s96, 32, s93
    s_mov_b32 s5, s92
    s_cmp_lg_u32 s72, 0
    s_cbranch_scc1 NOATOM
    s_waitcnt vmcnt(9)
    s_lshl_b32 s92, s92, 2
    v_mov_b32 v36, s92
    v_mov_b32 v37, s94
    s_mov_b64 exec, 1
    global_atomic_add v36, v37, s[64:65] sc1
    s_mov_b64 exec, -1
NOATOM:
    s_waitcnt vmcnt(13)
    ds_write_b128 v2, a[24:27] offset:0
    ds_write_b128 v3, a[28:31] offset:0
    ds_write_b128 v4, a[32:35] offset:0
    ds_write_b128 v2, a[36:39] offset:3328
    ds_write_b128 v3, a[40:43] offset:3328
    ds_write_b128 v4, a[44:47] offset:3328
    ds_read_b128 a[24:27], v5 offset:0
    ds_read_b128 a[28:31], v5 offset:64
    ds_read_b128 a[32:35], v5 offset:128
    ds_read_b128 a[36:39], v5 offset:192
    ds_read_b128 a[40:43], v5 offset:256
    ds_read_b128 a[44:47], v5 offset:320
    buffer_load_dwordx4 a[240:243], v101, s[36:39], s91 offen
    buffer_load_dwordx4 a[240:243], v102, s[36:39], s91 offen
    buffer_load_dwordx4 a[240:243], v103, s[36:39], s91 offen
    buffer_load_dwordx4 a[240:243], v104, s[36:39], s91 offen
    buffer_load_dwordx4 a[240:243], v105, s[36:39], s91 offen
    buffer_load_dwordx4 a[240:243], v106, s[36:39], s91 offen
    s_barrier
    s_waitcnt vmcnt(12)
    ds_write_b128 v2, a[48:51] offset:0
    ds_write_b128 v3, a[52:55] offset:0
    ds_write_b128 v4, a[56:59] offset:0
    ds_write_b128 v2, a[60:63] offset:3328
    ds_write_b128 v3, a[64:67] offset:3328
    ds_write_b128 v4, a[68:71] offset:3328
    ds_read_b128 a[48:51], v5 offset:0
    ds_read_b128 a[52:55], v5 offset:64
    ds_read_b128 a[56:59], v5 offset:128
    ds_read_b128 a[60:63], v5 offset:192
    ds_read_b128 a[64:67], v5 offset:256
    ds_read_b128 a[68:71], v5 offset:320
    v_lshlrev_b32 v98, 2, v0
    buffer_load_dwordx4 a[96:99], v1, s[8:11], s86 offen offset:0 nt
    buffer_load_dwordx4 a[100:103], v1, s[8:11], s86 offen offset:1024 nt
    buffer_load_dwordx4 a[104:107], v1, s[8:11], s86 offen offset:2048 nt
    buffer_load_dwordx4 a[108:111], v1, s[8:11], s86 offen offset:3072 nt
    buffer_load_dwordx4 a[112:115], v23, s[8:11], s86 offen offset:0 nt
    buffer_load_dwordx4 a[116:119], v23, s[8:11], s86 offen offset:1024 nt
    s_barrier
    buffer_load_dwordx4 a[120:123], v1, s[8:11], s87 offen offset:0 nt
    buffer_load_dwordx4 a[124:127], v1, s[8:11], s87 offen offset:1024 nt
    buffer_load_dwordx4 a[128:131], v1, s[8:11], s87 offen offset:2048 nt
    buffer_load_dwordx4 a[132:135], v1, s[8:11], s87 offen offset:3072 nt
    buffer_load_dwordx4 a[136:139], v23, s[8:11], s87 offen offset:0 nt
    buffer_load_dwordx4 a[140:143], v23, s[8:11], s87 offen offset:1024 nt
    s_barrier
    s_waitcnt vmcnt(18)
    ds_write_b128 v2, a[72:75] offset:0
    ds_write_b128 v3, a[76:79] offset:0
    ds_write_b128 v4, a[80:83] offset:0
    ds_write_b128 v2, a[84:87] offset:3328
    ds_write_b128 v3, a[88:91] offset:3328
    ds_write_b128 v4, a[92:95] offset:3328
    ds_read_b128 a[72:75], v5 offset:0
    ds_read_b128 a[76:79], v5 offset:64
    ds_read_b128 a[80:83], v5 offset:128
    ds_read_b128 a[84:87], v5 offset:192
    ds_read_b128 a[88:91], v5 offset:256
    ds_read_b128 a[92:95], v5 offset:320
    buffer_load_dwordx4 a[144:147], v1, s[8:11], s88 offen offset:0 nt
    buffer_load_dwordx4 a[148:151], v1, s[8:11], s88 offen offset:1024 nt
    buffer_load_dwordx4 a[152:155], v1, s[8:11], s88 offen offset:2048 nt
    buffer_load_dwordx4 a[156:159], v1, s[8:11], s88 offen offset:3072 nt
    buffer_load_dwordx4 a[160:163], v23, s[8:11], s88 offen offset:0 nt
    buffer_load_dwordx4 a[164:167], v23, s[8:11], s88 offen offset:1024 nt
    s_barrier
    s_waitcnt vmcnt(12)
    ds_write_b128 v2, a[96:99] offset:0
    ds_write_b128 v3, a[100:103] offset:0
    ds_write_b128 v4, a[104:107] offset:0
    ds_write_b128 v2, a[108:111] offset:3328
    ds_write_b128 v3, a[112:115] offset:3328
    ds_write_b128 v4, a[116:119] offset:3328
    ds_read_b128 a[96:99], v5 offset:0
    ds_read_b128 a[100:103], v5 offset:64
    ds_read_b128 a[104:107], v5 offset:128
    ds_read_b128 a[108:111], v5 offset:192
    ds_read_b128 a[112:115], v5 offset:256
    ds_read_b128 a[116:119], v5 offset:320
    buffer_load_dwordx4 a[168:171], v1, s[8:11], s89 offen offset:0 nt
    buffer_load_dwordx4 a[172:175], v1, s[8:11], s89 offen offset:1024 nt
    buffer_load_dwordx4 a[176:179], v1, s[8:11], s89 offen offset:2048 nt
    buffer_load_dwordx4 a[180:183], v1, s[8:11], s89 offen offset:3072 nt
    buffer_load_dwordx4 a[184:187], v23, s[8:11], s89 offen offset:0 nt
    buffer_load_dwordx4 a[188:191], v23, s[8:11], s89 offen offset:1024 nt
    s_barrier
    s_cmp_ge_u32 s69, 20
    s_cbranch_scc1 DMAF
    s_lshl_b32 s66, s72, 3
    s_add_u32 s66, s66, s68
    s_mul_i32 s66, s66, 245760
    s_lshl_b32 s78, s69, 6
    s_add_u32 s66, s66, s78
    s_mul_i32 s67, s72, 12288
    s_add_u32 s67, s67, 57344
    v_lshrrev_b32 v38, 2, v0
    v_mul_u32_u24 v38, 1280, v38
    v_and_b32 v39, 3, v0
    v_lshl_add_u32 v39, v39, 4, v38
    s_mov_b32 m0, s67
    s_add_u32 s67, s67, 1024
    buffer_load_dwordx4 v39, s[24:27], s66 offen  lds
    s_add_u32 s66, s66, 20480
    s_mov_b32 m0, s67
    s_add_u32 s67, s67, 1024
    buffer_load_dwordx4 v39, s[24:27], s66 offen  lds
    s_add_u32 s66, s66, 20480
DMAX:
    v_mov_b32 v109, v20
    v_and_b32 v25, 15, v0
    v_lshrrev_b32 v26, 4, v0
    v_add_u32 v27, 4, v26
    v_mul_u32_u24 v20, 1280, v26
    v_add_u32 v20, 665600, v20
    s_mul_i32 s7, s68, 81920
    s_add_u32 s7, s7, 47360
    v_mov_b32 v28, s7
    v_cmp_eq_u32 vcc, s68, v26
    s_nop 1
    v_cndmask_b32 v20, v20, v28, vcc
    v_mul_u32_u24 v21, 1280, v27
    v_add_u32 v21, 665600, v21
    s_mul_i32 s7, s68, 81920
    s_add_u32 s7, s7, 47360
    v_mov_b32 v28, s7
    v_cmp_eq_u32 vcc, s68, v27
    s_nop 1
    v_cndmask_b32 v21, v21, v28, vcc
    s_min_u32 s7, s69, 19
    s_lshl_b32 s7, s7, 6
    v_lshl_add_u32 v25, v25, 2, s7
    v_add_u32 v20, v20, v25
    v_add_u32 v21, v21, v25
    buffer_load_dwordx4 a[216:219], v1, s[12:15], s73 offen offset:0 nt
    v_and_b32 v25, 15, v0
    v_bfe_u32 v27, v0, 2, 2
    v_and_b32 v28, 3, v0
    s_mul_i32 s7, s72, 12288
    s_add_u32 s7, s7, 57344
    v_lshl_add_u32 v29, v26, 3, v27
    v_lshlrev_b32 v29, 6, v29
    v_lshl_add_u32 v29, v28, 3, v29
    v_add_u32 v29, s7, v29
    v_accvgpr_write_b32 a246, v29
    s_mul_i32 s7, s72, 3072
    s_add_u32 s7, s7, 32768
    v_lshl_add_u32 v29, v25, 4, s7
    v_lshl_add_u32 v29, v26, 7, v29
    v_accvgpr_write_b32 a247, v29
    s_lshl_b32 s7, s72, 6
    s_add_u32 s7, s7, 45056
    v_and_b32 v29, 1, v26
    v_lshl_add_u32 v29, v29, 5, s7
    v_accvgpr_write_b32 a248, v29
    s_lshl_b32 s7, s72, 8
    s_add_u32 s7, s7, 122368
    v_lshl_add_u32 v29, v0, 2, s7
    v_accvgpr_write_b32 a249, v29
    s_lshl_b32 s81, s69, 6
    s_mul_i32 s80, s68, 1280
    s_add_u32 s80, s80, s81
    s_add_u32 s80, s80, 655360
    s_add_u32 s81, s81, s3
    s_add_u32 s81, s81, 46080
    s_waitcnt vmcnt(13)
    ds_write_b128 v2, a[120:123] offset:0
    ds_write_b128 v3, a[124:127] offset:0
    ds_write_b128 v4, a[128:131] offset:0
    ds_write_b128 v2, a[132:135] offset:3328
    ds_write_b128 v3, a[136:139] offset:3328
    ds_write_b128 v4, a[140:143] offset:3328
    ds_read_b128 a[120:123], v5 offset:0
    ds_read_b128 a[124:127], v5 offset:64
    ds_read_b128 a[128:131], v5 offset:128
    ds_read_b128 a[132:135], v5 offset:192
    ds_read_b128 a[136:139], v5 offset:256
    ds_read_b128 a[140:143], v5 offset:320
    buffer_load_dwordx4 a[220:223], v1, s[12:15], s73 offen offset:1024 nt
    buffer_load_dwordx4 a[224:227], v1, s[12:15], s73 offen offset:2048 nt
    buffer_load_dwordx4 a[228:231], v1, s[12:15], s73 offen offset:3072 nt
    buffer_load_dwordx4 a[232:235], v23, s[12:15], s73 offen offset:0 nt
    buffer_load_dwordx4 a[236:239], v23, s[12:15], s73 offen offset:1024 nt
    s_barrier
    global_load_dword v99, v98, s[64:65] sc1
    s_waitcnt vmcnt(13)
    ds_write_b128 v2, a[144:147] offset:0
    ds_write_b128 v3, a[148:151] offset:0
    ds_write_b128 v4, a[152:155] offset:0
    ds_write_b128 v2, a[156:159] offset:3328
    ds_write_b128 v3, a[160:163] offset:3328
    ds_write_b128 v4, a[164:167] offset:3328
    ds_read_b128 a[144:147], v5 offset:0
    ds_read_b128 a[148:151], v5 offset:64
    ds_read_b128 a[152:155], v5 offset:128
    ds_read_b128 a[156:159], v5 offset:192
    ds_read_b128 a[160:163], v5 offset:256
    ds_read_b128 a[164:167], v5 offset:320
    buffer_load_dwordx4 v[112:115], v1, s[12:15], s83 offen offset:0 nt
    buffer_load_dwordx4 v[116:119], v1, s[12:15], s83 offen offset:1024 nt
    buffer_load_dwordx4 v[120:123], v1, s[12:15], s83 offen offset:2048 nt
    buffer_load_dwordx4 v[124:127], v1, s[12:15], s83 offen offset:3072 nt
    buffer_load_dwordx4 v[128:131], v23, s[12:15], s83 offen offset:0 nt
    buffer_load_dwordx4 v[132:135], v23, s[12:15], s83 offen offset:1024 nt
    s_barrier
    s_waitcnt vmcnt(13)
    ds_write_b128 v2, a[168:171] offset:0
    ds_write_b128 v3, a[172:175] offset:0
    ds_write_b128 v4, a[176:179] offset:0
    ds_write_b128 v2, a[180:183] offset:3328
    ds_write_b128 v3, a[184:187] offset:3328
    ds_write_b128 v4, a[188:191] offset:3328
    ds_read_b128 a[168:171], v5 offset:0
    ds_read_b128 a[172:175], v5 offset:64
    ds_read_b128 a[176:179], v5 offset:128
    ds_read_b128 a[180:183], v5 offset:192
    ds_read_b128 a[184:187], v5 offset:256
    ds_read_b128 a[188:191], v5 offset:320
    buffer_load_dwordx4 v[136:139], v1, s[12:15], s84 offen offset:0 nt
    buffer_load_dwordx4 v[140:143], v1, s[12:15], s84 offen offset:1024 nt
    buffer_load_dwordx4 v[144:147], v1, s[12:15], s84 offen offset:2048 nt
    buffer_load_dwordx4 v[148:151], v1, s[12:15], s84 offen offset:3072 nt
    buffer_load_dwordx4 v[152:155], v23, s[12:15], s84 offen offset:0 nt
    buffer_load_dwordx4 v[156:159], v23, s[12:15], s84 offen offset:1024 nt
    s_barrier
    s_waitcnt vmcnt(12)
    s_mov_b32 s76, -1
    v_sad_u8 v100, v99, 0, 0
    s_nop 1
    v_add_u32_dpp v100, v100, v100 quad_perm:[1,0,3,2] row_mask:0xf bank_mask:0xf
    s_nop 1
    v_add_u32_dpp v100, v100, v100 quad_perm:[2,3,0,1] row_mask:0xf bank_mask:0xf
    v_cmp_gt_u32 vcc, 32, v100
    s_mov_b32 vcc_hi, 0
    s_cmp_eq_u64 vcc, 0
    s_cbranch_scc0 RDYLOOP
RDYOK:
    v_readlane_b32 s77, v99, s5
    s_nop 0
    s_cmp_eq_u32 s77, s96
    s_cselect_b32 s75, 1, 0
    buffer_load_dwordx4 a[240:243], v109, s[16:19], 0 offen sc1
    v_lshrrev_b32 v106, 3, v0
    v_mul_u32_u24 v106, 2560, v106
    v_and_b32 v107, 7, v0
    v_lshl_add_u32 v106, v107, 4, v106
    s_lshl_b32 s77, s69, 7
    s_add_u32 s77, s77, s3
    s_add_u32 s77, s77, 51200
    s_cmp_lt_u32 s69, 20
    s_cselect_b32 s77, s77, 1879048176
    s_cmp_eq_u32 s72, 3
    s_cselect_b32 s77, s77, 1879048176
    v_add_u32 v106, s77, v106
    v_add_u32 v107, 20480, v106
    v_mov_b32 v108, 2147483632
    v_cmp_le_u32 vcc, 32, v0
    s_nop 1
    v_cndmask_b32 v107, v107, v108, vcc
    buffer_load_dwordx4 a[240:243], v106, s[16:19], 0 offen sc1
    v_accvgpr_write_b32 a250, v106
    buffer_load_dwordx4 a[240:243], v107, s[16:19], 0 offen sc1
    v_accvgpr_write_b32 a251, v107
    s_mul_i32 s77, s70, 3072
    s_mul_i32 s78, s72, 96
    s_add_u32 s77, s77, s78
    s_add_u32 s77, s77, s3
    v_lshrrev_b32 v24, 4, v0
    v_mul_u32_u24 v24, 384, v24
    v_and_b32 v25, 15, v0
    v_min_u32 v25, 11, v25
    v_lshl_add_u32 v24, v25, 3, v24
    buffer_load_dwordx2 v[64:65], v24, s[16:19], s77 offen offset:0 sc1
    buffer_load_dwordx2 v[66:67], v24, s[16:19], s77 offen offset:1536 sc1
    s_cmp_lg_u32 s72, 1
    s_cbranch_scc1 NOBASE0
    s_cmp_ge_u32 s69, 20
    s_cbranch_scc1 NOBASE0
    v_mov_b32 v28, v22
    s_lshl_b32 s77, s69, 6
    s_add_u32 s77, s77, s3
    s_add_u32 s77, s77, 48640
    v_lshlrev_b32 v27, 2, v0
    v_mov_b32_dpp v29, v28 quad_perm:[1,1,1,1] row_mask:0xf bank_mask:0xf
    v_mov_b32_dpp v30, v28 quad_perm:[2,2,2,2] row_mask:0xf bank_mask:0xf
    v_mov_b32_dpp v31, v28 quad_perm:[3,3,3,3] row_mask:0xf bank_mask:0xf
    s_mov_b32 exec_lo, 0x1111
    s_mov_b32 exec_hi, 0x0
    s_cmp_eq_u32 s75, 1
    s_cbranch_scc0 SLOW1
    buffer_store_dwordx4 v[28:31], v27, s[16:19], s77 offen
BACK1:
    s_mov_b64 exec, -1
NOBASE0:
    ds_write_b128 v2, a[216:219] offset:0
    ds_write_b128 v3, a[220:223] offset:0
    ds_write_b128 v4, a[224:227] offset:0
    ds_write_b128 v2, a[228:231] offset:3328
    ds_write_b128 v3, a[232:235] offset:3328
    ds_write_b128 v4, a[236:239] offset:3328
    ds_read_b64_tr_b16 a[192:193], v6 offset:0
    ds_read_b64_tr_b16 a[196:197], v6 offset:32
    ds_read_b64_tr_b16 a[200:201], v6 offset:64
    ds_read_b64_tr_b16 a[204:205], v6 offset:96
    ds_read_b64_tr_b16 a[208:209], v6 offset:128
    ds_read_b64_tr_b16 a[212:213], v6 offset:160
    ds_read_b64_tr_b16 a[216:217], v6 offset:192
    ds_read_b64_tr_b16 a[220:221], v6 offset:224
    ds_read_b64_tr_b16 a[224:225], v6 offset:256
    ds_read_b64_tr_b16 a[228:229], v6 offset:288
    ds_read_b64_tr_b16 a[232:233], v6 offset:320
    ds_read_b64_tr_b16 a[236:237], v6 offset:352
    buffer_load_dwordx4 v[160:163], v1, s[12:15], s85 offen offset:0 nt
    s_waitcnt vmcnt(12)
    ds_write_b128 v2, v[112:115] offset:0
    ds_write_b128 v3, v[116:119] offset:0
    ds_write_b128 v4, v[120:123] offset:0
    ds_write_b128 v2, v[124:127] offset:3328
    ds_write_b128 v3, v[128:131] offset:3328
    ds_write_b128 v4, v[132:135] offset:3328
    ds_read_b64_tr_b16 a[194:195], v6 offset:0
    ds_read_b64_tr_b16 a[198:199], v6 offset:32
    ds_read_b64_tr_b16 a[202:203], v6 offset:64
    ds_read_b64_tr_b16 a[206:207], v6 offset:96
    ds_read_b64_tr_b16 a[210:211], v6 offset:128
    ds_read_b64_tr_b16 a[214:215], v6 offset:160
    ds_read_b64_tr_b16 a[218:219], v6 offset:192
    ds_read_b64_tr_b16 a[222:223], v6 offset:224
    ds_read_b64_tr_b16 a[226:227], v6 offset:256
    ds_read_b64_tr_b16 a[230:231], v6 offset:288
    ds_read_b64_tr_b16 a[234:235], v6 offset:320
    ds_read_b64_tr_b16 a[238:239], v6 offset:352
    buffer_load_dwordx4 v[164:167], v1, s[12:15], s85 offen offset:1024 nt
    buffer_load_dwordx4 v[168:171], v1, s[12:15], s85 offen offset:2048 nt
    buffer_load_dwordx4 v[172:175], v1, s[12:15], s85 offen offset:3072 nt
    buffer_load_dwordx4 v[176:179], v23, s[12:15], s85 offen offset:0 nt
    buffer_load_dwordx4 v[180:183], v23, s[12:15], s85 offen offset:1024 nt
    s_barrier
    buffer_load_dwordx4 v[184:187], v1, s[12:15], s86 offen offset:0 nt
    s_waitcnt vmcnt(12)
    ds_write_b128 v2, v[136:139] offset:0
    ds_write_b128 v3, v[140:143] offset:0
    ds_write_b128 v4, v[144:147] offset:0
    ds_write_b128 v2, v[148:151] offset:3328
    ds_write_b128 v3, v[152:155] offset:3328
    ds_write_b128 v4, v[156:159] offset:3328
    ds_read_b64_tr_b16 v[112:113], v6 offset:0
    ds_read_b64_tr_b16 v[116:117], v6 offset:32
    ds_read_b64_tr_b16 v[120:121], v6 offset:64
    ds_read_b64_tr_b16 v[124:125], v6 offset:96
    ds_read_b64_tr_b16 v[128:129], v6 offset:128
    ds_read_b64_tr_b16 v[132:133], v6 offset:160
    ds_read_b64_tr_b16 v[136:137], v6 offset:192
    ds_read_b64_tr_b16 v[140:141], v6 offset:224
    ds_read_b64_tr_b16 v[144:145], v6 offset:256
    ds_read_b64_tr_b16 v[148:149], v6 offset:288
    ds_read_b64_tr_b16 v[152:153], v6 offset:320
    ds_read_b64_tr_b16 v[156:157], v6 offset:352
    buffer_load_dwordx4 v[188:191], v1, s[12:15], s86 offen offset:1024 nt
    buffer_load_dwordx4 v[192:195], v1, s[12:15], s86 offen offset:2048 nt
    buffer_load_dwordx4 v[196:199], v1, s[12:15], s86 offen offset:3072 nt
    buffer_load_dwordx4 v[200:203], v23, s[12:15], s86 offen offset:0 nt
    buffer_load_dwordx4 v[204:207], v23, s[12:15], s86 offen offset:1024 nt
    s_barrier
    s_waitcnt vmcnt(12)
    v_lshlrev_b32 v24, 16, v64
    v_and_b32 v25, 0xffff0000, v64
    v_lshlrev_b32 v26, 16, v65
    v_and_b32 v27, 0xffff0000, v65
    v_lshlrev_b32 v28, 16, v66
    v_and_b32 v29, 0xffff0000, v66
    v_lshlrev_b32 v30, 16, v67
    v_and_b32 v31, 0xffff0000, v67
    v_add_f32 v24, v24, v28
    v_add_f32 v25, v25, v29
    v_add_f32 v26, v26, v30
    v_add_f32 v27, v27, v31
    s_nop 0
    v_permlane32_swap_b32 v24, v26
    v_permlane32_swap_b32 v25, v27
    v_add_f32 v24, v24, v26
    v_add_f32 v25, v25, v27
    s_nop 1
    v_permlane16_swap_b32 v24, v25
    v_add_f32 v24, v24, v25
    v_cvt_pk_bf16_f32 v24, v24, v24
    ds_write_b16 v12, v24
    buffer_load_dwordx4 v[208:211], v1, s[12:15], s87 offen offset:0 nt
    v_mov_b32 v40, 0
    v_mov_b32 v41, 0
    v_mov_b32 v44, 0
    v_mov_b32 v45, 0
    v_mov_b32 v48, 0
    v_mov_b32 v49, 0
    v_mov_b32 v52, 0
    v_mov_b32 v53, 0
    v_mov_b32 v56, 0
    v_mov_b32 v57, 0
    v_mov_b32 v60, 0
    v_mov_b32 v61, 0
    v_mov_b32 v64, 0
    v_mov_b32 v65, 0
    v_mov_b32 v68, 0
    v_mov_b32 v69, 0
    v_mov_b32 v72, 0
    v_mov_b32 v73, 0
    v_mov_b32 v74, 0
    v_mov_b32 v75, 0
    v_mov_b32 v76, 0
    v_mov_b32 v77, 0
    v_mov_b32 v78, 0
    v_mov_b32 v79, 0
    v_mov_b32 v80, 0
    v_mov_b32 v81, 0
    v_mov_b32 v82, 0
    v_mov_b32 v83, 0
    v_mov_b32 v84, 0
    v_mov_b32 v85, 0
    v_mov_b32 v86, 0
    v_mov_b32 v87, 0
    buffer_load_dwordx4 v[212:215], v1, s[12:15], s87 offen offset:1024 nt
    buffer_load_dwordx4 v[216:219], v1, s[12:15], s87 offen offset:2048 nt
    s_waitcnt lgkmcnt(0)
    s_barrier
    ds_read_b128 v[28:31], v13 offset:0
    ds_read_b128 v[32:35], v13 offset:128
    ds_read_b128 v[36:39], v13 offset:256
    v_mov_b32 v18, 0x3dd53b94
    s_waitcnt lgkmcnt(2)
    v_smfmac_f32_16x16x64_bf16 v[40:43], v[28:31], a[0:7], v14
    v_smfmac_f32_16x16x64_bf16 v[56:59], v[28:31], a[96:103], v14
    v_smfmac_f32_16x16x64_bf16 v[44:47], v[28:31], a[24:31], v14
    v_smfmac_f32_16x16x64_bf16 v[60:63], v[28:31], a[120:127], v14
    v_smfmac_f32_16x16x64_bf16 v[48:51], v[28:31], a[48:55], v14
    v_smfmac_f32_16x16x64_bf16 v[64:67], v[28:31], a[144:151], v14
    v_smfmac_f32_16x16x64_bf16 v[52:55], v[28:31], a[72:79], v14
    v_smfmac_f32_16x16x64_bf16 v[68:71], v[28:31], a[168:175], v14
    buffer_load_dwordx4 v[220:223], v1, s[12:15], s87 offen offset:3072 nt
    s_waitcnt lgkmcnt(1)
    v_smfmac_f32_16x16x64_bf16 v[40:43], v[32:35], a[8:15], v14
    v_smfmac_f32_16x16x64_bf16 v[56:59], v[32:35], a[104:111], v14
    v_smfmac_f32_16x16x64_bf16 v[44:47], v[32:35], a[32:39], v14
    v_smfmac_f32_16x16x64_bf16 v[60:63], v[32:35], a[128:135], v14
    v_smfmac_f32_16x16x64_bf16 v[48:51], v[32:35], a[56:63], v14
    v_smfmac_f32_16x16x64_bf16 v[64:67], v[32:35], a[152:159], v14
    v_smfmac_f32_16x16x64_bf16 v[52:55], v[32:35], a[80:87], v14
    v_smfmac_f32_16x16x64_bf16 v[68:71], v[32:35], a[176:183], v14
    s_waitcnt lgkmcnt(0)
    v_smfmac_f32_16x16x64_bf16 v[40:43], v[36:39], a[16:23], v14
    v_smfmac_f32_16x16x64_bf16 v[56:59], v[36:39], a[112:119], v14
    v_smfmac_f32_16x16x64_bf16 v[44:47], v[36:39], a[40:47], v14
    v_smfmac_f32_16x16x64_bf16 v[60:63], v[36:39], a[136:143], v14
    v_smfmac_f32_16x16x64_bf16 v[48:51], v[36:39], a[64:71], v14
    v_smfmac_f32_16x16x64_bf16 v[64:67], v[36:39], a[160:167], v14
    v_smfmac_f32_16x16x64_bf16 v[52:55], v[36:39], a[88:95], v14
    v_smfmac_f32_16x16x64_bf16 v[68:71], v[36:39], a[184:191], v14
    buffer_load_dwordx4 v[224:227], v23, s[12:15], s87 offen offset:0 nt
    s_lshl_b32 s78, s72, 8
    v_add_f32_dpp v24, v40, v41 quad_perm:[0,1,2,3] row_mask:0x1 bank_mask:0xf
    v_add_f32_dpp v25, v56, v57 quad_perm:[0,1,2,3] row_mask:0x1 bank_mask:0xf
    v_bfe_u32 v27, v0, 4, 1
    v_add_f32_dpp v24, v44, v45 quad_perm:[0,1,2,3] row_mask:0x2 bank_mask:0xf
    v_add_f32_dpp v25, v60, v61 quad_perm:[0,1,2,3] row_mask:0x2 bank_mask:0xf
    v_bfe_u32 v28, v0, 2, 1
    v_add_f32_dpp v24, v48, v49 quad_perm:[0,1,2,3] row_mask:0x4 bank_mask:0xf
    v_add_f32_dpp v25, v64, v65 quad_perm:[0,1,2,3] row_mask:0x4 bank_mask:0xf
    s_add_u32 s78, s78, 124416
    v_add_f32_dpp v24, v52, v53 quad_perm:[0,1,2,3] row_mask:0x8 bank_mask:0xf
    v_add_f32_dpp v25, v68, v69 quad_perm:[0,1,2,3] row_mask:0x8 bank_mask:0xf
    v_max_f32 v26, v24, v25
    v_lshl_add_u32 v27, v27, 5, s78
    v_lshl_add_u32 v27, v28, 4, v27
    v_max_f32_dpp v26, v26, v26 row_ror:8 row_mask:0xf bank_mask:0xf
    s_nop 1
    v_max_f32_dpp v26, v26, v26 row_ror:4 row_mask:0xf bank_mask:0xf
    s_nop 1
    v_max_f32_dpp v26, v26, v26 row_ror:2 row_mask:0xf bank_mask:0xf
    s_nop 1
    v_max_f32_dpp v26, v26, v26 row_ror:1 row_mask:0xf bank_mask:0xf
    v_mov_b32 v28, v26
    s_nop 1
    v_permlane32_swap_b32 v26, v28
    v_max_f32 v26, v26, v28
    v_mov_b32 v28, v26
    s_nop 1
    v_permlane16_swap_b32 v26, v28
    v_max_f32 v26, v26, v28
    buffer_load_dwordx4 v[228:231], v23, s[12:15], s87 offen offset:1024 nt
    s_barrier
    v_mul_f32 v26, v26, v18
    v_fma_f32 v24, v24, v18, -v26
    v_fma_f32 v25, v25, v18, -v26
    v_exp_f32 v24, v24
    v_exp_f32 v25, v25
    s_nop 0
    v_cvt_pk_bf16_f32 v28, v24, v25
    ds_write_b16 v19, v28
    ds_write_b16_d16_hi v19, v28 offset:128
    s_mov_b32 exec_lo, 0xff00ff
    s_mov_b32 exec_hi, 0xff00ff00
    ds_read_b128 v[72:75], v27 offset:0
    ds_read_b128 v[76:79], v27 offset:64
    ds_read_b128 v[80:83], v27 offset:128
    ds_read_b128 v[84:87], v27 offset:192
    s_mov_b64 exec, -1
    v_add_f32 v27, v24, v25
    v_mov_b32 v40, 0
    v_mov_b32 v44, 0
    v_add_f32_dpp v27, v27, v27 row_ror:8 row_mask:0xf bank_mask:0xf
    v_mov_b32 v48, 0
    v_mov_b32 v52, 0
    v_add_f32_dpp v27, v27, v27 row_ror:4 row_mask:0xf bank_mask:0xf
    v_mov_b32 v56, 0
    v_mov_b32 v60, 0
    v_add_f32_dpp v27, v27, v27 row_ror:2 row_mask:0xf bank_mask:0xf
    s_lshl_b32 s78, s72, 3
    s_add_u32 s78, s78, 125440
    v_add_f32_dpp v27, v27, v27 row_ror:1 row_mask:0xf bank_mask:0xf
    v_mov_b32 v28, v27
    s_nop 1
    v_permlane32_swap_b32 v27, v28
    v_add_f32 v27, v27, v28
    v_mov_b32 v28, v27
    s_nop 1
    v_permlane16_swap_b32 v27, v28
    v_add_f32 v27, v27, v28
    v_mov_b32 v28, s78
    ds_write_b64 v28, v[26:27]
    s_waitcnt vmcnt(12)
    ds_write_b128 v2, v[160:163] offset:0
    ds_write_b128 v3, v[164:167] offset:0
    ds_write_b128 v4, v[168:171] offset:0
    ds_write_b128 v2, v[172:175] offset:3328
    ds_write_b128 v3, v[176:179] offset:3328
    ds_write_b128 v4, v[180:183] offset:3328
    ds_read_b64_tr_b16 v[114:115], v6 offset:0
    ds_read_b64_tr_b16 v[118:119], v6 offset:32
    ds_read_b64_tr_b16 v[122:123], v6 offset:64
    ds_read_b64_tr_b16 v[126:127], v6 offset:96
    ds_read_b64_tr_b16 v[130:131], v6 offset:128
    ds_read_b64_tr_b16 v[134:135], v6 offset:160
    ds_read_b64_tr_b16 v[138:139], v6 offset:192
    ds_read_b64_tr_b16 v[142:143], v6 offset:224
    ds_read_b64_tr_b16 v[146:147], v6 offset:256
    ds_read_b64_tr_b16 v[150:151], v6 offset:288
    ds_read_b64_tr_b16 v[154:155], v6 offset:320
    ds_read_b64_tr_b16 v[158:159], v6 offset:352
    buffer_load_dwordx4 v[232:235], v1, s[12:15], s88 offen offset:0 nt
    buffer_load_dwordx4 v[236:239], v1, s[12:15], s88 offen offset:1024 nt
    s_waitcnt lgkmcnt(0)
    v_smfmac_f32_16x16x64_bf16 v[40:43], v[72:75], a[192:199], v14 abid:1
    v_smfmac_f32_16x16x64_bf16 v[44:47], v[72:75], a[200:207], v14 abid:1
    v_smfmac_f32_16x16x64_bf16 v[48:51], v[72:75], a[208:215], v14 abid:1
    v_smfmac_f32_16x16x64_bf16 v[52:55], v[72:75], a[216:223], v14 abid:1
    v_smfmac_f32_16x16x64_bf16 v[56:59], v[72:75], a[224:231], v14 abid:1
    v_smfmac_f32_16x16x64_bf16 v[60:63], v[72:75], a[232:239], v14 abid:1
    buffer_load_dwordx4 v[240:243], v1, s[12:15], s88 offen offset:2048 nt
    v_smfmac_f32_16x16x64_bf16 v[40:43], v[76:79], v[112:119], v14 abid:1
    v_smfmac_f32_16x16x64_bf16 v[44:47], v[76:79], v[120:127], v14 abid:1
    v_smfmac_f32_16x16x64_bf16 v[48:51], v[76:79], v[128:135], v14 abid:1
    v_smfmac_f32_16x16x64_bf16 v[52:55], v[76:79], v[136:143], v14 abid:1
    v_smfmac_f32_16x16x64_bf16 v[56:59], v[76:79], v[144:151], v14 abid:1
    v_smfmac_f32_16x16x64_bf16 v[60:63], v[76:79], v[152:159], v14 abid:1
    buffer_load_dwordx4 v[244:247], v1, s[12:15], s88 offen offset:3072 nt
    buffer_load_dwordx4 v[248:251], v23, s[12:15], s88 offen offset:0 nt
    buffer_load_dwordx4 v[252:255], v23, s[12:15], s88 offen offset:1024 nt
    s_barrier
    s_waitcnt vmcnt(12)
    ds_write_b128 v2, v[184:187] offset:0
    ds_write_b128 v3, v[188:191] offset:0
    ds_write_b128 v4, v[192:195] offset:0
    ds_write_b128 v2, v[196:199] offset:3328
    ds_write_b128 v3, v[200:203] offset:3328
    ds_write_b128 v4, v[204:207] offset:3328
    ds_read_b64_tr_b16 v[160:161], v6 offset:0
    ds_read_b64_tr_b16 v[164:165], v6 offset:32
    ds_read_b64_tr_b16 v[168:169], v6 offset:64
    ds_read_b64_tr_b16 v[172:173], v6 offset:96
    ds_read_b64_tr_b16 v[176:177], v6 offset:128
    ds_read_b64_tr_b16 v[180:181], v6 offset:160
    ds_read_b64_tr_b16 v[184:185], v6 offset:192
    ds_read_b64_tr_b16 v[188:189], v6 offset:224
    ds_read_b64_tr_b16 v[192:193], v6 offset:256
    ds_read_b64_tr_b16 v[196:197], v6 offset:288
    ds_read_b64_tr_b16 v[200:201], v6 offset:320
    ds_read_b64_tr_b16 v[204:205], v6 offset:352
    buffer_load_dwordx4 v[88:91], v1, s[12:15], s89 offen offset:0 nt
    buffer_load_dwordx4 v[92:95], v1, s[12:15], s89 offen offset:1024 nt
    buffer_load_dwordx4 v[96:99], v1, s[12:15], s89 offen offset:2048 nt
    buffer_load_dwordx4 v[100:103], v1, s[12:15], s89 offen offset:3072 nt
    buffer_load_dwordx4 v[104:107], v23, s[12:15], s89 offen offset:0 nt
    buffer_load_dwordx4 v[108:111], v23, s[12:15], s89 offen offset:1024 nt
    s_waitcnt vmcnt(12)
    ds_write_b128 v2, v[208:211] offset:0
    ds_write_b128 v3, v[212:215] offset:0
    ds_write_b128 v4, v[216:219] offset:0
    ds_write_b128 v2, v[220:223] offset:3328
    ds_write_b128 v3, v[224:227] offset:3328
    ds_write_b128 v4, v[228:231] offset:3328
    ds_read_b64_tr_b16 v[162:163], v6 offset:0
    ds_read_b64_tr_b16 v[166:167], v6 offset:32
    ds_read_b64_tr_b16 v[170:171], v6 offset:64
    ds_read_b64_tr_b16 v[174:175], v6 offset:96
    ds_read_b64_tr_b16 v[178:179], v6 offset:128
    ds_read_b64_tr_b16 v[182:183], v6 offset:160
    ds_read_b64_tr_b16 v[186:187], v6 offset:192
    ds_read_b64_tr_b16 v[190:191], v6 offset:224
    ds_read_b64_tr_b16 v[194:195], v6 offset:256
    ds_read_b64_tr_b16 v[198:199], v6 offset:288
    ds_read_b64_tr_b16 v[202:203], v6 offset:320
    ds_read_b64_tr_b16 v[206:207], v6 offset:352
    v_and_b32 v23, 0xffff0000, v22
    v_lshlrev_b32 v22, 16, v22
    s_cmp_ge_u32 s69, 20
    s_cbranch_scc1 TAILF
    v_lshrrev_b32 v38, 2, v0
    v_mul_u32_u24 v38, 1280, v38
    v_and_b32 v39, 3, v0
    v_lshl_add_u32 v39, v39, 4, v38
    s_mov_b32 m0, s67
    s_add_u32 s67, s67, 1024
    buffer_load_dwordx4 v39, s[24:27], s66 offen  lds
    s_add_u32 s66, s66, 20480
    s_mov_b32 m0, s67
    s_add_u32 s67, s67, 1024
    buffer_load_dwordx4 v39, s[24:27], s66 offen  lds
    s_add_u32 s66, s66, 20480
    s_mov_b32 m0, s67
    s_add_u32 s67, s67, 1024
    buffer_load_dwordx4 v39, s[24:27], s66 offen  lds
    s_add_u32 s66, s66, 20480
    s_waitcnt lgkmcnt(0)
    v_smfmac_f32_16x16x64_bf16 v[40:43], v[80:83], v[160:167], v14 abid:1
    v_smfmac_f32_16x16x64_bf16 v[44:47], v[80:83], v[168:175], v14 abid:1
    v_smfmac_f32_16x16x64_bf16 v[48:51], v[80:83], v[176:183], v14 abid:1
    v_smfmac_f32_16x16x64_bf16 v[52:55], v[80:83], v[184:191], v14 abid:1
    v_smfmac_f32_16x16x64_bf16 v[56:59], v[80:83], v[192:199], v14 abid:1
    v_smfmac_f32_16x16x64_bf16 v[60:63], v[80:83], v[200:207], v14 abid:1
    s_waitcnt vmcnt(9)
    ds_write_b128 v2, v[232:235] offset:0
    ds_write_b128 v3, v[236:239] offset:0
    ds_write_b128 v4, v[240:243] offset:0
    ds_write_b128 v2, v[244:247] offset:3328
    ds_write_b128 v3, v[248:251] offset:3328
    ds_write_b128 v4, v[252:255] offset:3328
    ds_read_b64_tr_b16 v[208:209], v6 offset:0
    ds_read_b64_tr_b16 v[212:213], v6 offset:32
    ds_read_b64_tr_b16 v[216:217], v6 offset:64
    ds_read_b64_tr_b16 v[220:221], v6 offset:96
    ds_read_b64_tr_b16 v[224:225], v6 offset:128
    ds_read_b64_tr_b16 v[228:229], v6 offset:160
    ds_read_b64_tr_b16 v[232:233], v6 offset:192
    ds_read_b64_tr_b16 v[236:237], v6 offset:224
    ds_read_b64_tr_b16 v[240:241], v6 offset:256
    ds_read_b64_tr_b16 v[244:245], v6 offset:288
    ds_read_b64_tr_b16 v[248:249], v6 offset:320
    ds_read_b64_tr_b16 v[252:253], v6 offset:352
    s_mov_b32 m0, s67
    s_add_u32 s67, s67, 1024
    buffer_load_dwordx4 v39, s[24:27], s66 offen  lds
    s_add_u32 s66, s66, 20480
    s_mov_b32 m0, s67
    s_add_u32 s67, s67, 1024
    buffer_load_dwordx4 v39, s[24:27], s66 offen  lds
    s_add_u32 s66, s66, 20480
    s_mov_b32 m0, s67
    s_add_u32 s67, s67, 1024
    buffer_load_dwordx4 v39, s[24:27], s66 offen  lds
    s_add_u32 s66, s66, 20480
    s_waitcnt vmcnt(11)
    ds_write_b128 v2, v[88:91] offset:0
    s_waitcnt vmcnt(10)
    ds_write_b128 v3, v[92:95] offset:0
    s_waitcnt vmcnt(9)
    ds_write_b128 v4, v[96:99] offset:0
    s_waitcnt vmcnt(8)
    ds_write_b128 v2, v[100:103] offset:3328
    s_waitcnt vmcnt(7)
    ds_write_b128 v3, v[104:107] offset:3328
    s_waitcnt vmcnt(6)
    ds_write_b128 v4, v[108:111] offset:3328
    ds_read_b64_tr_b16 v[210:211], v6 offset:0
    ds_read_b64_tr_b16 v[214:215], v6 offset:32
    ds_read_b64_tr_b16 v[218:219], v6 offset:64
    ds_read_b64_tr_b16 v[222:223], v6 offset:96
    ds_read_b64_tr_b16 v[226:227], v6 offset:128
    ds_read_b64_tr_b16 v[230:231], v6 offset:160
    ds_read_b64_tr_b16 v[234:235], v6 offset:192
    ds_read_b64_tr_b16 v[238:239], v6 offset:224
    ds_read_b64_tr_b16 v[242:243], v6 offset:256
    ds_read_b64_tr_b16 v[246:247], v6 offset:288
    ds_read_b64_tr_b16 v[250:251], v6 offset:320
    ds_read_b64_tr_b16 v[254:255], v6 offset:352
    s_branch ATT_LAST
TAILF:
    s_lshl_b32 s90, s72, 3
    s_add_u32 s90, s90, s68
    s_mul_i32 s90, s90, 24
    s_add_u32 s90, s90, s69
    s_sub_u32 s90, s90, 8
    s_mul_i32 s90, s90, 10240
    buffer_load_dwordx4 a[240:243], v1, s[20:23], s90 offen offset:0
    buffer_load_dwordx4 a[240:243], v1, s[20:23], s90 offen offset:1024
    buffer_load_dwordx4 a[240:243], v1, s[20:23], s90 offen offset:2048
    buffer_load_dwordx4 a[240:243], v1, s[20:23], s90 offen offset:3072
    s_add_u32 s90, s90, 4096
    buffer_load_dwordx4 a[240:243], v1, s[20:23], s90 offen offset:0
    buffer_load_dwordx4 a[240:243], v1, s[20:23], s90 offen offset:1024
    buffer_load_dwordx4 a[240:243], v1, s[20:23], s90 offen offset:2048
    s_waitcnt lgkmcnt(0)
    v_smfmac_f32_16x16x64_bf16 v[40:43], v[80:83], v[160:167], v14 abid:1
    v_smfmac_f32_16x16x64_bf16 v[44:47], v[80:83], v[168:175], v14 abid:1
    v_smfmac_f32_16x16x64_bf16 v[48:51], v[80:83], v[176:183], v14 abid:1
    v_smfmac_f32_16x16x64_bf16 v[52:55], v[80:83], v[184:191], v14 abid:1
    v_smfmac_f32_16x16x64_bf16 v[56:59], v[80:83], v[192:199], v14 abid:1
    v_smfmac_f32_16x16x64_bf16 v[60:63], v[80:83], v[200:207], v14 abid:1
    s_waitcnt vmcnt(13)
    ds_write_b128 v2, v[232:235] offset:0
    ds_write_b128 v3, v[236:239] offset:0
    ds_write_b128 v4, v[240:243] offset:0
    ds_write_b128 v2, v[244:247] offset:3328
    ds_write_b128 v3, v[248:251] offset:3328
    ds_write_b128 v4, v[252:255] offset:3328
    ds_read_b64_tr_b16 v[208:209], v6 offset:0
    ds_read_b64_tr_b16 v[212:213], v6 offset:32
    ds_read_b64_tr_b16 v[216:217], v6 offset:64
    ds_read_b64_tr_b16 v[220:221], v6 offset:96
    ds_read_b64_tr_b16 v[224:225], v6 offset:128
    ds_read_b64_tr_b16 v[228:229], v6 offset:160
    ds_read_b64_tr_b16 v[232:233], v6 offset:192
    ds_read_b64_tr_b16 v[236:237], v6 offset:224
    ds_read_b64_tr_b16 v[240:241], v6 offset:256
    ds_read_b64_tr_b16 v[244:245], v6 offset:288
    ds_read_b64_tr_b16 v[248:249], v6 offset:320
    ds_read_b64_tr_b16 v[252:253], v6 offset:352
    buffer_load_dwordx4 a[240:243], v1, s[20:23], s90 offen offset:3072
    s_add_u32 s90, s90, 4096
    buffer_load_dwordx4 a[240:243], v1, s[20:23], s90 offen offset:0
    buffer_load_dwordx4 a[240:243], v1, s[20:23], s90 offen offset:1024
    s_waitcnt vmcnt(15)
    ds_write_b128 v2, v[88:91] offset:0
    s_waitcnt vmcnt(14)
    ds_write_b128 v3, v[92:95] offset:0
    s_waitcnt vmcnt(13)
    ds_write_b128 v4, v[96:99] offset:0
    s_waitcnt vmcnt(12)
    ds_write_b128 v2, v[100:103] offset:3328
    s_waitcnt vmcnt(11)
    ds_write_b128 v3, v[104:107] offset:3328
    s_waitcnt vmcnt(10)
    ds_write_b128 v4, v[108:111] offset:3328
    ds_read_b64_tr_b16 v[210:211], v6 offset:0
    ds_read_b64_tr_b16 v[214:215], v6 offset:32
    ds_read_b64_tr_b16 v[218:219], v6 offset:64
    ds_read_b64_tr_b16 v[222:223], v6 offset:96
    ds_read_b64_tr_b16 v[226:227], v6 offset:128
    ds_read_b64_tr_b16 v[230:231], v6 offset:160
    ds_read_b64_tr_b16 v[234:235], v6 offset:192
    ds_read_b64_tr_b16 v[238:239], v6 offset:224
    ds_read_b64_tr_b16 v[242:243], v6 offset:256
    ds_read_b64_tr_b16 v[246:247], v6 offset:288
    ds_read_b64_tr_b16 v[250:251], v6 offset:320
    ds_read_b64_tr_b16 v[254:255], v6 offset:352
    s_branch ATT_LAST
LOOP:
    s_cmp_lt_u32 s69, 20
    s_cselect_b32 s5, s72, 4
    s_add_u32 s96, s3, 688128
    s_add_u32 s97, s96, 4096
    buffer_load_dwordx4 v[88:91], v11, s[16:19], s96 offen sc1
    buffer_load_dwordx4 v[92:95], v11, s[16:19], s97 offen sc1
    ds_read_b64_tr_b16 v[40:41], v16 offset:0
    ds_read_b64_tr_b16 v[42:43], v16 offset:1536
    ds_read_b64_tr_b16 v[44:45], v16 offset:12288
    ds_read_b64_tr_b16 v[46:47], v16 offset:13824
    ds_read_b64_tr_b16 v[48:49], v17 offset:24576
    ds_read_b64_tr_b16 v[50:51], v16 offset:32
    ds_read_b64_tr_b16 v[52:53], v16 offset:1568
    ds_read_b64_tr_b16 v[54:55], v16 offset:12320
    ds_read_b64_tr_b16 v[56:57], v16 offset:13856
    ds_read_b64_tr_b16 v[58:59], v17 offset:24608
    ds_read_b64_tr_b16 v[60:61], v16 offset:64
    ds_read_b64_tr_b16 v[62:63], v16 offset:1600
    ds_read_b64_tr_b16 v[64:65], v16 offset:12352
    ds_read_b64_tr_b16 v[66:67], v16 offset:13888
    ds_read_b64_tr_b16 v[68:69], v17 offset:24640
    v_and_b32 v25, 15, v0
    v_cmp_eq_u32 vcc, 12, v25
    v_mov_b32 v36, 0x3f803f80
    s_nop 0
    v_cndmask_b32 v70, 0, v36, vcc
    v_mov_b32 v71, v70
    v_mov_b32 v72, v70
    v_mov_b32 v73, v70
    v_mov_b32 v74, v70
    v_mov_b32 v75, v70
    v_mov_b32 v76, v70
    v_mov_b32 v77, v70
    v_mov_b32 v78, v70
    v_mov_b32 v79, v70
    s_add_u32 s79, s3, 4096
    s_mul_i32 s77, s72, 6656
    v_mul_u32_u24 v26, 103, v0
    v_lshrrev_b32 v26, 10, v26
    v_lshl_add_u32 v26, v26, 4, v1
    v_add_u32 v26, s77, v26
    v_mul_u32_u24 v27, 176, v25
    v_add_u32 v27, s77, v27
    v_lshrrev_b32 v28, 4, v0
    v_lshl_add_u32 v29, v28, 3, v27
    v_lshl_add_u32 v27, v28, 4, v27
    s_mul_i32 s77, s71, 160
    s_add_u32 s77, s77, s3
    s_sub_u32 s77, s77, 640768
    s_waitcnt lgkmcnt(0)
    s_mov_b32 exec_lo, 0x3ff
    s_mov_b32 exec_hi, 0x0
    s_mov_b32 s76, 1
POLL2:
    buffer_load_dword v24, v1, s[16:19], s77 offen sc1
POLLW2:
    s_waitcnt vmcnt(0)
    v_cmp_eq_u32 vcc, -1, v24
    s_cbranch_vccnz AGAIN2
POLLX2:
    s_mov_b32 exec_lo, 0xffffffff
    s_mov_b32 exec_hi, 0xfffffff
    buffer_load_dwordx4 v[80:83], v8, s[16:19], 0 offen sc1
    buffer_load_dwordx4 v[84:87], v9, s[16:19], 0 offen sc1
    buffer_load_dwordx4 v[88:91], v11, s[16:19], s96 offen sc1
    buffer_load_dwordx4 v[92:95], v11, s[16:19], s97 offen sc1
    s_waitcnt vmcnt(2)
    v_max_u32 v24, v80, v84
    v_cmp_eq_u32 vcc, -1, v24
    s_cbranch_vccnz AGAIN3
POLLX3:
    ds_write_b128 v26, v[80:83]
    ds_write_b128 v26, v[84:87] offset:1056
    s_mov_b32 exec_lo, 0x1ff01ff
    s_mov_b32 exec_hi, 0x1ff01ff
    ds_read_b128 v[70:73], v27
    ds_read_b128 v[74:77], v27 offset:64
    ds_read_b64 v[78:79], v29 offset:128
    s_mov_b64 exec, -1
    s_cmp_lg_u32 s5, 1
    s_cbranch_scc1 NOOWL
    buffer_load_dword a244, v20, s[16:19], 0 offen sc1
    buffer_load_dword a245, v21, s[16:19], 0 offen sc1
NOOWL:
    s_waitcnt lgkmcnt(2)
    v_mfma_f32_16x16x32_bf16 v[24:27], v[70:73], v[40:43], 0
    v_mfma_f32_16x16x32_bf16 v[32:35], v[70:73], v[60:63], 0
    s_waitcnt lgkmcnt(0)
    v_mfma_f32_16x16x32_bf16 v[24:27], v[74:77], v[44:47], v[24:27]
    v_mfma_f32_16x16x32_bf16 v[32:35], v[74:77], v[64:67], v[32:35]
    v_mfma_f32_16x16x16_bf16 v[24:27], v[78:79], v[48:49], v[24:27]
    v_mfma_f32_16x16x16_bf16 v[32:35], v[78:79], v[68:69], v[32:35]
    v_mfma_f32_16x16x32_bf16 v[28:31], v[70:73], v[50:53], 0
    v_mfma_f32_16x16x32_bf16 v[36:39], v[70:73], v[70:73], 0
    v_mfma_f32_16x16x32_bf16 v[28:31], v[74:77], v[54:57], v[28:31]
    v_mfma_f32_16x16x32_bf16 v[36:39], v[74:77], v[74:77], v[36:39]
    v_mfma_f32_16x16x16_bf16 v[28:31], v[78:79], v[58:59], v[28:31]
    v_mfma_f32_16x16x16_bf16 v[36:39], v[78:79], v[78:79], v[36:39]
    s_nop 0
    v_add_f32 v24, v24, v25
    v_add_f32 v26, v26, v27
    v_add_f32 v24, v24, v26
    v_add_f32 v32, v32, v33
    v_add_f32 v34, v34, v35
    v_add_f32 v32, v32, v34
    s_nop 1
    v_permlane32_swap_b32 v24, v32
    v_add_f32 v28, v28, v29
    v_add_f32 v30, v30, v31
    v_add_f32 v36, v36, v37
    v_add_f32 v38, v38, v39
    v_add_f32 v24, v24, v32
    v_add_f32 v28, v28, v30
    v_add_f32 v36, v36, v38
    s_nop 1
    v_permlane32_swap_b32 v28, v36
    v_add_f32 v28, v28, v36
    s_nop 1
    v_permlane16_swap_b32 v24, v28
    v_add_f32 v24, v24, v28
    s_cmp_eq_u32 s75, 1
    s_cbranch_scc0 SLOW4
    buffer_store_dword v24, v10, s[16:19], s3 offen
BACK4:
    v_mov_b32 v40, 0
    v_mov_b32 v41, 0
    v_mov_b32 v44, 0
    v_mov_b32 v45, 0
    v_mov_b32 v48, 0
    v_mov_b32 v49, 0
    v_mov_b32 v52, 0
    v_mov_b32 v53, 0
    v_mov_b32 v56, 0
    v_mov_b32 v57, 0
    v_mov_b32 v60, 0
    v_mov_b32 v61, 0
    v_mov_b32 v64, 0
    v_mov_b32 v65, 0
    v_mov_b32 v68, 0
    v_mov_b32 v69, 0
    v_mov_b32 v72, 0
    v_mov_b32 v73, 0
    v_mov_b32 v74, 0
    v_mov_b32 v75, 0
    v_mov_b32 v76, 0
    v_mov_b32 v77, 0
    v_mov_b32 v78, 0
    v_mov_b32 v79, 0
    v_mov_b32 v80, 0
    v_mov_b32 v81, 0
    v_mov_b32 v82, 0
    v_mov_b32 v83, 0
    v_mov_b32 v84, 0
    v_mov_b32 v85, 0
    v_mov_b32 v86, 0
    v_mov_b32 v87, 0
    s_waitcnt vmcnt(1)
    v_add_f32 v88, v88, v92
    v_add_f32 v89, v89, v93
    v_add_f32 v90, v90, v94
    v_add_f32 v91, v91, v95
    s_nop 0
    v_permlane32_swap_b32 v88, v90
    v_permlane32_swap_b32 v89, v91
    v_add_f32 v88, v88, v90
    v_add_f32 v89, v89, v91
    s_nop 1
    v_permlane16_swap_b32 v88, v89
    v_add_f32 v88, v88, v89
    v_mul_f32 v7, 0x3acccccd, v88
    s_mov_b32 s76, 1
POLL5:
    buffer_load_dwordx4 v[24:27], v11, s[16:19], s3 offen sc1
    buffer_load_dwordx4 v[28:31], v11, s[16:19], s79 offen sc1
POLLW5:
    s_waitcnt vmcnt(0)
    v_max3_u32 v32, v24, v25, v26
    v_max3_u32 v32, v32, v27, v28
    v_max3_u32 v32, v32, v29, v30
    v_max_u32 v32, v32, v31
    v_cmp_eq_u32 vcc, -1, v32
    s_cbranch_vccnz AGAIN5
POLLX5:
    v_add_f32 v24, v24, v28
    v_add_f32 v25, v25, v29
    v_add_f32 v26, v26, v30
    v_add_f32 v27, v27, v31
    s_nop 0
    v_permlane32_swap_b32 v24, v26
    v_permlane32_swap_b32 v25, v27
    v_add_f32 v24, v24, v26
    v_add_f32 v25, v25, v27
    s_nop 1
    v_permlane16_swap_b32 v24, v25
    v_add_f32 v24, v24, v25
    s_nop 0
    v_readlane_b32 s77, v24, 15
    s_mov_b32 vcc_lo, 0x70007000
    s_mov_b32 vcc_hi, 0x70007000
    v_fma_f32 v25, -s77, v7, v24
    v_cvt_pk_bf16_f32 v25, v25, v25
    ds_write_b16 v12, v25
    v_cndmask_b32 v26, 0, v24, vcc
    s_nop 1
    v_add_f32_dpp v26, v26, v26 quad_perm:[1,0,3,2] row_mask:0xf bank_mask:0xf
    s_nop 1
    v_add_f32_dpp v26, v26, v26 quad_perm:[2,3,0,1] row_mask:0xf bank_mask:0xf
    v_mov_b32 v27, v26
    s_nop 1
    v_permlane32_swap_b32 v26, v27
    v_add_f32 v26, v26, v27
    s_waitcnt lgkmcnt(0)
    s_barrier
    ds_read_b128 v[28:31], v13 offset:0
    ds_read_b128 v[32:35], v13 offset:128
    ds_read_b128 v[36:39], v13 offset:256
    v_mov_b32 v27, v26
    v_mov_b32 v25, s77
    v_subrev_f32 v25, 0x44200000, v25
    v_permlane16_swap_b32 v26, v27
    v_add_f32 v26, v26, v27
    v_mul_f32 v24, 0x3acccccd, v25
    v_readlane_b32 s77, v26, 15
    v_mul_f32 v24, v24, v24
    s_mov_b32 s78, 0x3acccccd
    v_sub_f32 v26, s77, v25
    v_fma_f32 v26, v26, s78, -v24
    v_max_f32 v26, 0, v26
    v_add_f32 v26, 0x3727c5ac, v26
    v_rsq_f32 v26, v26
    s_nop 0
    v_mul_f32 v18, 0x3dd53b94, v26
    s_waitcnt lgkmcnt(2)
    v_smfmac_f32_16x16x64_bf16 v[40:43], v[28:31], a[0:7], v14
    v_smfmac_f32_16x16x64_bf16 v[56:59], v[28:31], a[96:103], v14
    v_smfmac_f32_16x16x64_bf16 v[44:47], v[28:31], a[24:31], v14
    v_smfmac_f32_16x16x64_bf16 v[60:63], v[28:31], a[120:127], v14
    v_smfmac_f32_16x16x64_bf16 v[48:51], v[28:31], a[48:55], v14
    v_smfmac_f32_16x16x64_bf16 v[64:67], v[28:31], a[144:151], v14
    v_smfmac_f32_16x16x64_bf16 v[52:55], v[28:31], a[72:79], v14
    v_smfmac_f32_16x16x64_bf16 v[68:71], v[28:31], a[168:175], v14
    s_waitcnt lgkmcnt(1)
    v_smfmac_f32_16x16x64_bf16 v[40:43], v[32:35], a[8:15], v14
    v_smfmac_f32_16x16x64_bf16 v[56:59], v[32:35], a[104:111], v14
    v_smfmac_f32_16x16x64_bf16 v[44:47], v[32:35], a[32:39], v14
    v_smfmac_f32_16x16x64_bf16 v[60:63], v[32:35], a[128:135], v14
    v_smfmac_f32_16x16x64_bf16 v[48:51], v[32:35], a[56:63], v14
    v_smfmac_f32_16x16x64_bf16 v[64:67], v[32:35], a[152:159], v14
    v_smfmac_f32_16x16x64_bf16 v[52:55], v[32:35], a[80:87], v14
    v_smfmac_f32_16x16x64_bf16 v[68:71], v[32:35], a[176:183], v14
    s_waitcnt lgkmcnt(0)
    v_smfmac_f32_16x16x64_bf16 v[40:43], v[36:39], a[16:23], v14
    v_smfmac_f32_16x16x64_bf16 v[56:59], v[36:39], a[112:119], v14
    v_smfmac_f32_16x16x64_bf16 v[44:47], v[36:39], a[40:47], v14
    v_smfmac_f32_16x16x64_bf16 v[60:63], v[36:39], a[136:143], v14
    v_smfmac_f32_16x16x64_bf16 v[48:51], v[36:39], a[64:71], v14
    v_smfmac_f32_16x16x64_bf16 v[64:67], v[36:39], a[160:167], v14
    v_smfmac_f32_16x16x64_bf16 v[52:55], v[36:39], a[88:95], v14
    v_smfmac_f32_16x16x64_bf16 v[68:71], v[36:39], a[184:191], v14
    s_lshl_b32 s78, s72, 8
    v_add_f32_dpp v24, v40, v41 quad_perm:[0,1,2,3] row_mask:0x1 bank_mask:0xf
    v_add_f32_dpp v25, v56, v57 quad_perm:[0,1,2,3] row_mask:0x1 bank_mask:0xf
    v_bfe_u32 v27, v0, 4, 1
    v_add_f32_dpp v24, v44, v45 quad_perm:[0,1,2,3] row_mask:0x2 bank_mask:0xf
    v_add_f32_dpp v25, v60, v61 quad_perm:[0,1,2,3] row_mask:0x2 bank_mask:0xf
    v_bfe_u32 v28, v0, 2, 1
    v_add_f32_dpp v24, v48, v49 quad_perm:[0,1,2,3] row_mask:0x4 bank_mask:0xf
    v_add_f32_dpp v25, v64, v65 quad_perm:[0,1,2,3] row_mask:0x4 bank_mask:0xf
    s_add_u32 s78, s78, 124416
    v_add_f32_dpp v24, v52, v53 quad_perm:[0,1,2,3] row_mask:0x8 bank_mask:0xf
    v_add_f32_dpp v25, v68, v69 quad_perm:[0,1,2,3] row_mask:0x8 bank_mask:0xf
    v_max_f32 v26, v24, v25
    v_lshl_add_u32 v27, v27, 5, s78
    v_lshl_add_u32 v27, v28, 4, v27
    v_max_f32_dpp v26, v26, v26 row_ror:8 row_mask:0xf bank_mask:0xf
    s_nop 1
    v_max_f32_dpp v26, v26, v26 row_ror:4 row_mask:0xf bank_mask:0xf
    s_nop 1
    v_max_f32_dpp v26, v26, v26 row_ror:2 row_mask:0xf bank_mask:0xf
    s_nop 1
    v_max_f32_dpp v26, v26, v26 row_ror:1 row_mask:0xf bank_mask:0xf
    v_mov_b32 v28, v26
    s_nop 1
    v_permlane32_swap_b32 v26, v28
    v_max_f32 v26, v26, v28
    v_mov_b32 v28, v26
    s_nop 1
    v_permlane16_swap_b32 v26, v28
    v_max_f32 v26, v26, v28
    v_mul_f32 v26, v26, v18
    v_fma_f32 v24, v24, v18, -v26
    v_fma_f32 v25, v25, v18, -v26
    v_exp_f32 v24, v24
    v_exp_f32 v25, v25
    s_nop 0
    v_cvt_pk_bf16_f32 v28, v24, v25
    ds_write_b16 v19, v28
    ds_write_b16_d16_hi v19, v28 offset:128
    s_mov_b32 exec_lo, 0xff00ff
    s_mov_b32 exec_hi, 0xff00ff00
    ds_read_b128 v[72:75], v27 offset:0
    ds_read_b128 v[76:79], v27 offset:64
    ds_read_b128 v[80:83], v27 offset:128
    ds_read_b128 v[84:87], v27 offset:192
    s_mov_b64 exec, -1
    v_add_f32 v27, v24, v25
    v_mov_b32 v40, 0
    v_mov_b32 v44, 0
    v_add_f32_dpp v27, v27, v27 row_ror:8 row_mask:0xf bank_mask:0xf
    v_mov_b32 v48, 0
    v_mov_b32 v52, 0
    v_add_f32_dpp v27, v27, v27 row_ror:4 row_mask:0xf bank_mask:0xf
    v_mov_b32 v56, 0
    v_mov_b32 v60, 0
    v_add_f32_dpp v27, v27, v27 row_ror:2 row_mask:0xf bank_mask:0xf
    s_lshl_b32 s78, s72, 3
    s_add_u32 s78, s78, 125440
    v_add_f32_dpp v27, v27, v27 row_ror:1 row_mask:0xf bank_mask:0xf
    v_mov_b32 v28, v27
    s_nop 1
    v_permlane32_swap_b32 v27, v28
    v_add_f32 v27, v27, v28
    v_mov_b32 v28, v27
    s_nop 1
    v_permlane16_swap_b32 v27, v28
    v_add_f32 v27, v27, v28
    v_mov_b32 v28, s78
    ds_write_b64 v28, v[26:27]
    s_waitcnt lgkmcnt(4)
    v_smfmac_f32_16x16x64_bf16 v[40:43], v[72:75], a[192:199], v14 abid:1
    v_smfmac_f32_16x16x64_bf16 v[44:47], v[72:75], a[200:207], v14 abid:1
    v_smfmac_f32_16x16x64_bf16 v[48:51], v[72:75], a[208:215], v14 abid:1
    v_smfmac_f32_16x16x64_bf16 v[52:55], v[72:75], a[216:223], v14 abid:1
    v_smfmac_f32_16x16x64_bf16 v[56:59], v[72:75], a[224:231], v14 abid:1
    v_smfmac_f32_16x16x64_bf16 v[60:63], v[72:75], a[232:239], v14 abid:1
    s_waitcnt lgkmcnt(3)
    v_smfmac_f32_16x16x64_bf16 v[40:43], v[76:79], v[112:119], v14 abid:1
    v_smfmac_f32_16x16x64_bf16 v[44:47], v[76:79], v[120:127], v14 abid:1
    v_smfmac_f32_16x16x64_bf16 v[48:51], v[76:79], v[128:135], v14 abid:1
    v_smfmac_f32_16x16x64_bf16 v[52:55], v[76:79], v[136:143], v14 abid:1
    v_smfmac_f32_16x16x64_bf16 v[56:59], v[76:79], v[144:151], v14 abid:1
    v_smfmac_f32_16x16x64_bf16 v[60:63], v[76:79], v[152:159], v14 abid:1
    s_waitcnt lgkmcnt(2)
    v_smfmac_f32_16x16x64_bf16 v[40:43], v[80:83], v[160:167], v14 abid:1
    v_smfmac_f32_16x16x64_bf16 v[44:47], v[80:83], v[168:175], v14 abid:1
    v_smfmac_f32_16x16x64_bf16 v[48:51], v[80:83], v[176:183], v14 abid:1
    v_smfmac_f32_16x16x64_bf16 v[52:55], v[80:83], v[184:191], v14 abid:1
    v_smfmac_f32_16x16x64_bf16 v[56:59], v[80:83], v[192:199], v14 abid:1
    v_smfmac_f32_16x16x64_bf16 v[60:63], v[80:83], v[200:207], v14 abid:1
    s_waitcnt lgkmcnt(0)
ATT_LAST:
    s_waitcnt lgkmcnt(8)
    v_smfmac_f32_16x16x64_bf16 v[40:43], v[84:87], v[208:215], v14 abid:1
    v_smfmac_f32_16x16x64_bf16 v[44:47], v[84:87], v[216:223], v14 abid:1
    s_waitcnt lgkmcnt(4)
    v_smfmac_f32_16x16x64_bf16 v[48:51], v[84:87], v[224:231], v14 abid:1
    v_smfmac_f32_16x16x64_bf16 v[52:55], v[84:87], v[232:239], v14 abid:1
    s_waitcnt lgkmcnt(0)
    v_smfmac_f32_16x16x64_bf16 v[56:59], v[84:87], v[240:247], v14 abid:1
    v_smfmac_f32_16x16x64_bf16 v[60:63], v[84:87], v[248:255], v14 abid:1
    v_add_u32 v24, 119296, v1
    v_mov_b32 v25, 125440
    v_lshlrev_b32 v39, 6, v0
    v_permlane16_swap_b32 v40, v44
    v_add_f32 v40, v40, v44
    ds_write_b32 v15, v40 offset:0
    v_permlane16_swap_b32 v48, v52
    v_add_f32 v48, v48, v52
    ds_write_b32 v15, v48 offset:256
    v_permlane16_swap_b32 v56, v60
    v_add_f32 v56, v56, v60
    ds_write_b32 v15, v56 offset:512
    s_cmp_lg_u32 s72, 0
    s_waitcnt lgkmcnt(0)
    s_barrier
    s_cbranch_scc1 ODONE
    ds_read_b128 v[64:67], v25
    ds_read_b128 v[68:71], v25 offset:16
    ds_read_b128 v[40:43], v24 offset:0
    ds_read_b128 v[44:47], v24 offset:768
    ds_read_b128 v[48:51], v24 offset:1536
    ds_read_b128 v[52:55], v24 offset:2304
    s_mul_i32 s77, s70, 3072
    s_lshl_b32 s78, s71, 4
    s_add_u32 s77, s77, s78
    s_add_u32 s77, s77, s3
    s_add_u32 s77, s77, 32768
    s_lshl_b32 s78, s69, 3
    s_add_u32 s78, s78, s3
    s_add_u32 s78, s78, 45056
    s_waitcnt lgkmcnt(4)
    v_max3_f32 v32, v64, v66, v68
    v_max_f32 v32, v32, v70
    v_sub_f32 v64, v64, v32
    v_sub_f32 v66, v66, v32
    v_sub_f32 v68, v68, v32
    v_sub_f32 v70, v70, v32
    v_exp_f32 v64, v64
    v_exp_f32 v66, v66
    v_exp_f32 v68, v68
    v_exp_f32 v70, v70
    s_waitcnt lgkmcnt(0)
    v_mul_f32 v28, v64, v40
    v_mul_f32 v29, v64, v41
    v_mul_f32 v30, v64, v42
    v_mul_f32 v31, v64, v43
    v_fmac_f32 v28, v66, v44
    v_fmac_f32 v29, v66, v45
    v_fmac_f32 v30, v66, v46
    v_fmac_f32 v31, v66, v47
    v_fmac_f32 v28, v68, v48
    v_fmac_f32 v29, v68, v49
    v_fmac_f32 v30, v68, v50
    v_fmac_f32 v31, v68, v51
    v_fmac_f32 v28, v70, v52
    v_fmac_f32 v29, v70, v53
    v_fmac_f32 v30, v70, v54
    v_fmac_f32 v31, v70, v55
    v_cvt_pk_bf16_f32 v28, v28, v29
    v_cvt_pk_bf16_f32 v29, v30, v31
    s_nop 0
    v_mov_b32_dpp v30, v28 quad_perm:[1,1,3,3] row_mask:0xf bank_mask:0xf
    v_mov_b32_dpp v31, v29 quad_perm:[1,1,3,3] row_mask:0xf bank_mask:0xf
    s_mov_b32 exec_lo, 0x55555555
    s_mov_b32 exec_hi, 0x5555
    s_cmp_eq_u32 s75, 1
    s_cbranch_scc0 SLOW6
    buffer_store_dwordx4 v[28:31], v39, s[16:19], s77 offen
BACK6:
    v_mul_f32 v33, v64, v65
    v_fmac_f32 v33, v66, v67
    v_fmac_f32 v33, v68, v69
    v_fmac_f32 v33, v70, v71
    s_mov_b64 exec, 1
    s_cmp_eq_u32 s75, 1
    s_cbranch_scc0 SLOW7
    buffer_store_dwordx2 v[32:33], v39, s[16:19], s78 offen
BACK7:
    s_mov_b64 exec, -1
ODONE:
    s_cmp_ge_u32 s69, 20
    s_cbranch_scc1 ROLEF
    s_cmp_eq_u32 s74, 0
    s_cbranch_scc1 WLATE
    v_accvgpr_read_b32 v2, a246
    v_accvgpr_read_b32 v3, a247
    v_accvgpr_read_b32 v4, a248
    v_mov_b32 v88, 0
    v_mov_b32 v92, 0
    v_mov_b32 v96, 0
    v_mov_b32 v100, 0
    v_mov_b32 v104, 0
    v_mov_b32 v108, 0
    ds_read_b64_tr_b16 v[40:41], v2 offset:0
    ds_read_b64_tr_b16 v[42:43], v2 offset:256
    ds_read_b64_tr_b16 v[64:65], v2 offset:32
    ds_read_b64_tr_b16 v[66:67], v2 offset:288
    ds_read_b64_tr_b16 v[44:45], v2 offset:2048
    ds_read_b64_tr_b16 v[46:47], v2 offset:2304
    ds_read_b64_tr_b16 v[68:69], v2 offset:2080
    ds_read_b64_tr_b16 v[70:71], v2 offset:2336
    ds_read_b64_tr_b16 v[48:49], v2 offset:4096
    ds_read_b64_tr_b16 v[50:51], v2 offset:4352
    s_cmp_lg_u32 s72, 1
    s_cbranch_scc1 NOOWN0
    v_accvgpr_read_b32 v28, a244
    v_accvgpr_read_b32 v29, a245
    v_max_u32 v30, v28, v29
    v_cmp_eq_u32 vcc, -1, v30
    s_cbranch_vccnz RETRY8
OK8:
    v_lshlrev_b32 v30, 16, v28
    v_and_b32 v28, 0xffff0000, v28
    v_lshlrev_b32 v31, 16, v29
    v_and_b32 v29, 0xffff0000, v29
    v_add_f32 v30, v30, v31
    v_add_f32 v28, v28, v29
    v_mov_b32 v31, v30
    v_mov_b32 v29, v28
    s_nop 0
    v_permlane32_swap_b32 v30, v31
    v_permlane32_swap_b32 v28, v29
    v_add_f32 v30, v30, v31
    v_add_f32 v28, v28, v29
    v_mov_b32 v31, v30
    v_mov_b32 v29, v28
    s_nop 0
    v_permlane16_swap_b32 v30, v31
    v_permlane16_swap_b32 v28, v29
    v_add_f32 v30, v30, v31
    v_add_f32 v28, v28, v29
    v_add_f32 v22, v22, v30
    v_add_f32 v23, v23, v28
    v_cvt_pk_bf16_f32 v28, v22, v23
    s_lshl_b32 s77, s69, 6
    s_add_u32 s77, s77, s3
    s_add_u32 s77, s77, 48640
    v_lshlrev_b32 v37, 2, v0
    v_mov_b32_dpp v29, v28 quad_perm:[1,1,1,1] row_mask:0xf bank_mask:0xf
    v_mov_b32_dpp v30, v28 quad_perm:[2,2,2,2] row_mask:0xf bank_mask:0xf
    v_mov_b32_dpp v31, v28 quad_perm:[3,3,3,3] row_mask:0xf bank_mask:0xf
    s_mov_b32 exec_lo, 0x1111
    s_mov_b32 exec_hi, 0x0
    s_cmp_eq_u32 s75, 1
    s_cbranch_scc0 SLOW9
    buffer_store_dwordx4 v[28:31], v37, s[16:19], s77 offen
BACK9:
    s_mov_b64 exec, -1
NOOWN0:
    v_mov_b32 v25, 0
    v_mov_b32 v27, 0
    v_mov_b32 v37, 0
    v_mov_b32 v39, 0
    s_mov_b32 exec_lo, 0x00ff00ff
    s_mov_b32 exec_hi, 0x00ff00ff
    buffer_load_dwordx4 v[88:91], v3, s[16:19], s3 offen offset:0 sc1
    buffer_load_dwordx4 v[92:95], v3, s[16:19], s3 offen offset:512 sc1
    buffer_load_dwordx4 v[96:99], v3, s[16:19], s3 offen offset:1024 sc1
    buffer_load_dwordx4 v[100:103], v3, s[16:19], s3 offen offset:1536 sc1
    buffer_load_dwordx4 v[104:107], v3, s[16:19], s3 offen offset:2048 sc1
    buffer_load_dwordx4 v[108:111], v3, s[16:19], s3 offen offset:2560 sc1
    s_mov_b32 exec_lo, -1
    s_mov_b32 exec_hi, 0
    buffer_load_dwordx4 v[24:27], v4, s[16:19], s3 offen offset:0 sc1
    buffer_load_dwordx4 v[36:39], v4, s[16:19], s3 offen offset:16 sc1
    s_mov_b64 exec, -1
    ds_read_b64_tr_b16 v[72:73], v2 offset:4128
    ds_read_b64_tr_b16 v[74:75], v2 offset:4384
    ds_read_b64_tr_b16 v[52:53], v2 offset:6144
    ds_read_b64_tr_b16 v[54:55], v2 offset:6400
    ds_read_b64_tr_b16 v[76:77], v2 offset:6176
    ds_read_b64_tr_b16 v[78:79], v2 offset:6432
    ds_read_b64_tr_b16 v[56:57], v2 offset:8192
    ds_read_b64_tr_b16 v[58:59], v2 offset:8448
    ds_read_b64_tr_b16 v[80:81], v2 offset:8224
    ds_read_b64_tr_b16 v[82:83], v2 offset:8480
    ds_read_b64_tr_b16 v[60:61], v2 offset:10240
    ds_read_b64_tr_b16 v[62:63], v2 offset:10496
    ds_read_b64_tr_b16 v[84:85], v2 offset:10272
    ds_read_b64_tr_b16 v[86:87], v2 offset:10528
    v_accvgpr_read_b32 v5, a249
    v_add_u32 v6, 119296, v1
    v_lshrrev_b32 v18, 1, v1
WCHK:
    s_waitcnt vmcnt(0)
    v_max3_u32 v28, v88, v92, v96
    v_max3_u32 v28, v28, v100, v104
    v_max3_u32 v28, v28, v108, v25
    v_max3_u32 v28, v28, v27, v37
    v_max_u32 v28, v28, v39
    v_cmp_eq_u32 vcc, -1, v28
    s_cbranch_vccnz AGAIN10
POLLX10:
    s_waitcnt lgkmcnt(0)
    v_mfma_f32_16x16x32_bf16 v[28:31], v[88:91], v[40:43], 0
    v_mfma_f32_16x16x32_bf16 v[32:35], v[88:91], v[64:67], 0
    v_max3_f32 v88, v24, v26, v36
    v_max_f32 v88, v88, v38
    v_mfma_f32_16x16x32_bf16 v[28:31], v[92:95], v[44:47], v[28:31]
    v_mov_b32 v89, v88
    v_mfma_f32_16x16x32_bf16 v[32:35], v[92:95], v[68:71], v[32:35]
    s_nop 0
    v_permlane16_swap_b32 v88, v89
    v_max_f32 v88, v88, v89
    v_mfma_f32_16x16x32_bf16 v[28:31], v[96:99], v[48:51], v[28:31]
    v_sub_f32 v24, v24, v88
    v_sub_f32 v26, v26, v88
    v_mfma_f32_16x16x32_bf16 v[32:35], v[96:99], v[72:75], v[32:35]
    v_sub_f32 v36, v36, v88
    v_sub_f32 v38, v38, v88
    v_mfma_f32_16x16x32_bf16 v[28:31], v[100:103], v[52:55], v[28:31]
    v_exp_f32 v24, v24
    v_mfma_f32_16x16x32_bf16 v[32:35], v[100:103], v[76:79], v[32:35]
    v_exp_f32 v26, v26
    v_mfma_f32_16x16x32_bf16 v[28:31], v[104:107], v[56:59], v[28:31]
    v_exp_f32 v36, v36
    v_mfma_f32_16x16x32_bf16 v[32:35], v[104:107], v[80:83], v[32:35]
    v_exp_f32 v38, v38
    v_mfma_f32_16x16x32_bf16 v[28:31], v[108:111], v[60:63], v[28:31]
    v_mul_f32 v90, v24, v25
    v_fmac_f32 v90, v26, v27
    v_mfma_f32_16x16x32_bf16 v[32:35], v[108:111], v[84:87], v[32:35]
    v_fmac_f32 v90, v36, v37
    v_fmac_f32 v90, v38, v39
    v_mov_b32 v89, v90
    s_cmp_lg_u32 s72, 0
    s_nop 0
    v_permlane16_swap_b32 v90, v89
    v_add_f32 v90, v90, v89
    v_rcp_f32 v90, v90
    v_mul_f32 v28, v24, v28
    v_mul_f32 v32, v24, v32
    v_fmac_f32 v28, v26, v29
    v_fmac_f32 v32, v26, v33
    v_fmac_f32 v28, v36, v30
    v_fmac_f32 v32, v36, v34
    v_fmac_f32 v28, v38, v31
    v_fmac_f32 v32, v38, v35
    s_nop 1
    v_permlane16_swap_b32 v28, v32
    v_add_f32 v28, v28, v32
    v_mul_f32 v28, v28, v90
    ds_write_b32 v5, v28
    s_waitcnt lgkmcnt(0)
    s_barrier
    s_cbranch_scc1 WNOT0
    ds_read_b128 v[40:43], v6 offset:3072
    ds_read_b128 v[44:47], v6 offset:3328
    ds_read_b128 v[48:51], v6 offset:3584
    ds_read_b128 v[52:55], v6 offset:3840
    s_waitcnt lgkmcnt(2)
    v_add_f32 v28, v40, v44
    v_add_f32 v29, v41, v45
    v_add_f32 v30, v42, v46
    v_add_f32 v31, v43, v47
    s_waitcnt lgkmcnt(0)
    v_add_f32 v32, v48, v52
    v_add_f32 v33, v49, v53
    v_add_f32 v34, v50, v54
    v_add_f32 v35, v51, v55
    v_add_f32 v28, v28, v32
    v_add_f32 v29, v29, v33
    v_add_f32 v30, v30, v34
    v_add_f32 v31, v31, v35
    v_cvt_pk_bf16_f32 v28, v28, v29
    v_cvt_pk_bf16_f32 v29, v30, v31
    s_nop 0
    v_mov_b32_dpp v30, v28 quad_perm:[1,1,3,3] row_mask:0xf bank_mask:0xf
    v_mov_b32_dpp v31, v29 quad_perm:[1,1,3,3] row_mask:0xf bank_mask:0xf
    s_mov_b32 exec_lo, 0x55
    s_mov_b32 exec_hi, 0x0
    buffer_store_dwordx4 v[28:31], v18, s[16:19], s80 offen sc1
    s_cmp_eq_u32 s75, 1
    s_cbranch_scc0 SLOW11
    buffer_store_dwordx4 v[28:31], v18, s[16:19], s81 offen
BACK11:
    s_mov_b64 exec, -1
    v_lshrrev_b32 v37, 5, v0
    v_mul_u32_u24 v37, 2560, v37
    v_and_b32 v38, 31, v0
    v_lshl_add_u32 v37, v38, 2, v37
    v_add_u32 v41, 5120, v37
    v_add_u32 v42, 10240, v37
    v_add_u32 v43, 15360, v37
    v_add_u32 v44, 20480, v37
    v_add_u32 v45, 25600, v37
    s_lshl_b32 s79, s69, 7
    s_add_u32 s79, s79, s3
    s_add_u32 s79, s79, 51200
    s_add_u32 s96, s80, 10240
    s_add_u32 s97, s81, 1280
    v_lshlrev_b32 v39, 1, v0
    s_cmp_lg_u32 s74, 0
    s_cbranch_scc1 NOLC
    s_mul_i32 s77, s69, 2464
    s_add_u32 s78, s3, 720896
    v_add_u32 v48, s77, v1
    v_min_u32 v48, 49136, v48
    s_add_u32 s77, s77, 1024
    v_add_u32 v49, s77, v1
    v_min_u32 v49, 49136, v49
    s_add_u32 s77, s77, 1024
    v_add_u32 v50, s77, v1
    v_min_u32 v50, 49136, v50
    s_add_u32 s77, s77, 1024
    buffer_load_dwordx4 a[240:243], v48, s[16:19], s78 offen sc1
    buffer_load_dwordx4 a[240:243], v49, s[16:19], s78 offen sc1
    buffer_load_dwordx4 a[240:243], v50, s[16:19], s78 offen sc1
    v_mov_b32 v52, -1
    v_mov_b32 v53, -1
    v_mov_b32 v54, -1
    v_mov_b32 v55, -1
    s_add_u32 s77, s80, 688128
    s_add_u32 s7, s96, 688128
    s_waitcnt vmcnt(0)
    s_cmp_eq_u32 s75, 1
    s_cbranch_scc0 SLOW12
    buffer_store_dwordx4 v[52:55], v48, s[16:19], s78 offen
BACK12:
    s_cmp_eq_u32 s75, 1
    s_cbranch_scc0 SLOW13
    buffer_store_dwordx4 v[52:55], v49, s[16:19], s78 offen
BACK13:
    s_cmp_eq_u32 s75, 1
    s_cbranch_scc0 SLOW14
    buffer_store_dwordx4 v[52:55], v50, s[16:19], s78 offen
BACK14:
    s_mov_b64 exec, 15
    buffer_store_dwordx4 v[52:55], v1, s[16:19], s77 offen sc1
    buffer_store_dwordx4 v[52:55], v1, s[16:19], s7 offen sc1
    s_mov_b64 exec, -1
NOLC:
    s_mov_b32 s76, 1
POLL15:
    buffer_load_dword v28, v37, s[16:19], s79 offen sc1
    buffer_load_dword v29, v41, s[16:19], s79 offen sc1
    buffer_load_dword v30, v42, s[16:19], s79 offen sc1
    buffer_load_dword v31, v43, s[16:19], s79 offen sc1
    buffer_load_dword v32, v44, s[16:19], s79 offen sc1
    buffer_load_dword v33, v45, s[16:19], s79 offen sc1
POLLW15:
    s_waitcnt vmcnt(0)
    v_max3_u32 v36, v28, v29, v30
    v_max3_u32 v36, v36, v31, v32
    v_max_u32 v36, v36, v33
    v_cmp_eq_u32 vcc, -1, v36
    s_cbranch_vccnz AGAIN15
POLLX15:
    v_add_f32 v28, v28, v29
    v_add_f32 v30, v30, v31
    v_add_f32 v32, v32, v33
    v_add_f32 v28, v28, v30
    v_add_f32 v28, v28, v32
    v_mov_b32 v29, v28
    s_nop 1
    v_permlane32_swap_b32 v28, v29
    v_add_f32 v28, v28, v29
    s_nop 1
    v_mov_b32_dpp v29, v28 row_shl:1 row_mask:0xf bank_mask:0xf
    v_cvt_pk_bf16_f32 v28, v28, v29
    s_nop 1
    v_mov_b32_dpp v29, v28 row_shl:2 row_mask:0xf bank_mask:0xf
    v_mov_b32_dpp v30, v28 row_shl:4 row_mask:0xf bank_mask:0xf
    v_mov_b32_dpp v31, v28 row_shl:6 row_mask:0xf bank_mask:0xf
    s_mov_b32 exec_lo, 0x1010101
    s_mov_b32 exec_hi, 0x0
    buffer_store_dwordx4 v[28:31], v39, s[16:19], s96 offen sc1
    s_cmp_eq_u32 s75, 1
    s_cbranch_scc0 SLOW16
    buffer_store_dwordx4 v[28:31], v39, s[16:19], s97 offen
BACK16:
    s_mov_b64 exec, -1
    s_branch NEXT
AGAIN2:
    s_add_u32 s76, s76, 1
    s_cmp_lt_u32 s76, 32768
    s_cbranch_scc1 POLL2
    s_branch POLLX2
AGAIN3:
    s_mov_b64 s[94:95], exec
    s_mov_b32 s76, 1
AG23:
    v_cmp_eq_u32 vcc, -1, v80
    s_nop 0
    s_mov_b64 exec, vcc
    s_cbranch_execz AG33_0
    buffer_load_dwordx4 v[80:83], v8, s[16:19], 0 offen sc1
AG33_0:
    s_mov_b64 exec, s[94:95]
    v_cmp_eq_u32 vcc, -1, v84
    s_nop 0
    s_mov_b64 exec, vcc
    s_cbranch_execz AG33_1
    buffer_load_dwordx4 v[84:87], v9, s[16:19], 0 offen sc1
AG33_1:
    s_mov_b64 exec, s[94:95]
    s_add_u32 s76, s76, 1
    s_cmp_ge_u32 s76, 32768
    s_waitcnt vmcnt(0)
    v_max_u32 v24, v80, v84
    v_cmp_eq_u32 vcc, -1, v24
    s_cbranch_vccz POLLX3
    s_cbranch_scc0 AG23
    s_branch POLLX3
AGAIN5:
    s_add_u32 s76, s76, 1
    s_cmp_lt_u32 s76, 32768
    s_cbranch_scc1 POLL5
    s_branch POLLX5
WLATE:
    v_lshrrev_b32 v38, 2, v0
    v_mul_u32_u24 v38, 1280, v38
    v_and_b32 v39, 3, v0
    v_lshl_add_u32 v39, v39, 4, v38
    s_mov_b32 m0, s67
    s_add_u32 s67, s67, 1024
    buffer_load_dwordx4 v39, s[24:27], s66 offen  lds
    s_add_u32 s66, s66, 20480
    s_mov_b32 m0, s67
    s_add_u32 s67, s67, 1024
    buffer_load_dwordx4 v39, s[24:27], s66 offen  lds
    s_add_u32 s66, s66, 20480
    s_mov_b32 m0, s67
    s_add_u32 s67, s67, 1024
    buffer_load_dwordx4 v39, s[24:27], s66 offen  lds
    s_add_u32 s66, s66, 20480
    s_mov_b32 m0, s67
    s_add_u32 s67, s67, 1024
    buffer_load_dwordx4 v39, s[24:27], s66 offen  lds
    s_add_u32 s66, s66, 20480
    s_add_u32 s77, s3, 1376256
    s_cmp_eq_u32 s75, 1
    s_cbranch_scc0 SLOW17
    buffer_store_dword v7, v10, s[16:19], s77 offen
BACK17:
    s_cmp_lg_u32 s72, 3
    s_cbranch_scc1 NOFPC
    v_mov_b32 v24, -1
    v_mov_b32 v25, -1
    v_mov_b32 v26, -1
    v_mov_b32 v27, -1
    v_accvgpr_read_b32 v28, a250
    s_cmp_eq_u32 s75, 1
    s_cbranch_scc0 SLOW18
    buffer_store_dwordx4 v[24:27], v28, s[16:19], 0 offen
BACK18:
    v_accvgpr_read_b32 v29, a251
    s_cmp_eq_u32 s75, 1
    s_cbranch_scc0 SLOW19
    buffer_store_dwordx4 v[24:27], v29, s[16:19], 0 offen
BACK19:
NOFPC:
    v_accvgpr_read_b32 v2, a246
    v_accvgpr_read_b32 v3, a247
    v_accvgpr_read_b32 v4, a248
    v_mov_b32 v88, 0
    v_mov_b32 v92, 0
    v_mov_b32 v96, 0
    v_mov_b32 v100, 0
    v_mov_b32 v104, 0
    v_mov_b32 v108, 0
    v_mov_b32 v25, 0
    v_mov_b32 v27, 0
    v_mov_b32 v37, 0
    v_mov_b32 v39, 0
    s_mov_b32 exec_lo, 0x00ff00ff
    s_mov_b32 exec_hi, 0x00ff00ff
    buffer_load_dwordx4 v[88:91], v3, s[16:19], s3 offen offset:0 sc1
    buffer_load_dwordx4 v[92:95], v3, s[16:19], s3 offen offset:512 sc1
    buffer_load_dwordx4 v[96:99], v3, s[16:19], s3 offen offset:1024 sc1
    buffer_load_dwordx4 v[100:103], v3, s[16:19], s3 offen offset:1536 sc1
    buffer_load_dwordx4 v[104:107], v3, s[16:19], s3 offen offset:2048 sc1
    buffer_load_dwordx4 v[108:111], v3, s[16:19], s3 offen offset:2560 sc1
    s_mov_b32 exec_lo, -1
    s_mov_b32 exec_hi, 0
    buffer_load_dwordx4 v[24:27], v4, s[16:19], s3 offen offset:0 sc1
    buffer_load_dwordx4 v[36:39], v4, s[16:19], s3 offen offset:16 sc1
    s_mov_b64 exec, -1
    s_waitcnt vmcnt(8)
    ds_read_b64_tr_b16 v[40:41], v2 offset:0
    ds_read_b64_tr_b16 v[42:43], v2 offset:256
    ds_read_b64_tr_b16 v[64:65], v2 offset:32
    ds_read_b64_tr_b16 v[66:67], v2 offset:288
    ds_read_b64_tr_b16 v[44:45], v2 offset:2048
    ds_read_b64_tr_b16 v[46:47], v2 offset:2304
    ds_read_b64_tr_b16 v[68:69], v2 offset:2080
    ds_read_b64_tr_b16 v[70:71], v2 offset:2336
    ds_read_b64_tr_b16 v[48:49], v2 offset:4096
    ds_read_b64_tr_b16 v[50:51], v2 offset:4352
    ds_read_b64_tr_b16 v[72:73], v2 offset:4128
    ds_read_b64_tr_b16 v[74:75], v2 offset:4384
    ds_read_b64_tr_b16 v[52:53], v2 offset:6144
    ds_read_b64_tr_b16 v[54:55], v2 offset:6400
    ds_read_b64_tr_b16 v[76:77], v2 offset:6176
    ds_read_b64_tr_b16 v[78:79], v2 offset:6432
    ds_read_b64_tr_b16 v[56:57], v2 offset:8192
    ds_read_b64_tr_b16 v[58:59], v2 offset:8448
    ds_read_b64_tr_b16 v[80:81], v2 offset:8224
    ds_read_b64_tr_b16 v[82:83], v2 offset:8480
    ds_read_b64_tr_b16 v[60:61], v2 offset:10240
    ds_read_b64_tr_b16 v[62:63], v2 offset:10496
    ds_read_b64_tr_b16 v[84:85], v2 offset:10272
    ds_read_b64_tr_b16 v[86:87], v2 offset:10528
    v_accvgpr_read_b32 v5, a249
    v_add_u32 v6, 119296, v1
    v_lshrrev_b32 v18, 1, v1
    s_branch WCHK
AGAIN10:
    s_mov_b64 s[94:95], exec
    s_mov_b32 s76, 1
AG210:
    v_max3_u32 v28, v88, v92, v96
    v_max3_u32 v28, v28, v100, v104
    v_max_u32 v28, v28, v108
    v_cmp_eq_u32 vcc, -1, v28
    s_nop 0
    s_mov_b64 exec, vcc
    s_cbranch_execz AG310_0
    buffer_load_dwordx4 v[88:91], v3, s[16:19], s3 offen offset:0 sc1
    buffer_load_dwordx4 v[92:95], v3, s[16:19], s3 offen offset:512 sc1
    buffer_load_dwordx4 v[96:99], v3, s[16:19], s3 offen offset:1024 sc1
    buffer_load_dwordx4 v[100:103], v3, s[16:19], s3 offen offset:1536 sc1
    buffer_load_dwordx4 v[104:107], v3, s[16:19], s3 offen offset:2048 sc1
    buffer_load_dwordx4 v[108:111], v3, s[16:19], s3 offen offset:2560 sc1
AG310_0:
    s_mov_b64 exec, s[94:95]
    v_max3_u32 v28, v25, v27, v37
    v_max_u32 v28, v28, v39
    v_cmp_eq_u32 vcc, -1, v28
    s_nop 0
    s_mov_b64 exec, vcc
    s_cbranch_execz AG310_1
    buffer_load_dwordx4 v[24:27], v4, s[16:19], s3 offen offset:0 sc1
    buffer_load_dwordx4 v[36:39], v4, s[16:19], s3 offen offset:16 sc1
AG310_1:
    s_mov_b64 exec, s[94:95]
    s_add_u32 s76, s76, 1
    s_cmp_ge_u32 s76, 32768
    s_waitcnt vmcnt(0)
    v_max3_u32 v28, v88, v92, v96
    v_max3_u32 v28, v28, v100, v104
    v_max3_u32 v28, v28, v108, v25
    v_max3_u32 v28, v28, v27, v37
    v_max_u32 v28, v28, v39
    v_cmp_eq_u32 vcc, -1, v28
    s_cbranch_vccz POLLX10
    s_cbranch_scc0 AG210
    s_branch POLLX10
AGAIN15:
    s_add_u32 s76, s76, 1
    s_cmp_lt_u32 s76, 32768
    s_cbranch_scc1 POLL15
    s_branch POLLX15
WNOT0:
    s_cmp_lg_u32 s72, 1
    s_cbranch_scc1 NEXT
    v_and_b32 v25, 15, v0
    v_lshrrev_b32 v26, 4, v0
    v_mul_u32_u24 v37, 1280, v26
    v_add_u32 v37, 655360, v37
    s_mul_i32 s7, s68, 81920
    s_add_u32 s7, s7, 46080
    v_mov_b32 v38, s7
    v_cmp_eq_u32 vcc, s68, v26
    s_nop 1
    v_cndmask_b32 v37, v37, v38, vcc
    v_add_u32 v39, 4, v26
    v_mul_u32_u24 v38, 1280, v39
    v_add_u32 v38, 655360, v38
    s_mul_i32 s7, s68, 81920
    s_add_u32 s7, s7, 46080
    v_mov_b32 v28, s7
    v_cmp_eq_u32 vcc, s68, v39
    s_nop 1
    v_cndmask_b32 v38, v38, v28, vcc
    s_lshl_b32 s77, s69, 6
    s_add_u32 s77, s77, s74
    v_lshl_add_u32 v37, v25, 2, v37
    v_lshl_add_u32 v38, v25, 2, v38
    s_sleep 16
    s_mov_b32 s76, 1
POLL20:
    buffer_load_dword v28, v37, s[16:19], s77 offen sc1
    buffer_load_dword v29, v38, s[16:19], s77 offen sc1
POLLW20:
    s_waitcnt vmcnt(0)
    v_max_u32 v30, v28, v29
    v_cmp_eq_u32 vcc, -1, v30
    s_cbranch_vccnz AGAIN20
POLLX20:
    v_lshlrev_b32 v30, 16, v28
    v_and_b32 v28, 0xffff0000, v28
    v_lshlrev_b32 v31, 16, v29
    v_and_b32 v29, 0xffff0000, v29
    v_add_f32 v30, v30, v31
    v_add_f32 v28, v28, v29
    v_mov_b32 v31, v30
    v_mov_b32 v29, v28
    s_nop 0
    v_permlane32_swap_b32 v30, v31
    v_permlane32_swap_b32 v28, v29
    v_add_f32 v30, v30, v31
    v_add_f32 v28, v28, v29
    v_mov_b32 v31, v30
    v_mov_b32 v29, v28
    s_nop 0
    v_permlane16_swap_b32 v30, v31
    v_permlane16_swap_b32 v28, v29
    v_add_f32 v30, v30, v31
    v_add_f32 v28, v28, v29
    v_add_f32 v22, v22, v30
    v_add_f32 v23, v23, v28
    v_cvt_pk_bf16_f32 v28, v22, v23
    s_cmp_lg_u32 s74, 0
    s_cbranch_scc1 FINAL
    s_lshl_b32 s77, s69, 6
    s_add_u32 s77, s77, s3
    s_add_u32 s77, s77, 49920
    v_lshlrev_b32 v37, 2, v0
    v_mov_b32_dpp v29, v28 quad_perm:[1,1,1,1] row_mask:0xf bank_mask:0xf
    v_mov_b32_dpp v30, v28 quad_perm:[2,2,2,2] row_mask:0xf bank_mask:0xf
    v_mov_b32_dpp v31, v28 quad_perm:[3,3,3,3] row_mask:0xf bank_mask:0xf
    s_mov_b32 exec_lo, 0x1111
    s_mov_b32 exec_hi, 0x0
    s_cmp_eq_u32 s75, 1
    s_cbranch_scc0 SLOW21
    buffer_store_dwordx4 v[28:31], v37, s[16:19], s77 offen
BACK21:
    s_mov_b64 exec, -1
    s_branch NEXT
FINAL:
    s_cmp_lg_u32 s68, 0
    s_cbranch_scc1 DONE
    s_lshl_b32 s77, s69, 6
    v_lshlrev_b32 v37, 2, v0
    s_add_u32 s79, s77, s3
    s_add_u32 s79, s79, 47360
    s_mov_b64 exec, 15
    s_mov_b32 s76, 1
POLL22:
    buffer_load_dword v28, v1, s[16:19], s79 offen sc1
POLLW22:
    s_waitcnt vmcnt(0)
    v_cmp_eq_u32 vcc, -1, v28
    s_cbranch_vccnz AGAIN22
POLLX22:
    s_mov_b64 exec, -1
    s_mov_b32 s76, 1
POLL23:
    buffer_load_dword v28, v20, s[16:19], s74 offen sc1
    buffer_load_dword v29, v21, s[16:19], s74 offen sc1
POLLW23:
    s_waitcnt vmcnt(0)
    v_max_u32 v30, v28, v29
    v_cmp_eq_u32 vcc, -1, v30
    s_cbranch_vccnz AGAIN23
POLLX23:
    v_lshlrev_b32 v30, 16, v28
    v_and_b32 v28, 0xffff0000, v28
    v_lshlrev_b32 v31, 16, v29
    v_and_b32 v29, 0xffff0000, v29
    v_add_f32 v30, v30, v31
    v_add_f32 v28, v28, v29
    v_mov_b32 v31, v30
    v_mov_b32 v29, v28
    s_nop 0
    v_permlane32_swap_b32 v30, v31
    v_permlane32_swap_b32 v28, v29
    v_add_f32 v30, v30, v31
    v_add_f32 v28, v28, v29
    v_mov_b32 v31, v30
    v_mov_b32 v29, v28
    s_nop 0
    v_permlane16_swap_b32 v30, v31
    v_permlane16_swap_b32 v28, v29
    v_add_f32 v30, v30, v31
    v_add_f32 v28, v28, v29
    v_add_f32 v22, v22, v30
    v_add_f32 v23, v23, v28
    v_cvt_pk_bf16_f32 v28, v22, v23
    s_mov_b32 exec_lo, 0xffff
    s_mov_b32 exec_hi, 0x0
    buffer_store_dword v28, v37, s[40:43], s77 offen
    s_mov_b64 exec, -1
    s_endpgm
AGAIN20:
    s_sleep 4
    s_add_u32 s76, s76, 1
    s_cmp_lt_u32 s76, 32768
    s_cbranch_scc1 POLL20
    s_branch POLLX20
AGAIN22:
    s_add_u32 s76, s76, 1
    s_cmp_lt_u32 s76, 32768
    s_cbranch_scc1 POLL22
    s_branch POLLX22
AGAIN23:
    s_add_u32 s76, s76, 1
    s_cmp_lt_u32 s76, 32768
    s_cbranch_scc1 POLL23
    s_branch POLLX23
ROLEF:
    v_and_b32 v25, 15, v0
    v_lshrrev_b32 v26, 4, v0
    v_bfe_u32 v27, v0, 2, 2
    v_and_b32 v36, 3, v0
    s_mov_b32 s4, 1
    s_cmp_lg_u32 s74, 0
    s_cbranch_scc1 FW
    s_mov_b32 s4, 0
FW:
    s_mul_i32 s77, s72, 5120
    s_add_u32 s77, s77, 57344
    v_lshl_add_u32 v37, v26, 3, v27
    v_lshlrev_b32 v37, 5, v37
    v_lshl_add_u32 v37, v36, 3, v37
    v_add_u32 v37, s77, v37
    ds_read_b64_tr_b16 v[40:41], v37 offset:0
    ds_read_b64_tr_b16 v[42:43], v37 offset:128
    ds_read_b64_tr_b16 v[44:45], v37 offset:1024
    ds_read_b64_tr_b16 v[46:47], v37 offset:1152
    ds_read_b64_tr_b16 v[48:49], v37 offset:2048
    ds_read_b64_tr_b16 v[50:51], v37 offset:2176
    ds_read_b64_tr_b16 v[52:53], v37 offset:3072
    ds_read_b64_tr_b16 v[54:55], v37 offset:3200
    ds_read_b64_tr_b16 v[56:57], v37 offset:4096
    ds_read_b64_tr_b16 v[58:59], v37 offset:4224
    ds_read_b64_tr_b16 v[60:61], v37 offset:20480
    ds_read_b64_tr_b16 v[62:63], v37 offset:20608
    ds_read_b64_tr_b16 v[64:65], v37 offset:21504
    ds_read_b64_tr_b16 v[66:67], v37 offset:21632
    ds_read_b64_tr_b16 v[68:69], v37 offset:22528
    ds_read_b64_tr_b16 v[70:71], v37 offset:22656
    ds_read_b64_tr_b16 v[72:73], v37 offset:23552
    ds_read_b64_tr_b16 v[74:75], v37 offset:23680
    ds_read_b64_tr_b16 v[76:77], v37 offset:24576
    ds_read_b64_tr_b16 v[78:79], v37 offset:24704
    s_mul_i32 s77, s72, 320
    s_add_u32 s77, s77, 98304
    v_lshrrev_b32 v80, 2, v0
    v_mul_u32_u24 v80, 1280, v80
    v_lshl_add_u32 v80, v36, 3, v80
    v_add_u32 v80, s77, v80
    s_lshl_b32 s79, s72, 2
    s_add_u32 s79, s79, 123392
    v_add_u32 v81, s79, v1
    v_lshl_add_u32 v82, v26, 2, v36
    v_lshlrev_b32 v82, 4, v82
    v_add_u32 v82, 123392, v82
    v_cmp_eq_u32 vcc, 12, v25
    v_mov_b32 v38, 13
    s_nop 0
    v_cndmask_b32 v83, v25, v38, vcc
    v_lshlrev_b32 v83, 4, v83
    v_add_u32 v83, 123904, v83
    v_mov_b32 v85, 124096
    v_lshlrev_b32 v84, 6, v25
    v_lshl_add_u32 v84, v26, 4, v84
    v_mov_b32 v38, 0x3f803f80
    v_cndmask_b32 v88, 0, v38, vcc
    v_mov_b32 v89, v88
    v_mov_b32 v90, v88
    v_mov_b32 v91, v88
    v_mov_b32 v92, v88
    v_mov_b32 v93, v88
    v_mov_b32 v94, v88
    v_mov_b32 v95, v88
    v_mov_b32 v96, v88
    v_mov_b32 v97, v88
    v_mov_b32 v98, v88
    v_mov_b32 v99, v88
    v_mov_b32 v100, v88
    v_mov_b32 v101, v88
    v_mov_b32 v102, v88
    v_mov_b32 v103, v88
    v_mov_b32 v104, v88
    v_mov_b32 v105, v88
    v_mov_b32 v106, v88
    v_mov_b32 v107, v88
    s_mul_i32 s77, s72, 6656
    v_mul_u32_u24 v6, 336, v25
    v_lshl_add_u32 v6, v26, 4, v6
    v_add_u32 v6, s77, v6
    v_mul_u32_u24 v37, 52, v0
    v_lshrrev_b32 v37, 10, v37
    v_lshl_add_u32 v87, v37, 4, v1
    v_add_u32 v87, s77, v87
    v_mul_u32_u24 v27, 320, v37
    v_sub_u32 v27, v1, v27
    v_mul_u32_u24 v86, 1280, v37
    v_add_u32 v86, 655360, v86
    s_mul_i32 s7, s68, 81920
    s_add_u32 s7, s7, 46080
    v_mov_b32 v38, s7
    v_cmp_eq_u32 vcc, s68, v37
    s_nop 1
    v_cndmask_b32 v86, v86, v38, vcc
    v_add_u32 v38, 2560, v38
    v_cmp_le_u32 vcc, 8, v37
    s_nop 1
    v_cndmask_b32 v86, v86, v38, vcc
    v_add_u32 v86, v86, v27
    v_add_u32 v37, 3, v37
    v_mul_u32_u24 v18, 1280, v37
    v_add_u32 v18, 655360, v18
    s_mul_i32 s7, s68, 81920
    s_add_u32 s7, s7, 46080
    v_mov_b32 v38, s7
    v_cmp_eq_u32 vcc, s68, v37
    s_nop 1
    v_cndmask_b32 v18, v18, v38, vcc
    v_add_u32 v38, 2560, v38
    v_cmp_le_u32 vcc, 8, v37
    s_nop 1
    v_cndmask_b32 v18, v18, v38, vcc
    v_add_u32 v18, v18, v27
    v_add_u32 v37, 3, v37
    v_mul_u32_u24 v20, 1280, v37
    v_add_u32 v20, 655360, v20
    s_mul_i32 s7, s68, 81920
    s_add_u32 s7, s7, 46080
    v_mov_b32 v38, s7
    v_cmp_eq_u32 vcc, s68, v37
    s_nop 1
    v_cndmask_b32 v20, v20, v38, vcc
    v_add_u32 v38, 2560, v38
    v_cmp_le_u32 vcc, 8, v37
    s_nop 1
    v_cndmask_b32 v20, v20, v38, vcc
    v_add_u32 v20, v20, v27
    s_mul_i32 s77, s72, 320
    s_add_u32 s77, s77, s74
    s_sub_u32 s78, s69, 20
    s_mul_i32 s78, s78, 2560
    s_mul_i32 s7, s72, 640
    s_add_u32 s78, s78, s7
    s_add_u32 s78, s78, s3
    s_add_u32 s78, s78, 51200
    s_waitcnt lgkmcnt(0)
    s_cmp_eq_u32 s4, 0
    s_cbranch_scc1 FW2
FPOLL:
    ds_read_b64_tr_b16 a[240:241], v80 offset:0
    ds_read_b64_tr_b16 a[242:243], v80 offset:32
    ds_read_b64_tr_b16 a[244:245], v80 offset:64
    ds_read_b64_tr_b16 a[246:247], v80 offset:96
    ds_read_b64_tr_b16 a[248:249], v80 offset:128
    ds_read_b64_tr_b16 a[250:251], v80 offset:160
    ds_read_b64_tr_b16 v[108:109], v80 offset:192
    ds_read_b64_tr_b16 v[110:111], v80 offset:224
    ds_read_b64_tr_b16 v[2:3], v80 offset:256
    ds_read_b64_tr_b16 v[4:5], v80 offset:288
    s_waitcnt lgkmcnt(0)
    s_mul_i32 s79, s72, 320
    s_add_u32 s79, s79, s3
    s_add_u32 s79, s79, 46080
    s_mov_b32 exec_lo, 0xfffff
    s_mov_b32 exec_hi, 0x0
    s_mov_b32 s76, 1
POLL24:
    buffer_load_dword v36, v1, s[16:19], s79 offen sc1
POLLW24:
    s_waitcnt vmcnt(0)
    v_cmp_eq_u32 vcc, -1, v36
    s_cbranch_vccnz AGAIN24
POLLX24:
    s_mov_b32 exec_lo, 0xffffffff
    s_mov_b32 exec_hi, 0xfffffff
    buffer_load_dwordx4 v[24:27], v86, s[16:19], s77 offen sc1
    buffer_load_dwordx4 v[28:31], v18, s[16:19], s77 offen sc1
    buffer_load_dwordx4 v[32:35], v20, s[16:19], s77 offen sc1
    s_waitcnt vmcnt(0)
    v_max3_u32 v36, v24, v28, v32
    v_cmp_eq_u32 vcc, -1, v36
    s_cbranch_vccnz AGAIN25
POLLX25:
    ds_write_b128 v87, v[24:27] offset:0
    ds_write_b128 v87, v[28:31] offset:1008
    ds_write_b128 v87, v[32:35] offset:2016
    s_mov_b32 exec_lo, 0x1ff01ff
    s_mov_b32 exec_hi, 0x1ff01ff
    ds_read_b128 v[88:91], v6 offset:0
    ds_read_b128 v[92:95], v6 offset:64
    ds_read_b128 v[96:99], v6 offset:128
    ds_read_b128 v[100:103], v6 offset:192
    ds_read_b128 v[104:107], v6 offset:256
    s_mov_b64 exec, -1
FMM:
    s_waitcnt lgkmcnt(4)
    v_mfma_f32_16x16x32_bf16 v[24:27], v[88:91], v[40:43], 0
    v_mfma_f32_16x16x32_bf16 v[28:31], v[88:91], v[60:63], 0
    v_mfma_f32_16x16x32_bf16 v[32:35], v[88:91], v[88:91], 0
    s_waitcnt lgkmcnt(3)
    v_mfma_f32_16x16x32_bf16 v[24:27], v[92:95], v[44:47], v[24:27]
    v_mfma_f32_16x16x32_bf16 v[28:31], v[92:95], v[64:67], v[28:31]
    v_mfma_f32_16x16x32_bf16 v[32:35], v[92:95], v[92:95], v[32:35]
    s_waitcnt lgkmcnt(2)
    v_mfma_f32_16x16x32_bf16 v[24:27], v[96:99], v[48:51], v[24:27]
    v_mfma_f32_16x16x32_bf16 v[28:31], v[96:99], v[68:71], v[28:31]
    v_mfma_f32_16x16x32_bf16 v[32:35], v[96:99], v[96:99], v[32:35]
    s_waitcnt lgkmcnt(1)
    v_mfma_f32_16x16x32_bf16 v[24:27], v[100:103], v[52:55], v[24:27]
    v_mfma_f32_16x16x32_bf16 v[28:31], v[100:103], v[72:75], v[28:31]
    v_mfma_f32_16x16x32_bf16 v[32:35], v[100:103], v[100:103], v[32:35]
    s_waitcnt lgkmcnt(0)
    v_mfma_f32_16x16x32_bf16 v[24:27], v[104:107], v[56:59], v[24:27]
    v_mfma_f32_16x16x32_bf16 v[28:31], v[104:107], v[76:79], v[28:31]
    v_mfma_f32_16x16x32_bf16 v[32:35], v[104:107], v[104:107], v[32:35]
    s_nop 5
    v_add_f32 v24, v24, v25
    v_add_f32 v26, v26, v27
    v_add_f32 v28, v28, v29
    v_add_f32 v30, v30, v31
    v_add_f32 v32, v32, v33
    v_add_f32 v34, v34, v35
    v_add_f32 v24, v24, v26
    v_add_f32 v28, v28, v30
    v_add_f32 v32, v32, v34
    s_nop 1
    v_permlane32_swap_b32 v24, v32
    v_permlane32_swap_b32 v28, v25
    v_add_f32 v24, v24, v32
    v_add_f32 v28, v28, v25
    s_nop 1
    v_permlane16_swap_b32 v24, v28
    v_add_f32 v24, v24, v28
    ds_write_b32 v81, v24
    s_cmp_eq_u32 s4, 0
    s_waitcnt lgkmcnt(0)
    s_barrier
    ds_read_b128 v[24:27], v83
    ds_read_b128 v[28:31], v85
    ds_read_b128 v[32:35], v82
    ds_read_b128 v[36:39], v82 offset:256
    s_cbranch_scc1 FCS
    s_waitcnt lgkmcnt(3)
    v_add_f32 v24, v24, v25
    v_add_f32 v26, v26, v27
    v_add_f32 v24, v24, v26
    s_waitcnt lgkmcnt(2)
    v_add_f32 v28, v28, v29
    v_add_f32_dpp v24, v24, v24 row_ror:8 row_mask:0xf bank_mask:0xf
    v_add_f32 v30, v30, v31
    v_add_f32 v28, v28, v30
    v_add_f32_dpp v24, v24, v24 row_ror:4 row_mask:0xf bank_mask:0xf
    s_waitcnt lgkmcnt(0)
    v_subrev_f32 v29, 0x44200000, v28
    v_add_f32_dpp v24, v24, v24 row_ror:2 row_mask:0xf bank_mask:0xf
    v_add_f32 v32, v32, v33
    v_mul_f32 v30, 0x3acccccd, v29
    v_add_f32_dpp v24, v24, v24 row_ror:1 row_mask:0xf bank_mask:0xf
    v_add_f32 v34, v34, v35
    v_sub_f32 v24, v24, v29
    v_add_f32 v32, v32, v34
    v_mul_f32 v24, 0x3acccccd, v24
    v_add_f32 v36, v36, v37
    v_fma_f32 v24, -v30, v30, v24
    v_add_f32 v38, v38, v39
    v_max_f32 v24, 0, v24
    v_fma_f32 v32, -v28, v22, v32
    v_add_f32 v24, 0x3727c5ac, v24
    v_add_f32 v36, v36, v38
    v_rsq_f32 v24, v24
    v_fma_f32 v36, -v28, v23, v36
    v_mul_f32 v33, 0xbfb8aa3b, v32
    v_mul_f32 v33, v33, v24
    v_mul_f32 v36, v36, v32
    v_exp_f32 v33, v33
    v_mul_f32 v36, v36, v24
    v_add_f32 v33, 1.0, v33
    v_mul_f32 v36, v36, v24
    v_rcp_f32 v33, v33
    s_nop 0
    v_mul_f32 v36, v36, v33
    s_nop 1
    v_mov_b32_dpp v28, v36 quad_perm:[0,0,0,0] row_mask:0xf bank_mask:0xf
    v_mov_b32_dpp v29, v36 quad_perm:[1,1,1,1] row_mask:0xf bank_mask:0xf
    v_mov_b32_dpp v30, v36 quad_perm:[2,2,2,2] row_mask:0xf bank_mask:0xf
    v_mov_b32_dpp v31, v36 quad_perm:[3,3,3,3] row_mask:0xf bank_mask:0xf
    v_cvt_pk_bf16_f32 v28, v28, v29
    v_cvt_pk_bf16_f32 v29, v30, v31
    v_cndmask_b32 v60, 0, v28, s[44:45]
    v_cndmask_b32 v61, 0, v29, s[44:45]
    v_cndmask_b32 v62, 0, v28, s[46:47]
    v_cndmask_b32 v63, 0, v29, s[46:47]
    v_cndmask_b32 v64, 0, v28, s[48:49]
    v_cndmask_b32 v65, 0, v29, s[48:49]
    v_mfma_f32_16x16x32_bf16 v[24:27], a[240:243], v[60:63], 0
    v_cndmask_b32 v66, 0, v28, s[50:51]
    v_cndmask_b32 v67, 0, v29, s[50:51]
    v_cndmask_b32 v68, 0, v28, s[52:53]
    v_cndmask_b32 v69, 0, v29, s[52:53]
    v_mfma_f32_16x16x32_bf16 v[24:27], a[244:247], v[64:67], v[24:27]
    v_cndmask_b32 v70, 0, v28, s[54:55]
    v_cndmask_b32 v71, 0, v29, s[54:55]
    v_cndmask_b32 v72, 0, v28, s[56:57]
    v_cndmask_b32 v73, 0, v29, s[56:57]
    v_mfma_f32_16x16x32_bf16 v[24:27], a[248:251], v[68:71], v[24:27]
    v_cndmask_b32 v74, 0, v28, s[58:59]
    v_cndmask_b32 v75, 0, v29, s[58:59]
    v_cndmask_b32 v76, 0, v28, s[60:61]
    v_cndmask_b32 v77, 0, v29, s[60:61]
    v_mfma_f32_16x16x32_bf16 v[24:27], v[108:111], v[72:75], v[24:27]
    v_cndmask_b32 v78, 0, v28, s[62:63]
    v_cndmask_b32 v79, 0, v29, s[62:63]
    s_nop 1
    v_mfma_f32_16x16x32_bf16 v[24:27], v[2:5], v[76:79], v[24:27]
    s_mov_b32 exec_lo, 0x3ff03ff
    s_mov_b32 exec_hi, 0x3ff03ff
    s_cmp_eq_u32 s75, 1
    s_cbranch_scc0 SLOW26
    s_nop 3
    buffer_store_dwordx4 v[24:27], v84, s[16:19], s78 offen
BACK26:
    s_mov_b64 exec, -1
NEXT:
    s_cmp_lg_u32 s74, 0
    s_cbranch_scc1 DONE
    s_mov_b32 s74, 688128
    s_add_u32 s3, s3, 688128
    s_add_u32 s80, s80, 688128
    s_add_u32 s81, s81, 688128
    s_branch LOOP
AGAIN24:
    s_add_u32 s76, s76, 1
    s_cmp_lt_u32 s76, 32768
    s_cbranch_scc1 POLL24
    s_branch POLLX24
AGAIN25:
    s_mov_b64 s[94:95], exec
    s_mov_b32 s76, 1
AG225:
    v_cmp_eq_u32 vcc, -1, v24
    s_nop 0
    s_mov_b64 exec, vcc
    s_cbranch_execz AG325_0
    buffer_load_dwordx4 v[24:27], v86, s[16:19], s77 offen sc1
AG325_0:
    s_mov_b64 exec, s[94:95]
    v_cmp_eq_u32 vcc, -1, v28
    s_nop 0
    s_mov_b64 exec, vcc
    s_cbranch_execz AG325_1
    buffer_load_dwordx4 v[28:31], v18, s[16:19], s77 offen sc1
AG325_1:
    s_mov_b64 exec, s[94:95]
    v_cmp_eq_u32 vcc, -1, v32
    s_nop 0
    s_mov_b64 exec, vcc
    s_cbranch_execz AG325_2
    buffer_load_dwordx4 v[32:35], v20, s[16:19], s77 offen sc1
AG325_2:
    s_mov_b64 exec, s[94:95]
    s_add_u32 s76, s76, 1
    s_cmp_ge_u32 s76, 32768
    s_waitcnt vmcnt(0)
    v_max3_u32 v36, v24, v28, v32
    v_cmp_eq_u32 vcc, -1, v36
    s_cbranch_vccz POLLX25
    s_cbranch_scc0 AG225
    s_branch POLLX25
DONE:
    s_endpgm
DMAF:
    v_lshrrev_b32 v38, 1, v0
    v_mul_u32_u24 v38, 3072, v38
    v_and_b32 v39, 1, v0
    v_lshl_add_u32 v38, v39, 4, v38
    s_mul_i32 s79, s68, 12
    s_add_u32 s79, s79, s69
    s_sub_u32 s79, s79, 20
    s_mul_i32 s77, s72, 491520
    s_lshl_b32 s78, s79, 5
    s_add_u32 s77, s77, s78
    s_mul_i32 s78, s72, 5120
    s_add_u32 m0, s78, 57344
    s_nop 0
    buffer_load_dwordx4 v38, s[24:27], s77 offen  lds
    s_add_u32 m0, s78, 77824
    s_nop 0
    buffer_load_dwordx4 v38, s[28:31], s77 offen  lds
    s_add_u32 s77, s77, 98304
    s_add_u32 m0, s78, 58368
    s_nop 0
    buffer_load_dwordx4 v38, s[24:27], s77 offen  lds
    s_add_u32 m0, s78, 78848
    s_nop 0
    buffer_load_dwordx4 v38, s[28:31], s77 offen  lds
    s_add_u32 s77, s77, 98304
    s_add_u32 m0, s78, 59392
    s_nop 0
    buffer_load_dwordx4 v38, s[24:27], s77 offen  lds
    s_add_u32 m0, s78, 79872
    s_nop 0
    buffer_load_dwordx4 v38, s[28:31], s77 offen  lds
    s_add_u32 s77, s77, 98304
    s_add_u32 m0, s78, 60416
    s_nop 0
    buffer_load_dwordx4 v38, s[24:27], s77 offen  lds
    s_add_u32 m0, s78, 80896
    s_nop 0
    buffer_load_dwordx4 v38, s[28:31], s77 offen  lds
    s_add_u32 s77, s77, 98304
    s_add_u32 m0, s78, 61440
    s_nop 0
    buffer_load_dwordx4 v38, s[24:27], s77 offen  lds
    s_add_u32 m0, s78, 81920
    s_nop 0
    buffer_load_dwordx4 v38, s[28:31], s77 offen  lds
    s_branch DMAX
RDYLOOP:
    s_mov_b32 s76, 0
RDYL2:
    s_sleep 24
    global_load_dword v99, v98, s[64:65] sc1
    s_waitcnt vmcnt(0)
    v_sad_u8 v100, v99, 0, 0
    s_nop 1
    v_add_u32_dpp v100, v100, v100 quad_perm:[1,0,3,2] row_mask:0xf bank_mask:0xf
    s_nop 1
    v_add_u32_dpp v100, v100, v100 quad_perm:[2,3,0,1] row_mask:0xf bank_mask:0xf
    v_cmp_gt_u32 vcc, 32, v100
    s_mov_b32 vcc_hi, 0
    s_cmp_eq_u64 vcc, 0
    s_cbranch_scc1 RDYOK
    s_add_u32 s76, s76, 1
    s_cmp_lt_u32 s76, 32768
    s_cbranch_scc1 RDYL2
    s_branch RDYOK
SLOW1:
    buffer_store_dwordx4 v[28:31], v27, s[16:19], s77 offen sc1
    s_branch BACK1
SLOW4:
    buffer_store_dword v24, v10, s[16:19], s3 offen sc1
    s_branch BACK4
SLOW6:
    buffer_store_dwordx4 v[28:31], v39, s[16:19], s77 offen sc1
    s_branch BACK6
SLOW7:
    buffer_store_dwordx2 v[32:33], v39, s[16:19], s78 offen sc1
    s_branch BACK7
RETRY8:
    s_mov_b32 s76, 1
POLL27:
    buffer_load_dword v28, v20, s[16:19], 0 offen sc1
    buffer_load_dword v29, v21, s[16:19], 0 offen sc1
POLLW27:
    s_waitcnt vmcnt(0)
    v_max_u32 v30, v28, v29
    v_cmp_eq_u32 vcc, -1, v30
    s_cbranch_vccnz AGAIN27
POLLX27:
    s_branch OK8
AGAIN27:
    s_add_u32 s76, s76, 1
    s_cmp_lt_u32 s76, 32768
    s_cbranch_scc1 POLL27
    s_branch POLLX27
SLOW9:
    buffer_store_dwordx4 v[28:31], v37, s[16:19], s77 offen sc1
    s_branch BACK9
SLOW11:
    buffer_store_dwordx4 v[28:31], v18, s[16:19], s81 offen sc1
    s_branch BACK11
SLOW12:
    buffer_store_dwordx4 v[52:55], v48, s[16:19], s78 offen sc1
    s_branch BACK12
SLOW13:
    buffer_store_dwordx4 v[52:55], v49, s[16:19], s78 offen sc1
    s_branch BACK13
SLOW14:
    buffer_store_dwordx4 v[52:55], v50, s[16:19], s78 offen sc1
    s_branch BACK14
SLOW16:
    buffer_store_dwordx4 v[28:31], v39, s[16:19], s97 offen sc1
    s_branch BACK16
SLOW17:
    buffer_store_dword v7, v10, s[16:19], s77 offen sc1
    s_branch BACK17
SLOW18:
    buffer_store_dwordx4 v[24:27], v28, s[16:19], 0 offen sc1
    s_branch BACK18
SLOW19:
    buffer_store_dwordx4 v[24:27], v29, s[16:19], 0 offen sc1
    s_branch BACK19
SLOW21:
    buffer_store_dwordx4 v[28:31], v37, s[16:19], s77 offen sc1
    s_branch BACK21
FW2:
    s_add_u32 s96, s3, 1376256
    s_cmp_eq_u32 s75, 1
    s_cbranch_scc0 SLOW28
    buffer_store_dword v7, v10, s[16:19], s96 offen
BACK28:
    s_mul_i32 s79, s68, 12
    s_add_u32 s79, s79, s69
    s_sub_u32 s79, s79, 20
    s_mul_i32 s97, s72, 5120
    s_mul_i32 s96, s79, 20480
    s_add_u32 s96, s96, s97
    s_add_u32 m0, s97, 98304
    s_nop 0
    buffer_load_dwordx4 v1, s[32:35], s96 offen nt lds
    s_add_u32 s96, s96, 1024
    s_add_u32 m0, s97, 99328
    s_nop 0
    buffer_load_dwordx4 v1, s[32:35], s96 offen nt lds
    s_add_u32 s96, s96, 1024
    s_add_u32 m0, s97, 100352
    s_nop 0
    buffer_load_dwordx4 v1, s[32:35], s96 offen nt lds
    s_add_u32 s96, s96, 1024
    s_add_u32 m0, s97, 101376
    s_nop 0
    buffer_load_dwordx4 v1, s[32:35], s96 offen nt lds
    s_add_u32 s96, s96, 1024
    s_add_u32 m0, s97, 102400
    s_nop 0
    buffer_load_dwordx4 v1, s[32:35], s96 offen nt lds
    s_sub_u32 s96, s69, 20
    s_lshl_b32 s96, s96, 2
    s_add_u32 s96, s96, s72
    s_mul_i32 s96, s96, 688
    v_add_u32 v21, s96, v1
    v_min_u32 v21, 32752, v21
    s_add_u32 s97, s3, 688128
    buffer_load_dwordx4 a[240:243], v21, s[16:19], s97 offen sc1
    s_branch FMM
SLOW26:
    s_nop 3
    buffer_store_dwordx4 v[24:27], v84, s[16:19], s78 offen sc1
    s_branch BACK26
FCS:
    s_waitcnt lgkmcnt(0)
    v_add_f32 v32, v32, v33
    v_add_f32 v34, v34, v35
    v_add_f32 v32, v32, v34
    v_add_f32 v36, v36, v37
    v_add_f32 v38, v38, v39
    v_add_f32 v36, v36, v38
    v_mul_f32 v22, 0x3acccccd, v32
    v_mul_f32 v23, 0x3acccccd, v36
    s_mov_b32 s4, 1
    s_waitcnt vmcnt(0)
    v_mov_b32 v24, -1
    v_mov_b32 v25, -1
    v_mov_b32 v26, -1
    v_mov_b32 v27, -1
    s_cmp_eq_u32 s75, 1
    s_cbranch_scc0 SLOW29
    buffer_store_dwordx4 v[24:27], v21, s[16:19], s97 offen
BACK29:
    s_barrier
    s_branch FPOLL
SLOW28:
    buffer_store_dword v7, v10, s[16:19], s96 offen sc1
    s_branch BACK28
SLOW29:
    buffer_store_dwordx4 v[24:27], v21, s[16:19], s97 offen sc1
    s_branch BACK29
CODE_END:
    s_endpgm
.section .rodata,"a"
.p2align 6
.amdhsa_kernel interleave_layers__sliding_block_cached__glu_gated_swiglu__decode_kernel
  .amdhsa_next_free_vgpr 512
  .amdhsa_next_free_sgpr 102
  .amdhsa_accum_offset 256
  .amdhsa_group_segment_fixed_size 0
  .amdhsa_kernarg_size 96
  .amdhsa_user_sgpr_count 2
  .amdhsa_user_sgpr_kernarg_segment_ptr 1
  .amdhsa_system_sgpr_workgroup_id_x 1
.end_amdhsa_kernel
```

```asm
; @launch grid=(256,1,1) block=(256,1,1) lds=125568
.amdgcn_target "amdgcn-amd-amdhsa--gfx950"
.text
.globl interleave_layers__sliding_block_cached__glu_gated_swiglu__decode_kernel
.p2align 8
.type interleave_layers__sliding_block_cached__glu_gated_swiglu__decode_kernel,@function
interleave_layers__sliding_block_cached__glu_gated_swiglu__decode_kernel:
    s_load_dwordx16 s[44:59], s[0:1], 0
    s_load_dwordx8 s[60:67], s[0:1], 64
    s_cmp_ge_u32 s2, 256
    s_cbranch_scc1 CODE_END
    v_lshrrev_b32 v2, 6, v0
    v_and_b32 v24, 63, v0
    v_readfirstlane_b32 s72, v2
    s_and_b32 s68, s2, 7
    s_lshr_b32 s69, s2, 3
    s_lshr_b32 s70, s69, 3
    s_and_b32 s71, s69, 7
    v_lshlrev_b32 v1, 4, v24
    s_lshl_b32 s77, s70, 3
    s_add_u32 s77, s77, s68
    s_mul_i32 s73, s77, 12582912
    s_lshl_b32 s78, s71, 2
    s_add_u32 s78, s78, s72
    s_mul_i32 s78, s78, 6144
    s_add_u32 s73, s73, s78
    s_add_u32 s73, s73, 11010048
    v_add_u32 v23, 4096, v1
    s_mov_b32 s10, 402653184
    s_mov_b32 s11, 0x20000
    s_getpc_b64 s[100:101]
PCREF:
    s_sub_u32 s100, s100, PCREF-interleave_layers__sliding_block_cached__glu_gated_swiglu__decode_kernel
    s_subb_u32 s101, s101, 0
    s_lshl_b32 s78, s71, 12
    v_lshl_add_u32 v25, v0, 4, s78
    v_cmp_gt_u32 vcc, CODE_END-interleave_layers__sliding_block_cached__glu_gated_swiglu__decode_kernel-16, v25
    s_nop 0
    s_and_saveexec_b64 s[98:99], vcc
    s_cbranch_execz NOCPF
    global_load_dwordx4 a[240:243], v25, s[100:101]
NOCPF:
    s_mov_b64 exec, -1
    s_mul_i32 s79, s77, 384
    s_mov_b32 s74, 0
    s_mul_i32 s3, s68, 81920
    s_mov_b32 s75, 0
    v_mov_b32 v32, -1
    v_mov_b32 v33, -1
    v_mov_b32 v34, -1
    v_mov_b32 v35, -1
    s_mul_i32 s77, s69, 576
    s_add_u32 s77, s77, s3
    s_add_u32 s77, s77, 32768
    v_add_u32 v20, s77, v1
    s_mul_i32 s77, s2, 80
    s_add_u32 s77, s77, 654784
    v_add_u32 v25, s77, v1
    v_cmp_le_u32 vcc, 36, v0
    s_nop 1
    v_cndmask_b32 v21, v20, v25, vcc
    v_mov_b32 v25, 2147483632
    v_cndmask_b32 v20, v20, v25, vcc
    v_cmp_le_u32 vcc, 41, v0
    s_nop 1
    v_cndmask_b32 v21, v21, v25, vcc
    s_mov_b32 s18, 1610612736
    s_mov_b32 s19, 0x20000
    s_waitcnt lgkmcnt(0)
    s_mov_b32 s8, s46
    s_and_b32 s9, s47, 0xffff
    s_mov_b32 s16, s66
    s_and_b32 s17, s67, 0xffff
    buffer_store_dwordx4 v[32:35], v21, s[16:19], 0 offen sc1
    buffer_load_dwordx4 a[0:3], v1, s[8:11], s73 offen offset:0 nt
    buffer_load_dwordx4 a[4:7], v1, s[8:11], s73 offen offset:1024 nt
    s_add_u32 s83, s73, 196608
    s_mov_b32 s12, s48
    s_and_b32 s13, s49, 0xffff
    s_mov_b32 s14, 402653184
    s_mov_b32 s15, 0x20000
    s_mov_b32 s20, s50
    s_and_b32 s21, s51, 0xffff
    s_mov_b32 s22, 7864320
    s_mov_b32 s23, 0x20000
    s_mov_b32 s36, s44
    s_and_b32 s37, s45, 0xffff
    s_mov_b32 s38, 1280
    s_mov_b32 s39, 0x20000
    s_mov_b32 s40, s62
    s_and_b32 s41, s63, 0xffff
    s_mov_b32 s42, 1280
    s_mov_b32 s43, 0x20000
    s_mov_b32 s28, s58
    s_and_b32 s29, s59, 0xffff
    s_mov_b32 s30, 1966080
    s_mov_b32 s31, 0x20000
    s_mov_b32 s32, s60
    s_and_b32 s33, s61, 0xffff
    s_mov_b32 s34, 1966080
    s_mov_b32 s35, 0x20000
    s_cmp_lt_u32 s69, 20
    s_cselect_b32 s24, s52, s56
    s_cselect_b32 s25, s53, s57
    s_cselect_b32 s26, s22, s30
    s_and_b32 s25, s25, 0xffff
    s_mov_b32 s27, 0x20000
    s_add_u32 s84, s83, 196608
    s_add_u32 s85, s84, 196608
    s_add_u32 s86, s85, 196608
    s_add_u32 s87, s86, 196608
    s_add_u32 s88, s87, 196608
    s_add_u32 s89, s88, 196608
    v_mov_b32 v0, v24
    s_mul_i32 s77, s72, 6656
    v_add_u32 v25, 0, v0
    v_mul_u32_u24 v26, 171, v25
    v_lshrrev_b32 v26, 12, v26
    v_mul_u32_u24 v27, 24, v26
    v_sub_u32 v27, v25, v27
    v_lshlrev_b32 v27, 4, v27
    v_mul_u32_u24 v25, 416, v26
    v_add3_u32 v2, v25, v27, s77
    v_mul_u32_u24 v25, 12288, v26
    v_add_u32 v40, v25, v27
    v_mul_u32_u24 v25, 3072, v26
    v_add_u32 v101, v25, v27
    v_add_u32 v25, 64, v0
    v_mul_u32_u24 v26, 171, v25
    v_lshrrev_b32 v26, 12, v26
    v_mul_u32_u24 v27, 24, v26
    v_sub_u32 v27, v25, v27
    v_lshlrev_b32 v27, 4, v27
    v_mul_u32_u24 v25, 416, v26
    v_add3_u32 v3, v25, v27, s77
    v_mul_u32_u24 v25, 12288, v26
    v_add_u32 v41, v25, v27
    v_mul_u32_u24 v25, 3072, v26
    v_add_u32 v102, v25, v27
    v_add_u32 v25, 128, v0
    v_mul_u32_u24 v26, 171, v25
    v_lshrrev_b32 v26, 12, v26
    v_mul_u32_u24 v27, 24, v26
    v_sub_u32 v27, v25, v27
    v_lshlrev_b32 v27, 4, v27
    v_mul_u32_u24 v25, 416, v26
    v_add3_u32 v4, v25, v27, s77
    v_mul_u32_u24 v25, 12288, v26
    v_add_u32 v42, v25, v27
    v_mul_u32_u24 v25, 3072, v26
    v_add_u32 v103, v25, v27
    v_and_b32 v25, 15, v0
    v_lshrrev_b32 v26, 4, v0
    v_bfe_u32 v27, v0, 2, 2
    v_and_b32 v28, 3, v0
    s_mul_i32 s78, s71, 160
    v_lshlrev_b32 v36, 4, v26
    v_lshlrev_b32 v37, 3, v26
    v_lshlrev_b32 v39, 2, v0
    buffer_load_dwordx4 v[70:73], v36, s[36:39], s78 offen
    buffer_load_dwordx4 v[74:77], v36, s[36:39], s78 offen offset:64
    buffer_load_dwordx2 v[78:79], v37, s[36:39], s78 offen offset:128
    buffer_load_dwordx4 v[80:83], v1, s[36:39], 0 offen
    buffer_load_dword v84, v39, s[36:39], 0 offen offset:1024
    s_lshl_b32 s7, s69, 6
    v_lshlrev_b32 v38, 2, v25
    buffer_load_dword v22, v38, s[36:39], s7 offen
    s_mul_i32 s78, s71, 983040
    s_add_u32 s79, s79, s78
    s_mul_i32 s78, s72, 98304
    s_add_u32 s79, s79, s78
    s_mul_i32 s78, s72, 3072
    s_add_u32 s78, s78, 26624
    s_add_u32 m0, s78, 0
    s_nop 0
    buffer_load_dwordx4 v40, s[20:23], s79 offen nt lds
    s_add_u32 m0, s78, 1024
    s_nop 0
    buffer_load_dwordx4 v41, s[20:23], s79 offen nt lds
    s_add_u32 m0, s78, 2048
    s_nop 0
    buffer_load_dwordx4 v42, s[20:23], s79 offen nt lds
    s_add_u32 s79, s79, 393216
    s_add_u32 m0, s78, 12288
    s_nop 0
    buffer_load_dwordx4 v40, s[20:23], s79 offen nt lds
    s_add_u32 m0, s78, 13312
    s_nop 0
    buffer_load_dwordx4 v41, s[20:23], s79 offen nt lds
    s_add_u32 m0, s78, 14336
    s_nop 0
    buffer_load_dwordx4 v42, s[20:23], s79 offen nt lds
    s_add_u32 s79, s79, 393216
    s_cmp_ge_u32 s72, 2
    s_cbranch_scc1 NOWQ3
    s_add_u32 m0, s78, 24576
    s_nop 0
    buffer_load_dwordx4 v40, s[20:23], s79 offen nt lds
    s_add_u32 m0, s78, 25600
    s_nop 0
    buffer_load_dwordx4 v41, s[20:23], s79 offen nt lds
    s_add_u32 m0, s78, 26624
    s_nop 0
    buffer_load_dwordx4 v42, s[20:23], s79 offen nt lds
NOWQ3:
    s_mul_i32 s78, s71, 160
    s_mov_b32 s20, s52
    s_and_b32 s21, s53, 0xffff
    s_mov_b32 s22, 7864320
    s_mov_b32 s23, 0x20000
    s_cmp_lt_u32 s72, 2
    s_cselect_b32 s36, s56, s58
    s_cselect_b32 s37, s57, s59
    s_and_b32 s37, s37, 0xffff
    s_mov_b32 s38, 1966080
    s_lshl_b32 s90, s70, 3
    s_add_u32 s90, s90, s68
    s_lshl_b32 s90, s90, 3
    s_add_u32 s90, s90, s71
    s_mul_i32 s90, s90, 30720
    s_mul_i32 s79, s72, 6144
    s_add_u32 s90, s90, s79
    s_cmp_eq_u32 s72, 3
    s_cselect_b32 s79, 3072, 0
    s_add_u32 s90, s90, s79
    s_cmp_lt_u32 s72, 2
    s_cselect_b32 s79, 1879048176, 0
    v_add_u32 v108, s79, v23
    v_add_u32 v109, 4096, v108
    s_and_b32 s91, s72, 1
    s_lshl_b32 s79, s69, 1
    s_add_u32 s91, s91, s79
    s_mul_i32 s79, s91, 0
    s_add_u32 s79, s79, 640
    s_mul_i32 s91, s91, 16
    s_cmp_lt_u32 s69, 20
    s_cselect_b32 s91, s91, s79
    s_mov_b32 s7, 49152
    s_cselect_b32 s7, s7, 0
    s_mul_i32 s91, s91, 3072
    s_mul_i32 s79, s68, 384
    s_add_u32 s91, s91, s79
    v_mov_b32 v29, 1879048176
    v_add_u32 v104, 24576, v101
    v_add_u32 v105, 24576, v102
    v_add_u32 v106, 24576, v103
    v_cmp_gt_u32 vcc, s7, v101
    s_nop 1
    v_cndmask_b32 v101, v29, v101, vcc
    v_cmp_gt_u32 vcc, s7, v102
    s_nop 1
    v_cndmask_b32 v102, v29, v102, vcc
    v_cmp_gt_u32 vcc, s7, v103
    s_nop 1
    v_cndmask_b32 v103, v29, v103, vcc
    v_cmp_gt_u32 vcc, s7, v104
    s_nop 1
    v_cndmask_b32 v104, v29, v104, vcc
    v_cmp_gt_u32 vcc, s7, v105
    s_nop 1
    v_cndmask_b32 v105, v29, v105, vcc
    v_cmp_gt_u32 vcc, s7, v106
    s_nop 1
    v_cndmask_b32 v106, v29, v106, vcc
    buffer_load_dwordx4 a[8:11], v1, s[8:11], s73 offen offset:2048 nt
    buffer_load_dwordx4 a[12:15], v1, s[8:11], s73 offen offset:3072 nt
    buffer_load_dwordx4 a[16:19], v23, s[8:11], s73 offen offset:0 nt
    v_mul_u32_u24 v29, 416, v25
    v_lshl_add_u32 v29, v26, 4, v29
    v_add_u32 v5, s77, v29
    v_lshrrev_b32 v29, 2, v0
    v_mul_u32_u24 v29, 416, v29
    v_lshl_add_u32 v29, v28, 3, v29
    v_add_u32 v6, s77, v29
    s_mul_i32 s79, s72, 96
    s_add_u32 s79, s79, 26624
    v_lshl_add_u32 v29, v26, 3, v27
    v_mul_u32_u24 v29, 384, v29
    v_lshl_add_u32 v29, v28, 3, v29
    v_add_u32 v16, s79, v29
    v_lshl_add_u32 v29, v26, 2, v27
    v_mul_u32_u24 v29, 384, v29
    v_lshl_add_u32 v29, v28, 3, v29
    v_add_u32 v17, s79, v29
    buffer_load_dwordx4 a[20:23], v23, s[8:11], s73 offen offset:1024 nt
    v_mul_u32_u24 v31, 103, v0
    v_lshrrev_b32 v31, 10, v31
    v_mul_u32_u24 v30, 10, v31
    v_sub_u32 v30, v0, v30
    v_lshl_add_u32 v29, v30, 4, s78
    v_mul_u32_u24 v8, 1280, v31
    v_add_u32 v8, 665600, v8
    s_mul_i32 s7, s68, 81920
    s_add_u32 s7, s7, 47360
    v_mov_b32 v30, s7
    v_cmp_eq_u32 vcc, s68, v31
    s_nop 1
    v_cndmask_b32 v8, v8, v30, vcc
    v_add_u32 v30, 2560, v30
    v_cmp_le_u32 vcc, 8, v31
    s_nop 1
    v_cndmask_b32 v8, v8, v30, vcc
    v_add_u32 v8, v8, v29
    v_add_u32 v31, 6, v31
    v_mul_u32_u24 v9, 1280, v31
    v_add_u32 v9, 665600, v9
    s_mul_i32 s7, s68, 81920
    s_add_u32 s7, s7, 47360
    v_mov_b32 v30, s7
    v_cmp_eq_u32 vcc, s68, v31
    s_nop 1
    v_cndmask_b32 v9, v9, v30, vcc
    v_add_u32 v30, 2560, v30
    v_cmp_le_u32 vcc, 8, v31
    s_nop 1
    v_cndmask_b32 v9, v9, v30, vcc
    v_add_u32 v9, v9, v29
    v_mov_b32 v30, 2147483632
    v_cmp_le_u32 vcc, 30, v0
    s_nop 1
    v_cndmask_b32 v9, v9, v30, vcc
    s_lshl_b32 s78, s69, 10
    s_lshl_b32 s79, s72, 8
    s_add_u32 s78, s78, s79
    v_lshl_add_u32 v10, v0, 2, s78
    s_lshl_b32 s78, s70, 13
    s_add_u32 s78, s78, s79
    v_lshlrev_b32 v29, 10, v26
    v_lshl_add_u32 v29, v25, 4, v29
    v_add_u32 v11, s78, v29
    buffer_load_dwordx4 a[24:27], v1, s[8:11], s83 offen offset:0 nt
    s_mul_i32 s78, s72, 96
    s_add_u32 s78, s78, 118784
    v_lshl_add_u32 v29, v27, 5, s78
    v_lshl_add_u32 v29, v28, 2, v29
    v_lshrrev_b32 v30, 1, v26
    v_lshl_add_u32 v29, v30, 4, v29
    v_and_b32 v30, 1, v26
    v_lshl_add_u32 v29, v30, 1, v29
    v_mov_b32 v30, 119168
    v_cmp_le_u32 vcc, 12, v25
    s_nop 1
    v_cndmask_b32 v12, v29, v30, vcc
    v_and_b32 v30, 1, v0
    v_lshlrev_b32 v29, 5, v26
    v_lshl_add_u32 v29, v30, 4, v29
    v_add_u32 v13, 118784, v29
    v_mul_u32_u24 v30, 0xaaaa, v30
    v_and_b32 v29, 1, v27
    v_mul_u32_u24 v29, 0xaaaa, v29
    v_lshl_or_b32 v29, v29, 16, v30
    v_add_u32 v14, 0x44444444, v29
    buffer_load_dwordx4 a[28:31], v1, s[8:11], s83 offen offset:1024 nt
    s_lshl_b32 s78, s72, 8
    s_add_u32 s78, s78, 124416
    v_lshrrev_b32 v29, 5, v0
    v_lshl_add_u32 v29, v29, 6, s78
    v_bfe_u32 v30, v0, 3, 1
    v_lshl_add_u32 v29, v30, 5, v29
    v_bfe_u32 v30, v0, 1, 1
    v_lshl_add_u32 v29, v30, 4, v29
    v_bfe_u32 v30, v0, 2, 1
    v_lshl_add_u32 v29, v30, 3, v29
    v_bfe_u32 v30, v0, 4, 1
    v_lshl_add_u32 v29, v30, 2, v29
    v_bfe_u32 v30, v0, 0, 1
    v_lshl_add_u32 v29, v30, 1, v29
    v_mov_b32 v19, v29
    v_bfe_u32 v29, v0, 4, 1
    v_bfe_u32 v30, v0, 2, 1
    v_lshl_add_u32 v29, v29, 5, s78
    v_lshl_add_u32 v29, v30, 4, v29
    v_accvgpr_write_b32 a252, v29
    s_mul_i32 s78, s72, 768
    s_add_u32 s78, s78, 119296
    v_lshl_add_u32 v29, v25, 2, s78
    v_bfe_u32 v30, v0, 4, 1
    v_lshl_add_u32 v29, v30, 7, v29
    v_lshrrev_b32 v30, 5, v0
    v_lshl_add_u32 v15, v30, 6, v29
    s_waitcnt vmcnt(12)
    v_lshlrev_b32 v88, 16, v80
    v_and_b32 v89, 0xffff0000, v80
    v_lshlrev_b32 v90, 16, v81
    v_and_b32 v91, 0xffff0000, v81
    v_lshlrev_b32 v92, 16, v82
    v_and_b32 v93, 0xffff0000, v82
    v_lshlrev_b32 v94, 16, v83
    v_and_b32 v95, 0xffff0000, v83
    v_lshlrev_b32 v96, 16, v84
    v_and_b32 v97, 0xffff0000, v84
    v_add_f32 v80, v88, v89
    v_add_f32 v80, v80, v90
    v_add_f32 v80, v80, v91
    v_add_f32 v80, v80, v92
    v_add_f32 v80, v80, v93
    v_add_f32 v80, v80, v94
    v_add_f32 v80, v80, v95
    v_add_f32 v80, v80, v96
    v_add_f32 v80, v80, v97
    s_nop 1
    v_add_f32_dpp v80, v80, v80 row_ror:8 row_mask:0xf bank_mask:0xf
    s_nop 1
    v_add_f32_dpp v80, v80, v80 row_ror:4 row_mask:0xf bank_mask:0xf
    s_nop 1
    v_add_f32_dpp v80, v80, v80 row_ror:2 row_mask:0xf bank_mask:0xf
    s_nop 1
    v_add_f32_dpp v80, v80, v80 row_ror:1 row_mask:0xf bank_mask:0xf
    v_mov_b32 v81, v80
    s_nop 1
    v_permlane32_swap_b32 v80, v81
    v_add_f32 v80, v80, v81
    v_mov_b32 v81, v80
    s_nop 1
    v_permlane16_swap_b32 v80, v81
    v_add_f32 v80, v80, v81
    v_mul_f32 v80, 0x3acccccd, v80
    v_sub_f32 v88, v88, v80
    v_sub_f32 v89, v89, v80
    v_sub_f32 v90, v90, v80
    v_sub_f32 v91, v91, v80
    v_sub_f32 v92, v92, v80
    v_sub_f32 v93, v93, v80
    v_sub_f32 v94, v94, v80
    v_sub_f32 v95, v95, v80
    v_sub_f32 v96, v96, v80
    v_sub_f32 v97, v97, v80
    v_mul_f32 v82, v88, v88
    v_fmac_f32 v82, v89, v89
    v_fmac_f32 v82, v90, v90
    v_fmac_f32 v82, v91, v91
    v_fmac_f32 v82, v92, v92
    v_fmac_f32 v82, v93, v93
    v_fmac_f32 v82, v94, v94
    v_fmac_f32 v82, v95, v95
    v_fmac_f32 v82, v96, v96
    v_fmac_f32 v82, v97, v97
    buffer_load_dwordx4 a[32:35], v1, s[8:11], s83 offen offset:2048 nt
    s_nop 0
    v_add_f32_dpp v82, v82, v82 row_ror:8 row_mask:0xf bank_mask:0xf
    s_nop 1
    v_add_f32_dpp v82, v82, v82 row_ror:4 row_mask:0xf bank_mask:0xf
    s_nop 1
    v_add_f32_dpp v82, v82, v82 row_ror:2 row_mask:0xf bank_mask:0xf
    s_nop 1
    v_add_f32_dpp v82, v82, v82 row_ror:1 row_mask:0xf bank_mask:0xf
    v_mov_b32 v81, v82
    s_nop 1
    v_permlane32_swap_b32 v82, v81
    v_add_f32 v82, v82, v81
    v_mov_b32 v81, v82
    s_nop 1
    v_permlane16_swap_b32 v82, v81
    v_add_f32 v82, v82, v81
    v_mul_f32 v82, 0x3acccccd, v82
    v_add_f32 v82, 0x3727c5ac, v82
    v_rsq_f32 v82, v82
    s_mov_b32 vcc_lo, 0xaaaaaaaa
    s_mov_b32 vcc_hi, 0xaaaaaaaa
    v_mov_b32 v85, 0x3f803f80
    v_lshlrev_b32 v83, 16, v70
    v_and_b32 v84, 0xffff0000, v70
    v_sub_f32 v83, v83, v80
    v_sub_f32 v84, v84, v80
    v_mul_f32 v83, v83, v82
    v_mul_f32 v84, v84, v82
    v_cvt_pk_bf16_f32 v83, v83, v84
    v_cndmask_b32 v70, v83, v85, vcc
    v_lshlrev_b32 v83, 16, v71
    v_and_b32 v84, 0xffff0000, v71
    v_sub_f32 v83, v83, v80
    v_sub_f32 v84, v84, v80
    v_mul_f32 v83, v83, v82
    v_mul_f32 v84, v84, v82
    v_cvt_pk_bf16_f32 v83, v83, v84
    v_cndmask_b32 v71, v83, v85, vcc
    v_lshlrev_b32 v83, 16, v72
    v_and_b32 v84, 0xffff0000, v72
    v_sub_f32 v83, v83, v80
    v_sub_f32 v84, v84, v80
    v_mul_f32 v83, v83, v82
    v_mul_f32 v84, v84, v82
    v_cvt_pk_bf16_f32 v83, v83, v84
    v_cndmask_b32 v72, v83, v85, vcc
    v_lshlrev_b32 v83, 16, v73
    v_and_b32 v84, 0xffff0000, v73
    v_sub_f32 v83, v83, v80
    v_sub_f32 v84, v84, v80
    v_mul_f32 v83, v83, v82
    v_mul_f32 v84, v84, v82
    v_cvt_pk_bf16_f32 v83, v83, v84
    v_cndmask_b32 v73, v83, v85, vcc
    v_lshlrev_b32 v83, 16, v74
    v_and_b32 v84, 0xffff0000, v74
    v_sub_f32 v83, v83, v80
    v_sub_f32 v84, v84, v80
    v_mul_f32 v83, v83, v82
    v_mul_f32 v84, v84, v82
    v_cvt_pk_bf16_f32 v83, v83, v84
    v_cndmask_b32 v74, v83, v85, vcc
    v_lshlrev_b32 v83, 16, v75
    v_and_b32 v84, 0xffff0000, v75
    v_sub_f32 v83, v83, v80
    v_sub_f32 v84, v84, v80
    v_mul_f32 v83, v83, v82
    v_mul_f32 v84, v84, v82
    v_cvt_pk_bf16_f32 v83, v83, v84
    v_cndmask_b32 v75, v83, v85, vcc
    buffer_load_dwordx4 a[36:39], v1, s[8:11], s83 offen offset:3072 nt
    v_lshlrev_b32 v83, 16, v76
    v_and_b32 v84, 0xffff0000, v76
    v_sub_f32 v83, v83, v80
    v_sub_f32 v84, v84, v80
    v_mul_f32 v83, v83, v82
    v_mul_f32 v84, v84, v82
    v_cvt_pk_bf16_f32 v83, v83, v84
    v_cndmask_b32 v76, v83, v85, vcc
    v_lshlrev_b32 v83, 16, v77
    v_and_b32 v84, 0xffff0000, v77
    v_sub_f32 v83, v83, v80
    v_sub_f32 v84, v84, v80
    v_mul_f32 v83, v83, v82
    v_mul_f32 v84, v84, v82
    v_cvt_pk_bf16_f32 v83, v83, v84
    v_cndmask_b32 v77, v83, v85, vcc
    v_lshlrev_b32 v83, 16, v78
    v_and_b32 v84, 0xffff0000, v78
    v_sub_f32 v83, v83, v80
    v_sub_f32 v84, v84, v80
    v_mul_f32 v83, v83, v82
    v_mul_f32 v84, v84, v82
    v_cvt_pk_bf16_f32 v83, v83, v84
    v_cndmask_b32 v78, v83, v85, vcc
    v_lshlrev_b32 v83, 16, v79
    v_and_b32 v84, 0xffff0000, v79
    v_sub_f32 v83, v83, v80
    v_sub_f32 v84, v84, v80
    v_mul_f32 v83, v83, v82
    v_mul_f32 v84, v84, v82
    v_cvt_pk_bf16_f32 v83, v83, v84
    v_cndmask_b32 v79, v83, v85, vcc
    s_waitcnt vmcnt(8)
    s_barrier
    ds_read_b64_tr_b16 v[40:41], v16 offset:0
    ds_read_b64_tr_b16 v[42:43], v16 offset:1536
    ds_read_b64_tr_b16 v[44:45], v16 offset:12288
    ds_read_b64_tr_b16 v[46:47], v16 offset:13824
    ds_read_b64_tr_b16 v[48:49], v17 offset:24576
    ds_read_b64_tr_b16 v[50:51], v16 offset:32
    ds_read_b64_tr_b16 v[52:53], v16 offset:1568
    ds_read_b64_tr_b16 v[54:55], v16 offset:12320
    ds_read_b64_tr_b16 v[56:57], v16 offset:13856
    ds_read_b64_tr_b16 v[58:59], v17 offset:24608
    ds_read_b64_tr_b16 v[60:61], v16 offset:64
    ds_read_b64_tr_b16 v[62:63], v16 offset:1600
    ds_read_b64_tr_b16 v[64:65], v16 offset:12352
    ds_read_b64_tr_b16 v[66:67], v16 offset:13888
    ds_read_b64_tr_b16 v[68:69], v17 offset:24640
    buffer_load_dwordx4 a[40:43], v23, s[8:11], s83 offen offset:0 nt
    buffer_load_dwordx4 a[44:47], v23, s[8:11], s83 offen offset:1024 nt
    s_mul_i32 s79, s72, 96
    s_add_u32 s79, s79, 119296
    v_min_u32 v36, 48, v0
    v_lshl_add_u32 v36, v36, 1, s79
    v_mov_b32 v37, 119808
    v_cmp_le_u32 vcc, 48, v0
    s_nop 1
    v_cndmask_b32 v36, v36, v37, vcc
    v_add_u32 v37, 119296, v1
    s_waitcnt lgkmcnt(0)
    v_mfma_f32_16x16x32_bf16 v[24:27], v[70:73], v[40:43], 0
    v_mfma_f32_16x16x32_bf16 v[28:31], v[70:73], v[50:53], 0
    v_mfma_f32_16x16x32_bf16 v[32:35], v[70:73], v[60:63], 0
    v_mfma_f32_16x16x32_bf16 v[24:27], v[74:77], v[44:47], v[24:27]
    v_mfma_f32_16x16x32_bf16 v[28:31], v[74:77], v[54:57], v[28:31]
    v_mfma_f32_16x16x32_bf16 v[32:35], v[74:77], v[64:67], v[32:35]
    v_mfma_f32_16x16x16_bf16 v[24:27], v[78:79], v[48:49], v[24:27]
    v_mfma_f32_16x16x16_bf16 v[28:31], v[78:79], v[58:59], v[28:31]
    v_mfma_f32_16x16x16_bf16 v[32:35], v[78:79], v[68:69], v[32:35]
    buffer_load_dwordx4 a[48:51], v1, s[8:11], s84 offen offset:0 nt
    s_nop 4
    v_mov_b32 v7, v25
    v_mov_b32_dpp v24, v28 quad_perm:[0,1,2,3] row_mask:0x2 bank_mask:0xf
    s_nop 0
    v_mov_b32_dpp v7, v29 quad_perm:[0,1,2,3] row_mask:0x2 bank_mask:0xf
    v_mov_b32_dpp v24, v32 quad_perm:[0,1,2,3] row_mask:0x4 bank_mask:0xf
    s_nop 0
    v_mov_b32_dpp v7, v33 quad_perm:[0,1,2,3] row_mask:0x4 bank_mask:0xf
    v_cvt_pk_bf16_f32 v24, v24, v24
    ds_write_b16 v36, v24
    buffer_load_dwordx4 a[52:55], v1, s[8:11], s84 offen offset:1024 nt
    buffer_load_dwordx4 a[56:59], v1, s[8:11], s84 offen offset:2048 nt
    s_waitcnt lgkmcnt(0)
    s_barrier
    ds_read_b128 v[28:31], v37
    s_mul_i32 s79, s69, 384
    s_add_u32 s79, s79, s3
    s_cmp_eq_u32 s72, 0
    s_cselect_b32 exec_lo, 0xffffff, 1
    s_mov_b32 exec_hi, 0
    s_cselect_b32 s78, 0, 1879048176
    v_add_u32 v37, s78, v1
    s_waitcnt lgkmcnt(0)
    buffer_store_dwordx4 v[28:31], v37, s[16:19], s79 offen sc1
    s_mov_b64 exec, -1
    buffer_load_dwordx4 a[60:63], v1, s[8:11], s84 offen offset:3072 nt
    buffer_load_dwordx4 a[64:67], v23, s[8:11], s84 offen offset:0 nt
    s_waitcnt vmcnt(12)
    ds_write_b128 v2, a[0:3] offset:0
    ds_write_b128 v3, a[4:7] offset:0
    ds_write_b128 v4, a[8:11] offset:0
    ds_write_b128 v2, a[12:15] offset:3328
    ds_write_b128 v3, a[16:19] offset:3328
    ds_write_b128 v4, a[20:23] offset:3328
    ds_read_b128 a[0:3], v5 offset:0
    ds_read_b128 a[4:7], v5 offset:64
    ds_read_b128 a[8:11], v5 offset:128
    ds_read_b128 a[12:15], v5 offset:192
    ds_read_b128 a[16:19], v5 offset:256
    ds_read_b128 a[20:23], v5 offset:320
    buffer_load_dwordx4 a[68:71], v23, s[8:11], s84 offen offset:1024 nt
    s_barrier
    buffer_load_dwordx4 a[72:75], v1, s[8:11], s85 offen offset:0 nt
    buffer_load_dwordx4 a[76:79], v1, s[8:11], s85 offen offset:1024 nt
    buffer_load_dwordx4 a[80:83], v1, s[8:11], s85 offen offset:2048 nt
    buffer_load_dwordx4 a[84:87], v1, s[8:11], s85 offen offset:3072 nt
    buffer_load_dwordx4 a[88:91], v23, s[8:11], s85 offen offset:0 nt
    buffer_load_dwordx4 a[92:95], v23, s[8:11], s85 offen offset:1024 nt
    s_barrier
    s_getreg_b32 s5, hwreg(HW_REG_XCC_ID, 0, 4)
    s_lshr_b32 s92, s5, 2
    s_lshl_b32 s93, s68, 2
    s_add_u32 s92, s92, s93
    s_and_b32 s93, s5, 3
    s_lshl_b32 s93, s93, 3
    s_lshl_b32 s94, 1, s93
    s_lshl_b32 s96, 32, s93
    s_mov_b32 s5, s92
    s_cmp_lg_u32 s72, 0
    s_cbranch_scc1 NOATOM
    s_waitcnt vmcnt(9)
    s_lshl_b32 s92, s92, 2
    v_mov_b32 v36, s92
    v_mov_b32 v37, s94
    s_mov_b64 exec, 1
    global_atomic_add v36, v37, s[64:65] sc1
    s_mov_b64 exec, -1
NOATOM:
    s_waitcnt vmcnt(13)
    ds_write_b128 v2, a[24:27] offset:0
    ds_write_b128 v3, a[28:31] offset:0
    ds_write_b128 v4, a[32:35] offset:0
    ds_write_b128 v2, a[36:39] offset:3328
    ds_write_b128 v3, a[40:43] offset:3328
    ds_write_b128 v4, a[44:47] offset:3328
    ds_read_b128 a[24:27], v5 offset:0
    ds_read_b128 a[28:31], v5 offset:64
    ds_read_b128 a[32:35], v5 offset:128
    ds_read_b128 a[36:39], v5 offset:192
    ds_read_b128 a[40:43], v5 offset:256
    ds_read_b128 a[44:47], v5 offset:320
    buffer_load_dwordx4 a[240:243], v101, s[36:39], s91 offen
    buffer_load_dwordx4 a[240:243], v102, s[36:39], s91 offen
    buffer_load_dwordx4 a[240:243], v103, s[36:39], s91 offen
    buffer_load_dwordx4 a[240:243], v104, s[36:39], s91 offen
    buffer_load_dwordx4 a[240:243], v105, s[36:39], s91 offen
    buffer_load_dwordx4 a[240:243], v106, s[36:39], s91 offen
    s_barrier
    s_waitcnt vmcnt(12)
    ds_write_b128 v2, a[48:51] offset:0
    ds_write_b128 v3, a[52:55] offset:0
    ds_write_b128 v4, a[56:59] offset:0
    ds_write_b128 v2, a[60:63] offset:3328
    ds_write_b128 v3, a[64:67] offset:3328
    ds_write_b128 v4, a[68:71] offset:3328
    ds_read_b128 a[48:51], v5 offset:0
    ds_read_b128 a[52:55], v5 offset:64
    ds_read_b128 a[56:59], v5 offset:128
    ds_read_b128 a[60:63], v5 offset:192
    ds_read_b128 a[64:67], v5 offset:256
    ds_read_b128 a[68:71], v5 offset:320
    v_lshlrev_b32 v98, 2, v0
    buffer_load_dwordx4 a[96:99], v1, s[8:11], s86 offen offset:0 nt
    buffer_load_dwordx4 a[100:103], v1, s[8:11], s86 offen offset:1024 nt
    buffer_load_dwordx4 a[104:107], v1, s[8:11], s86 offen offset:2048 nt
    buffer_load_dwordx4 a[108:111], v1, s[8:11], s86 offen offset:3072 nt
    buffer_load_dwordx4 a[112:115], v23, s[8:11], s86 offen offset:0 nt
    buffer_load_dwordx4 a[116:119], v23, s[8:11], s86 offen offset:1024 nt
    s_barrier
    buffer_load_dwordx4 a[120:123], v1, s[8:11], s87 offen offset:0 nt
    buffer_load_dwordx4 a[124:127], v1, s[8:11], s87 offen offset:1024 nt
    buffer_load_dwordx4 a[128:131], v1, s[8:11], s87 offen offset:2048 nt
    buffer_load_dwordx4 a[132:135], v1, s[8:11], s87 offen offset:3072 nt
    buffer_load_dwordx4 a[136:139], v23, s[8:11], s87 offen offset:0 nt
    buffer_load_dwordx4 a[140:143], v23, s[8:11], s87 offen offset:1024 nt
    s_barrier
    s_waitcnt vmcnt(18)
    ds_write_b128 v2, a[72:75] offset:0
    ds_write_b128 v3, a[76:79] offset:0
    ds_write_b128 v4, a[80:83] offset:0
    ds_write_b128 v2, a[84:87] offset:3328
    ds_write_b128 v3, a[88:91] offset:3328
    ds_write_b128 v4, a[92:95] offset:3328
    ds_read_b128 a[72:75], v5 offset:0
    ds_read_b128 a[76:79], v5 offset:64
    ds_read_b128 a[80:83], v5 offset:128
    ds_read_b128 a[84:87], v5 offset:192
    ds_read_b128 a[88:91], v5 offset:256
    ds_read_b128 a[92:95], v5 offset:320
    buffer_load_dwordx4 a[144:147], v1, s[8:11], s88 offen offset:0 nt
    buffer_load_dwordx4 a[148:151], v1, s[8:11], s88 offen offset:1024 nt
    buffer_load_dwordx4 a[152:155], v1, s[8:11], s88 offen offset:2048 nt
    buffer_load_dwordx4 a[156:159], v1, s[8:11], s88 offen offset:3072 nt
    buffer_load_dwordx4 a[160:163], v23, s[8:11], s88 offen offset:0 nt
    buffer_load_dwordx4 a[164:167], v23, s[8:11], s88 offen offset:1024 nt
    s_barrier
    s_waitcnt vmcnt(12)
    ds_write_b128 v2, a[96:99] offset:0
    ds_write_b128 v3, a[100:103] offset:0
    ds_write_b128 v4, a[104:107] offset:0
    ds_write_b128 v2, a[108:111] offset:3328
    ds_write_b128 v3, a[112:115] offset:3328
    ds_write_b128 v4, a[116:119] offset:3328
    ds_read_b128 a[96:99], v5 offset:0
    ds_read_b128 a[100:103], v5 offset:64
    ds_read_b128 a[104:107], v5 offset:128
    ds_read_b128 a[108:111], v5 offset:192
    ds_read_b128 a[112:115], v5 offset:256
    ds_read_b128 a[116:119], v5 offset:320
    buffer_load_dwordx4 a[168:171], v1, s[8:11], s89 offen offset:0 nt
    buffer_load_dwordx4 a[172:175], v1, s[8:11], s89 offen offset:1024 nt
    buffer_load_dwordx4 a[176:179], v1, s[8:11], s89 offen offset:2048 nt
    buffer_load_dwordx4 a[180:183], v1, s[8:11], s89 offen offset:3072 nt
    buffer_load_dwordx4 a[184:187], v23, s[8:11], s89 offen offset:0 nt
    buffer_load_dwordx4 a[188:191], v23, s[8:11], s89 offen offset:1024 nt
    s_barrier
    s_cmp_ge_u32 s69, 20
    s_cbranch_scc1 DMAF
    s_lshl_b32 s66, s72, 3
    s_add_u32 s66, s66, s68
    s_mul_i32 s66, s66, 245760
    s_lshl_b32 s78, s69, 6
    s_add_u32 s66, s66, s78
    s_mul_i32 s67, s72, 12288
    s_add_u32 s67, s67, 57344
    v_lshrrev_b32 v38, 2, v0
    v_mul_u32_u24 v38, 1280, v38
    v_and_b32 v39, 3, v0
    v_lshl_add_u32 v39, v39, 4, v38
    s_mov_b32 m0, s67
    s_add_u32 s67, s67, 1024
    buffer_load_dwordx4 v39, s[24:27], s66 offen  lds
    s_add_u32 s66, s66, 20480
    s_mov_b32 m0, s67
    s_add_u32 s67, s67, 1024
    buffer_load_dwordx4 v39, s[24:27], s66 offen  lds
    s_add_u32 s66, s66, 20480
DMAX:
    v_mov_b32 v109, v20
    v_and_b32 v25, 15, v0
    v_lshrrev_b32 v26, 4, v0
    v_add_u32 v27, 4, v26
    v_mul_u32_u24 v20, 1280, v26
    v_add_u32 v20, 665600, v20
    s_mul_i32 s7, s68, 81920
    s_add_u32 s7, s7, 47360
    v_mov_b32 v28, s7
    v_cmp_eq_u32 vcc, s68, v26
    s_nop 1
    v_cndmask_b32 v20, v20, v28, vcc
    v_mul_u32_u24 v21, 1280, v27
    v_add_u32 v21, 665600, v21
    s_mul_i32 s7, s68, 81920
    s_add_u32 s7, s7, 47360
    v_mov_b32 v28, s7
    v_cmp_eq_u32 vcc, s68, v27
    s_nop 1
    v_cndmask_b32 v21, v21, v28, vcc
    s_min_u32 s7, s69, 19
    s_lshl_b32 s7, s7, 6
    v_lshl_add_u32 v25, v25, 2, s7
    v_add_u32 v20, v20, v25
    v_add_u32 v21, v21, v25
    buffer_load_dwordx4 a[216:219], v1, s[12:15], s73 offen offset:0 nt
    v_and_b32 v25, 15, v0
    v_bfe_u32 v27, v0, 2, 2
    v_and_b32 v28, 3, v0
    s_mul_i32 s7, s72, 12288
    s_add_u32 s7, s7, 57344
    v_lshl_add_u32 v29, v26, 3, v27
    v_lshlrev_b32 v29, 6, v29
    v_lshl_add_u32 v29, v28, 3, v29
    v_add_u32 v29, s7, v29
    v_accvgpr_write_b32 a246, v29
    s_mul_i32 s7, s72, 3072
    s_add_u32 s7, s7, 32768
    v_lshl_add_u32 v29, v25, 4, s7
    v_lshl_add_u32 v29, v26, 7, v29
    v_accvgpr_write_b32 a247, v29
    s_lshl_b32 s7, s72, 6
    s_add_u32 s7, s7, 45056
    v_and_b32 v29, 1, v26
    v_lshl_add_u32 v29, v29, 5, s7
    v_accvgpr_write_b32 a248, v29
    s_lshl_b32 s7, s72, 8
    s_add_u32 s7, s7, 122368
    v_lshl_add_u32 v29, v0, 2, s7
    v_accvgpr_write_b32 a249, v29
    s_lshl_b32 s81, s69, 6
    s_mul_i32 s80, s68, 1280
    s_add_u32 s80, s80, s81
    s_add_u32 s80, s80, 655360
    s_add_u32 s81, s81, s3
    s_add_u32 s81, s81, 46080
    s_waitcnt vmcnt(13)
    ds_write_b128 v2, a[120:123] offset:0
    ds_write_b128 v3, a[124:127] offset:0
    ds_write_b128 v4, a[128:131] offset:0
    ds_write_b128 v2, a[132:135] offset:3328
    ds_write_b128 v3, a[136:139] offset:3328
    ds_write_b128 v4, a[140:143] offset:3328
    ds_read_b128 a[120:123], v5 offset:0
    ds_read_b128 a[124:127], v5 offset:64
    ds_read_b128 a[128:131], v5 offset:128
    ds_read_b128 a[132:135], v5 offset:192
    ds_read_b128 a[136:139], v5 offset:256
    ds_read_b128 a[140:143], v5 offset:320
    buffer_load_dwordx4 a[220:223], v1, s[12:15], s73 offen offset:1024 nt
    buffer_load_dwordx4 a[224:227], v1, s[12:15], s73 offen offset:2048 nt
    buffer_load_dwordx4 a[228:231], v1, s[12:15], s73 offen offset:3072 nt
    buffer_load_dwordx4 a[232:235], v23, s[12:15], s73 offen offset:0 nt
    buffer_load_dwordx4 a[236:239], v23, s[12:15], s73 offen offset:1024 nt
    s_barrier
    global_load_dword v99, v98, s[64:65] sc1
    s_waitcnt vmcnt(13)
    ds_write_b128 v2, a[144:147] offset:0
    ds_write_b128 v3, a[148:151] offset:0
    ds_write_b128 v4, a[152:155] offset:0
    ds_write_b128 v2, a[156:159] offset:3328
    ds_write_b128 v3, a[160:163] offset:3328
    ds_write_b128 v4, a[164:167] offset:3328
    ds_read_b128 a[144:147], v5 offset:0
    ds_read_b128 a[148:151], v5 offset:64
    ds_read_b128 a[152:155], v5 offset:128
    ds_read_b128 a[156:159], v5 offset:192
    ds_read_b128 a[160:163], v5 offset:256
    ds_read_b128 a[164:167], v5 offset:320
    buffer_load_dwordx4 v[112:115], v1, s[12:15], s83 offen offset:0 nt
    buffer_load_dwordx4 v[116:119], v1, s[12:15], s83 offen offset:1024 nt
    buffer_load_dwordx4 v[120:123], v1, s[12:15], s83 offen offset:2048 nt
    buffer_load_dwordx4 v[124:127], v1, s[12:15], s83 offen offset:3072 nt
    buffer_load_dwordx4 v[128:131], v23, s[12:15], s83 offen offset:0 nt
    buffer_load_dwordx4 v[132:135], v23, s[12:15], s83 offen offset:1024 nt
    s_barrier
    s_waitcnt vmcnt(13)
    ds_write_b128 v2, a[168:171] offset:0
    ds_write_b128 v3, a[172:175] offset:0
    ds_write_b128 v4, a[176:179] offset:0
    ds_write_b128 v2, a[180:183] offset:3328
    ds_write_b128 v3, a[184:187] offset:3328
    ds_write_b128 v4, a[188:191] offset:3328
    ds_read_b128 a[168:171], v5 offset:0
    ds_read_b128 a[172:175], v5 offset:64
    ds_read_b128 a[176:179], v5 offset:128
    ds_read_b128 a[180:183], v5 offset:192
    ds_read_b128 a[184:187], v5 offset:256
    ds_read_b128 a[188:191], v5 offset:320
    buffer_load_dwordx4 v[136:139], v1, s[12:15], s84 offen offset:0 nt
    buffer_load_dwordx4 v[140:143], v1, s[12:15], s84 offen offset:1024 nt
    buffer_load_dwordx4 v[144:147], v1, s[12:15], s84 offen offset:2048 nt
    buffer_load_dwordx4 v[148:151], v1, s[12:15], s84 offen offset:3072 nt
    buffer_load_dwordx4 v[152:155], v23, s[12:15], s84 offen offset:0 nt
    buffer_load_dwordx4 v[156:159], v23, s[12:15], s84 offen offset:1024 nt
    s_barrier
    s_waitcnt vmcnt(12)
    s_mov_b32 s76, -1
    v_sad_u8 v100, v99, 0, 0
    s_nop 1
    v_add_u32_dpp v100, v100, v100 quad_perm:[1,0,3,2] row_mask:0xf bank_mask:0xf
    s_nop 1
    v_add_u32_dpp v100, v100, v100 quad_perm:[2,3,0,1] row_mask:0xf bank_mask:0xf
    v_cmp_gt_u32 vcc, 32, v100
    s_mov_b32 vcc_hi, 0
    s_cmp_eq_u64 vcc, 0
    s_cbranch_scc0 RDYLOOP
RDYOK:
    v_readlane_b32 s77, v99, s5
    s_nop 0
    s_cmp_eq_u32 s77, s96
    s_cselect_b32 s10, s18, 0
    s_mov_b32 s8, s16
    s_mov_b32 s9, s17
    s_mov_b32 s11, 0x20000
    buffer_load_dwordx4 a[240:243], v109, s[16:19], 0 offen sc1
    v_lshrrev_b32 v106, 3, v0
    v_mul_u32_u24 v106, 2560, v106
    v_and_b32 v107, 7, v0
    v_lshl_add_u32 v106, v107, 4, v106
    s_lshl_b32 s77, s69, 7
    s_add_u32 s77, s77, s3
    s_add_u32 s77, s77, 51200
    s_cmp_lt_u32 s69, 20
    s_cselect_b32 s77, s77, 1879048176
    s_cmp_eq_u32 s72, 3
    s_cselect_b32 s77, s77, 1879048176
    v_add_u32 v106, s77, v106
    v_add_u32 v107, 20480, v106
    v_mov_b32 v108, 2147483632
    v_cmp_le_u32 vcc, 32, v0
    s_nop 1
    v_cndmask_b32 v107, v107, v108, vcc
    buffer_load_dwordx4 a[240:243], v106, s[16:19], 0 offen sc1
    v_accvgpr_write_b32 a250, v106
    buffer_load_dwordx4 a[240:243], v107, s[16:19], 0 offen sc1
    v_accvgpr_write_b32 a251, v107
    s_mul_i32 s77, s70, 3072
    s_mul_i32 s78, s72, 96
    s_add_u32 s77, s77, s78
    s_add_u32 s77, s77, s3
    v_lshrrev_b32 v24, 4, v0
    v_mul_u32_u24 v24, 384, v24
    v_and_b32 v25, 15, v0
    v_min_u32 v25, 11, v25
    v_lshl_add_u32 v24, v25, 3, v24
    buffer_load_dwordx2 v[64:65], v24, s[16:19], s77 offen offset:0 sc1
    buffer_load_dwordx2 v[66:67], v24, s[16:19], s77 offen offset:1536 sc1
    s_cmp_lg_u32 s72, 1
    s_cbranch_scc1 NOBASE0
    s_cmp_ge_u32 s69, 20
    s_cbranch_scc1 NOBASE0
    v_mov_b32 v28, v22
    s_lshl_b32 s77, s69, 6
    s_add_u32 s77, s77, s3
    s_add_u32 s77, s77, 48640
    v_lshlrev_b32 v27, 2, v0
    v_mov_b32_dpp v29, v28 quad_perm:[1,1,1,1] row_mask:0xf bank_mask:0xf
    v_mov_b32_dpp v30, v28 quad_perm:[2,2,2,2] row_mask:0xf bank_mask:0xf
    v_mov_b32_dpp v31, v28 quad_perm:[3,3,3,3] row_mask:0xf bank_mask:0xf
    s_mov_b32 exec_lo, 0x1111
    s_mov_b32 exec_hi, 0x0
    buffer_store_dwordx4 v[28:31], v27, s[8:11], s77 offen
    s_cmp_eq_u32 s10, 0
    s_cbranch_scc1 SLOW1
BACK1:
    s_mov_b64 exec, -1
NOBASE0:
    ds_write_b128 v2, a[216:219] offset:0
    ds_write_b128 v3, a[220:223] offset:0
    ds_write_b128 v4, a[224:227] offset:0
    ds_write_b128 v2, a[228:231] offset:3328
    ds_write_b128 v3, a[232:235] offset:3328
    ds_write_b128 v4, a[236:239] offset:3328
    ds_read_b64_tr_b16 a[192:193], v6 offset:0
    ds_read_b64_tr_b16 a[196:197], v6 offset:32
    ds_read_b64_tr_b16 a[200:201], v6 offset:64
    ds_read_b64_tr_b16 a[204:205], v6 offset:96
    ds_read_b64_tr_b16 a[208:209], v6 offset:128
    ds_read_b64_tr_b16 a[212:213], v6 offset:160
    ds_read_b64_tr_b16 a[216:217], v6 offset:192
    ds_read_b64_tr_b16 a[220:221], v6 offset:224
    ds_read_b64_tr_b16 a[224:225], v6 offset:256
    ds_read_b64_tr_b16 a[228:229], v6 offset:288
    ds_read_b64_tr_b16 a[232:233], v6 offset:320
    ds_read_b64_tr_b16 a[236:237], v6 offset:352
    buffer_load_dwordx4 v[160:163], v1, s[12:15], s85 offen offset:0 nt
    s_waitcnt vmcnt(12)
    ds_write_b128 v2, v[112:115] offset:0
    ds_write_b128 v3, v[116:119] offset:0
    ds_write_b128 v4, v[120:123] offset:0
    ds_write_b128 v2, v[124:127] offset:3328
    ds_write_b128 v3, v[128:131] offset:3328
    ds_write_b128 v4, v[132:135] offset:3328
    ds_read_b64_tr_b16 a[194:195], v6 offset:0
    ds_read_b64_tr_b16 a[198:199], v6 offset:32
    ds_read_b64_tr_b16 a[202:203], v6 offset:64
    ds_read_b64_tr_b16 a[206:207], v6 offset:96
    ds_read_b64_tr_b16 a[210:211], v6 offset:128
    ds_read_b64_tr_b16 a[214:215], v6 offset:160
    ds_read_b64_tr_b16 a[218:219], v6 offset:192
    ds_read_b64_tr_b16 a[222:223], v6 offset:224
    ds_read_b64_tr_b16 a[226:227], v6 offset:256
    ds_read_b64_tr_b16 a[230:231], v6 offset:288
    ds_read_b64_tr_b16 a[234:235], v6 offset:320
    ds_read_b64_tr_b16 a[238:239], v6 offset:352
    buffer_load_dwordx4 v[164:167], v1, s[12:15], s85 offen offset:1024 nt
    buffer_load_dwordx4 v[168:171], v1, s[12:15], s85 offen offset:2048 nt
    buffer_load_dwordx4 v[172:175], v1, s[12:15], s85 offen offset:3072 nt
    buffer_load_dwordx4 v[176:179], v23, s[12:15], s85 offen offset:0 nt
    buffer_load_dwordx4 v[180:183], v23, s[12:15], s85 offen offset:1024 nt
    s_barrier
    buffer_load_dwordx4 v[184:187], v1, s[12:15], s86 offen offset:0 nt
    s_waitcnt vmcnt(12)
    ds_write_b128 v2, v[136:139] offset:0
    ds_write_b128 v3, v[140:143] offset:0
    ds_write_b128 v4, v[144:147] offset:0
    ds_write_b128 v2, v[148:151] offset:3328
    ds_write_b128 v3, v[152:155] offset:3328
    ds_write_b128 v4, v[156:159] offset:3328
    ds_read_b64_tr_b16 v[112:113], v6 offset:0
    ds_read_b64_tr_b16 v[116:117], v6 offset:32
    ds_read_b64_tr_b16 v[120:121], v6 offset:64
    ds_read_b64_tr_b16 v[124:125], v6 offset:96
    ds_read_b64_tr_b16 v[128:129], v6 offset:128
    ds_read_b64_tr_b16 v[132:133], v6 offset:160
    ds_read_b64_tr_b16 v[136:137], v6 offset:192
    ds_read_b64_tr_b16 v[140:141], v6 offset:224
    ds_read_b64_tr_b16 v[144:145], v6 offset:256
    ds_read_b64_tr_b16 v[148:149], v6 offset:288
    ds_read_b64_tr_b16 v[152:153], v6 offset:320
    ds_read_b64_tr_b16 v[156:157], v6 offset:352
    buffer_load_dwordx4 v[188:191], v1, s[12:15], s86 offen offset:1024 nt
    buffer_load_dwordx4 v[192:195], v1, s[12:15], s86 offen offset:2048 nt
    buffer_load_dwordx4 v[196:199], v1, s[12:15], s86 offen offset:3072 nt
    buffer_load_dwordx4 v[200:203], v23, s[12:15], s86 offen offset:0 nt
    buffer_load_dwordx4 v[204:207], v23, s[12:15], s86 offen offset:1024 nt
    s_barrier
    s_waitcnt vmcnt(12)
    v_lshlrev_b32 v24, 16, v64
    v_and_b32 v25, 0xffff0000, v64
    v_lshlrev_b32 v26, 16, v65
    v_and_b32 v27, 0xffff0000, v65
    v_lshlrev_b32 v28, 16, v66
    v_and_b32 v29, 0xffff0000, v66
    v_lshlrev_b32 v30, 16, v67
    v_and_b32 v31, 0xffff0000, v67
    v_add_f32 v24, v24, v28
    v_add_f32 v25, v25, v29
    v_add_f32 v26, v26, v30
    v_add_f32 v27, v27, v31
    s_nop 0
    v_permlane32_swap_b32 v24, v26
    v_permlane32_swap_b32 v25, v27
    v_add_f32 v24, v24, v26
    v_add_f32 v25, v25, v27
    s_nop 1
    v_permlane16_swap_b32 v24, v25
    v_add_f32 v24, v24, v25
    v_cvt_pk_bf16_f32 v24, v24, v24
    ds_write_b16 v12, v24
    buffer_load_dwordx4 v[208:211], v1, s[12:15], s87 offen offset:0 nt
    v_mov_b32 v40, 0
    v_mov_b32 v41, 0
    v_mov_b32 v44, 0
    v_mov_b32 v45, 0
    v_mov_b32 v48, 0
    v_mov_b32 v49, 0
    v_mov_b32 v52, 0
    v_mov_b32 v53, 0
    v_mov_b32 v56, 0
    v_mov_b32 v57, 0
    v_mov_b32 v60, 0
    v_mov_b32 v61, 0
    v_mov_b32 v64, 0
    v_mov_b32 v65, 0
    v_mov_b32 v68, 0
    v_mov_b32 v69, 0
    v_mov_b32 v72, 0
    v_mov_b32 v73, 0
    v_mov_b32 v74, 0
    v_mov_b32 v75, 0
    v_mov_b32 v76, 0
    v_mov_b32 v77, 0
    v_mov_b32 v78, 0
    v_mov_b32 v79, 0
    v_mov_b32 v80, 0
    v_mov_b32 v81, 0
    v_mov_b32 v82, 0
    v_mov_b32 v83, 0
    v_mov_b32 v84, 0
    v_mov_b32 v85, 0
    v_mov_b32 v86, 0
    v_mov_b32 v87, 0
    buffer_load_dwordx4 v[212:215], v1, s[12:15], s87 offen offset:1024 nt
    buffer_load_dwordx4 v[216:219], v1, s[12:15], s87 offen offset:2048 nt
    s_waitcnt lgkmcnt(0)
    s_barrier
    ds_read_b128 v[28:31], v13 offset:0
    ds_read_b128 v[32:35], v13 offset:128
    ds_read_b128 v[36:39], v13 offset:256
    v_mov_b32 v18, 0x3dd53b94
    s_waitcnt lgkmcnt(2)
    v_smfmac_f32_16x16x64_bf16 v[40:43], v[28:31], a[0:7], v14
    v_smfmac_f32_16x16x64_bf16 v[44:47], v[28:31], a[24:31], v14
    v_smfmac_f32_16x16x64_bf16 v[48:51], v[28:31], a[48:55], v14
    v_smfmac_f32_16x16x64_bf16 v[52:55], v[28:31], a[72:79], v14
    v_smfmac_f32_16x16x64_bf16 v[56:59], v[28:31], a[96:103], v14
    v_smfmac_f32_16x16x64_bf16 v[60:63], v[28:31], a[120:127], v14
    v_smfmac_f32_16x16x64_bf16 v[64:67], v[28:31], a[144:151], v14
    v_smfmac_f32_16x16x64_bf16 v[68:71], v[28:31], a[168:175], v14
    buffer_load_dwordx4 v[220:223], v1, s[12:15], s87 offen offset:3072 nt
    s_waitcnt lgkmcnt(1)
    v_smfmac_f32_16x16x64_bf16 v[40:43], v[32:35], a[8:15], v14
    v_smfmac_f32_16x16x64_bf16 v[44:47], v[32:35], a[32:39], v14
    v_smfmac_f32_16x16x64_bf16 v[48:51], v[32:35], a[56:63], v14
    v_smfmac_f32_16x16x64_bf16 v[52:55], v[32:35], a[80:87], v14
    v_smfmac_f32_16x16x64_bf16 v[56:59], v[32:35], a[104:111], v14
    v_smfmac_f32_16x16x64_bf16 v[60:63], v[32:35], a[128:135], v14
    v_smfmac_f32_16x16x64_bf16 v[64:67], v[32:35], a[152:159], v14
    v_smfmac_f32_16x16x64_bf16 v[68:71], v[32:35], a[176:183], v14
    s_waitcnt lgkmcnt(0)
    v_smfmac_f32_16x16x64_bf16 v[40:43], v[36:39], a[16:23], v14
    v_smfmac_f32_16x16x64_bf16 v[44:47], v[36:39], a[40:47], v14
    v_smfmac_f32_16x16x64_bf16 v[48:51], v[36:39], a[64:71], v14
    v_smfmac_f32_16x16x64_bf16 v[52:55], v[36:39], a[88:95], v14
    v_smfmac_f32_16x16x64_bf16 v[56:59], v[36:39], a[112:119], v14
    v_smfmac_f32_16x16x64_bf16 v[60:63], v[36:39], a[136:143], v14
    v_smfmac_f32_16x16x64_bf16 v[64:67], v[36:39], a[160:167], v14
    v_smfmac_f32_16x16x64_bf16 v[68:71], v[36:39], a[184:191], v14
    buffer_load_dwordx4 v[224:227], v23, s[12:15], s87 offen offset:0 nt
    v_add_f32 v24, v40, v41
    v_add_f32 v44, v44, v45
    v_add_f32 v48, v48, v49
    v_max3_f32 v26, v24, v44, v48
    v_add_f32 v52, v52, v53
    v_add_f32 v25, v56, v57
    v_max3_f32 v26, v26, v52, v25
    v_add_f32 v60, v60, v61
    v_add_f32 v64, v64, v65
    v_max3_f32 v26, v26, v60, v64
    v_add_f32 v68, v68, v69
    v_max_f32 v26, v26, v68
    v_mov_b32_dpp v24, v44 quad_perm:[0,1,2,3] row_mask:0x2 bank_mask:0xf
    v_mov_b32_dpp v25, v60 quad_perm:[0,1,2,3] row_mask:0x2 bank_mask:0xf
    v_max_f32_dpp v26, v26, v26 row_ror:8 row_mask:0xf bank_mask:0xf
    v_mov_b32_dpp v24, v48 quad_perm:[0,1,2,3] row_mask:0x4 bank_mask:0xf
    v_mov_b32_dpp v25, v64 quad_perm:[0,1,2,3] row_mask:0x4 bank_mask:0xf
    v_max_f32_dpp v26, v26, v26 row_ror:4 row_mask:0xf bank_mask:0xf
    v_mov_b32_dpp v24, v52 quad_perm:[0,1,2,3] row_mask:0x8 bank_mask:0xf
    v_mov_b32_dpp v25, v68 quad_perm:[0,1,2,3] row_mask:0x8 bank_mask:0xf
    v_max_f32_dpp v26, v26, v26 row_ror:2 row_mask:0xf bank_mask:0xf
    v_accvgpr_read_b32 v27, a252
    s_nop 0
    v_max_f32_dpp v26, v26, v26 row_ror:1 row_mask:0xf bank_mask:0xf
    buffer_load_dwordx4 v[228:231], v23, s[12:15], s87 offen offset:1024 nt
    s_barrier
    v_mul_f32 v26, v26, v18
    v_fma_f32 v24, v24, v18, -v26
    v_fma_f32 v25, v25, v18, -v26
    v_exp_f32 v24, v24
    v_exp_f32 v25, v25
    s_nop 0
    v_cvt_pk_bf16_f32 v28, v24, v25
    ds_write_b16 v19, v28
    ds_write_b16_d16_hi v19, v28 offset:128
    s_mov_b32 exec_lo, 0xff00ff
    s_mov_b32 exec_hi, 0xff00ff00
    ds_read_b128 v[72:75], v27 offset:0
    ds_read_b128 v[76:79], v27 offset:64
    ds_read_b128 v[80:83], v27 offset:128
    ds_read_b128 v[84:87], v27 offset:192
    s_mov_b64 exec, -1
    v_add_f32 v27, v24, v25
    v_mov_b32 v40, 0
    v_mov_b32 v44, 0
    v_add_f32_dpp v27, v27, v27 row_ror:8 row_mask:0xf bank_mask:0xf
    v_mov_b32 v48, 0
    v_mov_b32 v52, 0
    v_add_f32_dpp v27, v27, v27 row_ror:4 row_mask:0xf bank_mask:0xf
    v_mov_b32 v56, 0
    v_mov_b32 v60, 0
    v_add_f32_dpp v27, v27, v27 row_ror:2 row_mask:0xf bank_mask:0xf
    s_lshl_b32 s78, s72, 3
    s_add_u32 s78, s78, 125440
    v_add_f32_dpp v27, v27, v27 row_ror:1 row_mask:0xf bank_mask:0xf
    v_mov_b32 v28, v27
    s_nop 1
    v_permlane32_swap_b32 v27, v28
    v_add_f32 v27, v27, v28
    v_mov_b32 v28, v27
    s_nop 1
    v_permlane16_swap_b32 v27, v28
    v_add_f32 v27, v27, v28
    v_mov_b32 v28, s78
    ds_write_b64 v28, v[26:27]
    s_waitcnt vmcnt(12)
    ds_write_b128 v2, v[160:163] offset:0
    ds_write_b128 v3, v[164:167] offset:0
    ds_write_b128 v4, v[168:171] offset:0
    ds_write_b128 v2, v[172:175] offset:3328
    ds_write_b128 v3, v[176:179] offset:3328
    ds_write_b128 v4, v[180:183] offset:3328
    ds_read_b64_tr_b16 v[114:115], v6 offset:0
    ds_read_b64_tr_b16 v[118:119], v6 offset:32
    ds_read_b64_tr_b16 v[122:123], v6 offset:64
    ds_read_b64_tr_b16 v[126:127], v6 offset:96
    ds_read_b64_tr_b16 v[130:131], v6 offset:128
    ds_read_b64_tr_b16 v[134:135], v6 offset:160
    ds_read_b64_tr_b16 v[138:139], v6 offset:192
    ds_read_b64_tr_b16 v[142:143], v6 offset:224
    ds_read_b64_tr_b16 v[146:147], v6 offset:256
    ds_read_b64_tr_b16 v[150:151], v6 offset:288
    ds_read_b64_tr_b16 v[154:155], v6 offset:320
    ds_read_b64_tr_b16 v[158:159], v6 offset:352
    buffer_load_dwordx4 v[232:235], v1, s[12:15], s88 offen offset:0 nt
    buffer_load_dwordx4 v[236:239], v1, s[12:15], s88 offen offset:1024 nt
    s_waitcnt lgkmcnt(0)
    v_smfmac_f32_16x16x64_bf16 v[40:43], v[72:75], a[192:199], v14 abid:1
    v_smfmac_f32_16x16x64_bf16 v[44:47], v[72:75], a[200:207], v14 abid:1
    v_smfmac_f32_16x16x64_bf16 v[48:51], v[72:75], a[208:215], v14 abid:1
    v_smfmac_f32_16x16x64_bf16 v[52:55], v[72:75], a[216:223], v14 abid:1
    v_smfmac_f32_16x16x64_bf16 v[56:59], v[72:75], a[224:231], v14 abid:1
    v_smfmac_f32_16x16x64_bf16 v[60:63], v[72:75], a[232:239], v14 abid:1
    buffer_load_dwordx4 v[240:243], v1, s[12:15], s88 offen offset:2048 nt
    v_smfmac_f32_16x16x64_bf16 v[40:43], v[76:79], v[112:119], v14 abid:1
    v_smfmac_f32_16x16x64_bf16 v[44:47], v[76:79], v[120:127], v14 abid:1
    v_smfmac_f32_16x16x64_bf16 v[48:51], v[76:79], v[128:135], v14 abid:1
    v_smfmac_f32_16x16x64_bf16 v[52:55], v[76:79], v[136:143], v14 abid:1
    v_smfmac_f32_16x16x64_bf16 v[56:59], v[76:79], v[144:151], v14 abid:1
    v_smfmac_f32_16x16x64_bf16 v[60:63], v[76:79], v[152:159], v14 abid:1
    buffer_load_dwordx4 v[244:247], v1, s[12:15], s88 offen offset:3072 nt
    buffer_load_dwordx4 v[248:251], v23, s[12:15], s88 offen offset:0 nt
    buffer_load_dwordx4 v[252:255], v23, s[12:15], s88 offen offset:1024 nt
    s_barrier
    s_waitcnt vmcnt(12)
    ds_write_b128 v2, v[184:187] offset:0
    ds_write_b128 v3, v[188:191] offset:0
    ds_write_b128 v4, v[192:195] offset:0
    ds_write_b128 v2, v[196:199] offset:3328
    ds_write_b128 v3, v[200:203] offset:3328
    ds_write_b128 v4, v[204:207] offset:3328
    ds_read_b64_tr_b16 v[160:161], v6 offset:0
    ds_read_b64_tr_b16 v[164:165], v6 offset:32
    ds_read_b64_tr_b16 v[168:169], v6 offset:64
    ds_read_b64_tr_b16 v[172:173], v6 offset:96
    ds_read_b64_tr_b16 v[176:177], v6 offset:128
    ds_read_b64_tr_b16 v[180:181], v6 offset:160
    ds_read_b64_tr_b16 v[184:185], v6 offset:192
    ds_read_b64_tr_b16 v[188:189], v6 offset:224
    ds_read_b64_tr_b16 v[192:193], v6 offset:256
    ds_read_b64_tr_b16 v[196:197], v6 offset:288
    ds_read_b64_tr_b16 v[200:201], v6 offset:320
    ds_read_b64_tr_b16 v[204:205], v6 offset:352
    buffer_load_dwordx4 v[88:91], v1, s[12:15], s89 offen offset:0 nt
    buffer_load_dwordx4 v[92:95], v1, s[12:15], s89 offen offset:1024 nt
    buffer_load_dwordx4 v[96:99], v1, s[12:15], s89 offen offset:2048 nt
    buffer_load_dwordx4 v[100:103], v1, s[12:15], s89 offen offset:3072 nt
    buffer_load_dwordx4 v[104:107], v23, s[12:15], s89 offen offset:0 nt
    buffer_load_dwordx4 v[108:111], v23, s[12:15], s89 offen offset:1024 nt
    s_waitcnt vmcnt(12)
    ds_write_b128 v2, v[208:211] offset:0
    ds_write_b128 v3, v[212:215] offset:0
    ds_write_b128 v4, v[216:219] offset:0
    ds_write_b128 v2, v[220:223] offset:3328
    ds_write_b128 v3, v[224:227] offset:3328
    ds_write_b128 v4, v[228:231] offset:3328
    ds_read_b64_tr_b16 v[162:163], v6 offset:0
    ds_read_b64_tr_b16 v[166:167], v6 offset:32
    ds_read_b64_tr_b16 v[170:171], v6 offset:64
    ds_read_b64_tr_b16 v[174:175], v6 offset:96
    ds_read_b64_tr_b16 v[178:179], v6 offset:128
    ds_read_b64_tr_b16 v[182:183], v6 offset:160
    ds_read_b64_tr_b16 v[186:187], v6 offset:192
    ds_read_b64_tr_b16 v[190:191], v6 offset:224
    ds_read_b64_tr_b16 v[194:195], v6 offset:256
    ds_read_b64_tr_b16 v[198:199], v6 offset:288
    ds_read_b64_tr_b16 v[202:203], v6 offset:320
    ds_read_b64_tr_b16 v[206:207], v6 offset:352
    v_and_b32 v23, 0xffff0000, v22
    v_lshlrev_b32 v22, 16, v22
    s_mov_b32 s82, 0x1010101
    s_mov_b32 s83, 0x1010101
    s_mov_b32 s84, 0x1ff01ff
    s_mov_b32 s85, 0x1ff01ff
    s_mov_b32 s86, 0xffffffff
    s_mov_b32 s87, 0xfffffff
    s_mov_b32 s88, 0xff00ff
    s_mov_b32 s89, 0xff00ff00
    s_mov_b32 s92, 0x1010101
    s_mov_b32 s93, 0x0
    s_cmp_ge_u32 s69, 20
    s_cbranch_scc1 TAILF
    v_lshrrev_b32 v38, 2, v0
    v_mul_u32_u24 v38, 1280, v38
    v_and_b32 v39, 3, v0
    v_lshl_add_u32 v39, v39, 4, v38
    s_mov_b32 m0, s67
    s_add_u32 s67, s67, 1024
    buffer_load_dwordx4 v39, s[24:27], s66 offen  lds
    s_add_u32 s66, s66, 20480
    s_mov_b32 m0, s67
    s_add_u32 s67, s67, 1024
    buffer_load_dwordx4 v39, s[24:27], s66 offen  lds
    s_add_u32 s66, s66, 20480
    s_mov_b32 m0, s67
    s_add_u32 s67, s67, 1024
    buffer_load_dwordx4 v39, s[24:27], s66 offen  lds
    s_add_u32 s66, s66, 20480
    s_waitcnt lgkmcnt(0)
    v_smfmac_f32_16x16x64_bf16 v[40:43], v[80:83], v[160:167], v14 abid:1
    v_smfmac_f32_16x16x64_bf16 v[44:47], v[80:83], v[168:175], v14 abid:1
    v_smfmac_f32_16x16x64_bf16 v[48:51], v[80:83], v[176:183], v14 abid:1
    v_smfmac_f32_16x16x64_bf16 v[52:55], v[80:83], v[184:191], v14 abid:1
    v_smfmac_f32_16x16x64_bf16 v[56:59], v[80:83], v[192:199], v14 abid:1
    v_smfmac_f32_16x16x64_bf16 v[60:63], v[80:83], v[200:207], v14 abid:1
    s_waitcnt vmcnt(9)
    ds_write_b128 v2, v[232:235] offset:0
    ds_write_b128 v3, v[236:239] offset:0
    ds_write_b128 v4, v[240:243] offset:0
    ds_write_b128 v2, v[244:247] offset:3328
    ds_write_b128 v3, v[248:251] offset:3328
    ds_write_b128 v4, v[252:255] offset:3328
    ds_read_b64_tr_b16 v[208:209], v6 offset:0
    ds_read_b64_tr_b16 v[212:213], v6 offset:32
    ds_read_b64_tr_b16 v[216:217], v6 offset:64
    ds_read_b64_tr_b16 v[220:221], v6 offset:96
    ds_read_b64_tr_b16 v[224:225], v6 offset:128
    ds_read_b64_tr_b16 v[228:229], v6 offset:160
    ds_read_b64_tr_b16 v[232:233], v6 offset:192
    ds_read_b64_tr_b16 v[236:237], v6 offset:224
    ds_read_b64_tr_b16 v[240:241], v6 offset:256
    ds_read_b64_tr_b16 v[244:245], v6 offset:288
    ds_read_b64_tr_b16 v[248:249], v6 offset:320
    ds_read_b64_tr_b16 v[252:253], v6 offset:352
    s_mov_b32 m0, s67
    s_add_u32 s67, s67, 1024
    buffer_load_dwordx4 v39, s[24:27], s66 offen  lds
    s_add_u32 s66, s66, 20480
    s_mov_b32 m0, s67
    s_add_u32 s67, s67, 1024
    buffer_load_dwordx4 v39, s[24:27], s66 offen  lds
    s_add_u32 s66, s66, 20480
    s_mov_b32 m0, s67
    s_add_u32 s67, s67, 1024
    buffer_load_dwordx4 v39, s[24:27], s66 offen  lds
    s_add_u32 s66, s66, 20480
    s_waitcnt vmcnt(11)
    ds_write_b128 v2, v[88:91] offset:0
    s_waitcnt vmcnt(10)
    ds_write_b128 v3, v[92:95] offset:0
    s_waitcnt vmcnt(9)
    ds_write_b128 v4, v[96:99] offset:0
    s_waitcnt vmcnt(8)
    ds_write_b128 v2, v[100:103] offset:3328
    s_waitcnt vmcnt(7)
    ds_write_b128 v3, v[104:107] offset:3328
    s_waitcnt vmcnt(6)
    ds_write_b128 v4, v[108:111] offset:3328
    ds_read_b64_tr_b16 v[210:211], v6 offset:0
    ds_read_b64_tr_b16 v[214:215], v6 offset:32
    ds_read_b64_tr_b16 v[218:219], v6 offset:64
    ds_read_b64_tr_b16 v[222:223], v6 offset:96
    ds_read_b64_tr_b16 v[226:227], v6 offset:128
    ds_read_b64_tr_b16 v[230:231], v6 offset:160
    ds_read_b64_tr_b16 v[234:235], v6 offset:192
    ds_read_b64_tr_b16 v[238:239], v6 offset:224
    ds_read_b64_tr_b16 v[242:243], v6 offset:256
    ds_read_b64_tr_b16 v[246:247], v6 offset:288
    ds_read_b64_tr_b16 v[250:251], v6 offset:320
    ds_read_b64_tr_b16 v[254:255], v6 offset:352
    s_branch ATT_LAST
TAILF:
    s_lshl_b32 s90, s72, 3
    s_add_u32 s90, s90, s68
    s_mul_i32 s90, s90, 24
    s_add_u32 s90, s90, s69
    s_sub_u32 s90, s90, 8
    s_mul_i32 s90, s90, 10240
    buffer_load_dwordx4 a[240:243], v1, s[20:23], s90 offen offset:0
    buffer_load_dwordx4 a[240:243], v1, s[20:23], s90 offen offset:1024
    buffer_load_dwordx4 a[240:243], v1, s[20:23], s90 offen offset:2048
    buffer_load_dwordx4 a[240:243], v1, s[20:23], s90 offen offset:3072
    s_add_u32 s90, s90, 4096
    buffer_load_dwordx4 a[240:243], v1, s[20:23], s90 offen offset:0
    buffer_load_dwordx4 a[240:243], v1, s[20:23], s90 offen offset:1024
    buffer_load_dwordx4 a[240:243], v1, s[20:23], s90 offen offset:2048
    s_waitcnt lgkmcnt(0)
    v_smfmac_f32_16x16x64_bf16 v[40:43], v[80:83], v[160:167], v14 abid:1
    v_smfmac_f32_16x16x64_bf16 v[44:47], v[80:83], v[168:175], v14 abid:1
    v_smfmac_f32_16x16x64_bf16 v[48:51], v[80:83], v[176:183], v14 abid:1
    v_smfmac_f32_16x16x64_bf16 v[52:55], v[80:83], v[184:191], v14 abid:1
    v_smfmac_f32_16x16x64_bf16 v[56:59], v[80:83], v[192:199], v14 abid:1
    v_smfmac_f32_16x16x64_bf16 v[60:63], v[80:83], v[200:207], v14 abid:1
    s_waitcnt vmcnt(13)
    ds_write_b128 v2, v[232:235] offset:0
    ds_write_b128 v3, v[236:239] offset:0
    ds_write_b128 v4, v[240:243] offset:0
    ds_write_b128 v2, v[244:247] offset:3328
    ds_write_b128 v3, v[248:251] offset:3328
    ds_write_b128 v4, v[252:255] offset:3328
    ds_read_b64_tr_b16 v[208:209], v6 offset:0
    ds_read_b64_tr_b16 v[212:213], v6 offset:32
    ds_read_b64_tr_b16 v[216:217], v6 offset:64
    ds_read_b64_tr_b16 v[220:221], v6 offset:96
    ds_read_b64_tr_b16 v[224:225], v6 offset:128
    ds_read_b64_tr_b16 v[228:229], v6 offset:160
    ds_read_b64_tr_b16 v[232:233], v6 offset:192
    ds_read_b64_tr_b16 v[236:237], v6 offset:224
    ds_read_b64_tr_b16 v[240:241], v6 offset:256
    ds_read_b64_tr_b16 v[244:245], v6 offset:288
    ds_read_b64_tr_b16 v[248:249], v6 offset:320
    ds_read_b64_tr_b16 v[252:253], v6 offset:352
    buffer_load_dwordx4 a[240:243], v1, s[20:23], s90 offen offset:3072
    s_add_u32 s90, s90, 4096
    buffer_load_dwordx4 a[240:243], v1, s[20:23], s90 offen offset:0
    buffer_load_dwordx4 a[240:243], v1, s[20:23], s90 offen offset:1024
    s_waitcnt vmcnt(15)
    ds_write_b128 v2, v[88:91] offset:0
    s_waitcnt vmcnt(14)
    ds_write_b128 v3, v[92:95] offset:0
    s_waitcnt vmcnt(13)
    ds_write_b128 v4, v[96:99] offset:0
    s_waitcnt vmcnt(12)
    ds_write_b128 v2, v[100:103] offset:3328
    s_waitcnt vmcnt(11)
    ds_write_b128 v3, v[104:107] offset:3328
    s_waitcnt vmcnt(10)
    ds_write_b128 v4, v[108:111] offset:3328
    ds_read_b64_tr_b16 v[210:211], v6 offset:0
    ds_read_b64_tr_b16 v[214:215], v6 offset:32
    ds_read_b64_tr_b16 v[218:219], v6 offset:64
    ds_read_b64_tr_b16 v[222:223], v6 offset:96
    ds_read_b64_tr_b16 v[226:227], v6 offset:128
    ds_read_b64_tr_b16 v[230:231], v6 offset:160
    ds_read_b64_tr_b16 v[234:235], v6 offset:192
    ds_read_b64_tr_b16 v[238:239], v6 offset:224
    ds_read_b64_tr_b16 v[242:243], v6 offset:256
    ds_read_b64_tr_b16 v[246:247], v6 offset:288
    ds_read_b64_tr_b16 v[250:251], v6 offset:320
    ds_read_b64_tr_b16 v[254:255], v6 offset:352
    s_branch ATT_LAST
LOOP:
    s_cmp_lt_u32 s69, 20
    s_cselect_b32 s5, s72, 4
    s_add_u32 s96, s3, 688128
    s_add_u32 s97, s96, 4096
    buffer_load_dwordx4 v[88:91], v11, s[16:19], s96 offen sc1
    buffer_load_dwordx4 v[92:95], v11, s[16:19], s97 offen sc1
    ds_read_b64_tr_b16 v[40:41], v16 offset:0
    ds_read_b64_tr_b16 v[42:43], v16 offset:1536
    ds_read_b64_tr_b16 v[44:45], v16 offset:12288
    ds_read_b64_tr_b16 v[46:47], v16 offset:13824
    ds_read_b64_tr_b16 v[48:49], v17 offset:24576
    ds_read_b64_tr_b16 v[50:51], v16 offset:32
    ds_read_b64_tr_b16 v[52:53], v16 offset:1568
    ds_read_b64_tr_b16 v[54:55], v16 offset:12320
    ds_read_b64_tr_b16 v[56:57], v16 offset:13856
    ds_read_b64_tr_b16 v[58:59], v17 offset:24608
    ds_read_b64_tr_b16 v[60:61], v16 offset:64
    ds_read_b64_tr_b16 v[62:63], v16 offset:1600
    ds_read_b64_tr_b16 v[64:65], v16 offset:12352
    ds_read_b64_tr_b16 v[66:67], v16 offset:13888
    ds_read_b64_tr_b16 v[68:69], v17 offset:24640
    v_and_b32 v25, 15, v0
    v_cmp_eq_u32 vcc, 12, v25
    v_mov_b32 v36, 0x3f803f80
    s_nop 0
    v_cndmask_b32 v70, 0, v36, vcc
    v_mov_b32 v71, v70
    v_mov_b32 v72, v70
    v_mov_b32 v73, v70
    v_mov_b32 v74, v70
    v_mov_b32 v75, v70
    v_mov_b32 v76, v70
    v_mov_b32 v77, v70
    v_mov_b32 v78, v70
    v_mov_b32 v79, v70
    s_add_u32 s79, s3, 4096
    s_mul_i32 s77, s72, 6656
    v_mul_u32_u24 v26, 103, v0
    v_lshrrev_b32 v26, 10, v26
    v_lshl_add_u32 v26, v26, 4, v1
    v_add_u32 v26, s77, v26
    v_mul_u32_u24 v27, 176, v25
    v_add_u32 v27, s77, v27
    v_lshrrev_b32 v28, 4, v0
    v_lshl_add_u32 v29, v28, 3, v27
    v_lshl_add_u32 v27, v28, 4, v27
    s_mul_i32 s77, s71, 160
    s_add_u32 s77, s77, s3
    s_sub_u32 s77, s77, 640768
    s_waitcnt lgkmcnt(0)
    s_mov_b32 exec_lo, 0x3ff
    s_mov_b32 exec_hi, 0x0
    s_mov_b32 s76, 1
POLL2:
    buffer_load_dword v24, v1, s[16:19], s77 offen sc1
POLLW2:
    s_waitcnt vmcnt(0)
    v_cmp_eq_u32 vcc, -1, v24
    s_cbranch_vccnz AGAIN2
POLLX2:
    s_mov_b64 exec, s[86:87]
    buffer_load_dwordx4 v[80:83], v8, s[16:19], 0 offen sc1
    buffer_load_dwordx4 v[84:87], v9, s[16:19], 0 offen sc1
    buffer_load_dwordx4 v[88:91], v11, s[16:19], s96 offen sc1
    buffer_load_dwordx4 v[92:95], v11, s[16:19], s97 offen sc1
    s_waitcnt vmcnt(2)
BW3:
    ds_write_b128 v26, v[80:83]
    ds_write_b128 v26, v[84:87] offset:1056
    v_max_u32 v24, v80, v84
    v_cmp_eq_u32 vcc, -1, v24
    s_mov_b64 exec, s[84:85]
    ds_read_b128 v[70:73], v27
    ds_read_b128 v[74:77], v27 offset:64
    ds_read_b64 v[78:79], v29 offset:128
    s_mov_b64 exec, -1
    s_cbranch_vccnz BR3
BX3:
    s_cmp_lg_u32 s5, 1
    s_cbranch_scc1 NOOWL
    buffer_load_dword a244, v20, s[16:19], 0 offen sc1
    buffer_load_dword a245, v21, s[16:19], 0 offen sc1
NOOWL:
    s_waitcnt lgkmcnt(2)
    v_mfma_f32_16x16x32_bf16 v[24:27], v[70:73], v[40:43], 0
    v_mfma_f32_16x16x32_bf16 v[32:35], v[70:73], v[60:63], 0
    s_waitcnt lgkmcnt(0)
    v_mfma_f32_16x16x32_bf16 v[24:27], v[74:77], v[44:47], v[24:27]
    v_mfma_f32_16x16x32_bf16 v[32:35], v[74:77], v[64:67], v[32:35]
    v_mfma_f32_16x16x16_bf16 v[24:27], v[78:79], v[48:49], v[24:27]
    v_mfma_f32_16x16x16_bf16 v[32:35], v[78:79], v[68:69], v[32:35]
    v_mfma_f32_16x16x32_bf16 v[28:31], v[70:73], v[50:53], 0
    v_mfma_f32_16x16x32_bf16 v[36:39], v[70:73], v[70:73], 0
    v_mfma_f32_16x16x32_bf16 v[28:31], v[74:77], v[54:57], v[28:31]
    v_mfma_f32_16x16x32_bf16 v[36:39], v[74:77], v[74:77], v[36:39]
    v_mfma_f32_16x16x16_bf16 v[28:31], v[78:79], v[58:59], v[28:31]
    v_mfma_f32_16x16x16_bf16 v[36:39], v[78:79], v[78:79], v[36:39]
    s_nop 0
    v_add_f32 v24, v24, v25
    v_add_f32 v26, v26, v27
    v_add_f32 v24, v24, v26
    v_add_f32 v32, v32, v33
    v_add_f32 v34, v34, v35
    v_add_f32 v32, v32, v34
    s_nop 1
    v_permlane32_swap_b32 v24, v32
    v_add_f32 v28, v28, v29
    v_add_f32 v30, v30, v31
    v_add_f32 v36, v36, v37
    v_add_f32 v38, v38, v39
    v_add_f32 v24, v24, v32
    v_add_f32 v28, v28, v30
    v_add_f32 v36, v36, v38
    s_nop 1
    v_permlane32_swap_b32 v28, v36
    v_add_f32 v28, v28, v36
    s_nop 1
    v_permlane16_swap_b32 v24, v28
    v_add_f32 v24, v24, v28
    buffer_store_dword v24, v10, s[8:11], s3 offen
    s_cmp_eq_u32 s10, 0
    s_cbranch_scc1 SLOW4
BACK4:
    v_mov_b32 v40, 0
    v_mov_b32 v41, 0
    v_mov_b32 v44, 0
    v_mov_b32 v45, 0
    v_mov_b32 v48, 0
    v_mov_b32 v49, 0
    v_mov_b32 v52, 0
    v_mov_b32 v53, 0
    v_mov_b32 v56, 0
    v_mov_b32 v57, 0
    v_mov_b32 v60, 0
    v_mov_b32 v61, 0
    v_mov_b32 v64, 0
    v_mov_b32 v65, 0
    v_mov_b32 v68, 0
    v_mov_b32 v69, 0
    v_mov_b32 v72, 0
    v_mov_b32 v73, 0
    v_mov_b32 v74, 0
    v_mov_b32 v75, 0
    v_mov_b32 v76, 0
    v_mov_b32 v77, 0
    v_mov_b32 v78, 0
    v_mov_b32 v79, 0
    v_mov_b32 v80, 0
    v_mov_b32 v81, 0
    v_mov_b32 v82, 0
    v_mov_b32 v83, 0
    v_mov_b32 v84, 0
    v_mov_b32 v85, 0
    v_mov_b32 v86, 0
    v_mov_b32 v87, 0
    s_waitcnt vmcnt(1)
    v_add_f32 v88, v88, v92
    v_add_f32 v89, v89, v93
    v_add_f32 v90, v90, v94
    v_add_f32 v91, v91, v95
    s_nop 0
    v_permlane32_swap_b32 v88, v90
    v_permlane32_swap_b32 v89, v91
    v_add_f32 v88, v88, v90
    v_add_f32 v89, v89, v91
    s_nop 1
    v_permlane16_swap_b32 v88, v89
    v_add_f32 v88, v88, v89
    v_mul_f32 v7, 0x3acccccd, v88
    s_mov_b32 s76, 1
POLL5:
    buffer_load_dwordx4 v[24:27], v11, s[16:19], s3 offen sc1
    buffer_load_dwordx4 v[28:31], v11, s[16:19], s79 offen sc1
    s_waitcnt vmcnt(0)
    v_add_f32 v24, v24, v28
    v_add_f32 v25, v25, v29
    v_add_f32 v26, v26, v30
    v_add_f32 v27, v27, v31
    s_nop 0
    v_permlane32_swap_b32 v24, v26
    v_permlane32_swap_b32 v25, v27
    v_add_f32 v24, v24, v26
    v_add_f32 v25, v25, v27
    s_nop 1
    v_permlane16_swap_b32 v24, v25
    v_add_f32 v24, v24, v25
    v_cmp_u_f32 vcc, v24, v24
    s_cbranch_vccnz AGAIN5
POLLX5:
    v_readlane_b32 s77, v24, 15
    s_mov_b32 vcc_lo, 0x70007000
    s_mov_b32 vcc_hi, 0x70007000
    v_fma_f32 v25, -s77, v7, v24
    v_cvt_pk_bf16_f32 v25, v25, v25
    ds_write_b16 v12, v25
    v_cndmask_b32 v26, 0, v24, vcc
    s_nop 1
    v_add_f32_dpp v26, v26, v26 quad_perm:[1,0,3,2] row_mask:0xf bank_mask:0xf
    s_nop 1
    v_add_f32_dpp v26, v26, v26 quad_perm:[2,3,0,1] row_mask:0xf bank_mask:0xf
    v_mov_b32 v27, v26
    s_nop 1
    v_permlane32_swap_b32 v26, v27
    v_add_f32 v26, v26, v27
    s_waitcnt lgkmcnt(0)
    s_barrier
    ds_read_b128 v[28:31], v13 offset:0
    ds_read_b128 v[32:35], v13 offset:128
    ds_read_b128 v[36:39], v13 offset:256
    v_mov_b32 v27, v26
    v_mov_b32 v25, s77
    v_subrev_f32 v25, 0x44200000, v25
    v_permlane16_swap_b32 v26, v27
    v_add_f32 v26, v26, v27
    v_mul_f32 v24, 0x3acccccd, v25
    v_readlane_b32 s77, v26, 15
    v_mul_f32 v24, v24, v24
    s_mov_b32 s78, 0x3acccccd
    v_sub_f32 v26, s77, v25
    v_fma_f32 v26, v26, s78, -v24
    v_max_f32 v26, 0, v26
    v_add_f32 v26, 0x3727c5ac, v26
    v_rsq_f32 v26, v26
    s_nop 0
    v_mul_f32 v18, 0x3dd53b94, v26
    s_waitcnt lgkmcnt(2)
    v_smfmac_f32_16x16x64_bf16 v[40:43], v[28:31], a[0:7], v14
    v_smfmac_f32_16x16x64_bf16 v[44:47], v[28:31], a[24:31], v14
    v_smfmac_f32_16x16x64_bf16 v[48:51], v[28:31], a[48:55], v14
    v_smfmac_f32_16x16x64_bf16 v[52:55], v[28:31], a[72:79], v14
    v_smfmac_f32_16x16x64_bf16 v[56:59], v[28:31], a[96:103], v14
    v_smfmac_f32_16x16x64_bf16 v[60:63], v[28:31], a[120:127], v14
    v_smfmac_f32_16x16x64_bf16 v[64:67], v[28:31], a[144:151], v14
    v_smfmac_f32_16x16x64_bf16 v[68:71], v[28:31], a[168:175], v14
    s_waitcnt lgkmcnt(1)
    v_smfmac_f32_16x16x64_bf16 v[40:43], v[32:35], a[8:15], v14
    v_smfmac_f32_16x16x64_bf16 v[44:47], v[32:35], a[32:39], v14
    v_smfmac_f32_16x16x64_bf16 v[48:51], v[32:35], a[56:63], v14
    v_smfmac_f32_16x16x64_bf16 v[52:55], v[32:35], a[80:87], v14
    v_smfmac_f32_16x16x64_bf16 v[56:59], v[32:35], a[104:111], v14
    v_smfmac_f32_16x16x64_bf16 v[60:63], v[32:35], a[128:135], v14
    v_smfmac_f32_16x16x64_bf16 v[64:67], v[32:35], a[152:159], v14
    v_smfmac_f32_16x16x64_bf16 v[68:71], v[32:35], a[176:183], v14
    s_waitcnt lgkmcnt(0)
    v_smfmac_f32_16x16x64_bf16 v[40:43], v[36:39], a[16:23], v14
    v_smfmac_f32_16x16x64_bf16 v[44:47], v[36:39], a[40:47], v14
    v_smfmac_f32_16x16x64_bf16 v[48:51], v[36:39], a[64:71], v14
    v_smfmac_f32_16x16x64_bf16 v[52:55], v[36:39], a[88:95], v14
    v_smfmac_f32_16x16x64_bf16 v[56:59], v[36:39], a[112:119], v14
    v_smfmac_f32_16x16x64_bf16 v[60:63], v[36:39], a[136:143], v14
    v_smfmac_f32_16x16x64_bf16 v[64:67], v[36:39], a[160:167], v14
    v_smfmac_f32_16x16x64_bf16 v[68:71], v[36:39], a[184:191], v14
    s_nop 0
    v_add_f32 v24, v40, v41
    v_add_f32 v44, v44, v45
    v_add_f32 v48, v48, v49
    v_max3_f32 v26, v24, v44, v48
    v_add_f32 v52, v52, v53
    v_add_f32 v25, v56, v57
    v_max3_f32 v26, v26, v52, v25
    v_add_f32 v60, v60, v61
    v_add_f32 v64, v64, v65
    v_max3_f32 v26, v26, v60, v64
    v_add_f32 v68, v68, v69
    v_max_f32 v26, v26, v68
    v_mov_b32_dpp v24, v44 quad_perm:[0,1,2,3] row_mask:0x2 bank_mask:0xf
    v_mov_b32_dpp v25, v60 quad_perm:[0,1,2,3] row_mask:0x2 bank_mask:0xf
    v_max_f32_dpp v26, v26, v26 row_ror:8 row_mask:0xf bank_mask:0xf
    v_mov_b32_dpp v24, v48 quad_perm:[0,1,2,3] row_mask:0x4 bank_mask:0xf
    v_mov_b32_dpp v25, v64 quad_perm:[0,1,2,3] row_mask:0x4 bank_mask:0xf
    v_max_f32_dpp v26, v26, v26 row_ror:4 row_mask:0xf bank_mask:0xf
    v_mov_b32_dpp v24, v52 quad_perm:[0,1,2,3] row_mask:0x8 bank_mask:0xf
    v_mov_b32_dpp v25, v68 quad_perm:[0,1,2,3] row_mask:0x8 bank_mask:0xf
    v_max_f32_dpp v26, v26, v26 row_ror:2 row_mask:0xf bank_mask:0xf
    v_accvgpr_read_b32 v27, a252
    s_nop 0
    v_max_f32_dpp v26, v26, v26 row_ror:1 row_mask:0xf bank_mask:0xf
    v_mul_f32 v26, v26, v18
    v_fma_f32 v24, v24, v18, -v26
    v_fma_f32 v25, v25, v18, -v26
    v_exp_f32 v24, v24
    v_exp_f32 v25, v25
    s_nop 0
    v_cvt_pk_bf16_f32 v28, v24, v25
    ds_write_b16 v19, v28
    ds_write_b16_d16_hi v19, v28 offset:128
    s_mov_b64 exec, s[88:89]
    ds_read_b128 v[72:75], v27 offset:0
    ds_read_b128 v[76:79], v27 offset:64
    ds_read_b128 v[80:83], v27 offset:128
    ds_read_b128 v[84:87], v27 offset:192
    s_mov_b64 exec, -1
    v_add_f32 v27, v24, v25
    v_mov_b32 v40, 0
    v_mov_b32 v44, 0
    v_add_f32_dpp v27, v27, v27 row_ror:8 row_mask:0xf bank_mask:0xf
    v_mov_b32 v48, 0
    v_mov_b32 v52, 0
    v_add_f32_dpp v27, v27, v27 row_ror:4 row_mask:0xf bank_mask:0xf
    v_mov_b32 v56, 0
    v_mov_b32 v60, 0
    v_add_f32_dpp v27, v27, v27 row_ror:2 row_mask:0xf bank_mask:0xf
    s_lshl_b32 s78, s72, 3
    s_add_u32 s78, s78, 125440
    v_add_f32_dpp v27, v27, v27 row_ror:1 row_mask:0xf bank_mask:0xf
    v_mov_b32 v28, v27
    s_nop 1
    v_permlane32_swap_b32 v27, v28
    v_add_f32 v27, v27, v28
    v_mov_b32 v28, v27
    s_nop 1
    v_permlane16_swap_b32 v27, v28
    v_add_f32 v27, v27, v28
    v_mov_b32 v28, s78
    ds_write_b64 v28, v[26:27]
    s_waitcnt lgkmcnt(4)
    v_smfmac_f32_16x16x64_bf16 v[40:43], v[72:75], a[192:199], v14 abid:1
    v_smfmac_f32_16x16x64_bf16 v[44:47], v[72:75], a[200:207], v14 abid:1
    v_smfmac_f32_16x16x64_bf16 v[48:51], v[72:75], a[208:215], v14 abid:1
    v_smfmac_f32_16x16x64_bf16 v[52:55], v[72:75], a[216:223], v14 abid:1
    v_smfmac_f32_16x16x64_bf16 v[56:59], v[72:75], a[224:231], v14 abid:1
    v_smfmac_f32_16x16x64_bf16 v[60:63], v[72:75], a[232:239], v14 abid:1
    s_waitcnt lgkmcnt(3)
    v_smfmac_f32_16x16x64_bf16 v[40:43], v[76:79], v[112:119], v14 abid:1
    v_smfmac_f32_16x16x64_bf16 v[44:47], v[76:79], v[120:127], v14 abid:1
    v_smfmac_f32_16x16x64_bf16 v[48:51], v[76:79], v[128:135], v14 abid:1
    v_smfmac_f32_16x16x64_bf16 v[52:55], v[76:79], v[136:143], v14 abid:1
    v_smfmac_f32_16x16x64_bf16 v[56:59], v[76:79], v[144:151], v14 abid:1
    v_smfmac_f32_16x16x64_bf16 v[60:63], v[76:79], v[152:159], v14 abid:1
    s_waitcnt lgkmcnt(2)
    v_smfmac_f32_16x16x64_bf16 v[40:43], v[80:83], v[160:167], v14 abid:1
    v_smfmac_f32_16x16x64_bf16 v[44:47], v[80:83], v[168:175], v14 abid:1
    v_smfmac_f32_16x16x64_bf16 v[48:51], v[80:83], v[176:183], v14 abid:1
    v_smfmac_f32_16x16x64_bf16 v[52:55], v[80:83], v[184:191], v14 abid:1
    v_smfmac_f32_16x16x64_bf16 v[56:59], v[80:83], v[192:199], v14 abid:1
    v_smfmac_f32_16x16x64_bf16 v[60:63], v[80:83], v[200:207], v14 abid:1
    s_waitcnt lgkmcnt(0)
ATT_LAST:
    s_waitcnt lgkmcnt(8)
    v_smfmac_f32_16x16x64_bf16 v[40:43], v[84:87], v[208:215], v14 abid:1
    v_smfmac_f32_16x16x64_bf16 v[44:47], v[84:87], v[216:223], v14 abid:1
    s_waitcnt lgkmcnt(4)
    v_smfmac_f32_16x16x64_bf16 v[48:51], v[84:87], v[224:231], v14 abid:1
    v_smfmac_f32_16x16x64_bf16 v[52:55], v[84:87], v[232:239], v14 abid:1
    s_waitcnt lgkmcnt(0)
    v_smfmac_f32_16x16x64_bf16 v[56:59], v[84:87], v[240:247], v14 abid:1
    v_smfmac_f32_16x16x64_bf16 v[60:63], v[84:87], v[248:255], v14 abid:1
    s_lshl_b32 s77, s72, 8
    s_add_u32 s77, s77, 119296
    v_lshl_add_u32 v24, v0, 2, s77
    v_permlane16_swap_b32 v40, v44
    v_add_f32 v40, v40, v44
    ds_write_b32 v15, v40 offset:0
    v_permlane16_swap_b32 v48, v52
    v_add_f32 v48, v48, v52
    ds_write_b32 v15, v48 offset:256
    v_permlane16_swap_b32 v56, v60
    v_add_f32 v56, v56, v60
    ds_write_b32 v15, v56 offset:512
    v_and_b32 v25, 3, v0
    v_lshlrev_b32 v25, 3, v25
    v_add_u32 v25, 125440, v25
    s_waitcnt lgkmcnt(0)
    s_barrier
    ds_read_b64 v[32:33], v25
    ds_read2st64_b32 v[40:41], v24 offset0:0 offset1:3
    ds_read2st64_b32 v[42:43], v24 offset0:6 offset1:9
    s_mul_i32 s77, s70, 3072
    s_lshl_b32 s78, s71, 4
    s_add_u32 s77, s77, s78
    s_lshl_b32 s78, s72, 10
    s_add_u32 s77, s77, s78
    s_add_u32 s77, s77, s3
    s_add_u32 s77, s77, 32768
    s_lshl_b32 s78, s69, 3
    s_add_u32 s78, s78, s3
    s_add_u32 s78, s78, 45056
    s_cmp_eq_u32 s72, 3
    s_waitcnt lgkmcnt(2)
    v_max_f32_dpp v34, v32, v32 quad_perm:[1,0,3,2] row_mask:0xf bank_mask:0xf
    s_nop 1
    v_max_f32_dpp v34, v34, v34 quad_perm:[2,3,0,1] row_mask:0xf bank_mask:0xf
    v_sub_f32 v32, v32, v34
    v_exp_f32 v32, v32
    s_cbranch_scc1 OML
    s_waitcnt lgkmcnt(0)
    v_mul_f32_dpp v28, v32, v40 quad_perm:[0,0,0,0] row_mask:0xf bank_mask:0xf
    v_mul_f32_dpp v29, v32, v41 quad_perm:[1,1,1,1] row_mask:0xf bank_mask:0xf
    v_mul_f32_dpp v30, v32, v42 quad_perm:[2,2,2,2] row_mask:0xf bank_mask:0xf
    v_fmac_f32_dpp v28, v32, v43 quad_perm:[3,3,3,3] row_mask:0xf bank_mask:0xf
    v_add_f32 v29, v29, v30
    v_add_f32 v28, v28, v29
    s_nop 1
    v_mov_b32_dpp v29, v28 row_shl:1 row_mask:0xf bank_mask:0xf
    v_cvt_pk_bf16_f32 v28, v28, v29
    s_nop 1
    v_mov_b32_dpp v29, v28 row_shl:2 row_mask:0xf bank_mask:0xf
    v_mov_b32_dpp v30, v28 row_shl:4 row_mask:0xf bank_mask:0xf
    v_mov_b32_dpp v31, v28 row_shl:6 row_mask:0xf bank_mask:0xf
    s_mov_b64 exec, s[82:83]
    buffer_store_dwordx4 v[28:31], v1, s[8:11], s77 offen
    s_cmp_eq_u32 s10, 0
    s_cbranch_scc1 SLOW6
BACK6:
    s_mov_b64 exec, -1
ODONE:
    s_cmp_ge_u32 s69, 20
    s_cbranch_scc1 ROLEF
    s_cmp_eq_u32 s74, 0
    s_cbranch_scc1 WLATE
    v_accvgpr_read_b32 v2, a246
    v_accvgpr_read_b32 v3, a247
    v_accvgpr_read_b32 v4, a248
    v_mov_b32 v88, 0
    v_mov_b32 v92, 0
    v_mov_b32 v96, 0
    v_mov_b32 v100, 0
    v_mov_b32 v104, 0
    v_mov_b32 v108, 0
    ds_read_b64_tr_b16 v[40:41], v2 offset:0
    ds_read_b64_tr_b16 v[42:43], v2 offset:256
    ds_read_b64_tr_b16 v[64:65], v2 offset:32
    ds_read_b64_tr_b16 v[66:67], v2 offset:288
    ds_read_b64_tr_b16 v[44:45], v2 offset:2048
    ds_read_b64_tr_b16 v[46:47], v2 offset:2304
    ds_read_b64_tr_b16 v[68:69], v2 offset:2080
    ds_read_b64_tr_b16 v[70:71], v2 offset:2336
    ds_read_b64_tr_b16 v[48:49], v2 offset:4096
    ds_read_b64_tr_b16 v[50:51], v2 offset:4352
    s_cmp_lg_u32 s72, 1
    s_cbranch_scc1 NOOWN0
    v_accvgpr_read_b32 v28, a244
    v_accvgpr_read_b32 v29, a245
    v_max_u32 v30, v28, v29
    v_cmp_eq_u32 vcc, -1, v30
    s_cbranch_vccnz RETRY7
OK7:
    v_lshlrev_b32 v30, 16, v28
    v_and_b32 v28, 0xffff0000, v28
    v_lshlrev_b32 v31, 16, v29
    v_and_b32 v29, 0xffff0000, v29
    v_add_f32 v30, v30, v31
    v_add_f32 v28, v28, v29
    v_mov_b32 v31, v30
    v_mov_b32 v29, v28
    s_nop 0
    v_permlane32_swap_b32 v30, v31
    v_permlane32_swap_b32 v28, v29
    v_add_f32 v30, v30, v31
    v_add_f32 v28, v28, v29
    v_mov_b32 v31, v30
    v_mov_b32 v29, v28
    s_nop 0
    v_permlane16_swap_b32 v30, v31
    v_permlane16_swap_b32 v28, v29
    v_add_f32 v30, v30, v31
    v_add_f32 v28, v28, v29
    v_add_f32 v22, v22, v30
    v_add_f32 v23, v23, v28
    v_cvt_pk_bf16_f32 v28, v22, v23
    s_lshl_b32 s77, s69, 6
    s_add_u32 s77, s77, s3
    s_add_u32 s77, s77, 48640
    v_lshlrev_b32 v37, 2, v0
    v_mov_b32_dpp v29, v28 quad_perm:[1,1,1,1] row_mask:0xf bank_mask:0xf
    v_mov_b32_dpp v30, v28 quad_perm:[2,2,2,2] row_mask:0xf bank_mask:0xf
    v_mov_b32_dpp v31, v28 quad_perm:[3,3,3,3] row_mask:0xf bank_mask:0xf
    s_mov_b32 exec_lo, 0x1111
    s_mov_b32 exec_hi, 0x0
    buffer_store_dwordx4 v[28:31], v37, s[8:11], s77 offen
    s_cmp_eq_u32 s10, 0
    s_cbranch_scc1 SLOW8
BACK8:
    s_mov_b64 exec, -1
NOOWN0:
    v_mov_b32 v25, 0
    v_mov_b32 v27, 0
    v_mov_b32 v37, 0
    v_mov_b32 v39, 0
    s_mov_b32 exec_lo, 0x00ff00ff
    s_mov_b32 exec_hi, 0x00ff00ff
    buffer_load_dwordx4 v[88:91], v3, s[16:19], s3 offen offset:0 sc1
    buffer_load_dwordx4 v[92:95], v3, s[16:19], s3 offen offset:512 sc1
    buffer_load_dwordx4 v[96:99], v3, s[16:19], s3 offen offset:1024 sc1
    buffer_load_dwordx4 v[100:103], v3, s[16:19], s3 offen offset:1536 sc1
    buffer_load_dwordx4 v[104:107], v3, s[16:19], s3 offen offset:2048 sc1
    buffer_load_dwordx4 v[108:111], v3, s[16:19], s3 offen offset:2560 sc1
    s_mov_b32 exec_lo, -1
    s_mov_b32 exec_hi, 0
    buffer_load_dwordx4 v[24:27], v4, s[16:19], s3 offen offset:0 sc1
    buffer_load_dwordx4 v[36:39], v4, s[16:19], s3 offen offset:16 sc1
    s_mov_b64 exec, -1
    ds_read_b64_tr_b16 v[72:73], v2 offset:4128
    ds_read_b64_tr_b16 v[74:75], v2 offset:4384
    ds_read_b64_tr_b16 v[52:53], v2 offset:6144
    ds_read_b64_tr_b16 v[54:55], v2 offset:6400
    ds_read_b64_tr_b16 v[76:77], v2 offset:6176
    ds_read_b64_tr_b16 v[78:79], v2 offset:6432
    ds_read_b64_tr_b16 v[56:57], v2 offset:8192
    ds_read_b64_tr_b16 v[58:59], v2 offset:8448
    ds_read_b64_tr_b16 v[80:81], v2 offset:8224
    ds_read_b64_tr_b16 v[82:83], v2 offset:8480
    ds_read_b64_tr_b16 v[60:61], v2 offset:10240
    ds_read_b64_tr_b16 v[62:63], v2 offset:10496
    ds_read_b64_tr_b16 v[84:85], v2 offset:10272
    ds_read_b64_tr_b16 v[86:87], v2 offset:10528
    v_accvgpr_read_b32 v5, a249
    v_lshlrev_b32 v18, 1, v0
WCHK:
    s_waitcnt vmcnt(0)
    v_max3_u32 v28, v88, v92, v96
    v_max3_u32 v28, v28, v100, v104
    v_max3_u32 v28, v28, v108, v25
    v_max3_u32 v28, v28, v27, v37
    v_max_u32 v28, v28, v39
    v_cmp_eq_u32 vcc, -1, v28
    s_cbranch_vccnz AGAIN9
POLLX9:
    s_waitcnt lgkmcnt(0)
    v_mfma_f32_16x16x32_bf16 v[28:31], v[88:91], v[40:43], 0
    v_mfma_f32_16x16x32_bf16 v[32:35], v[88:91], v[64:67], 0
    v_max3_f32 v88, v24, v26, v36
    v_max_f32 v88, v88, v38
    v_mfma_f32_16x16x32_bf16 v[28:31], v[92:95], v[44:47], v[28:31]
    v_mov_b32 v89, v88
    v_mfma_f32_16x16x32_bf16 v[32:35], v[92:95], v[68:71], v[32:35]
    s_nop 0
    v_permlane16_swap_b32 v88, v89
    v_max_f32 v88, v88, v89
    v_mfma_f32_16x16x32_bf16 v[28:31], v[96:99], v[48:51], v[28:31]
    v_sub_f32 v24, v24, v88
    v_sub_f32 v26, v26, v88
    v_mfma_f32_16x16x32_bf16 v[32:35], v[96:99], v[72:75], v[32:35]
    v_sub_f32 v36, v36, v88
    v_sub_f32 v38, v38, v88
    v_mfma_f32_16x16x32_bf16 v[28:31], v[100:103], v[52:55], v[28:31]
    v_exp_f32 v24, v24
    v_mfma_f32_16x16x32_bf16 v[32:35], v[100:103], v[76:79], v[32:35]
    v_exp_f32 v26, v26
    v_mfma_f32_16x16x32_bf16 v[28:31], v[104:107], v[56:59], v[28:31]
    v_exp_f32 v36, v36
    v_mfma_f32_16x16x32_bf16 v[32:35], v[104:107], v[80:83], v[32:35]
    v_exp_f32 v38, v38
    v_mfma_f32_16x16x32_bf16 v[28:31], v[108:111], v[60:63], v[28:31]
    v_mul_f32 v90, v24, v25
    v_fmac_f32 v90, v26, v27
    v_mfma_f32_16x16x32_bf16 v[32:35], v[108:111], v[84:87], v[32:35]
    v_fmac_f32 v90, v36, v37
    v_fmac_f32 v90, v38, v39
    v_mov_b32 v89, v90
    s_cmp_lg_u32 s72, 0
    s_nop 0
    v_permlane16_swap_b32 v90, v89
    v_add_f32 v90, v90, v89
    v_rcp_f32 v90, v90
    v_mul_f32 v28, v24, v28
    v_mul_f32 v32, v24, v32
    v_fmac_f32 v28, v26, v29
    v_fmac_f32 v32, v26, v33
    v_fmac_f32 v28, v36, v30
    v_fmac_f32 v32, v36, v34
    v_fmac_f32 v28, v38, v31
    v_fmac_f32 v32, v38, v35
    s_nop 1
    v_permlane16_swap_b32 v28, v32
    v_add_f32 v28, v28, v32
    v_mul_f32 v28, v28, v90
    ds_write_b32 v5, v28
    s_waitcnt lgkmcnt(0)
    s_barrier
    s_cbranch_scc1 WNOT0
    ds_read2st64_b32 v[28:29], v5 offset0:0 offset1:1
    ds_read2st64_b32 v[30:31], v5 offset0:2 offset1:3
    s_waitcnt lgkmcnt(1)
    v_add_f32 v28, v28, v29
    s_waitcnt lgkmcnt(0)
    v_add_f32 v30, v30, v31
    v_add_f32 v28, v28, v30
    s_nop 1
    v_mov_b32_dpp v29, v28 row_shl:1 row_mask:0xf bank_mask:0xf
    v_cvt_pk_bf16_f32 v28, v28, v29
    s_nop 1
    v_mov_b32_dpp v29, v28 row_shl:2 row_mask:0xf bank_mask:0xf
    v_mov_b32_dpp v30, v28 row_shl:4 row_mask:0xf bank_mask:0xf
    v_mov_b32_dpp v31, v28 row_shl:6 row_mask:0xf bank_mask:0xf
    s_mov_b64 exec, s[92:93]
    buffer_store_dwordx4 v[28:31], v18, s[16:19], s80 offen sc1
    buffer_store_dwordx4 v[28:31], v18, s[8:11], s81 offen
    s_cmp_eq_u32 s10, 0
    s_cbranch_scc1 SLOW10
BACK10:
    s_mov_b64 exec, -1
    v_lshrrev_b32 v37, 5, v0
    v_mul_u32_u24 v37, 2560, v37
    v_and_b32 v38, 31, v0
    v_lshl_add_u32 v37, v38, 2, v37
    v_add_u32 v41, 5120, v37
    v_add_u32 v42, 10240, v37
    v_add_u32 v43, 15360, v37
    v_add_u32 v44, 20480, v37
    v_add_u32 v45, 25600, v37
    s_lshl_b32 s79, s69, 7
    s_add_u32 s79, s79, s3
    s_add_u32 s79, s79, 51200
    s_add_u32 s96, s80, 10240
    s_add_u32 s97, s81, 1280
    v_lshlrev_b32 v39, 1, v0
    s_cmp_lg_u32 s74, 0
    s_cbranch_scc1 NOLC
    s_mul_i32 s77, s69, 2464
    s_add_u32 s78, s3, 720896
    v_add_u32 v48, s77, v1
    v_min_u32 v48, 49136, v48
    s_add_u32 s77, s77, 1024
    v_add_u32 v49, s77, v1
    v_min_u32 v49, 49136, v49
    s_add_u32 s77, s77, 1024
    v_add_u32 v50, s77, v1
    v_min_u32 v50, 49136, v50
    s_add_u32 s77, s77, 1024
    buffer_load_dwordx4 a[240:243], v48, s[16:19], s78 offen sc1
    buffer_load_dwordx4 a[240:243], v49, s[16:19], s78 offen sc1
    buffer_load_dwordx4 a[240:243], v50, s[16:19], s78 offen sc1
    v_mov_b32 v52, -1
    v_mov_b32 v53, -1
    v_mov_b32 v54, -1
    v_mov_b32 v55, -1
    s_add_u32 s77, s80, 688128
    s_add_u32 s7, s96, 688128
    s_waitcnt vmcnt(0)
    buffer_store_dwordx4 v[52:55], v48, s[8:11], s78 offen
    s_cmp_eq_u32 s10, 0
    s_cbranch_scc1 SLOW11
BACK11:
    buffer_store_dwordx4 v[52:55], v49, s[8:11], s78 offen
    s_cmp_eq_u32 s10, 0
    s_cbranch_scc1 SLOW12
BACK12:
    buffer_store_dwordx4 v[52:55], v50, s[8:11], s78 offen
    s_cmp_eq_u32 s10, 0
    s_cbranch_scc1 SLOW13
BACK13:
    s_mov_b64 exec, 15
    buffer_store_dwordx4 v[52:55], v1, s[16:19], s77 offen sc1
    buffer_store_dwordx4 v[52:55], v1, s[16:19], s7 offen sc1
    s_mov_b64 exec, -1
NOLC:
    s_mov_b32 s76, 1
POLL14:
    buffer_load_dword v28, v37, s[16:19], s79 offen sc1
    buffer_load_dword v29, v41, s[16:19], s79 offen sc1
    buffer_load_dword v30, v42, s[16:19], s79 offen sc1
    buffer_load_dword v31, v43, s[16:19], s79 offen sc1
    buffer_load_dword v32, v44, s[16:19], s79 offen sc1
    buffer_load_dword v33, v45, s[16:19], s79 offen sc1
    s_waitcnt vmcnt(0)
    v_add_f32 v28, v28, v29
    v_add_f32 v30, v30, v31
    v_add_f32 v32, v32, v33
    v_add_f32 v28, v28, v30
    v_add_f32 v29, v28, v32
    v_add_f32 v28, v28, v32
    v_cmp_u_f32 vcc, v28, v28
    s_cbranch_vccnz AGAIN14
POLLX14:
    v_permlane32_swap_b32 v28, v29
    v_add_f32 v28, v28, v29
    s_nop 1
    v_mov_b32_dpp v29, v28 row_shl:1 row_mask:0xf bank_mask:0xf
    v_cvt_pk_bf16_f32 v28, v28, v29
    s_nop 1
    v_mov_b32_dpp v29, v28 row_shl:2 row_mask:0xf bank_mask:0xf
    v_mov_b32_dpp v30, v28 row_shl:4 row_mask:0xf bank_mask:0xf
    v_mov_b32_dpp v31, v28 row_shl:6 row_mask:0xf bank_mask:0xf
    s_mov_b64 exec, s[92:93]
    buffer_store_dwordx4 v[28:31], v39, s[16:19], s96 offen sc1
    buffer_store_dwordx4 v[28:31], v39, s[8:11], s97 offen
    s_cmp_eq_u32 s10, 0
    s_cbranch_scc1 SLOW15
BACK15:
    s_mov_b64 exec, -1
    s_branch NEXT
AGAIN2:
    s_add_u32 s76, s76, 1
    s_cmp_lt_u32 s76, 32768
    s_cbranch_scc1 POLL2
    s_branch POLLX2
BR3:
    s_cmp_ge_u32 s76, 32768
    s_cbranch_scc1 BX3
BL3:
    s_mov_b64 exec, s[86:87]
    v_cmp_eq_u32 vcc, -1, v80
    s_nop 0
    s_mov_b64 exec, vcc
    s_cbranch_execz BS3_0
    buffer_load_dwordx4 v[80:83], v8, s[16:19], 0 offen sc1
BS3_0:
    s_mov_b64 exec, s[86:87]
    v_cmp_eq_u32 vcc, -1, v84
    s_nop 0
    s_mov_b64 exec, vcc
    s_cbranch_execz BS3_1
    buffer_load_dwordx4 v[84:87], v9, s[16:19], 0 offen sc1
BS3_1:
    s_mov_b64 exec, s[86:87]
    s_add_u32 s76, s76, 1
    s_cmp_ge_u32 s76, 32768
    s_waitcnt vmcnt(0)
    v_max_u32 v24, v80, v84
    v_cmp_eq_u32 vcc, -1, v24
    s_cbranch_vccz BW3
    s_cbranch_scc0 BL3
    s_branch BW3
AGAIN5:
    s_add_u32 s76, s76, 1
    s_cmp_lt_u32 s76, 32768
    s_cbranch_scc1 POLL5
    s_branch POLLX5
OML:
    v_mul_f32 v35, v32, v33
    s_nop 1
    v_add_f32_dpp v35, v35, v35 quad_perm:[1,0,3,2] row_mask:0xf bank_mask:0xf
    s_nop 1
    v_add_f32_dpp v35, v35, v35 quad_perm:[2,3,0,1] row_mask:0xf bank_mask:0xf
    s_mov_b64 exec, 1
    buffer_store_dwordx2 v[34:35], v1, s[8:11], s78 offen
    s_cmp_eq_u32 s10, 0
    s_cbranch_scc1 SLOW16
BACK16:
    s_mov_b64 exec, -1
    s_waitcnt lgkmcnt(0)
    s_branch ODONE
WLATE:
    v_lshrrev_b32 v38, 2, v0
    v_mul_u32_u24 v38, 1280, v38
    v_and_b32 v39, 3, v0
    v_lshl_add_u32 v39, v39, 4, v38
    s_mov_b32 m0, s67
    s_add_u32 s67, s67, 1024
    buffer_load_dwordx4 v39, s[24:27], s66 offen  lds
    s_add_u32 s66, s66, 20480
    s_mov_b32 m0, s67
    s_add_u32 s67, s67, 1024
    buffer_load_dwordx4 v39, s[24:27], s66 offen  lds
    s_add_u32 s66, s66, 20480
    s_mov_b32 m0, s67
    s_add_u32 s67, s67, 1024
    buffer_load_dwordx4 v39, s[24:27], s66 offen  lds
    s_add_u32 s66, s66, 20480
    s_mov_b32 m0, s67
    s_add_u32 s67, s67, 1024
    buffer_load_dwordx4 v39, s[24:27], s66 offen  lds
    s_add_u32 s66, s66, 20480
    s_add_u32 s77, s3, 1376256
    buffer_store_dword v7, v10, s[8:11], s77 offen
    s_cmp_eq_u32 s10, 0
    s_cbranch_scc1 SLOW17
BACK17:
    s_cmp_lg_u32 s72, 3
    s_cbranch_scc1 NOFPC
    v_mov_b32 v24, -1
    v_mov_b32 v25, -1
    v_mov_b32 v26, -1
    v_mov_b32 v27, -1
    v_accvgpr_read_b32 v28, a250
    buffer_store_dwordx4 v[24:27], v28, s[8:11], 0 offen
    s_cmp_eq_u32 s10, 0
    s_cbranch_scc1 SLOW18
BACK18:
    v_accvgpr_read_b32 v29, a251
    buffer_store_dwordx4 v[24:27], v29, s[8:11], 0 offen
    s_cmp_eq_u32 s10, 0
    s_cbranch_scc1 SLOW19
BACK19:
NOFPC:
    v_accvgpr_read_b32 v2, a246
    v_accvgpr_read_b32 v3, a247
    v_accvgpr_read_b32 v4, a248
    v_mov_b32 v88, 0
    v_mov_b32 v92, 0
    v_mov_b32 v96, 0
    v_mov_b32 v100, 0
    v_mov_b32 v104, 0
    v_mov_b32 v108, 0
    v_mov_b32 v25, 0
    v_mov_b32 v27, 0
    v_mov_b32 v37, 0
    v_mov_b32 v39, 0
    s_mov_b32 exec_lo, 0x00ff00ff
    s_mov_b32 exec_hi, 0x00ff00ff
    buffer_load_dwordx4 v[88:91], v3, s[16:19], s3 offen offset:0 sc1
    buffer_load_dwordx4 v[92:95], v3, s[16:19], s3 offen offset:512 sc1
    buffer_load_dwordx4 v[96:99], v3, s[16:19], s3 offen offset:1024 sc1
    buffer_load_dwordx4 v[100:103], v3, s[16:19], s3 offen offset:1536 sc1
    buffer_load_dwordx4 v[104:107], v3, s[16:19], s3 offen offset:2048 sc1
    buffer_load_dwordx4 v[108:111], v3, s[16:19], s3 offen offset:2560 sc1
    s_mov_b32 exec_lo, -1
    s_mov_b32 exec_hi, 0
    buffer_load_dwordx4 v[24:27], v4, s[16:19], s3 offen offset:0 sc1
    buffer_load_dwordx4 v[36:39], v4, s[16:19], s3 offen offset:16 sc1
    s_mov_b64 exec, -1
    s_waitcnt vmcnt(8)
    ds_read_b64_tr_b16 v[40:41], v2 offset:0
    ds_read_b64_tr_b16 v[42:43], v2 offset:256
    ds_read_b64_tr_b16 v[64:65], v2 offset:32
    ds_read_b64_tr_b16 v[66:67], v2 offset:288
    ds_read_b64_tr_b16 v[44:45], v2 offset:2048
    ds_read_b64_tr_b16 v[46:47], v2 offset:2304
    ds_read_b64_tr_b16 v[68:69], v2 offset:2080
    ds_read_b64_tr_b16 v[70:71], v2 offset:2336
    ds_read_b64_tr_b16 v[48:49], v2 offset:4096
    ds_read_b64_tr_b16 v[50:51], v2 offset:4352
    ds_read_b64_tr_b16 v[72:73], v2 offset:4128
    ds_read_b64_tr_b16 v[74:75], v2 offset:4384
    ds_read_b64_tr_b16 v[52:53], v2 offset:6144
    ds_read_b64_tr_b16 v[54:55], v2 offset:6400
    ds_read_b64_tr_b16 v[76:77], v2 offset:6176
    ds_read_b64_tr_b16 v[78:79], v2 offset:6432
    ds_read_b64_tr_b16 v[56:57], v2 offset:8192
    ds_read_b64_tr_b16 v[58:59], v2 offset:8448
    ds_read_b64_tr_b16 v[80:81], v2 offset:8224
    ds_read_b64_tr_b16 v[82:83], v2 offset:8480
    ds_read_b64_tr_b16 v[60:61], v2 offset:10240
    ds_read_b64_tr_b16 v[62:63], v2 offset:10496
    ds_read_b64_tr_b16 v[84:85], v2 offset:10272
    ds_read_b64_tr_b16 v[86:87], v2 offset:10528
    v_accvgpr_read_b32 v5, a249
    v_lshlrev_b32 v18, 1, v0
    s_branch WCHK
AGAIN9:
    s_mov_b64 s[94:95], exec
    s_mov_b32 s76, 1
AG29:
    v_max3_u32 v28, v88, v92, v96
    v_max3_u32 v28, v28, v100, v104
    v_max_u32 v28, v28, v108
    v_cmp_eq_u32 vcc, -1, v28
    s_nop 0
    s_mov_b64 exec, vcc
    s_cbranch_execz AG39_0
    buffer_load_dwordx4 v[88:91], v3, s[16:19], s3 offen offset:0 sc1
    buffer_load_dwordx4 v[92:95], v3, s[16:19], s3 offen offset:512 sc1
    buffer_load_dwordx4 v[96:99], v3, s[16:19], s3 offen offset:1024 sc1
    buffer_load_dwordx4 v[100:103], v3, s[16:19], s3 offen offset:1536 sc1
    buffer_load_dwordx4 v[104:107], v3, s[16:19], s3 offen offset:2048 sc1
    buffer_load_dwordx4 v[108:111], v3, s[16:19], s3 offen offset:2560 sc1
AG39_0:
    s_mov_b64 exec, s[94:95]
    v_max3_u32 v28, v25, v27, v37
    v_max_u32 v28, v28, v39
    v_cmp_eq_u32 vcc, -1, v28
    s_nop 0
    s_mov_b64 exec, vcc
    s_cbranch_execz AG39_1
    buffer_load_dwordx4 v[24:27], v4, s[16:19], s3 offen offset:0 sc1
    buffer_load_dwordx4 v[36:39], v4, s[16:19], s3 offen offset:16 sc1
AG39_1:
    s_mov_b64 exec, s[94:95]
    s_add_u32 s76, s76, 1
    s_cmp_ge_u32 s76, 32768
    s_waitcnt vmcnt(0)
    v_max3_u32 v28, v88, v92, v96
    v_max3_u32 v28, v28, v100, v104
    v_max3_u32 v28, v28, v108, v25
    v_max3_u32 v28, v28, v27, v37
    v_max_u32 v28, v28, v39
    v_cmp_eq_u32 vcc, -1, v28
    s_cbranch_vccz POLLX9
    s_cbranch_scc0 AG29
    s_branch POLLX9
AGAIN14:
    s_add_u32 s76, s76, 1
    s_cmp_lt_u32 s76, 32768
    s_cbranch_scc1 POLL14
    s_branch POLLX14
WNOT0:
    s_cmp_lg_u32 s72, 1
    s_cbranch_scc1 NEXT
    v_and_b32 v25, 15, v0
    v_lshrrev_b32 v26, 4, v0
    v_mul_u32_u24 v37, 1280, v26
    v_add_u32 v37, 655360, v37
    s_mul_i32 s7, s68, 81920
    s_add_u32 s7, s7, 46080
    v_mov_b32 v38, s7
    v_cmp_eq_u32 vcc, s68, v26
    s_nop 1
    v_cndmask_b32 v37, v37, v38, vcc
    v_add_u32 v39, 4, v26
    v_mul_u32_u24 v38, 1280, v39
    v_add_u32 v38, 655360, v38
    s_mul_i32 s7, s68, 81920
    s_add_u32 s7, s7, 46080
    v_mov_b32 v28, s7
    v_cmp_eq_u32 vcc, s68, v39
    s_nop 1
    v_cndmask_b32 v38, v38, v28, vcc
    s_lshl_b32 s77, s69, 6
    s_add_u32 s77, s77, s74
    v_lshl_add_u32 v37, v25, 2, v37
    v_lshl_add_u32 v38, v25, 2, v38
    s_sleep 16
    s_mov_b32 s76, 1
POLL20:
    buffer_load_dword v28, v37, s[16:19], s77 offen sc1
    buffer_load_dword v29, v38, s[16:19], s77 offen sc1
POLLW20:
    s_waitcnt vmcnt(0)
    v_max_u32 v30, v28, v29
    v_cmp_eq_u32 vcc, -1, v30
    s_cbranch_vccnz AGAIN20
POLLX20:
    v_lshlrev_b32 v30, 16, v28
    v_and_b32 v28, 0xffff0000, v28
    v_lshlrev_b32 v31, 16, v29
    v_and_b32 v29, 0xffff0000, v29
    v_add_f32 v30, v30, v31
    v_add_f32 v28, v28, v29
    v_mov_b32 v31, v30
    v_mov_b32 v29, v28
    s_nop 0
    v_permlane32_swap_b32 v30, v31
    v_permlane32_swap_b32 v28, v29
    v_add_f32 v30, v30, v31
    v_add_f32 v28, v28, v29
    v_mov_b32 v31, v30
    v_mov_b32 v29, v28
    s_nop 0
    v_permlane16_swap_b32 v30, v31
    v_permlane16_swap_b32 v28, v29
    v_add_f32 v30, v30, v31
    v_add_f32 v28, v28, v29
    v_add_f32 v22, v22, v30
    v_add_f32 v23, v23, v28
    v_cvt_pk_bf16_f32 v28, v22, v23
    s_cmp_lg_u32 s74, 0
    s_cbranch_scc1 FINAL
    s_lshl_b32 s77, s69, 6
    s_add_u32 s77, s77, s3
    s_add_u32 s77, s77, 49920
    v_lshlrev_b32 v37, 2, v0
    v_mov_b32_dpp v29, v28 quad_perm:[1,1,1,1] row_mask:0xf bank_mask:0xf
    v_mov_b32_dpp v30, v28 quad_perm:[2,2,2,2] row_mask:0xf bank_mask:0xf
    v_mov_b32_dpp v31, v28 quad_perm:[3,3,3,3] row_mask:0xf bank_mask:0xf
    s_mov_b32 exec_lo, 0x1111
    s_mov_b32 exec_hi, 0x0
    buffer_store_dwordx4 v[28:31], v37, s[8:11], s77 offen
    s_cmp_eq_u32 s10, 0
    s_cbranch_scc1 SLOW21
BACK21:
    s_mov_b64 exec, -1
    s_branch NEXT
FINAL:
    s_cmp_lg_u32 s68, 0
    s_cbranch_scc1 DONE
    s_lshl_b32 s77, s69, 6
    v_lshlrev_b32 v37, 2, v0
    s_add_u32 s79, s77, s3
    s_add_u32 s79, s79, 47360
    s_mov_b32 exec_lo, 0xffff
    s_mov_b32 exec_hi, 0x0
    buffer_load_dword v29, v37, s[40:43], s77 offen
    s_mov_b64 exec, 15
    s_mov_b32 s76, 1
POLL22:
    buffer_load_dword v28, v1, s[16:19], s79 offen sc1
POLLW22:
    s_waitcnt vmcnt(0)
    v_cmp_eq_u32 vcc, -1, v28
    s_cbranch_vccnz AGAIN22
POLLX22:
    s_mov_b64 exec, -1
    s_mov_b32 s76, 1
POLL23:
    buffer_load_dword v28, v20, s[16:19], s74 offen sc1
    buffer_load_dword v29, v21, s[16:19], s74 offen sc1
POLLW23:
    s_waitcnt vmcnt(0)
    v_max_u32 v30, v28, v29
    v_cmp_eq_u32 vcc, -1, v30
    s_cbranch_vccnz AGAIN23
POLLX23:
    v_lshlrev_b32 v30, 16, v28
    v_and_b32 v28, 0xffff0000, v28
    v_lshlrev_b32 v31, 16, v29
    v_and_b32 v29, 0xffff0000, v29
    v_add_f32 v30, v30, v31
    v_add_f32 v28, v28, v29
    v_mov_b32 v31, v30
    v_mov_b32 v29, v28
    s_nop 0
    v_permlane32_swap_b32 v30, v31
    v_permlane32_swap_b32 v28, v29
    v_add_f32 v30, v30, v31
    v_add_f32 v28, v28, v29
    v_mov_b32 v31, v30
    v_mov_b32 v29, v28
    s_nop 0
    v_permlane16_swap_b32 v30, v31
    v_permlane16_swap_b32 v28, v29
    v_add_f32 v30, v30, v31
    v_add_f32 v28, v28, v29
    v_add_f32 v22, v22, v30
    v_add_f32 v23, v23, v28
    v_cvt_pk_bf16_f32 v28, v22, v23
    s_mov_b32 exec_lo, 0xffff
    s_mov_b32 exec_hi, 0x0
    buffer_store_dword v28, v37, s[40:43], s77 offen
    s_mov_b64 exec, -1
    s_endpgm
AGAIN20:
    s_sleep 4
    s_add_u32 s76, s76, 1
    s_cmp_lt_u32 s76, 32768
    s_cbranch_scc1 POLL20
    s_branch POLLX20
AGAIN22:
    s_add_u32 s76, s76, 1
    s_cmp_lt_u32 s76, 32768
    s_cbranch_scc1 POLL22
    s_branch POLLX22
AGAIN23:
    s_add_u32 s76, s76, 1
    s_cmp_lt_u32 s76, 32768
    s_cbranch_scc1 POLL23
    s_branch POLLX23
ROLEF:
    v_and_b32 v25, 15, v0
    v_lshrrev_b32 v26, 4, v0
    v_bfe_u32 v27, v0, 2, 2
    v_and_b32 v36, 3, v0
    s_mov_b32 s4, 1
    s_cmp_lg_u32 s74, 0
    s_cbranch_scc1 FW
    s_mov_b32 s4, 0
FW:
    s_mul_i32 s77, s72, 5120
    s_add_u32 s77, s77, 57344
    v_lshl_add_u32 v37, v26, 3, v27
    v_lshlrev_b32 v37, 5, v37
    v_lshl_add_u32 v37, v36, 3, v37
    v_add_u32 v37, s77, v37
    ds_read_b64_tr_b16 v[40:41], v37 offset:0
    ds_read_b64_tr_b16 v[42:43], v37 offset:128
    ds_read_b64_tr_b16 v[44:45], v37 offset:1024
    ds_read_b64_tr_b16 v[46:47], v37 offset:1152
    ds_read_b64_tr_b16 v[48:49], v37 offset:2048
    ds_read_b64_tr_b16 v[50:51], v37 offset:2176
    ds_read_b64_tr_b16 v[52:53], v37 offset:3072
    ds_read_b64_tr_b16 v[54:55], v37 offset:3200
    ds_read_b64_tr_b16 v[56:57], v37 offset:4096
    ds_read_b64_tr_b16 v[58:59], v37 offset:4224
    ds_read_b64_tr_b16 v[60:61], v37 offset:20480
    ds_read_b64_tr_b16 v[62:63], v37 offset:20608
    ds_read_b64_tr_b16 v[64:65], v37 offset:21504
    ds_read_b64_tr_b16 v[66:67], v37 offset:21632
    ds_read_b64_tr_b16 v[68:69], v37 offset:22528
    ds_read_b64_tr_b16 v[70:71], v37 offset:22656
    ds_read_b64_tr_b16 v[72:73], v37 offset:23552
    ds_read_b64_tr_b16 v[74:75], v37 offset:23680
    ds_read_b64_tr_b16 v[76:77], v37 offset:24576
    ds_read_b64_tr_b16 v[78:79], v37 offset:24704
    s_mul_i32 s77, s72, 320
    s_add_u32 s77, s77, 98304
    v_lshrrev_b32 v80, 2, v0
    v_mul_u32_u24 v80, 1280, v80
    v_lshl_add_u32 v80, v36, 3, v80
    v_add_u32 v80, s77, v80
    s_lshl_b32 s79, s72, 2
    s_add_u32 s79, s79, 123392
    v_add_u32 v81, s79, v1
    v_lshl_add_u32 v82, v26, 2, v36
    v_lshlrev_b32 v82, 4, v82
    v_add_u32 v82, 123392, v82
    v_cmp_eq_u32 vcc, 12, v25
    v_mov_b32 v83, 123904
    v_mov_b32 v85, 0x3727c5ac
    v_lshlrev_b32 v84, 6, v25
    v_lshl_add_u32 v84, v26, 4, v84
    s_mov_b32 s64, 0x03ff03ff
    s_mov_b32 s65, 0x03ff03ff
    s_mov_b32 s66, 0x3acccccd
    s_mov_b32 s44, 0x10001
    s_mov_b32 s45, 0x10001
    s_mov_b32 s46, 0x20002
    s_mov_b32 s47, 0x20002
    s_mov_b32 s48, 0x40004
    s_mov_b32 s49, 0x40004
    s_mov_b32 s50, 0x80008
    s_mov_b32 s51, 0x80008
    s_mov_b32 s52, 0x100010
    s_mov_b32 s53, 0x100010
    s_mov_b32 s54, 0x200020
    s_mov_b32 s55, 0x200020
    s_mov_b32 s56, 0x400040
    s_mov_b32 s57, 0x400040
    s_mov_b32 s58, 0x800080
    s_mov_b32 s59, 0x800080
    s_mov_b32 s60, 0x1000100
    s_mov_b32 s61, 0x1000100
    s_mov_b32 s62, 0x2000200
    s_mov_b32 s63, 0x2000200
    v_mov_b32 v38, 0x3f803f80
    v_cndmask_b32 v88, 0, v38, vcc
    v_mov_b32 v89, v88
    v_mov_b32 v90, v88
    v_mov_b32 v91, v88
    v_mov_b32 v92, v88
    v_mov_b32 v93, v88
    v_mov_b32 v94, v88
    v_mov_b32 v95, v88
    v_mov_b32 v96, v88
    v_mov_b32 v97, v88
    v_mov_b32 v98, v88
    v_mov_b32 v99, v88
    v_mov_b32 v100, v88
    v_mov_b32 v101, v88
    v_mov_b32 v102, v88
    v_mov_b32 v103, v88
    v_mov_b32 v104, v88
    v_mov_b32 v105, v88
    v_mov_b32 v106, v88
    v_mov_b32 v107, v88
    s_mul_i32 s77, s72, 6656
    v_mul_u32_u24 v6, 336, v25
    v_lshl_add_u32 v6, v26, 4, v6
    v_add_u32 v6, s77, v6
    v_mul_u32_u24 v37, 52, v0
    v_lshrrev_b32 v37, 10, v37
    v_lshl_add_u32 v87, v37, 4, v1
    v_add_u32 v87, s77, v87
    v_mul_u32_u24 v27, 320, v37
    v_sub_u32 v27, v1, v27
    v_mul_u32_u24 v86, 1280, v37
    v_add_u32 v86, 655360, v86
    s_mul_i32 s7, s68, 81920
    s_add_u32 s7, s7, 46080
    v_mov_b32 v38, s7
    v_cmp_eq_u32 vcc, s68, v37
    s_nop 1
    v_cndmask_b32 v86, v86, v38, vcc
    v_add_u32 v38, 2560, v38
    v_cmp_le_u32 vcc, 8, v37
    s_nop 1
    v_cndmask_b32 v86, v86, v38, vcc
    v_add_u32 v86, v86, v27
    v_add_u32 v37, 3, v37
    v_mul_u32_u24 v18, 1280, v37
    v_add_u32 v18, 655360, v18
    s_mul_i32 s7, s68, 81920
    s_add_u32 s7, s7, 46080
    v_mov_b32 v38, s7
    v_cmp_eq_u32 vcc, s68, v37
    s_nop 1
    v_cndmask_b32 v18, v18, v38, vcc
    v_add_u32 v38, 2560, v38
    v_cmp_le_u32 vcc, 8, v37
    s_nop 1
    v_cndmask_b32 v18, v18, v38, vcc
    v_add_u32 v18, v18, v27
    v_add_u32 v37, 3, v37
    v_mul_u32_u24 v20, 1280, v37
    v_add_u32 v20, 655360, v20
    s_mul_i32 s7, s68, 81920
    s_add_u32 s7, s7, 46080
    v_mov_b32 v38, s7
    v_cmp_eq_u32 vcc, s68, v37
    s_nop 1
    v_cndmask_b32 v20, v20, v38, vcc
    v_add_u32 v38, 2560, v38
    v_cmp_le_u32 vcc, 8, v37
    s_nop 1
    v_cndmask_b32 v20, v20, v38, vcc
    v_add_u32 v20, v20, v27
    s_mul_i32 s77, s72, 320
    s_add_u32 s77, s77, s74
    s_sub_u32 s78, s69, 20
    s_mul_i32 s78, s78, 2560
    s_mul_i32 s7, s72, 640
    s_add_u32 s78, s78, s7
    s_add_u32 s78, s78, s3
    s_add_u32 s78, s78, 51200
    s_waitcnt lgkmcnt(0)
    s_cmp_eq_u32 s4, 0
    s_cbranch_scc1 FW2
FPOLL:
    ds_read_b64_tr_b16 a[240:241], v80 offset:0
    ds_read_b64_tr_b16 a[242:243], v80 offset:32
    ds_read_b64_tr_b16 a[244:245], v80 offset:64
    ds_read_b64_tr_b16 a[246:247], v80 offset:96
    ds_read_b64_tr_b16 a[248:249], v80 offset:128
    ds_read_b64_tr_b16 a[250:251], v80 offset:160
    ds_read_b64_tr_b16 v[108:109], v80 offset:192
    ds_read_b64_tr_b16 v[110:111], v80 offset:224
    ds_read_b64_tr_b16 v[2:3], v80 offset:256
    ds_read_b64_tr_b16 v[4:5], v80 offset:288
    s_waitcnt lgkmcnt(0)
    s_mul_i32 s79, s72, 320
    s_add_u32 s79, s79, s3
    s_add_u32 s79, s79, 46080
    s_mov_b32 exec_lo, 0xfffff
    s_mov_b32 exec_hi, 0x0
    s_mov_b32 s76, 1
POLL24:
    buffer_load_dword v36, v1, s[16:19], s79 offen sc1
POLLW24:
    s_waitcnt vmcnt(0)
    v_cmp_eq_u32 vcc, -1, v36
    s_cbranch_vccnz AGAIN24
POLLX24:
    s_mov_b64 exec, s[86:87]
    buffer_load_dwordx4 v[24:27], v86, s[16:19], s77 offen sc1
    buffer_load_dwordx4 v[28:31], v18, s[16:19], s77 offen sc1
    buffer_load_dwordx4 v[32:35], v20, s[16:19], s77 offen sc1
    s_waitcnt vmcnt(0)
BW25:
    ds_write_b128 v87, v[24:27] offset:0
    ds_write_b128 v87, v[28:31] offset:1008
    ds_write_b128 v87, v[32:35] offset:2016
    v_max3_u32 v36, v24, v28, v32
    v_cmp_eq_u32 vcc, -1, v36
    s_mov_b64 exec, s[84:85]
    ds_read_b128 v[88:91], v6 offset:0
    ds_read_b128 v[92:95], v6 offset:64
    ds_read_b128 v[96:99], v6 offset:128
    ds_read_b128 v[100:103], v6 offset:192
    ds_read_b128 v[104:107], v6 offset:256
    s_mov_b64 exec, -1
    s_cbranch_vccnz BR25
BX25:
FMM:
    s_waitcnt lgkmcnt(4)
    v_mfma_f32_16x16x32_bf16 v[32:35], v[88:91], v[88:91], 0
    s_waitcnt lgkmcnt(3)
    v_mfma_f32_16x16x32_bf16 v[32:35], v[92:95], v[92:95], v[32:35]
    s_waitcnt lgkmcnt(2)
    v_mfma_f32_16x16x32_bf16 v[32:35], v[96:99], v[96:99], v[32:35]
    s_waitcnt lgkmcnt(1)
    v_mfma_f32_16x16x32_bf16 v[32:35], v[100:103], v[100:103], v[32:35]
    s_waitcnt lgkmcnt(0)
    v_mfma_f32_16x16x32_bf16 v[32:35], v[104:107], v[104:107], v[32:35]
    v_mfma_f32_16x16x32_bf16 v[24:27], v[88:91], v[40:43], 0
    v_mov_b32 v36, 0
    v_mov_b32 v37, 0
    v_mfma_f32_16x16x32_bf16 v[24:27], v[92:95], v[44:47], v[24:27]
    v_mov_b32 v38, 0
    s_cmp_eq_u32 s4, 0
    v_mfma_f32_16x16x32_bf16 v[24:27], v[96:99], v[48:51], v[24:27]
    v_mfma_f32_16x16x32_bf16 v[24:27], v[100:103], v[52:55], v[24:27]
    v_add_f32 v32, v32, v33
    v_add_f32 v34, v34, v35
    v_mfma_f32_16x16x32_bf16 v[24:27], v[104:107], v[56:59], v[24:27]
    v_mfma_f32_16x16x32_bf16 v[28:31], v[88:91], v[60:63], 0
    v_add_f32_dpp v36, v32, v34 quad_perm:[0,1,2,3] row_mask:0xf bank_mask:0x7
    v_mfma_f32_16x16x32_bf16 v[28:31], v[92:95], v[64:67], v[28:31]
    s_nop 0
    v_add_f32_dpp v36, v36, v36 row_ror:8 row_mask:0xf bank_mask:0xf
    v_mfma_f32_16x16x32_bf16 v[28:31], v[96:99], v[68:71], v[28:31]
    s_nop 0
    v_add_f32_dpp v36, v36, v36 row_ror:4 row_mask:0xf bank_mask:0xf
    v_mfma_f32_16x16x32_bf16 v[28:31], v[100:103], v[72:75], v[28:31]
    s_nop 0
    v_add_f32_dpp v36, v36, v36 row_ror:2 row_mask:0xf bank_mask:0xf
    v_mfma_f32_16x16x32_bf16 v[28:31], v[104:107], v[76:79], v[28:31]
    v_add_f32 v24, v24, v25
    v_add_f32_dpp v37, v36, v36 row_ror:1 row_mask:0x7 bank_mask:0xf
    v_add_f32_dpp v38, v36, v36 row_ror:1 row_mask:0x8 bank_mask:0xf
    v_add_f32 v26, v26, v27
    v_add_f32 v24, v24, v26
    s_nop 1
    v_permlane32_swap_b32 v24, v37
    v_add_f32 v28, v28, v29
    v_add_f32 v30, v30, v31
    v_add_f32 v28, v28, v30
    v_add_f32 v24, v24, v37
    s_nop 0
    v_permlane32_swap_b32 v28, v38
    v_add_f32 v28, v28, v38
    s_nop 1
    v_permlane16_swap_b32 v24, v28
    v_add_f32 v24, v24, v28
    ds_write_b32 v81, v24
    s_waitcnt lgkmcnt(0)
    s_barrier
    ds_read_b128 v[28:31], v83 offset:256
    ds_read_b128 v[24:27], v83
    ds_read_b128 v[32:35], v82
    ds_read_b128 v[36:39], v82 offset:256
    s_cbranch_scc1 FCS
    s_waitcnt lgkmcnt(3)
    v_add_f32 v28, v28, v29
    v_add_f32 v30, v30, v31
    v_add_f32 v28, v28, v30
    v_mul_f32 v28, s66, v28
    s_waitcnt lgkmcnt(2)
    v_add_f32 v24, v24, v25
    v_add_f32 v26, v26, v27
    v_add_f32 v24, v24, v26
    v_fma_f32 v24, v24, s66, v85
    v_fma_f32 v24, -v28, v28, v24
    v_add_f32 v28, 1.0, v28
    v_max_f32 v24, v24, v85
    s_waitcnt lgkmcnt(1)
    v_rsq_f32 v25, v24
    v_add_f32 v32, v32, v33
    v_add_f32 v34, v34, v35
    v_add_f32 v32, v32, v34
    v_mul_f32 v25, 0xbfb8aa3b, v25
    v_fma_f32 v32, -v28, v22, v32
    v_mul_f32 v33, v32, v25
    v_exp_f32 v33, v33
    s_waitcnt lgkmcnt(0)
    v_add_f32 v36, v36, v37
    v_fma_f32 v33, v33, v24, v24
    v_rcp_f32 v33, v33
    v_add_f32 v38, v38, v39
    v_add_f32 v36, v36, v38
    v_mul_f32 v33, v33, v32
    v_fma_f32 v36, -v28, v23, v36
    v_mul_f32 v36, v36, v33
    s_nop 1
    v_mov_b32_dpp v28, v36 quad_perm:[0,0,0,0] row_mask:0xf bank_mask:0xf
    v_mov_b32_dpp v29, v36 quad_perm:[1,1,1,1] row_mask:0xf bank_mask:0xf
    v_mov_b32_dpp v30, v36 quad_perm:[2,2,2,2] row_mask:0xf bank_mask:0xf
    v_mov_b32_dpp v31, v36 quad_perm:[3,3,3,3] row_mask:0xf bank_mask:0xf
    v_cvt_pk_bf16_f32 v28, v28, v29
    v_cvt_pk_bf16_f32 v29, v30, v31
    v_cndmask_b32 v60, 0, v28, s[44:45]
    v_cndmask_b32 v61, 0, v29, s[44:45]
    v_cndmask_b32 v62, 0, v28, s[46:47]
    v_cndmask_b32 v63, 0, v29, s[46:47]
    v_cndmask_b32 v64, 0, v28, s[48:49]
    v_cndmask_b32 v65, 0, v29, s[48:49]
    v_mfma_f32_16x16x32_bf16 v[24:27], a[240:243], v[60:63], 0
    v_cndmask_b32 v66, 0, v28, s[50:51]
    v_cndmask_b32 v67, 0, v29, s[50:51]
    v_cndmask_b32 v68, 0, v28, s[52:53]
    v_cndmask_b32 v69, 0, v29, s[52:53]
    v_mfma_f32_16x16x32_bf16 v[24:27], a[244:247], v[64:67], v[24:27]
    v_cndmask_b32 v70, 0, v28, s[54:55]
    v_cndmask_b32 v71, 0, v29, s[54:55]
    v_cndmask_b32 v72, 0, v28, s[56:57]
    v_cndmask_b32 v73, 0, v29, s[56:57]
    v_mfma_f32_16x16x32_bf16 v[24:27], a[248:251], v[68:71], v[24:27]
    v_cndmask_b32 v74, 0, v28, s[58:59]
    v_cndmask_b32 v75, 0, v29, s[58:59]
    v_cndmask_b32 v76, 0, v28, s[60:61]
    v_cndmask_b32 v77, 0, v29, s[60:61]
    v_mfma_f32_16x16x32_bf16 v[24:27], v[108:111], v[72:75], v[24:27]
    v_cndmask_b32 v78, 0, v28, s[62:63]
    v_cndmask_b32 v79, 0, v29, s[62:63]
    s_nop 1
    v_mfma_f32_16x16x32_bf16 v[24:27], v[2:5], v[76:79], v[24:27]
    s_mov_b64 exec, s[64:65]
    s_nop 6
    buffer_store_dwordx4 v[24:27], v84, s[8:11], s78 offen
    s_cmp_eq_u32 s10, 0
    s_cbranch_scc1 SLOW26
BACK26:
    s_mov_b64 exec, -1
NEXT:
    s_cmp_lg_u32 s74, 0
    s_cbranch_scc1 DONE
    s_mov_b32 s74, 688128
    s_add_u32 s3, s3, 688128
    s_add_u32 s80, s80, 688128
    s_add_u32 s81, s81, 688128
    s_branch LOOP
AGAIN24:
    s_add_u32 s76, s76, 1
    s_cmp_lt_u32 s76, 32768
    s_cbranch_scc1 POLL24
    s_branch POLLX24
BR25:
    s_cmp_ge_u32 s76, 32768
    s_cbranch_scc1 BX25
BL25:
    s_mov_b64 exec, s[86:87]
    v_cmp_eq_u32 vcc, -1, v24
    s_nop 0
    s_mov_b64 exec, vcc
    s_cbranch_execz BS25_0
    buffer_load_dwordx4 v[24:27], v86, s[16:19], s77 offen sc1
BS25_0:
    s_mov_b64 exec, s[86:87]
    v_cmp_eq_u32 vcc, -1, v28
    s_nop 0
    s_mov_b64 exec, vcc
    s_cbranch_execz BS25_1
    buffer_load_dwordx4 v[28:31], v18, s[16:19], s77 offen sc1
BS25_1:
    s_mov_b64 exec, s[86:87]
    v_cmp_eq_u32 vcc, -1, v32
    s_nop 0
    s_mov_b64 exec, vcc
    s_cbranch_execz BS25_2
    buffer_load_dwordx4 v[32:35], v20, s[16:19], s77 offen sc1
BS25_2:
    s_mov_b64 exec, s[86:87]
    s_add_u32 s76, s76, 1
    s_cmp_ge_u32 s76, 32768
    s_waitcnt vmcnt(0)
    v_max3_u32 v36, v24, v28, v32
    v_cmp_eq_u32 vcc, -1, v36
    s_cbranch_vccz BW25
    s_cbranch_scc0 BL25
    s_branch BW25
DONE:
    s_endpgm
DMAF:
    v_lshrrev_b32 v38, 1, v0
    v_mul_u32_u24 v38, 3072, v38
    v_and_b32 v39, 1, v0
    v_lshl_add_u32 v38, v39, 4, v38
    s_mul_i32 s79, s68, 12
    s_add_u32 s79, s79, s69
    s_sub_u32 s79, s79, 20
    s_mul_i32 s77, s72, 491520
    s_lshl_b32 s78, s79, 5
    s_add_u32 s77, s77, s78
    s_mul_i32 s78, s72, 5120
    s_add_u32 m0, s78, 57344
    s_nop 0
    buffer_load_dwordx4 v38, s[24:27], s77 offen  lds
    s_add_u32 m0, s78, 77824
    s_nop 0
    buffer_load_dwordx4 v38, s[28:31], s77 offen  lds
    s_add_u32 s77, s77, 98304
    s_add_u32 m0, s78, 58368
    s_nop 0
    buffer_load_dwordx4 v38, s[24:27], s77 offen  lds
    s_add_u32 m0, s78, 78848
    s_nop 0
    buffer_load_dwordx4 v38, s[28:31], s77 offen  lds
    s_add_u32 s77, s77, 98304
    s_add_u32 m0, s78, 59392
    s_nop 0
    buffer_load_dwordx4 v38, s[24:27], s77 offen  lds
    s_add_u32 m0, s78, 79872
    s_nop 0
    buffer_load_dwordx4 v38, s[28:31], s77 offen  lds
    s_add_u32 s77, s77, 98304
    s_add_u32 m0, s78, 60416
    s_nop 0
    buffer_load_dwordx4 v38, s[24:27], s77 offen  lds
    s_add_u32 m0, s78, 80896
    s_nop 0
    buffer_load_dwordx4 v38, s[28:31], s77 offen  lds
    s_add_u32 s77, s77, 98304
    s_add_u32 m0, s78, 61440
    s_nop 0
    buffer_load_dwordx4 v38, s[24:27], s77 offen  lds
    s_add_u32 m0, s78, 81920
    s_nop 0
    buffer_load_dwordx4 v38, s[28:31], s77 offen  lds
    s_branch DMAX
RDYLOOP:
    s_mov_b32 s76, 0
RDYL2:
    s_sleep 24
    global_load_dword v99, v98, s[64:65] sc1
    s_waitcnt vmcnt(0)
    v_sad_u8 v100, v99, 0, 0
    s_nop 1
    v_add_u32_dpp v100, v100, v100 quad_perm:[1,0,3,2] row_mask:0xf bank_mask:0xf
    s_nop 1
    v_add_u32_dpp v100, v100, v100 quad_perm:[2,3,0,1] row_mask:0xf bank_mask:0xf
    v_cmp_gt_u32 vcc, 32, v100
    s_mov_b32 vcc_hi, 0
    s_cmp_eq_u64 vcc, 0
    s_cbranch_scc1 RDYOK
    s_add_u32 s76, s76, 1
    s_cmp_lt_u32 s76, 32768
    s_cbranch_scc1 RDYL2
    s_branch RDYOK
SLOW1:
    buffer_store_dwordx4 v[28:31], v27, s[16:19], s77 offen sc1
    s_branch BACK1
SLOW4:
    buffer_store_dword v24, v10, s[16:19], s3 offen sc1
    s_branch BACK4
SLOW6:
    buffer_store_dwordx4 v[28:31], v1, s[16:19], s77 offen sc1
    s_branch BACK6
RETRY7:
    s_mov_b32 s76, 1
POLL27:
    buffer_load_dword v28, v20, s[16:19], 0 offen sc1
    buffer_load_dword v29, v21, s[16:19], 0 offen sc1
POLLW27:
    s_waitcnt vmcnt(0)
    v_max_u32 v30, v28, v29
    v_cmp_eq_u32 vcc, -1, v30
    s_cbranch_vccnz AGAIN27
POLLX27:
    s_branch OK7
AGAIN27:
    s_add_u32 s76, s76, 1
    s_cmp_lt_u32 s76, 32768
    s_cbranch_scc1 POLL27
    s_branch POLLX27
SLOW8:
    buffer_store_dwordx4 v[28:31], v37, s[16:19], s77 offen sc1
    s_branch BACK8
SLOW10:
    buffer_store_dwordx4 v[28:31], v18, s[16:19], s81 offen sc1
    s_branch BACK10
SLOW11:
    buffer_store_dwordx4 v[52:55], v48, s[16:19], s78 offen sc1
    s_branch BACK11
SLOW12:
    buffer_store_dwordx4 v[52:55], v49, s[16:19], s78 offen sc1
    s_branch BACK12
SLOW13:
    buffer_store_dwordx4 v[52:55], v50, s[16:19], s78 offen sc1
    s_branch BACK13
SLOW15:
    buffer_store_dwordx4 v[28:31], v39, s[16:19], s97 offen sc1
    s_branch BACK15
SLOW16:
    buffer_store_dwordx2 v[34:35], v1, s[16:19], s78 offen sc1
    s_branch BACK16
SLOW17:
    buffer_store_dword v7, v10, s[16:19], s77 offen sc1
    s_branch BACK17
SLOW18:
    buffer_store_dwordx4 v[24:27], v28, s[16:19], 0 offen sc1
    s_branch BACK18
SLOW19:
    buffer_store_dwordx4 v[24:27], v29, s[16:19], 0 offen sc1
    s_branch BACK19
SLOW21:
    buffer_store_dwordx4 v[28:31], v37, s[16:19], s77 offen sc1
    s_branch BACK21
FW2:
    s_add_u32 s96, s3, 1376256
    buffer_store_dword v7, v10, s[8:11], s96 offen
    s_cmp_eq_u32 s10, 0
    s_cbranch_scc1 SLOW28
BACK28:
    s_mul_i32 s79, s68, 12
    s_add_u32 s79, s79, s69
    s_sub_u32 s79, s79, 20
    s_mul_i32 s97, s72, 5120
    s_mul_i32 s96, s79, 20480
    s_add_u32 s96, s96, s97
    s_add_u32 m0, s97, 98304
    s_nop 0
    buffer_load_dwordx4 v1, s[32:35], s96 offen nt lds
    s_add_u32 s96, s96, 1024
    s_add_u32 m0, s97, 99328
    s_nop 0
    buffer_load_dwordx4 v1, s[32:35], s96 offen nt lds
    s_add_u32 s96, s96, 1024
    s_add_u32 m0, s97, 100352
    s_nop 0
    buffer_load_dwordx4 v1, s[32:35], s96 offen nt lds
    s_add_u32 s96, s96, 1024
    s_add_u32 m0, s97, 101376
    s_nop 0
    buffer_load_dwordx4 v1, s[32:35], s96 offen nt lds
    s_add_u32 s96, s96, 1024
    s_add_u32 m0, s97, 102400
    s_nop 0
    buffer_load_dwordx4 v1, s[32:35], s96 offen nt lds
    s_sub_u32 s96, s69, 20
    s_lshl_b32 s96, s96, 2
    s_add_u32 s96, s96, s72
    s_mul_i32 s96, s96, 688
    v_add_u32 v21, s96, v1
    v_min_u32 v21, 32752, v21
    s_add_u32 s97, s3, 688128
    buffer_load_dwordx4 a[240:243], v21, s[16:19], s97 offen sc1
    s_branch FMM
SLOW26:
    buffer_store_dwordx4 v[24:27], v84, s[16:19], s78 offen sc1
    s_branch BACK26
FCS:
    s_waitcnt lgkmcnt(0)
    v_add_f32 v32, v32, v33
    v_add_f32 v34, v34, v35
    v_add_f32 v32, v32, v34
    v_add_f32 v36, v36, v37
    v_add_f32 v38, v38, v39
    v_add_f32 v36, v36, v38
    v_mov_b32 v22, v32
    v_mov_b32 v23, v36
    s_mov_b32 s4, 1
    s_waitcnt vmcnt(0)
    v_mov_b32 v24, -1
    v_mov_b32 v25, -1
    v_mov_b32 v26, -1
    v_mov_b32 v27, -1
    buffer_store_dwordx4 v[24:27], v21, s[8:11], s97 offen
    s_cmp_eq_u32 s10, 0
    s_cbranch_scc1 SLOW29
BACK29:
    s_barrier
    s_branch FPOLL
SLOW28:
    buffer_store_dword v7, v10, s[16:19], s96 offen sc1
    s_branch BACK28
SLOW29:
    buffer_store_dwordx4 v[24:27], v21, s[16:19], s97 offen sc1
    s_branch BACK29
CODE_END:
    s_endpgm
.section .rodata,"a"
.p2align 6
.amdhsa_kernel interleave_layers__sliding_block_cached__glu_gated_swiglu__decode_kernel
  .amdhsa_next_free_vgpr 512
  .amdhsa_next_free_sgpr 102
  .amdhsa_accum_offset 256
  .amdhsa_group_segment_fixed_size 0
  .amdhsa_kernarg_size 96
  .amdhsa_user_sgpr_count 2
  .amdhsa_user_sgpr_kernarg_segment_ptr 1
  .amdhsa_system_sgpr_workgroup_id_x 1
.end_amdhsa_kernel
```

```asm
; @launch grid=(256,1,1) block=(256,1,1) lds=125568
.amdgcn_target "amdgcn-amd-amdhsa--gfx950"
.text
.globl interleave_layers__sliding_block_cached__glu_gated_swiglu__decode_kernel
.p2align 8
.type interleave_layers__sliding_block_cached__glu_gated_swiglu__decode_kernel,@function
interleave_layers__sliding_block_cached__glu_gated_swiglu__decode_kernel:
    s_load_dwordx16 s[44:59], s[0:1], 0
    s_load_dwordx8 s[60:67], s[0:1], 64
    s_cmp_ge_u32 s2, 256
    s_cbranch_scc1 CODE_END
    v_lshrrev_b32 v2, 6, v0
    v_and_b32 v24, 63, v0
    v_readfirstlane_b32 s72, v2
    s_and_b32 s68, s2, 7
    s_lshr_b32 s69, s2, 3
    s_lshr_b32 s70, s69, 3
    s_and_b32 s71, s69, 7
    v_lshlrev_b32 v1, 4, v24
    s_lshl_b32 s77, s70, 3
    s_add_u32 s77, s77, s68
    s_mul_i32 s73, s77, 12582912
    s_lshl_b32 s78, s71, 2
    s_add_u32 s78, s78, s72
    s_mul_i32 s78, s78, 6144
    s_add_u32 s73, s73, s78
    s_add_u32 s73, s73, 11010048
    v_add_u32 v23, 4096, v1
    s_mov_b32 s10, 402653184
    s_mov_b32 s11, 0x20000
    s_getpc_b64 s[100:101]
PCREF:
    s_sub_u32 s100, s100, PCREF-interleave_layers__sliding_block_cached__glu_gated_swiglu__decode_kernel
    s_subb_u32 s101, s101, 0
    s_lshl_b32 s78, s71, 12
    v_lshl_add_u32 v25, v0, 4, s78
    v_cmp_gt_u32 vcc, CODE_END-interleave_layers__sliding_block_cached__glu_gated_swiglu__decode_kernel-16, v25
    s_nop 0
    s_and_saveexec_b64 s[98:99], vcc
    s_cbranch_execz NOCPF
    global_load_dwordx4 a[240:243], v25, s[100:101]
NOCPF:
    s_mov_b64 exec, -1
    s_mul_i32 s79, s77, 384
    s_mov_b32 s74, 0
    s_mul_i32 s3, s68, 81920
    s_mov_b32 s75, 0
    v_mov_b32 v32, -1
    v_mov_b32 v33, -1
    v_mov_b32 v34, -1
    v_mov_b32 v35, -1
    s_mul_i32 s77, s69, 576
    s_add_u32 s77, s77, s3
    s_add_u32 s77, s77, 32768
    v_add_u32 v20, s77, v1
    s_mul_i32 s77, s2, 80
    s_add_u32 s77, s77, 654784
    v_add_u32 v25, s77, v1
    v_cmp_le_u32 vcc, 36, v0
    s_nop 1
    v_cndmask_b32 v21, v20, v25, vcc
    v_mov_b32 v25, 2147483632
    v_cndmask_b32 v20, v20, v25, vcc
    v_cmp_le_u32 vcc, 41, v0
    s_nop 1
    v_cndmask_b32 v21, v21, v25, vcc
    s_mov_b32 s18, 1610612736
    s_mov_b32 s19, 0x20000
    s_waitcnt lgkmcnt(0)
    s_mov_b32 s8, s46
    s_and_b32 s9, s47, 0xffff
    s_mov_b32 s16, s66
    s_and_b32 s17, s67, 0xffff
    buffer_store_dwordx4 v[32:35], v21, s[16:19], 0 offen sc1
    buffer_load_dwordx4 a[0:3], v1, s[8:11], s73 offen offset:0 nt
    buffer_load_dwordx4 a[4:7], v1, s[8:11], s73 offen offset:1024 nt
    s_add_u32 s83, s73, 196608
    s_mov_b32 s12, s48
    s_and_b32 s13, s49, 0xffff
    s_mov_b32 s14, 402653184
    s_mov_b32 s15, 0x20000
    s_mov_b32 s20, s50
    s_and_b32 s21, s51, 0xffff
    s_mov_b32 s22, 7864320
    s_mov_b32 s23, 0x20000
    s_mov_b32 s36, s44
    s_and_b32 s37, s45, 0xffff
    s_mov_b32 s38, 1280
    s_mov_b32 s39, 0x20000
    s_mov_b32 s40, s62
    s_and_b32 s41, s63, 0xffff
    s_mov_b32 s42, 1280
    s_mov_b32 s43, 0x20000
    s_mov_b32 s28, s58
    s_and_b32 s29, s59, 0xffff
    s_mov_b32 s30, 1966080
    s_mov_b32 s31, 0x20000
    s_mov_b32 s32, s60
    s_and_b32 s33, s61, 0xffff
    s_mov_b32 s34, 1966080
    s_mov_b32 s35, 0x20000
    s_cmp_lt_u32 s69, 20
    s_cselect_b32 s24, s52, s56
    s_cselect_b32 s25, s53, s57
    s_cselect_b32 s26, s22, s30
    s_and_b32 s25, s25, 0xffff
    s_mov_b32 s27, 0x20000
    s_add_u32 s84, s83, 196608
    s_add_u32 s85, s84, 196608
    s_add_u32 s86, s85, 196608
    s_add_u32 s87, s86, 196608
    s_add_u32 s88, s87, 196608
    s_add_u32 s89, s88, 196608
    v_mov_b32 v0, v24
    s_mul_i32 s77, s72, 6656
    v_add_u32 v25, 0, v0
    v_mul_u32_u24 v26, 171, v25
    v_lshrrev_b32 v26, 12, v26
    v_mul_u32_u24 v27, 24, v26
    v_sub_u32 v27, v25, v27
    v_lshlrev_b32 v27, 4, v27
    v_mul_u32_u24 v25, 416, v26
    v_add3_u32 v2, v25, v27, s77
    v_mul_u32_u24 v25, 12288, v26
    v_add_u32 v40, v25, v27
    v_mul_u32_u24 v25, 3072, v26
    v_add_u32 v101, v25, v27
    v_add_u32 v25, 64, v0
    v_mul_u32_u24 v26, 171, v25
    v_lshrrev_b32 v26, 12, v26
    v_mul_u32_u24 v27, 24, v26
    v_sub_u32 v27, v25, v27
    v_lshlrev_b32 v27, 4, v27
    v_mul_u32_u24 v25, 416, v26
    v_add3_u32 v3, v25, v27, s77
    v_mul_u32_u24 v25, 12288, v26
    v_add_u32 v41, v25, v27
    v_mul_u32_u24 v25, 3072, v26
    v_add_u32 v102, v25, v27
    v_add_u32 v25, 128, v0
    v_mul_u32_u24 v26, 171, v25
    v_lshrrev_b32 v26, 12, v26
    v_mul_u32_u24 v27, 24, v26
    v_sub_u32 v27, v25, v27
    v_lshlrev_b32 v27, 4, v27
    v_mul_u32_u24 v25, 416, v26
    v_add3_u32 v4, v25, v27, s77
    v_mul_u32_u24 v25, 12288, v26
    v_add_u32 v42, v25, v27
    v_mul_u32_u24 v25, 3072, v26
    v_add_u32 v103, v25, v27
    v_and_b32 v25, 15, v0
    v_lshrrev_b32 v26, 4, v0
    v_bfe_u32 v27, v0, 2, 2
    v_and_b32 v28, 3, v0
    s_mul_i32 s78, s71, 160
    v_lshlrev_b32 v36, 4, v26
    v_lshlrev_b32 v37, 3, v26
    v_lshlrev_b32 v39, 2, v0
    buffer_load_dwordx4 v[70:73], v36, s[36:39], s78 offen
    buffer_load_dwordx4 v[74:77], v36, s[36:39], s78 offen offset:64
    buffer_load_dwordx2 v[78:79], v37, s[36:39], s78 offen offset:128
    buffer_load_dwordx4 v[80:83], v1, s[36:39], 0 offen
    buffer_load_dword v84, v39, s[36:39], 0 offen offset:1024
    s_lshl_b32 s7, s69, 6
    v_lshlrev_b32 v38, 2, v25
    buffer_load_dword v22, v38, s[36:39], s7 offen
    s_mul_i32 s78, s71, 983040
    s_add_u32 s79, s79, s78
    s_mul_i32 s78, s72, 98304
    s_add_u32 s79, s79, s78
    s_mul_i32 s78, s72, 3072
    s_add_u32 s78, s78, 26624
    s_add_u32 m0, s78, 0
    s_nop 0
    buffer_load_dwordx4 v40, s[20:23], s79 offen nt lds
    s_add_u32 m0, s78, 1024
    s_nop 0
    buffer_load_dwordx4 v41, s[20:23], s79 offen nt lds
    s_add_u32 m0, s78, 2048
    s_nop 0
    buffer_load_dwordx4 v42, s[20:23], s79 offen nt lds
    s_add_u32 s79, s79, 393216
    s_add_u32 m0, s78, 12288
    s_nop 0
    buffer_load_dwordx4 v40, s[20:23], s79 offen nt lds
    s_add_u32 m0, s78, 13312
    s_nop 0
    buffer_load_dwordx4 v41, s[20:23], s79 offen nt lds
    s_add_u32 m0, s78, 14336
    s_nop 0
    buffer_load_dwordx4 v42, s[20:23], s79 offen nt lds
    s_add_u32 s79, s79, 393216
    s_cmp_ge_u32 s72, 2
    s_cbranch_scc1 NOWQ3
    s_add_u32 m0, s78, 24576
    s_nop 0
    buffer_load_dwordx4 v40, s[20:23], s79 offen nt lds
    s_add_u32 m0, s78, 25600
    s_nop 0
    buffer_load_dwordx4 v41, s[20:23], s79 offen nt lds
    s_add_u32 m0, s78, 26624
    s_nop 0
    buffer_load_dwordx4 v42, s[20:23], s79 offen nt lds
NOWQ3:
    s_mul_i32 s78, s71, 160
    s_mov_b32 s20, s52
    s_and_b32 s21, s53, 0xffff
    s_mov_b32 s22, 7864320
    s_mov_b32 s23, 0x20000
    s_cmp_lt_u32 s72, 2
    s_cselect_b32 s36, s56, s58
    s_cselect_b32 s37, s57, s59
    s_and_b32 s37, s37, 0xffff
    s_mov_b32 s38, 1966080
    s_lshl_b32 s90, s70, 3
    s_add_u32 s90, s90, s68
    s_lshl_b32 s90, s90, 3
    s_add_u32 s90, s90, s71
    s_mul_i32 s90, s90, 30720
    s_mul_i32 s79, s72, 6144
    s_add_u32 s90, s90, s79
    s_cmp_eq_u32 s72, 3
    s_cselect_b32 s79, 3072, 0
    s_add_u32 s90, s90, s79
    s_cmp_lt_u32 s72, 2
    s_cselect_b32 s79, 1879048176, 0
    v_add_u32 v108, s79, v23
    v_add_u32 v109, 4096, v108
    s_and_b32 s91, s72, 1
    s_lshl_b32 s79, s69, 1
    s_add_u32 s91, s91, s79
    s_mul_i32 s79, s91, 0
    s_add_u32 s79, s79, 640
    s_mul_i32 s91, s91, 16
    s_cmp_lt_u32 s69, 20
    s_cselect_b32 s91, s91, s79
    s_mov_b32 s7, 49152
    s_cselect_b32 s7, s7, 0
    s_mul_i32 s91, s91, 3072
    s_mul_i32 s79, s68, 384
    s_add_u32 s91, s91, s79
    v_mov_b32 v29, 1879048176
    v_add_u32 v104, 24576, v101
    v_add_u32 v105, 24576, v102
    v_add_u32 v106, 24576, v103
    v_cmp_gt_u32 vcc, s7, v101
    s_nop 1
    v_cndmask_b32 v101, v29, v101, vcc
    v_cmp_gt_u32 vcc, s7, v102
    s_nop 1
    v_cndmask_b32 v102, v29, v102, vcc
    v_cmp_gt_u32 vcc, s7, v103
    s_nop 1
    v_cndmask_b32 v103, v29, v103, vcc
    v_cmp_gt_u32 vcc, s7, v104
    s_nop 1
    v_cndmask_b32 v104, v29, v104, vcc
    v_cmp_gt_u32 vcc, s7, v105
    s_nop 1
    v_cndmask_b32 v105, v29, v105, vcc
    v_cmp_gt_u32 vcc, s7, v106
    s_nop 1
    v_cndmask_b32 v106, v29, v106, vcc
    buffer_load_dwordx4 a[8:11], v1, s[8:11], s73 offen offset:2048 nt
    buffer_load_dwordx4 a[12:15], v1, s[8:11], s73 offen offset:3072 nt
    buffer_load_dwordx4 a[16:19], v23, s[8:11], s73 offen offset:0 nt
    v_mul_u32_u24 v29, 416, v25
    v_lshl_add_u32 v29, v26, 4, v29
    v_add_u32 v5, s77, v29
    v_lshrrev_b32 v29, 2, v0
    v_mul_u32_u24 v29, 416, v29
    v_lshl_add_u32 v29, v28, 3, v29
    v_add_u32 v6, s77, v29
    s_mul_i32 s79, s72, 96
    s_add_u32 s79, s79, 26624
    v_lshl_add_u32 v29, v26, 3, v27
    v_mul_u32_u24 v29, 384, v29
    v_lshl_add_u32 v29, v28, 3, v29
    v_add_u32 v16, s79, v29
    v_lshl_add_u32 v29, v26, 2, v27
    v_mul_u32_u24 v29, 384, v29
    v_lshl_add_u32 v29, v28, 3, v29
    v_add_u32 v17, s79, v29
    buffer_load_dwordx4 a[20:23], v23, s[8:11], s73 offen offset:1024 nt
    v_mul_u32_u24 v31, 103, v0
    v_lshrrev_b32 v31, 10, v31
    v_mul_u32_u24 v30, 10, v31
    v_sub_u32 v30, v0, v30
    v_lshl_add_u32 v29, v30, 4, s78
    v_mul_u32_u24 v8, 1280, v31
    v_add_u32 v8, 665600, v8
    s_mul_i32 s7, s68, 81920
    s_add_u32 s7, s7, 47360
    v_mov_b32 v30, s7
    v_cmp_eq_u32 vcc, s68, v31
    s_nop 1
    v_cndmask_b32 v8, v8, v30, vcc
    v_add_u32 v30, 2560, v30
    v_cmp_le_u32 vcc, 8, v31
    s_nop 1
    v_cndmask_b32 v8, v8, v30, vcc
    v_add_u32 v8, v8, v29
    v_add_u32 v31, 6, v31
    v_mul_u32_u24 v9, 1280, v31
    v_add_u32 v9, 665600, v9
    s_mul_i32 s7, s68, 81920
    s_add_u32 s7, s7, 47360
    v_mov_b32 v30, s7
    v_cmp_eq_u32 vcc, s68, v31
    s_nop 1
    v_cndmask_b32 v9, v9, v30, vcc
    v_add_u32 v30, 2560, v30
    v_cmp_le_u32 vcc, 8, v31
    s_nop 1
    v_cndmask_b32 v9, v9, v30, vcc
    v_add_u32 v9, v9, v29
    v_mov_b32 v30, 2147483632
    v_cmp_le_u32 vcc, 30, v0
    s_nop 1
    v_cndmask_b32 v9, v9, v30, vcc
    s_lshl_b32 s78, s69, 10
    s_lshl_b32 s79, s72, 8
    s_add_u32 s78, s78, s79
    v_lshl_add_u32 v10, v0, 2, s78
    s_lshl_b32 s78, s70, 13
    s_add_u32 s78, s78, s79
    v_lshlrev_b32 v29, 10, v26
    v_lshl_add_u32 v29, v25, 4, v29
    v_add_u32 v11, s78, v29
    buffer_load_dwordx4 a[24:27], v1, s[8:11], s83 offen offset:0 nt
    s_mul_i32 s78, s72, 96
    s_add_u32 s78, s78, 118784
    v_lshl_add_u32 v29, v27, 5, s78
    v_lshl_add_u32 v29, v28, 2, v29
    v_lshrrev_b32 v30, 1, v26
    v_lshl_add_u32 v29, v30, 4, v29
    v_and_b32 v30, 1, v26
    v_lshl_add_u32 v29, v30, 1, v29
    v_mov_b32 v30, 119168
    v_cmp_le_u32 vcc, 12, v25
    s_nop 1
    v_cndmask_b32 v12, v29, v30, vcc
    v_and_b32 v30, 1, v0
    v_lshlrev_b32 v29, 5, v26
    v_lshl_add_u32 v29, v30, 4, v29
    v_add_u32 v13, 118784, v29
    v_mul_u32_u24 v30, 0xaaaa, v30
    v_and_b32 v29, 1, v27
    v_mul_u32_u24 v29, 0xaaaa, v29
    v_lshl_or_b32 v29, v29, 16, v30
    v_add_u32 v14, 0x44444444, v29
    buffer_load_dwordx4 a[28:31], v1, s[8:11], s83 offen offset:1024 nt
    s_lshl_b32 s78, s72, 8
    s_add_u32 s78, s78, 124416
    v_lshrrev_b32 v29, 5, v0
    v_lshl_add_u32 v29, v29, 6, s78
    v_bfe_u32 v30, v0, 3, 1
    v_lshl_add_u32 v29, v30, 5, v29
    v_bfe_u32 v30, v0, 1, 1
    v_lshl_add_u32 v29, v30, 4, v29
    v_bfe_u32 v30, v0, 2, 1
    v_lshl_add_u32 v29, v30, 3, v29
    v_bfe_u32 v30, v0, 4, 1
    v_lshl_add_u32 v29, v30, 2, v29
    v_bfe_u32 v30, v0, 0, 1
    v_lshl_add_u32 v29, v30, 1, v29
    v_mov_b32 v19, v29
    v_bfe_u32 v29, v0, 4, 1
    v_bfe_u32 v30, v0, 2, 1
    v_lshl_add_u32 v29, v29, 5, s78
    v_lshl_add_u32 v29, v30, 4, v29
    v_accvgpr_write_b32 a252, v29
    s_mul_i32 s78, s72, 768
    s_add_u32 s78, s78, 119296
    v_lshl_add_u32 v29, v25, 2, s78
    v_bfe_u32 v30, v0, 4, 1
    v_lshl_add_u32 v29, v30, 7, v29
    v_lshrrev_b32 v30, 5, v0
    v_lshl_add_u32 v15, v30, 6, v29
    s_waitcnt vmcnt(12)
    v_lshlrev_b32 v88, 16, v80
    v_and_b32 v89, 0xffff0000, v80
    v_lshlrev_b32 v90, 16, v81
    v_and_b32 v91, 0xffff0000, v81
    v_lshlrev_b32 v92, 16, v82
    v_and_b32 v93, 0xffff0000, v82
    v_lshlrev_b32 v94, 16, v83
    v_and_b32 v95, 0xffff0000, v83
    v_lshlrev_b32 v96, 16, v84
    v_and_b32 v97, 0xffff0000, v84
    v_add_f32 v80, v88, v89
    v_add_f32 v80, v80, v90
    v_add_f32 v80, v80, v91
    v_add_f32 v80, v80, v92
    v_add_f32 v80, v80, v93
    v_add_f32 v80, v80, v94
    v_add_f32 v80, v80, v95
    v_add_f32 v80, v80, v96
    v_add_f32 v80, v80, v97
    s_nop 1
    v_add_f32_dpp v80, v80, v80 row_ror:8 row_mask:0xf bank_mask:0xf
    s_nop 1
    v_add_f32_dpp v80, v80, v80 row_ror:4 row_mask:0xf bank_mask:0xf
    s_nop 1
    v_add_f32_dpp v80, v80, v80 row_ror:2 row_mask:0xf bank_mask:0xf
    s_nop 1
    v_add_f32_dpp v80, v80, v80 row_ror:1 row_mask:0xf bank_mask:0xf
    v_mov_b32 v81, v80
    s_nop 1
    v_permlane32_swap_b32 v80, v81
    v_add_f32 v80, v80, v81
    v_mov_b32 v81, v80
    s_nop 1
    v_permlane16_swap_b32 v80, v81
    v_add_f32 v80, v80, v81
    v_mul_f32 v80, 0x3acccccd, v80
    v_sub_f32 v88, v88, v80
    v_sub_f32 v89, v89, v80
    v_sub_f32 v90, v90, v80
    v_sub_f32 v91, v91, v80
    v_sub_f32 v92, v92, v80
    v_sub_f32 v93, v93, v80
    v_sub_f32 v94, v94, v80
    v_sub_f32 v95, v95, v80
    v_sub_f32 v96, v96, v80
    v_sub_f32 v97, v97, v80
    v_mul_f32 v82, v88, v88
    v_fmac_f32 v82, v89, v89
    v_fmac_f32 v82, v90, v90
    v_fmac_f32 v82, v91, v91
    v_fmac_f32 v82, v92, v92
    v_fmac_f32 v82, v93, v93
    v_fmac_f32 v82, v94, v94
    v_fmac_f32 v82, v95, v95
    v_fmac_f32 v82, v96, v96
    v_fmac_f32 v82, v97, v97
    buffer_load_dwordx4 a[32:35], v1, s[8:11], s83 offen offset:2048 nt
    s_nop 0
    v_add_f32_dpp v82, v82, v82 row_ror:8 row_mask:0xf bank_mask:0xf
    s_nop 1
    v_add_f32_dpp v82, v82, v82 row_ror:4 row_mask:0xf bank_mask:0xf
    s_nop 1
    v_add_f32_dpp v82, v82, v82 row_ror:2 row_mask:0xf bank_mask:0xf
    s_nop 1
    v_add_f32_dpp v82, v82, v82 row_ror:1 row_mask:0xf bank_mask:0xf
    v_mov_b32 v81, v82
    s_nop 1
    v_permlane32_swap_b32 v82, v81
    v_add_f32 v82, v82, v81
    v_mov_b32 v81, v82
    s_nop 1
    v_permlane16_swap_b32 v82, v81
    v_add_f32 v82, v82, v81
    v_mul_f32 v82, 0x3acccccd, v82
    v_add_f32 v82, 0x3727c5ac, v82
    v_rsq_f32 v82, v82
    s_mov_b32 vcc_lo, 0xaaaaaaaa
    s_mov_b32 vcc_hi, 0xaaaaaaaa
    v_mov_b32 v85, 0x3f803f80
    v_lshlrev_b32 v83, 16, v70
    v_and_b32 v84, 0xffff0000, v70
    v_sub_f32 v83, v83, v80
    v_sub_f32 v84, v84, v80
    v_mul_f32 v83, v83, v82
    v_mul_f32 v84, v84, v82
    v_cvt_pk_bf16_f32 v83, v83, v84
    v_cndmask_b32 v70, v83, v85, vcc
    v_lshlrev_b32 v83, 16, v71
    v_and_b32 v84, 0xffff0000, v71
    v_sub_f32 v83, v83, v80
    v_sub_f32 v84, v84, v80
    v_mul_f32 v83, v83, v82
    v_mul_f32 v84, v84, v82
    v_cvt_pk_bf16_f32 v83, v83, v84
    v_cndmask_b32 v71, v83, v85, vcc
    v_lshlrev_b32 v83, 16, v72
    v_and_b32 v84, 0xffff0000, v72
    v_sub_f32 v83, v83, v80
    v_sub_f32 v84, v84, v80
    v_mul_f32 v83, v83, v82
    v_mul_f32 v84, v84, v82
    v_cvt_pk_bf16_f32 v83, v83, v84
    v_cndmask_b32 v72, v83, v85, vcc
    v_lshlrev_b32 v83, 16, v73
    v_and_b32 v84, 0xffff0000, v73
    v_sub_f32 v83, v83, v80
    v_sub_f32 v84, v84, v80
    v_mul_f32 v83, v83, v82
    v_mul_f32 v84, v84, v82
    v_cvt_pk_bf16_f32 v83, v83, v84
    v_cndmask_b32 v73, v83, v85, vcc
    v_lshlrev_b32 v83, 16, v74
    v_and_b32 v84, 0xffff0000, v74
    v_sub_f32 v83, v83, v80
    v_sub_f32 v84, v84, v80
    v_mul_f32 v83, v83, v82
    v_mul_f32 v84, v84, v82
    v_cvt_pk_bf16_f32 v83, v83, v84
    v_cndmask_b32 v74, v83, v85, vcc
    v_lshlrev_b32 v83, 16, v75
    v_and_b32 v84, 0xffff0000, v75
    v_sub_f32 v83, v83, v80
    v_sub_f32 v84, v84, v80
    v_mul_f32 v83, v83, v82
    v_mul_f32 v84, v84, v82
    v_cvt_pk_bf16_f32 v83, v83, v84
    v_cndmask_b32 v75, v83, v85, vcc
    buffer_load_dwordx4 a[36:39], v1, s[8:11], s83 offen offset:3072 nt
    v_lshlrev_b32 v83, 16, v76
    v_and_b32 v84, 0xffff0000, v76
    v_sub_f32 v83, v83, v80
    v_sub_f32 v84, v84, v80
    v_mul_f32 v83, v83, v82
    v_mul_f32 v84, v84, v82
    v_cvt_pk_bf16_f32 v83, v83, v84
    v_cndmask_b32 v76, v83, v85, vcc
    v_lshlrev_b32 v83, 16, v77
    v_and_b32 v84, 0xffff0000, v77
    v_sub_f32 v83, v83, v80
    v_sub_f32 v84, v84, v80
    v_mul_f32 v83, v83, v82
    v_mul_f32 v84, v84, v82
    v_cvt_pk_bf16_f32 v83, v83, v84
    v_cndmask_b32 v77, v83, v85, vcc
    v_lshlrev_b32 v83, 16, v78
    v_and_b32 v84, 0xffff0000, v78
    v_sub_f32 v83, v83, v80
    v_sub_f32 v84, v84, v80
    v_mul_f32 v83, v83, v82
    v_mul_f32 v84, v84, v82
    v_cvt_pk_bf16_f32 v83, v83, v84
    v_cndmask_b32 v78, v83, v85, vcc
    v_lshlrev_b32 v83, 16, v79
    v_and_b32 v84, 0xffff0000, v79
    v_sub_f32 v83, v83, v80
    v_sub_f32 v84, v84, v80
    v_mul_f32 v83, v83, v82
    v_mul_f32 v84, v84, v82
    v_cvt_pk_bf16_f32 v83, v83, v84
    v_cndmask_b32 v79, v83, v85, vcc
    s_waitcnt vmcnt(8)
    s_barrier
    ds_read_b64_tr_b16 v[40:41], v16 offset:0
    ds_read_b64_tr_b16 v[42:43], v16 offset:1536
    ds_read_b64_tr_b16 v[44:45], v16 offset:12288
    ds_read_b64_tr_b16 v[46:47], v16 offset:13824
    ds_read_b64_tr_b16 v[48:49], v17 offset:24576
    ds_read_b64_tr_b16 v[50:51], v16 offset:32
    ds_read_b64_tr_b16 v[52:53], v16 offset:1568
    ds_read_b64_tr_b16 v[54:55], v16 offset:12320
    ds_read_b64_tr_b16 v[56:57], v16 offset:13856
    ds_read_b64_tr_b16 v[58:59], v17 offset:24608
    ds_read_b64_tr_b16 v[60:61], v16 offset:64
    ds_read_b64_tr_b16 v[62:63], v16 offset:1600
    ds_read_b64_tr_b16 v[64:65], v16 offset:12352
    ds_read_b64_tr_b16 v[66:67], v16 offset:13888
    ds_read_b64_tr_b16 v[68:69], v17 offset:24640
    buffer_load_dwordx4 a[40:43], v23, s[8:11], s83 offen offset:0 nt
    buffer_load_dwordx4 a[44:47], v23, s[8:11], s83 offen offset:1024 nt
    s_mul_i32 s79, s72, 96
    s_add_u32 s79, s79, 119296
    v_min_u32 v36, 48, v0
    v_lshl_add_u32 v36, v36, 1, s79
    v_mov_b32 v37, 119808
    v_cmp_le_u32 vcc, 48, v0
    s_nop 1
    v_cndmask_b32 v36, v36, v37, vcc
    v_add_u32 v37, 119296, v1
    s_waitcnt lgkmcnt(0)
    v_mfma_f32_16x16x32_bf16 v[24:27], v[70:73], v[40:43], 0
    v_mfma_f32_16x16x32_bf16 v[28:31], v[70:73], v[50:53], 0
    v_mfma_f32_16x16x32_bf16 v[32:35], v[70:73], v[60:63], 0
    v_mfma_f32_16x16x32_bf16 v[24:27], v[74:77], v[44:47], v[24:27]
    v_mfma_f32_16x16x32_bf16 v[28:31], v[74:77], v[54:57], v[28:31]
    v_mfma_f32_16x16x32_bf16 v[32:35], v[74:77], v[64:67], v[32:35]
    v_mfma_f32_16x16x16_bf16 v[24:27], v[78:79], v[48:49], v[24:27]
    v_mfma_f32_16x16x16_bf16 v[28:31], v[78:79], v[58:59], v[28:31]
    v_mfma_f32_16x16x16_bf16 v[32:35], v[78:79], v[68:69], v[32:35]
    buffer_load_dwordx4 a[48:51], v1, s[8:11], s84 offen offset:0 nt
    s_nop 4
    v_mov_b32 v7, v25
    v_mov_b32_dpp v24, v28 quad_perm:[0,1,2,3] row_mask:0x2 bank_mask:0xf
    s_nop 0
    v_mov_b32_dpp v7, v29 quad_perm:[0,1,2,3] row_mask:0x2 bank_mask:0xf
    v_mov_b32_dpp v24, v32 quad_perm:[0,1,2,3] row_mask:0x4 bank_mask:0xf
    s_nop 0
    v_mov_b32_dpp v7, v33 quad_perm:[0,1,2,3] row_mask:0x4 bank_mask:0xf
    v_cvt_pk_bf16_f32 v24, v24, v24
    ds_write_b16 v36, v24
    buffer_load_dwordx4 a[52:55], v1, s[8:11], s84 offen offset:1024 nt
    buffer_load_dwordx4 a[56:59], v1, s[8:11], s84 offen offset:2048 nt
    s_waitcnt lgkmcnt(0)
    s_barrier
    ds_read_b128 v[28:31], v37
    s_mul_i32 s79, s69, 384
    s_add_u32 s79, s79, s3
    s_cmp_eq_u32 s72, 0
    s_cselect_b32 exec_lo, 0xffffff, 1
    s_mov_b32 exec_hi, 0
    s_cselect_b32 s78, 0, 1879048176
    v_add_u32 v37, s78, v1
    s_waitcnt lgkmcnt(0)
    buffer_store_dwordx4 v[28:31], v37, s[16:19], s79 offen sc1
    s_mov_b64 exec, -1
    buffer_load_dwordx4 a[60:63], v1, s[8:11], s84 offen offset:3072 nt
    buffer_load_dwordx4 a[64:67], v23, s[8:11], s84 offen offset:0 nt
    s_waitcnt vmcnt(12)
    ds_write_b128 v2, a[0:3] offset:0
    ds_write_b128 v3, a[4:7] offset:0
    ds_write_b128 v4, a[8:11] offset:0
    ds_write_b128 v2, a[12:15] offset:3328
    ds_write_b128 v3, a[16:19] offset:3328
    ds_write_b128 v4, a[20:23] offset:3328
    ds_read_b128 a[0:3], v5 offset:0
    ds_read_b128 a[4:7], v5 offset:64
    ds_read_b128 a[8:11], v5 offset:128
    ds_read_b128 a[12:15], v5 offset:192
    ds_read_b128 a[16:19], v5 offset:256
    ds_read_b128 a[20:23], v5 offset:320
    buffer_load_dwordx4 a[68:71], v23, s[8:11], s84 offen offset:1024 nt
    s_barrier
    buffer_load_dwordx4 a[72:75], v1, s[8:11], s85 offen offset:0 nt
    buffer_load_dwordx4 a[76:79], v1, s[8:11], s85 offen offset:1024 nt
    buffer_load_dwordx4 a[80:83], v1, s[8:11], s85 offen offset:2048 nt
    buffer_load_dwordx4 a[84:87], v1, s[8:11], s85 offen offset:3072 nt
    buffer_load_dwordx4 a[88:91], v23, s[8:11], s85 offen offset:0 nt
    buffer_load_dwordx4 a[92:95], v23, s[8:11], s85 offen offset:1024 nt
    s_barrier
    s_getreg_b32 s5, hwreg(HW_REG_XCC_ID, 0, 4)
    s_lshr_b32 s92, s5, 2
    s_lshl_b32 s93, s68, 2
    s_add_u32 s92, s92, s93
    s_and_b32 s93, s5, 3
    s_lshl_b32 s93, s93, 3
    s_lshl_b32 s94, 1, s93
    s_lshl_b32 s96, 32, s93
    s_mov_b32 s5, s92
    s_cmp_lg_u32 s72, 0
    s_cbranch_scc1 NOATOM
    s_waitcnt vmcnt(9)
    s_lshl_b32 s92, s92, 2
    v_mov_b32 v36, s92
    v_mov_b32 v37, s94
    s_mov_b64 exec, 1
    global_atomic_add v36, v37, s[64:65] sc1
    s_mov_b64 exec, -1
NOATOM:
    s_waitcnt vmcnt(13)
    ds_write_b128 v2, a[24:27] offset:0
    ds_write_b128 v3, a[28:31] offset:0
    ds_write_b128 v4, a[32:35] offset:0
    ds_write_b128 v2, a[36:39] offset:3328
    ds_write_b128 v3, a[40:43] offset:3328
    ds_write_b128 v4, a[44:47] offset:3328
    ds_read_b128 a[24:27], v5 offset:0
    ds_read_b128 a[28:31], v5 offset:64
    ds_read_b128 a[32:35], v5 offset:128
    ds_read_b128 a[36:39], v5 offset:192
    ds_read_b128 a[40:43], v5 offset:256
    ds_read_b128 a[44:47], v5 offset:320
    buffer_load_dwordx4 a[240:243], v101, s[36:39], s91 offen
    buffer_load_dwordx4 a[240:243], v102, s[36:39], s91 offen
    buffer_load_dwordx4 a[240:243], v103, s[36:39], s91 offen
    buffer_load_dwordx4 a[240:243], v104, s[36:39], s91 offen
    buffer_load_dwordx4 a[240:243], v105, s[36:39], s91 offen
    buffer_load_dwordx4 a[240:243], v106, s[36:39], s91 offen
    s_barrier
    s_waitcnt vmcnt(12)
    ds_write_b128 v2, a[48:51] offset:0
    ds_write_b128 v3, a[52:55] offset:0
    ds_write_b128 v4, a[56:59] offset:0
    ds_write_b128 v2, a[60:63] offset:3328
    ds_write_b128 v3, a[64:67] offset:3328
    ds_write_b128 v4, a[68:71] offset:3328
    ds_read_b128 a[48:51], v5 offset:0
    ds_read_b128 a[52:55], v5 offset:64
    ds_read_b128 a[56:59], v5 offset:128
    ds_read_b128 a[60:63], v5 offset:192
    ds_read_b128 a[64:67], v5 offset:256
    ds_read_b128 a[68:71], v5 offset:320
    v_lshlrev_b32 v98, 2, v0
    buffer_load_dwordx4 a[96:99], v1, s[8:11], s86 offen offset:0 nt
    buffer_load_dwordx4 a[100:103], v1, s[8:11], s86 offen offset:1024 nt
    buffer_load_dwordx4 a[104:107], v1, s[8:11], s86 offen offset:2048 nt
    buffer_load_dwordx4 a[108:111], v1, s[8:11], s86 offen offset:3072 nt
    buffer_load_dwordx4 a[112:115], v23, s[8:11], s86 offen offset:0 nt
    buffer_load_dwordx4 a[116:119], v23, s[8:11], s86 offen offset:1024 nt
    s_barrier
    buffer_load_dwordx4 a[120:123], v1, s[8:11], s87 offen offset:0 nt
    buffer_load_dwordx4 a[124:127], v1, s[8:11], s87 offen offset:1024 nt
    buffer_load_dwordx4 a[128:131], v1, s[8:11], s87 offen offset:2048 nt
    buffer_load_dwordx4 a[132:135], v1, s[8:11], s87 offen offset:3072 nt
    buffer_load_dwordx4 a[136:139], v23, s[8:11], s87 offen offset:0 nt
    buffer_load_dwordx4 a[140:143], v23, s[8:11], s87 offen offset:1024 nt
    s_barrier
    s_waitcnt vmcnt(18)
    ds_write_b128 v2, a[72:75] offset:0
    ds_write_b128 v3, a[76:79] offset:0
    ds_write_b128 v4, a[80:83] offset:0
    ds_write_b128 v2, a[84:87] offset:3328
    ds_write_b128 v3, a[88:91] offset:3328
    ds_write_b128 v4, a[92:95] offset:3328
    ds_read_b128 a[72:75], v5 offset:0
    ds_read_b128 a[76:79], v5 offset:64
    ds_read_b128 a[80:83], v5 offset:128
    ds_read_b128 a[84:87], v5 offset:192
    ds_read_b128 a[88:91], v5 offset:256
    ds_read_b128 a[92:95], v5 offset:320
    buffer_load_dwordx4 a[144:147], v1, s[8:11], s88 offen offset:0 nt
    buffer_load_dwordx4 a[148:151], v1, s[8:11], s88 offen offset:1024 nt
    buffer_load_dwordx4 a[152:155], v1, s[8:11], s88 offen offset:2048 nt
    buffer_load_dwordx4 a[156:159], v1, s[8:11], s88 offen offset:3072 nt
    buffer_load_dwordx4 a[160:163], v23, s[8:11], s88 offen offset:0 nt
    buffer_load_dwordx4 a[164:167], v23, s[8:11], s88 offen offset:1024 nt
    s_barrier
    s_waitcnt vmcnt(12)
    ds_write_b128 v2, a[96:99] offset:0
    ds_write_b128 v3, a[100:103] offset:0
    ds_write_b128 v4, a[104:107] offset:0
    ds_write_b128 v2, a[108:111] offset:3328
    ds_write_b128 v3, a[112:115] offset:3328
    ds_write_b128 v4, a[116:119] offset:3328
    ds_read_b128 a[96:99], v5 offset:0
    ds_read_b128 a[100:103], v5 offset:64
    ds_read_b128 a[104:107], v5 offset:128
    ds_read_b128 a[108:111], v5 offset:192
    ds_read_b128 a[112:115], v5 offset:256
    ds_read_b128 a[116:119], v5 offset:320
    buffer_load_dwordx4 a[168:171], v1, s[8:11], s89 offen offset:0 nt
    buffer_load_dwordx4 a[172:175], v1, s[8:11], s89 offen offset:1024 nt
    buffer_load_dwordx4 a[176:179], v1, s[8:11], s89 offen offset:2048 nt
    buffer_load_dwordx4 a[180:183], v1, s[8:11], s89 offen offset:3072 nt
    buffer_load_dwordx4 a[184:187], v23, s[8:11], s89 offen offset:0 nt
    buffer_load_dwordx4 a[188:191], v23, s[8:11], s89 offen offset:1024 nt
    s_barrier
    s_cmp_ge_u32 s69, 20
    s_cbranch_scc1 DMAF
    s_lshl_b32 s66, s72, 3
    s_add_u32 s66, s66, s68
    s_mul_i32 s66, s66, 245760
    s_lshl_b32 s78, s69, 6
    s_add_u32 s66, s66, s78
    s_mul_i32 s67, s72, 12288
    s_add_u32 s67, s67, 57344
    v_lshrrev_b32 v38, 2, v0
    v_mul_u32_u24 v38, 1280, v38
    v_and_b32 v39, 3, v0
    v_lshl_add_u32 v39, v39, 4, v38
    s_mov_b32 m0, s67
    s_add_u32 s67, s67, 1024
    buffer_load_dwordx4 v39, s[24:27], s66 offen  lds
    s_add_u32 s66, s66, 20480
    s_mov_b32 m0, s67
    s_add_u32 s67, s67, 1024
    buffer_load_dwordx4 v39, s[24:27], s66 offen  lds
    s_add_u32 s66, s66, 20480
DMAX:
    v_mov_b32 v109, v20
    v_and_b32 v25, 15, v0
    v_lshrrev_b32 v26, 4, v0
    v_add_u32 v27, 4, v26
    v_mul_u32_u24 v20, 1280, v26
    v_add_u32 v20, 665600, v20
    s_mul_i32 s7, s68, 81920
    s_add_u32 s7, s7, 47360
    v_mov_b32 v28, s7
    v_cmp_eq_u32 vcc, s68, v26
    s_nop 1
    v_cndmask_b32 v20, v20, v28, vcc
    v_mul_u32_u24 v21, 1280, v27
    v_add_u32 v21, 665600, v21
    s_mul_i32 s7, s68, 81920
    s_add_u32 s7, s7, 47360
    v_mov_b32 v28, s7
    v_cmp_eq_u32 vcc, s68, v27
    s_nop 1
    v_cndmask_b32 v21, v21, v28, vcc
    s_min_u32 s7, s69, 19
    s_lshl_b32 s7, s7, 6
    v_lshl_add_u32 v25, v25, 2, s7
    v_add_u32 v20, v20, v25
    v_add_u32 v21, v21, v25
    buffer_load_dwordx4 a[216:219], v1, s[12:15], s73 offen offset:0 nt
    v_and_b32 v25, 15, v0
    v_bfe_u32 v27, v0, 2, 2
    v_and_b32 v28, 3, v0
    s_mul_i32 s7, s72, 12288
    s_add_u32 s7, s7, 57344
    v_lshl_add_u32 v29, v26, 3, v27
    v_lshlrev_b32 v29, 6, v29
    v_lshl_add_u32 v29, v28, 3, v29
    v_add_u32 v29, s7, v29
    v_accvgpr_write_b32 a246, v29
    s_mul_i32 s7, s72, 3072
    s_add_u32 s7, s7, 32768
    v_lshl_add_u32 v29, v25, 4, s7
    v_lshl_add_u32 v29, v26, 7, v29
    v_accvgpr_write_b32 a247, v29
    s_lshl_b32 s7, s72, 6
    s_add_u32 s7, s7, 45056
    v_and_b32 v29, 1, v26
    v_lshl_add_u32 v29, v29, 5, s7
    v_accvgpr_write_b32 a248, v29
    s_lshl_b32 s7, s72, 8
    s_add_u32 s7, s7, 122368
    v_lshl_add_u32 v29, v0, 2, s7
    v_accvgpr_write_b32 a249, v29
    s_lshl_b32 s81, s69, 6
    s_mul_i32 s80, s68, 1280
    s_add_u32 s80, s80, s81
    s_add_u32 s80, s80, 655360
    s_add_u32 s81, s81, s3
    s_add_u32 s81, s81, 46080
    s_waitcnt vmcnt(13)
    ds_write_b128 v2, a[120:123] offset:0
    ds_write_b128 v3, a[124:127] offset:0
    ds_write_b128 v4, a[128:131] offset:0
    ds_write_b128 v2, a[132:135] offset:3328
    ds_write_b128 v3, a[136:139] offset:3328
    ds_write_b128 v4, a[140:143] offset:3328
    ds_read_b128 a[120:123], v5 offset:0
    ds_read_b128 a[124:127], v5 offset:64
    ds_read_b128 a[128:131], v5 offset:128
    ds_read_b128 a[132:135], v5 offset:192
    ds_read_b128 a[136:139], v5 offset:256
    ds_read_b128 a[140:143], v5 offset:320
    buffer_load_dwordx4 a[220:223], v1, s[12:15], s73 offen offset:1024 nt
    buffer_load_dwordx4 a[224:227], v1, s[12:15], s73 offen offset:2048 nt
    buffer_load_dwordx4 a[228:231], v1, s[12:15], s73 offen offset:3072 nt
    buffer_load_dwordx4 a[232:235], v23, s[12:15], s73 offen offset:0 nt
    buffer_load_dwordx4 a[236:239], v23, s[12:15], s73 offen offset:1024 nt
    s_barrier
    global_load_dword v99, v98, s[64:65] sc1
    s_waitcnt vmcnt(13)
    ds_write_b128 v2, a[144:147] offset:0
    ds_write_b128 v3, a[148:151] offset:0
    ds_write_b128 v4, a[152:155] offset:0
    ds_write_b128 v2, a[156:159] offset:3328
    ds_write_b128 v3, a[160:163] offset:3328
    ds_write_b128 v4, a[164:167] offset:3328
    ds_read_b128 a[144:147], v5 offset:0
    ds_read_b128 a[148:151], v5 offset:64
    ds_read_b128 a[152:155], v5 offset:128
    ds_read_b128 a[156:159], v5 offset:192
    ds_read_b128 a[160:163], v5 offset:256
    ds_read_b128 a[164:167], v5 offset:320
    buffer_load_dwordx4 v[112:115], v1, s[12:15], s83 offen offset:0 nt
    buffer_load_dwordx4 v[116:119], v1, s[12:15], s83 offen offset:1024 nt
    buffer_load_dwordx4 v[120:123], v1, s[12:15], s83 offen offset:2048 nt
    buffer_load_dwordx4 v[124:127], v1, s[12:15], s83 offen offset:3072 nt
    buffer_load_dwordx4 v[128:131], v23, s[12:15], s83 offen offset:0 nt
    buffer_load_dwordx4 v[132:135], v23, s[12:15], s83 offen offset:1024 nt
    s_barrier
    s_waitcnt vmcnt(13)
    ds_write_b128 v2, a[168:171] offset:0
    ds_write_b128 v3, a[172:175] offset:0
    ds_write_b128 v4, a[176:179] offset:0
    ds_write_b128 v2, a[180:183] offset:3328
    ds_write_b128 v3, a[184:187] offset:3328
    ds_write_b128 v4, a[188:191] offset:3328
    ds_read_b128 a[168:171], v5 offset:0
    ds_read_b128 a[172:175], v5 offset:64
    ds_read_b128 a[176:179], v5 offset:128
    ds_read_b128 a[180:183], v5 offset:192
    ds_read_b128 a[184:187], v5 offset:256
    ds_read_b128 a[188:191], v5 offset:320
    buffer_load_dwordx4 v[136:139], v1, s[12:15], s84 offen offset:0 nt
    buffer_load_dwordx4 v[140:143], v1, s[12:15], s84 offen offset:1024 nt
    buffer_load_dwordx4 v[144:147], v1, s[12:15], s84 offen offset:2048 nt
    buffer_load_dwordx4 v[148:151], v1, s[12:15], s84 offen offset:3072 nt
    buffer_load_dwordx4 v[152:155], v23, s[12:15], s84 offen offset:0 nt
    buffer_load_dwordx4 v[156:159], v23, s[12:15], s84 offen offset:1024 nt
    s_barrier
    s_waitcnt vmcnt(12)
    s_mov_b32 s76, -1
    v_sad_u8 v100, v99, 0, 0
    s_nop 1
    v_add_u32_dpp v100, v100, v100 quad_perm:[1,0,3,2] row_mask:0xf bank_mask:0xf
    s_nop 1
    v_add_u32_dpp v100, v100, v100 quad_perm:[2,3,0,1] row_mask:0xf bank_mask:0xf
    v_cmp_gt_u32 vcc, 32, v100
    s_mov_b32 vcc_hi, 0
    s_cmp_eq_u64 vcc, 0
    s_cbranch_scc0 RDYLOOP
RDYOK:
    v_readlane_b32 s77, v99, s5
    s_nop 0
    s_cmp_eq_u32 s77, s96
    s_cselect_b32 s10, s18, 0
    s_mov_b32 s8, s16
    s_mov_b32 s9, s17
    s_mov_b32 s11, 0x20000
    buffer_load_dwordx4 a[240:243], v109, s[16:19], 0 offen sc1
    v_lshrrev_b32 v106, 3, v0
    v_mul_u32_u24 v106, 2560, v106
    v_and_b32 v107, 7, v0
    v_lshl_add_u32 v106, v107, 4, v106
    s_lshl_b32 s77, s69, 7
    s_add_u32 s77, s77, s3
    s_add_u32 s77, s77, 51200
    s_cmp_lt_u32 s69, 20
    s_cselect_b32 s77, s77, 1879048176
    s_cmp_eq_u32 s72, 3
    s_cselect_b32 s77, s77, 1879048176
    v_add_u32 v106, s77, v106
    v_add_u32 v107, 20480, v106
    v_mov_b32 v108, 2147483632
    v_cmp_le_u32 vcc, 32, v0
    s_nop 1
    v_cndmask_b32 v107, v107, v108, vcc
    buffer_load_dwordx4 a[240:243], v106, s[16:19], 0 offen sc1
    v_accvgpr_write_b32 a250, v106
    buffer_load_dwordx4 a[240:243], v107, s[16:19], 0 offen sc1
    v_accvgpr_write_b32 a251, v107
    s_mul_i32 s77, s70, 3072
    s_mul_i32 s78, s72, 96
    s_add_u32 s77, s77, s78
    s_add_u32 s77, s77, s3
    v_lshrrev_b32 v24, 4, v0
    v_mul_u32_u24 v24, 384, v24
    v_and_b32 v25, 15, v0
    v_min_u32 v25, 11, v25
    v_lshl_add_u32 v24, v25, 3, v24
    buffer_load_dwordx2 v[64:65], v24, s[16:19], s77 offen offset:0 sc1
    buffer_load_dwordx2 v[66:67], v24, s[16:19], s77 offen offset:1536 sc1
    s_cmp_lg_u32 s72, 1
    s_cbranch_scc1 NOBASE0
    s_cmp_ge_u32 s69, 20
    s_cbranch_scc1 NOBASE0
    v_mov_b32 v28, v22
    s_lshl_b32 s77, s69, 6
    s_add_u32 s77, s77, s3
    s_add_u32 s77, s77, 48640
    v_lshlrev_b32 v27, 2, v0
    v_mov_b32_dpp v29, v28 quad_perm:[1,1,1,1] row_mask:0xf bank_mask:0xf
    v_mov_b32_dpp v30, v28 quad_perm:[2,2,2,2] row_mask:0xf bank_mask:0xf
    v_mov_b32_dpp v31, v28 quad_perm:[3,3,3,3] row_mask:0xf bank_mask:0xf
    s_mov_b32 exec_lo, 0x1111
    s_mov_b32 exec_hi, 0x0
    buffer_store_dwordx4 v[28:31], v27, s[8:11], s77 offen
    s_cmp_eq_u32 s10, 0
    s_cbranch_scc1 SLOW1
BACK1:
    s_mov_b64 exec, -1
NOBASE0:
    ds_write_b128 v2, a[216:219] offset:0
    ds_write_b128 v3, a[220:223] offset:0
    ds_write_b128 v4, a[224:227] offset:0
    ds_write_b128 v2, a[228:231] offset:3328
    ds_write_b128 v3, a[232:235] offset:3328
    ds_write_b128 v4, a[236:239] offset:3328
    ds_read_b64_tr_b16 a[192:193], v6 offset:0
    ds_read_b64_tr_b16 a[196:197], v6 offset:32
    ds_read_b64_tr_b16 a[200:201], v6 offset:64
    ds_read_b64_tr_b16 a[204:205], v6 offset:96
    ds_read_b64_tr_b16 a[208:209], v6 offset:128
    ds_read_b64_tr_b16 a[212:213], v6 offset:160
    ds_read_b64_tr_b16 a[216:217], v6 offset:192
    ds_read_b64_tr_b16 a[220:221], v6 offset:224
    ds_read_b64_tr_b16 a[224:225], v6 offset:256
    ds_read_b64_tr_b16 a[228:229], v6 offset:288
    ds_read_b64_tr_b16 a[232:233], v6 offset:320
    ds_read_b64_tr_b16 a[236:237], v6 offset:352
    buffer_load_dwordx4 v[160:163], v1, s[12:15], s85 offen offset:0 nt
    s_waitcnt vmcnt(12)
    ds_write_b128 v2, v[112:115] offset:0
    ds_write_b128 v3, v[116:119] offset:0
    ds_write_b128 v4, v[120:123] offset:0
    ds_write_b128 v2, v[124:127] offset:3328
    ds_write_b128 v3, v[128:131] offset:3328
    ds_write_b128 v4, v[132:135] offset:3328
    ds_read_b64_tr_b16 a[194:195], v6 offset:0
    ds_read_b64_tr_b16 a[198:199], v6 offset:32
    ds_read_b64_tr_b16 a[202:203], v6 offset:64
    ds_read_b64_tr_b16 a[206:207], v6 offset:96
    ds_read_b64_tr_b16 a[210:211], v6 offset:128
    ds_read_b64_tr_b16 a[214:215], v6 offset:160
    ds_read_b64_tr_b16 a[218:219], v6 offset:192
    ds_read_b64_tr_b16 a[222:223], v6 offset:224
    ds_read_b64_tr_b16 a[226:227], v6 offset:256
    ds_read_b64_tr_b16 a[230:231], v6 offset:288
    ds_read_b64_tr_b16 a[234:235], v6 offset:320
    ds_read_b64_tr_b16 a[238:239], v6 offset:352
    buffer_load_dwordx4 v[164:167], v1, s[12:15], s85 offen offset:1024 nt
    buffer_load_dwordx4 v[168:171], v1, s[12:15], s85 offen offset:2048 nt
    buffer_load_dwordx4 v[172:175], v1, s[12:15], s85 offen offset:3072 nt
    buffer_load_dwordx4 v[176:179], v23, s[12:15], s85 offen offset:0 nt
    buffer_load_dwordx4 v[180:183], v23, s[12:15], s85 offen offset:1024 nt
    s_barrier
    buffer_load_dwordx4 v[184:187], v1, s[12:15], s86 offen offset:0 nt
    s_waitcnt vmcnt(12)
    ds_write_b128 v2, v[136:139] offset:0
    ds_write_b128 v3, v[140:143] offset:0
    ds_write_b128 v4, v[144:147] offset:0
    ds_write_b128 v2, v[148:151] offset:3328
    ds_write_b128 v3, v[152:155] offset:3328
    ds_write_b128 v4, v[156:159] offset:3328
    ds_read_b64_tr_b16 v[112:113], v6 offset:0
    ds_read_b64_tr_b16 v[116:117], v6 offset:32
    ds_read_b64_tr_b16 v[120:121], v6 offset:64
    ds_read_b64_tr_b16 v[124:125], v6 offset:96
    ds_read_b64_tr_b16 v[128:129], v6 offset:128
    ds_read_b64_tr_b16 v[132:133], v6 offset:160
    ds_read_b64_tr_b16 v[136:137], v6 offset:192
    ds_read_b64_tr_b16 v[140:141], v6 offset:224
    ds_read_b64_tr_b16 v[144:145], v6 offset:256
    ds_read_b64_tr_b16 v[148:149], v6 offset:288
    ds_read_b64_tr_b16 v[152:153], v6 offset:320
    ds_read_b64_tr_b16 v[156:157], v6 offset:352
    buffer_load_dwordx4 v[188:191], v1, s[12:15], s86 offen offset:1024 nt
    buffer_load_dwordx4 v[192:195], v1, s[12:15], s86 offen offset:2048 nt
    buffer_load_dwordx4 v[196:199], v1, s[12:15], s86 offen offset:3072 nt
    buffer_load_dwordx4 v[200:203], v23, s[12:15], s86 offen offset:0 nt
    buffer_load_dwordx4 v[204:207], v23, s[12:15], s86 offen offset:1024 nt
    s_barrier
    s_waitcnt vmcnt(12)
    v_lshlrev_b32 v24, 16, v64
    v_and_b32 v25, 0xffff0000, v64
    v_lshlrev_b32 v26, 16, v65
    v_and_b32 v27, 0xffff0000, v65
    v_lshlrev_b32 v28, 16, v66
    v_and_b32 v29, 0xffff0000, v66
    v_lshlrev_b32 v30, 16, v67
    v_and_b32 v31, 0xffff0000, v67
    v_add_f32 v24, v24, v28
    v_add_f32 v25, v25, v29
    v_add_f32 v26, v26, v30
    v_add_f32 v27, v27, v31
    s_nop 0
    v_permlane32_swap_b32 v24, v26
    v_permlane32_swap_b32 v25, v27
    v_add_f32 v24, v24, v26
    v_add_f32 v25, v25, v27
    s_nop 1
    v_permlane16_swap_b32 v24, v25
    v_add_f32 v24, v24, v25
    v_cvt_pk_bf16_f32 v24, v24, v24
    ds_write_b16 v12, v24
    buffer_load_dwordx4 v[208:211], v1, s[12:15], s87 offen offset:0 nt
    v_mov_b32 v40, 0
    v_mov_b32 v41, 0
    v_mov_b32 v44, 0
    v_mov_b32 v45, 0
    v_mov_b32 v48, 0
    v_mov_b32 v49, 0
    v_mov_b32 v52, 0
    v_mov_b32 v53, 0
    v_mov_b32 v56, 0
    v_mov_b32 v57, 0
    v_mov_b32 v60, 0
    v_mov_b32 v61, 0
    v_mov_b32 v64, 0
    v_mov_b32 v65, 0
    v_mov_b32 v68, 0
    v_mov_b32 v69, 0
    v_mov_b32 v72, 0
    v_mov_b32 v73, 0
    v_mov_b32 v74, 0
    v_mov_b32 v75, 0
    v_mov_b32 v76, 0
    v_mov_b32 v77, 0
    v_mov_b32 v78, 0
    v_mov_b32 v79, 0
    v_mov_b32 v80, 0
    v_mov_b32 v81, 0
    v_mov_b32 v82, 0
    v_mov_b32 v83, 0
    v_mov_b32 v84, 0
    v_mov_b32 v85, 0
    v_mov_b32 v86, 0
    v_mov_b32 v87, 0
    buffer_load_dwordx4 v[212:215], v1, s[12:15], s87 offen offset:1024 nt
    buffer_load_dwordx4 v[216:219], v1, s[12:15], s87 offen offset:2048 nt
    s_waitcnt lgkmcnt(0)
    s_barrier
    ds_read_b128 v[28:31], v13 offset:0
    ds_read_b128 v[32:35], v13 offset:128
    ds_read_b128 v[36:39], v13 offset:256
    v_mov_b32 v18, 0x3dd53b94
    s_waitcnt lgkmcnt(2)
    v_smfmac_f32_16x16x64_bf16 v[40:43], v[28:31], a[0:7], v14
    v_smfmac_f32_16x16x64_bf16 v[44:47], v[28:31], a[24:31], v14
    v_smfmac_f32_16x16x64_bf16 v[48:51], v[28:31], a[48:55], v14
    v_smfmac_f32_16x16x64_bf16 v[52:55], v[28:31], a[72:79], v14
    v_smfmac_f32_16x16x64_bf16 v[56:59], v[28:31], a[96:103], v14
    v_smfmac_f32_16x16x64_bf16 v[60:63], v[28:31], a[120:127], v14
    v_smfmac_f32_16x16x64_bf16 v[64:67], v[28:31], a[144:151], v14
    v_smfmac_f32_16x16x64_bf16 v[68:71], v[28:31], a[168:175], v14
    buffer_load_dwordx4 v[220:223], v1, s[12:15], s87 offen offset:3072 nt
    s_waitcnt lgkmcnt(1)
    v_smfmac_f32_16x16x64_bf16 v[40:43], v[32:35], a[8:15], v14
    v_smfmac_f32_16x16x64_bf16 v[44:47], v[32:35], a[32:39], v14
    v_smfmac_f32_16x16x64_bf16 v[48:51], v[32:35], a[56:63], v14
    v_smfmac_f32_16x16x64_bf16 v[52:55], v[32:35], a[80:87], v14
    v_smfmac_f32_16x16x64_bf16 v[56:59], v[32:35], a[104:111], v14
    v_smfmac_f32_16x16x64_bf16 v[60:63], v[32:35], a[128:135], v14
    v_smfmac_f32_16x16x64_bf16 v[64:67], v[32:35], a[152:159], v14
    v_smfmac_f32_16x16x64_bf16 v[68:71], v[32:35], a[176:183], v14
    s_waitcnt lgkmcnt(0)
    v_smfmac_f32_16x16x64_bf16 v[40:43], v[36:39], a[16:23], v14
    v_smfmac_f32_16x16x64_bf16 v[44:47], v[36:39], a[40:47], v14
    v_smfmac_f32_16x16x64_bf16 v[48:51], v[36:39], a[64:71], v14
    v_smfmac_f32_16x16x64_bf16 v[52:55], v[36:39], a[88:95], v14
    v_smfmac_f32_16x16x64_bf16 v[56:59], v[36:39], a[112:119], v14
    v_smfmac_f32_16x16x64_bf16 v[60:63], v[36:39], a[136:143], v14
    v_smfmac_f32_16x16x64_bf16 v[64:67], v[36:39], a[160:167], v14
    v_smfmac_f32_16x16x64_bf16 v[68:71], v[36:39], a[184:191], v14
    buffer_load_dwordx4 v[224:227], v23, s[12:15], s87 offen offset:0 nt
    v_add_f32 v24, v40, v41
    v_add_f32 v44, v44, v45
    v_add_f32 v48, v48, v49
    v_max3_f32 v26, v24, v44, v48
    v_add_f32 v52, v52, v53
    v_add_f32 v25, v56, v57
    v_max3_f32 v26, v26, v52, v25
    v_add_f32 v60, v60, v61
    v_add_f32 v64, v64, v65
    v_max3_f32 v26, v26, v60, v64
    v_add_f32 v68, v68, v69
    v_max_f32 v26, v26, v68
    v_mov_b32_dpp v24, v44 quad_perm:[0,1,2,3] row_mask:0x2 bank_mask:0xf
    v_mov_b32_dpp v25, v60 quad_perm:[0,1,2,3] row_mask:0x2 bank_mask:0xf
    v_max_f32_dpp v26, v26, v26 row_ror:8 row_mask:0xf bank_mask:0xf
    v_mov_b32_dpp v24, v48 quad_perm:[0,1,2,3] row_mask:0x4 bank_mask:0xf
    v_mov_b32_dpp v25, v64 quad_perm:[0,1,2,3] row_mask:0x4 bank_mask:0xf
    v_max_f32_dpp v26, v26, v26 row_ror:4 row_mask:0xf bank_mask:0xf
    v_mov_b32_dpp v24, v52 quad_perm:[0,1,2,3] row_mask:0x8 bank_mask:0xf
    v_mov_b32_dpp v25, v68 quad_perm:[0,1,2,3] row_mask:0x8 bank_mask:0xf
    v_max_f32_dpp v26, v26, v26 row_ror:2 row_mask:0xf bank_mask:0xf
    v_accvgpr_read_b32 v27, a252
    s_nop 0
    v_max_f32_dpp v26, v26, v26 row_ror:1 row_mask:0xf bank_mask:0xf
    buffer_load_dwordx4 v[228:231], v23, s[12:15], s87 offen offset:1024 nt
    s_barrier
    v_mul_f32 v26, v26, v18
    v_fma_f32 v24, v24, v18, -v26
    v_fma_f32 v25, v25, v18, -v26
    v_exp_f32 v24, v24
    v_exp_f32 v25, v25
    s_nop 0
    v_cvt_pk_bf16_f32 v28, v24, v25
    ds_write_b16 v19, v28
    ds_write_b16_d16_hi v19, v28 offset:128
    s_mov_b32 exec_lo, 0xff00ff
    s_mov_b32 exec_hi, 0xff00ff00
    ds_read_b128 v[72:75], v27 offset:0
    ds_read_b128 v[76:79], v27 offset:64
    ds_read_b128 v[80:83], v27 offset:128
    ds_read_b128 v[84:87], v27 offset:192
    s_mov_b64 exec, -1
    v_add_f32 v27, v24, v25
    v_mov_b32 v40, 0
    v_mov_b32 v44, 0
    v_add_f32_dpp v27, v27, v27 row_ror:8 row_mask:0xf bank_mask:0xf
    v_mov_b32 v48, 0
    v_mov_b32 v52, 0
    v_add_f32_dpp v27, v27, v27 row_ror:4 row_mask:0xf bank_mask:0xf
    v_mov_b32 v56, 0
    v_mov_b32 v60, 0
    v_add_f32_dpp v27, v27, v27 row_ror:2 row_mask:0xf bank_mask:0xf
    s_lshl_b32 s78, s72, 3
    s_add_u32 s78, s78, 125440
    v_add_f32_dpp v27, v27, v27 row_ror:1 row_mask:0xf bank_mask:0xf
    v_mov_b32 v28, v27
    s_nop 1
    v_permlane32_swap_b32 v27, v28
    v_add_f32 v27, v27, v28
    v_mov_b32 v28, v27
    s_nop 1
    v_permlane16_swap_b32 v27, v28
    v_add_f32 v27, v27, v28
    v_mov_b32 v28, s78
    ds_write_b64 v28, v[26:27]
    s_waitcnt vmcnt(12)
    ds_write_b128 v2, v[160:163] offset:0
    ds_write_b128 v3, v[164:167] offset:0
    ds_write_b128 v4, v[168:171] offset:0
    ds_write_b128 v2, v[172:175] offset:3328
    ds_write_b128 v3, v[176:179] offset:3328
    ds_write_b128 v4, v[180:183] offset:3328
    ds_read_b64_tr_b16 v[114:115], v6 offset:0
    ds_read_b64_tr_b16 v[118:119], v6 offset:32
    ds_read_b64_tr_b16 v[122:123], v6 offset:64
    ds_read_b64_tr_b16 v[126:127], v6 offset:96
    ds_read_b64_tr_b16 v[130:131], v6 offset:128
    ds_read_b64_tr_b16 v[134:135], v6 offset:160
    ds_read_b64_tr_b16 v[138:139], v6 offset:192
    ds_read_b64_tr_b16 v[142:143], v6 offset:224
    ds_read_b64_tr_b16 v[146:147], v6 offset:256
    ds_read_b64_tr_b16 v[150:151], v6 offset:288
    ds_read_b64_tr_b16 v[154:155], v6 offset:320
    ds_read_b64_tr_b16 v[158:159], v6 offset:352
    buffer_load_dwordx4 v[232:235], v1, s[12:15], s88 offen offset:0 nt
    buffer_load_dwordx4 v[236:239], v1, s[12:15], s88 offen offset:1024 nt
    s_waitcnt lgkmcnt(0)
    v_smfmac_f32_16x16x64_bf16 v[40:43], v[72:75], a[192:199], v14 abid:1
    v_smfmac_f32_16x16x64_bf16 v[44:47], v[72:75], a[200:207], v14 abid:1
    v_smfmac_f32_16x16x64_bf16 v[48:51], v[72:75], a[208:215], v14 abid:1
    v_smfmac_f32_16x16x64_bf16 v[52:55], v[72:75], a[216:223], v14 abid:1
    v_smfmac_f32_16x16x64_bf16 v[56:59], v[72:75], a[224:231], v14 abid:1
    v_smfmac_f32_16x16x64_bf16 v[60:63], v[72:75], a[232:239], v14 abid:1
    buffer_load_dwordx4 v[240:243], v1, s[12:15], s88 offen offset:2048 nt
    v_smfmac_f32_16x16x64_bf16 v[40:43], v[76:79], v[112:119], v14 abid:1
    v_smfmac_f32_16x16x64_bf16 v[44:47], v[76:79], v[120:127], v14 abid:1
    v_smfmac_f32_16x16x64_bf16 v[48:51], v[76:79], v[128:135], v14 abid:1
    v_smfmac_f32_16x16x64_bf16 v[52:55], v[76:79], v[136:143], v14 abid:1
    v_smfmac_f32_16x16x64_bf16 v[56:59], v[76:79], v[144:151], v14 abid:1
    v_smfmac_f32_16x16x64_bf16 v[60:63], v[76:79], v[152:159], v14 abid:1
    buffer_load_dwordx4 v[244:247], v1, s[12:15], s88 offen offset:3072 nt
    buffer_load_dwordx4 v[248:251], v23, s[12:15], s88 offen offset:0 nt
    buffer_load_dwordx4 v[252:255], v23, s[12:15], s88 offen offset:1024 nt
    s_barrier
    s_waitcnt vmcnt(12)
    ds_write_b128 v2, v[184:187] offset:0
    ds_write_b128 v3, v[188:191] offset:0
    ds_write_b128 v4, v[192:195] offset:0
    ds_write_b128 v2, v[196:199] offset:3328
    ds_write_b128 v3, v[200:203] offset:3328
    ds_write_b128 v4, v[204:207] offset:3328
    ds_read_b64_tr_b16 v[160:161], v6 offset:0
    ds_read_b64_tr_b16 v[164:165], v6 offset:32
    ds_read_b64_tr_b16 v[168:169], v6 offset:64
    ds_read_b64_tr_b16 v[172:173], v6 offset:96
    ds_read_b64_tr_b16 v[176:177], v6 offset:128
    ds_read_b64_tr_b16 v[180:181], v6 offset:160
    ds_read_b64_tr_b16 v[184:185], v6 offset:192
    ds_read_b64_tr_b16 v[188:189], v6 offset:224
    ds_read_b64_tr_b16 v[192:193], v6 offset:256
    ds_read_b64_tr_b16 v[196:197], v6 offset:288
    ds_read_b64_tr_b16 v[200:201], v6 offset:320
    ds_read_b64_tr_b16 v[204:205], v6 offset:352
    buffer_load_dwordx4 v[88:91], v1, s[12:15], s89 offen offset:0 nt
    buffer_load_dwordx4 v[92:95], v1, s[12:15], s89 offen offset:1024 nt
    buffer_load_dwordx4 v[96:99], v1, s[12:15], s89 offen offset:2048 nt
    buffer_load_dwordx4 v[100:103], v1, s[12:15], s89 offen offset:3072 nt
    buffer_load_dwordx4 v[104:107], v23, s[12:15], s89 offen offset:0 nt
    buffer_load_dwordx4 v[108:111], v23, s[12:15], s89 offen offset:1024 nt
    s_waitcnt vmcnt(12)
    ds_write_b128 v2, v[208:211] offset:0
    ds_write_b128 v3, v[212:215] offset:0
    ds_write_b128 v4, v[216:219] offset:0
    ds_write_b128 v2, v[220:223] offset:3328
    ds_write_b128 v3, v[224:227] offset:3328
    ds_write_b128 v4, v[228:231] offset:3328
    ds_read_b64_tr_b16 v[162:163], v6 offset:0
    ds_read_b64_tr_b16 v[166:167], v6 offset:32
    ds_read_b64_tr_b16 v[170:171], v6 offset:64
    ds_read_b64_tr_b16 v[174:175], v6 offset:96
    ds_read_b64_tr_b16 v[178:179], v6 offset:128
    ds_read_b64_tr_b16 v[182:183], v6 offset:160
    ds_read_b64_tr_b16 v[186:187], v6 offset:192
    ds_read_b64_tr_b16 v[190:191], v6 offset:224
    ds_read_b64_tr_b16 v[194:195], v6 offset:256
    ds_read_b64_tr_b16 v[198:199], v6 offset:288
    ds_read_b64_tr_b16 v[202:203], v6 offset:320
    ds_read_b64_tr_b16 v[206:207], v6 offset:352
    v_and_b32 v23, 0xffff0000, v22
    v_lshlrev_b32 v22, 16, v22
    s_mov_b32 s82, 0x1010101
    s_mov_b32 s83, 0x1010101
    s_mov_b32 s84, 0x1ff01ff
    s_mov_b32 s85, 0x1ff01ff
    s_mov_b32 s86, 0xffffffff
    s_mov_b32 s87, 0xfffffff
    s_mov_b32 s88, 0xff00ff
    s_mov_b32 s89, 0xff00ff00
    s_mov_b32 s92, 0x1010101
    s_mov_b32 s93, 0x0
    s_cmp_ge_u32 s69, 20
    s_cbranch_scc1 TAILF
    v_lshrrev_b32 v38, 2, v0
    v_mul_u32_u24 v38, 1280, v38
    v_and_b32 v39, 3, v0
    v_lshl_add_u32 v39, v39, 4, v38
    s_mov_b32 m0, s67
    s_add_u32 s67, s67, 1024
    buffer_load_dwordx4 v39, s[24:27], s66 offen  lds
    s_add_u32 s66, s66, 20480
    s_mov_b32 m0, s67
    s_add_u32 s67, s67, 1024
    buffer_load_dwordx4 v39, s[24:27], s66 offen  lds
    s_add_u32 s66, s66, 20480
    s_mov_b32 m0, s67
    s_add_u32 s67, s67, 1024
    buffer_load_dwordx4 v39, s[24:27], s66 offen  lds
    s_add_u32 s66, s66, 20480
    s_waitcnt lgkmcnt(0)
    v_smfmac_f32_16x16x64_bf16 v[40:43], v[80:83], v[160:167], v14 abid:1
    v_smfmac_f32_16x16x64_bf16 v[44:47], v[80:83], v[168:175], v14 abid:1
    v_smfmac_f32_16x16x64_bf16 v[48:51], v[80:83], v[176:183], v14 abid:1
    v_smfmac_f32_16x16x64_bf16 v[52:55], v[80:83], v[184:191], v14 abid:1
    v_smfmac_f32_16x16x64_bf16 v[56:59], v[80:83], v[192:199], v14 abid:1
    v_smfmac_f32_16x16x64_bf16 v[60:63], v[80:83], v[200:207], v14 abid:1
    s_waitcnt vmcnt(9)
    ds_write_b128 v2, v[232:235] offset:0
    ds_write_b128 v3, v[236:239] offset:0
    ds_write_b128 v4, v[240:243] offset:0
    ds_write_b128 v2, v[244:247] offset:3328
    ds_write_b128 v3, v[248:251] offset:3328
    ds_write_b128 v4, v[252:255] offset:3328
    ds_read_b64_tr_b16 v[208:209], v6 offset:0
    ds_read_b64_tr_b16 v[212:213], v6 offset:32
    ds_read_b64_tr_b16 v[216:217], v6 offset:64
    ds_read_b64_tr_b16 v[220:221], v6 offset:96
    ds_read_b64_tr_b16 v[224:225], v6 offset:128
    ds_read_b64_tr_b16 v[228:229], v6 offset:160
    ds_read_b64_tr_b16 v[232:233], v6 offset:192
    ds_read_b64_tr_b16 v[236:237], v6 offset:224
    ds_read_b64_tr_b16 v[240:241], v6 offset:256
    ds_read_b64_tr_b16 v[244:245], v6 offset:288
    ds_read_b64_tr_b16 v[248:249], v6 offset:320
    ds_read_b64_tr_b16 v[252:253], v6 offset:352
    s_mov_b32 m0, s67
    s_add_u32 s67, s67, 1024
    buffer_load_dwordx4 v39, s[24:27], s66 offen  lds
    s_add_u32 s66, s66, 20480
    s_mov_b32 m0, s67
    s_add_u32 s67, s67, 1024
    buffer_load_dwordx4 v39, s[24:27], s66 offen  lds
    s_add_u32 s66, s66, 20480
    s_mov_b32 m0, s67
    s_add_u32 s67, s67, 1024
    buffer_load_dwordx4 v39, s[24:27], s66 offen  lds
    s_add_u32 s66, s66, 20480
    s_waitcnt vmcnt(11)
    ds_write_b128 v2, v[88:91] offset:0
    s_waitcnt vmcnt(10)
    ds_write_b128 v3, v[92:95] offset:0
    s_waitcnt vmcnt(9)
    ds_write_b128 v4, v[96:99] offset:0
    s_waitcnt vmcnt(8)
    ds_write_b128 v2, v[100:103] offset:3328
    s_waitcnt vmcnt(7)
    ds_write_b128 v3, v[104:107] offset:3328
    s_waitcnt vmcnt(6)
    ds_write_b128 v4, v[108:111] offset:3328
    ds_read_b64_tr_b16 v[210:211], v6 offset:0
    ds_read_b64_tr_b16 v[214:215], v6 offset:32
    ds_read_b64_tr_b16 v[218:219], v6 offset:64
    ds_read_b64_tr_b16 v[222:223], v6 offset:96
    ds_read_b64_tr_b16 v[226:227], v6 offset:128
    ds_read_b64_tr_b16 v[230:231], v6 offset:160
    ds_read_b64_tr_b16 v[234:235], v6 offset:192
    ds_read_b64_tr_b16 v[238:239], v6 offset:224
    ds_read_b64_tr_b16 v[242:243], v6 offset:256
    ds_read_b64_tr_b16 v[246:247], v6 offset:288
    ds_read_b64_tr_b16 v[250:251], v6 offset:320
    ds_read_b64_tr_b16 v[254:255], v6 offset:352
    s_branch ATT_LAST
TAILF:
    s_lshl_b32 s90, s72, 3
    s_add_u32 s90, s90, s68
    s_mul_i32 s90, s90, 24
    s_add_u32 s90, s90, s69
    s_sub_u32 s90, s90, 8
    s_mul_i32 s90, s90, 10240
    buffer_load_dwordx4 a[240:243], v1, s[20:23], s90 offen offset:0
    buffer_load_dwordx4 a[240:243], v1, s[20:23], s90 offen offset:1024
    buffer_load_dwordx4 a[240:243], v1, s[20:23], s90 offen offset:2048
    buffer_load_dwordx4 a[240:243], v1, s[20:23], s90 offen offset:3072
    s_add_u32 s90, s90, 4096
    buffer_load_dwordx4 a[240:243], v1, s[20:23], s90 offen offset:0
    buffer_load_dwordx4 a[240:243], v1, s[20:23], s90 offen offset:1024
    buffer_load_dwordx4 a[240:243], v1, s[20:23], s90 offen offset:2048
    s_waitcnt lgkmcnt(0)
    v_smfmac_f32_16x16x64_bf16 v[40:43], v[80:83], v[160:167], v14 abid:1
    v_smfmac_f32_16x16x64_bf16 v[44:47], v[80:83], v[168:175], v14 abid:1
    v_smfmac_f32_16x16x64_bf16 v[48:51], v[80:83], v[176:183], v14 abid:1
    v_smfmac_f32_16x16x64_bf16 v[52:55], v[80:83], v[184:191], v14 abid:1
    v_smfmac_f32_16x16x64_bf16 v[56:59], v[80:83], v[192:199], v14 abid:1
    v_smfmac_f32_16x16x64_bf16 v[60:63], v[80:83], v[200:207], v14 abid:1
    s_waitcnt vmcnt(13)
    ds_write_b128 v2, v[232:235] offset:0
    ds_write_b128 v3, v[236:239] offset:0
    ds_write_b128 v4, v[240:243] offset:0
    ds_write_b128 v2, v[244:247] offset:3328
    ds_write_b128 v3, v[248:251] offset:3328
    ds_write_b128 v4, v[252:255] offset:3328
    ds_read_b64_tr_b16 v[208:209], v6 offset:0
    ds_read_b64_tr_b16 v[212:213], v6 offset:32
    ds_read_b64_tr_b16 v[216:217], v6 offset:64
    ds_read_b64_tr_b16 v[220:221], v6 offset:96
    ds_read_b64_tr_b16 v[224:225], v6 offset:128
    ds_read_b64_tr_b16 v[228:229], v6 offset:160
    ds_read_b64_tr_b16 v[232:233], v6 offset:192
    ds_read_b64_tr_b16 v[236:237], v6 offset:224
    ds_read_b64_tr_b16 v[240:241], v6 offset:256
    ds_read_b64_tr_b16 v[244:245], v6 offset:288
    ds_read_b64_tr_b16 v[248:249], v6 offset:320
    ds_read_b64_tr_b16 v[252:253], v6 offset:352
    buffer_load_dwordx4 a[240:243], v1, s[20:23], s90 offen offset:3072
    s_add_u32 s90, s90, 4096
    buffer_load_dwordx4 a[240:243], v1, s[20:23], s90 offen offset:0
    buffer_load_dwordx4 a[240:243], v1, s[20:23], s90 offen offset:1024
    s_waitcnt vmcnt(15)
    ds_write_b128 v2, v[88:91] offset:0
    s_waitcnt vmcnt(14)
    ds_write_b128 v3, v[92:95] offset:0
    s_waitcnt vmcnt(13)
    ds_write_b128 v4, v[96:99] offset:0
    s_waitcnt vmcnt(12)
    ds_write_b128 v2, v[100:103] offset:3328
    s_waitcnt vmcnt(11)
    ds_write_b128 v3, v[104:107] offset:3328
    s_waitcnt vmcnt(10)
    ds_write_b128 v4, v[108:111] offset:3328
    ds_read_b64_tr_b16 v[210:211], v6 offset:0
    ds_read_b64_tr_b16 v[214:215], v6 offset:32
    ds_read_b64_tr_b16 v[218:219], v6 offset:64
    ds_read_b64_tr_b16 v[222:223], v6 offset:96
    ds_read_b64_tr_b16 v[226:227], v6 offset:128
    ds_read_b64_tr_b16 v[230:231], v6 offset:160
    ds_read_b64_tr_b16 v[234:235], v6 offset:192
    ds_read_b64_tr_b16 v[238:239], v6 offset:224
    ds_read_b64_tr_b16 v[242:243], v6 offset:256
    ds_read_b64_tr_b16 v[246:247], v6 offset:288
    ds_read_b64_tr_b16 v[250:251], v6 offset:320
    ds_read_b64_tr_b16 v[254:255], v6 offset:352
    s_branch ATT_LAST
LOOP:
    s_cmp_lt_u32 s69, 20
    s_cselect_b32 s5, s72, 4
    s_add_u32 s96, s3, 688128
    s_add_u32 s97, s96, 4096
    buffer_load_dwordx4 v[88:91], v11, s[16:19], s96 offen sc1
    buffer_load_dwordx4 v[92:95], v11, s[16:19], s97 offen sc1
    ds_read_b64_tr_b16 v[40:41], v16 offset:0
    ds_read_b64_tr_b16 v[42:43], v16 offset:1536
    ds_read_b64_tr_b16 v[44:45], v16 offset:12288
    ds_read_b64_tr_b16 v[46:47], v16 offset:13824
    ds_read_b64_tr_b16 v[48:49], v17 offset:24576
    ds_read_b64_tr_b16 v[50:51], v16 offset:32
    ds_read_b64_tr_b16 v[52:53], v16 offset:1568
    ds_read_b64_tr_b16 v[54:55], v16 offset:12320
    ds_read_b64_tr_b16 v[56:57], v16 offset:13856
    ds_read_b64_tr_b16 v[58:59], v17 offset:24608
    ds_read_b64_tr_b16 v[60:61], v16 offset:64
    ds_read_b64_tr_b16 v[62:63], v16 offset:1600
    ds_read_b64_tr_b16 v[64:65], v16 offset:12352
    ds_read_b64_tr_b16 v[66:67], v16 offset:13888
    ds_read_b64_tr_b16 v[68:69], v17 offset:24640
    v_and_b32 v25, 15, v0
    v_cmp_eq_u32 vcc, 12, v25
    v_mov_b32 v36, 0x3f803f80
    s_nop 0
    v_cndmask_b32 v70, 0, v36, vcc
    v_mov_b32 v71, v70
    v_mov_b32 v72, v70
    v_mov_b32 v73, v70
    v_mov_b32 v74, v70
    v_mov_b32 v75, v70
    v_mov_b32 v76, v70
    v_mov_b32 v77, v70
    v_mov_b32 v78, v70
    v_mov_b32 v79, v70
    s_add_u32 s79, s3, 4096
    s_mul_i32 s77, s72, 6656
    v_mul_u32_u24 v26, 103, v0
    v_lshrrev_b32 v26, 10, v26
    v_lshl_add_u32 v26, v26, 4, v1
    v_add_u32 v26, s77, v26
    v_mul_u32_u24 v27, 176, v25
    v_add_u32 v27, s77, v27
    v_lshrrev_b32 v28, 4, v0
    v_lshl_add_u32 v29, v28, 3, v27
    v_lshl_add_u32 v27, v28, 4, v27
    s_mul_i32 s77, s71, 160
    s_add_u32 s77, s77, s3
    s_sub_u32 s77, s77, 640768
    s_waitcnt lgkmcnt(0)
    s_mov_b32 exec_lo, 0x3ff
    s_mov_b32 exec_hi, 0x0
    s_mov_b32 s76, 1
POLL2:
    buffer_load_dword v24, v1, s[16:19], s77 offen sc1
POLLW2:
    s_waitcnt vmcnt(0)
    v_cmp_eq_u32 vcc, -1, v24
    s_cbranch_vccnz AGAIN2
POLLX2:
    s_mov_b64 exec, s[86:87]
    buffer_load_dwordx4 v[80:83], v8, s[16:19], 0 offen sc1
    buffer_load_dwordx4 v[84:87], v9, s[16:19], 0 offen sc1
    buffer_load_dwordx4 v[88:91], v11, s[16:19], s96 offen sc1
    buffer_load_dwordx4 v[92:95], v11, s[16:19], s97 offen sc1
    s_waitcnt vmcnt(2)
BW3:
    ds_write_b128 v26, v[80:83]
    ds_write_b128 v26, v[84:87] offset:1056
    v_max_u32 v24, v80, v84
    v_cmp_eq_u32 vcc, -1, v24
    s_mov_b64 exec, s[84:85]
    ds_read_b128 v[70:73], v27
    ds_read_b128 v[74:77], v27 offset:64
    ds_read_b64 v[78:79], v29 offset:128
    s_mov_b64 exec, -1
    s_cbranch_vccnz BR3
BX3:
    s_cmp_lg_u32 s5, 1
    s_cbranch_scc1 NOOWL
    buffer_load_dword a244, v20, s[16:19], 0 offen sc1
    buffer_load_dword a245, v21, s[16:19], 0 offen sc1
NOOWL:
    s_waitcnt lgkmcnt(2)
    v_mfma_f32_16x16x32_bf16 v[24:27], v[70:73], v[40:43], 0
    v_mfma_f32_16x16x32_bf16 v[32:35], v[70:73], v[60:63], 0
    s_waitcnt lgkmcnt(0)
    v_mfma_f32_16x16x32_bf16 v[24:27], v[74:77], v[44:47], v[24:27]
    v_mfma_f32_16x16x32_bf16 v[32:35], v[74:77], v[64:67], v[32:35]
    v_mfma_f32_16x16x16_bf16 v[24:27], v[78:79], v[48:49], v[24:27]
    v_mfma_f32_16x16x16_bf16 v[32:35], v[78:79], v[68:69], v[32:35]
    v_mfma_f32_16x16x32_bf16 v[28:31], v[70:73], v[50:53], 0
    v_mfma_f32_16x16x32_bf16 v[36:39], v[70:73], v[70:73], 0
    v_mfma_f32_16x16x32_bf16 v[28:31], v[74:77], v[54:57], v[28:31]
    v_mfma_f32_16x16x32_bf16 v[36:39], v[74:77], v[74:77], v[36:39]
    v_mfma_f32_16x16x16_bf16 v[28:31], v[78:79], v[58:59], v[28:31]
    v_mfma_f32_16x16x16_bf16 v[36:39], v[78:79], v[78:79], v[36:39]
    s_nop 0
    v_add_f32 v24, v24, v25
    v_add_f32 v26, v26, v27
    v_add_f32 v24, v24, v26
    v_add_f32 v32, v32, v33
    v_add_f32 v34, v34, v35
    v_add_f32 v32, v32, v34
    s_nop 1
    v_permlane32_swap_b32 v24, v32
    v_add_f32 v28, v28, v29
    v_add_f32 v30, v30, v31
    v_add_f32 v36, v36, v37
    v_add_f32 v38, v38, v39
    v_add_f32 v24, v24, v32
    v_add_f32 v28, v28, v30
    v_add_f32 v36, v36, v38
    s_nop 1
    v_permlane32_swap_b32 v28, v36
    v_add_f32 v28, v28, v36
    s_nop 1
    v_permlane16_swap_b32 v24, v28
    v_add_f32 v24, v24, v28
    buffer_store_dword v24, v10, s[8:11], s3 offen
    s_cmp_eq_u32 s10, 0
    s_cbranch_scc1 SLOW4
BACK4:
    v_mov_b32 v40, 0
    v_mov_b32 v41, 0
    v_mov_b32 v44, 0
    v_mov_b32 v45, 0
    v_mov_b32 v48, 0
    v_mov_b32 v49, 0
    v_mov_b32 v52, 0
    v_mov_b32 v53, 0
    v_mov_b32 v56, 0
    v_mov_b32 v57, 0
    v_mov_b32 v60, 0
    v_mov_b32 v61, 0
    v_mov_b32 v64, 0
    v_mov_b32 v65, 0
    v_mov_b32 v68, 0
    v_mov_b32 v69, 0
    v_mov_b32 v72, 0
    v_mov_b32 v73, 0
    v_mov_b32 v74, 0
    v_mov_b32 v75, 0
    v_mov_b32 v76, 0
    v_mov_b32 v77, 0
    v_mov_b32 v78, 0
    v_mov_b32 v79, 0
    v_mov_b32 v80, 0
    v_mov_b32 v81, 0
    v_mov_b32 v82, 0
    v_mov_b32 v83, 0
    v_mov_b32 v84, 0
    v_mov_b32 v85, 0
    v_mov_b32 v86, 0
    v_mov_b32 v87, 0
    s_waitcnt vmcnt(1)
    v_add_f32 v88, v88, v92
    v_add_f32 v89, v89, v93
    v_add_f32 v90, v90, v94
    v_add_f32 v91, v91, v95
    s_nop 0
    v_permlane32_swap_b32 v88, v90
    v_permlane32_swap_b32 v89, v91
    v_add_f32 v88, v88, v90
    v_add_f32 v89, v89, v91
    s_nop 1
    v_permlane16_swap_b32 v88, v89
    v_add_f32 v88, v88, v89
    v_mul_f32 v7, 0x3acccccd, v88
    s_mov_b32 s76, 1
POLL5:
    buffer_load_dwordx4 v[24:27], v11, s[16:19], s3 offen sc1
    buffer_load_dwordx4 v[28:31], v11, s[16:19], s79 offen sc1
    s_waitcnt vmcnt(0)
    v_add_f32 v24, v24, v28
    v_add_f32 v25, v25, v29
    v_add_f32 v26, v26, v30
    v_add_f32 v27, v27, v31
    s_nop 0
    v_permlane32_swap_b32 v24, v26
    v_permlane32_swap_b32 v25, v27
    v_add_f32 v24, v24, v26
    v_add_f32 v25, v25, v27
    s_nop 1
    v_permlane16_swap_b32 v24, v25
    v_add_f32 v24, v24, v25
    v_cmp_u_f32 vcc, v24, v24
    s_cbranch_vccnz AGAIN5
POLLX5:
    v_readlane_b32 s77, v24, 15
    s_mov_b32 vcc_lo, 0x70007000
    s_mov_b32 vcc_hi, 0x70007000
    v_fma_f32 v25, -s77, v7, v24
    v_cvt_pk_bf16_f32 v25, v25, v25
    ds_write_b16 v12, v25
    v_cndmask_b32 v26, 0, v24, vcc
    s_nop 1
    v_add_f32_dpp v26, v26, v26 quad_perm:[1,0,3,2] row_mask:0xf bank_mask:0xf
    s_nop 1
    v_add_f32_dpp v26, v26, v26 quad_perm:[2,3,0,1] row_mask:0xf bank_mask:0xf
    v_mov_b32 v27, v26
    s_nop 1
    v_permlane32_swap_b32 v26, v27
    v_add_f32 v26, v26, v27
    s_waitcnt lgkmcnt(0)
    s_barrier
    ds_read_b128 v[28:31], v13 offset:0
    ds_read_b128 v[32:35], v13 offset:128
    ds_read_b128 v[36:39], v13 offset:256
    v_mov_b32 v27, v26
    v_mov_b32 v25, s77
    v_subrev_f32 v25, 0x44200000, v25
    v_permlane16_swap_b32 v26, v27
    v_add_f32 v26, v26, v27
    v_mul_f32 v24, 0x3acccccd, v25
    v_readlane_b32 s77, v26, 15
    v_mul_f32 v24, v24, v24
    s_mov_b32 s78, 0x3acccccd
    v_sub_f32 v26, s77, v25
    v_fma_f32 v26, v26, s78, -v24
    v_max_f32 v26, 0, v26
    v_add_f32 v26, 0x3727c5ac, v26
    v_rsq_f32 v26, v26
    s_nop 0
    v_mul_f32 v18, 0x3dd53b94, v26
    s_waitcnt lgkmcnt(2)
    v_smfmac_f32_16x16x64_bf16 v[40:43], v[28:31], a[0:7], v14
    v_smfmac_f32_16x16x64_bf16 v[44:47], v[28:31], a[24:31], v14
    v_smfmac_f32_16x16x64_bf16 v[48:51], v[28:31], a[48:55], v14
    v_smfmac_f32_16x16x64_bf16 v[52:55], v[28:31], a[72:79], v14
    v_smfmac_f32_16x16x64_bf16 v[56:59], v[28:31], a[96:103], v14
    v_smfmac_f32_16x16x64_bf16 v[60:63], v[28:31], a[120:127], v14
    v_smfmac_f32_16x16x64_bf16 v[64:67], v[28:31], a[144:151], v14
    v_smfmac_f32_16x16x64_bf16 v[68:71], v[28:31], a[168:175], v14
    s_waitcnt lgkmcnt(1)
    v_smfmac_f32_16x16x64_bf16 v[40:43], v[32:35], a[8:15], v14
    v_smfmac_f32_16x16x64_bf16 v[44:47], v[32:35], a[32:39], v14
    v_smfmac_f32_16x16x64_bf16 v[48:51], v[32:35], a[56:63], v14
    v_smfmac_f32_16x16x64_bf16 v[52:55], v[32:35], a[80:87], v14
    v_smfmac_f32_16x16x64_bf16 v[56:59], v[32:35], a[104:111], v14
    v_smfmac_f32_16x16x64_bf16 v[60:63], v[32:35], a[128:135], v14
    v_smfmac_f32_16x16x64_bf16 v[64:67], v[32:35], a[152:159], v14
    v_smfmac_f32_16x16x64_bf16 v[68:71], v[32:35], a[176:183], v14
    s_waitcnt lgkmcnt(0)
    v_smfmac_f32_16x16x64_bf16 v[40:43], v[36:39], a[16:23], v14
    v_smfmac_f32_16x16x64_bf16 v[44:47], v[36:39], a[40:47], v14
    v_smfmac_f32_16x16x64_bf16 v[48:51], v[36:39], a[64:71], v14
    v_smfmac_f32_16x16x64_bf16 v[52:55], v[36:39], a[88:95], v14
    v_smfmac_f32_16x16x64_bf16 v[56:59], v[36:39], a[112:119], v14
    v_smfmac_f32_16x16x64_bf16 v[60:63], v[36:39], a[136:143], v14
    v_smfmac_f32_16x16x64_bf16 v[64:67], v[36:39], a[160:167], v14
    v_smfmac_f32_16x16x64_bf16 v[68:71], v[36:39], a[184:191], v14
    s_nop 0
    v_add_f32 v24, v40, v41
    v_add_f32 v44, v44, v45
    v_add_f32 v48, v48, v49
    v_max3_f32 v26, v24, v44, v48
    v_add_f32 v52, v52, v53
    v_add_f32 v25, v56, v57
    v_max3_f32 v26, v26, v52, v25
    v_add_f32 v60, v60, v61
    v_add_f32 v64, v64, v65
    v_max3_f32 v26, v26, v60, v64
    v_add_f32 v68, v68, v69
    v_max_f32 v26, v26, v68
    v_mov_b32_dpp v24, v44 quad_perm:[0,1,2,3] row_mask:0x2 bank_mask:0xf
    v_mov_b32_dpp v25, v60 quad_perm:[0,1,2,3] row_mask:0x2 bank_mask:0xf
    v_max_f32_dpp v26, v26, v26 row_ror:8 row_mask:0xf bank_mask:0xf
    v_mov_b32_dpp v24, v48 quad_perm:[0,1,2,3] row_mask:0x4 bank_mask:0xf
    v_mov_b32_dpp v25, v64 quad_perm:[0,1,2,3] row_mask:0x4 bank_mask:0xf
    v_max_f32_dpp v26, v26, v26 row_ror:4 row_mask:0xf bank_mask:0xf
    v_mov_b32_dpp v24, v52 quad_perm:[0,1,2,3] row_mask:0x8 bank_mask:0xf
    v_mov_b32_dpp v25, v68 quad_perm:[0,1,2,3] row_mask:0x8 bank_mask:0xf
    v_max_f32_dpp v26, v26, v26 row_ror:2 row_mask:0xf bank_mask:0xf
    v_accvgpr_read_b32 v27, a252
    s_nop 0
    v_max_f32_dpp v26, v26, v26 row_ror:1 row_mask:0xf bank_mask:0xf
    v_mul_f32 v26, v26, v18
    v_fma_f32 v24, v24, v18, -v26
    v_fma_f32 v25, v25, v18, -v26
    v_exp_f32 v24, v24
    v_exp_f32 v25, v25
    s_nop 0
    v_cvt_pk_bf16_f32 v28, v24, v25
    ds_write_b16 v19, v28
    ds_write_b16_d16_hi v19, v28 offset:128
    s_mov_b64 exec, s[88:89]
    ds_read_b128 v[72:75], v27 offset:0
    ds_read_b128 v[76:79], v27 offset:64
    ds_read_b128 v[80:83], v27 offset:128
    ds_read_b128 v[84:87], v27 offset:192
    s_mov_b64 exec, -1
    v_add_f32 v27, v24, v25
    v_mov_b32 v40, 0
    v_mov_b32 v44, 0
    v_add_f32_dpp v27, v27, v27 row_ror:8 row_mask:0xf bank_mask:0xf
    v_mov_b32 v48, 0
    v_mov_b32 v52, 0
    v_add_f32_dpp v27, v27, v27 row_ror:4 row_mask:0xf bank_mask:0xf
    v_mov_b32 v56, 0
    v_mov_b32 v60, 0
    v_add_f32_dpp v27, v27, v27 row_ror:2 row_mask:0xf bank_mask:0xf
    s_lshl_b32 s78, s72, 3
    s_add_u32 s78, s78, 125440
    v_add_f32_dpp v27, v27, v27 row_ror:1 row_mask:0xf bank_mask:0xf
    v_mov_b32 v28, v27
    s_nop 1
    v_permlane32_swap_b32 v27, v28
    v_add_f32 v27, v27, v28
    v_mov_b32 v28, v27
    s_nop 1
    v_permlane16_swap_b32 v27, v28
    v_add_f32 v27, v27, v28
    v_mov_b32 v28, s78
    ds_write_b64 v28, v[26:27]
    s_waitcnt lgkmcnt(4)
    v_smfmac_f32_16x16x64_bf16 v[40:43], v[72:75], a[192:199], v14 abid:1
    v_smfmac_f32_16x16x64_bf16 v[44:47], v[72:75], a[200:207], v14 abid:1
    v_smfmac_f32_16x16x64_bf16 v[48:51], v[72:75], a[208:215], v14 abid:1
    v_smfmac_f32_16x16x64_bf16 v[52:55], v[72:75], a[216:223], v14 abid:1
    v_smfmac_f32_16x16x64_bf16 v[56:59], v[72:75], a[224:231], v14 abid:1
    v_smfmac_f32_16x16x64_bf16 v[60:63], v[72:75], a[232:239], v14 abid:1
    s_waitcnt lgkmcnt(3)
    v_smfmac_f32_16x16x64_bf16 v[40:43], v[76:79], v[112:119], v14 abid:1
    v_smfmac_f32_16x16x64_bf16 v[44:47], v[76:79], v[120:127], v14 abid:1
    v_smfmac_f32_16x16x64_bf16 v[48:51], v[76:79], v[128:135], v14 abid:1
    v_smfmac_f32_16x16x64_bf16 v[52:55], v[76:79], v[136:143], v14 abid:1
    v_smfmac_f32_16x16x64_bf16 v[56:59], v[76:79], v[144:151], v14 abid:1
    v_smfmac_f32_16x16x64_bf16 v[60:63], v[76:79], v[152:159], v14 abid:1
    s_waitcnt lgkmcnt(2)
    v_smfmac_f32_16x16x64_bf16 v[40:43], v[80:83], v[160:167], v14 abid:1
    v_smfmac_f32_16x16x64_bf16 v[44:47], v[80:83], v[168:175], v14 abid:1
    v_smfmac_f32_16x16x64_bf16 v[48:51], v[80:83], v[176:183], v14 abid:1
    v_smfmac_f32_16x16x64_bf16 v[52:55], v[80:83], v[184:191], v14 abid:1
    v_smfmac_f32_16x16x64_bf16 v[56:59], v[80:83], v[192:199], v14 abid:1
    v_smfmac_f32_16x16x64_bf16 v[60:63], v[80:83], v[200:207], v14 abid:1
    s_waitcnt lgkmcnt(0)
ATT_LAST:
    s_waitcnt lgkmcnt(8)
    v_smfmac_f32_16x16x64_bf16 v[40:43], v[84:87], v[208:215], v14 abid:1
    v_smfmac_f32_16x16x64_bf16 v[44:47], v[84:87], v[216:223], v14 abid:1
    s_waitcnt lgkmcnt(4)
    v_smfmac_f32_16x16x64_bf16 v[48:51], v[84:87], v[224:231], v14 abid:1
    v_smfmac_f32_16x16x64_bf16 v[52:55], v[84:87], v[232:239], v14 abid:1
    s_waitcnt lgkmcnt(0)
    v_smfmac_f32_16x16x64_bf16 v[56:59], v[84:87], v[240:247], v14 abid:1
    v_smfmac_f32_16x16x64_bf16 v[60:63], v[84:87], v[248:255], v14 abid:1
    s_lshl_b32 s77, s72, 8
    s_add_u32 s77, s77, 119296
    v_lshl_add_u32 v24, v0, 2, s77
    v_permlane16_swap_b32 v40, v44
    v_add_f32 v40, v40, v44
    ds_write_b32 v15, v40 offset:0
    v_permlane16_swap_b32 v48, v52
    v_add_f32 v48, v48, v52
    ds_write_b32 v15, v48 offset:256
    v_permlane16_swap_b32 v56, v60
    v_add_f32 v56, v56, v60
    ds_write_b32 v15, v56 offset:512
    v_and_b32 v25, 3, v0
    v_lshlrev_b32 v25, 3, v25
    v_add_u32 v25, 125440, v25
    s_waitcnt lgkmcnt(0)
    s_barrier
    ds_read_b64 v[32:33], v25
    ds_read2st64_b32 v[40:41], v24 offset0:0 offset1:3
    ds_read2st64_b32 v[42:43], v24 offset0:6 offset1:9
    s_mul_i32 s77, s70, 3072
    s_lshl_b32 s78, s71, 4
    s_add_u32 s77, s77, s78
    s_lshl_b32 s78, s72, 10
    s_add_u32 s77, s77, s78
    s_add_u32 s77, s77, s3
    s_add_u32 s77, s77, 32768
    s_lshl_b32 s78, s69, 3
    s_add_u32 s78, s78, s3
    s_add_u32 s78, s78, 45056
    s_cmp_eq_u32 s72, 3
    s_waitcnt lgkmcnt(2)
    v_max_f32_dpp v34, v32, v32 quad_perm:[1,0,3,2] row_mask:0xf bank_mask:0xf
    s_nop 1
    v_max_f32_dpp v34, v34, v34 quad_perm:[2,3,0,1] row_mask:0xf bank_mask:0xf
    v_sub_f32 v32, v32, v34
    v_exp_f32 v32, v32
    s_cbranch_scc1 OML
    s_waitcnt lgkmcnt(0)
    v_mul_f32_dpp v28, v32, v40 quad_perm:[0,0,0,0] row_mask:0xf bank_mask:0xf
    v_mul_f32_dpp v29, v32, v41 quad_perm:[1,1,1,1] row_mask:0xf bank_mask:0xf
    v_mul_f32_dpp v30, v32, v42 quad_perm:[2,2,2,2] row_mask:0xf bank_mask:0xf
    v_fmac_f32_dpp v28, v32, v43 quad_perm:[3,3,3,3] row_mask:0xf bank_mask:0xf
    v_add_f32 v29, v29, v30
    v_add_f32 v28, v28, v29
    s_nop 1
    v_mov_b32_dpp v29, v28 row_shl:1 row_mask:0xf bank_mask:0xf
    v_cvt_pk_bf16_f32 v28, v28, v29
    s_nop 1
    v_mov_b32_dpp v29, v28 row_shl:2 row_mask:0xf bank_mask:0xf
    v_mov_b32_dpp v30, v28 row_shl:4 row_mask:0xf bank_mask:0xf
    v_mov_b32_dpp v31, v28 row_shl:6 row_mask:0xf bank_mask:0xf
    s_mov_b64 exec, s[82:83]
    buffer_store_dwordx4 v[28:31], v1, s[8:11], s77 offen
    s_cmp_eq_u32 s10, 0
    s_cbranch_scc1 SLOW6
BACK6:
    s_mov_b64 exec, -1
ODONE:
    s_cmp_ge_u32 s69, 20
    s_cbranch_scc1 ROLEF
    s_cmp_eq_u32 s74, 0
    s_cbranch_scc1 WLATE
    v_accvgpr_read_b32 v2, a246
    v_accvgpr_read_b32 v3, a247
    v_accvgpr_read_b32 v4, a248
    v_mov_b32 v88, 0
    v_mov_b32 v92, 0
    v_mov_b32 v96, 0
    v_mov_b32 v100, 0
    v_mov_b32 v104, 0
    v_mov_b32 v108, 0
    ds_read_b64_tr_b16 v[40:41], v2 offset:0
    ds_read_b64_tr_b16 v[42:43], v2 offset:256
    ds_read_b64_tr_b16 v[64:65], v2 offset:32
    ds_read_b64_tr_b16 v[66:67], v2 offset:288
    ds_read_b64_tr_b16 v[44:45], v2 offset:2048
    ds_read_b64_tr_b16 v[46:47], v2 offset:2304
    ds_read_b64_tr_b16 v[68:69], v2 offset:2080
    ds_read_b64_tr_b16 v[70:71], v2 offset:2336
    ds_read_b64_tr_b16 v[48:49], v2 offset:4096
    ds_read_b64_tr_b16 v[50:51], v2 offset:4352
    s_cmp_lg_u32 s72, 1
    s_cbranch_scc1 NOOWN0
    v_accvgpr_read_b32 v28, a244
    v_accvgpr_read_b32 v29, a245
    v_max_u32 v30, v28, v29
    v_cmp_eq_u32 vcc, -1, v30
    s_cbranch_vccnz RETRY7
OK7:
    v_lshlrev_b32 v30, 16, v28
    v_and_b32 v28, 0xffff0000, v28
    v_lshlrev_b32 v31, 16, v29
    v_and_b32 v29, 0xffff0000, v29
    v_add_f32 v30, v30, v31
    v_add_f32 v28, v28, v29
    v_mov_b32 v31, v30
    v_mov_b32 v29, v28
    s_nop 0
    v_permlane32_swap_b32 v30, v31
    v_permlane32_swap_b32 v28, v29
    v_add_f32 v30, v30, v31
    v_add_f32 v28, v28, v29
    v_mov_b32 v31, v30
    v_mov_b32 v29, v28
    s_nop 0
    v_permlane16_swap_b32 v30, v31
    v_permlane16_swap_b32 v28, v29
    v_add_f32 v30, v30, v31
    v_add_f32 v28, v28, v29
    v_add_f32 v22, v22, v30
    v_add_f32 v23, v23, v28
    v_cvt_pk_bf16_f32 v28, v22, v23
    s_lshl_b32 s77, s69, 6
    s_add_u32 s77, s77, s3
    s_add_u32 s77, s77, 48640
    v_lshlrev_b32 v32, 2, v0
    v_mov_b32_dpp v29, v28 quad_perm:[1,1,1,1] row_mask:0xf bank_mask:0xf
    v_mov_b32_dpp v30, v28 quad_perm:[2,2,2,2] row_mask:0xf bank_mask:0xf
    v_mov_b32_dpp v31, v28 quad_perm:[3,3,3,3] row_mask:0xf bank_mask:0xf
    s_mov_b32 exec_lo, 0x1111
    s_mov_b32 exec_hi, 0x0
    buffer_store_dwordx4 v[28:31], v32, s[8:11], s77 offen
    s_cmp_eq_u32 s10, 0
    s_cbranch_scc1 SLOW8
BACK8:
    s_mov_b64 exec, -1
NOOWN0:
    v_mov_b32 v25, 0
    v_mov_b32 v27, 0
    v_mov_b32 v37, 0
    v_mov_b32 v39, 0
    s_mov_b32 exec_lo, 0x00ff00ff
    s_mov_b32 exec_hi, 0x00ff00ff
    buffer_load_dwordx4 v[88:91], v3, s[16:19], s3 offen offset:0 sc1
    buffer_load_dwordx4 v[92:95], v3, s[16:19], s3 offen offset:512 sc1
    buffer_load_dwordx4 v[96:99], v3, s[16:19], s3 offen offset:1024 sc1
    buffer_load_dwordx4 v[100:103], v3, s[16:19], s3 offen offset:1536 sc1
    buffer_load_dwordx4 v[104:107], v3, s[16:19], s3 offen offset:2048 sc1
    buffer_load_dwordx4 v[108:111], v3, s[16:19], s3 offen offset:2560 sc1
    s_mov_b32 exec_lo, -1
    s_mov_b32 exec_hi, 0
    buffer_load_dwordx4 v[24:27], v4, s[16:19], s3 offen offset:0 sc1
    buffer_load_dwordx4 v[36:39], v4, s[16:19], s3 offen offset:16 sc1
    s_mov_b64 exec, -1
    ds_read_b64_tr_b16 v[72:73], v2 offset:4128
    ds_read_b64_tr_b16 v[74:75], v2 offset:4384
    ds_read_b64_tr_b16 v[52:53], v2 offset:6144
    ds_read_b64_tr_b16 v[54:55], v2 offset:6400
    ds_read_b64_tr_b16 v[76:77], v2 offset:6176
    ds_read_b64_tr_b16 v[78:79], v2 offset:6432
    ds_read_b64_tr_b16 v[56:57], v2 offset:8192
    ds_read_b64_tr_b16 v[58:59], v2 offset:8448
    ds_read_b64_tr_b16 v[80:81], v2 offset:8224
    ds_read_b64_tr_b16 v[82:83], v2 offset:8480
    ds_read_b64_tr_b16 v[60:61], v2 offset:10240
    ds_read_b64_tr_b16 v[62:63], v2 offset:10496
    ds_read_b64_tr_b16 v[84:85], v2 offset:10272
    ds_read_b64_tr_b16 v[86:87], v2 offset:10528
    v_accvgpr_read_b32 v5, a249
    v_lshlrev_b32 v18, 1, v0
WCHK:
    s_waitcnt vmcnt(0)
    v_max3_u32 v28, v88, v92, v96
    v_max3_u32 v28, v28, v100, v104
    v_max3_u32 v28, v28, v108, v25
    v_max3_u32 v28, v28, v27, v37
    v_max_u32 v28, v28, v39
    v_cmp_eq_u32 vcc, -1, v28
    s_cbranch_vccnz AGAIN9
POLLX9:
    s_waitcnt lgkmcnt(0)
    v_mfma_f32_16x16x32_bf16 v[28:31], v[88:91], v[40:43], 0
    v_mfma_f32_16x16x32_bf16 v[32:35], v[88:91], v[64:67], 0
    v_max3_f32 v88, v24, v26, v36
    v_max_f32 v88, v88, v38
    v_mfma_f32_16x16x32_bf16 v[28:31], v[92:95], v[44:47], v[28:31]
    v_mov_b32 v89, v88
    v_mfma_f32_16x16x32_bf16 v[32:35], v[92:95], v[68:71], v[32:35]
    s_nop 0
    v_permlane16_swap_b32 v88, v89
    v_max_f32 v88, v88, v89
    v_mfma_f32_16x16x32_bf16 v[28:31], v[96:99], v[48:51], v[28:31]
    v_sub_f32 v24, v24, v88
    v_sub_f32 v26, v26, v88
    v_mfma_f32_16x16x32_bf16 v[32:35], v[96:99], v[72:75], v[32:35]
    v_sub_f32 v36, v36, v88
    v_sub_f32 v38, v38, v88
    v_mfma_f32_16x16x32_bf16 v[28:31], v[100:103], v[52:55], v[28:31]
    v_exp_f32 v24, v24
    v_mfma_f32_16x16x32_bf16 v[32:35], v[100:103], v[76:79], v[32:35]
    v_exp_f32 v26, v26
    v_mfma_f32_16x16x32_bf16 v[28:31], v[104:107], v[56:59], v[28:31]
    v_exp_f32 v36, v36
    v_mfma_f32_16x16x32_bf16 v[32:35], v[104:107], v[80:83], v[32:35]
    v_exp_f32 v38, v38
    v_mfma_f32_16x16x32_bf16 v[28:31], v[108:111], v[60:63], v[28:31]
    v_mul_f32 v90, v24, v25
    v_fmac_f32 v90, v26, v27
    v_mfma_f32_16x16x32_bf16 v[32:35], v[108:111], v[84:87], v[32:35]
    v_fmac_f32 v90, v36, v37
    v_fmac_f32 v90, v38, v39
    v_mov_b32 v89, v90
    s_cmp_lg_u32 s72, 0
    s_nop 0
    v_permlane16_swap_b32 v90, v89
    v_add_f32 v90, v90, v89
    v_rcp_f32 v90, v90
    v_mul_f32 v28, v24, v28
    v_mul_f32 v32, v24, v32
    v_fmac_f32 v28, v26, v29
    v_fmac_f32 v32, v26, v33
    v_fmac_f32 v28, v36, v30
    v_fmac_f32 v32, v36, v34
    v_fmac_f32 v28, v38, v31
    v_fmac_f32 v32, v38, v35
    s_nop 1
    v_permlane16_swap_b32 v28, v32
    v_add_f32 v28, v28, v32
    v_mul_f32 v28, v28, v90
    ds_write_b32 v5, v28
    s_waitcnt lgkmcnt(0)
    s_barrier
    s_cbranch_scc1 WNOT0
    ds_read2st64_b32 v[28:29], v5 offset0:0 offset1:1
    ds_read2st64_b32 v[30:31], v5 offset0:2 offset1:3
    s_waitcnt lgkmcnt(1)
    v_add_f32 v28, v28, v29
    s_waitcnt lgkmcnt(0)
    v_add_f32 v30, v30, v31
    v_add_f32 v28, v28, v30
    s_nop 1
    v_mov_b32_dpp v29, v28 row_shl:1 row_mask:0xf bank_mask:0xf
    v_cvt_pk_bf16_f32 v28, v28, v29
    s_nop 1
    v_mov_b32_dpp v29, v28 row_shl:2 row_mask:0xf bank_mask:0xf
    v_mov_b32_dpp v30, v28 row_shl:4 row_mask:0xf bank_mask:0xf
    v_mov_b32_dpp v31, v28 row_shl:6 row_mask:0xf bank_mask:0xf
    s_mov_b64 exec, s[92:93]
    buffer_store_dwordx4 v[28:31], v18, s[16:19], s80 offen sc1
    buffer_store_dwordx4 v[28:31], v18, s[8:11], s81 offen
    s_cmp_eq_u32 s10, 0
    s_cbranch_scc1 SLOW10
BACK10:
    s_mov_b64 exec, -1
    v_lshrrev_b32 v37, 5, v0
    v_mul_u32_u24 v37, 2560, v37
    v_and_b32 v38, 31, v0
    v_lshl_add_u32 v37, v38, 2, v37
    v_add_u32 v41, 5120, v37
    v_add_u32 v42, 10240, v37
    v_add_u32 v43, 15360, v37
    v_add_u32 v44, 20480, v37
    v_add_u32 v45, 25600, v37
    s_lshl_b32 s79, s69, 7
    s_add_u32 s79, s79, s3
    s_add_u32 s79, s79, 51200
    s_add_u32 s96, s80, 10240
    s_add_u32 s97, s81, 1280
    v_lshlrev_b32 v39, 1, v0
    s_cmp_lg_u32 s74, 0
    s_cbranch_scc1 NOLC
    s_mul_i32 s77, s69, 2464
    s_add_u32 s78, s3, 720896
    v_add_u32 v48, s77, v1
    v_min_u32 v48, 49136, v48
    s_add_u32 s77, s77, 1024
    v_add_u32 v49, s77, v1
    v_min_u32 v49, 49136, v49
    s_add_u32 s77, s77, 1024
    v_add_u32 v50, s77, v1
    v_min_u32 v50, 49136, v50
    s_add_u32 s77, s77, 1024
    buffer_load_dwordx4 a[240:243], v48, s[16:19], s78 offen sc1
    buffer_load_dwordx4 a[240:243], v49, s[16:19], s78 offen sc1
    buffer_load_dwordx4 a[240:243], v50, s[16:19], s78 offen sc1
    v_mov_b32 v52, -1
    v_mov_b32 v53, -1
    v_mov_b32 v54, -1
    v_mov_b32 v55, -1
    s_add_u32 s77, s80, 688128
    s_add_u32 s7, s96, 688128
    s_waitcnt vmcnt(0)
    buffer_store_dwordx4 v[52:55], v48, s[8:11], s78 offen
    s_cmp_eq_u32 s10, 0
    s_cbranch_scc1 SLOW11
BACK11:
    buffer_store_dwordx4 v[52:55], v49, s[8:11], s78 offen
    s_cmp_eq_u32 s10, 0
    s_cbranch_scc1 SLOW12
BACK12:
    buffer_store_dwordx4 v[52:55], v50, s[8:11], s78 offen
    s_cmp_eq_u32 s10, 0
    s_cbranch_scc1 SLOW13
BACK13:
    s_mov_b64 exec, 15
    buffer_store_dwordx4 v[52:55], v1, s[16:19], s77 offen sc1
    buffer_store_dwordx4 v[52:55], v1, s[16:19], s7 offen sc1
    s_mov_b64 exec, -1
NOLC:
    s_mov_b32 s76, 1
POLL14:
    buffer_load_dword v28, v37, s[16:19], s79 offen sc1
    buffer_load_dword v29, v41, s[16:19], s79 offen sc1
    buffer_load_dword v30, v42, s[16:19], s79 offen sc1
    buffer_load_dword v31, v43, s[16:19], s79 offen sc1
    buffer_load_dword v32, v44, s[16:19], s79 offen sc1
    buffer_load_dword v33, v45, s[16:19], s79 offen sc1
    s_waitcnt vmcnt(0)
    v_add_f32 v28, v28, v29
    v_add_f32 v30, v30, v31
    v_add_f32 v32, v32, v33
    v_add_f32 v28, v28, v30
    v_add_f32 v29, v28, v32
    v_add_f32 v28, v28, v32
    v_cmp_u_f32 vcc, v28, v28
    s_cbranch_vccnz AGAIN14
POLLX14:
    v_permlane32_swap_b32 v28, v29
    v_add_f32 v28, v28, v29
    s_nop 1
    v_mov_b32_dpp v29, v28 row_shl:1 row_mask:0xf bank_mask:0xf
    v_cvt_pk_bf16_f32 v28, v28, v29
    s_nop 1
    v_mov_b32_dpp v29, v28 row_shl:2 row_mask:0xf bank_mask:0xf
    v_mov_b32_dpp v30, v28 row_shl:4 row_mask:0xf bank_mask:0xf
    v_mov_b32_dpp v31, v28 row_shl:6 row_mask:0xf bank_mask:0xf
    s_mov_b64 exec, s[92:93]
    buffer_store_dwordx4 v[28:31], v39, s[16:19], s96 offen sc1
    buffer_store_dwordx4 v[28:31], v39, s[8:11], s97 offen
    s_cmp_eq_u32 s10, 0
    s_cbranch_scc1 SLOW15
BACK15:
    s_mov_b64 exec, -1
    s_branch NEXT
AGAIN2:
    s_add_u32 s76, s76, 1
    s_cmp_lt_u32 s76, 32768
    s_cbranch_scc1 POLL2
    s_branch POLLX2
BR3:
    s_cmp_ge_u32 s76, 32768
    s_cbranch_scc1 BX3
BL3:
    s_mov_b64 exec, s[86:87]
    v_cmp_eq_u32 vcc, -1, v80
    s_nop 0
    s_mov_b64 exec, vcc
    s_cbranch_execz BS3_0
    buffer_load_dwordx4 v[80:83], v8, s[16:19], 0 offen sc1
BS3_0:
    s_mov_b64 exec, s[86:87]
    v_cmp_eq_u32 vcc, -1, v84
    s_nop 0
    s_mov_b64 exec, vcc
    s_cbranch_execz BS3_1
    buffer_load_dwordx4 v[84:87], v9, s[16:19], 0 offen sc1
BS3_1:
    s_mov_b64 exec, s[86:87]
    s_add_u32 s76, s76, 1
    s_cmp_ge_u32 s76, 32768
    s_waitcnt vmcnt(0)
    v_max_u32 v24, v80, v84
    v_cmp_eq_u32 vcc, -1, v24
    s_cbranch_vccz BW3
    s_cbranch_scc0 BL3
    s_branch BW3
AGAIN5:
    s_add_u32 s76, s76, 1
    s_cmp_lt_u32 s76, 32768
    s_cbranch_scc1 POLL5
    s_branch POLLX5
OML:
    v_mul_f32 v35, v32, v33
    s_nop 1
    v_add_f32_dpp v35, v35, v35 quad_perm:[1,0,3,2] row_mask:0xf bank_mask:0xf
    s_nop 1
    v_add_f32_dpp v35, v35, v35 quad_perm:[2,3,0,1] row_mask:0xf bank_mask:0xf
    s_mov_b64 exec, 1
    buffer_store_dwordx2 v[34:35], v1, s[8:11], s78 offen
    s_cmp_eq_u32 s10, 0
    s_cbranch_scc1 SLOW16
BACK16:
    s_mov_b64 exec, -1
    s_waitcnt lgkmcnt(0)
    s_branch ODONE
WLATE:
    v_lshrrev_b32 v38, 2, v0
    v_mul_u32_u24 v38, 1280, v38
    v_and_b32 v39, 3, v0
    v_lshl_add_u32 v39, v39, 4, v38
    s_mov_b32 m0, s67
    s_add_u32 s67, s67, 1024
    buffer_load_dwordx4 v39, s[24:27], s66 offen  lds
    s_add_u32 s66, s66, 20480
    s_mov_b32 m0, s67
    s_add_u32 s67, s67, 1024
    buffer_load_dwordx4 v39, s[24:27], s66 offen  lds
    s_add_u32 s66, s66, 20480
    s_mov_b32 m0, s67
    s_add_u32 s67, s67, 1024
    buffer_load_dwordx4 v39, s[24:27], s66 offen  lds
    s_add_u32 s66, s66, 20480
    s_mov_b32 m0, s67
    s_add_u32 s67, s67, 1024
    buffer_load_dwordx4 v39, s[24:27], s66 offen  lds
    s_add_u32 s66, s66, 20480
    s_add_u32 s77, s3, 1376256
    buffer_store_dword v7, v10, s[8:11], s77 offen
    s_cmp_eq_u32 s10, 0
    s_cbranch_scc1 SLOW17
BACK17:
    s_cmp_lg_u32 s72, 3
    s_cbranch_scc1 NOFPC
    v_mov_b32 v24, -1
    v_mov_b32 v25, -1
    v_mov_b32 v26, -1
    v_mov_b32 v27, -1
    v_accvgpr_read_b32 v28, a250
    buffer_store_dwordx4 v[24:27], v28, s[8:11], 0 offen
    s_cmp_eq_u32 s10, 0
    s_cbranch_scc1 SLOW18
BACK18:
    v_accvgpr_read_b32 v29, a251
    buffer_store_dwordx4 v[24:27], v29, s[8:11], 0 offen
    s_cmp_eq_u32 s10, 0
    s_cbranch_scc1 SLOW19
BACK19:
NOFPC:
    v_accvgpr_read_b32 v2, a246
    v_accvgpr_read_b32 v3, a247
    v_accvgpr_read_b32 v4, a248
    v_mov_b32 v88, 0
    v_mov_b32 v92, 0
    v_mov_b32 v96, 0
    v_mov_b32 v100, 0
    v_mov_b32 v104, 0
    v_mov_b32 v108, 0
    v_mov_b32 v25, 0
    v_mov_b32 v27, 0
    v_mov_b32 v37, 0
    v_mov_b32 v39, 0
    s_mov_b32 exec_lo, 0x00ff00ff
    s_mov_b32 exec_hi, 0x00ff00ff
    buffer_load_dwordx4 v[88:91], v3, s[16:19], s3 offen offset:0 sc1
    buffer_load_dwordx4 v[92:95], v3, s[16:19], s3 offen offset:512 sc1
    buffer_load_dwordx4 v[96:99], v3, s[16:19], s3 offen offset:1024 sc1
    buffer_load_dwordx4 v[100:103], v3, s[16:19], s3 offen offset:1536 sc1
    buffer_load_dwordx4 v[104:107], v3, s[16:19], s3 offen offset:2048 sc1
    buffer_load_dwordx4 v[108:111], v3, s[16:19], s3 offen offset:2560 sc1
    s_mov_b32 exec_lo, -1
    s_mov_b32 exec_hi, 0
    buffer_load_dwordx4 v[24:27], v4, s[16:19], s3 offen offset:0 sc1
    buffer_load_dwordx4 v[36:39], v4, s[16:19], s3 offen offset:16 sc1
    s_mov_b64 exec, -1
    s_waitcnt vmcnt(8)
    ds_read_b64_tr_b16 v[40:41], v2 offset:0
    ds_read_b64_tr_b16 v[42:43], v2 offset:256
    ds_read_b64_tr_b16 v[64:65], v2 offset:32
    ds_read_b64_tr_b16 v[66:67], v2 offset:288
    ds_read_b64_tr_b16 v[44:45], v2 offset:2048
    ds_read_b64_tr_b16 v[46:47], v2 offset:2304
    ds_read_b64_tr_b16 v[68:69], v2 offset:2080
    ds_read_b64_tr_b16 v[70:71], v2 offset:2336
    ds_read_b64_tr_b16 v[48:49], v2 offset:4096
    ds_read_b64_tr_b16 v[50:51], v2 offset:4352
    ds_read_b64_tr_b16 v[72:73], v2 offset:4128
    ds_read_b64_tr_b16 v[74:75], v2 offset:4384
    ds_read_b64_tr_b16 v[52:53], v2 offset:6144
    ds_read_b64_tr_b16 v[54:55], v2 offset:6400
    ds_read_b64_tr_b16 v[76:77], v2 offset:6176
    ds_read_b64_tr_b16 v[78:79], v2 offset:6432
    ds_read_b64_tr_b16 v[56:57], v2 offset:8192
    ds_read_b64_tr_b16 v[58:59], v2 offset:8448
    ds_read_b64_tr_b16 v[80:81], v2 offset:8224
    ds_read_b64_tr_b16 v[82:83], v2 offset:8480
    ds_read_b64_tr_b16 v[60:61], v2 offset:10240
    ds_read_b64_tr_b16 v[62:63], v2 offset:10496
    ds_read_b64_tr_b16 v[84:85], v2 offset:10272
    ds_read_b64_tr_b16 v[86:87], v2 offset:10528
    v_accvgpr_read_b32 v5, a249
    v_lshlrev_b32 v18, 1, v0
    s_branch WCHK
AGAIN9:
    s_mov_b64 s[94:95], exec
    s_mov_b32 s76, 1
AG29:
    v_max3_u32 v28, v88, v92, v96
    v_max3_u32 v28, v28, v100, v104
    v_max_u32 v28, v28, v108
    v_cmp_eq_u32 vcc, -1, v28
    s_nop 0
    s_mov_b64 exec, vcc
    s_cbranch_execz AG39_0
    buffer_load_dwordx4 v[88:91], v3, s[16:19], s3 offen offset:0 sc1
    buffer_load_dwordx4 v[92:95], v3, s[16:19], s3 offen offset:512 sc1
    buffer_load_dwordx4 v[96:99], v3, s[16:19], s3 offen offset:1024 sc1
    buffer_load_dwordx4 v[100:103], v3, s[16:19], s3 offen offset:1536 sc1
    buffer_load_dwordx4 v[104:107], v3, s[16:19], s3 offen offset:2048 sc1
    buffer_load_dwordx4 v[108:111], v3, s[16:19], s3 offen offset:2560 sc1
AG39_0:
    s_mov_b64 exec, s[94:95]
    v_max3_u32 v28, v25, v27, v37
    v_max_u32 v28, v28, v39
    v_cmp_eq_u32 vcc, -1, v28
    s_nop 0
    s_mov_b64 exec, vcc
    s_cbranch_execz AG39_1
    buffer_load_dwordx4 v[24:27], v4, s[16:19], s3 offen offset:0 sc1
    buffer_load_dwordx4 v[36:39], v4, s[16:19], s3 offen offset:16 sc1
AG39_1:
    s_mov_b64 exec, s[94:95]
    s_add_u32 s76, s76, 1
    s_cmp_ge_u32 s76, 32768
    s_waitcnt vmcnt(0)
    v_max3_u32 v28, v88, v92, v96
    v_max3_u32 v28, v28, v100, v104
    v_max3_u32 v28, v28, v108, v25
    v_max3_u32 v28, v28, v27, v37
    v_max_u32 v28, v28, v39
    v_cmp_eq_u32 vcc, -1, v28
    s_cbranch_vccz POLLX9
    s_cbranch_scc0 AG29
    s_branch POLLX9
AGAIN14:
    s_add_u32 s76, s76, 1
    s_cmp_lt_u32 s76, 32768
    s_cbranch_scc1 POLL14
    s_branch POLLX14
WNOT0:
    s_cmp_lg_u32 s72, 1
    s_cbranch_scc1 NEXT
    v_and_b32 v25, 15, v0
    v_lshrrev_b32 v26, 4, v0
    v_mul_u32_u24 v37, 1280, v26
    v_add_u32 v37, 655360, v37
    s_mul_i32 s7, s68, 81920
    s_add_u32 s7, s7, 46080
    v_mov_b32 v38, s7
    v_cmp_eq_u32 vcc, s68, v26
    s_nop 1
    v_cndmask_b32 v37, v37, v38, vcc
    v_add_u32 v39, 4, v26
    v_mul_u32_u24 v38, 1280, v39
    v_add_u32 v38, 655360, v38
    s_mul_i32 s7, s68, 81920
    s_add_u32 s7, s7, 46080
    v_mov_b32 v28, s7
    v_cmp_eq_u32 vcc, s68, v39
    s_nop 1
    v_cndmask_b32 v38, v38, v28, vcc
    s_lshl_b32 s77, s69, 6
    s_add_u32 s77, s77, s74
    v_lshl_add_u32 v37, v25, 2, v37
    v_lshl_add_u32 v38, v25, 2, v38
    s_sleep 16
    s_mov_b32 s76, 1
POLL20:
    buffer_load_dword v28, v37, s[16:19], s77 offen sc1
    buffer_load_dword v29, v38, s[16:19], s77 offen sc1
POLLW20:
    s_waitcnt vmcnt(0)
    v_max_u32 v30, v28, v29
    v_cmp_eq_u32 vcc, -1, v30
    s_cbranch_vccnz AGAIN20
POLLX20:
    v_lshlrev_b32 v30, 16, v28
    v_and_b32 v28, 0xffff0000, v28
    v_lshlrev_b32 v31, 16, v29
    v_and_b32 v29, 0xffff0000, v29
    v_add_f32 v30, v30, v31
    v_add_f32 v28, v28, v29
    v_mov_b32 v31, v30
    v_mov_b32 v29, v28
    s_nop 0
    v_permlane32_swap_b32 v30, v31
    v_permlane32_swap_b32 v28, v29
    v_add_f32 v30, v30, v31
    v_add_f32 v28, v28, v29
    v_mov_b32 v31, v30
    v_mov_b32 v29, v28
    s_nop 0
    v_permlane16_swap_b32 v30, v31
    v_permlane16_swap_b32 v28, v29
    v_add_f32 v30, v30, v31
    v_add_f32 v28, v28, v29
    v_add_f32 v22, v22, v30
    v_add_f32 v23, v23, v28
    v_cvt_pk_bf16_f32 v28, v22, v23
    s_cmp_lg_u32 s74, 0
    s_cbranch_scc1 FINAL
    s_lshl_b32 s77, s69, 6
    s_add_u32 s77, s77, s3
    s_add_u32 s77, s77, 49920
    v_lshlrev_b32 v32, 2, v0
    v_mov_b32_dpp v29, v28 quad_perm:[1,1,1,1] row_mask:0xf bank_mask:0xf
    v_mov_b32_dpp v30, v28 quad_perm:[2,2,2,2] row_mask:0xf bank_mask:0xf
    v_mov_b32_dpp v31, v28 quad_perm:[3,3,3,3] row_mask:0xf bank_mask:0xf
    s_mov_b32 exec_lo, 0x1111
    s_mov_b32 exec_hi, 0x0
    buffer_store_dwordx4 v[28:31], v32, s[8:11], s77 offen
    s_cmp_eq_u32 s10, 0
    s_cbranch_scc1 SLOW21
BACK21:
    s_mov_b64 exec, -1
    s_branch NEXT
FINAL:
    s_cmp_lg_u32 s68, 0
    s_cbranch_scc1 DONE
    s_lshl_b32 s77, s69, 6
    v_lshlrev_b32 v37, 2, v0
    s_add_u32 s79, s77, s3
    s_add_u32 s79, s79, 47360
    s_mov_b64 exec, 15
    s_mov_b32 s76, 1
POLL22:
    buffer_load_dword v28, v1, s[16:19], s79 offen sc1
POLLW22:
    s_waitcnt vmcnt(0)
    v_cmp_eq_u32 vcc, -1, v28
    s_cbranch_vccnz AGAIN22
POLLX22:
    s_mov_b64 exec, -1
    s_mov_b32 s76, 1
POLL23:
    buffer_load_dword v28, v20, s[16:19], s74 offen sc1
    buffer_load_dword v29, v21, s[16:19], s74 offen sc1
POLLW23:
    s_waitcnt vmcnt(0)
    v_max_u32 v30, v28, v29
    v_cmp_eq_u32 vcc, -1, v30
    s_cbranch_vccnz AGAIN23
POLLX23:
    v_lshlrev_b32 v30, 16, v28
    v_and_b32 v28, 0xffff0000, v28
    v_lshlrev_b32 v31, 16, v29
    v_and_b32 v29, 0xffff0000, v29
    v_add_f32 v30, v30, v31
    v_add_f32 v28, v28, v29
    v_mov_b32 v31, v30
    v_mov_b32 v29, v28
    s_nop 0
    v_permlane32_swap_b32 v30, v31
    v_permlane32_swap_b32 v28, v29
    v_add_f32 v30, v30, v31
    v_add_f32 v28, v28, v29
    v_mov_b32 v31, v30
    v_mov_b32 v29, v28
    s_nop 0
    v_permlane16_swap_b32 v30, v31
    v_permlane16_swap_b32 v28, v29
    v_add_f32 v30, v30, v31
    v_add_f32 v28, v28, v29
    v_add_f32 v22, v22, v30
    v_add_f32 v23, v23, v28
    v_cvt_pk_bf16_f32 v28, v22, v23
    s_mov_b32 exec_lo, 0xffff
    s_mov_b32 exec_hi, 0x0
    buffer_store_dword v28, v37, s[40:43], s77 offen
    s_mov_b64 exec, -1
    s_endpgm
AGAIN20:
    s_sleep 4
    s_add_u32 s76, s76, 1
    s_cmp_lt_u32 s76, 32768
    s_cbranch_scc1 POLL20
    s_branch POLLX20
AGAIN22:
    s_add_u32 s76, s76, 1
    s_cmp_lt_u32 s76, 32768
    s_cbranch_scc1 POLL22
    s_branch POLLX22
AGAIN23:
    s_add_u32 s76, s76, 1
    s_cmp_lt_u32 s76, 32768
    s_cbranch_scc1 POLL23
    s_branch POLLX23
ROLEF:
    v_and_b32 v25, 15, v0
    v_lshrrev_b32 v26, 4, v0
    v_bfe_u32 v27, v0, 2, 2
    v_and_b32 v36, 3, v0
    s_mov_b32 s4, 1
    s_cmp_lg_u32 s74, 0
    s_cbranch_scc1 FW
    s_mov_b32 s4, 0
FW:
    s_mul_i32 s77, s72, 5120
    s_add_u32 s77, s77, 57344
    v_lshl_add_u32 v37, v26, 3, v27
    v_lshlrev_b32 v37, 5, v37
    v_lshl_add_u32 v37, v36, 3, v37
    v_add_u32 v37, s77, v37
    ds_read_b64_tr_b16 v[40:41], v37 offset:0
    ds_read_b64_tr_b16 v[42:43], v37 offset:128
    ds_read_b64_tr_b16 v[44:45], v37 offset:1024
    ds_read_b64_tr_b16 v[46:47], v37 offset:1152
    ds_read_b64_tr_b16 v[48:49], v37 offset:2048
    ds_read_b64_tr_b16 v[50:51], v37 offset:2176
    ds_read_b64_tr_b16 v[52:53], v37 offset:3072
    ds_read_b64_tr_b16 v[54:55], v37 offset:3200
    ds_read_b64_tr_b16 v[56:57], v37 offset:4096
    ds_read_b64_tr_b16 v[58:59], v37 offset:4224
    ds_read_b64_tr_b16 v[60:61], v37 offset:20480
    ds_read_b64_tr_b16 v[62:63], v37 offset:20608
    ds_read_b64_tr_b16 v[64:65], v37 offset:21504
    ds_read_b64_tr_b16 v[66:67], v37 offset:21632
    ds_read_b64_tr_b16 v[68:69], v37 offset:22528
    ds_read_b64_tr_b16 v[70:71], v37 offset:22656
    ds_read_b64_tr_b16 v[72:73], v37 offset:23552
    ds_read_b64_tr_b16 v[74:75], v37 offset:23680
    ds_read_b64_tr_b16 v[76:77], v37 offset:24576
    ds_read_b64_tr_b16 v[78:79], v37 offset:24704
    s_mul_i32 s77, s72, 320
    s_add_u32 s77, s77, 98304
    v_lshrrev_b32 v80, 2, v0
    v_mul_u32_u24 v80, 1280, v80
    v_lshl_add_u32 v80, v36, 3, v80
    v_add_u32 v80, s77, v80
    s_lshl_b32 s79, s72, 2
    s_add_u32 s79, s79, 123392
    v_add_u32 v81, s79, v1
    v_lshl_add_u32 v82, v26, 2, v36
    v_lshlrev_b32 v82, 4, v82
    v_add_u32 v82, 123392, v82
    v_cmp_eq_u32 vcc, 12, v25
    v_mov_b32 v83, 123904
    v_mov_b32 v85, 0x3727c5ac
    v_lshlrev_b32 v84, 6, v25
    v_lshl_add_u32 v84, v26, 4, v84
    s_mov_b32 s64, 0x03ff03ff
    s_mov_b32 s65, 0x03ff03ff
    s_mov_b32 s66, 0x3acccccd
    s_mov_b32 s44, 0x10001
    s_mov_b32 s45, 0x10001
    s_mov_b32 s46, 0x20002
    s_mov_b32 s47, 0x20002
    s_mov_b32 s48, 0x40004
    s_mov_b32 s49, 0x40004
    s_mov_b32 s50, 0x80008
    s_mov_b32 s51, 0x80008
    s_mov_b32 s52, 0x100010
    s_mov_b32 s53, 0x100010
    s_mov_b32 s54, 0x200020
    s_mov_b32 s55, 0x200020
    s_mov_b32 s56, 0x400040
    s_mov_b32 s57, 0x400040
    s_mov_b32 s58, 0x800080
    s_mov_b32 s59, 0x800080
    s_mov_b32 s60, 0x1000100
    s_mov_b32 s61, 0x1000100
    s_mov_b32 s62, 0x2000200
    s_mov_b32 s63, 0x2000200
    v_mov_b32 v38, 0x3f803f80
    v_cndmask_b32 v88, 0, v38, vcc
    v_mov_b32 v89, v88
    v_mov_b32 v90, v88
    v_mov_b32 v91, v88
    v_mov_b32 v92, v88
    v_mov_b32 v93, v88
    v_mov_b32 v94, v88
    v_mov_b32 v95, v88
    v_mov_b32 v96, v88
    v_mov_b32 v97, v88
    v_mov_b32 v98, v88
    v_mov_b32 v99, v88
    v_mov_b32 v100, v88
    v_mov_b32 v101, v88
    v_mov_b32 v102, v88
    v_mov_b32 v103, v88
    v_mov_b32 v104, v88
    v_mov_b32 v105, v88
    v_mov_b32 v106, v88
    v_mov_b32 v107, v88
    s_mul_i32 s77, s72, 6656
    v_mul_u32_u24 v6, 336, v25
    v_lshl_add_u32 v6, v26, 4, v6
    v_add_u32 v6, s77, v6
    v_mul_u32_u24 v37, 52, v0
    v_lshrrev_b32 v37, 10, v37
    v_lshl_add_u32 v87, v37, 4, v1
    v_add_u32 v87, s77, v87
    v_mul_u32_u24 v27, 320, v37
    v_sub_u32 v27, v1, v27
    v_mul_u32_u24 v86, 1280, v37
    v_add_u32 v86, 655360, v86
    s_mul_i32 s7, s68, 81920
    s_add_u32 s7, s7, 46080
    v_mov_b32 v38, s7
    v_cmp_eq_u32 vcc, s68, v37
    s_nop 1
    v_cndmask_b32 v86, v86, v38, vcc
    v_add_u32 v38, 2560, v38
    v_cmp_le_u32 vcc, 8, v37
    s_nop 1
    v_cndmask_b32 v86, v86, v38, vcc
    v_add_u32 v86, v86, v27
    v_add_u32 v37, 3, v37
    v_mul_u32_u24 v18, 1280, v37
    v_add_u32 v18, 655360, v18
    s_mul_i32 s7, s68, 81920
    s_add_u32 s7, s7, 46080
    v_mov_b32 v38, s7
    v_cmp_eq_u32 vcc, s68, v37
    s_nop 1
    v_cndmask_b32 v18, v18, v38, vcc
    v_add_u32 v38, 2560, v38
    v_cmp_le_u32 vcc, 8, v37
    s_nop 1
    v_cndmask_b32 v18, v18, v38, vcc
    v_add_u32 v18, v18, v27
    v_add_u32 v37, 3, v37
    v_mul_u32_u24 v20, 1280, v37
    v_add_u32 v20, 655360, v20
    s_mul_i32 s7, s68, 81920
    s_add_u32 s7, s7, 46080
    v_mov_b32 v38, s7
    v_cmp_eq_u32 vcc, s68, v37
    s_nop 1
    v_cndmask_b32 v20, v20, v38, vcc
    v_add_u32 v38, 2560, v38
    v_cmp_le_u32 vcc, 8, v37
    s_nop 1
    v_cndmask_b32 v20, v20, v38, vcc
    v_add_u32 v20, v20, v27
    s_mul_i32 s77, s72, 320
    s_add_u32 s77, s77, s74
    s_sub_u32 s78, s69, 20
    s_mul_i32 s78, s78, 2560
    s_mul_i32 s7, s72, 640
    s_add_u32 s78, s78, s7
    s_add_u32 s78, s78, s3
    s_add_u32 s78, s78, 51200
    s_waitcnt lgkmcnt(0)
    s_cmp_eq_u32 s4, 0
    s_cbranch_scc1 FW2
FPOLL:
    ds_read_b64_tr_b16 a[240:241], v80 offset:0
    ds_read_b64_tr_b16 a[242:243], v80 offset:32
    ds_read_b64_tr_b16 a[244:245], v80 offset:64
    ds_read_b64_tr_b16 a[246:247], v80 offset:96
    ds_read_b64_tr_b16 a[248:249], v80 offset:128
    ds_read_b64_tr_b16 a[250:251], v80 offset:160
    ds_read_b64_tr_b16 v[108:109], v80 offset:192
    ds_read_b64_tr_b16 v[110:111], v80 offset:224
    ds_read_b64_tr_b16 v[2:3], v80 offset:256
    ds_read_b64_tr_b16 v[4:5], v80 offset:288
    s_waitcnt lgkmcnt(0)
    s_mul_i32 s79, s72, 320
    s_add_u32 s79, s79, s3
    s_add_u32 s79, s79, 46080
    s_mov_b32 exec_lo, 0xfffff
    s_mov_b32 exec_hi, 0x0
    s_mov_b32 s76, 1
POLL24:
    buffer_load_dword v36, v1, s[16:19], s79 offen sc1
POLLW24:
    s_waitcnt vmcnt(0)
    v_cmp_eq_u32 vcc, -1, v36
    s_cbranch_vccnz AGAIN24
POLLX24:
    s_mov_b64 exec, s[86:87]
    buffer_load_dwordx4 v[24:27], v86, s[16:19], s77 offen sc1
    buffer_load_dwordx4 v[28:31], v18, s[16:19], s77 offen sc1
    buffer_load_dwordx4 v[32:35], v20, s[16:19], s77 offen sc1
    s_waitcnt vmcnt(0)
BW25:
    ds_write_b128 v87, v[24:27] offset:0
    ds_write_b128 v87, v[28:31] offset:1008
    ds_write_b128 v87, v[32:35] offset:2016
    v_max3_u32 v36, v24, v28, v32
    v_cmp_eq_u32 vcc, -1, v36
    s_mov_b64 exec, s[84:85]
    ds_read_b128 v[88:91], v6 offset:0
    ds_read_b128 v[92:95], v6 offset:64
    ds_read_b128 v[96:99], v6 offset:128
    ds_read_b128 v[100:103], v6 offset:192
    ds_read_b128 v[104:107], v6 offset:256
    s_mov_b64 exec, -1
    s_cbranch_vccnz BR25
BX25:
FMM:
    s_waitcnt lgkmcnt(4)
    v_mfma_f32_16x16x32_bf16 v[32:35], v[88:91], v[88:91], 0
    s_waitcnt lgkmcnt(3)
    v_mfma_f32_16x16x32_bf16 v[32:35], v[92:95], v[92:95], v[32:35]
    s_waitcnt lgkmcnt(2)
    v_mfma_f32_16x16x32_bf16 v[32:35], v[96:99], v[96:99], v[32:35]
    s_waitcnt lgkmcnt(1)
    v_mfma_f32_16x16x32_bf16 v[32:35], v[100:103], v[100:103], v[32:35]
    s_waitcnt lgkmcnt(0)
    v_mfma_f32_16x16x32_bf16 v[32:35], v[104:107], v[104:107], v[32:35]
    v_mfma_f32_16x16x32_bf16 v[24:27], v[88:91], v[40:43], 0
    v_mov_b32 v36, 0
    v_mov_b32 v37, 0
    v_mfma_f32_16x16x32_bf16 v[24:27], v[92:95], v[44:47], v[24:27]
    v_mov_b32 v38, 0
    s_cmp_eq_u32 s4, 0
    v_mfma_f32_16x16x32_bf16 v[24:27], v[96:99], v[48:51], v[24:27]
    v_mfma_f32_16x16x32_bf16 v[24:27], v[100:103], v[52:55], v[24:27]
    v_add_f32 v32, v32, v33
    v_add_f32 v34, v34, v35
    v_mfma_f32_16x16x32_bf16 v[24:27], v[104:107], v[56:59], v[24:27]
    v_mfma_f32_16x16x32_bf16 v[28:31], v[88:91], v[60:63], 0
    v_add_f32_dpp v36, v32, v34 quad_perm:[0,1,2,3] row_mask:0xf bank_mask:0x7
    v_mfma_f32_16x16x32_bf16 v[28:31], v[92:95], v[64:67], v[28:31]
    s_nop 0
    v_add_f32_dpp v36, v36, v36 row_ror:8 row_mask:0xf bank_mask:0xf
    v_mfma_f32_16x16x32_bf16 v[28:31], v[96:99], v[68:71], v[28:31]
    s_nop 0
    v_add_f32_dpp v36, v36, v36 row_ror:4 row_mask:0xf bank_mask:0xf
    v_mfma_f32_16x16x32_bf16 v[28:31], v[100:103], v[72:75], v[28:31]
    s_nop 0
    v_add_f32_dpp v36, v36, v36 row_ror:2 row_mask:0xf bank_mask:0xf
    v_mfma_f32_16x16x32_bf16 v[28:31], v[104:107], v[76:79], v[28:31]
    v_add_f32 v24, v24, v25
    v_add_f32_dpp v37, v36, v36 row_ror:1 row_mask:0x7 bank_mask:0xf
    v_add_f32_dpp v38, v36, v36 row_ror:1 row_mask:0x8 bank_mask:0xf
    v_add_f32 v26, v26, v27
    v_add_f32 v24, v24, v26
    s_nop 1
    v_permlane32_swap_b32 v24, v37
    v_add_f32 v28, v28, v29
    v_add_f32 v30, v30, v31
    v_add_f32 v28, v28, v30
    v_add_f32 v24, v24, v37
    s_nop 0
    v_permlane32_swap_b32 v28, v38
    v_add_f32 v28, v28, v38
    s_nop 1
    v_permlane16_swap_b32 v24, v28
    v_add_f32 v24, v24, v28
    ds_write_b32 v81, v24
    s_waitcnt lgkmcnt(0)
    s_barrier
    ds_read_b128 v[28:31], v83 offset:256
    ds_read_b128 v[24:27], v83
    ds_read_b128 v[32:35], v82
    ds_read_b128 v[36:39], v82 offset:256
    s_cbranch_scc1 FCS
    s_waitcnt lgkmcnt(3)
    v_add_f32 v28, v28, v29
    v_add_f32 v30, v30, v31
    v_add_f32 v28, v28, v30
    v_mul_f32 v28, s66, v28
    s_waitcnt lgkmcnt(2)
    v_add_f32 v24, v24, v25
    v_add_f32 v26, v26, v27
    v_add_f32 v24, v24, v26
    v_fma_f32 v24, v24, s66, v85
    v_fma_f32 v24, -v28, v28, v24
    v_add_f32 v28, 1.0, v28
    v_max_f32 v24, v24, v85
    s_waitcnt lgkmcnt(1)
    v_rsq_f32 v25, v24
    v_add_f32 v32, v32, v33
    v_add_f32 v34, v34, v35
    v_add_f32 v32, v32, v34
    v_mul_f32 v25, 0xbfb8aa3b, v25
    v_fma_f32 v32, -v28, v22, v32
    v_mul_f32 v33, v32, v25
    v_exp_f32 v33, v33
    s_waitcnt lgkmcnt(0)
    v_add_f32 v36, v36, v37
    v_fma_f32 v33, v33, v24, v24
    v_rcp_f32 v33, v33
    v_add_f32 v38, v38, v39
    v_add_f32 v36, v36, v38
    v_mul_f32 v33, v33, v32
    v_fma_f32 v36, -v28, v23, v36
    v_mul_f32 v36, v36, v33
    s_nop 1
    v_mov_b32_dpp v28, v36 quad_perm:[0,0,0,0] row_mask:0xf bank_mask:0xf
    v_mov_b32_dpp v29, v36 quad_perm:[1,1,1,1] row_mask:0xf bank_mask:0xf
    v_mov_b32_dpp v30, v36 quad_perm:[2,2,2,2] row_mask:0xf bank_mask:0xf
    v_mov_b32_dpp v31, v36 quad_perm:[3,3,3,3] row_mask:0xf bank_mask:0xf
    v_cvt_pk_bf16_f32 v28, v28, v29
    v_cvt_pk_bf16_f32 v29, v30, v31
    v_cndmask_b32 v60, 0, v28, s[44:45]
    v_cndmask_b32 v61, 0, v29, s[44:45]
    v_cndmask_b32 v62, 0, v28, s[46:47]
    v_cndmask_b32 v63, 0, v29, s[46:47]
    v_cndmask_b32 v64, 0, v28, s[48:49]
    v_cndmask_b32 v65, 0, v29, s[48:49]
    v_mfma_f32_16x16x32_bf16 v[24:27], a[240:243], v[60:63], 0
    v_cndmask_b32 v66, 0, v28, s[50:51]
    v_cndmask_b32 v67, 0, v29, s[50:51]
    v_cndmask_b32 v68, 0, v28, s[52:53]
    v_cndmask_b32 v69, 0, v29, s[52:53]
    v_mfma_f32_16x16x32_bf16 v[24:27], a[244:247], v[64:67], v[24:27]
    v_cndmask_b32 v70, 0, v28, s[54:55]
    v_cndmask_b32 v71, 0, v29, s[54:55]
    v_cndmask_b32 v72, 0, v28, s[56:57]
    v_cndmask_b32 v73, 0, v29, s[56:57]
    v_mfma_f32_16x16x32_bf16 v[24:27], a[248:251], v[68:71], v[24:27]
    v_cndmask_b32 v74, 0, v28, s[58:59]
    v_cndmask_b32 v75, 0, v29, s[58:59]
    v_cndmask_b32 v76, 0, v28, s[60:61]
    v_cndmask_b32 v77, 0, v29, s[60:61]
    v_mfma_f32_16x16x32_bf16 v[24:27], v[108:111], v[72:75], v[24:27]
    v_cndmask_b32 v78, 0, v28, s[62:63]
    v_cndmask_b32 v79, 0, v29, s[62:63]
    s_nop 1
    v_mfma_f32_16x16x32_bf16 v[24:27], v[2:5], v[76:79], v[24:27]
    s_mov_b64 exec, s[64:65]
    s_nop 6
    buffer_store_dwordx4 v[24:27], v84, s[8:11], s78 offen
    s_cmp_eq_u32 s10, 0
    s_cbranch_scc1 SLOW26
BACK26:
    s_mov_b64 exec, -1
NEXT:
    s_cmp_lg_u32 s74, 0
    s_cbranch_scc1 DONE
    s_mov_b32 s74, 688128
    s_add_u32 s3, s3, 688128
    s_add_u32 s80, s80, 688128
    s_add_u32 s81, s81, 688128
    s_branch LOOP
AGAIN24:
    s_add_u32 s76, s76, 1
    s_cmp_lt_u32 s76, 32768
    s_cbranch_scc1 POLL24
    s_branch POLLX24
BR25:
    s_cmp_ge_u32 s76, 32768
    s_cbranch_scc1 BX25
BL25:
    s_mov_b64 exec, s[86:87]
    v_cmp_eq_u32 vcc, -1, v24
    s_nop 0
    s_mov_b64 exec, vcc
    s_cbranch_execz BS25_0
    buffer_load_dwordx4 v[24:27], v86, s[16:19], s77 offen sc1
BS25_0:
    s_mov_b64 exec, s[86:87]
    v_cmp_eq_u32 vcc, -1, v28
    s_nop 0
    s_mov_b64 exec, vcc
    s_cbranch_execz BS25_1
    buffer_load_dwordx4 v[28:31], v18, s[16:19], s77 offen sc1
BS25_1:
    s_mov_b64 exec, s[86:87]
    v_cmp_eq_u32 vcc, -1, v32
    s_nop 0
    s_mov_b64 exec, vcc
    s_cbranch_execz BS25_2
    buffer_load_dwordx4 v[32:35], v20, s[16:19], s77 offen sc1
BS25_2:
    s_mov_b64 exec, s[86:87]
    s_add_u32 s76, s76, 1
    s_cmp_ge_u32 s76, 32768
    s_waitcnt vmcnt(0)
    v_max3_u32 v36, v24, v28, v32
    v_cmp_eq_u32 vcc, -1, v36
    s_cbranch_vccz BW25
    s_cbranch_scc0 BL25
    s_branch BW25
DONE:
    s_endpgm
DMAF:
    v_lshrrev_b32 v38, 1, v0
    v_mul_u32_u24 v38, 3072, v38
    v_and_b32 v39, 1, v0
    v_lshl_add_u32 v38, v39, 4, v38
    s_mul_i32 s79, s68, 12
    s_add_u32 s79, s79, s69
    s_sub_u32 s79, s79, 20
    s_mul_i32 s77, s72, 491520
    s_lshl_b32 s78, s79, 5
    s_add_u32 s77, s77, s78
    s_mul_i32 s78, s72, 5120
    s_add_u32 m0, s78, 57344
    s_nop 0
    buffer_load_dwordx4 v38, s[24:27], s77 offen  lds
    s_add_u32 m0, s78, 77824
    s_nop 0
    buffer_load_dwordx4 v38, s[28:31], s77 offen  lds
    s_add_u32 s77, s77, 98304
    s_add_u32 m0, s78, 58368
    s_nop 0
    buffer_load_dwordx4 v38, s[24:27], s77 offen  lds
    s_add_u32 m0, s78, 78848
    s_nop 0
    buffer_load_dwordx4 v38, s[28:31], s77 offen  lds
    s_add_u32 s77, s77, 98304
    s_add_u32 m0, s78, 59392
    s_nop 0
    buffer_load_dwordx4 v38, s[24:27], s77 offen  lds
    s_add_u32 m0, s78, 79872
    s_nop 0
    buffer_load_dwordx4 v38, s[28:31], s77 offen  lds
    s_add_u32 s77, s77, 98304
    s_add_u32 m0, s78, 60416
    s_nop 0
    buffer_load_dwordx4 v38, s[24:27], s77 offen  lds
    s_add_u32 m0, s78, 80896
    s_nop 0
    buffer_load_dwordx4 v38, s[28:31], s77 offen  lds
    s_add_u32 s77, s77, 98304
    s_add_u32 m0, s78, 61440
    s_nop 0
    buffer_load_dwordx4 v38, s[24:27], s77 offen  lds
    s_add_u32 m0, s78, 81920
    s_nop 0
    buffer_load_dwordx4 v38, s[28:31], s77 offen  lds
    s_branch DMAX
RDYLOOP:
    s_mov_b32 s76, 0
RDYL2:
    s_sleep 24
    global_load_dword v99, v98, s[64:65] sc1
    s_waitcnt vmcnt(0)
    v_sad_u8 v100, v99, 0, 0
    s_nop 1
    v_add_u32_dpp v100, v100, v100 quad_perm:[1,0,3,2] row_mask:0xf bank_mask:0xf
    s_nop 1
    v_add_u32_dpp v100, v100, v100 quad_perm:[2,3,0,1] row_mask:0xf bank_mask:0xf
    v_cmp_gt_u32 vcc, 32, v100
    s_mov_b32 vcc_hi, 0
    s_cmp_eq_u64 vcc, 0
    s_cbranch_scc1 RDYOK
    s_add_u32 s76, s76, 1
    s_cmp_lt_u32 s76, 32768
    s_cbranch_scc1 RDYL2
    s_branch RDYOK
SLOW1:
    buffer_store_dwordx4 v[28:31], v27, s[16:19], s77 offen sc1
    s_branch BACK1
SLOW4:
    buffer_store_dword v24, v10, s[16:19], s3 offen sc1
    s_branch BACK4
SLOW6:
    buffer_store_dwordx4 v[28:31], v1, s[16:19], s77 offen sc1
    s_branch BACK6
RETRY7:
    s_mov_b32 s76, 1
POLL27:
    buffer_load_dword v28, v20, s[16:19], 0 offen sc1
    buffer_load_dword v29, v21, s[16:19], 0 offen sc1
POLLW27:
    s_waitcnt vmcnt(0)
    v_max_u32 v30, v28, v29
    v_cmp_eq_u32 vcc, -1, v30
    s_cbranch_vccnz AGAIN27
POLLX27:
    s_branch OK7
AGAIN27:
    s_add_u32 s76, s76, 1
    s_cmp_lt_u32 s76, 32768
    s_cbranch_scc1 POLL27
    s_branch POLLX27
SLOW8:
    buffer_store_dwordx4 v[28:31], v32, s[16:19], s77 offen sc1
    s_branch BACK8
SLOW10:
    buffer_store_dwordx4 v[28:31], v18, s[16:19], s81 offen sc1
    s_branch BACK10
SLOW11:
    buffer_store_dwordx4 v[52:55], v48, s[16:19], s78 offen sc1
    s_branch BACK11
SLOW12:
    buffer_store_dwordx4 v[52:55], v49, s[16:19], s78 offen sc1
    s_branch BACK12
SLOW13:
    buffer_store_dwordx4 v[52:55], v50, s[16:19], s78 offen sc1
    s_branch BACK13
SLOW15:
    buffer_store_dwordx4 v[28:31], v39, s[16:19], s97 offen sc1
    s_branch BACK15
SLOW16:
    buffer_store_dwordx2 v[34:35], v1, s[16:19], s78 offen sc1
    s_branch BACK16
SLOW17:
    buffer_store_dword v7, v10, s[16:19], s77 offen sc1
    s_branch BACK17
SLOW18:
    buffer_store_dwordx4 v[24:27], v28, s[16:19], 0 offen sc1
    s_branch BACK18
SLOW19:
    buffer_store_dwordx4 v[24:27], v29, s[16:19], 0 offen sc1
    s_branch BACK19
SLOW21:
    buffer_store_dwordx4 v[28:31], v32, s[16:19], s77 offen sc1
    s_branch BACK21
FW2:
    s_add_u32 s96, s3, 1376256
    buffer_store_dword v7, v10, s[8:11], s96 offen
    s_cmp_eq_u32 s10, 0
    s_cbranch_scc1 SLOW28
BACK28:
    s_mul_i32 s79, s68, 12
    s_add_u32 s79, s79, s69
    s_sub_u32 s79, s79, 20
    s_mul_i32 s97, s72, 5120
    s_mul_i32 s96, s79, 20480
    s_add_u32 s96, s96, s97
    s_add_u32 m0, s97, 98304
    s_nop 0
    buffer_load_dwordx4 v1, s[32:35], s96 offen nt lds
    s_add_u32 s96, s96, 1024
    s_add_u32 m0, s97, 99328
    s_nop 0
    buffer_load_dwordx4 v1, s[32:35], s96 offen nt lds
    s_add_u32 s96, s96, 1024
    s_add_u32 m0, s97, 100352
    s_nop 0
    buffer_load_dwordx4 v1, s[32:35], s96 offen nt lds
    s_add_u32 s96, s96, 1024
    s_add_u32 m0, s97, 101376
    s_nop 0
    buffer_load_dwordx4 v1, s[32:35], s96 offen nt lds
    s_add_u32 s96, s96, 1024
    s_add_u32 m0, s97, 102400
    s_nop 0
    buffer_load_dwordx4 v1, s[32:35], s96 offen nt lds
    s_sub_u32 s96, s69, 20
    s_lshl_b32 s96, s96, 2
    s_add_u32 s96, s96, s72
    s_mul_i32 s96, s96, 688
    v_add_u32 v21, s96, v1
    v_min_u32 v21, 32752, v21
    s_add_u32 s97, s3, 688128
    buffer_load_dwordx4 a[240:243], v21, s[16:19], s97 offen sc1
    s_branch FMM
SLOW26:
    buffer_store_dwordx4 v[24:27], v84, s[16:19], s78 offen sc1
    s_branch BACK26
FCS:
    s_waitcnt lgkmcnt(0)
    v_add_f32 v32, v32, v33
    v_add_f32 v34, v34, v35
    v_add_f32 v32, v32, v34
    v_add_f32 v36, v36, v37
    v_add_f32 v38, v38, v39
    v_add_f32 v36, v36, v38
    v_mov_b32 v22, v32
    v_mov_b32 v23, v36
    s_mov_b32 s4, 1
    s_waitcnt vmcnt(0)
    v_mov_b32 v24, -1
    v_mov_b32 v25, -1
    v_mov_b32 v26, -1
    v_mov_b32 v27, -1
    buffer_store_dwordx4 v[24:27], v21, s[8:11], s97 offen
    s_cmp_eq_u32 s10, 0
    s_cbranch_scc1 SLOW29
BACK29:
    s_barrier
    s_branch FPOLL
SLOW28:
    buffer_store_dword v7, v10, s[16:19], s96 offen sc1
    s_branch BACK28
SLOW29:
    buffer_store_dwordx4 v[24:27], v21, s[16:19], s97 offen sc1
    s_branch BACK29
CODE_END:
    s_endpgm
.section .rodata,"a"
.p2align 6
.amdhsa_kernel interleave_layers__sliding_block_cached__glu_gated_swiglu__decode_kernel
  .amdhsa_next_free_vgpr 512
  .amdhsa_next_free_sgpr 102
  .amdhsa_accum_offset 256
  .amdhsa_group_segment_fixed_size 0
  .amdhsa_kernarg_size 96
  .amdhsa_user_sgpr_count 2
  .amdhsa_user_sgpr_kernarg_segment_ptr 1
  .amdhsa_system_sgpr_workgroup_id_x 1
.end_amdhsa_kernel
```

```asm
; @launch grid=(256,1,1) block=(256,1,1) lds=125568
.amdgcn_target "amdgcn-amd-amdhsa--gfx950"
.text
.globl interleave_layers__sliding_block_cached__glu_gated_swiglu__decode_kernel
.p2align 8
.type interleave_layers__sliding_block_cached__glu_gated_swiglu__decode_kernel,@function
interleave_layers__sliding_block_cached__glu_gated_swiglu__decode_kernel:
    s_load_dwordx16 s[44:59], s[0:1], 0
    s_load_dwordx8 s[60:67], s[0:1], 64
    s_cmp_ge_u32 s2, 256
    s_cbranch_scc1 CODE_END
    s_memrealtime s[96:97]
    v_lshrrev_b32 v2, 6, v0
    v_and_b32 v24, 63, v0
    v_readfirstlane_b32 s72, v2
    s_and_b32 s68, s2, 7
    s_lshr_b32 s69, s2, 3
    s_lshr_b32 s70, s69, 3
    s_and_b32 s71, s69, 7
    v_lshlrev_b32 v1, 4, v24
    s_lshl_b32 s77, s70, 3
    s_add_u32 s77, s77, s68
    s_mul_i32 s73, s77, 12582912
    s_lshl_b32 s78, s71, 2
    s_add_u32 s78, s78, s72
    s_mul_i32 s78, s78, 6144
    s_add_u32 s73, s73, s78
    s_add_u32 s73, s73, 11010048
    v_add_u32 v23, 4096, v1
    s_mov_b32 s10, 402653184
    s_mov_b32 s11, 0x20000
    s_getpc_b64 s[100:101]
PCREF:
    s_sub_u32 s100, s100, PCREF-interleave_layers__sliding_block_cached__glu_gated_swiglu__decode_kernel
    s_subb_u32 s101, s101, 0
    s_lshl_b32 s78, s71, 12
    v_lshl_add_u32 v25, v0, 4, s78
    v_cmp_gt_u32 vcc, CODE_END-interleave_layers__sliding_block_cached__glu_gated_swiglu__decode_kernel-16, v25
    s_nop 0
    s_and_saveexec_b64 s[98:99], vcc
    s_cbranch_execz NOCPF
    global_load_dwordx4 a[240:243], v25, s[100:101]
NOCPF:
    s_mov_b64 exec, -1
    s_mul_i32 s79, s77, 384
    s_mov_b32 s74, 0
    s_mul_i32 s3, s68, 81920
    s_mov_b32 s75, 0
    s_lshl_b32 s77, s69, 9
    s_add_u32 s77, s77, s3
    s_add_u32 s77, s77, 32768
    v_add_u32 v20, s77, v1
    s_lshl_b32 s77, s68, 2
    s_add_u32 s77, s77, s69
    s_mul_i32 s77, s77, 320
    s_add_u32 s77, s77, 654848
    v_add_u32 v25, s77, v1
    v_cmp_le_u32 vcc, 32, v0
    s_nop 1
    v_cndmask_b32 v21, v20, v25, vcc
    v_mov_b32 v25, 2147483632
    v_cndmask_b32 v20, v20, v25, vcc
    s_cmp_lt_u32 s69, 4
    s_cselect_b32 s77, 52, 32
    v_cmp_le_u32 vcc, s77, v0
    s_nop 1
    v_cndmask_b32 v21, v21, v25, vcc
    s_mov_b32 s18, 1610612736
    s_mov_b32 s19, 0x20000
    s_waitcnt lgkmcnt(0)
    s_mov_b32 s8, s46
    s_and_b32 s9, s47, 0xffff
    s_mov_b32 s16, s66
    s_and_b32 s17, s67, 0xffff
    buffer_load_dwordx4 a[0:3], v1, s[8:11], s73 offen offset:0 nt
    buffer_load_dwordx4 a[4:7], v1, s[8:11], s73 offen offset:1024 nt
    s_or_b32 s77, s2, s72
    s_cbranch_scc1 NOTAG
    s_or_b32 s77, s96, 1
    v_mov_b32 v26, s77
    s_mov_b64 exec, 1
    global_store_dword v1, v26, s[64:65] sc1
    s_mov_b64 exec, -1
NOTAG:
    s_add_u32 s83, s73, 196608
    s_mov_b32 s12, s48
    s_and_b32 s13, s49, 0xffff
    s_mov_b32 s14, 402653184
    s_mov_b32 s15, 0x20000
    s_mov_b32 s20, s50
    s_and_b32 s21, s51, 0xffff
    s_mov_b32 s22, 7864320
    s_mov_b32 s23, 0x20000
    s_mov_b32 s36, s44
    s_and_b32 s37, s45, 0xffff
    s_mov_b32 s38, 1280
    s_mov_b32 s39, 0x20000
    s_mov_b32 s40, s62
    s_and_b32 s41, s63, 0xffff
    s_mov_b32 s42, 1280
    s_mov_b32 s43, 0x20000
    s_mov_b32 s28, s58
    s_and_b32 s29, s59, 0xffff
    s_mov_b32 s30, 1966080
    s_mov_b32 s31, 0x20000
    s_mov_b32 s32, s60
    s_and_b32 s33, s61, 0xffff
    s_mov_b32 s34, 1966080
    s_mov_b32 s35, 0x20000
    s_cmp_lt_u32 s69, 20
    s_cselect_b32 s24, s52, s56
    s_cselect_b32 s25, s53, s57
    s_cselect_b32 s26, s22, s30
    s_and_b32 s25, s25, 0xffff
    s_mov_b32 s27, 0x20000
    s_add_u32 s84, s83, 196608
    s_add_u32 s85, s84, 196608
    s_add_u32 s86, s85, 196608
    s_add_u32 s87, s86, 196608
    s_add_u32 s88, s87, 196608
    s_add_u32 s89, s88, 196608
    v_mov_b32 v0, v24
    s_mul_i32 s77, s72, 6656
    v_add_u32 v25, 0, v0
    v_mul_u32_u24 v26, 171, v25
    v_lshrrev_b32 v26, 12, v26
    v_mul_u32_u24 v27, 24, v26
    v_sub_u32 v27, v25, v27
    v_lshlrev_b32 v27, 4, v27
    v_mul_u32_u24 v25, 416, v26
    v_add3_u32 v2, v25, v27, s77
    v_mul_u32_u24 v25, 12288, v26
    v_add_u32 v40, v25, v27
    v_mul_u32_u24 v25, 3072, v26
    v_add_u32 v101, v25, v27
    v_add_u32 v25, 64, v0
    v_mul_u32_u24 v26, 171, v25
    v_lshrrev_b32 v26, 12, v26
    v_mul_u32_u24 v27, 24, v26
    v_sub_u32 v27, v25, v27
    v_lshlrev_b32 v27, 4, v27
    v_mul_u32_u24 v25, 416, v26
    v_add3_u32 v3, v25, v27, s77
    v_mul_u32_u24 v25, 12288, v26
    v_add_u32 v41, v25, v27
    v_mul_u32_u24 v25, 3072, v26
    v_add_u32 v102, v25, v27
    v_add_u32 v25, 128, v0
    v_mul_u32_u24 v26, 171, v25
    v_lshrrev_b32 v26, 12, v26
    v_mul_u32_u24 v27, 24, v26
    v_sub_u32 v27, v25, v27
    v_lshlrev_b32 v27, 4, v27
    v_mul_u32_u24 v25, 416, v26
    v_add3_u32 v4, v25, v27, s77
    v_mul_u32_u24 v25, 12288, v26
    v_add_u32 v42, v25, v27
    v_mul_u32_u24 v25, 3072, v26
    v_add_u32 v103, v25, v27
    v_and_b32 v25, 15, v0
    v_lshrrev_b32 v26, 4, v0
    v_bfe_u32 v27, v0, 2, 2
    v_and_b32 v28, 3, v0
    s_mul_i32 s78, s71, 160
    v_lshlrev_b32 v36, 4, v26
    v_lshlrev_b32 v37, 3, v26
    v_lshlrev_b32 v39, 2, v0
    buffer_load_dwordx4 v[70:73], v36, s[36:39], s78 offen
    buffer_load_dwordx4 v[74:77], v36, s[36:39], s78 offen offset:64
    buffer_load_dwordx2 v[78:79], v37, s[36:39], s78 offen offset:128
    buffer_load_dwordx4 v[80:83], v1, s[36:39], 0 offen
    buffer_load_dword v84, v39, s[36:39], 0 offen offset:1024
    s_lshl_b32 s7, s69, 6
    v_lshlrev_b32 v38, 2, v25
    buffer_load_dword v22, v38, s[36:39], s7 offen
    s_mul_i32 s78, s71, 983040
    s_add_u32 s79, s79, s78
    s_mul_i32 s78, s72, 98304
    s_add_u32 s79, s79, s78
    s_mul_i32 s78, s72, 3072
    s_add_u32 s78, s78, 26624
    s_add_u32 m0, s78, 0
    s_nop 0
    buffer_load_dwordx4 v40, s[20:23], s79 offen nt lds
    s_add_u32 m0, s78, 1024
    s_nop 0
    buffer_load_dwordx4 v41, s[20:23], s79 offen nt lds
    s_add_u32 m0, s78, 2048
    s_nop 0
    buffer_load_dwordx4 v42, s[20:23], s79 offen nt lds
    s_add_u32 s79, s79, 393216
    s_add_u32 m0, s78, 12288
    s_nop 0
    buffer_load_dwordx4 v40, s[20:23], s79 offen nt lds
    s_add_u32 m0, s78, 13312
    s_nop 0
    buffer_load_dwordx4 v41, s[20:23], s79 offen nt lds
    s_add_u32 m0, s78, 14336
    s_nop 0
    buffer_load_dwordx4 v42, s[20:23], s79 offen nt lds
    s_add_u32 s79, s79, 393216
    s_cmp_ge_u32 s72, 2
    s_cbranch_scc1 NOWQ3
    s_add_u32 m0, s78, 24576
    s_nop 0
    buffer_load_dwordx4 v40, s[20:23], s79 offen nt lds
    s_add_u32 m0, s78, 25600
    s_nop 0
    buffer_load_dwordx4 v41, s[20:23], s79 offen nt lds
    s_add_u32 m0, s78, 26624
    s_nop 0
    buffer_load_dwordx4 v42, s[20:23], s79 offen nt lds
NOWQ3:
    s_mul_i32 s78, s71, 160
    s_mov_b32 s20, s52
    s_and_b32 s21, s53, 0xffff
    s_mov_b32 s22, 7864320
    s_mov_b32 s23, 0x20000
    s_cmp_lt_u32 s72, 2
    s_cselect_b32 s36, s56, s58
    s_cselect_b32 s37, s57, s59
    s_and_b32 s37, s37, 0xffff
    s_mov_b32 s38, 1966080
    s_lshl_b32 s90, s70, 3
    s_add_u32 s90, s90, s68
    s_lshl_b32 s90, s90, 3
    s_add_u32 s90, s90, s71
    s_mul_i32 s90, s90, 30720
    s_mul_i32 s79, s72, 6144
    s_add_u32 s90, s90, s79
    s_cmp_eq_u32 s72, 3
    s_cselect_b32 s79, 3072, 0
    s_add_u32 s90, s90, s79
    s_cmp_lt_u32 s72, 2
    s_cselect_b32 s79, 1879048176, 0
    v_add_u32 v108, s79, v23
    v_add_u32 v109, 4096, v108
    s_and_b32 s91, s72, 1
    s_lshl_b32 s79, s69, 1
    s_add_u32 s91, s91, s79
    s_mul_i32 s79, s91, 0
    s_add_u32 s79, s79, 640
    s_mul_i32 s91, s91, 16
    s_cmp_lt_u32 s69, 20
    s_cselect_b32 s91, s91, s79
    s_mov_b32 s7, 49152
    s_cselect_b32 s7, s7, 0
    s_mul_i32 s91, s91, 3072
    s_mul_i32 s79, s68, 384
    s_add_u32 s91, s91, s79
    v_mov_b32 v29, 1879048176
    v_add_u32 v104, 24576, v101
    v_add_u32 v105, 24576, v102
    v_add_u32 v106, 24576, v103
    v_cmp_gt_u32 vcc, s7, v101
    s_nop 1
    v_cndmask_b32 v101, v29, v101, vcc
    v_cmp_gt_u32 vcc, s7, v102
    s_nop 1
    v_cndmask_b32 v102, v29, v102, vcc
    v_cmp_gt_u32 vcc, s7, v103
    s_nop 1
    v_cndmask_b32 v103, v29, v103, vcc
    v_cmp_gt_u32 vcc, s7, v104
    s_nop 1
    v_cndmask_b32 v104, v29, v104, vcc
    v_cmp_gt_u32 vcc, s7, v105
    s_nop 1
    v_cndmask_b32 v105, v29, v105, vcc
    v_cmp_gt_u32 vcc, s7, v106
    s_nop 1
    v_cndmask_b32 v106, v29, v106, vcc
    buffer_load_dwordx4 a[8:11], v1, s[8:11], s73 offen offset:2048 nt
    buffer_load_dwordx4 a[12:15], v1, s[8:11], s73 offen offset:3072 nt
    buffer_load_dwordx4 a[16:19], v23, s[8:11], s73 offen offset:0 nt
    v_mul_u32_u24 v29, 416, v25
    v_lshl_add_u32 v29, v26, 4, v29
    v_add_u32 v5, s77, v29
    v_lshrrev_b32 v29, 2, v0
    v_mul_u32_u24 v29, 416, v29
    v_lshl_add_u32 v29, v28, 3, v29
    v_add_u32 v6, s77, v29
    s_mul_i32 s79, s72, 96
    s_add_u32 s79, s79, 26624
    v_lshl_add_u32 v29, v26, 3, v27
    v_mul_u32_u24 v29, 384, v29
    v_lshl_add_u32 v29, v28, 3, v29
    v_add_u32 v16, s79, v29
    v_lshl_add_u32 v29, v26, 2, v27
    v_mul_u32_u24 v29, 384, v29
    v_lshl_add_u32 v29, v28, 3, v29
    v_add_u32 v17, s79, v29
    buffer_load_dwordx4 a[20:23], v23, s[8:11], s73 offen offset:1024 nt
    v_mul_u32_u24 v31, 103, v0
    v_lshrrev_b32 v31, 10, v31
    v_mul_u32_u24 v30, 10, v31
    v_sub_u32 v30, v0, v30
    v_lshl_add_u32 v29, v30, 4, s78
    v_mul_u32_u24 v8, 1280, v31
    v_add_u32 v8, 665600, v8
    s_mul_i32 s7, s68, 81920
    s_add_u32 s7, s7, 46592
    v_mov_b32 v30, s7
    v_cmp_eq_u32 vcc, s68, v31
    s_nop 1
    v_cndmask_b32 v8, v8, v30, vcc
    v_add_u32 v30, 2560, v30
    v_cmp_le_u32 vcc, 8, v31
    s_nop 1
    v_cndmask_b32 v8, v8, v30, vcc
    v_add_u32 v8, v8, v29
    v_add_u32 v31, 6, v31
    v_mul_u32_u24 v9, 1280, v31
    v_add_u32 v9, 665600, v9
    s_mul_i32 s7, s68, 81920
    s_add_u32 s7, s7, 46592
    v_mov_b32 v30, s7
    v_cmp_eq_u32 vcc, s68, v31
    s_nop 1
    v_cndmask_b32 v9, v9, v30, vcc
    v_add_u32 v30, 2560, v30
    v_cmp_le_u32 vcc, 8, v31
    s_nop 1
    v_cndmask_b32 v9, v9, v30, vcc
    v_add_u32 v9, v9, v29
    v_mov_b32 v30, 2147483632
    v_cmp_le_u32 vcc, 30, v0
    s_nop 1
    v_cndmask_b32 v9, v9, v30, vcc
    s_lshl_b32 s78, s69, 10
    s_lshl_b32 s79, s72, 8
    s_add_u32 s78, s78, s79
    v_lshl_add_u32 v10, v0, 2, s78
    s_lshl_b32 s78, s70, 13
    s_add_u32 s78, s78, s79
    v_lshlrev_b32 v29, 10, v26
    v_lshl_add_u32 v29, v25, 4, v29
    v_add_u32 v11, s78, v29
    buffer_load_dwordx4 a[24:27], v1, s[8:11], s83 offen offset:0 nt
    s_mul_i32 s78, s72, 96
    s_add_u32 s78, s78, 118784
    v_lshl_add_u32 v29, v27, 5, s78
    v_lshl_add_u32 v29, v28, 2, v29
    v_lshrrev_b32 v30, 1, v26
    v_lshl_add_u32 v29, v30, 4, v29
    v_and_b32 v30, 1, v26
    v_lshl_add_u32 v29, v30, 1, v29
    v_mov_b32 v30, 119168
    v_cmp_le_u32 vcc, 12, v25
    s_nop 1
    v_cndmask_b32 v12, v29, v30, vcc
    v_and_b32 v30, 1, v0
    v_lshlrev_b32 v29, 5, v26
    v_lshl_add_u32 v29, v30, 4, v29
    v_add_u32 v13, 118784, v29
    v_mul_u32_u24 v30, 0xaaaa, v30
    v_and_b32 v29, 1, v27
    v_mul_u32_u24 v29, 0xaaaa, v29
    v_lshl_or_b32 v29, v29, 16, v30
    v_add_u32 v14, 0x44444444, v29
    buffer_load_dwordx4 a[28:31], v1, s[8:11], s83 offen offset:1024 nt
    s_lshl_b32 s78, s72, 8
    s_add_u32 s78, s78, 124416
    v_lshrrev_b32 v29, 5, v0
    v_lshl_add_u32 v29, v29, 6, s78
    v_bfe_u32 v30, v0, 3, 1
    v_lshl_add_u32 v29, v30, 5, v29
    v_bfe_u32 v30, v0, 1, 1
    v_lshl_add_u32 v29, v30, 4, v29
    v_bfe_u32 v30, v0, 2, 1
    v_lshl_add_u32 v29, v30, 3, v29
    v_bfe_u32 v30, v0, 4, 1
    v_lshl_add_u32 v29, v30, 2, v29
    v_bfe_u32 v30, v0, 0, 1
    v_lshl_add_u32 v29, v30, 1, v29
    v_mov_b32 v19, v29
    v_bfe_u32 v29, v0, 4, 1
    v_bfe_u32 v30, v0, 2, 1
    v_lshl_add_u32 v29, v29, 5, s78
    v_lshl_add_u32 v29, v30, 4, v29
    v_accvgpr_write_b32 a252, v29
    s_mul_i32 s78, s72, 768
    s_add_u32 s78, s78, 119296
    v_lshl_add_u32 v29, v25, 2, s78
    v_bfe_u32 v30, v0, 4, 1
    v_lshl_add_u32 v29, v30, 7, v29
    v_lshrrev_b32 v30, 5, v0
    v_lshl_add_u32 v15, v30, 6, v29
    s_waitcnt vmcnt(12)
    v_lshlrev_b32 v88, 16, v80
    v_and_b32 v89, 0xffff0000, v80
    v_lshlrev_b32 v90, 16, v81
    v_and_b32 v91, 0xffff0000, v81
    v_lshlrev_b32 v92, 16, v82
    v_and_b32 v93, 0xffff0000, v82
    v_lshlrev_b32 v94, 16, v83
    v_and_b32 v95, 0xffff0000, v83
    v_lshlrev_b32 v96, 16, v84
    v_and_b32 v97, 0xffff0000, v84
    v_add_f32 v80, v88, v89
    v_add_f32 v80, v80, v90
    v_add_f32 v80, v80, v91
    v_add_f32 v80, v80, v92
    v_add_f32 v80, v80, v93
    v_add_f32 v80, v80, v94
    v_add_f32 v80, v80, v95
    v_add_f32 v80, v80, v96
    v_add_f32 v80, v80, v97
    s_nop 1
    v_add_f32_dpp v80, v80, v80 row_ror:8 row_mask:0xf bank_mask:0xf
    s_nop 1
    v_add_f32_dpp v80, v80, v80 row_ror:4 row_mask:0xf bank_mask:0xf
    s_nop 1
    v_add_f32_dpp v80, v80, v80 row_ror:2 row_mask:0xf bank_mask:0xf
    s_nop 1
    v_add_f32_dpp v80, v80, v80 row_ror:1 row_mask:0xf bank_mask:0xf
    v_mov_b32 v81, v80
    s_nop 1
    v_permlane32_swap_b32 v80, v81
    v_add_f32 v80, v80, v81
    v_mov_b32 v81, v80
    s_nop 1
    v_permlane16_swap_b32 v80, v81
    v_add_f32 v80, v80, v81
    v_mul_f32 v80, 0x3acccccd, v80
    v_sub_f32 v88, v88, v80
    v_sub_f32 v89, v89, v80
    v_sub_f32 v90, v90, v80
    v_sub_f32 v91, v91, v80
    v_sub_f32 v92, v92, v80
    v_sub_f32 v93, v93, v80
    v_sub_f32 v94, v94, v80
    v_sub_f32 v95, v95, v80
    v_sub_f32 v96, v96, v80
    v_sub_f32 v97, v97, v80
    v_mul_f32 v82, v88, v88
    v_fmac_f32 v82, v89, v89
    v_fmac_f32 v82, v90, v90
    v_fmac_f32 v82, v91, v91
    v_fmac_f32 v82, v92, v92
    v_fmac_f32 v82, v93, v93
    v_fmac_f32 v82, v94, v94
    v_fmac_f32 v82, v95, v95
    v_fmac_f32 v82, v96, v96
    v_fmac_f32 v82, v97, v97
    buffer_load_dwordx4 a[32:35], v1, s[8:11], s83 offen offset:2048 nt
    s_nop 0
    v_add_f32_dpp v82, v82, v82 row_ror:8 row_mask:0xf bank_mask:0xf
    s_nop 1
    v_add_f32_dpp v82, v82, v82 row_ror:4 row_mask:0xf bank_mask:0xf
    s_nop 1
    v_add_f32_dpp v82, v82, v82 row_ror:2 row_mask:0xf bank_mask:0xf
    s_nop 1
    v_add_f32_dpp v82, v82, v82 row_ror:1 row_mask:0xf bank_mask:0xf
    v_mov_b32 v81, v82
    s_nop 1
    v_permlane32_swap_b32 v82, v81
    v_add_f32 v82, v82, v81
    v_mov_b32 v81, v82
    s_nop 1
    v_permlane16_swap_b32 v82, v81
    v_add_f32 v82, v82, v81
    v_mul_f32 v82, 0x3acccccd, v82
    v_add_f32 v82, 0x3727c5ac, v82
    v_rsq_f32 v82, v82
    s_mov_b32 vcc_lo, 0xaaaaaaaa
    s_mov_b32 vcc_hi, 0xaaaaaaaa
    v_mov_b32 v85, 0x3f803f80
    v_lshlrev_b32 v83, 16, v70
    v_and_b32 v84, 0xffff0000, v70
    v_sub_f32 v83, v83, v80
    v_sub_f32 v84, v84, v80
    v_mul_f32 v83, v83, v82
    v_mul_f32 v84, v84, v82
    v_cvt_pk_bf16_f32 v83, v83, v84
    v_cndmask_b32 v70, v83, v85, vcc
    v_lshlrev_b32 v83, 16, v71
    v_and_b32 v84, 0xffff0000, v71
    v_sub_f32 v83, v83, v80
    v_sub_f32 v84, v84, v80
    v_mul_f32 v83, v83, v82
    v_mul_f32 v84, v84, v82
    v_cvt_pk_bf16_f32 v83, v83, v84
    v_cndmask_b32 v71, v83, v85, vcc
    v_lshlrev_b32 v83, 16, v72
    v_and_b32 v84, 0xffff0000, v72
    v_sub_f32 v83, v83, v80
    v_sub_f32 v84, v84, v80
    v_mul_f32 v83, v83, v82
    v_mul_f32 v84, v84, v82
    v_cvt_pk_bf16_f32 v83, v83, v84
    v_cndmask_b32 v72, v83, v85, vcc
    v_lshlrev_b32 v83, 16, v73
    v_and_b32 v84, 0xffff0000, v73
    v_sub_f32 v83, v83, v80
    v_sub_f32 v84, v84, v80
    v_mul_f32 v83, v83, v82
    v_mul_f32 v84, v84, v82
    v_cvt_pk_bf16_f32 v83, v83, v84
    v_cndmask_b32 v73, v83, v85, vcc
    v_lshlrev_b32 v83, 16, v74
    v_and_b32 v84, 0xffff0000, v74
    v_sub_f32 v83, v83, v80
    v_sub_f32 v84, v84, v80
    v_mul_f32 v83, v83, v82
    v_mul_f32 v84, v84, v82
    v_cvt_pk_bf16_f32 v83, v83, v84
    v_cndmask_b32 v74, v83, v85, vcc
    v_lshlrev_b32 v83, 16, v75
    v_and_b32 v84, 0xffff0000, v75
    v_sub_f32 v83, v83, v80
    v_sub_f32 v84, v84, v80
    v_mul_f32 v83, v83, v82
    v_mul_f32 v84, v84, v82
    v_cvt_pk_bf16_f32 v83, v83, v84
    v_cndmask_b32 v75, v83, v85, vcc
    buffer_load_dwordx4 a[36:39], v1, s[8:11], s83 offen offset:3072 nt
    v_lshlrev_b32 v83, 16, v76
    v_and_b32 v84, 0xffff0000, v76
    v_sub_f32 v83, v83, v80
    v_sub_f32 v84, v84, v80
    v_mul_f32 v83, v83, v82
    v_mul_f32 v84, v84, v82
    v_cvt_pk_bf16_f32 v83, v83, v84
    v_cndmask_b32 v76, v83, v85, vcc
    v_lshlrev_b32 v83, 16, v77
    v_and_b32 v84, 0xffff0000, v77
    v_sub_f32 v83, v83, v80
    v_sub_f32 v84, v84, v80
    v_mul_f32 v83, v83, v82
    v_mul_f32 v84, v84, v82
    v_cvt_pk_bf16_f32 v83, v83, v84
    v_cndmask_b32 v77, v83, v85, vcc
    v_lshlrev_b32 v83, 16, v78
    v_and_b32 v84, 0xffff0000, v78
    v_sub_f32 v83, v83, v80
    v_sub_f32 v84, v84, v80
    v_mul_f32 v83, v83, v82
    v_mul_f32 v84, v84, v82
    v_cvt_pk_bf16_f32 v83, v83, v84
    v_cndmask_b32 v78, v83, v85, vcc
    v_lshlrev_b32 v83, 16, v79
    v_and_b32 v84, 0xffff0000, v79
    v_sub_f32 v83, v83, v80
    v_sub_f32 v84, v84, v80
    v_mul_f32 v83, v83, v82
    v_mul_f32 v84, v84, v82
    v_cvt_pk_bf16_f32 v83, v83, v84
    v_cndmask_b32 v79, v83, v85, vcc
    s_waitcnt vmcnt(8)
    s_barrier
    ds_read_b64_tr_b16 v[40:41], v16 offset:0
    ds_read_b64_tr_b16 v[42:43], v16 offset:1536
    ds_read_b64_tr_b16 v[44:45], v16 offset:12288
    ds_read_b64_tr_b16 v[46:47], v16 offset:13824
    ds_read_b64_tr_b16 v[48:49], v17 offset:24576
    ds_read_b64_tr_b16 v[50:51], v16 offset:32
    ds_read_b64_tr_b16 v[52:53], v16 offset:1568
    ds_read_b64_tr_b16 v[54:55], v16 offset:12320
    ds_read_b64_tr_b16 v[56:57], v16 offset:13856
    ds_read_b64_tr_b16 v[58:59], v17 offset:24608
    ds_read_b64_tr_b16 v[60:61], v16 offset:64
    ds_read_b64_tr_b16 v[62:63], v16 offset:1600
    ds_read_b64_tr_b16 v[64:65], v16 offset:12352
    ds_read_b64_tr_b16 v[66:67], v16 offset:13888
    ds_read_b64_tr_b16 v[68:69], v17 offset:24640
    v_mov_b32 v100, 0
    s_cmp_lg_u32 s72, 0
    s_cbranch_scc1 NOTL
    s_mov_b64 exec, 1
    global_load_dword v98, v100, s[64:65] sc1
    s_mov_b64 exec, -1
NOTL:
    buffer_load_dwordx4 a[40:43], v23, s[8:11], s83 offen offset:0 nt
    buffer_load_dwordx4 a[44:47], v23, s[8:11], s83 offen offset:1024 nt
    s_mul_i32 s79, s72, 96
    s_add_u32 s79, s79, 119296
    v_min_u32 v36, 48, v0
    v_lshl_add_u32 v36, v36, 1, s79
    v_mov_b32 v37, 119808
    v_cmp_le_u32 vcc, 48, v0
    s_nop 1
    v_cndmask_b32 v36, v36, v37, vcc
    v_add_u32 v37, 119296, v1
    s_waitcnt lgkmcnt(0)
    v_mfma_f32_16x16x32_bf16 v[24:27], v[70:73], v[40:43], 0
    v_mfma_f32_16x16x32_bf16 v[28:31], v[70:73], v[50:53], 0
    v_mfma_f32_16x16x32_bf16 v[32:35], v[70:73], v[60:63], 0
    v_mfma_f32_16x16x32_bf16 v[24:27], v[74:77], v[44:47], v[24:27]
    v_mfma_f32_16x16x32_bf16 v[28:31], v[74:77], v[54:57], v[28:31]
    v_mfma_f32_16x16x32_bf16 v[32:35], v[74:77], v[64:67], v[32:35]
    v_mfma_f32_16x16x16_bf16 v[24:27], v[78:79], v[48:49], v[24:27]
    v_mfma_f32_16x16x16_bf16 v[28:31], v[78:79], v[58:59], v[28:31]
    v_mfma_f32_16x16x16_bf16 v[32:35], v[78:79], v[68:69], v[32:35]
    buffer_load_dwordx4 a[48:51], v1, s[8:11], s84 offen offset:0 nt
    s_nop 4
    v_mov_b32 v7, v25
    v_mov_b32_dpp v24, v28 quad_perm:[0,1,2,3] row_mask:0x2 bank_mask:0xf
    s_nop 0
    v_mov_b32_dpp v7, v29 quad_perm:[0,1,2,3] row_mask:0x2 bank_mask:0xf
    v_mov_b32_dpp v24, v32 quad_perm:[0,1,2,3] row_mask:0x4 bank_mask:0xf
    s_nop 0
    v_mov_b32_dpp v7, v33 quad_perm:[0,1,2,3] row_mask:0x4 bank_mask:0xf
    v_cvt_pk_bf16_f32 v24, v24, v24
    ds_write_b16 v36, v24
    buffer_load_dwordx4 a[52:55], v1, s[8:11], s84 offen offset:1024 nt
    buffer_load_dwordx4 a[56:59], v1, s[8:11], s84 offen offset:2048 nt
    s_waitcnt lgkmcnt(0)
    s_barrier
    ds_read_b128 v[28:31], v37
    s_lshl_b32 s79, s69, 9
    s_add_u32 s79, s79, s3
    s_cmp_eq_u32 s72, 0
    s_cselect_b32 exec_lo, 0xffffff, 1
    s_mov_b32 exec_hi, 0
    s_cselect_b32 s78, 0, 1879048176
    v_add_u32 v37, s78, v1
    s_waitcnt lgkmcnt(0)
    buffer_store_dwordx4 v[28:31], v37, s[16:19], s79 offen sc1
    s_mov_b64 exec, -1
    v_mov_b32 v32, -1
    v_mov_b32 v33, -1
    v_mov_b32 v34, -1
    v_mov_b32 v35, -1
    buffer_store_dwordx4 v[32:35], v21, s[16:19], 0 offen sc1
    buffer_load_dwordx4 a[60:63], v1, s[8:11], s84 offen offset:3072 nt
    s_waitcnt vmcnt(12)
    ds_write_b128 v2, a[0:3] offset:0
    ds_write_b128 v3, a[4:7] offset:0
    ds_write_b128 v4, a[8:11] offset:0
    ds_write_b128 v2, a[12:15] offset:3328
    ds_write_b128 v3, a[16:19] offset:3328
    ds_write_b128 v4, a[20:23] offset:3328
    ds_read_b128 a[0:3], v5 offset:0
    ds_read_b128 a[4:7], v5 offset:64
    ds_read_b128 a[8:11], v5 offset:128
    ds_read_b128 a[12:15], v5 offset:192
    ds_read_b128 a[16:19], v5 offset:256
    ds_read_b128 a[20:23], v5 offset:320
    buffer_load_dwordx4 a[64:67], v23, s[8:11], s84 offen offset:0 nt
    buffer_load_dwordx4 a[68:71], v23, s[8:11], s84 offen offset:1024 nt
    s_barrier
    buffer_load_dwordx4 a[72:75], v1, s[8:11], s85 offen offset:0 nt
    buffer_load_dwordx4 a[76:79], v1, s[8:11], s85 offen offset:1024 nt
    buffer_load_dwordx4 a[80:83], v1, s[8:11], s85 offen offset:2048 nt
    buffer_load_dwordx4 a[84:87], v1, s[8:11], s85 offen offset:3072 nt
    buffer_load_dwordx4 a[88:91], v23, s[8:11], s85 offen offset:0 nt
    buffer_load_dwordx4 a[92:95], v23, s[8:11], s85 offen offset:1024 nt
    s_barrier
    s_getreg_b32 s5, hwreg(HW_REG_XCC_ID, 0, 4)
    s_cmp_lg_u32 s72, 0
    s_cbranch_scc1 NOHDR
    s_waitcnt vmcnt(9)
    v_readfirstlane_b32 s96, v98
    s_nop 0
    s_cmp_eq_u32 s96, 0
    s_cbranch_scc1 TAGLOOP
TAGOK:
    v_mov_b32 v99, s5
    s_mov_b64 exec, 1
    buffer_store_dwordx2 v[98:99], v1, s[16:19], s79 offen offset:384 sc1
    s_mov_b64 exec, -1
NOHDR:
    s_waitcnt vmcnt(14)
    ds_write_b128 v2, a[24:27] offset:0
    ds_write_b128 v3, a[28:31] offset:0
    ds_write_b128 v4, a[32:35] offset:0
    ds_write_b128 v2, a[36:39] offset:3328
    ds_write_b128 v3, a[40:43] offset:3328
    ds_write_b128 v4, a[44:47] offset:3328
    ds_read_b128 a[24:27], v5 offset:0
    ds_read_b128 a[28:31], v5 offset:64
    ds_read_b128 a[32:35], v5 offset:128
    ds_read_b128 a[36:39], v5 offset:192
    ds_read_b128 a[40:43], v5 offset:256
    ds_read_b128 a[44:47], v5 offset:320
    buffer_load_dwordx4 a[240:243], v101, s[36:39], s91 offen
    buffer_load_dwordx4 a[240:243], v102, s[36:39], s91 offen
    buffer_load_dwordx4 a[240:243], v103, s[36:39], s91 offen
    buffer_load_dwordx4 a[240:243], v104, s[36:39], s91 offen
    buffer_load_dwordx4 a[240:243], v105, s[36:39], s91 offen
    buffer_load_dwordx4 a[240:243], v106, s[36:39], s91 offen
    s_barrier
    s_waitcnt vmcnt(12)
    ds_write_b128 v2, a[48:51] offset:0
    ds_write_b128 v3, a[52:55] offset:0
    ds_write_b128 v4, a[56:59] offset:0
    ds_write_b128 v2, a[60:63] offset:3328
    ds_write_b128 v3, a[64:67] offset:3328
    ds_write_b128 v4, a[68:71] offset:3328
    ds_read_b128 a[48:51], v5 offset:0
    ds_read_b128 a[52:55], v5 offset:64
    ds_read_b128 a[56:59], v5 offset:128
    ds_read_b128 a[60:63], v5 offset:192
    ds_read_b128 a[64:67], v5 offset:256
    ds_read_b128 a[68:71], v5 offset:320
    v_lshlrev_b32 v100, 9, v0
    v_add_u32 v100, s3, v100
    v_bfe_u32 v96, v0, 2, 3
    v_mul_u32_u24 v96, 81920, v96
    v_and_b32 v97, 3, v0
    v_lshl_add_u32 v96, v97, 9, v96
    v_cmp_le_u32 vcc, 32, v0
    s_nop 1
    v_cndmask_b32 v100, v100, v96, vcc
    s_cmp_eq_u32 s72, 0
    s_cselect_b32 s77, 0, 1879048176
    v_add_u32 v100, s77, v100
    buffer_load_dwordx4 a[96:99], v1, s[8:11], s86 offen offset:0 nt
    buffer_load_dwordx4 a[100:103], v1, s[8:11], s86 offen offset:1024 nt
    buffer_load_dwordx4 a[104:107], v1, s[8:11], s86 offen offset:2048 nt
    buffer_load_dwordx4 a[108:111], v1, s[8:11], s86 offen offset:3072 nt
    buffer_load_dwordx4 a[112:115], v23, s[8:11], s86 offen offset:0 nt
    buffer_load_dwordx4 a[116:119], v23, s[8:11], s86 offen offset:1024 nt
    s_barrier
    buffer_load_dwordx4 a[120:123], v1, s[8:11], s87 offen offset:0 nt
    buffer_load_dwordx4 a[124:127], v1, s[8:11], s87 offen offset:1024 nt
    buffer_load_dwordx4 a[128:131], v1, s[8:11], s87 offen offset:2048 nt
    buffer_load_dwordx4 a[132:135], v1, s[8:11], s87 offen offset:3072 nt
    buffer_load_dwordx4 a[136:139], v23, s[8:11], s87 offen offset:0 nt
    buffer_load_dwordx4 a[140:143], v23, s[8:11], s87 offen offset:1024 nt
    s_barrier
    s_waitcnt vmcnt(18)
    ds_write_b128 v2, a[72:75] offset:0
    ds_write_b128 v3, a[76:79] offset:0
    ds_write_b128 v4, a[80:83] offset:0
    ds_write_b128 v2, a[84:87] offset:3328
    ds_write_b128 v3, a[88:91] offset:3328
    ds_write_b128 v4, a[92:95] offset:3328
    ds_read_b128 a[72:75], v5 offset:0
    ds_read_b128 a[76:79], v5 offset:64
    ds_read_b128 a[80:83], v5 offset:128
    ds_read_b128 a[84:87], v5 offset:192
    ds_read_b128 a[88:91], v5 offset:256
    ds_read_b128 a[92:95], v5 offset:320
    buffer_load_dwordx4 a[144:147], v1, s[8:11], s88 offen offset:0 nt
    buffer_load_dwordx4 a[148:151], v1, s[8:11], s88 offen offset:1024 nt
    buffer_load_dwordx4 a[152:155], v1, s[8:11], s88 offen offset:2048 nt
    buffer_load_dwordx4 a[156:159], v1, s[8:11], s88 offen offset:3072 nt
    buffer_load_dwordx4 a[160:163], v23, s[8:11], s88 offen offset:0 nt
    buffer_load_dwordx4 a[164:167], v23, s[8:11], s88 offen offset:1024 nt
    s_barrier
    s_waitcnt vmcnt(12)
    ds_write_b128 v2, a[96:99] offset:0
    ds_write_b128 v3, a[100:103] offset:0
    ds_write_b128 v4, a[104:107] offset:0
    ds_write_b128 v2, a[108:111] offset:3328
    ds_write_b128 v3, a[112:115] offset:3328
    ds_write_b128 v4, a[116:119] offset:3328
    ds_read_b128 a[96:99], v5 offset:0
    ds_read_b128 a[100:103], v5 offset:64
    ds_read_b128 a[104:107], v5 offset:128
    ds_read_b128 a[108:111], v5 offset:192
    ds_read_b128 a[112:115], v5 offset:256
    ds_read_b128 a[116:119], v5 offset:320
    buffer_load_dwordx4 a[168:171], v1, s[8:11], s89 offen offset:0 nt
    buffer_load_dwordx4 a[172:175], v1, s[8:11], s89 offen offset:1024 nt
    buffer_load_dwordx4 a[176:179], v1, s[8:11], s89 offen offset:2048 nt
    buffer_load_dwordx4 a[180:183], v1, s[8:11], s89 offen offset:3072 nt
    buffer_load_dwordx4 a[184:187], v23, s[8:11], s89 offen offset:0 nt
    buffer_load_dwordx4 a[188:191], v23, s[8:11], s89 offen offset:1024 nt
    s_barrier
    s_cmp_ge_u32 s69, 20
    s_cbranch_scc1 DMAF
    s_lshl_b32 s66, s72, 3
    s_add_u32 s66, s66, s68
    s_mul_i32 s66, s66, 245760
    s_lshl_b32 s78, s69, 6
    s_add_u32 s66, s66, s78
    s_mul_i32 s67, s72, 12288
    s_add_u32 s67, s67, 57344
    v_lshrrev_b32 v38, 2, v0
    v_mul_u32_u24 v38, 1280, v38
    v_and_b32 v39, 3, v0
    v_lshl_add_u32 v39, v39, 4, v38
    s_mov_b32 m0, s67
    s_add_u32 s67, s67, 1024
    buffer_load_dwordx4 v39, s[24:27], s66 offen  lds
    s_add_u32 s66, s66, 20480
    s_mov_b32 m0, s67
    s_add_u32 s67, s67, 1024
    buffer_load_dwordx4 v39, s[24:27], s66 offen  lds
    s_add_u32 s66, s66, 20480
DMAX:
    v_mov_b32 v109, v20
    v_and_b32 v25, 15, v0
    v_lshrrev_b32 v26, 4, v0
    v_add_u32 v27, 4, v26
    v_mul_u32_u24 v20, 1280, v26
    v_add_u32 v20, 665600, v20
    s_mul_i32 s7, s68, 81920
    s_add_u32 s7, s7, 46592
    v_mov_b32 v28, s7
    v_cmp_eq_u32 vcc, s68, v26
    s_nop 1
    v_cndmask_b32 v20, v20, v28, vcc
    v_mul_u32_u24 v21, 1280, v27
    v_add_u32 v21, 665600, v21
    s_mul_i32 s7, s68, 81920
    s_add_u32 s7, s7, 46592
    v_mov_b32 v28, s7
    v_cmp_eq_u32 vcc, s68, v27
    s_nop 1
    v_cndmask_b32 v21, v21, v28, vcc
    s_min_u32 s7, s69, 19
    s_lshl_b32 s7, s7, 6
    v_lshl_add_u32 v25, v25, 2, s7
    v_add_u32 v20, v20, v25
    v_add_u32 v21, v21, v25
    buffer_load_dwordx4 a[216:219], v1, s[12:15], s73 offen offset:0 nt
    v_and_b32 v25, 15, v0
    v_bfe_u32 v27, v0, 2, 2
    v_and_b32 v28, 3, v0
    s_mul_i32 s7, s72, 12288
    s_add_u32 s7, s7, 57344
    v_lshl_add_u32 v29, v26, 3, v27
    v_lshlrev_b32 v29, 6, v29
    v_lshl_add_u32 v29, v28, 3, v29
    v_add_u32 v29, s7, v29
    v_accvgpr_write_b32 a246, v29
    s_mul_i32 s7, s72, 3072
    s_add_u32 s7, s7, 32768
    v_lshl_add_u32 v29, v25, 4, s7
    v_lshl_add_u32 v29, v26, 7, v29
    v_accvgpr_write_b32 a247, v29
    s_lshl_b32 s7, s72, 6
    s_add_u32 s7, s7, 45056
    v_and_b32 v29, 1, v26
    v_lshl_add_u32 v29, v29, 5, s7
    v_accvgpr_write_b32 a248, v29
    s_lshl_b32 s7, s72, 8
    s_add_u32 s7, s7, 122368
    v_lshl_add_u32 v29, v0, 2, s7
    v_accvgpr_write_b32 a249, v29
    s_lshl_b32 s81, s69, 6
    s_mul_i32 s80, s68, 1280
    s_add_u32 s80, s80, s81
    s_add_u32 s80, s80, 655360
    s_add_u32 s81, s81, s3
    s_add_u32 s81, s81, 45312
    s_waitcnt vmcnt(13)
    ds_write_b128 v2, a[120:123] offset:0
    ds_write_b128 v3, a[124:127] offset:0
    ds_write_b128 v4, a[128:131] offset:0
    ds_write_b128 v2, a[132:135] offset:3328
    ds_write_b128 v3, a[136:139] offset:3328
    ds_write_b128 v4, a[140:143] offset:3328
    ds_read_b128 a[120:123], v5 offset:0
    ds_read_b128 a[124:127], v5 offset:64
    ds_read_b128 a[128:131], v5 offset:128
    ds_read_b128 a[132:135], v5 offset:192
    ds_read_b128 a[136:139], v5 offset:256
    ds_read_b128 a[140:143], v5 offset:320
    buffer_load_dwordx4 a[220:223], v1, s[12:15], s73 offen offset:1024 nt
    buffer_load_dwordx4 a[224:227], v1, s[12:15], s73 offen offset:2048 nt
    buffer_load_dwordx4 a[228:231], v1, s[12:15], s73 offen offset:3072 nt
    buffer_load_dwordx4 a[232:235], v23, s[12:15], s73 offen offset:0 nt
    buffer_load_dwordx4 a[236:239], v23, s[12:15], s73 offen offset:1024 nt
    s_barrier
    buffer_load_dwordx2 v[98:99], v100, s[16:19], 0 offen offset:384 sc1
    s_waitcnt vmcnt(13)
    ds_write_b128 v2, a[144:147] offset:0
    ds_write_b128 v3, a[148:151] offset:0
    ds_write_b128 v4, a[152:155] offset:0
    ds_write_b128 v2, a[156:159] offset:3328
    ds_write_b128 v3, a[160:163] offset:3328
    ds_write_b128 v4, a[164:167] offset:3328
    ds_read_b128 a[144:147], v5 offset:0
    ds_read_b128 a[148:151], v5 offset:64
    ds_read_b128 a[152:155], v5 offset:128
    ds_read_b128 a[156:159], v5 offset:192
    ds_read_b128 a[160:163], v5 offset:256
    ds_read_b128 a[164:167], v5 offset:320
    buffer_load_dwordx4 v[112:115], v1, s[12:15], s83 offen offset:0 nt
    buffer_load_dwordx4 v[116:119], v1, s[12:15], s83 offen offset:1024 nt
    buffer_load_dwordx4 v[120:123], v1, s[12:15], s83 offen offset:2048 nt
    buffer_load_dwordx4 v[124:127], v1, s[12:15], s83 offen offset:3072 nt
    buffer_load_dwordx4 v[128:131], v23, s[12:15], s83 offen offset:0 nt
    buffer_load_dwordx4 v[132:135], v23, s[12:15], s83 offen offset:1024 nt
    s_barrier
    s_waitcnt vmcnt(13)
    ds_write_b128 v2, a[168:171] offset:0
    ds_write_b128 v3, a[172:175] offset:0
    ds_write_b128 v4, a[176:179] offset:0
    ds_write_b128 v2, a[180:183] offset:3328
    ds_write_b128 v3, a[184:187] offset:3328
    ds_write_b128 v4, a[188:191] offset:3328
    ds_read_b128 a[168:171], v5 offset:0
    ds_read_b128 a[172:175], v5 offset:64
    ds_read_b128 a[176:179], v5 offset:128
    ds_read_b128 a[180:183], v5 offset:192
    ds_read_b128 a[184:187], v5 offset:256
    ds_read_b128 a[188:191], v5 offset:320
    buffer_load_dwordx4 v[136:139], v1, s[12:15], s84 offen offset:0 nt
    buffer_load_dwordx4 v[140:143], v1, s[12:15], s84 offen offset:1024 nt
    buffer_load_dwordx4 v[144:147], v1, s[12:15], s84 offen offset:2048 nt
    buffer_load_dwordx4 v[148:151], v1, s[12:15], s84 offen offset:3072 nt
    buffer_load_dwordx4 v[152:155], v23, s[12:15], s84 offen offset:0 nt
    buffer_load_dwordx4 v[156:159], v23, s[12:15], s84 offen offset:1024 nt
    s_barrier
    s_waitcnt vmcnt(12)
    s_mov_b32 s76, -1
    v_mov_b32 v97, 125504
    s_cmp_lg_u32 s72, 0
    s_cbranch_scc1 RDYX
    v_cmp_ne_u32 vcc, s96, v98
    s_cbranch_vccnz RDYLOOP
RDYOK:
    v_cmp_ne_u32 vcc, s5, v99
    s_nop 1
    v_mov_b32 v96, vcc_lo
    ds_write_b32 v97, v96
RDYX:
    buffer_load_dwordx4 v[160:163], v1, s[12:15], s85 offen offset:0 nt
    buffer_load_dwordx4 v[164:167], v1, s[12:15], s85 offen offset:1024 nt
    s_waitcnt lgkmcnt(0)
    s_barrier
    ds_read_b32 v96, v97
    s_waitcnt lgkmcnt(0)
    v_readfirstlane_b32 s77, v96
    s_nop 0
    s_cmp_eq_u32 s77, 0
    s_cselect_b32 s10, s18, 0
    s_mov_b32 s8, s16
    s_mov_b32 s9, s17
    s_mov_b32 s11, 0x20000
    buffer_load_dwordx4 a[240:243], v109, s[16:19], 0 offen sc1
    v_lshrrev_b32 v106, 3, v0
    v_mul_u32_u24 v106, 2560, v106
    v_and_b32 v107, 7, v0
    v_lshl_add_u32 v106, v107, 4, v106
    s_lshl_b32 s77, s69, 7
    s_add_u32 s77, s77, s3
    s_add_u32 s77, s77, 51200
    s_cmp_lt_u32 s69, 20
    s_cselect_b32 s77, s77, 1879048176
    s_cmp_eq_u32 s72, 3
    s_cselect_b32 s77, s77, 1879048176
    v_add_u32 v106, s77, v106
    v_add_u32 v107, 20480, v106
    v_mov_b32 v108, 2147483632
    v_cmp_le_u32 vcc, 32, v0
    s_lshl_b32 s78, s69, 6
    s_sub_u32 s78, s77, s78
    s_sub_u32 s78, s78, 2560
    v_add_u32 v24, s78, v1
    v_cndmask_b32 v107, v107, v24, vcc
    v_cmp_le_u32 vcc, 36, v0
    s_nop 1
    v_cndmask_b32 v107, v107, v108, vcc
    buffer_load_dwordx4 a[240:243], v106, s[16:19], 0 offen sc1
    v_accvgpr_write_b32 a250, v106
    buffer_load_dwordx4 a[240:243], v107, s[16:19], 0 offen sc1
    v_accvgpr_write_b32 a251, v107
    s_lshl_b32 s77, s70, 12
    s_mul_i32 s78, s72, 96
    s_add_u32 s77, s77, s78
    s_add_u32 s77, s77, s3
    v_lshrrev_b32 v24, 4, v0
    v_lshlrev_b32 v24, 9, v24
    v_and_b32 v25, 15, v0
    v_min_u32 v25, 11, v25
    v_lshl_add_u32 v24, v25, 3, v24
    buffer_load_dwordx2 v[64:65], v24, s[16:19], s77 offen offset:0 sc1
    buffer_load_dwordx2 v[66:67], v24, s[16:19], s77 offen offset:2048 sc1
    s_cmp_lg_u32 s72, 1
    s_cbranch_scc1 NOBASE0
    s_cmp_ge_u32 s69, 20
    s_cbranch_scc1 NOBASE0
    v_mov_b32 v28, v22
    s_lshl_b32 s77, s69, 6
    s_add_u32 s77, s77, s3
    s_add_u32 s77, s77, 47872
    v_lshlrev_b32 v27, 2, v0
    v_mov_b32_dpp v29, v28 quad_perm:[1,1,1,1] row_mask:0xf bank_mask:0xf
    v_mov_b32_dpp v30, v28 quad_perm:[2,2,2,2] row_mask:0xf bank_mask:0xf
    v_mov_b32_dpp v31, v28 quad_perm:[3,3,3,3] row_mask:0xf bank_mask:0xf
    s_mov_b32 exec_lo, 0x1111
    s_mov_b32 exec_hi, 0x0
    buffer_store_dwordx4 v[28:31], v27, s[8:11], s77 offen
    s_cmp_eq_u32 s10, 0
    s_cbranch_scc1 SLOW1
BACK1:
    s_mov_b64 exec, -1
NOBASE0:
    ds_write_b128 v2, a[216:219] offset:0
    ds_write_b128 v3, a[220:223] offset:0
    ds_write_b128 v4, a[224:227] offset:0
    ds_write_b128 v2, a[228:231] offset:3328
    ds_write_b128 v3, a[232:235] offset:3328
    ds_write_b128 v4, a[236:239] offset:3328
    ds_read_b64_tr_b16 a[192:193], v6 offset:0
    ds_read_b64_tr_b16 a[196:197], v6 offset:32
    ds_read_b64_tr_b16 a[200:201], v6 offset:64
    ds_read_b64_tr_b16 a[204:205], v6 offset:96
    ds_read_b64_tr_b16 a[208:209], v6 offset:128
    ds_read_b64_tr_b16 a[212:213], v6 offset:160
    ds_read_b64_tr_b16 a[216:217], v6 offset:192
    ds_read_b64_tr_b16 a[220:221], v6 offset:224
    ds_read_b64_tr_b16 a[224:225], v6 offset:256
    ds_read_b64_tr_b16 a[228:229], v6 offset:288
    ds_read_b64_tr_b16 a[232:233], v6 offset:320
    ds_read_b64_tr_b16 a[236:237], v6 offset:352
    s_waitcnt vmcnt(13)
    ds_write_b128 v2, v[112:115] offset:0
    ds_write_b128 v3, v[116:119] offset:0
    ds_write_b128 v4, v[120:123] offset:0
    ds_write_b128 v2, v[124:127] offset:3328
    ds_write_b128 v3, v[128:131] offset:3328
    ds_write_b128 v4, v[132:135] offset:3328
    ds_read_b64_tr_b16 a[194:195], v6 offset:0
    ds_read_b64_tr_b16 a[198:199], v6 offset:32
    ds_read_b64_tr_b16 a[202:203], v6 offset:64
    ds_read_b64_tr_b16 a[206:207], v6 offset:96
    ds_read_b64_tr_b16 a[210:211], v6 offset:128
    ds_read_b64_tr_b16 a[214:215], v6 offset:160
    ds_read_b64_tr_b16 a[218:219], v6 offset:192
    ds_read_b64_tr_b16 a[222:223], v6 offset:224
    ds_read_b64_tr_b16 a[226:227], v6 offset:256
    ds_read_b64_tr_b16 a[230:231], v6 offset:288
    ds_read_b64_tr_b16 a[234:235], v6 offset:320
    ds_read_b64_tr_b16 a[238:239], v6 offset:352
    buffer_load_dwordx4 v[168:171], v1, s[12:15], s85 offen offset:2048 nt
    buffer_load_dwordx4 v[172:175], v1, s[12:15], s85 offen offset:3072 nt
    buffer_load_dwordx4 v[176:179], v23, s[12:15], s85 offen offset:0 nt
    buffer_load_dwordx4 v[180:183], v23, s[12:15], s85 offen offset:1024 nt
    s_barrier
    buffer_load_dwordx4 v[184:187], v1, s[12:15], s86 offen offset:0 nt
    s_waitcnt vmcnt(12)
    ds_write_b128 v2, v[136:139] offset:0
    ds_write_b128 v3, v[140:143] offset:0
    ds_write_b128 v4, v[144:147] offset:0
    ds_write_b128 v2, v[148:151] offset:3328
    ds_write_b128 v3, v[152:155] offset:3328
    ds_write_b128 v4, v[156:159] offset:3328
    ds_read_b64_tr_b16 v[112:113], v6 offset:0
    ds_read_b64_tr_b16 v[116:117], v6 offset:32
    ds_read_b64_tr_b16 v[120:121], v6 offset:64
    ds_read_b64_tr_b16 v[124:125], v6 offset:96
    ds_read_b64_tr_b16 v[128:129], v6 offset:128
    ds_read_b64_tr_b16 v[132:133], v6 offset:160
    ds_read_b64_tr_b16 v[136:137], v6 offset:192
    ds_read_b64_tr_b16 v[140:141], v6 offset:224
    ds_read_b64_tr_b16 v[144:145], v6 offset:256
    ds_read_b64_tr_b16 v[148:149], v6 offset:288
    ds_read_b64_tr_b16 v[152:153], v6 offset:320
    ds_read_b64_tr_b16 v[156:157], v6 offset:352
    buffer_load_dwordx4 v[188:191], v1, s[12:15], s86 offen offset:1024 nt
    buffer_load_dwordx4 v[192:195], v1, s[12:15], s86 offen offset:2048 nt
    buffer_load_dwordx4 v[196:199], v1, s[12:15], s86 offen offset:3072 nt
    buffer_load_dwordx4 v[200:203], v23, s[12:15], s86 offen offset:0 nt
    buffer_load_dwordx4 v[204:207], v23, s[12:15], s86 offen offset:1024 nt
    s_barrier
    buffer_load_dwordx4 v[208:211], v1, s[12:15], s87 offen offset:0 nt
    buffer_load_dwordx4 v[212:215], v1, s[12:15], s87 offen offset:1024 nt
    s_waitcnt vmcnt(12)
    v_lshlrev_b32 v24, 16, v64
    v_and_b32 v25, 0xffff0000, v64
    v_lshlrev_b32 v26, 16, v65
    v_and_b32 v27, 0xffff0000, v65
    v_lshlrev_b32 v28, 16, v66
    v_and_b32 v29, 0xffff0000, v66
    v_lshlrev_b32 v30, 16, v67
    v_and_b32 v31, 0xffff0000, v67
    v_add_f32 v24, v24, v28
    v_add_f32 v25, v25, v29
    v_add_f32 v26, v26, v30
    v_add_f32 v27, v27, v31
    s_nop 0
    v_permlane32_swap_b32 v24, v26
    v_permlane32_swap_b32 v25, v27
    v_add_f32 v24, v24, v26
    v_add_f32 v25, v25, v27
    s_nop 1
    v_permlane16_swap_b32 v24, v25
    v_add_f32 v24, v24, v25
    v_cvt_pk_bf16_f32 v24, v24, v24
    ds_write_b16 v12, v24
    buffer_load_dwordx4 v[216:219], v1, s[12:15], s87 offen offset:2048 nt
    v_mov_b32 v40, 0
    v_mov_b32 v41, 0
    v_mov_b32 v44, 0
    v_mov_b32 v45, 0
    v_mov_b32 v48, 0
    v_mov_b32 v49, 0
    v_mov_b32 v52, 0
    v_mov_b32 v53, 0
    v_mov_b32 v56, 0
    v_mov_b32 v57, 0
    v_mov_b32 v60, 0
    v_mov_b32 v61, 0
    v_mov_b32 v64, 0
    v_mov_b32 v65, 0
    v_mov_b32 v68, 0
    v_mov_b32 v69, 0
    v_mov_b32 v72, 0
    v_mov_b32 v73, 0
    v_mov_b32 v74, 0
    v_mov_b32 v75, 0
    v_mov_b32 v76, 0
    v_mov_b32 v77, 0
    v_mov_b32 v78, 0
    v_mov_b32 v79, 0
    v_mov_b32 v80, 0
    v_mov_b32 v81, 0
    v_mov_b32 v82, 0
    v_mov_b32 v83, 0
    v_mov_b32 v84, 0
    v_mov_b32 v85, 0
    v_mov_b32 v86, 0
    v_mov_b32 v87, 0
    buffer_load_dwordx4 v[220:223], v1, s[12:15], s87 offen offset:3072 nt
    buffer_load_dwordx4 v[224:227], v23, s[12:15], s87 offen offset:0 nt
    s_waitcnt lgkmcnt(0)
    s_barrier
    ds_read_b128 v[28:31], v13 offset:0
    ds_read_b128 v[32:35], v13 offset:128
    ds_read_b128 v[36:39], v13 offset:256
    v_mov_b32 v18, 0x3dd53b94
    s_waitcnt lgkmcnt(2)
    v_smfmac_f32_16x16x64_bf16 v[40:43], v[28:31], a[0:7], v14
    v_smfmac_f32_16x16x64_bf16 v[44:47], v[28:31], a[24:31], v14
    v_smfmac_f32_16x16x64_bf16 v[48:51], v[28:31], a[48:55], v14
    v_smfmac_f32_16x16x64_bf16 v[52:55], v[28:31], a[72:79], v14
    v_smfmac_f32_16x16x64_bf16 v[56:59], v[28:31], a[96:103], v14
    v_smfmac_f32_16x16x64_bf16 v[60:63], v[28:31], a[120:127], v14
    v_smfmac_f32_16x16x64_bf16 v[64:67], v[28:31], a[144:151], v14
    v_smfmac_f32_16x16x64_bf16 v[68:71], v[28:31], a[168:175], v14
    buffer_load_dwordx4 v[228:231], v23, s[12:15], s87 offen offset:1024 nt
    s_barrier
    s_waitcnt lgkmcnt(1)
    v_smfmac_f32_16x16x64_bf16 v[40:43], v[32:35], a[8:15], v14
    v_smfmac_f32_16x16x64_bf16 v[44:47], v[32:35], a[32:39], v14
    v_smfmac_f32_16x16x64_bf16 v[48:51], v[32:35], a[56:63], v14
    v_smfmac_f32_16x16x64_bf16 v[52:55], v[32:35], a[80:87], v14
    v_smfmac_f32_16x16x64_bf16 v[56:59], v[32:35], a[104:111], v14
    v_smfmac_f32_16x16x64_bf16 v[60:63], v[32:35], a[128:135], v14
    v_smfmac_f32_16x16x64_bf16 v[64:67], v[32:35], a[152:159], v14
    v_smfmac_f32_16x16x64_bf16 v[68:71], v[32:35], a[176:183], v14
    s_waitcnt lgkmcnt(0)
    v_smfmac_f32_16x16x64_bf16 v[40:43], v[36:39], a[16:23], v14
    v_smfmac_f32_16x16x64_bf16 v[44:47], v[36:39], a[40:47], v14
    v_smfmac_f32_16x16x64_bf16 v[48:51], v[36:39], a[64:71], v14
    v_smfmac_f32_16x16x64_bf16 v[52:55], v[36:39], a[88:95], v14
    v_smfmac_f32_16x16x64_bf16 v[56:59], v[36:39], a[112:119], v14
    v_smfmac_f32_16x16x64_bf16 v[60:63], v[36:39], a[136:143], v14
    v_smfmac_f32_16x16x64_bf16 v[64:67], v[36:39], a[160:167], v14
    v_smfmac_f32_16x16x64_bf16 v[68:71], v[36:39], a[184:191], v14
    buffer_load_dwordx4 v[232:235], v1, s[12:15], s88 offen offset:0 nt
    v_add_f32 v24, v40, v41
    v_add_f32 v44, v44, v45
    v_add_f32 v48, v48, v49
    v_max3_f32 v26, v24, v44, v48
    v_add_f32 v52, v52, v53
    v_add_f32 v25, v56, v57
    v_max3_f32 v26, v26, v52, v25
    v_add_f32 v60, v60, v61
    v_add_f32 v64, v64, v65
    v_max3_f32 v26, v26, v60, v64
    v_add_f32 v68, v68, v69
    v_max_f32 v26, v26, v68
    v_mov_b32_dpp v24, v44 quad_perm:[0,1,2,3] row_mask:0x2 bank_mask:0xf
    v_mov_b32_dpp v25, v60 quad_perm:[0,1,2,3] row_mask:0x2 bank_mask:0xf
    v_max_f32_dpp v26, v26, v26 row_ror:8 row_mask:0xf bank_mask:0xf
    v_mov_b32_dpp v24, v48 quad_perm:[0,1,2,3] row_mask:0x4 bank_mask:0xf
    v_mov_b32_dpp v25, v64 quad_perm:[0,1,2,3] row_mask:0x4 bank_mask:0xf
    v_max_f32_dpp v26, v26, v26 row_ror:4 row_mask:0xf bank_mask:0xf
    v_mov_b32_dpp v24, v52 quad_perm:[0,1,2,3] row_mask:0x8 bank_mask:0xf
    v_mov_b32_dpp v25, v68 quad_perm:[0,1,2,3] row_mask:0x8 bank_mask:0xf
    v_max_f32_dpp v26, v26, v26 row_ror:2 row_mask:0xf bank_mask:0xf
    v_accvgpr_read_b32 v27, a252
    s_nop 0
    v_max_f32_dpp v26, v26, v26 row_ror:1 row_mask:0xf bank_mask:0xf
    buffer_load_dwordx4 v[236:239], v1, s[12:15], s88 offen offset:1024 nt
    v_mul_f32 v26, v26, v18
    v_fma_f32 v24, v24, v18, -v26
    v_fma_f32 v25, v25, v18, -v26
    v_exp_f32 v24, v24
    v_exp_f32 v25, v25
    s_nop 0
    v_cvt_pk_bf16_f32 v28, v24, v25
    ds_write_b16 v19, v28
    ds_write_b16_d16_hi v19, v28 offset:128
    s_mov_b32 exec_lo, 0xff00ff
    s_mov_b32 exec_hi, 0xff00ff00
    ds_read_b128 v[72:75], v27 offset:0
    ds_read_b128 v[76:79], v27 offset:64
    ds_read_b128 v[80:83], v27 offset:128
    ds_read_b128 v[84:87], v27 offset:192
    s_mov_b64 exec, -1
    v_add_f32 v27, v24, v25
    v_mov_b32 v40, 0
    v_mov_b32 v44, 0
    v_add_f32_dpp v27, v27, v27 row_ror:8 row_mask:0xf bank_mask:0xf
    v_mov_b32 v48, 0
    v_mov_b32 v52, 0
    v_add_f32_dpp v27, v27, v27 row_ror:4 row_mask:0xf bank_mask:0xf
    v_mov_b32 v56, 0
    v_mov_b32 v60, 0
    v_add_f32_dpp v27, v27, v27 row_ror:2 row_mask:0xf bank_mask:0xf
    s_lshl_b32 s78, s72, 3
    s_add_u32 s78, s78, 125440
    v_add_f32_dpp v27, v27, v27 row_ror:1 row_mask:0xf bank_mask:0xf
    v_mov_b32 v28, v27
    s_nop 1
    v_permlane32_swap_b32 v27, v28
    v_add_f32 v27, v27, v28
    v_mov_b32 v28, v27
    s_nop 1
    v_permlane16_swap_b32 v27, v28
    v_add_f32 v27, v27, v28
    v_mov_b32 v28, s78
    ds_write_b64 v28, v[26:27]
    s_waitcnt vmcnt(14)
    ds_write_b128 v2, v[160:163] offset:0
    ds_write_b128 v3, v[164:167] offset:0
    ds_write_b128 v4, v[168:171] offset:0
    ds_write_b128 v2, v[172:175] offset:3328
    ds_write_b128 v3, v[176:179] offset:3328
    ds_write_b128 v4, v[180:183] offset:3328
    ds_read_b64_tr_b16 v[114:115], v6 offset:0
    ds_read_b64_tr_b16 v[118:119], v6 offset:32
    ds_read_b64_tr_b16 v[122:123], v6 offset:64
    ds_read_b64_tr_b16 v[126:127], v6 offset:96
    ds_read_b64_tr_b16 v[130:131], v6 offset:128
    ds_read_b64_tr_b16 v[134:135], v6 offset:160
    ds_read_b64_tr_b16 v[138:139], v6 offset:192
    ds_read_b64_tr_b16 v[142:143], v6 offset:224
    ds_read_b64_tr_b16 v[146:147], v6 offset:256
    ds_read_b64_tr_b16 v[150:151], v6 offset:288
    ds_read_b64_tr_b16 v[154:155], v6 offset:320
    ds_read_b64_tr_b16 v[158:159], v6 offset:352
    buffer_load_dwordx4 v[240:243], v1, s[12:15], s88 offen offset:2048 nt
    buffer_load_dwordx4 v[244:247], v1, s[12:15], s88 offen offset:3072 nt
    s_waitcnt lgkmcnt(0)
    v_smfmac_f32_16x16x64_bf16 v[40:43], v[72:75], a[192:199], v14 abid:1
    v_smfmac_f32_16x16x64_bf16 v[44:47], v[72:75], a[200:207], v14 abid:1
    v_smfmac_f32_16x16x64_bf16 v[48:51], v[72:75], a[208:215], v14 abid:1
    v_smfmac_f32_16x16x64_bf16 v[52:55], v[72:75], a[216:223], v14 abid:1
    v_smfmac_f32_16x16x64_bf16 v[56:59], v[72:75], a[224:231], v14 abid:1
    v_smfmac_f32_16x16x64_bf16 v[60:63], v[72:75], a[232:239], v14 abid:1
    buffer_load_dwordx4 v[248:251], v23, s[12:15], s88 offen offset:0 nt
    v_smfmac_f32_16x16x64_bf16 v[40:43], v[76:79], v[112:119], v14 abid:1
    v_smfmac_f32_16x16x64_bf16 v[44:47], v[76:79], v[120:127], v14 abid:1
    v_smfmac_f32_16x16x64_bf16 v[48:51], v[76:79], v[128:135], v14 abid:1
    v_smfmac_f32_16x16x64_bf16 v[52:55], v[76:79], v[136:143], v14 abid:1
    v_smfmac_f32_16x16x64_bf16 v[56:59], v[76:79], v[144:151], v14 abid:1
    v_smfmac_f32_16x16x64_bf16 v[60:63], v[76:79], v[152:159], v14 abid:1
    buffer_load_dwordx4 v[252:255], v23, s[12:15], s88 offen offset:1024 nt
    s_barrier
    s_waitcnt vmcnt(12)
    ds_write_b128 v2, v[184:187] offset:0
    ds_write_b128 v3, v[188:191] offset:0
    ds_write_b128 v4, v[192:195] offset:0
    ds_write_b128 v2, v[196:199] offset:3328
    ds_write_b128 v3, v[200:203] offset:3328
    ds_write_b128 v4, v[204:207] offset:3328
    ds_read_b64_tr_b16 v[160:161], v6 offset:0
    ds_read_b64_tr_b16 v[164:165], v6 offset:32
    ds_read_b64_tr_b16 v[168:169], v6 offset:64
    ds_read_b64_tr_b16 v[172:173], v6 offset:96
    ds_read_b64_tr_b16 v[176:177], v6 offset:128
    ds_read_b64_tr_b16 v[180:181], v6 offset:160
    ds_read_b64_tr_b16 v[184:185], v6 offset:192
    ds_read_b64_tr_b16 v[188:189], v6 offset:224
    ds_read_b64_tr_b16 v[192:193], v6 offset:256
    ds_read_b64_tr_b16 v[196:197], v6 offset:288
    ds_read_b64_tr_b16 v[200:201], v6 offset:320
    ds_read_b64_tr_b16 v[204:205], v6 offset:352
    buffer_load_dwordx4 v[88:91], v1, s[12:15], s89 offen offset:0 nt
    buffer_load_dwordx4 v[92:95], v1, s[12:15], s89 offen offset:1024 nt
    buffer_load_dwordx4 v[96:99], v1, s[12:15], s89 offen offset:2048 nt
    buffer_load_dwordx4 v[100:103], v1, s[12:15], s89 offen offset:3072 nt
    buffer_load_dwordx4 v[104:107], v23, s[12:15], s89 offen offset:0 nt
    buffer_load_dwordx4 v[108:111], v23, s[12:15], s89 offen offset:1024 nt
    s_waitcnt vmcnt(12)
    ds_write_b128 v2, v[208:211] offset:0
    ds_write_b128 v3, v[212:215] offset:0
    ds_write_b128 v4, v[216:219] offset:0
    ds_write_b128 v2, v[220:223] offset:3328
    ds_write_b128 v3, v[224:227] offset:3328
    ds_write_b128 v4, v[228:231] offset:3328
    ds_read_b64_tr_b16 v[162:163], v6 offset:0
    ds_read_b64_tr_b16 v[166:167], v6 offset:32
    ds_read_b64_tr_b16 v[170:171], v6 offset:64
    ds_read_b64_tr_b16 v[174:175], v6 offset:96
    ds_read_b64_tr_b16 v[178:179], v6 offset:128
    ds_read_b64_tr_b16 v[182:183], v6 offset:160
    ds_read_b64_tr_b16 v[186:187], v6 offset:192
    ds_read_b64_tr_b16 v[190:191], v6 offset:224
    ds_read_b64_tr_b16 v[194:195], v6 offset:256
    ds_read_b64_tr_b16 v[198:199], v6 offset:288
    ds_read_b64_tr_b16 v[202:203], v6 offset:320
    ds_read_b64_tr_b16 v[206:207], v6 offset:352
    v_and_b32 v23, 0xffff0000, v22
    v_lshlrev_b32 v22, 16, v22
    s_mov_b32 s82, 0x1010101
    s_mov_b32 s83, 0x1010101
    s_mov_b32 s84, 0x1ff01ff
    s_mov_b32 s85, 0x1ff01ff
    s_mov_b32 s86, 0xffffffff
    s_mov_b32 s87, 0xfffffff
    s_mov_b32 s88, 0xff00ff
    s_mov_b32 s89, 0xff00ff00
    s_mov_b32 s92, 0x1010101
    s_mov_b32 s93, 0x0
    s_cmp_ge_u32 s69, 20
    s_cbranch_scc1 TAILF
    v_lshrrev_b32 v38, 2, v0
    v_mul_u32_u24 v38, 1280, v38
    v_and_b32 v39, 3, v0
    v_lshl_add_u32 v39, v39, 4, v38
    s_mov_b32 m0, s67
    s_add_u32 s67, s67, 1024
    buffer_load_dwordx4 v39, s[24:27], s66 offen  lds
    s_add_u32 s66, s66, 20480
    s_mov_b32 m0, s67
    s_add_u32 s67, s67, 1024
    buffer_load_dwordx4 v39, s[24:27], s66 offen  lds
    s_add_u32 s66, s66, 20480
    s_mov_b32 m0, s67
    s_add_u32 s67, s67, 1024
    buffer_load_dwordx4 v39, s[24:27], s66 offen  lds
    s_add_u32 s66, s66, 20480
    s_waitcnt lgkmcnt(0)
    v_smfmac_f32_16x16x64_bf16 v[40:43], v[80:83], v[160:167], v14 abid:1
    v_smfmac_f32_16x16x64_bf16 v[44:47], v[80:83], v[168:175], v14 abid:1
    v_smfmac_f32_16x16x64_bf16 v[48:51], v[80:83], v[176:183], v14 abid:1
    v_smfmac_f32_16x16x64_bf16 v[52:55], v[80:83], v[184:191], v14 abid:1
    v_smfmac_f32_16x16x64_bf16 v[56:59], v[80:83], v[192:199], v14 abid:1
    v_smfmac_f32_16x16x64_bf16 v[60:63], v[80:83], v[200:207], v14 abid:1
    s_waitcnt vmcnt(9)
    ds_write_b128 v2, v[232:235] offset:0
    ds_write_b128 v3, v[236:239] offset:0
    ds_write_b128 v4, v[240:243] offset:0
    ds_write_b128 v2, v[244:247] offset:3328
    ds_write_b128 v3, v[248:251] offset:3328
    ds_write_b128 v4, v[252:255] offset:3328
    ds_read_b64_tr_b16 v[208:209], v6 offset:0
    ds_read_b64_tr_b16 v[212:213], v6 offset:32
    ds_read_b64_tr_b16 v[216:217], v6 offset:64
    ds_read_b64_tr_b16 v[220:221], v6 offset:96
    ds_read_b64_tr_b16 v[224:225], v6 offset:128
    ds_read_b64_tr_b16 v[228:229], v6 offset:160
    ds_read_b64_tr_b16 v[232:233], v6 offset:192
    ds_read_b64_tr_b16 v[236:237], v6 offset:224
    ds_read_b64_tr_b16 v[240:241], v6 offset:256
    ds_read_b64_tr_b16 v[244:245], v6 offset:288
    ds_read_b64_tr_b16 v[248:249], v6 offset:320
    ds_read_b64_tr_b16 v[252:253], v6 offset:352
    s_mov_b32 m0, s67
    s_add_u32 s67, s67, 1024
    buffer_load_dwordx4 v39, s[24:27], s66 offen  lds
    s_add_u32 s66, s66, 20480
    s_mov_b32 m0, s67
    s_add_u32 s67, s67, 1024
    buffer_load_dwordx4 v39, s[24:27], s66 offen  lds
    s_add_u32 s66, s66, 20480
    s_mov_b32 m0, s67
    s_add_u32 s67, s67, 1024
    buffer_load_dwordx4 v39, s[24:27], s66 offen  lds
    s_add_u32 s66, s66, 20480
    s_waitcnt vmcnt(11)
    ds_write_b128 v2, v[88:91] offset:0
    s_waitcnt vmcnt(10)
    ds_write_b128 v3, v[92:95] offset:0
    s_waitcnt vmcnt(9)
    ds_write_b128 v4, v[96:99] offset:0
    s_waitcnt vmcnt(8)
    ds_write_b128 v2, v[100:103] offset:3328
    s_waitcnt vmcnt(7)
    ds_write_b128 v3, v[104:107] offset:3328
    s_waitcnt vmcnt(6)
    ds_write_b128 v4, v[108:111] offset:3328
    ds_read_b64_tr_b16 v[210:211], v6 offset:0
    ds_read_b64_tr_b16 v[214:215], v6 offset:32
    ds_read_b64_tr_b16 v[218:219], v6 offset:64
    ds_read_b64_tr_b16 v[222:223], v6 offset:96
    ds_read_b64_tr_b16 v[226:227], v6 offset:128
    ds_read_b64_tr_b16 v[230:231], v6 offset:160
    ds_read_b64_tr_b16 v[234:235], v6 offset:192
    ds_read_b64_tr_b16 v[238:239], v6 offset:224
    ds_read_b64_tr_b16 v[242:243], v6 offset:256
    ds_read_b64_tr_b16 v[246:247], v6 offset:288
    ds_read_b64_tr_b16 v[250:251], v6 offset:320
    ds_read_b64_tr_b16 v[254:255], v6 offset:352
    s_branch ATT_LAST
TAILF:
    s_lshl_b32 s90, s72, 3
    s_add_u32 s90, s90, s68
    s_mul_i32 s90, s90, 24
    s_add_u32 s90, s90, s69
    s_sub_u32 s90, s90, 8
    s_mul_i32 s90, s90, 10240
    buffer_load_dwordx4 a[240:243], v1, s[20:23], s90 offen offset:0
    buffer_load_dwordx4 a[240:243], v1, s[20:23], s90 offen offset:1024
    buffer_load_dwordx4 a[240:243], v1, s[20:23], s90 offen offset:2048
    buffer_load_dwordx4 a[240:243], v1, s[20:23], s90 offen offset:3072
    s_add_u32 s90, s90, 4096
    buffer_load_dwordx4 a[240:243], v1, s[20:23], s90 offen offset:0
    buffer_load_dwordx4 a[240:243], v1, s[20:23], s90 offen offset:1024
    buffer_load_dwordx4 a[240:243], v1, s[20:23], s90 offen offset:2048
    s_waitcnt lgkmcnt(0)
    v_smfmac_f32_16x16x64_bf16 v[40:43], v[80:83], v[160:167], v14 abid:1
    v_smfmac_f32_16x16x64_bf16 v[44:47], v[80:83], v[168:175], v14 abid:1
    v_smfmac_f32_16x16x64_bf16 v[48:51], v[80:83], v[176:183], v14 abid:1
    v_smfmac_f32_16x16x64_bf16 v[52:55], v[80:83], v[184:191], v14 abid:1
    v_smfmac_f32_16x16x64_bf16 v[56:59], v[80:83], v[192:199], v14 abid:1
    v_smfmac_f32_16x16x64_bf16 v[60:63], v[80:83], v[200:207], v14 abid:1
    s_waitcnt vmcnt(13)
    ds_write_b128 v2, v[232:235] offset:0
    ds_write_b128 v3, v[236:239] offset:0
    ds_write_b128 v4, v[240:243] offset:0
    ds_write_b128 v2, v[244:247] offset:3328
    ds_write_b128 v3, v[248:251] offset:3328
    ds_write_b128 v4, v[252:255] offset:3328
    ds_read_b64_tr_b16 v[208:209], v6 offset:0
    ds_read_b64_tr_b16 v[212:213], v6 offset:32
    ds_read_b64_tr_b16 v[216:217], v6 offset:64
    ds_read_b64_tr_b16 v[220:221], v6 offset:96
    ds_read_b64_tr_b16 v[224:225], v6 offset:128
    ds_read_b64_tr_b16 v[228:229], v6 offset:160
    ds_read_b64_tr_b16 v[232:233], v6 offset:192
    ds_read_b64_tr_b16 v[236:237], v6 offset:224
    ds_read_b64_tr_b16 v[240:241], v6 offset:256
    ds_read_b64_tr_b16 v[244:245], v6 offset:288
    ds_read_b64_tr_b16 v[248:249], v6 offset:320
    ds_read_b64_tr_b16 v[252:253], v6 offset:352
    buffer_load_dwordx4 a[240:243], v1, s[20:23], s90 offen offset:3072
    s_add_u32 s90, s90, 4096
    buffer_load_dwordx4 a[240:243], v1, s[20:23], s90 offen offset:0
    buffer_load_dwordx4 a[240:243], v1, s[20:23], s90 offen offset:1024
    s_waitcnt vmcnt(15)
    ds_write_b128 v2, v[88:91] offset:0
    s_waitcnt vmcnt(14)
    ds_write_b128 v3, v[92:95] offset:0
    s_waitcnt vmcnt(13)
    ds_write_b128 v4, v[96:99] offset:0
    s_waitcnt vmcnt(12)
    ds_write_b128 v2, v[100:103] offset:3328
    s_waitcnt vmcnt(11)
    ds_write_b128 v3, v[104:107] offset:3328
    s_waitcnt vmcnt(10)
    ds_write_b128 v4, v[108:111] offset:3328
    ds_read_b64_tr_b16 v[210:211], v6 offset:0
    ds_read_b64_tr_b16 v[214:215], v6 offset:32
    ds_read_b64_tr_b16 v[218:219], v6 offset:64
    ds_read_b64_tr_b16 v[222:223], v6 offset:96
    ds_read_b64_tr_b16 v[226:227], v6 offset:128
    ds_read_b64_tr_b16 v[230:231], v6 offset:160
    ds_read_b64_tr_b16 v[234:235], v6 offset:192
    ds_read_b64_tr_b16 v[238:239], v6 offset:224
    ds_read_b64_tr_b16 v[242:243], v6 offset:256
    ds_read_b64_tr_b16 v[246:247], v6 offset:288
    ds_read_b64_tr_b16 v[250:251], v6 offset:320
    ds_read_b64_tr_b16 v[254:255], v6 offset:352
    s_branch ATT_LAST
LOOP:
    s_cmp_lt_u32 s69, 20
    s_cselect_b32 s5, s72, 4
    s_add_u32 s96, s3, 688128
    s_add_u32 s97, s96, 4096
    buffer_load_dwordx4 v[88:91], v11, s[16:19], s96 offen sc1
    buffer_load_dwordx4 v[92:95], v11, s[16:19], s97 offen sc1
    ds_read_b64_tr_b16 v[40:41], v16 offset:0
    ds_read_b64_tr_b16 v[42:43], v16 offset:1536
    ds_read_b64_tr_b16 v[44:45], v16 offset:12288
    ds_read_b64_tr_b16 v[46:47], v16 offset:13824
    ds_read_b64_tr_b16 v[48:49], v17 offset:24576
    ds_read_b64_tr_b16 v[50:51], v16 offset:32
    ds_read_b64_tr_b16 v[52:53], v16 offset:1568
    ds_read_b64_tr_b16 v[54:55], v16 offset:12320
    ds_read_b64_tr_b16 v[56:57], v16 offset:13856
    ds_read_b64_tr_b16 v[58:59], v17 offset:24608
    ds_read_b64_tr_b16 v[60:61], v16 offset:64
    ds_read_b64_tr_b16 v[62:63], v16 offset:1600
    ds_read_b64_tr_b16 v[64:65], v16 offset:12352
    ds_read_b64_tr_b16 v[66:67], v16 offset:13888
    ds_read_b64_tr_b16 v[68:69], v17 offset:24640
    v_and_b32 v25, 15, v0
    v_cmp_eq_u32 vcc, 12, v25
    v_mov_b32 v36, 0x3f803f80
    s_nop 0
    v_cndmask_b32 v70, 0, v36, vcc
    v_mov_b32 v71, v70
    v_mov_b32 v72, v70
    v_mov_b32 v73, v70
    v_mov_b32 v74, v70
    v_mov_b32 v75, v70
    v_mov_b32 v76, v70
    v_mov_b32 v77, v70
    v_mov_b32 v78, v70
    v_mov_b32 v79, v70
    s_add_u32 s79, s3, 4096
    s_mul_i32 s77, s72, 6656
    v_mul_u32_u24 v26, 103, v0
    v_lshrrev_b32 v26, 10, v26
    v_lshl_add_u32 v26, v26, 4, v1
    v_add_u32 v26, s77, v26
    v_mul_u32_u24 v27, 176, v25
    v_add_u32 v27, s77, v27
    v_lshrrev_b32 v28, 4, v0
    v_lshl_add_u32 v29, v28, 3, v27
    v_lshl_add_u32 v27, v28, 4, v27
    s_mul_i32 s77, s71, 160
    s_add_u32 s77, s77, s3
    s_sub_u32 s77, s77, 641536
    s_waitcnt lgkmcnt(0)
    s_mov_b32 exec_lo, 0x3ff
    s_mov_b32 exec_hi, 0x0
    s_mov_b32 s76, 1
POLL2:
    buffer_load_dword v24, v1, s[16:19], s77 offen sc1
POLLW2:
    s_waitcnt vmcnt(0)
    v_cmp_eq_u32 vcc, -1, v24
    s_cbranch_vccnz AGAIN2
POLLX2:
    s_mov_b64 exec, s[86:87]
    buffer_load_dwordx4 v[80:83], v8, s[16:19], 0 offen sc1
    buffer_load_dwordx4 v[84:87], v9, s[16:19], 0 offen sc1
    buffer_load_dwordx4 v[88:91], v11, s[16:19], s96 offen sc1
    buffer_load_dwordx4 v[92:95], v11, s[16:19], s97 offen sc1
    s_waitcnt vmcnt(2)
BW3:
    ds_write_b128 v26, v[80:83]
    ds_write_b128 v26, v[84:87] offset:1056
    v_max_u32 v24, v80, v84
    v_cmp_eq_u32 vcc, -1, v24
    s_mov_b64 exec, s[84:85]
    ds_read_b128 v[70:73], v27
    ds_read_b128 v[74:77], v27 offset:64
    ds_read_b64 v[78:79], v29 offset:128
    s_mov_b64 exec, -1
    s_cbranch_vccnz BR3
BX3:
    s_cmp_lg_u32 s5, 1
    s_cbranch_scc1 NOOWL
    buffer_load_dword a244, v20, s[16:19], 0 offen sc1
    buffer_load_dword a245, v21, s[16:19], 0 offen sc1
NOOWL:
    s_waitcnt lgkmcnt(2)
    v_mfma_f32_16x16x32_bf16 v[24:27], v[70:73], v[40:43], 0
    v_mfma_f32_16x16x32_bf16 v[32:35], v[70:73], v[60:63], 0
    s_waitcnt lgkmcnt(0)
    v_mfma_f32_16x16x32_bf16 v[24:27], v[74:77], v[44:47], v[24:27]
    v_mfma_f32_16x16x32_bf16 v[32:35], v[74:77], v[64:67], v[32:35]
    v_mfma_f32_16x16x16_bf16 v[24:27], v[78:79], v[48:49], v[24:27]
    v_mfma_f32_16x16x16_bf16 v[32:35], v[78:79], v[68:69], v[32:35]
    v_mfma_f32_16x16x32_bf16 v[28:31], v[70:73], v[50:53], 0
    v_mfma_f32_16x16x32_bf16 v[36:39], v[70:73], v[70:73], 0
    v_mfma_f32_16x16x32_bf16 v[28:31], v[74:77], v[54:57], v[28:31]
    v_mfma_f32_16x16x32_bf16 v[36:39], v[74:77], v[74:77], v[36:39]
    v_mfma_f32_16x16x16_bf16 v[28:31], v[78:79], v[58:59], v[28:31]
    v_mfma_f32_16x16x16_bf16 v[36:39], v[78:79], v[78:79], v[36:39]
    s_nop 0
    v_add_f32 v24, v24, v25
    v_add_f32 v26, v26, v27
    v_add_f32 v24, v24, v26
    v_add_f32 v32, v32, v33
    v_add_f32 v34, v34, v35
    v_add_f32 v32, v32, v34
    s_nop 1
    v_permlane32_swap_b32 v24, v32
    v_add_f32 v28, v28, v29
    v_add_f32 v30, v30, v31
    v_add_f32 v36, v36, v37
    v_add_f32 v38, v38, v39
    v_add_f32 v24, v24, v32
    v_add_f32 v28, v28, v30
    v_add_f32 v36, v36, v38
    s_nop 1
    v_permlane32_swap_b32 v28, v36
    v_add_f32 v28, v28, v36
    s_nop 1
    v_permlane16_swap_b32 v24, v28
    v_add_f32 v24, v24, v28
    buffer_store_dword v24, v10, s[8:11], s3 offen
    s_cmp_eq_u32 s10, 0
    s_cbranch_scc1 SLOW4
BACK4:
    v_mov_b32 v40, 0
    v_mov_b32 v41, 0
    v_mov_b32 v44, 0
    v_mov_b32 v45, 0
    v_mov_b32 v48, 0
    v_mov_b32 v49, 0
    v_mov_b32 v52, 0
    v_mov_b32 v53, 0
    v_mov_b32 v56, 0
    v_mov_b32 v57, 0
    v_mov_b32 v60, 0
    v_mov_b32 v61, 0
    v_mov_b32 v64, 0
    v_mov_b32 v65, 0
    v_mov_b32 v68, 0
    v_mov_b32 v69, 0
    v_mov_b32 v72, 0
    v_mov_b32 v73, 0
    v_mov_b32 v74, 0
    v_mov_b32 v75, 0
    v_mov_b32 v76, 0
    v_mov_b32 v77, 0
    v_mov_b32 v78, 0
    v_mov_b32 v79, 0
    v_mov_b32 v80, 0
    v_mov_b32 v81, 0
    v_mov_b32 v82, 0
    v_mov_b32 v83, 0
    v_mov_b32 v84, 0
    v_mov_b32 v85, 0
    v_mov_b32 v86, 0
    v_mov_b32 v87, 0
    s_waitcnt vmcnt(1)
    v_add_f32 v88, v88, v92
    v_add_f32 v89, v89, v93
    v_add_f32 v90, v90, v94
    v_add_f32 v91, v91, v95
    s_nop 0
    v_permlane32_swap_b32 v88, v90
    v_permlane32_swap_b32 v89, v91
    v_add_f32 v88, v88, v90
    v_add_f32 v89, v89, v91
    s_nop 1
    v_permlane16_swap_b32 v88, v89
    v_add_f32 v88, v88, v89
    v_mul_f32 v7, 0x3acccccd, v88
    s_mov_b32 s76, 1
POLL5:
    buffer_load_dwordx4 v[24:27], v11, s[16:19], s3 offen sc1
    buffer_load_dwordx4 v[28:31], v11, s[16:19], s79 offen sc1
    s_waitcnt vmcnt(0)
    v_add_f32 v24, v24, v28
    v_add_f32 v25, v25, v29
    v_add_f32 v26, v26, v30
    v_add_f32 v27, v27, v31
    s_nop 0
    v_permlane32_swap_b32 v24, v26
    v_permlane32_swap_b32 v25, v27
    v_add_f32 v24, v24, v26
    v_add_f32 v25, v25, v27
    s_nop 1
    v_permlane16_swap_b32 v24, v25
    v_add_f32 v24, v24, v25
    v_cmp_u_f32 vcc, v24, v24
    s_cbranch_vccnz AGAIN5
POLLX5:
    v_readlane_b32 s77, v24, 15
    s_mov_b32 vcc_lo, 0x70007000
    s_mov_b32 vcc_hi, 0x70007000
    v_fma_f32 v25, -s77, v7, v24
    v_cvt_pk_bf16_f32 v25, v25, v25
    ds_write_b16 v12, v25
    v_cndmask_b32 v26, 0, v24, vcc
    s_nop 1
    v_add_f32_dpp v26, v26, v26 quad_perm:[1,0,3,2] row_mask:0xf bank_mask:0xf
    s_nop 1
    v_add_f32_dpp v26, v26, v26 quad_perm:[2,3,0,1] row_mask:0xf bank_mask:0xf
    v_mov_b32 v27, v26
    s_nop 1
    v_permlane32_swap_b32 v26, v27
    v_add_f32 v26, v26, v27
    s_waitcnt lgkmcnt(0)
    s_barrier
    ds_read_b128 v[28:31], v13 offset:0
    ds_read_b128 v[32:35], v13 offset:128
    ds_read_b128 v[36:39], v13 offset:256
    v_mov_b32 v27, v26
    v_mov_b32 v25, s77
    v_subrev_f32 v25, 0x44200000, v25
    v_permlane16_swap_b32 v26, v27
    v_add_f32 v26, v26, v27
    v_mul_f32 v24, 0x3acccccd, v25
    v_readlane_b32 s77, v26, 15
    v_mul_f32 v24, v24, v24
    s_mov_b32 s78, 0x3acccccd
    v_sub_f32 v26, s77, v25
    v_fma_f32 v26, v26, s78, -v24
    v_max_f32 v26, 0, v26
    v_add_f32 v26, 0x3727c5ac, v26
    v_rsq_f32 v26, v26
    s_nop 0
    v_mul_f32 v18, 0x3dd53b94, v26
    s_waitcnt lgkmcnt(2)
    v_smfmac_f32_16x16x64_bf16 v[40:43], v[28:31], a[0:7], v14
    v_smfmac_f32_16x16x64_bf16 v[44:47], v[28:31], a[24:31], v14
    v_smfmac_f32_16x16x64_bf16 v[48:51], v[28:31], a[48:55], v14
    v_smfmac_f32_16x16x64_bf16 v[52:55], v[28:31], a[72:79], v14
    v_smfmac_f32_16x16x64_bf16 v[56:59], v[28:31], a[96:103], v14
    v_smfmac_f32_16x16x64_bf16 v[60:63], v[28:31], a[120:127], v14
    v_smfmac_f32_16x16x64_bf16 v[64:67], v[28:31], a[144:151], v14
    v_smfmac_f32_16x16x64_bf16 v[68:71], v[28:31], a[168:175], v14
    s_waitcnt lgkmcnt(1)
    v_smfmac_f32_16x16x64_bf16 v[40:43], v[32:35], a[8:15], v14
    v_smfmac_f32_16x16x64_bf16 v[44:47], v[32:35], a[32:39], v14
    v_smfmac_f32_16x16x64_bf16 v[48:51], v[32:35], a[56:63], v14
    v_smfmac_f32_16x16x64_bf16 v[52:55], v[32:35], a[80:87], v14
    v_smfmac_f32_16x16x64_bf16 v[56:59], v[32:35], a[104:111], v14
    v_smfmac_f32_16x16x64_bf16 v[60:63], v[32:35], a[128:135], v14
    v_smfmac_f32_16x16x64_bf16 v[64:67], v[32:35], a[152:159], v14
    v_smfmac_f32_16x16x64_bf16 v[68:71], v[32:35], a[176:183], v14
    s_waitcnt lgkmcnt(0)
    v_smfmac_f32_16x16x64_bf16 v[40:43], v[36:39], a[16:23], v14
    v_smfmac_f32_16x16x64_bf16 v[44:47], v[36:39], a[40:47], v14
    v_smfmac_f32_16x16x64_bf16 v[48:51], v[36:39], a[64:71], v14
    v_smfmac_f32_16x16x64_bf16 v[52:55], v[36:39], a[88:95], v14
    v_smfmac_f32_16x16x64_bf16 v[56:59], v[36:39], a[112:119], v14
    v_smfmac_f32_16x16x64_bf16 v[60:63], v[36:39], a[136:143], v14
    v_smfmac_f32_16x16x64_bf16 v[64:67], v[36:39], a[160:167], v14
    v_smfmac_f32_16x16x64_bf16 v[68:71], v[36:39], a[184:191], v14
    s_nop 0
    v_add_f32 v24, v40, v41
    v_add_f32 v44, v44, v45
    v_add_f32 v48, v48, v49
    v_max3_f32 v26, v24, v44, v48
    v_add_f32 v52, v52, v53
    v_add_f32 v25, v56, v57
    v_max3_f32 v26, v26, v52, v25
    v_add_f32 v60, v60, v61
    v_add_f32 v64, v64, v65
    v_max3_f32 v26, v26, v60, v64
    v_add_f32 v68, v68, v69
    v_max_f32 v26, v26, v68
    v_mov_b32_dpp v24, v44 quad_perm:[0,1,2,3] row_mask:0x2 bank_mask:0xf
    v_mov_b32_dpp v25, v60 quad_perm:[0,1,2,3] row_mask:0x2 bank_mask:0xf
    v_max_f32_dpp v26, v26, v26 row_ror:8 row_mask:0xf bank_mask:0xf
    v_mov_b32_dpp v24, v48 quad_perm:[0,1,2,3] row_mask:0x4 bank_mask:0xf
    v_mov_b32_dpp v25, v64 quad_perm:[0,1,2,3] row_mask:0x4 bank_mask:0xf
    v_max_f32_dpp v26, v26, v26 row_ror:4 row_mask:0xf bank_mask:0xf
    v_mov_b32_dpp v24, v52 quad_perm:[0,1,2,3] row_mask:0x8 bank_mask:0xf
    v_mov_b32_dpp v25, v68 quad_perm:[0,1,2,3] row_mask:0x8 bank_mask:0xf
    v_max_f32_dpp v26, v26, v26 row_ror:2 row_mask:0xf bank_mask:0xf
    v_accvgpr_read_b32 v27, a252
    s_nop 0
    v_max_f32_dpp v26, v26, v26 row_ror:1 row_mask:0xf bank_mask:0xf
    v_mul_f32 v26, v26, v18
    v_fma_f32 v24, v24, v18, -v26
    v_fma_f32 v25, v25, v18, -v26
    v_exp_f32 v24, v24
    v_exp_f32 v25, v25
    s_nop 0
    v_cvt_pk_bf16_f32 v28, v24, v25
    ds_write_b16 v19, v28
    ds_write_b16_d16_hi v19, v28 offset:128
    s_mov_b64 exec, s[88:89]
    ds_read_b128 v[72:75], v27 offset:0
    ds_read_b128 v[76:79], v27 offset:64
    ds_read_b128 v[80:83], v27 offset:128
    ds_read_b128 v[84:87], v27 offset:192
    s_mov_b64 exec, -1
    v_add_f32 v27, v24, v25
    v_mov_b32 v40, 0
    v_mov_b32 v44, 0
    v_add_f32_dpp v27, v27, v27 row_ror:8 row_mask:0xf bank_mask:0xf
    v_mov_b32 v48, 0
    v_mov_b32 v52, 0
    v_add_f32_dpp v27, v27, v27 row_ror:4 row_mask:0xf bank_mask:0xf
    v_mov_b32 v56, 0
    v_mov_b32 v60, 0
    v_add_f32_dpp v27, v27, v27 row_ror:2 row_mask:0xf bank_mask:0xf
    s_lshl_b32 s78, s72, 3
    s_add_u32 s78, s78, 125440
    v_add_f32_dpp v27, v27, v27 row_ror:1 row_mask:0xf bank_mask:0xf
    v_mov_b32 v28, v27
    s_nop 1
    v_permlane32_swap_b32 v27, v28
    v_add_f32 v27, v27, v28
    v_mov_b32 v28, v27
    s_nop 1
    v_permlane16_swap_b32 v27, v28
    v_add_f32 v27, v27, v28
    v_mov_b32 v28, s78
    ds_write_b64 v28, v[26:27]
    s_waitcnt lgkmcnt(4)
    v_smfmac_f32_16x16x64_bf16 v[40:43], v[72:75], a[192:199], v14 abid:1
    v_smfmac_f32_16x16x64_bf16 v[44:47], v[72:75], a[200:207], v14 abid:1
    v_smfmac_f32_16x16x64_bf16 v[48:51], v[72:75], a[208:215], v14 abid:1
    v_smfmac_f32_16x16x64_bf16 v[52:55], v[72:75], a[216:223], v14 abid:1
    v_smfmac_f32_16x16x64_bf16 v[56:59], v[72:75], a[224:231], v14 abid:1
    v_smfmac_f32_16x16x64_bf16 v[60:63], v[72:75], a[232:239], v14 abid:1
    s_waitcnt lgkmcnt(3)
    v_smfmac_f32_16x16x64_bf16 v[40:43], v[76:79], v[112:119], v14 abid:1
    v_smfmac_f32_16x16x64_bf16 v[44:47], v[76:79], v[120:127], v14 abid:1
    v_smfmac_f32_16x16x64_bf16 v[48:51], v[76:79], v[128:135], v14 abid:1
    v_smfmac_f32_16x16x64_bf16 v[52:55], v[76:79], v[136:143], v14 abid:1
    v_smfmac_f32_16x16x64_bf16 v[56:59], v[76:79], v[144:151], v14 abid:1
    v_smfmac_f32_16x16x64_bf16 v[60:63], v[76:79], v[152:159], v14 abid:1
    s_waitcnt lgkmcnt(2)
    v_smfmac_f32_16x16x64_bf16 v[40:43], v[80:83], v[160:167], v14 abid:1
    v_smfmac_f32_16x16x64_bf16 v[44:47], v[80:83], v[168:175], v14 abid:1
    v_smfmac_f32_16x16x64_bf16 v[48:51], v[80:83], v[176:183], v14 abid:1
    v_smfmac_f32_16x16x64_bf16 v[52:55], v[80:83], v[184:191], v14 abid:1
    v_smfmac_f32_16x16x64_bf16 v[56:59], v[80:83], v[192:199], v14 abid:1
    v_smfmac_f32_16x16x64_bf16 v[60:63], v[80:83], v[200:207], v14 abid:1
    s_waitcnt lgkmcnt(0)
ATT_LAST:
    s_waitcnt lgkmcnt(8)
    v_smfmac_f32_16x16x64_bf16 v[40:43], v[84:87], v[208:215], v14 abid:1
    v_smfmac_f32_16x16x64_bf16 v[44:47], v[84:87], v[216:223], v14 abid:1
    s_waitcnt lgkmcnt(4)
    v_smfmac_f32_16x16x64_bf16 v[48:51], v[84:87], v[224:231], v14 abid:1
    v_smfmac_f32_16x16x64_bf16 v[52:55], v[84:87], v[232:239], v14 abid:1
    s_waitcnt lgkmcnt(0)
    v_smfmac_f32_16x16x64_bf16 v[56:59], v[84:87], v[240:247], v14 abid:1
    v_smfmac_f32_16x16x64_bf16 v[60:63], v[84:87], v[248:255], v14 abid:1
    s_lshl_b32 s77, s72, 8
    s_add_u32 s77, s77, 119296
    v_lshl_add_u32 v24, v0, 2, s77
    v_permlane16_swap_b32 v40, v44
    v_add_f32 v40, v40, v44
    ds_write_b32 v15, v40 offset:0
    v_permlane16_swap_b32 v48, v52
    v_add_f32 v48, v48, v52
    ds_write_b32 v15, v48 offset:256
    v_permlane16_swap_b32 v56, v60
    v_add_f32 v56, v56, v60
    ds_write_b32 v15, v56 offset:512
    v_and_b32 v25, 3, v0
    v_lshlrev_b32 v25, 3, v25
    v_add_u32 v25, 125440, v25
    s_waitcnt lgkmcnt(0)
    s_barrier
    ds_read_b64 v[32:33], v25
    ds_read2st64_b32 v[40:41], v24 offset0:0 offset1:3
    ds_read2st64_b32 v[42:43], v24 offset0:6 offset1:9
    s_mul_i32 s77, s70, 3072
    s_lshl_b32 s78, s71, 4
    s_add_u32 s77, s77, s78
    s_lshl_b32 s78, s72, 10
    s_add_u32 s77, s77, s78
    s_add_u32 s77, s77, s3
    s_add_u32 s77, s77, 32768
    s_lshl_b32 s78, s69, 3
    s_add_u32 s78, s78, s3
    s_add_u32 s78, s78, 45056
    s_cmp_eq_u32 s72, 3
    s_waitcnt lgkmcnt(2)
    v_max_f32_dpp v34, v32, v32 quad_perm:[1,0,3,2] row_mask:0xf bank_mask:0xf
    s_nop 1
    v_max_f32_dpp v34, v34, v34 quad_perm:[2,3,0,1] row_mask:0xf bank_mask:0xf
    v_sub_f32 v32, v32, v34
    v_exp_f32 v32, v32
    s_cbranch_scc1 OML
    s_waitcnt lgkmcnt(0)
    v_mul_f32_dpp v28, v32, v40 quad_perm:[0,0,0,0] row_mask:0xf bank_mask:0xf
    v_mul_f32_dpp v29, v32, v41 quad_perm:[1,1,1,1] row_mask:0xf bank_mask:0xf
    v_mul_f32_dpp v30, v32, v42 quad_perm:[2,2,2,2] row_mask:0xf bank_mask:0xf
    v_fmac_f32_dpp v28, v32, v43 quad_perm:[3,3,3,3] row_mask:0xf bank_mask:0xf
    v_add_f32 v29, v29, v30
    v_add_f32 v28, v28, v29
    s_nop 1
    v_mov_b32_dpp v29, v28 row_shl:1 row_mask:0xf bank_mask:0xf
    v_cvt_pk_bf16_f32 v28, v28, v29
    s_nop 1
    v_mov_b32_dpp v29, v28 row_shl:2 row_mask:0xf bank_mask:0xf
    v_mov_b32_dpp v30, v28 row_shl:4 row_mask:0xf bank_mask:0xf
    v_mov_b32_dpp v31, v28 row_shl:6 row_mask:0xf bank_mask:0xf
    s_mov_b64 exec, s[82:83]
    buffer_store_dwordx4 v[28:31], v1, s[8:11], s77 offen
    s_cmp_eq_u32 s10, 0
    s_cbranch_scc1 SLOW6
BACK6:
    s_mov_b64 exec, -1
ODONE:
    s_cmp_ge_u32 s69, 20
    s_cbranch_scc1 ROLEF
    s_cmp_eq_u32 s74, 0
    s_cbranch_scc1 WLATE
    v_accvgpr_read_b32 v2, a246
    v_accvgpr_read_b32 v3, a247
    v_accvgpr_read_b32 v4, a248
    v_mov_b32 v88, 0
    v_mov_b32 v92, 0
    v_mov_b32 v96, 0
    v_mov_b32 v100, 0
    v_mov_b32 v104, 0
    v_mov_b32 v108, 0
    ds_read_b64_tr_b16 v[40:41], v2 offset:0
    ds_read_b64_tr_b16 v[42:43], v2 offset:256
    ds_read_b64_tr_b16 v[64:65], v2 offset:32
    ds_read_b64_tr_b16 v[66:67], v2 offset:288
    ds_read_b64_tr_b16 v[44:45], v2 offset:2048
    ds_read_b64_tr_b16 v[46:47], v2 offset:2304
    ds_read_b64_tr_b16 v[68:69], v2 offset:2080
    ds_read_b64_tr_b16 v[70:71], v2 offset:2336
    ds_read_b64_tr_b16 v[48:49], v2 offset:4096
    ds_read_b64_tr_b16 v[50:51], v2 offset:4352
    s_cmp_lg_u32 s72, 1
    s_cbranch_scc1 NOOWN0
    v_accvgpr_read_b32 v28, a244
    v_accvgpr_read_b32 v29, a245
    v_max_u32 v30, v28, v29
    v_cmp_eq_u32 vcc, -1, v30
    s_cbranch_vccnz RETRY7
OK7:
    v_lshlrev_b32 v30, 16, v28
    v_and_b32 v28, 0xffff0000, v28
    v_lshlrev_b32 v31, 16, v29
    v_and_b32 v29, 0xffff0000, v29
    v_add_f32 v30, v30, v31
    v_add_f32 v28, v28, v29
    v_mov_b32 v31, v30
    v_mov_b32 v29, v28
    s_nop 0
    v_permlane32_swap_b32 v30, v31
    v_permlane32_swap_b32 v28, v29
    v_add_f32 v30, v30, v31
    v_add_f32 v28, v28, v29
    v_mov_b32 v31, v30
    v_mov_b32 v29, v28
    s_nop 0
    v_permlane16_swap_b32 v30, v31
    v_permlane16_swap_b32 v28, v29
    v_add_f32 v30, v30, v31
    v_add_f32 v28, v28, v29
    v_add_f32 v22, v22, v30
    v_add_f32 v23, v23, v28
    v_cvt_pk_bf16_f32 v28, v22, v23
    s_lshl_b32 s77, s69, 6
    s_add_u32 s77, s77, s3
    s_add_u32 s77, s77, 47872
    v_lshlrev_b32 v32, 2, v0
    v_mov_b32_dpp v29, v28 quad_perm:[1,1,1,1] row_mask:0xf bank_mask:0xf
    v_mov_b32_dpp v30, v28 quad_perm:[2,2,2,2] row_mask:0xf bank_mask:0xf
    v_mov_b32_dpp v31, v28 quad_perm:[3,3,3,3] row_mask:0xf bank_mask:0xf
    s_mov_b32 exec_lo, 0x1111
    s_mov_b32 exec_hi, 0x0
    buffer_store_dwordx4 v[28:31], v32, s[8:11], s77 offen
    s_cmp_eq_u32 s10, 0
    s_cbranch_scc1 SLOW8
BACK8:
    s_mov_b64 exec, -1
NOOWN0:
    v_mov_b32 v25, 0
    v_mov_b32 v27, 0
    v_mov_b32 v37, 0
    v_mov_b32 v39, 0
    s_mov_b32 exec_lo, 0x00ff00ff
    s_mov_b32 exec_hi, 0x00ff00ff
    buffer_load_dwordx4 v[88:91], v3, s[16:19], s3 offen offset:0 sc1
    buffer_load_dwordx4 v[92:95], v3, s[16:19], s3 offen offset:512 sc1
    buffer_load_dwordx4 v[96:99], v3, s[16:19], s3 offen offset:1024 sc1
    buffer_load_dwordx4 v[100:103], v3, s[16:19], s3 offen offset:1536 sc1
    buffer_load_dwordx4 v[104:107], v3, s[16:19], s3 offen offset:2048 sc1
    buffer_load_dwordx4 v[108:111], v3, s[16:19], s3 offen offset:2560 sc1
    s_mov_b32 exec_lo, -1
    s_mov_b32 exec_hi, 0
    buffer_load_dwordx4 v[24:27], v4, s[16:19], s3 offen offset:0 sc1
    buffer_load_dwordx4 v[36:39], v4, s[16:19], s3 offen offset:16 sc1
    s_mov_b64 exec, -1
    ds_read_b64_tr_b16 v[72:73], v2 offset:4128
    ds_read_b64_tr_b16 v[74:75], v2 offset:4384
    ds_read_b64_tr_b16 v[52:53], v2 offset:6144
    ds_read_b64_tr_b16 v[54:55], v2 offset:6400
    ds_read_b64_tr_b16 v[76:77], v2 offset:6176
    ds_read_b64_tr_b16 v[78:79], v2 offset:6432
    ds_read_b64_tr_b16 v[56:57], v2 offset:8192
    ds_read_b64_tr_b16 v[58:59], v2 offset:8448
    ds_read_b64_tr_b16 v[80:81], v2 offset:8224
    ds_read_b64_tr_b16 v[82:83], v2 offset:8480
    ds_read_b64_tr_b16 v[60:61], v2 offset:10240
    ds_read_b64_tr_b16 v[62:63], v2 offset:10496
    ds_read_b64_tr_b16 v[84:85], v2 offset:10272
    ds_read_b64_tr_b16 v[86:87], v2 offset:10528
    v_accvgpr_read_b32 v5, a249
    v_lshlrev_b32 v18, 1, v0
WCHK:
    s_waitcnt vmcnt(0)
    v_max3_u32 v28, v88, v92, v96
    v_max3_u32 v28, v28, v100, v104
    v_max3_u32 v28, v28, v108, v25
    v_max3_u32 v28, v28, v27, v37
    v_max_u32 v28, v28, v39
    v_cmp_eq_u32 vcc, -1, v28
    s_cbranch_vccnz AGAIN9
POLLX9:
    s_waitcnt lgkmcnt(0)
    v_mfma_f32_16x16x32_bf16 v[28:31], v[88:91], v[40:43], 0
    v_mfma_f32_16x16x32_bf16 v[32:35], v[88:91], v[64:67], 0
    v_max3_f32 v88, v24, v26, v36
    v_max_f32 v88, v88, v38
    v_mfma_f32_16x16x32_bf16 v[28:31], v[92:95], v[44:47], v[28:31]
    v_mov_b32 v89, v88
    v_mfma_f32_16x16x32_bf16 v[32:35], v[92:95], v[68:71], v[32:35]
    s_nop 0
    v_permlane16_swap_b32 v88, v89
    v_max_f32 v88, v88, v89
    v_mfma_f32_16x16x32_bf16 v[28:31], v[96:99], v[48:51], v[28:31]
    v_sub_f32 v24, v24, v88
    v_sub_f32 v26, v26, v88
    v_mfma_f32_16x16x32_bf16 v[32:35], v[96:99], v[72:75], v[32:35]
    v_sub_f32 v36, v36, v88
    v_sub_f32 v38, v38, v88
    v_mfma_f32_16x16x32_bf16 v[28:31], v[100:103], v[52:55], v[28:31]
    v_exp_f32 v24, v24
    v_mfma_f32_16x16x32_bf16 v[32:35], v[100:103], v[76:79], v[32:35]
    v_exp_f32 v26, v26
    v_mfma_f32_16x16x32_bf16 v[28:31], v[104:107], v[56:59], v[28:31]
    v_exp_f32 v36, v36
    v_mfma_f32_16x16x32_bf16 v[32:35], v[104:107], v[80:83], v[32:35]
    v_exp_f32 v38, v38
    v_mfma_f32_16x16x32_bf16 v[28:31], v[108:111], v[60:63], v[28:31]
    v_mul_f32 v90, v24, v25
    v_fmac_f32 v90, v26, v27
    v_mfma_f32_16x16x32_bf16 v[32:35], v[108:111], v[84:87], v[32:35]
    v_fmac_f32 v90, v36, v37
    v_fmac_f32 v90, v38, v39
    v_mov_b32 v89, v90
    s_cmp_lg_u32 s72, 0
    s_nop 0
    v_permlane16_swap_b32 v90, v89
    v_add_f32 v90, v90, v89
    v_rcp_f32 v90, v90
    v_mul_f32 v28, v24, v28
    v_mul_f32 v32, v24, v32
    v_fmac_f32 v28, v26, v29
    v_fmac_f32 v32, v26, v33
    v_fmac_f32 v28, v36, v30
    v_fmac_f32 v32, v36, v34
    v_fmac_f32 v28, v38, v31
    v_fmac_f32 v32, v38, v35
    s_nop 1
    v_permlane16_swap_b32 v28, v32
    v_add_f32 v28, v28, v32
    v_mul_f32 v28, v28, v90
    ds_write_b32 v5, v28
    s_waitcnt lgkmcnt(0)
    s_barrier
    s_cbranch_scc1 WNOT0
    ds_read2st64_b32 v[28:29], v5 offset0:0 offset1:1
    ds_read2st64_b32 v[30:31], v5 offset0:2 offset1:3
    s_waitcnt lgkmcnt(1)
    v_add_f32 v28, v28, v29
    s_waitcnt lgkmcnt(0)
    v_add_f32 v30, v30, v31
    v_add_f32 v28, v28, v30
    s_nop 1
    v_mov_b32_dpp v29, v28 row_shl:1 row_mask:0xf bank_mask:0xf
    v_cvt_pk_bf16_f32 v28, v28, v29
    s_nop 1
    v_mov_b32_dpp v29, v28 row_shl:2 row_mask:0xf bank_mask:0xf
    v_mov_b32_dpp v30, v28 row_shl:4 row_mask:0xf bank_mask:0xf
    v_mov_b32_dpp v31, v28 row_shl:6 row_mask:0xf bank_mask:0xf
    s_mov_b64 exec, s[92:93]
    buffer_store_dwordx4 v[28:31], v18, s[16:19], s80 offen sc1
    buffer_store_dwordx4 v[28:31], v18, s[8:11], s81 offen
    s_cmp_eq_u32 s10, 0
    s_cbranch_scc1 SLOW10
BACK10:
    s_mov_b64 exec, -1
    v_lshrrev_b32 v37, 5, v0
    v_mul_u32_u24 v37, 2560, v37
    v_and_b32 v38, 31, v0
    v_lshl_add_u32 v37, v38, 2, v37
    v_add_u32 v41, 5120, v37
    v_add_u32 v42, 10240, v37
    v_add_u32 v43, 15360, v37
    v_add_u32 v44, 20480, v37
    v_add_u32 v45, 25600, v37
    s_lshl_b32 s79, s69, 7
    s_add_u32 s79, s79, s3
    s_add_u32 s79, s79, 51200
    s_add_u32 s96, s80, 10240
    s_add_u32 s97, s81, 1280
    v_lshlrev_b32 v39, 1, v0
    s_cmp_lg_u32 s74, 0
    s_cbranch_scc1 NOLC
    s_mul_i32 s77, s69, 2464
    s_add_u32 s78, s3, 720896
    v_add_u32 v48, s77, v1
    v_min_u32 v48, 49136, v48
    s_add_u32 s77, s77, 1024
    v_add_u32 v49, s77, v1
    v_min_u32 v49, 49136, v49
    s_add_u32 s77, s77, 1024
    v_add_u32 v50, s77, v1
    v_min_u32 v50, 49136, v50
    s_add_u32 s77, s77, 1024
    buffer_load_dwordx4 a[240:243], v48, s[16:19], s78 offen sc1
    buffer_load_dwordx4 a[240:243], v49, s[16:19], s78 offen sc1
    buffer_load_dwordx4 a[240:243], v50, s[16:19], s78 offen sc1
    v_mov_b32 v52, -1
    v_mov_b32 v53, -1
    v_mov_b32 v54, -1
    v_mov_b32 v55, -1
    s_add_u32 s77, s80, 688128
    s_add_u32 s7, s96, 688128
    s_waitcnt vmcnt(0)
    buffer_store_dwordx4 v[52:55], v48, s[8:11], s78 offen
    s_cmp_eq_u32 s10, 0
    s_cbranch_scc1 SLOW11
BACK11:
    buffer_store_dwordx4 v[52:55], v49, s[8:11], s78 offen
    s_cmp_eq_u32 s10, 0
    s_cbranch_scc1 SLOW12
BACK12:
    buffer_store_dwordx4 v[52:55], v50, s[8:11], s78 offen
    s_cmp_eq_u32 s10, 0
    s_cbranch_scc1 SLOW13
BACK13:
    s_mov_b64 exec, 15
    buffer_store_dwordx4 v[52:55], v1, s[16:19], s77 offen sc1
    buffer_store_dwordx4 v[52:55], v1, s[16:19], s7 offen sc1
    s_mov_b64 exec, -1
NOLC:
    s_mov_b32 s76, 1
POLL14:
    buffer_load_dword v28, v37, s[16:19], s79 offen sc1
    buffer_load_dword v29, v41, s[16:19], s79 offen sc1
    buffer_load_dword v30, v42, s[16:19], s79 offen sc1
    buffer_load_dword v31, v43, s[16:19], s79 offen sc1
    buffer_load_dword v32, v44, s[16:19], s79 offen sc1
    buffer_load_dword v33, v45, s[16:19], s79 offen sc1
    s_waitcnt vmcnt(0)
    v_add_f32 v28, v28, v29
    v_add_f32 v30, v30, v31
    v_add_f32 v32, v32, v33
    v_add_f32 v28, v28, v30
    v_add_f32 v29, v28, v32
    v_add_f32 v28, v28, v32
    v_cmp_u_f32 vcc, v28, v28
    s_cbranch_vccnz AGAIN14
POLLX14:
    v_permlane32_swap_b32 v28, v29
    v_add_f32 v28, v28, v29
    s_nop 1
    v_mov_b32_dpp v29, v28 row_shl:1 row_mask:0xf bank_mask:0xf
    v_cvt_pk_bf16_f32 v28, v28, v29
    s_nop 1
    v_mov_b32_dpp v29, v28 row_shl:2 row_mask:0xf bank_mask:0xf
    v_mov_b32_dpp v30, v28 row_shl:4 row_mask:0xf bank_mask:0xf
    v_mov_b32_dpp v31, v28 row_shl:6 row_mask:0xf bank_mask:0xf
    s_mov_b64 exec, s[92:93]
    buffer_store_dwordx4 v[28:31], v39, s[16:19], s96 offen sc1
    buffer_store_dwordx4 v[28:31], v39, s[8:11], s97 offen
    s_cmp_eq_u32 s10, 0
    s_cbranch_scc1 SLOW15
BACK15:
    s_mov_b64 exec, -1
    s_branch NEXT
AGAIN2:
    s_add_u32 s76, s76, 1
    s_cmp_lt_u32 s76, 32768
    s_cbranch_scc1 POLL2
    s_branch POLLX2
BR3:
    s_cmp_ge_u32 s76, 32768
    s_cbranch_scc1 BX3
BL3:
    s_mov_b64 exec, s[86:87]
    v_cmp_eq_u32 vcc, -1, v80
    s_nop 0
    s_mov_b64 exec, vcc
    s_cbranch_execz BS3_0
    buffer_load_dwordx4 v[80:83], v8, s[16:19], 0 offen sc1
BS3_0:
    s_mov_b64 exec, s[86:87]
    v_cmp_eq_u32 vcc, -1, v84
    s_nop 0
    s_mov_b64 exec, vcc
    s_cbranch_execz BS3_1
    buffer_load_dwordx4 v[84:87], v9, s[16:19], 0 offen sc1
BS3_1:
    s_mov_b64 exec, s[86:87]
    s_add_u32 s76, s76, 1
    s_cmp_ge_u32 s76, 32768
    s_waitcnt vmcnt(0)
    v_max_u32 v24, v80, v84
    v_cmp_eq_u32 vcc, -1, v24
    s_cbranch_vccz BW3
    s_cbranch_scc0 BL3
    s_branch BW3
AGAIN5:
    s_add_u32 s76, s76, 1
    s_cmp_lt_u32 s76, 32768
    s_cbranch_scc1 POLL5
    s_branch POLLX5
OML:
    v_mul_f32 v35, v32, v33
    s_nop 1
    v_add_f32_dpp v35, v35, v35 quad_perm:[1,0,3,2] row_mask:0xf bank_mask:0xf
    s_nop 1
    v_add_f32_dpp v35, v35, v35 quad_perm:[2,3,0,1] row_mask:0xf bank_mask:0xf
    s_mov_b64 exec, 1
    buffer_store_dwordx2 v[34:35], v1, s[8:11], s78 offen
    s_cmp_eq_u32 s10, 0
    s_cbranch_scc1 SLOW16
BACK16:
    s_mov_b64 exec, -1
    s_waitcnt lgkmcnt(0)
    s_branch ODONE
WLATE:
    v_lshrrev_b32 v38, 2, v0
    v_mul_u32_u24 v38, 1280, v38
    v_and_b32 v39, 3, v0
    v_lshl_add_u32 v39, v39, 4, v38
    s_mov_b32 m0, s67
    s_add_u32 s67, s67, 1024
    buffer_load_dwordx4 v39, s[24:27], s66 offen  lds
    s_add_u32 s66, s66, 20480
    s_mov_b32 m0, s67
    s_add_u32 s67, s67, 1024
    buffer_load_dwordx4 v39, s[24:27], s66 offen  lds
    s_add_u32 s66, s66, 20480
    s_mov_b32 m0, s67
    s_add_u32 s67, s67, 1024
    buffer_load_dwordx4 v39, s[24:27], s66 offen  lds
    s_add_u32 s66, s66, 20480
    s_mov_b32 m0, s67
    s_add_u32 s67, s67, 1024
    buffer_load_dwordx4 v39, s[24:27], s66 offen  lds
    s_add_u32 s66, s66, 20480
    s_add_u32 s77, s3, 1376256
    buffer_store_dword v7, v10, s[8:11], s77 offen
    s_cmp_eq_u32 s10, 0
    s_cbranch_scc1 SLOW17
BACK17:
    s_cmp_lg_u32 s72, 3
    s_cbranch_scc1 NOFPC
    v_mov_b32 v24, -1
    v_mov_b32 v25, -1
    v_mov_b32 v26, -1
    v_mov_b32 v27, -1
    v_accvgpr_read_b32 v28, a250
    buffer_store_dwordx4 v[24:27], v28, s[8:11], 0 offen
    s_cmp_eq_u32 s10, 0
    s_cbranch_scc1 SLOW18
BACK18:
    v_accvgpr_read_b32 v29, a251
    buffer_store_dwordx4 v[24:27], v29, s[8:11], 0 offen
    s_cmp_eq_u32 s10, 0
    s_cbranch_scc1 SLOW19
BACK19:
    s_add_u32 s77, s80, 10240
    s_mov_b64 exec, 15
    buffer_store_dwordx4 v[24:27], v1, s[16:19], s77 offen sc1
    s_mov_b64 exec, -1
NOFPC:
    v_accvgpr_read_b32 v2, a246
    v_accvgpr_read_b32 v3, a247
    v_accvgpr_read_b32 v4, a248
    v_mov_b32 v88, 0
    v_mov_b32 v92, 0
    v_mov_b32 v96, 0
    v_mov_b32 v100, 0
    v_mov_b32 v104, 0
    v_mov_b32 v108, 0
    v_mov_b32 v25, 0
    v_mov_b32 v27, 0
    v_mov_b32 v37, 0
    v_mov_b32 v39, 0
    s_mov_b32 exec_lo, 0x00ff00ff
    s_mov_b32 exec_hi, 0x00ff00ff
    buffer_load_dwordx4 v[88:91], v3, s[16:19], s3 offen offset:0 sc1
    buffer_load_dwordx4 v[92:95], v3, s[16:19], s3 offen offset:512 sc1
    buffer_load_dwordx4 v[96:99], v3, s[16:19], s3 offen offset:1024 sc1
    buffer_load_dwordx4 v[100:103], v3, s[16:19], s3 offen offset:1536 sc1
    buffer_load_dwordx4 v[104:107], v3, s[16:19], s3 offen offset:2048 sc1
    buffer_load_dwordx4 v[108:111], v3, s[16:19], s3 offen offset:2560 sc1
    s_mov_b32 exec_lo, -1
    s_mov_b32 exec_hi, 0
    buffer_load_dwordx4 v[24:27], v4, s[16:19], s3 offen offset:0 sc1
    buffer_load_dwordx4 v[36:39], v4, s[16:19], s3 offen offset:16 sc1
    s_mov_b64 exec, -1
    s_waitcnt vmcnt(8)
    ds_read_b64_tr_b16 v[40:41], v2 offset:0
    ds_read_b64_tr_b16 v[42:43], v2 offset:256
    ds_read_b64_tr_b16 v[64:65], v2 offset:32
    ds_read_b64_tr_b16 v[66:67], v2 offset:288
    ds_read_b64_tr_b16 v[44:45], v2 offset:2048
    ds_read_b64_tr_b16 v[46:47], v2 offset:2304
    ds_read_b64_tr_b16 v[68:69], v2 offset:2080
    ds_read_b64_tr_b16 v[70:71], v2 offset:2336
    ds_read_b64_tr_b16 v[48:49], v2 offset:4096
    ds_read_b64_tr_b16 v[50:51], v2 offset:4352
    ds_read_b64_tr_b16 v[72:73], v2 offset:4128
    ds_read_b64_tr_b16 v[74:75], v2 offset:4384
    ds_read_b64_tr_b16 v[52:53], v2 offset:6144
    ds_read_b64_tr_b16 v[54:55], v2 offset:6400
    ds_read_b64_tr_b16 v[76:77], v2 offset:6176
    ds_read_b64_tr_b16 v[78:79], v2 offset:6432
    ds_read_b64_tr_b16 v[56:57], v2 offset:8192
    ds_read_b64_tr_b16 v[58:59], v2 offset:8448
    ds_read_b64_tr_b16 v[80:81], v2 offset:8224
    ds_read_b64_tr_b16 v[82:83], v2 offset:8480
    ds_read_b64_tr_b16 v[60:61], v2 offset:10240
    ds_read_b64_tr_b16 v[62:63], v2 offset:10496
    ds_read_b64_tr_b16 v[84:85], v2 offset:10272
    ds_read_b64_tr_b16 v[86:87], v2 offset:10528
    v_accvgpr_read_b32 v5, a249
    v_lshlrev_b32 v18, 1, v0
    s_branch WCHK
AGAIN9:
    s_mov_b64 s[94:95], exec
    s_mov_b32 s76, 1
AG29:
    v_max3_u32 v28, v88, v92, v96
    v_max3_u32 v28, v28, v100, v104
    v_max_u32 v28, v28, v108
    v_cmp_eq_u32 vcc, -1, v28
    s_nop 0
    s_mov_b64 exec, vcc
    s_cbranch_execz AG39_0
    buffer_load_dwordx4 v[88:91], v3, s[16:19], s3 offen offset:0 sc1
    buffer_load_dwordx4 v[92:95], v3, s[16:19], s3 offen offset:512 sc1
    buffer_load_dwordx4 v[96:99], v3, s[16:19], s3 offen offset:1024 sc1
    buffer_load_dwordx4 v[100:103], v3, s[16:19], s3 offen offset:1536 sc1
    buffer_load_dwordx4 v[104:107], v3, s[16:19], s3 offen offset:2048 sc1
    buffer_load_dwordx4 v[108:111], v3, s[16:19], s3 offen offset:2560 sc1
AG39_0:
    s_mov_b64 exec, s[94:95]
    v_max3_u32 v28, v25, v27, v37
    v_max_u32 v28, v28, v39
    v_cmp_eq_u32 vcc, -1, v28
    s_nop 0
    s_mov_b64 exec, vcc
    s_cbranch_execz AG39_1
    buffer_load_dwordx4 v[24:27], v4, s[16:19], s3 offen offset:0 sc1
    buffer_load_dwordx4 v[36:39], v4, s[16:19], s3 offen offset:16 sc1
AG39_1:
    s_mov_b64 exec, s[94:95]
    s_add_u32 s76, s76, 1
    s_cmp_ge_u32 s76, 32768
    s_waitcnt vmcnt(0)
    v_max3_u32 v28, v88, v92, v96
    v_max3_u32 v28, v28, v100, v104
    v_max3_u32 v28, v28, v108, v25
    v_max3_u32 v28, v28, v27, v37
    v_max_u32 v28, v28, v39
    v_cmp_eq_u32 vcc, -1, v28
    s_cbranch_vccz POLLX9
    s_cbranch_scc0 AG29
    s_branch POLLX9
AGAIN14:
    s_add_u32 s76, s76, 1
    s_cmp_lt_u32 s76, 32768
    s_cbranch_scc1 POLL14
    s_branch POLLX14
WNOT0:
    s_cmp_lg_u32 s72, 1
    s_cbranch_scc1 NEXT
    v_and_b32 v25, 15, v0
    v_lshrrev_b32 v26, 4, v0
    v_mul_u32_u24 v37, 1280, v26
    v_add_u32 v37, 655360, v37
    s_mul_i32 s7, s68, 81920
    s_add_u32 s7, s7, 45312
    v_mov_b32 v38, s7
    v_cmp_eq_u32 vcc, s68, v26
    s_nop 1
    v_cndmask_b32 v37, v37, v38, vcc
    v_add_u32 v39, 4, v26
    v_mul_u32_u24 v38, 1280, v39
    v_add_u32 v38, 655360, v38
    s_mul_i32 s7, s68, 81920
    s_add_u32 s7, s7, 45312
    v_mov_b32 v28, s7
    v_cmp_eq_u32 vcc, s68, v39
    s_nop 1
    v_cndmask_b32 v38, v38, v28, vcc
    s_lshl_b32 s77, s69, 6
    s_add_u32 s77, s77, s74
    v_lshl_add_u32 v37, v25, 2, v37
    v_lshl_add_u32 v38, v25, 2, v38
    s_sleep 16
    s_mov_b32 s76, 1
POLL20:
    buffer_load_dword v28, v37, s[16:19], s77 offen sc1
    buffer_load_dword v29, v38, s[16:19], s77 offen sc1
POLLW20:
    s_waitcnt vmcnt(0)
    v_max_u32 v30, v28, v29
    v_cmp_eq_u32 vcc, -1, v30
    s_cbranch_vccnz AGAIN20
POLLX20:
    v_lshlrev_b32 v30, 16, v28
    v_and_b32 v28, 0xffff0000, v28
    v_lshlrev_b32 v31, 16, v29
    v_and_b32 v29, 0xffff0000, v29
    v_add_f32 v30, v30, v31
    v_add_f32 v28, v28, v29
    v_mov_b32 v31, v30
    v_mov_b32 v29, v28
    s_nop 0
    v_permlane32_swap_b32 v30, v31
    v_permlane32_swap_b32 v28, v29
    v_add_f32 v30, v30, v31
    v_add_f32 v28, v28, v29
    v_mov_b32 v31, v30
    v_mov_b32 v29, v28
    s_nop 0
    v_permlane16_swap_b32 v30, v31
    v_permlane16_swap_b32 v28, v29
    v_add_f32 v30, v30, v31
    v_add_f32 v28, v28, v29
    v_add_f32 v22, v22, v30
    v_add_f32 v23, v23, v28
    v_cvt_pk_bf16_f32 v28, v22, v23
    s_cmp_lg_u32 s74, 0
    s_cbranch_scc1 FINAL
    s_lshl_b32 s77, s69, 6
    s_add_u32 s77, s77, s3
    s_add_u32 s77, s77, 49152
    v_lshlrev_b32 v32, 2, v0
    v_mov_b32_dpp v29, v28 quad_perm:[1,1,1,1] row_mask:0xf bank_mask:0xf
    v_mov_b32_dpp v30, v28 quad_perm:[2,2,2,2] row_mask:0xf bank_mask:0xf
    v_mov_b32_dpp v31, v28 quad_perm:[3,3,3,3] row_mask:0xf bank_mask:0xf
    s_mov_b32 exec_lo, 0x1111
    s_mov_b32 exec_hi, 0x0
    buffer_store_dwordx4 v[28:31], v32, s[8:11], s77 offen
    s_cmp_eq_u32 s10, 0
    s_cbranch_scc1 SLOW21
BACK21:
    s_mov_b64 exec, -1
    s_branch NEXT
FINAL:
    s_cmp_lg_u32 s68, 0
    s_cbranch_scc1 DONE
    s_lshl_b32 s77, s69, 6
    v_lshlrev_b32 v37, 2, v0
    s_add_u32 s79, s77, s3
    s_add_u32 s79, s79, 46592
    s_mov_b64 exec, 15
    s_mov_b32 s76, 1
POLL22:
    buffer_load_dword v28, v1, s[16:19], s79 offen sc1
POLLW22:
    s_waitcnt vmcnt(0)
    v_cmp_eq_u32 vcc, -1, v28
    s_cbranch_vccnz AGAIN22
POLLX22:
    s_mov_b64 exec, -1
    s_mov_b32 s76, 1
POLL23:
    buffer_load_dword v28, v20, s[16:19], s74 offen sc1
    buffer_load_dword v29, v21, s[16:19], s74 offen sc1
POLLW23:
    s_waitcnt vmcnt(0)
    v_max_u32 v30, v28, v29
    v_cmp_eq_u32 vcc, -1, v30
    s_cbranch_vccnz AGAIN23
POLLX23:
    v_lshlrev_b32 v30, 16, v28
    v_and_b32 v28, 0xffff0000, v28
    v_lshlrev_b32 v31, 16, v29
    v_and_b32 v29, 0xffff0000, v29
    v_add_f32 v30, v30, v31
    v_add_f32 v28, v28, v29
    v_mov_b32 v31, v30
    v_mov_b32 v29, v28
    s_nop 0
    v_permlane32_swap_b32 v30, v31
    v_permlane32_swap_b32 v28, v29
    v_add_f32 v30, v30, v31
    v_add_f32 v28, v28, v29
    v_mov_b32 v31, v30
    v_mov_b32 v29, v28
    s_nop 0
    v_permlane16_swap_b32 v30, v31
    v_permlane16_swap_b32 v28, v29
    v_add_f32 v30, v30, v31
    v_add_f32 v28, v28, v29
    v_add_f32 v22, v22, v30
    v_add_f32 v23, v23, v28
    v_cvt_pk_bf16_f32 v28, v22, v23
    s_mov_b32 exec_lo, 0xffff
    s_mov_b32 exec_hi, 0x0
    buffer_store_dword v28, v37, s[40:43], s77 offen
    s_mov_b64 exec, -1
    s_endpgm
AGAIN20:
    s_sleep 4
    s_add_u32 s76, s76, 1
    s_cmp_lt_u32 s76, 32768
    s_cbranch_scc1 POLL20
    s_branch POLLX20
AGAIN22:
    s_add_u32 s76, s76, 1
    s_cmp_lt_u32 s76, 32768
    s_cbranch_scc1 POLL22
    s_branch POLLX22
AGAIN23:
    s_add_u32 s76, s76, 1
    s_cmp_lt_u32 s76, 32768
    s_cbranch_scc1 POLL23
    s_branch POLLX23
ROLEF:
    v_and_b32 v25, 15, v0
    v_lshrrev_b32 v26, 4, v0
    v_bfe_u32 v27, v0, 2, 2
    v_and_b32 v36, 3, v0
    s_mov_b32 s4, 1
    s_cmp_lg_u32 s74, 0
    s_cbranch_scc1 FW
    s_mov_b32 s4, 0
FW:
    s_mul_i32 s77, s72, 5120
    s_add_u32 s77, s77, 57344
    v_lshl_add_u32 v37, v26, 3, v27
    v_lshlrev_b32 v37, 5, v37
    v_lshl_add_u32 v37, v36, 3, v37
    v_add_u32 v37, s77, v37
    ds_read_b64_tr_b16 v[40:41], v37 offset:0
    ds_read_b64_tr_b16 v[42:43], v37 offset:128
    ds_read_b64_tr_b16 v[44:45], v37 offset:1024
    ds_read_b64_tr_b16 v[46:47], v37 offset:1152
    ds_read_b64_tr_b16 v[48:49], v37 offset:2048
    ds_read_b64_tr_b16 v[50:51], v37 offset:2176
    ds_read_b64_tr_b16 v[52:53], v37 offset:3072
    ds_read_b64_tr_b16 v[54:55], v37 offset:3200
    ds_read_b64_tr_b16 v[56:57], v37 offset:4096
    ds_read_b64_tr_b16 v[58:59], v37 offset:4224
    ds_read_b64_tr_b16 v[60:61], v37 offset:20480
    ds_read_b64_tr_b16 v[62:63], v37 offset:20608
    ds_read_b64_tr_b16 v[64:65], v37 offset:21504
    ds_read_b64_tr_b16 v[66:67], v37 offset:21632
    ds_read_b64_tr_b16 v[68:69], v37 offset:22528
    ds_read_b64_tr_b16 v[70:71], v37 offset:22656
    ds_read_b64_tr_b16 v[72:73], v37 offset:23552
    ds_read_b64_tr_b16 v[74:75], v37 offset:23680
    ds_read_b64_tr_b16 v[76:77], v37 offset:24576
    ds_read_b64_tr_b16 v[78:79], v37 offset:24704
    s_mul_i32 s77, s72, 320
    s_add_u32 s77, s77, 98304
    v_lshrrev_b32 v80, 2, v0
    v_mul_u32_u24 v80, 1280, v80
    v_lshl_add_u32 v80, v36, 3, v80
    v_add_u32 v80, s77, v80
    s_lshl_b32 s79, s72, 2
    s_add_u32 s79, s79, 123392
    v_add_u32 v81, s79, v1
    v_lshl_add_u32 v82, v26, 2, v36
    v_lshlrev_b32 v82, 4, v82
    v_add_u32 v82, 123392, v82
    v_cmp_eq_u32 vcc, 12, v25
    v_mov_b32 v83, 123904
    v_mov_b32 v85, 0x3727c5ac
    v_lshlrev_b32 v84, 6, v25
    v_lshl_add_u32 v84, v26, 4, v84
    s_mov_b32 s64, 0x03ff03ff
    s_mov_b32 s65, 0x03ff03ff
    s_mov_b32 s66, 0x3acccccd
    s_mov_b32 s44, 0x10001
    s_mov_b32 s45, 0x10001
    s_mov_b32 s46, 0x20002
    s_mov_b32 s47, 0x20002
    s_mov_b32 s48, 0x40004
    s_mov_b32 s49, 0x40004
    s_mov_b32 s50, 0x80008
    s_mov_b32 s51, 0x80008
    s_mov_b32 s52, 0x100010
    s_mov_b32 s53, 0x100010
    s_mov_b32 s54, 0x200020
    s_mov_b32 s55, 0x200020
    s_mov_b32 s56, 0x400040
    s_mov_b32 s57, 0x400040
    s_mov_b32 s58, 0x800080
    s_mov_b32 s59, 0x800080
    s_mov_b32 s60, 0x1000100
    s_mov_b32 s61, 0x1000100
    s_mov_b32 s62, 0x2000200
    s_mov_b32 s63, 0x2000200
    v_mov_b32 v38, 0x3f803f80
    v_cndmask_b32 v88, 0, v38, vcc
    v_mov_b32 v89, v88
    v_mov_b32 v90, v88
    v_mov_b32 v91, v88
    v_mov_b32 v92, v88
    v_mov_b32 v93, v88
    v_mov_b32 v94, v88
    v_mov_b32 v95, v88
    v_mov_b32 v96, v88
    v_mov_b32 v97, v88
    v_mov_b32 v98, v88
    v_mov_b32 v99, v88
    v_mov_b32 v100, v88
    v_mov_b32 v101, v88
    v_mov_b32 v102, v88
    v_mov_b32 v103, v88
    v_mov_b32 v104, v88
    v_mov_b32 v105, v88
    v_mov_b32 v106, v88
    v_mov_b32 v107, v88
    s_mul_i32 s77, s72, 6656
    v_mul_u32_u24 v6, 336, v25
    v_lshl_add_u32 v6, v26, 4, v6
    v_add_u32 v6, s77, v6
    v_mul_u32_u24 v37, 52, v0
    v_lshrrev_b32 v37, 10, v37
    v_lshl_add_u32 v87, v37, 4, v1
    v_add_u32 v87, s77, v87
    v_mul_u32_u24 v27, 320, v37
    v_sub_u32 v27, v1, v27
    v_mul_u32_u24 v86, 1280, v37
    v_add_u32 v86, 655360, v86
    s_mul_i32 s7, s68, 81920
    s_add_u32 s7, s7, 45312
    v_mov_b32 v38, s7
    v_cmp_eq_u32 vcc, s68, v37
    s_nop 1
    v_cndmask_b32 v86, v86, v38, vcc
    v_add_u32 v38, 2560, v38
    v_cmp_le_u32 vcc, 8, v37
    s_nop 1
    v_cndmask_b32 v86, v86, v38, vcc
    v_add_u32 v86, v86, v27
    v_add_u32 v37, 3, v37
    v_mul_u32_u24 v18, 1280, v37
    v_add_u32 v18, 655360, v18
    s_mul_i32 s7, s68, 81920
    s_add_u32 s7, s7, 45312
    v_mov_b32 v38, s7
    v_cmp_eq_u32 vcc, s68, v37
    s_nop 1
    v_cndmask_b32 v18, v18, v38, vcc
    v_add_u32 v38, 2560, v38
    v_cmp_le_u32 vcc, 8, v37
    s_nop 1
    v_cndmask_b32 v18, v18, v38, vcc
    v_add_u32 v18, v18, v27
    v_add_u32 v37, 3, v37
    v_mul_u32_u24 v20, 1280, v37
    v_add_u32 v20, 655360, v20
    s_mul_i32 s7, s68, 81920
    s_add_u32 s7, s7, 45312
    v_mov_b32 v38, s7
    v_cmp_eq_u32 vcc, s68, v37
    s_nop 1
    v_cndmask_b32 v20, v20, v38, vcc
    v_add_u32 v38, 2560, v38
    v_cmp_le_u32 vcc, 8, v37
    s_nop 1
    v_cndmask_b32 v20, v20, v38, vcc
    v_add_u32 v20, v20, v27
    s_mul_i32 s77, s72, 320
    s_add_u32 s77, s77, s74
    s_sub_u32 s78, s69, 20
    s_mul_i32 s78, s78, 2560
    s_mul_i32 s7, s72, 640
    s_add_u32 s78, s78, s7
    s_add_u32 s78, s78, s3
    s_add_u32 s78, s78, 51200
    s_waitcnt lgkmcnt(0)
    s_cmp_eq_u32 s4, 0
    s_cbranch_scc1 FW2
FPOLL:
    ds_read_b64_tr_b16 a[240:241], v80 offset:0
    ds_read_b64_tr_b16 a[242:243], v80 offset:32
    ds_read_b64_tr_b16 a[244:245], v80 offset:64
    ds_read_b64_tr_b16 a[246:247], v80 offset:96
    ds_read_b64_tr_b16 a[248:249], v80 offset:128
    ds_read_b64_tr_b16 a[250:251], v80 offset:160
    ds_read_b64_tr_b16 v[108:109], v80 offset:192
    ds_read_b64_tr_b16 v[110:111], v80 offset:224
    ds_read_b64_tr_b16 v[2:3], v80 offset:256
    ds_read_b64_tr_b16 v[4:5], v80 offset:288
    s_waitcnt lgkmcnt(0)
    s_mul_i32 s79, s72, 320
    s_add_u32 s79, s79, s3
    s_add_u32 s79, s79, 45312
    s_mov_b32 exec_lo, 0xfffff
    s_mov_b32 exec_hi, 0x0
    s_mov_b32 s76, 1
POLL24:
    buffer_load_dword v36, v1, s[16:19], s79 offen sc1
POLLW24:
    s_waitcnt vmcnt(0)
    v_cmp_eq_u32 vcc, -1, v36
    s_cbranch_vccnz AGAIN24
POLLX24:
    s_mov_b64 exec, s[86:87]
    buffer_load_dwordx4 v[24:27], v86, s[16:19], s77 offen sc1
    buffer_load_dwordx4 v[28:31], v18, s[16:19], s77 offen sc1
    buffer_load_dwordx4 v[32:35], v20, s[16:19], s77 offen sc1
    s_waitcnt vmcnt(0)
BW25:
    ds_write_b128 v87, v[24:27] offset:0
    ds_write_b128 v87, v[28:31] offset:1008
    ds_write_b128 v87, v[32:35] offset:2016
    v_max3_u32 v36, v24, v28, v32
    v_cmp_eq_u32 vcc, -1, v36
    s_mov_b64 exec, s[84:85]
    ds_read_b128 v[88:91], v6 offset:0
    ds_read_b128 v[92:95], v6 offset:64
    ds_read_b128 v[96:99], v6 offset:128
    ds_read_b128 v[100:103], v6 offset:192
    ds_read_b128 v[104:107], v6 offset:256
    s_mov_b64 exec, -1
    s_cbranch_vccnz BR25
BX25:
FMM:
    s_waitcnt lgkmcnt(4)
    v_mfma_f32_16x16x32_bf16 v[32:35], v[88:91], v[88:91], 0
    s_waitcnt lgkmcnt(3)
    v_mfma_f32_16x16x32_bf16 v[32:35], v[92:95], v[92:95], v[32:35]
    s_waitcnt lgkmcnt(2)
    v_mfma_f32_16x16x32_bf16 v[32:35], v[96:99], v[96:99], v[32:35]
    s_waitcnt lgkmcnt(1)
    v_mfma_f32_16x16x32_bf16 v[32:35], v[100:103], v[100:103], v[32:35]
    s_waitcnt lgkmcnt(0)
    v_mfma_f32_16x16x32_bf16 v[32:35], v[104:107], v[104:107], v[32:35]
    v_mfma_f32_16x16x32_bf16 v[24:27], v[88:91], v[40:43], 0
    v_mov_b32 v36, 0
    v_mov_b32 v37, 0
    v_mfma_f32_16x16x32_bf16 v[24:27], v[92:95], v[44:47], v[24:27]
    v_mov_b32 v38, 0
    s_cmp_eq_u32 s4, 0
    v_mfma_f32_16x16x32_bf16 v[24:27], v[96:99], v[48:51], v[24:27]
    v_mfma_f32_16x16x32_bf16 v[24:27], v[100:103], v[52:55], v[24:27]
    v_add_f32 v32, v32, v33
    v_add_f32 v34, v34, v35
    v_mfma_f32_16x16x32_bf16 v[24:27], v[104:107], v[56:59], v[24:27]
    v_mfma_f32_16x16x32_bf16 v[28:31], v[88:91], v[60:63], 0
    v_add_f32_dpp v36, v32, v34 quad_perm:[0,1,2,3] row_mask:0xf bank_mask:0x7
    v_mfma_f32_16x16x32_bf16 v[28:31], v[92:95], v[64:67], v[28:31]
    s_nop 0
    v_add_f32_dpp v36, v36, v36 row_ror:8 row_mask:0xf bank_mask:0xf
    v_mfma_f32_16x16x32_bf16 v[28:31], v[96:99], v[68:71], v[28:31]
    s_nop 0
    v_add_f32_dpp v36, v36, v36 row_ror:4 row_mask:0xf bank_mask:0xf
    v_mfma_f32_16x16x32_bf16 v[28:31], v[100:103], v[72:75], v[28:31]
    s_nop 0
    v_add_f32_dpp v36, v36, v36 row_ror:2 row_mask:0xf bank_mask:0xf
    v_mfma_f32_16x16x32_bf16 v[28:31], v[104:107], v[76:79], v[28:31]
    v_add_f32 v24, v24, v25
    v_add_f32_dpp v37, v36, v36 row_ror:1 row_mask:0x7 bank_mask:0xf
    v_add_f32_dpp v38, v36, v36 row_ror:1 row_mask:0x8 bank_mask:0xf
    v_add_f32 v26, v26, v27
    v_add_f32 v24, v24, v26
    s_nop 1
    v_permlane32_swap_b32 v24, v37
    v_add_f32 v28, v28, v29
    v_add_f32 v30, v30, v31
    v_add_f32 v28, v28, v30
    v_add_f32 v24, v24, v37
    s_nop 0
    v_permlane32_swap_b32 v28, v38
    v_add_f32 v28, v28, v38
    s_nop 1
    v_permlane16_swap_b32 v24, v28
    v_add_f32 v24, v24, v28
    ds_write_b32 v81, v24
    s_waitcnt lgkmcnt(0)
    s_barrier
    ds_read_b128 v[28:31], v83 offset:256
    ds_read_b128 v[24:27], v83
    ds_read_b128 v[32:35], v82
    ds_read_b128 v[36:39], v82 offset:256
    s_cbranch_scc1 FCS
    s_waitcnt lgkmcnt(3)
    v_add_f32 v28, v28, v29
    v_add_f32 v30, v30, v31
    v_add_f32 v28, v28, v30
    v_mul_f32 v28, s66, v28
    s_waitcnt lgkmcnt(2)
    v_add_f32 v24, v24, v25
    v_add_f32 v26, v26, v27
    v_add_f32 v24, v24, v26
    v_fma_f32 v24, v24, s66, v85
    v_fma_f32 v24, -v28, v28, v24
    v_add_f32 v28, 1.0, v28
    v_max_f32 v24, v24, v85
    s_waitcnt lgkmcnt(1)
    v_rsq_f32 v25, v24
    v_add_f32 v32, v32, v33
    v_add_f32 v34, v34, v35
    v_add_f32 v32, v32, v34
    v_mul_f32 v25, 0xbfb8aa3b, v25
    v_fma_f32 v32, -v28, v22, v32
    v_mul_f32 v33, v32, v25
    v_exp_f32 v33, v33
    s_waitcnt lgkmcnt(0)
    v_add_f32 v36, v36, v37
    v_fma_f32 v33, v33, v24, v24
    v_rcp_f32 v33, v33
    v_add_f32 v38, v38, v39
    v_add_f32 v36, v36, v38
    v_mul_f32 v33, v33, v32
    v_fma_f32 v36, -v28, v23, v36
    v_mul_f32 v36, v36, v33
    s_nop 1
    v_mov_b32_dpp v28, v36 quad_perm:[0,0,0,0] row_mask:0xf bank_mask:0xf
    v_mov_b32_dpp v29, v36 quad_perm:[1,1,1,1] row_mask:0xf bank_mask:0xf
    v_mov_b32_dpp v30, v36 quad_perm:[2,2,2,2] row_mask:0xf bank_mask:0xf
    v_mov_b32_dpp v31, v36 quad_perm:[3,3,3,3] row_mask:0xf bank_mask:0xf
    v_cvt_pk_bf16_f32 v28, v28, v29
    v_cvt_pk_bf16_f32 v29, v30, v31
    v_cndmask_b32 v60, 0, v28, s[44:45]
    v_cndmask_b32 v61, 0, v29, s[44:45]
    v_cndmask_b32 v62, 0, v28, s[46:47]
    v_cndmask_b32 v63, 0, v29, s[46:47]
    v_cndmask_b32 v64, 0, v28, s[48:49]
    v_cndmask_b32 v65, 0, v29, s[48:49]
    v_mfma_f32_16x16x32_bf16 v[24:27], a[240:243], v[60:63], 0
    v_cndmask_b32 v66, 0, v28, s[50:51]
    v_cndmask_b32 v67, 0, v29, s[50:51]
    v_cndmask_b32 v68, 0, v28, s[52:53]
    v_cndmask_b32 v69, 0, v29, s[52:53]
    v_mfma_f32_16x16x32_bf16 v[24:27], a[244:247], v[64:67], v[24:27]
    v_cndmask_b32 v70, 0, v28, s[54:55]
    v_cndmask_b32 v71, 0, v29, s[54:55]
    v_cndmask_b32 v72, 0, v28, s[56:57]
    v_cndmask_b32 v73, 0, v29, s[56:57]
    v_mfma_f32_16x16x32_bf16 v[24:27], a[248:251], v[68:71], v[24:27]
    v_cndmask_b32 v74, 0, v28, s[58:59]
    v_cndmask_b32 v75, 0, v29, s[58:59]
    v_cndmask_b32 v76, 0, v28, s[60:61]
    v_cndmask_b32 v77, 0, v29, s[60:61]
    v_mfma_f32_16x16x32_bf16 v[24:27], v[108:111], v[72:75], v[24:27]
    v_cndmask_b32 v78, 0, v28, s[62:63]
    v_cndmask_b32 v79, 0, v29, s[62:63]
    s_nop 1
    v_mfma_f32_16x16x32_bf16 v[24:27], v[2:5], v[76:79], v[24:27]
    s_mov_b64 exec, s[64:65]
    s_nop 6
    buffer_store_dwordx4 v[24:27], v84, s[8:11], s78 offen
    s_cmp_eq_u32 s10, 0
    s_cbranch_scc1 SLOW26
BACK26:
    s_mov_b64 exec, -1
NEXT:
    s_cmp_lg_u32 s74, 0
    s_cbranch_scc1 DONE
    s_mov_b32 s74, 688128
    s_add_u32 s3, s3, 688128
    s_add_u32 s80, s80, 688128
    s_add_u32 s81, s81, 688128
    s_branch LOOP
AGAIN24:
    s_add_u32 s76, s76, 1
    s_cmp_lt_u32 s76, 32768
    s_cbranch_scc1 POLL24
    s_branch POLLX24
BR25:
    s_cmp_ge_u32 s76, 32768
    s_cbranch_scc1 BX25
BL25:
    s_mov_b64 exec, s[86:87]
    v_cmp_eq_u32 vcc, -1, v24
    s_nop 0
    s_mov_b64 exec, vcc
    s_cbranch_execz BS25_0
    buffer_load_dwordx4 v[24:27], v86, s[16:19], s77 offen sc1
BS25_0:
    s_mov_b64 exec, s[86:87]
    v_cmp_eq_u32 vcc, -1, v28
    s_nop 0
    s_mov_b64 exec, vcc
    s_cbranch_execz BS25_1
    buffer_load_dwordx4 v[28:31], v18, s[16:19], s77 offen sc1
BS25_1:
    s_mov_b64 exec, s[86:87]
    v_cmp_eq_u32 vcc, -1, v32
    s_nop 0
    s_mov_b64 exec, vcc
    s_cbranch_execz BS25_2
    buffer_load_dwordx4 v[32:35], v20, s[16:19], s77 offen sc1
BS25_2:
    s_mov_b64 exec, s[86:87]
    s_add_u32 s76, s76, 1
    s_cmp_ge_u32 s76, 32768
    s_waitcnt vmcnt(0)
    v_max3_u32 v36, v24, v28, v32
    v_cmp_eq_u32 vcc, -1, v36
    s_cbranch_vccz BW25
    s_cbranch_scc0 BL25
    s_branch BW25
DONE:
    s_endpgm
TAGLOOP:
    s_mov_b32 s76, 0
TAGL2:
    s_sleep 8
    global_load_dword v98, v100, s[64:65] sc1
    s_waitcnt vmcnt(0)
    v_readfirstlane_b32 s96, v98
    s_nop 0
    s_cmp_lg_u32 s96, 0
    s_cbranch_scc1 TAGOK
    s_add_u32 s76, s76, 1
    s_cmp_lt_u32 s76, 32768
    s_cbranch_scc1 TAGL2
    s_branch TAGOK
DMAF:
    v_lshrrev_b32 v38, 1, v0
    v_mul_u32_u24 v38, 3072, v38
    v_and_b32 v39, 1, v0
    v_lshl_add_u32 v38, v39, 4, v38
    s_mul_i32 s79, s68, 12
    s_add_u32 s79, s79, s69
    s_sub_u32 s79, s79, 20
    s_mul_i32 s77, s72, 491520
    s_lshl_b32 s78, s79, 5
    s_add_u32 s77, s77, s78
    s_mul_i32 s78, s72, 5120
    s_add_u32 m0, s78, 57344
    s_nop 0
    buffer_load_dwordx4 v38, s[24:27], s77 offen  lds
    s_add_u32 m0, s78, 77824
    s_nop 0
    buffer_load_dwordx4 v38, s[28:31], s77 offen  lds
    s_add_u32 s77, s77, 98304
    s_add_u32 m0, s78, 58368
    s_nop 0
    buffer_load_dwordx4 v38, s[24:27], s77 offen  lds
    s_add_u32 m0, s78, 78848
    s_nop 0
    buffer_load_dwordx4 v38, s[28:31], s77 offen  lds
    s_add_u32 s77, s77, 98304
    s_add_u32 m0, s78, 59392
    s_nop 0
    buffer_load_dwordx4 v38, s[24:27], s77 offen  lds
    s_add_u32 m0, s78, 79872
    s_nop 0
    buffer_load_dwordx4 v38, s[28:31], s77 offen  lds
    s_add_u32 s77, s77, 98304
    s_add_u32 m0, s78, 60416
    s_nop 0
    buffer_load_dwordx4 v38, s[24:27], s77 offen  lds
    s_add_u32 m0, s78, 80896
    s_nop 0
    buffer_load_dwordx4 v38, s[28:31], s77 offen  lds
    s_add_u32 s77, s77, 98304
    s_add_u32 m0, s78, 61440
    s_nop 0
    buffer_load_dwordx4 v38, s[24:27], s77 offen  lds
    s_add_u32 m0, s78, 81920
    s_nop 0
    buffer_load_dwordx4 v38, s[28:31], s77 offen  lds
    s_branch DMAX
RDYLOOP:
    s_mov_b32 s76, 0
RDYL2:
    s_sleep 8
    buffer_load_dwordx2 v[98:99], v100, s[16:19], 0 offen offset:384 sc1
    s_waitcnt vmcnt(0)
    v_cmp_ne_u32 vcc, s96, v98
    s_cbranch_vccz RDYOK
    s_add_u32 s76, s76, 1
    s_cmp_lt_u32 s76, 32768
    s_cbranch_scc1 RDYL2
    s_branch RDYOK
SLOW1:
    buffer_store_dwordx4 v[28:31], v27, s[16:19], s77 offen sc1
    s_branch BACK1
SLOW4:
    buffer_store_dword v24, v10, s[16:19], s3 offen sc1
    s_branch BACK4
SLOW6:
    buffer_store_dwordx4 v[28:31], v1, s[16:19], s77 offen sc1
    s_branch BACK6
RETRY7:
    s_mov_b32 s76, 1
POLL27:
    buffer_load_dword v28, v20, s[16:19], 0 offen sc1
    buffer_load_dword v29, v21, s[16:19], 0 offen sc1
POLLW27:
    s_waitcnt vmcnt(0)
    v_max_u32 v30, v28, v29
    v_cmp_eq_u32 vcc, -1, v30
    s_cbranch_vccnz AGAIN27
POLLX27:
    s_branch OK7
AGAIN27:
    s_add_u32 s76, s76, 1
    s_cmp_lt_u32 s76, 32768
    s_cbranch_scc1 POLL27
    s_branch POLLX27
SLOW8:
    buffer_store_dwordx4 v[28:31], v32, s[16:19], s77 offen sc1
    s_branch BACK8
SLOW10:
    buffer_store_dwordx4 v[28:31], v18, s[16:19], s81 offen sc1
    s_branch BACK10
SLOW11:
    buffer_store_dwordx4 v[52:55], v48, s[16:19], s78 offen sc1
    s_branch BACK11
SLOW12:
    buffer_store_dwordx4 v[52:55], v49, s[16:19], s78 offen sc1
    s_branch BACK12
SLOW13:
    buffer_store_dwordx4 v[52:55], v50, s[16:19], s78 offen sc1
    s_branch BACK13
SLOW15:
    buffer_store_dwordx4 v[28:31], v39, s[16:19], s97 offen sc1
    s_branch BACK15
SLOW16:
    buffer_store_dwordx2 v[34:35], v1, s[16:19], s78 offen sc1
    s_branch BACK16
SLOW17:
    buffer_store_dword v7, v10, s[16:19], s77 offen sc1
    s_branch BACK17
SLOW18:
    buffer_store_dwordx4 v[24:27], v28, s[16:19], 0 offen sc1
    s_branch BACK18
SLOW19:
    buffer_store_dwordx4 v[24:27], v29, s[16:19], 0 offen sc1
    s_branch BACK19
SLOW21:
    buffer_store_dwordx4 v[28:31], v32, s[16:19], s77 offen sc1
    s_branch BACK21
FW2:
    s_add_u32 s96, s3, 1376256
    buffer_store_dword v7, v10, s[8:11], s96 offen
    s_cmp_eq_u32 s10, 0
    s_cbranch_scc1 SLOW28
BACK28:
    s_mul_i32 s79, s68, 12
    s_add_u32 s79, s79, s69
    s_sub_u32 s79, s79, 20
    s_mul_i32 s97, s72, 5120
    s_mul_i32 s96, s79, 20480
    s_add_u32 s96, s96, s97
    s_add_u32 m0, s97, 98304
    s_nop 0
    buffer_load_dwordx4 v1, s[32:35], s96 offen nt lds
    s_add_u32 s96, s96, 1024
    s_add_u32 m0, s97, 99328
    s_nop 0
    buffer_load_dwordx4 v1, s[32:35], s96 offen nt lds
    s_add_u32 s96, s96, 1024
    s_add_u32 m0, s97, 100352
    s_nop 0
    buffer_load_dwordx4 v1, s[32:35], s96 offen nt lds
    s_add_u32 s96, s96, 1024
    s_add_u32 m0, s97, 101376
    s_nop 0
    buffer_load_dwordx4 v1, s[32:35], s96 offen nt lds
    s_add_u32 s96, s96, 1024
    s_add_u32 m0, s97, 102400
    s_nop 0
    buffer_load_dwordx4 v1, s[32:35], s96 offen nt lds
    s_sub_u32 s96, s69, 20
    s_lshl_b32 s96, s96, 2
    s_add_u32 s96, s96, s72
    s_mul_i32 s96, s96, 688
    v_add_u32 v21, s96, v1
    v_min_u32 v21, 32752, v21
    s_add_u32 s97, s3, 688128
    buffer_load_dwordx4 a[240:243], v21, s[16:19], s97 offen sc1
    s_branch FMM
SLOW26:
    buffer_store_dwordx4 v[24:27], v84, s[16:19], s78 offen sc1
    s_branch BACK26
FCS:
    s_waitcnt lgkmcnt(0)
    v_add_f32 v32, v32, v33
    v_add_f32 v34, v34, v35
    v_add_f32 v32, v32, v34
    v_add_f32 v36, v36, v37
    v_add_f32 v38, v38, v39
    v_add_f32 v36, v36, v38
    v_mov_b32 v22, v32
    v_mov_b32 v23, v36
    s_mov_b32 s4, 1
    s_waitcnt vmcnt(0)
    v_mov_b32 v24, -1
    v_mov_b32 v25, -1
    v_mov_b32 v26, -1
    v_mov_b32 v27, -1
    buffer_store_dwordx4 v[24:27], v21, s[8:11], s97 offen
    s_cmp_eq_u32 s10, 0
    s_cbranch_scc1 SLOW29
BACK29:
    s_barrier
    s_branch FPOLL
SLOW28:
    buffer_store_dword v7, v10, s[16:19], s96 offen sc1
    s_branch BACK28
SLOW29:
    buffer_store_dwordx4 v[24:27], v21, s[16:19], s97 offen sc1
    s_branch BACK29
CODE_END:
    s_endpgm
.section .rodata,"a"
.p2align 6
.amdhsa_kernel interleave_layers__sliding_block_cached__glu_gated_swiglu__decode_kernel
  .amdhsa_next_free_vgpr 512
  .amdhsa_next_free_sgpr 102
  .amdhsa_accum_offset 256
  .amdhsa_group_segment_fixed_size 0
  .amdhsa_kernarg_size 96
  .amdhsa_user_sgpr_count 2
  .amdhsa_user_sgpr_kernarg_segment_ptr 1
  .amdhsa_system_sgpr_workgroup_id_x 1
.end_amdhsa_kernel
```

```asm
; @launch grid=(256,1,1) block=(256,1,1) lds=125568
.amdgcn_target "amdgcn-amd-amdhsa--gfx950"
.text
.globl interleave_layers__sliding_block_cached__glu_gated_swiglu__decode_kernel
.p2align 8
.type interleave_layers__sliding_block_cached__glu_gated_swiglu__decode_kernel,@function
interleave_layers__sliding_block_cached__glu_gated_swiglu__decode_kernel:
    s_load_dwordx16 s[44:59], s[0:1], 0
    s_load_dwordx8 s[60:67], s[0:1], 64
    s_cmp_ge_u32 s2, 256
    s_cbranch_scc1 CODE_END
    s_memrealtime s[96:97]
    v_lshrrev_b32 v2, 6, v0
    v_and_b32 v24, 63, v0
    v_readfirstlane_b32 s72, v2
    s_and_b32 s68, s2, 7
    s_lshr_b32 s69, s2, 3
    s_lshr_b32 s70, s69, 3
    s_and_b32 s71, s69, 7
    v_lshlrev_b32 v1, 4, v24
    s_lshl_b32 s77, s70, 3
    s_add_u32 s77, s77, s68
    s_mul_i32 s73, s77, 12582912
    s_lshl_b32 s78, s71, 2
    s_add_u32 s78, s78, s72
    s_mul_i32 s78, s78, 6144
    s_add_u32 s73, s73, s78
    s_add_u32 s73, s73, 11010048
    v_add_u32 v23, 4096, v1
    s_mov_b32 s10, 402653184
    s_mov_b32 s11, 0x20000
    s_getpc_b64 s[100:101]
PCREF:
    s_sub_u32 s100, s100, PCREF-interleave_layers__sliding_block_cached__glu_gated_swiglu__decode_kernel
    s_subb_u32 s101, s101, 0
    s_lshl_b32 s78, s71, 12
    v_lshl_add_u32 v25, v0, 4, s78
    v_cmp_gt_u32 vcc, CODE_END-interleave_layers__sliding_block_cached__glu_gated_swiglu__decode_kernel-16, v25
    s_nop 0
    s_and_saveexec_b64 s[98:99], vcc
    s_cbranch_execz NOCPF
    global_load_dwordx4 a[240:243], v25, s[100:101]
NOCPF:
    s_mov_b64 exec, -1
    s_mul_i32 s79, s77, 384
    s_mov_b32 s74, 0
    s_mul_i32 s3, s68, 81920
    s_mov_b32 s75, 0
    s_lshl_b32 s77, s69, 9
    s_add_u32 s77, s77, s3
    s_add_u32 s77, s77, 32768
    v_add_u32 v20, s77, v1
    s_lshl_b32 s77, s68, 2
    s_add_u32 s77, s77, s69
    s_mul_i32 s77, s77, 320
    s_add_u32 s77, s77, 654848
    v_add_u32 v25, s77, v1
    v_cmp_le_u32 vcc, 32, v0
    s_nop 1
    v_cndmask_b32 v21, v20, v25, vcc
    v_mov_b32 v25, 2147483632
    v_cndmask_b32 v20, v20, v25, vcc
    s_cmp_lt_u32 s69, 4
    s_cselect_b32 s77, 52, 32
    v_cmp_le_u32 vcc, s77, v0
    s_nop 1
    v_cndmask_b32 v21, v21, v25, vcc
    s_mov_b32 s18, 1610612736
    s_mov_b32 s19, 0x20000
    s_waitcnt lgkmcnt(0)
    s_mov_b32 s8, s46
    s_and_b32 s9, s47, 0xffff
    s_mov_b32 s16, s66
    s_and_b32 s17, s67, 0xffff
    buffer_load_dwordx4 a[0:3], v1, s[8:11], s73 offen offset:0 nt
    buffer_load_dwordx4 a[4:7], v1, s[8:11], s73 offen offset:1024 nt
    s_or_b32 s77, s2, s72
    s_cbranch_scc1 NOTAG
    s_or_b32 s77, s96, 1
    v_mov_b32 v26, s77
    s_mov_b64 exec, 1
    global_store_dword v1, v26, s[64:65] sc1
    s_mov_b64 exec, -1
NOTAG:
    s_add_u32 s83, s73, 196608
    s_mov_b32 s12, s48
    s_and_b32 s13, s49, 0xffff
    s_mov_b32 s14, 402653184
    s_mov_b32 s15, 0x20000
    s_mov_b32 s20, s50
    s_and_b32 s21, s51, 0xffff
    s_mov_b32 s22, 7864320
    s_mov_b32 s23, 0x20000
    s_mov_b32 s36, s44
    s_and_b32 s37, s45, 0xffff
    s_mov_b32 s38, 1280
    s_mov_b32 s39, 0x20000
    s_mov_b32 s40, s62
    s_and_b32 s41, s63, 0xffff
    s_mov_b32 s42, 1280
    s_mov_b32 s43, 0x20000
    s_mov_b32 s28, s58
    s_and_b32 s29, s59, 0xffff
    s_mov_b32 s30, 1966080
    s_mov_b32 s31, 0x20000
    s_mov_b32 s32, s60
    s_and_b32 s33, s61, 0xffff
    s_mov_b32 s34, 1966080
    s_mov_b32 s35, 0x20000
    s_cmp_lt_u32 s69, 20
    s_cselect_b32 s24, s52, s56
    s_cselect_b32 s25, s53, s57
    s_cselect_b32 s26, s22, s30
    s_and_b32 s25, s25, 0xffff
    s_mov_b32 s27, 0x20000
    s_add_u32 s84, s83, 196608
    s_add_u32 s85, s84, 196608
    s_add_u32 s86, s85, 196608
    s_add_u32 s87, s86, 196608
    s_add_u32 s88, s87, 196608
    s_add_u32 s89, s88, 196608
    v_mov_b32 v0, v24
    s_mul_i32 s77, s72, 6656
    v_add_u32 v25, 0, v0
    v_mul_u32_u24 v26, 171, v25
    v_lshrrev_b32 v26, 12, v26
    v_mul_u32_u24 v27, 24, v26
    v_sub_u32 v27, v25, v27
    v_lshlrev_b32 v27, 4, v27
    v_mul_u32_u24 v25, 416, v26
    v_add3_u32 v2, v25, v27, s77
    v_mul_u32_u24 v25, 12288, v26
    v_add_u32 v40, v25, v27
    v_mul_u32_u24 v25, 3072, v26
    v_add_u32 v101, v25, v27
    v_add_u32 v25, 64, v0
    v_mul_u32_u24 v26, 171, v25
    v_lshrrev_b32 v26, 12, v26
    v_mul_u32_u24 v27, 24, v26
    v_sub_u32 v27, v25, v27
    v_lshlrev_b32 v27, 4, v27
    v_mul_u32_u24 v25, 416, v26
    v_add3_u32 v3, v25, v27, s77
    v_mul_u32_u24 v25, 12288, v26
    v_add_u32 v41, v25, v27
    v_mul_u32_u24 v25, 3072, v26
    v_add_u32 v102, v25, v27
    v_add_u32 v25, 128, v0
    v_mul_u32_u24 v26, 171, v25
    v_lshrrev_b32 v26, 12, v26
    v_mul_u32_u24 v27, 24, v26
    v_sub_u32 v27, v25, v27
    v_lshlrev_b32 v27, 4, v27
    v_mul_u32_u24 v25, 416, v26
    v_add3_u32 v4, v25, v27, s77
    v_mul_u32_u24 v25, 12288, v26
    v_add_u32 v42, v25, v27
    v_mul_u32_u24 v25, 3072, v26
    v_add_u32 v103, v25, v27
    v_and_b32 v25, 15, v0
    v_lshrrev_b32 v26, 4, v0
    v_bfe_u32 v27, v0, 2, 2
    v_and_b32 v28, 3, v0
    s_mul_i32 s78, s71, 160
    v_lshlrev_b32 v36, 4, v26
    v_lshlrev_b32 v37, 3, v26
    v_lshlrev_b32 v39, 2, v0
    buffer_load_dwordx4 v[70:73], v36, s[36:39], s78 offen
    buffer_load_dwordx4 v[74:77], v36, s[36:39], s78 offen offset:64
    buffer_load_dwordx2 v[78:79], v37, s[36:39], s78 offen offset:128
    buffer_load_dwordx4 v[80:83], v1, s[36:39], 0 offen
    buffer_load_dword v84, v39, s[36:39], 0 offen offset:1024
    s_lshl_b32 s7, s69, 6
    v_lshlrev_b32 v38, 2, v25
    buffer_load_dword v22, v38, s[36:39], s7 offen
    s_mul_i32 s78, s71, 983040
    s_add_u32 s79, s79, s78
    s_mul_i32 s78, s72, 98304
    s_add_u32 s79, s79, s78
    s_mul_i32 s78, s72, 3072
    s_add_u32 s78, s78, 26624
    s_add_u32 m0, s78, 0
    s_nop 0
    buffer_load_dwordx4 v40, s[20:23], s79 offen nt lds
    s_add_u32 m0, s78, 1024
    s_nop 0
    buffer_load_dwordx4 v41, s[20:23], s79 offen nt lds
    s_add_u32 m0, s78, 2048
    s_nop 0
    buffer_load_dwordx4 v42, s[20:23], s79 offen nt lds
    s_add_u32 s79, s79, 393216
    s_add_u32 m0, s78, 12288
    s_nop 0
    buffer_load_dwordx4 v40, s[20:23], s79 offen nt lds
    s_add_u32 m0, s78, 13312
    s_nop 0
    buffer_load_dwordx4 v41, s[20:23], s79 offen nt lds
    s_add_u32 m0, s78, 14336
    s_nop 0
    buffer_load_dwordx4 v42, s[20:23], s79 offen nt lds
    s_add_u32 s79, s79, 393216
    s_cmp_ge_u32 s72, 2
    s_cbranch_scc1 NOWQ3
    s_add_u32 m0, s78, 24576
    s_nop 0
    buffer_load_dwordx4 v40, s[20:23], s79 offen nt lds
    s_add_u32 m0, s78, 25600
    s_nop 0
    buffer_load_dwordx4 v41, s[20:23], s79 offen nt lds
    s_add_u32 m0, s78, 26624
    s_nop 0
    buffer_load_dwordx4 v42, s[20:23], s79 offen nt lds
NOWQ3:
    s_mul_i32 s78, s71, 160
    s_mov_b32 s20, s52
    s_and_b32 s21, s53, 0xffff
    s_mov_b32 s22, 7864320
    s_mov_b32 s23, 0x20000
    s_cmp_lt_u32 s72, 2
    s_cselect_b32 s36, s56, s58
    s_cselect_b32 s37, s57, s59
    s_and_b32 s37, s37, 0xffff
    s_mov_b32 s38, 1966080
    s_lshl_b32 s90, s70, 3
    s_add_u32 s90, s90, s68
    s_lshl_b32 s90, s90, 3
    s_add_u32 s90, s90, s71
    s_mul_i32 s90, s90, 30720
    s_mul_i32 s79, s72, 6144
    s_add_u32 s90, s90, s79
    s_cmp_eq_u32 s72, 3
    s_cselect_b32 s79, 3072, 0
    s_add_u32 s90, s90, s79
    s_cmp_lt_u32 s72, 2
    s_cselect_b32 s79, 1879048176, 0
    v_add_u32 v108, s79, v23
    v_add_u32 v109, 4096, v108
    s_and_b32 s91, s72, 1
    s_lshl_b32 s79, s69, 1
    s_add_u32 s91, s91, s79
    s_mul_i32 s79, s91, 0
    s_add_u32 s79, s79, 640
    s_mul_i32 s91, s91, 16
    s_cmp_lt_u32 s69, 20
    s_cselect_b32 s91, s91, s79
    s_mov_b32 s7, 49152
    s_cselect_b32 s7, s7, 0
    s_mul_i32 s91, s91, 3072
    s_mul_i32 s79, s68, 384
    s_add_u32 s91, s91, s79
    v_mov_b32 v29, 1879048176
    v_add_u32 v104, 24576, v101
    v_add_u32 v105, 24576, v102
    v_add_u32 v106, 24576, v103
    v_cmp_gt_u32 vcc, s7, v101
    s_nop 1
    v_cndmask_b32 v101, v29, v101, vcc
    v_cmp_gt_u32 vcc, s7, v102
    s_nop 1
    v_cndmask_b32 v102, v29, v102, vcc
    v_cmp_gt_u32 vcc, s7, v103
    s_nop 1
    v_cndmask_b32 v103, v29, v103, vcc
    v_cmp_gt_u32 vcc, s7, v104
    s_nop 1
    v_cndmask_b32 v104, v29, v104, vcc
    v_cmp_gt_u32 vcc, s7, v105
    s_nop 1
    v_cndmask_b32 v105, v29, v105, vcc
    v_cmp_gt_u32 vcc, s7, v106
    s_nop 1
    v_cndmask_b32 v106, v29, v106, vcc
    buffer_load_dwordx4 a[8:11], v1, s[8:11], s73 offen offset:2048 nt
    buffer_load_dwordx4 a[12:15], v1, s[8:11], s73 offen offset:3072 nt
    buffer_load_dwordx4 a[16:19], v23, s[8:11], s73 offen offset:0 nt
    v_mul_u32_u24 v29, 416, v25
    v_lshl_add_u32 v29, v26, 4, v29
    v_add_u32 v5, s77, v29
    v_lshrrev_b32 v29, 2, v0
    v_mul_u32_u24 v29, 416, v29
    v_lshl_add_u32 v29, v28, 3, v29
    v_add_u32 v6, s77, v29
    s_mul_i32 s79, s72, 96
    s_add_u32 s79, s79, 26624
    v_lshl_add_u32 v29, v26, 3, v27
    v_mul_u32_u24 v29, 384, v29
    v_lshl_add_u32 v29, v28, 3, v29
    v_add_u32 v16, s79, v29
    v_lshl_add_u32 v29, v26, 2, v27
    v_mul_u32_u24 v29, 384, v29
    v_lshl_add_u32 v29, v28, 3, v29
    v_add_u32 v17, s79, v29
    buffer_load_dwordx4 a[20:23], v23, s[8:11], s73 offen offset:1024 nt
    v_mul_u32_u24 v31, 103, v0
    v_lshrrev_b32 v31, 10, v31
    v_mul_u32_u24 v30, 10, v31
    v_sub_u32 v30, v0, v30
    v_lshl_add_u32 v29, v30, 4, s78
    s_mul_i32 s7, s68, 10240
    s_add_u32 s7, s7, 737280
    v_mul_u32_u24 v8, 1280, v31
    v_add_u32 v8, s7, v8
    s_mul_i32 s7, s68, 81920
    s_add_u32 s7, s7, 46592
    v_mov_b32 v30, s7
    v_cmp_eq_u32 vcc, s68, v31
    s_nop 1
    v_cndmask_b32 v8, v8, v30, vcc
    v_add_u32 v30, 2560, v30
    v_cmp_le_u32 vcc, 8, v31
    s_nop 1
    v_cndmask_b32 v8, v8, v30, vcc
    v_add_u32 v8, v8, v29
    v_add_u32 v31, 6, v31
    s_mul_i32 s7, s68, 10240
    s_add_u32 s7, s7, 737280
    v_mul_u32_u24 v9, 1280, v31
    v_add_u32 v9, s7, v9
    s_mul_i32 s7, s68, 81920
    s_add_u32 s7, s7, 46592
    v_mov_b32 v30, s7
    v_cmp_eq_u32 vcc, s68, v31
    s_nop 1
    v_cndmask_b32 v9, v9, v30, vcc
    v_add_u32 v30, 2560, v30
    v_cmp_le_u32 vcc, 8, v31
    s_nop 1
    v_cndmask_b32 v9, v9, v30, vcc
    v_add_u32 v9, v9, v29
    v_mov_b32 v30, 2147483632
    v_cmp_le_u32 vcc, 30, v0
    s_nop 1
    v_cndmask_b32 v9, v9, v30, vcc
    s_lshl_b32 s78, s69, 10
    s_lshl_b32 s79, s72, 8
    s_add_u32 s78, s78, s79
    v_lshl_add_u32 v10, v0, 2, s78
    s_lshl_b32 s78, s70, 13
    s_add_u32 s78, s78, s79
    v_lshlrev_b32 v29, 10, v26
    v_lshl_add_u32 v29, v25, 4, v29
    v_add_u32 v11, s78, v29
    buffer_load_dwordx4 a[24:27], v1, s[8:11], s83 offen offset:0 nt
    s_mul_i32 s78, s72, 96
    s_add_u32 s78, s78, 118784
    v_lshl_add_u32 v29, v27, 5, s78
    v_lshl_add_u32 v29, v28, 2, v29
    v_lshrrev_b32 v30, 1, v26
    v_lshl_add_u32 v29, v30, 4, v29
    v_and_b32 v30, 1, v26
    v_lshl_add_u32 v29, v30, 1, v29
    v_mov_b32 v30, 119168
    v_cmp_le_u32 vcc, 12, v25
    s_nop 1
    v_cndmask_b32 v12, v29, v30, vcc
    v_and_b32 v30, 1, v0
    v_lshlrev_b32 v29, 5, v26
    v_lshl_add_u32 v29, v30, 4, v29
    v_add_u32 v13, 118784, v29
    v_mul_u32_u24 v30, 0xaaaa, v30
    v_and_b32 v29, 1, v27
    v_mul_u32_u24 v29, 0xaaaa, v29
    v_lshl_or_b32 v29, v29, 16, v30
    v_add_u32 v14, 0x44444444, v29
    buffer_load_dwordx4 a[28:31], v1, s[8:11], s83 offen offset:1024 nt
    s_lshl_b32 s78, s72, 8
    s_add_u32 s78, s78, 124416
    v_lshrrev_b32 v29, 5, v0
    v_lshl_add_u32 v29, v29, 6, s78
    v_bfe_u32 v30, v0, 3, 1
    v_lshl_add_u32 v29, v30, 5, v29
    v_bfe_u32 v30, v0, 1, 1
    v_lshl_add_u32 v29, v30, 4, v29
    v_bfe_u32 v30, v0, 2, 1
    v_lshl_add_u32 v29, v30, 3, v29
    v_bfe_u32 v30, v0, 4, 1
    v_lshl_add_u32 v29, v30, 2, v29
    v_bfe_u32 v30, v0, 0, 1
    v_lshl_add_u32 v29, v30, 1, v29
    v_mov_b32 v19, v29
    v_bfe_u32 v29, v0, 4, 1
    v_bfe_u32 v30, v0, 2, 1
    v_lshl_add_u32 v29, v29, 5, s78
    v_lshl_add_u32 v29, v30, 4, v29
    v_accvgpr_write_b32 a252, v29
    s_mul_i32 s78, s72, 768
    s_add_u32 s78, s78, 119296
    v_lshl_add_u32 v29, v25, 2, s78
    v_bfe_u32 v30, v0, 4, 1
    v_lshl_add_u32 v29, v30, 7, v29
    v_lshrrev_b32 v30, 5, v0
    v_lshl_add_u32 v15, v30, 6, v29
    s_waitcnt vmcnt(12)
    v_lshlrev_b32 v88, 16, v80
    v_and_b32 v89, 0xffff0000, v80
    v_lshlrev_b32 v90, 16, v81
    v_and_b32 v91, 0xffff0000, v81
    v_lshlrev_b32 v92, 16, v82
    v_and_b32 v93, 0xffff0000, v82
    v_lshlrev_b32 v94, 16, v83
    v_and_b32 v95, 0xffff0000, v83
    v_lshlrev_b32 v96, 16, v84
    v_and_b32 v97, 0xffff0000, v84
    v_add_f32 v80, v88, v89
    v_add_f32 v80, v80, v90
    v_add_f32 v80, v80, v91
    v_add_f32 v80, v80, v92
    v_add_f32 v80, v80, v93
    v_add_f32 v80, v80, v94
    v_add_f32 v80, v80, v95
    v_add_f32 v80, v80, v96
    v_add_f32 v80, v80, v97
    s_nop 1
    v_add_f32_dpp v80, v80, v80 row_ror:8 row_mask:0xf bank_mask:0xf
    s_nop 1
    v_add_f32_dpp v80, v80, v80 row_ror:4 row_mask:0xf bank_mask:0xf
    s_nop 1
    v_add_f32_dpp v80, v80, v80 row_ror:2 row_mask:0xf bank_mask:0xf
    s_nop 1
    v_add_f32_dpp v80, v80, v80 row_ror:1 row_mask:0xf bank_mask:0xf
    v_mov_b32 v81, v80
    s_nop 1
    v_permlane32_swap_b32 v80, v81
    v_add_f32 v80, v80, v81
    v_mov_b32 v81, v80
    s_nop 1
    v_permlane16_swap_b32 v80, v81
    v_add_f32 v80, v80, v81
    v_mul_f32 v80, 0x3acccccd, v80
    v_sub_f32 v88, v88, v80
    v_sub_f32 v89, v89, v80
    v_sub_f32 v90, v90, v80
    v_sub_f32 v91, v91, v80
    v_sub_f32 v92, v92, v80
    v_sub_f32 v93, v93, v80
    v_sub_f32 v94, v94, v80
    v_sub_f32 v95, v95, v80
    v_sub_f32 v96, v96, v80
    v_sub_f32 v97, v97, v80
    v_mul_f32 v82, v88, v88
    v_fmac_f32 v82, v89, v89
    v_fmac_f32 v82, v90, v90
    v_fmac_f32 v82, v91, v91
    v_fmac_f32 v82, v92, v92
    v_fmac_f32 v82, v93, v93
    v_fmac_f32 v82, v94, v94
    v_fmac_f32 v82, v95, v95
    v_fmac_f32 v82, v96, v96
    v_fmac_f32 v82, v97, v97
    buffer_load_dwordx4 a[32:35], v1, s[8:11], s83 offen offset:2048 nt
    s_nop 0
    v_add_f32_dpp v82, v82, v82 row_ror:8 row_mask:0xf bank_mask:0xf
    s_nop 1
    v_add_f32_dpp v82, v82, v82 row_ror:4 row_mask:0xf bank_mask:0xf
    s_nop 1
    v_add_f32_dpp v82, v82, v82 row_ror:2 row_mask:0xf bank_mask:0xf
    s_nop 1
    v_add_f32_dpp v82, v82, v82 row_ror:1 row_mask:0xf bank_mask:0xf
    v_mov_b32 v81, v82
    s_nop 1
    v_permlane32_swap_b32 v82, v81
    v_add_f32 v82, v82, v81
    v_mov_b32 v81, v82
    s_nop 1
    v_permlane16_swap_b32 v82, v81
    v_add_f32 v82, v82, v81
    v_mul_f32 v82, 0x3acccccd, v82
    v_add_f32 v82, 0x3727c5ac, v82
    v_rsq_f32 v82, v82
    s_mov_b32 vcc_lo, 0xaaaaaaaa
    s_mov_b32 vcc_hi, 0xaaaaaaaa
    v_mov_b32 v85, 0x3f803f80
    v_lshlrev_b32 v83, 16, v70
    v_and_b32 v84, 0xffff0000, v70
    v_sub_f32 v83, v83, v80
    v_sub_f32 v84, v84, v80
    v_mul_f32 v83, v83, v82
    v_mul_f32 v84, v84, v82
    v_cvt_pk_bf16_f32 v83, v83, v84
    v_cndmask_b32 v70, v83, v85, vcc
    v_lshlrev_b32 v83, 16, v71
    v_and_b32 v84, 0xffff0000, v71
    v_sub_f32 v83, v83, v80
    v_sub_f32 v84, v84, v80
    v_mul_f32 v83, v83, v82
    v_mul_f32 v84, v84, v82
    v_cvt_pk_bf16_f32 v83, v83, v84
    v_cndmask_b32 v71, v83, v85, vcc
    v_lshlrev_b32 v83, 16, v72
    v_and_b32 v84, 0xffff0000, v72
    v_sub_f32 v83, v83, v80
    v_sub_f32 v84, v84, v80
    v_mul_f32 v83, v83, v82
    v_mul_f32 v84, v84, v82
    v_cvt_pk_bf16_f32 v83, v83, v84
    v_cndmask_b32 v72, v83, v85, vcc
    v_lshlrev_b32 v83, 16, v73
    v_and_b32 v84, 0xffff0000, v73
    v_sub_f32 v83, v83, v80
    v_sub_f32 v84, v84, v80
    v_mul_f32 v83, v83, v82
    v_mul_f32 v84, v84, v82
    v_cvt_pk_bf16_f32 v83, v83, v84
    v_cndmask_b32 v73, v83, v85, vcc
    v_lshlrev_b32 v83, 16, v74
    v_and_b32 v84, 0xffff0000, v74
    v_sub_f32 v83, v83, v80
    v_sub_f32 v84, v84, v80
    v_mul_f32 v83, v83, v82
    v_mul_f32 v84, v84, v82
    v_cvt_pk_bf16_f32 v83, v83, v84
    v_cndmask_b32 v74, v83, v85, vcc
    v_lshlrev_b32 v83, 16, v75
    v_and_b32 v84, 0xffff0000, v75
    v_sub_f32 v83, v83, v80
    v_sub_f32 v84, v84, v80
    v_mul_f32 v83, v83, v82
    v_mul_f32 v84, v84, v82
    v_cvt_pk_bf16_f32 v83, v83, v84
    v_cndmask_b32 v75, v83, v85, vcc
    buffer_load_dwordx4 a[36:39], v1, s[8:11], s83 offen offset:3072 nt
    v_lshlrev_b32 v83, 16, v76
    v_and_b32 v84, 0xffff0000, v76
    v_sub_f32 v83, v83, v80
    v_sub_f32 v84, v84, v80
    v_mul_f32 v83, v83, v82
    v_mul_f32 v84, v84, v82
    v_cvt_pk_bf16_f32 v83, v83, v84
    v_cndmask_b32 v76, v83, v85, vcc
    v_lshlrev_b32 v83, 16, v77
    v_and_b32 v84, 0xffff0000, v77
    v_sub_f32 v83, v83, v80
    v_sub_f32 v84, v84, v80
    v_mul_f32 v83, v83, v82
    v_mul_f32 v84, v84, v82
    v_cvt_pk_bf16_f32 v83, v83, v84
    v_cndmask_b32 v77, v83, v85, vcc
    v_lshlrev_b32 v83, 16, v78
    v_and_b32 v84, 0xffff0000, v78
    v_sub_f32 v83, v83, v80
    v_sub_f32 v84, v84, v80
    v_mul_f32 v83, v83, v82
    v_mul_f32 v84, v84, v82
    v_cvt_pk_bf16_f32 v83, v83, v84
    v_cndmask_b32 v78, v83, v85, vcc
    v_lshlrev_b32 v83, 16, v79
    v_and_b32 v84, 0xffff0000, v79
    v_sub_f32 v83, v83, v80
    v_sub_f32 v84, v84, v80
    v_mul_f32 v83, v83, v82
    v_mul_f32 v84, v84, v82
    v_cvt_pk_bf16_f32 v83, v83, v84
    v_cndmask_b32 v79, v83, v85, vcc
    s_waitcnt vmcnt(8)
    s_barrier
    ds_read_b64_tr_b16 v[40:41], v16 offset:0
    ds_read_b64_tr_b16 v[42:43], v16 offset:1536
    ds_read_b64_tr_b16 v[44:45], v16 offset:12288
    ds_read_b64_tr_b16 v[46:47], v16 offset:13824
    ds_read_b64_tr_b16 v[48:49], v17 offset:24576
    ds_read_b64_tr_b16 v[50:51], v16 offset:32
    ds_read_b64_tr_b16 v[52:53], v16 offset:1568
    ds_read_b64_tr_b16 v[54:55], v16 offset:12320
    ds_read_b64_tr_b16 v[56:57], v16 offset:13856
    ds_read_b64_tr_b16 v[58:59], v17 offset:24608
    ds_read_b64_tr_b16 v[60:61], v16 offset:64
    ds_read_b64_tr_b16 v[62:63], v16 offset:1600
    ds_read_b64_tr_b16 v[64:65], v16 offset:12352
    ds_read_b64_tr_b16 v[66:67], v16 offset:13888
    ds_read_b64_tr_b16 v[68:69], v17 offset:24640
    v_mov_b32 v100, 0
    s_cmp_lg_u32 s72, 0
    s_cbranch_scc1 NOTL
    s_mov_b64 exec, 1
    global_load_dword v98, v100, s[64:65] sc1
    s_mov_b64 exec, -1
NOTL:
    buffer_load_dwordx4 a[40:43], v23, s[8:11], s83 offen offset:0 nt
    buffer_load_dwordx4 a[44:47], v23, s[8:11], s83 offen offset:1024 nt
    s_mul_i32 s79, s72, 96
    s_add_u32 s79, s79, 119296
    v_min_u32 v36, 48, v0
    v_lshl_add_u32 v36, v36, 1, s79
    v_mov_b32 v37, 119808
    v_cmp_le_u32 vcc, 48, v0
    s_nop 1
    v_cndmask_b32 v36, v36, v37, vcc
    v_add_u32 v37, 119296, v1
    s_waitcnt lgkmcnt(0)
    v_mfma_f32_16x16x32_bf16 v[24:27], v[70:73], v[40:43], 0
    v_mfma_f32_16x16x32_bf16 v[28:31], v[70:73], v[50:53], 0
    v_mfma_f32_16x16x32_bf16 v[32:35], v[70:73], v[60:63], 0
    v_mfma_f32_16x16x32_bf16 v[24:27], v[74:77], v[44:47], v[24:27]
    v_mfma_f32_16x16x32_bf16 v[28:31], v[74:77], v[54:57], v[28:31]
    v_mfma_f32_16x16x32_bf16 v[32:35], v[74:77], v[64:67], v[32:35]
    v_mfma_f32_16x16x16_bf16 v[24:27], v[78:79], v[48:49], v[24:27]
    v_mfma_f32_16x16x16_bf16 v[28:31], v[78:79], v[58:59], v[28:31]
    v_mfma_f32_16x16x16_bf16 v[32:35], v[78:79], v[68:69], v[32:35]
    buffer_load_dwordx4 a[48:51], v1, s[8:11], s84 offen offset:0 nt
    s_nop 4
    v_mov_b32 v7, v25
    v_mov_b32_dpp v24, v28 quad_perm:[0,1,2,3] row_mask:0x2 bank_mask:0xf
    s_nop 0
    v_mov_b32_dpp v7, v29 quad_perm:[0,1,2,3] row_mask:0x2 bank_mask:0xf
    v_mov_b32_dpp v24, v32 quad_perm:[0,1,2,3] row_mask:0x4 bank_mask:0xf
    s_nop 0
    v_mov_b32_dpp v7, v33 quad_perm:[0,1,2,3] row_mask:0x4 bank_mask:0xf
    v_cvt_pk_bf16_f32 v24, v24, v24
    ds_write_b16 v36, v24
    buffer_load_dwordx4 a[52:55], v1, s[8:11], s84 offen offset:1024 nt
    buffer_load_dwordx4 a[56:59], v1, s[8:11], s84 offen offset:2048 nt
    s_waitcnt lgkmcnt(0)
    s_barrier
    ds_read_b128 v[28:31], v37
    s_lshl_b32 s79, s69, 9
    s_add_u32 s79, s79, s3
    s_cmp_eq_u32 s72, 0
    s_cselect_b32 exec_lo, 0xffffff, 1
    s_mov_b32 exec_hi, 0
    s_cselect_b32 s78, 0, 1879048176
    v_add_u32 v37, s78, v1
    s_waitcnt lgkmcnt(0)
    buffer_store_dwordx4 v[28:31], v37, s[16:19], s79 offen sc1
    s_mov_b64 exec, -1
    v_mov_b32 v32, -1
    v_mov_b32 v33, -1
    v_mov_b32 v34, -1
    v_mov_b32 v35, -1
    buffer_store_dwordx4 v[32:35], v21, s[16:19], 0 offen sc1
    buffer_load_dwordx4 a[60:63], v1, s[8:11], s84 offen offset:3072 nt
    s_waitcnt vmcnt(12)
    ds_write_b128 v2, a[0:3] offset:0
    ds_write_b128 v3, a[4:7] offset:0
    ds_write_b128 v4, a[8:11] offset:0
    ds_write_b128 v2, a[12:15] offset:3328
    ds_write_b128 v3, a[16:19] offset:3328
    ds_write_b128 v4, a[20:23] offset:3328
    ds_read_b128 a[0:3], v5 offset:0
    ds_read_b128 a[4:7], v5 offset:64
    ds_read_b128 a[8:11], v5 offset:128
    ds_read_b128 a[12:15], v5 offset:192
    ds_read_b128 a[16:19], v5 offset:256
    ds_read_b128 a[20:23], v5 offset:320
    buffer_load_dwordx4 a[64:67], v23, s[8:11], s84 offen offset:0 nt
    buffer_load_dwordx4 a[68:71], v23, s[8:11], s84 offen offset:1024 nt
    s_barrier
    buffer_load_dwordx4 a[72:75], v1, s[8:11], s85 offen offset:0 nt
    buffer_load_dwordx4 a[76:79], v1, s[8:11], s85 offen offset:1024 nt
    buffer_load_dwordx4 a[80:83], v1, s[8:11], s85 offen offset:2048 nt
    buffer_load_dwordx4 a[84:87], v1, s[8:11], s85 offen offset:3072 nt
    buffer_load_dwordx4 a[88:91], v23, s[8:11], s85 offen offset:0 nt
    buffer_load_dwordx4 a[92:95], v23, s[8:11], s85 offen offset:1024 nt
    s_barrier
    s_getreg_b32 s5, hwreg(HW_REG_XCC_ID, 0, 4)
    s_cmp_lg_u32 s72, 0
    s_cbranch_scc1 NOHDR
    s_waitcnt vmcnt(9)
    v_readfirstlane_b32 s96, v98
    s_nop 0
    s_cmp_eq_u32 s96, 0
    s_cbranch_scc1 TAGLOOP
TAGOK:
    v_mov_b32 v99, s5
    s_mov_b64 exec, 1
    buffer_store_dwordx2 v[98:99], v1, s[16:19], s79 offen offset:384 sc1
    s_mov_b64 exec, -1
NOHDR:
    s_waitcnt vmcnt(14)
    ds_write_b128 v2, a[24:27] offset:0
    ds_write_b128 v3, a[28:31] offset:0
    ds_write_b128 v4, a[32:35] offset:0
    ds_write_b128 v2, a[36:39] offset:3328
    ds_write_b128 v3, a[40:43] offset:3328
    ds_write_b128 v4, a[44:47] offset:3328
    ds_read_b128 a[24:27], v5 offset:0
    ds_read_b128 a[28:31], v5 offset:64
    ds_read_b128 a[32:35], v5 offset:128
    ds_read_b128 a[36:39], v5 offset:192
    ds_read_b128 a[40:43], v5 offset:256
    ds_read_b128 a[44:47], v5 offset:320
    buffer_load_dwordx4 a[240:243], v101, s[36:39], s91 offen
    buffer_load_dwordx4 a[240:243], v102, s[36:39], s91 offen
    buffer_load_dwordx4 a[240:243], v103, s[36:39], s91 offen
    buffer_load_dwordx4 a[240:243], v104, s[36:39], s91 offen
    buffer_load_dwordx4 a[240:243], v105, s[36:39], s91 offen
    buffer_load_dwordx4 a[240:243], v106, s[36:39], s91 offen
    s_barrier
    s_waitcnt vmcnt(12)
    ds_write_b128 v2, a[48:51] offset:0
    ds_write_b128 v3, a[52:55] offset:0
    ds_write_b128 v4, a[56:59] offset:0
    ds_write_b128 v2, a[60:63] offset:3328
    ds_write_b128 v3, a[64:67] offset:3328
    ds_write_b128 v4, a[68:71] offset:3328
    ds_read_b128 a[48:51], v5 offset:0
    ds_read_b128 a[52:55], v5 offset:64
    ds_read_b128 a[56:59], v5 offset:128
    ds_read_b128 a[60:63], v5 offset:192
    ds_read_b128 a[64:67], v5 offset:256
    ds_read_b128 a[68:71], v5 offset:320
    v_lshlrev_b32 v100, 9, v0
    v_add_u32 v100, s3, v100
    v_bfe_u32 v96, v0, 2, 3
    v_mul_u32_u24 v96, 81920, v96
    v_and_b32 v97, 3, v0
    v_lshl_add_u32 v96, v97, 9, v96
    v_cmp_le_u32 vcc, 32, v0
    s_nop 1
    v_cndmask_b32 v100, v100, v96, vcc
    s_cmp_eq_u32 s72, 0
    s_cselect_b32 s77, 0, 1879048176
    v_add_u32 v100, s77, v100
    buffer_load_dwordx4 a[96:99], v1, s[8:11], s86 offen offset:0 nt
    buffer_load_dwordx4 a[100:103], v1, s[8:11], s86 offen offset:1024 nt
    buffer_load_dwordx4 a[104:107], v1, s[8:11], s86 offen offset:2048 nt
    buffer_load_dwordx4 a[108:111], v1, s[8:11], s86 offen offset:3072 nt
    buffer_load_dwordx4 a[112:115], v23, s[8:11], s86 offen offset:0 nt
    buffer_load_dwordx4 a[116:119], v23, s[8:11], s86 offen offset:1024 nt
    s_barrier
    buffer_load_dwordx4 a[120:123], v1, s[8:11], s87 offen offset:0 nt
    buffer_load_dwordx4 a[124:127], v1, s[8:11], s87 offen offset:1024 nt
    buffer_load_dwordx4 a[128:131], v1, s[8:11], s87 offen offset:2048 nt
    buffer_load_dwordx4 a[132:135], v1, s[8:11], s87 offen offset:3072 nt
    buffer_load_dwordx4 a[136:139], v23, s[8:11], s87 offen offset:0 nt
    buffer_load_dwordx4 a[140:143], v23, s[8:11], s87 offen offset:1024 nt
    s_barrier
    s_waitcnt vmcnt(18)
    ds_write_b128 v2, a[72:75] offset:0
    ds_write_b128 v3, a[76:79] offset:0
    ds_write_b128 v4, a[80:83] offset:0
    ds_write_b128 v2, a[84:87] offset:3328
    ds_write_b128 v3, a[88:91] offset:3328
    ds_write_b128 v4, a[92:95] offset:3328
    ds_read_b128 a[72:75], v5 offset:0
    ds_read_b128 a[76:79], v5 offset:64
    ds_read_b128 a[80:83], v5 offset:128
    ds_read_b128 a[84:87], v5 offset:192
    ds_read_b128 a[88:91], v5 offset:256
    ds_read_b128 a[92:95], v5 offset:320
    buffer_load_dwordx4 a[144:147], v1, s[8:11], s88 offen offset:0 nt
    buffer_load_dwordx4 a[148:151], v1, s[8:11], s88 offen offset:1024 nt
    buffer_load_dwordx4 a[152:155], v1, s[8:11], s88 offen offset:2048 nt
    buffer_load_dwordx4 a[156:159], v1, s[8:11], s88 offen offset:3072 nt
    buffer_load_dwordx4 a[160:163], v23, s[8:11], s88 offen offset:0 nt
    buffer_load_dwordx4 a[164:167], v23, s[8:11], s88 offen offset:1024 nt
    s_barrier
    s_waitcnt vmcnt(12)
    ds_write_b128 v2, a[96:99] offset:0
    ds_write_b128 v3, a[100:103] offset:0
    ds_write_b128 v4, a[104:107] offset:0
    ds_write_b128 v2, a[108:111] offset:3328
    ds_write_b128 v3, a[112:115] offset:3328
    ds_write_b128 v4, a[116:119] offset:3328
    ds_read_b128 a[96:99], v5 offset:0
    ds_read_b128 a[100:103], v5 offset:64
    ds_read_b128 a[104:107], v5 offset:128
    ds_read_b128 a[108:111], v5 offset:192
    ds_read_b128 a[112:115], v5 offset:256
    ds_read_b128 a[116:119], v5 offset:320
    buffer_load_dwordx4 a[168:171], v1, s[8:11], s89 offen offset:0 nt
    buffer_load_dwordx4 a[172:175], v1, s[8:11], s89 offen offset:1024 nt
    buffer_load_dwordx4 a[176:179], v1, s[8:11], s89 offen offset:2048 nt
    buffer_load_dwordx4 a[180:183], v1, s[8:11], s89 offen offset:3072 nt
    buffer_load_dwordx4 a[184:187], v23, s[8:11], s89 offen offset:0 nt
    buffer_load_dwordx4 a[188:191], v23, s[8:11], s89 offen offset:1024 nt
    s_barrier
    s_cmp_ge_u32 s69, 20
    s_cbranch_scc1 DMAF
    s_lshl_b32 s66, s72, 3
    s_add_u32 s66, s66, s68
    s_mul_i32 s66, s66, 245760
    s_lshl_b32 s78, s69, 6
    s_add_u32 s66, s66, s78
    s_mul_i32 s67, s72, 12288
    s_add_u32 s67, s67, 57344
    v_lshrrev_b32 v38, 2, v0
    v_mul_u32_u24 v38, 1280, v38
    v_and_b32 v39, 3, v0
    v_lshl_add_u32 v39, v39, 4, v38
    s_mov_b32 m0, s67
    s_add_u32 s67, s67, 1024
    buffer_load_dwordx4 v39, s[24:27], s66 offen  lds
    s_add_u32 s66, s66, 20480
    s_mov_b32 m0, s67
    s_add_u32 s67, s67, 1024
    buffer_load_dwordx4 v39, s[24:27], s66 offen  lds
    s_add_u32 s66, s66, 20480
DMAX:
    v_mov_b32 v109, v20
    v_and_b32 v25, 15, v0
    v_lshrrev_b32 v26, 4, v0
    v_add_u32 v27, 4, v26
    s_mul_i32 s7, s68, 10240
    s_add_u32 s7, s7, 737280
    v_mul_u32_u24 v20, 1280, v26
    v_add_u32 v20, s7, v20
    s_mul_i32 s7, s68, 81920
    s_add_u32 s7, s7, 46592
    v_mov_b32 v28, s7
    v_cmp_eq_u32 vcc, s68, v26
    s_nop 1
    v_cndmask_b32 v20, v20, v28, vcc
    s_mul_i32 s7, s68, 10240
    s_add_u32 s7, s7, 737280
    v_mul_u32_u24 v21, 1280, v27
    v_add_u32 v21, s7, v21
    s_mul_i32 s7, s68, 81920
    s_add_u32 s7, s7, 46592
    v_mov_b32 v28, s7
    v_cmp_eq_u32 vcc, s68, v27
    s_nop 1
    v_cndmask_b32 v21, v21, v28, vcc
    s_min_u32 s7, s69, 19
    s_lshl_b32 s7, s7, 6
    v_lshl_add_u32 v25, v25, 2, s7
    v_add_u32 v20, v20, v25
    v_add_u32 v21, v21, v25
    buffer_load_dwordx4 a[216:219], v1, s[12:15], s73 offen offset:0 nt
    v_and_b32 v25, 15, v0
    v_bfe_u32 v27, v0, 2, 2
    v_and_b32 v28, 3, v0
    s_mul_i32 s7, s72, 12288
    s_add_u32 s7, s7, 57344
    v_lshl_add_u32 v29, v26, 3, v27
    v_lshlrev_b32 v29, 6, v29
    v_lshl_add_u32 v29, v28, 3, v29
    v_add_u32 v29, s7, v29
    v_accvgpr_write_b32 a246, v29
    s_mul_i32 s7, s72, 3072
    s_add_u32 s7, s7, 32768
    v_lshl_add_u32 v29, v25, 4, s7
    v_lshl_add_u32 v29, v26, 7, v29
    v_accvgpr_write_b32 a247, v29
    s_lshl_b32 s7, s72, 6
    s_add_u32 s7, s7, 45056
    v_and_b32 v29, 1, v26
    v_lshl_add_u32 v29, v29, 5, s7
    v_accvgpr_write_b32 a248, v29
    s_lshl_b32 s7, s72, 8
    s_add_u32 s7, s7, 122368
    v_lshl_add_u32 v29, v0, 2, s7
    v_accvgpr_write_b32 a249, v29
    s_lshl_b32 s81, s69, 6
    s_mul_i32 s80, s68, 1280
    s_add_u32 s80, s80, s81
    s_add_u32 s80, s80, 655360
    s_add_u32 s81, s81, s3
    s_add_u32 s81, s81, 45312
    s_waitcnt vmcnt(13)
    ds_write_b128 v2, a[120:123] offset:0
    ds_write_b128 v3, a[124:127] offset:0
    ds_write_b128 v4, a[128:131] offset:0
    ds_write_b128 v2, a[132:135] offset:3328
    ds_write_b128 v3, a[136:139] offset:3328
    ds_write_b128 v4, a[140:143] offset:3328
    ds_read_b128 a[120:123], v5 offset:0
    ds_read_b128 a[124:127], v5 offset:64
    ds_read_b128 a[128:131], v5 offset:128
    ds_read_b128 a[132:135], v5 offset:192
    ds_read_b128 a[136:139], v5 offset:256
    ds_read_b128 a[140:143], v5 offset:320
    buffer_load_dwordx4 a[220:223], v1, s[12:15], s73 offen offset:1024 nt
    buffer_load_dwordx4 a[224:227], v1, s[12:15], s73 offen offset:2048 nt
    buffer_load_dwordx4 a[228:231], v1, s[12:15], s73 offen offset:3072 nt
    buffer_load_dwordx4 a[232:235], v23, s[12:15], s73 offen offset:0 nt
    buffer_load_dwordx4 a[236:239], v23, s[12:15], s73 offen offset:1024 nt
    s_barrier
    buffer_load_dwordx2 v[98:99], v100, s[16:19], 0 offen offset:384 sc1
    s_waitcnt vmcnt(13)
    ds_write_b128 v2, a[144:147] offset:0
    ds_write_b128 v3, a[148:151] offset:0
    ds_write_b128 v4, a[152:155] offset:0
    ds_write_b128 v2, a[156:159] offset:3328
    ds_write_b128 v3, a[160:163] offset:3328
    ds_write_b128 v4, a[164:167] offset:3328
    ds_read_b128 a[144:147], v5 offset:0
    ds_read_b128 a[148:151], v5 offset:64
    ds_read_b128 a[152:155], v5 offset:128
    ds_read_b128 a[156:159], v5 offset:192
    ds_read_b128 a[160:163], v5 offset:256
    ds_read_b128 a[164:167], v5 offset:320
    buffer_load_dwordx4 v[112:115], v1, s[12:15], s83 offen offset:0 nt
    buffer_load_dwordx4 v[116:119], v1, s[12:15], s83 offen offset:1024 nt
    buffer_load_dwordx4 v[120:123], v1, s[12:15], s83 offen offset:2048 nt
    buffer_load_dwordx4 v[124:127], v1, s[12:15], s83 offen offset:3072 nt
    buffer_load_dwordx4 v[128:131], v23, s[12:15], s83 offen offset:0 nt
    buffer_load_dwordx4 v[132:135], v23, s[12:15], s83 offen offset:1024 nt
    s_barrier
    s_waitcnt vmcnt(13)
    ds_write_b128 v2, a[168:171] offset:0
    ds_write_b128 v3, a[172:175] offset:0
    ds_write_b128 v4, a[176:179] offset:0
    ds_write_b128 v2, a[180:183] offset:3328
    ds_write_b128 v3, a[184:187] offset:3328
    ds_write_b128 v4, a[188:191] offset:3328
    ds_read_b128 a[168:171], v5 offset:0
    ds_read_b128 a[172:175], v5 offset:64
    ds_read_b128 a[176:179], v5 offset:128
    ds_read_b128 a[180:183], v5 offset:192
    ds_read_b128 a[184:187], v5 offset:256
    ds_read_b128 a[188:191], v5 offset:320
    buffer_load_dwordx4 v[136:139], v1, s[12:15], s84 offen offset:0 nt
    buffer_load_dwordx4 v[140:143], v1, s[12:15], s84 offen offset:1024 nt
    buffer_load_dwordx4 v[144:147], v1, s[12:15], s84 offen offset:2048 nt
    buffer_load_dwordx4 v[148:151], v1, s[12:15], s84 offen offset:3072 nt
    buffer_load_dwordx4 v[152:155], v23, s[12:15], s84 offen offset:0 nt
    buffer_load_dwordx4 v[156:159], v23, s[12:15], s84 offen offset:1024 nt
    s_barrier
    s_waitcnt vmcnt(12)
    s_mov_b32 s76, -1
    v_mov_b32 v97, 125504
    s_cmp_lg_u32 s72, 0
    s_cbranch_scc1 RDYX
    v_cmp_ne_u32 vcc, s96, v98
    s_cbranch_vccnz RDYLOOP
RDYOK:
    v_cmp_ne_u32 vcc, s5, v99
    s_nop 1
    v_mov_b32 v96, vcc_lo
    ds_write_b32 v97, v96
RDYX:
    buffer_load_dwordx4 v[160:163], v1, s[12:15], s85 offen offset:0 nt
    buffer_load_dwordx4 v[164:167], v1, s[12:15], s85 offen offset:1024 nt
    s_waitcnt lgkmcnt(0)
    s_barrier
    ds_read_b32 v96, v97
    s_waitcnt lgkmcnt(0)
    v_readfirstlane_b32 s77, v96
    s_nop 0
    s_cmp_eq_u32 s77, 0
    s_cselect_b32 s10, s18, 0
    s_mov_b32 s8, s16
    s_mov_b32 s9, s17
    s_mov_b32 s11, 0x20000
    buffer_load_dwordx4 a[240:243], v109, s[16:19], 0 offen sc1
    v_lshrrev_b32 v106, 3, v0
    v_mul_u32_u24 v106, 2560, v106
    v_and_b32 v107, 7, v0
    v_lshl_add_u32 v106, v107, 4, v106
    s_lshl_b32 s77, s69, 7
    s_add_u32 s77, s77, s3
    s_add_u32 s77, s77, 51200
    s_cmp_lt_u32 s69, 20
    s_cselect_b32 s77, s77, 1879048176
    s_cmp_eq_u32 s72, 3
    s_cselect_b32 s77, s77, 1879048176
    v_add_u32 v106, s77, v106
    v_add_u32 v107, 20480, v106
    v_mov_b32 v108, 2147483632
    v_cmp_le_u32 vcc, 32, v0
    s_lshl_b32 s78, s69, 6
    s_sub_u32 s78, s77, s78
    s_sub_u32 s78, s78, 2560
    v_add_u32 v24, s78, v1
    v_cndmask_b32 v107, v107, v24, vcc
    v_cmp_le_u32 vcc, 36, v0
    s_nop 1
    v_cndmask_b32 v107, v107, v108, vcc
    buffer_load_dwordx4 a[240:243], v106, s[16:19], 0 offen sc1
    v_accvgpr_write_b32 a250, v106
    buffer_load_dwordx4 a[240:243], v107, s[16:19], 0 offen sc1
    v_accvgpr_write_b32 a251, v107
    s_lshl_b32 s77, s70, 12
    s_mul_i32 s78, s72, 96
    s_add_u32 s77, s77, s78
    s_add_u32 s77, s77, s3
    v_lshrrev_b32 v24, 4, v0
    v_lshlrev_b32 v24, 9, v24
    v_and_b32 v25, 15, v0
    v_min_u32 v25, 11, v25
    v_lshl_add_u32 v24, v25, 3, v24
    buffer_load_dwordx2 v[64:65], v24, s[16:19], s77 offen offset:0 sc1
    buffer_load_dwordx2 v[66:67], v24, s[16:19], s77 offen offset:2048 sc1
    s_cmp_lg_u32 s72, 1
    s_cbranch_scc1 NOBASE0
    s_cmp_ge_u32 s69, 20
    s_cbranch_scc1 NOBASE0
    v_mov_b32 v28, v22
    s_lshl_b32 s77, s69, 6
    s_add_u32 s77, s77, s3
    s_add_u32 s77, s77, 47872
    v_lshlrev_b32 v27, 2, v0
    v_mov_b32_dpp v29, v28 quad_perm:[1,1,1,1] row_mask:0xf bank_mask:0xf
    v_mov_b32_dpp v30, v28 quad_perm:[2,2,2,2] row_mask:0xf bank_mask:0xf
    v_mov_b32_dpp v31, v28 quad_perm:[3,3,3,3] row_mask:0xf bank_mask:0xf
    s_mov_b32 exec_lo, 0x1111
    s_mov_b32 exec_hi, 0x0
    buffer_store_dwordx4 v[28:31], v27, s[8:11], s77 offen
    s_cmp_eq_u32 s10, 0
    s_cbranch_scc1 SLOW1
BACK1:
    s_mov_b64 exec, -1
NOBASE0:
    ds_write_b128 v2, a[216:219] offset:0
    ds_write_b128 v3, a[220:223] offset:0
    ds_write_b128 v4, a[224:227] offset:0
    ds_write_b128 v2, a[228:231] offset:3328
    ds_write_b128 v3, a[232:235] offset:3328
    ds_write_b128 v4, a[236:239] offset:3328
    ds_read_b64_tr_b16 a[192:193], v6 offset:0
    ds_read_b64_tr_b16 a[196:197], v6 offset:32
    ds_read_b64_tr_b16 a[200:201], v6 offset:64
    ds_read_b64_tr_b16 a[204:205], v6 offset:96
    ds_read_b64_tr_b16 a[208:209], v6 offset:128
    ds_read_b64_tr_b16 a[212:213], v6 offset:160
    ds_read_b64_tr_b16 a[216:217], v6 offset:192
    ds_read_b64_tr_b16 a[220:221], v6 offset:224
    ds_read_b64_tr_b16 a[224:225], v6 offset:256
    ds_read_b64_tr_b16 a[228:229], v6 offset:288
    ds_read_b64_tr_b16 a[232:233], v6 offset:320
    ds_read_b64_tr_b16 a[236:237], v6 offset:352
    s_waitcnt vmcnt(13)
    ds_write_b128 v2, v[112:115] offset:0
    ds_write_b128 v3, v[116:119] offset:0
    ds_write_b128 v4, v[120:123] offset:0
    ds_write_b128 v2, v[124:127] offset:3328
    ds_write_b128 v3, v[128:131] offset:3328
    ds_write_b128 v4, v[132:135] offset:3328
    ds_read_b64_tr_b16 a[194:195], v6 offset:0
    ds_read_b64_tr_b16 a[198:199], v6 offset:32
    ds_read_b64_tr_b16 a[202:203], v6 offset:64
    ds_read_b64_tr_b16 a[206:207], v6 offset:96
    ds_read_b64_tr_b16 a[210:211], v6 offset:128
    ds_read_b64_tr_b16 a[214:215], v6 offset:160
    ds_read_b64_tr_b16 a[218:219], v6 offset:192
    ds_read_b64_tr_b16 a[222:223], v6 offset:224
    ds_read_b64_tr_b16 a[226:227], v6 offset:256
    ds_read_b64_tr_b16 a[230:231], v6 offset:288
    ds_read_b64_tr_b16 a[234:235], v6 offset:320
    ds_read_b64_tr_b16 a[238:239], v6 offset:352
    buffer_load_dwordx4 v[168:171], v1, s[12:15], s85 offen offset:2048 nt
    buffer_load_dwordx4 v[172:175], v1, s[12:15], s85 offen offset:3072 nt
    buffer_load_dwordx4 v[176:179], v23, s[12:15], s85 offen offset:0 nt
    buffer_load_dwordx4 v[180:183], v23, s[12:15], s85 offen offset:1024 nt
    s_barrier
    buffer_load_dwordx4 v[184:187], v1, s[12:15], s86 offen offset:0 nt
    s_waitcnt vmcnt(12)
    ds_write_b128 v2, v[136:139] offset:0
    ds_write_b128 v3, v[140:143] offset:0
    ds_write_b128 v4, v[144:147] offset:0
    ds_write_b128 v2, v[148:151] offset:3328
    ds_write_b128 v3, v[152:155] offset:3328
    ds_write_b128 v4, v[156:159] offset:3328
    ds_read_b64_tr_b16 v[112:113], v6 offset:0
    ds_read_b64_tr_b16 v[116:117], v6 offset:32
    ds_read_b64_tr_b16 v[120:121], v6 offset:64
    ds_read_b64_tr_b16 v[124:125], v6 offset:96
    ds_read_b64_tr_b16 v[128:129], v6 offset:128
    ds_read_b64_tr_b16 v[132:133], v6 offset:160
    ds_read_b64_tr_b16 v[136:137], v6 offset:192
    ds_read_b64_tr_b16 v[140:141], v6 offset:224
    ds_read_b64_tr_b16 v[144:145], v6 offset:256
    ds_read_b64_tr_b16 v[148:149], v6 offset:288
    ds_read_b64_tr_b16 v[152:153], v6 offset:320
    ds_read_b64_tr_b16 v[156:157], v6 offset:352
    buffer_load_dwordx4 v[188:191], v1, s[12:15], s86 offen offset:1024 nt
    buffer_load_dwordx4 v[192:195], v1, s[12:15], s86 offen offset:2048 nt
    buffer_load_dwordx4 v[196:199], v1, s[12:15], s86 offen offset:3072 nt
    buffer_load_dwordx4 v[200:203], v23, s[12:15], s86 offen offset:0 nt
    buffer_load_dwordx4 v[204:207], v23, s[12:15], s86 offen offset:1024 nt
    s_barrier
    buffer_load_dwordx4 v[208:211], v1, s[12:15], s87 offen offset:0 nt
    buffer_load_dwordx4 v[212:215], v1, s[12:15], s87 offen offset:1024 nt
    s_waitcnt vmcnt(12)
    v_lshlrev_b32 v24, 16, v64
    v_and_b32 v25, 0xffff0000, v64
    v_lshlrev_b32 v26, 16, v65
    v_and_b32 v27, 0xffff0000, v65
    v_lshlrev_b32 v28, 16, v66
    v_and_b32 v29, 0xffff0000, v66
    v_lshlrev_b32 v30, 16, v67
    v_and_b32 v31, 0xffff0000, v67
    v_add_f32 v24, v24, v28
    v_add_f32 v25, v25, v29
    v_add_f32 v26, v26, v30
    v_add_f32 v27, v27, v31
    s_nop 0
    v_permlane32_swap_b32 v24, v26
    v_permlane32_swap_b32 v25, v27
    v_add_f32 v24, v24, v26
    v_add_f32 v25, v25, v27
    s_nop 1
    v_permlane16_swap_b32 v24, v25
    v_add_f32 v24, v24, v25
    v_cvt_pk_bf16_f32 v24, v24, v24
    ds_write_b16 v12, v24
    buffer_load_dwordx4 v[216:219], v1, s[12:15], s87 offen offset:2048 nt
    v_mov_b32 v40, 0
    v_mov_b32 v41, 0
    v_mov_b32 v44, 0
    v_mov_b32 v45, 0
    v_mov_b32 v48, 0
    v_mov_b32 v49, 0
    v_mov_b32 v52, 0
    v_mov_b32 v53, 0
    v_mov_b32 v56, 0
    v_mov_b32 v57, 0
    v_mov_b32 v60, 0
    v_mov_b32 v61, 0
    v_mov_b32 v64, 0
    v_mov_b32 v65, 0
    v_mov_b32 v68, 0
    v_mov_b32 v69, 0
    v_mov_b32 v72, 0
    v_mov_b32 v73, 0
    v_mov_b32 v74, 0
    v_mov_b32 v75, 0
    v_mov_b32 v76, 0
    v_mov_b32 v77, 0
    v_mov_b32 v78, 0
    v_mov_b32 v79, 0
    v_mov_b32 v80, 0
    v_mov_b32 v81, 0
    v_mov_b32 v82, 0
    v_mov_b32 v83, 0
    v_mov_b32 v84, 0
    v_mov_b32 v85, 0
    v_mov_b32 v86, 0
    v_mov_b32 v87, 0
    buffer_load_dwordx4 v[220:223], v1, s[12:15], s87 offen offset:3072 nt
    buffer_load_dwordx4 v[224:227], v23, s[12:15], s87 offen offset:0 nt
    s_waitcnt lgkmcnt(0)
    s_barrier
    ds_read_b128 v[28:31], v13 offset:0
    ds_read_b128 v[32:35], v13 offset:128
    ds_read_b128 v[36:39], v13 offset:256
    v_mov_b32 v18, 0x3dd53b94
    s_waitcnt lgkmcnt(2)
    v_smfmac_f32_16x16x64_bf16 v[40:43], v[28:31], a[0:7], v14
    v_smfmac_f32_16x16x64_bf16 v[44:47], v[28:31], a[24:31], v14
    v_smfmac_f32_16x16x64_bf16 v[48:51], v[28:31], a[48:55], v14
    v_smfmac_f32_16x16x64_bf16 v[52:55], v[28:31], a[72:79], v14
    v_smfmac_f32_16x16x64_bf16 v[56:59], v[28:31], a[96:103], v14
    v_smfmac_f32_16x16x64_bf16 v[60:63], v[28:31], a[120:127], v14
    v_smfmac_f32_16x16x64_bf16 v[64:67], v[28:31], a[144:151], v14
    v_smfmac_f32_16x16x64_bf16 v[68:71], v[28:31], a[168:175], v14
    buffer_load_dwordx4 v[228:231], v23, s[12:15], s87 offen offset:1024 nt
    s_barrier
    s_waitcnt lgkmcnt(1)
    v_smfmac_f32_16x16x64_bf16 v[40:43], v[32:35], a[8:15], v14
    v_smfmac_f32_16x16x64_bf16 v[44:47], v[32:35], a[32:39], v14
    v_smfmac_f32_16x16x64_bf16 v[48:51], v[32:35], a[56:63], v14
    v_smfmac_f32_16x16x64_bf16 v[52:55], v[32:35], a[80:87], v14
    v_smfmac_f32_16x16x64_bf16 v[56:59], v[32:35], a[104:111], v14
    v_smfmac_f32_16x16x64_bf16 v[60:63], v[32:35], a[128:135], v14
    v_smfmac_f32_16x16x64_bf16 v[64:67], v[32:35], a[152:159], v14
    v_smfmac_f32_16x16x64_bf16 v[68:71], v[32:35], a[176:183], v14
    s_waitcnt lgkmcnt(0)
    v_smfmac_f32_16x16x64_bf16 v[40:43], v[36:39], a[16:23], v14
    v_smfmac_f32_16x16x64_bf16 v[44:47], v[36:39], a[40:47], v14
    v_smfmac_f32_16x16x64_bf16 v[48:51], v[36:39], a[64:71], v14
    v_smfmac_f32_16x16x64_bf16 v[52:55], v[36:39], a[88:95], v14
    v_smfmac_f32_16x16x64_bf16 v[56:59], v[36:39], a[112:119], v14
    v_smfmac_f32_16x16x64_bf16 v[60:63], v[36:39], a[136:143], v14
    v_smfmac_f32_16x16x64_bf16 v[64:67], v[36:39], a[160:167], v14
    v_smfmac_f32_16x16x64_bf16 v[68:71], v[36:39], a[184:191], v14
    buffer_load_dwordx4 v[232:235], v1, s[12:15], s88 offen offset:0 nt
    v_add_f32 v24, v40, v41
    v_add_f32 v44, v44, v45
    v_add_f32 v48, v48, v49
    v_max3_f32 v26, v24, v44, v48
    v_add_f32 v52, v52, v53
    v_add_f32 v25, v56, v57
    v_max3_f32 v26, v26, v52, v25
    v_add_f32 v60, v60, v61
    v_add_f32 v64, v64, v65
    v_max3_f32 v26, v26, v60, v64
    v_add_f32 v68, v68, v69
    v_max_f32 v26, v26, v68
    v_mov_b32_dpp v24, v44 quad_perm:[0,1,2,3] row_mask:0x2 bank_mask:0xf
    v_mov_b32_dpp v25, v60 quad_perm:[0,1,2,3] row_mask:0x2 bank_mask:0xf
    v_max_f32_dpp v26, v26, v26 row_ror:8 row_mask:0xf bank_mask:0xf
    v_mov_b32_dpp v24, v48 quad_perm:[0,1,2,3] row_mask:0x4 bank_mask:0xf
    v_mov_b32_dpp v25, v64 quad_perm:[0,1,2,3] row_mask:0x4 bank_mask:0xf
    v_max_f32_dpp v26, v26, v26 row_ror:4 row_mask:0xf bank_mask:0xf
    v_mov_b32_dpp v24, v52 quad_perm:[0,1,2,3] row_mask:0x8 bank_mask:0xf
    v_mov_b32_dpp v25, v68 quad_perm:[0,1,2,3] row_mask:0x8 bank_mask:0xf
    v_max_f32_dpp v26, v26, v26 row_ror:2 row_mask:0xf bank_mask:0xf
    v_accvgpr_read_b32 v27, a252
    s_nop 0
    v_max_f32_dpp v26, v26, v26 row_ror:1 row_mask:0xf bank_mask:0xf
    buffer_load_dwordx4 v[236:239], v1, s[12:15], s88 offen offset:1024 nt
    v_mul_f32 v26, v26, v18
    v_fma_f32 v24, v24, v18, -v26
    v_fma_f32 v25, v25, v18, -v26
    v_exp_f32 v24, v24
    v_exp_f32 v25, v25
    s_nop 0
    v_cvt_pk_bf16_f32 v28, v24, v25
    ds_write_b16 v19, v28
    ds_write_b16_d16_hi v19, v28 offset:128
    s_mov_b32 exec_lo, 0xff00ff
    s_mov_b32 exec_hi, 0xff00ff00
    ds_read_b128 v[72:75], v27 offset:0
    ds_read_b128 v[76:79], v27 offset:64
    ds_read_b128 v[80:83], v27 offset:128
    ds_read_b128 v[84:87], v27 offset:192
    s_mov_b64 exec, -1
    v_add_f32 v27, v24, v25
    v_mov_b32 v40, 0
    v_mov_b32 v44, 0
    v_add_f32_dpp v27, v27, v27 row_ror:8 row_mask:0xf bank_mask:0xf
    v_mov_b32 v48, 0
    v_mov_b32 v52, 0
    v_add_f32_dpp v27, v27, v27 row_ror:4 row_mask:0xf bank_mask:0xf
    v_mov_b32 v56, 0
    v_mov_b32 v60, 0
    v_add_f32_dpp v27, v27, v27 row_ror:2 row_mask:0xf bank_mask:0xf
    s_lshl_b32 s78, s72, 3
    s_add_u32 s78, s78, 125440
    v_add_f32_dpp v27, v27, v27 row_ror:1 row_mask:0xf bank_mask:0xf
    v_mov_b32 v28, v27
    s_nop 1
    v_permlane32_swap_b32 v27, v28
    v_add_f32 v27, v27, v28
    v_mov_b32 v28, v27
    s_nop 1
    v_permlane16_swap_b32 v27, v28
    v_add_f32 v27, v27, v28
    v_mov_b32 v28, s78
    ds_write_b64 v28, v[26:27]
    s_waitcnt vmcnt(14)
    ds_write_b128 v2, v[160:163] offset:0
    ds_write_b128 v3, v[164:167] offset:0
    ds_write_b128 v4, v[168:171] offset:0
    ds_write_b128 v2, v[172:175] offset:3328
    ds_write_b128 v3, v[176:179] offset:3328
    ds_write_b128 v4, v[180:183] offset:3328
    ds_read_b64_tr_b16 v[114:115], v6 offset:0
    ds_read_b64_tr_b16 v[118:119], v6 offset:32
    ds_read_b64_tr_b16 v[122:123], v6 offset:64
    ds_read_b64_tr_b16 v[126:127], v6 offset:96
    ds_read_b64_tr_b16 v[130:131], v6 offset:128
    ds_read_b64_tr_b16 v[134:135], v6 offset:160
    ds_read_b64_tr_b16 v[138:139], v6 offset:192
    ds_read_b64_tr_b16 v[142:143], v6 offset:224
    ds_read_b64_tr_b16 v[146:147], v6 offset:256
    ds_read_b64_tr_b16 v[150:151], v6 offset:288
    ds_read_b64_tr_b16 v[154:155], v6 offset:320
    ds_read_b64_tr_b16 v[158:159], v6 offset:352
    buffer_load_dwordx4 v[240:243], v1, s[12:15], s88 offen offset:2048 nt
    buffer_load_dwordx4 v[244:247], v1, s[12:15], s88 offen offset:3072 nt
    s_waitcnt lgkmcnt(0)
    v_smfmac_f32_16x16x64_bf16 v[40:43], v[72:75], a[192:199], v14 abid:1
    v_smfmac_f32_16x16x64_bf16 v[44:47], v[72:75], a[200:207], v14 abid:1
    v_smfmac_f32_16x16x64_bf16 v[48:51], v[72:75], a[208:215], v14 abid:1
    v_smfmac_f32_16x16x64_bf16 v[52:55], v[72:75], a[216:223], v14 abid:1
    v_smfmac_f32_16x16x64_bf16 v[56:59], v[72:75], a[224:231], v14 abid:1
    v_smfmac_f32_16x16x64_bf16 v[60:63], v[72:75], a[232:239], v14 abid:1
    buffer_load_dwordx4 v[248:251], v23, s[12:15], s88 offen offset:0 nt
    v_smfmac_f32_16x16x64_bf16 v[40:43], v[76:79], v[112:119], v14 abid:1
    v_smfmac_f32_16x16x64_bf16 v[44:47], v[76:79], v[120:127], v14 abid:1
    v_smfmac_f32_16x16x64_bf16 v[48:51], v[76:79], v[128:135], v14 abid:1
    v_smfmac_f32_16x16x64_bf16 v[52:55], v[76:79], v[136:143], v14 abid:1
    v_smfmac_f32_16x16x64_bf16 v[56:59], v[76:79], v[144:151], v14 abid:1
    v_smfmac_f32_16x16x64_bf16 v[60:63], v[76:79], v[152:159], v14 abid:1
    buffer_load_dwordx4 v[252:255], v23, s[12:15], s88 offen offset:1024 nt
    s_barrier
    s_waitcnt vmcnt(12)
    ds_write_b128 v2, v[184:187] offset:0
    ds_write_b128 v3, v[188:191] offset:0
    ds_write_b128 v4, v[192:195] offset:0
    ds_write_b128 v2, v[196:199] offset:3328
    ds_write_b128 v3, v[200:203] offset:3328
    ds_write_b128 v4, v[204:207] offset:3328
    ds_read_b64_tr_b16 v[160:161], v6 offset:0
    ds_read_b64_tr_b16 v[164:165], v6 offset:32
    ds_read_b64_tr_b16 v[168:169], v6 offset:64
    ds_read_b64_tr_b16 v[172:173], v6 offset:96
    ds_read_b64_tr_b16 v[176:177], v6 offset:128
    ds_read_b64_tr_b16 v[180:181], v6 offset:160
    ds_read_b64_tr_b16 v[184:185], v6 offset:192
    ds_read_b64_tr_b16 v[188:189], v6 offset:224
    ds_read_b64_tr_b16 v[192:193], v6 offset:256
    ds_read_b64_tr_b16 v[196:197], v6 offset:288
    ds_read_b64_tr_b16 v[200:201], v6 offset:320
    ds_read_b64_tr_b16 v[204:205], v6 offset:352
    buffer_load_dwordx4 v[88:91], v1, s[12:15], s89 offen offset:0 nt
    buffer_load_dwordx4 v[92:95], v1, s[12:15], s89 offen offset:1024 nt
    buffer_load_dwordx4 v[96:99], v1, s[12:15], s89 offen offset:2048 nt
    buffer_load_dwordx4 v[100:103], v1, s[12:15], s89 offen offset:3072 nt
    buffer_load_dwordx4 v[104:107], v23, s[12:15], s89 offen offset:0 nt
    buffer_load_dwordx4 v[108:111], v23, s[12:15], s89 offen offset:1024 nt
    s_waitcnt vmcnt(12)
    ds_write_b128 v2, v[208:211] offset:0
    ds_write_b128 v3, v[212:215] offset:0
    ds_write_b128 v4, v[216:219] offset:0
    ds_write_b128 v2, v[220:223] offset:3328
    ds_write_b128 v3, v[224:227] offset:3328
    ds_write_b128 v4, v[228:231] offset:3328
    ds_read_b64_tr_b16 v[162:163], v6 offset:0
    ds_read_b64_tr_b16 v[166:167], v6 offset:32
    ds_read_b64_tr_b16 v[170:171], v6 offset:64
    ds_read_b64_tr_b16 v[174:175], v6 offset:96
    ds_read_b64_tr_b16 v[178:179], v6 offset:128
    ds_read_b64_tr_b16 v[182:183], v6 offset:160
    ds_read_b64_tr_b16 v[186:187], v6 offset:192
    ds_read_b64_tr_b16 v[190:191], v6 offset:224
    ds_read_b64_tr_b16 v[194:195], v6 offset:256
    ds_read_b64_tr_b16 v[198:199], v6 offset:288
    ds_read_b64_tr_b16 v[202:203], v6 offset:320
    ds_read_b64_tr_b16 v[206:207], v6 offset:352
    v_and_b32 v23, 0xffff0000, v22
    v_lshlrev_b32 v22, 16, v22
    s_mov_b32 s82, 0x1010101
    s_mov_b32 s83, 0x1010101
    s_mov_b32 s84, 0x1ff01ff
    s_mov_b32 s85, 0x1ff01ff
    s_mov_b32 s86, 0xffffffff
    s_mov_b32 s87, 0xfffffff
    s_mov_b32 s88, 0xff00ff
    s_mov_b32 s89, 0xff00ff00
    s_mov_b32 s92, 0x1010101
    s_mov_b32 s93, 0x0
    s_mov_b32 s44, 0xf0f0f0f
    s_mov_b32 s45, 0xf0f0f0f
    s_mov_b64 s[46:47], s[92:93]
    s_mov_b64 s[48:49], s[44:45]
    s_cmp_ge_u32 s69, 20
    s_cbranch_scc1 TAILF
    v_mov_b32 v24, -1
    v_mov_b32 v25, -1
    v_mov_b32 v26, -1
    v_mov_b32 v27, -1
    v_and_b32 v28, 3, v0
    v_lshrrev_b32 v29, 5, v0
    v_lshl_add_u32 v28, v29, 2, v28
    v_mul_u32_u24 v28, 10240, v28
    v_bfe_u32 v29, v0, 3, 2
    v_lshl_add_u32 v28, v29, 4, v28
    s_cmp_eq_u32 s72, 3
    s_cselect_b32 s77, 0, 1879048176
    v_add_u32 v28, s77, v28
    s_add_u32 s77, s80, 81920
    s_mov_b64 exec, s[44:45]
    buffer_store_dwordx4 v[24:27], v28, s[16:19], s77 offen sc1
    s_mov_b64 exec, -1
    v_lshrrev_b32 v38, 2, v0
    v_mul_u32_u24 v38, 1280, v38
    v_and_b32 v39, 3, v0
    v_lshl_add_u32 v39, v39, 4, v38
    s_mov_b32 m0, s67
    s_add_u32 s67, s67, 1024
    buffer_load_dwordx4 v39, s[24:27], s66 offen  lds
    s_add_u32 s66, s66, 20480
    s_mov_b32 m0, s67
    s_add_u32 s67, s67, 1024
    buffer_load_dwordx4 v39, s[24:27], s66 offen  lds
    s_add_u32 s66, s66, 20480
    s_mov_b32 m0, s67
    s_add_u32 s67, s67, 1024
    buffer_load_dwordx4 v39, s[24:27], s66 offen  lds
    s_add_u32 s66, s66, 20480
    s_waitcnt lgkmcnt(0)
    v_smfmac_f32_16x16x64_bf16 v[40:43], v[80:83], v[160:167], v14 abid:1
    v_smfmac_f32_16x16x64_bf16 v[44:47], v[80:83], v[168:175], v14 abid:1
    v_smfmac_f32_16x16x64_bf16 v[48:51], v[80:83], v[176:183], v14 abid:1
    v_smfmac_f32_16x16x64_bf16 v[52:55], v[80:83], v[184:191], v14 abid:1
    v_smfmac_f32_16x16x64_bf16 v[56:59], v[80:83], v[192:199], v14 abid:1
    v_smfmac_f32_16x16x64_bf16 v[60:63], v[80:83], v[200:207], v14 abid:1
    s_waitcnt vmcnt(10)
    ds_write_b128 v2, v[232:235] offset:0
    ds_write_b128 v3, v[236:239] offset:0
    ds_write_b128 v4, v[240:243] offset:0
    ds_write_b128 v2, v[244:247] offset:3328
    ds_write_b128 v3, v[248:251] offset:3328
    ds_write_b128 v4, v[252:255] offset:3328
    ds_read_b64_tr_b16 v[208:209], v6 offset:0
    ds_read_b64_tr_b16 v[212:213], v6 offset:32
    ds_read_b64_tr_b16 v[216:217], v6 offset:64
    ds_read_b64_tr_b16 v[220:221], v6 offset:96
    ds_read_b64_tr_b16 v[224:225], v6 offset:128
    ds_read_b64_tr_b16 v[228:229], v6 offset:160
    ds_read_b64_tr_b16 v[232:233], v6 offset:192
    ds_read_b64_tr_b16 v[236:237], v6 offset:224
    ds_read_b64_tr_b16 v[240:241], v6 offset:256
    ds_read_b64_tr_b16 v[244:245], v6 offset:288
    ds_read_b64_tr_b16 v[248:249], v6 offset:320
    ds_read_b64_tr_b16 v[252:253], v6 offset:352
    s_mov_b32 m0, s67
    s_add_u32 s67, s67, 1024
    buffer_load_dwordx4 v39, s[24:27], s66 offen  lds
    s_add_u32 s66, s66, 20480
    s_mov_b32 m0, s67
    s_add_u32 s67, s67, 1024
    buffer_load_dwordx4 v39, s[24:27], s66 offen  lds
    s_add_u32 s66, s66, 20480
    s_mov_b32 m0, s67
    s_add_u32 s67, s67, 1024
    buffer_load_dwordx4 v39, s[24:27], s66 offen  lds
    s_add_u32 s66, s66, 20480
    s_waitcnt vmcnt(12)
    ds_write_b128 v2, v[88:91] offset:0
    s_waitcnt vmcnt(11)
    ds_write_b128 v3, v[92:95] offset:0
    s_waitcnt vmcnt(10)
    ds_write_b128 v4, v[96:99] offset:0
    s_waitcnt vmcnt(9)
    ds_write_b128 v2, v[100:103] offset:3328
    s_waitcnt vmcnt(8)
    ds_write_b128 v3, v[104:107] offset:3328
    s_waitcnt vmcnt(7)
    ds_write_b128 v4, v[108:111] offset:3328
    ds_read_b64_tr_b16 v[210:211], v6 offset:0
    ds_read_b64_tr_b16 v[214:215], v6 offset:32
    ds_read_b64_tr_b16 v[218:219], v6 offset:64
    ds_read_b64_tr_b16 v[222:223], v6 offset:96
    ds_read_b64_tr_b16 v[226:227], v6 offset:128
    ds_read_b64_tr_b16 v[230:231], v6 offset:160
    ds_read_b64_tr_b16 v[234:235], v6 offset:192
    ds_read_b64_tr_b16 v[238:239], v6 offset:224
    ds_read_b64_tr_b16 v[242:243], v6 offset:256
    ds_read_b64_tr_b16 v[246:247], v6 offset:288
    ds_read_b64_tr_b16 v[250:251], v6 offset:320
    ds_read_b64_tr_b16 v[254:255], v6 offset:352
    s_branch ATT_LAST
TAILF:
    s_lshl_b32 s90, s72, 3
    s_add_u32 s90, s90, s68
    s_mul_i32 s90, s90, 24
    s_add_u32 s90, s90, s69
    s_sub_u32 s90, s90, 8
    s_mul_i32 s90, s90, 10240
    buffer_load_dwordx4 a[240:243], v1, s[20:23], s90 offen offset:0
    buffer_load_dwordx4 a[240:243], v1, s[20:23], s90 offen offset:1024
    buffer_load_dwordx4 a[240:243], v1, s[20:23], s90 offen offset:2048
    buffer_load_dwordx4 a[240:243], v1, s[20:23], s90 offen offset:3072
    s_add_u32 s90, s90, 4096
    buffer_load_dwordx4 a[240:243], v1, s[20:23], s90 offen offset:0
    buffer_load_dwordx4 a[240:243], v1, s[20:23], s90 offen offset:1024
    buffer_load_dwordx4 a[240:243], v1, s[20:23], s90 offen offset:2048
    s_waitcnt lgkmcnt(0)
    v_smfmac_f32_16x16x64_bf16 v[40:43], v[80:83], v[160:167], v14 abid:1
    v_smfmac_f32_16x16x64_bf16 v[44:47], v[80:83], v[168:175], v14 abid:1
    v_smfmac_f32_16x16x64_bf16 v[48:51], v[80:83], v[176:183], v14 abid:1
    v_smfmac_f32_16x16x64_bf16 v[52:55], v[80:83], v[184:191], v14 abid:1
    v_smfmac_f32_16x16x64_bf16 v[56:59], v[80:83], v[192:199], v14 abid:1
    v_smfmac_f32_16x16x64_bf16 v[60:63], v[80:83], v[200:207], v14 abid:1
    s_waitcnt vmcnt(13)
    ds_write_b128 v2, v[232:235] offset:0
    ds_write_b128 v3, v[236:239] offset:0
    ds_write_b128 v4, v[240:243] offset:0
    ds_write_b128 v2, v[244:247] offset:3328
    ds_write_b128 v3, v[248:251] offset:3328
    ds_write_b128 v4, v[252:255] offset:3328
    ds_read_b64_tr_b16 v[208:209], v6 offset:0
    ds_read_b64_tr_b16 v[212:213], v6 offset:32
    ds_read_b64_tr_b16 v[216:217], v6 offset:64
    ds_read_b64_tr_b16 v[220:221], v6 offset:96
    ds_read_b64_tr_b16 v[224:225], v6 offset:128
    ds_read_b64_tr_b16 v[228:229], v6 offset:160
    ds_read_b64_tr_b16 v[232:233], v6 offset:192
    ds_read_b64_tr_b16 v[236:237], v6 offset:224
    ds_read_b64_tr_b16 v[240:241], v6 offset:256
    ds_read_b64_tr_b16 v[244:245], v6 offset:288
    ds_read_b64_tr_b16 v[248:249], v6 offset:320
    ds_read_b64_tr_b16 v[252:253], v6 offset:352
    buffer_load_dwordx4 a[240:243], v1, s[20:23], s90 offen offset:3072
    s_add_u32 s90, s90, 4096
    buffer_load_dwordx4 a[240:243], v1, s[20:23], s90 offen offset:0
    buffer_load_dwordx4 a[240:243], v1, s[20:23], s90 offen offset:1024
    s_waitcnt vmcnt(15)
    ds_write_b128 v2, v[88:91] offset:0
    s_waitcnt vmcnt(14)
    ds_write_b128 v3, v[92:95] offset:0
    s_waitcnt vmcnt(13)
    ds_write_b128 v4, v[96:99] offset:0
    s_waitcnt vmcnt(12)
    ds_write_b128 v2, v[100:103] offset:3328
    s_waitcnt vmcnt(11)
    ds_write_b128 v3, v[104:107] offset:3328
    s_waitcnt vmcnt(10)
    ds_write_b128 v4, v[108:111] offset:3328
    ds_read_b64_tr_b16 v[210:211], v6 offset:0
    ds_read_b64_tr_b16 v[214:215], v6 offset:32
    ds_read_b64_tr_b16 v[218:219], v6 offset:64
    ds_read_b64_tr_b16 v[222:223], v6 offset:96
    ds_read_b64_tr_b16 v[226:227], v6 offset:128
    ds_read_b64_tr_b16 v[230:231], v6 offset:160
    ds_read_b64_tr_b16 v[234:235], v6 offset:192
    ds_read_b64_tr_b16 v[238:239], v6 offset:224
    ds_read_b64_tr_b16 v[242:243], v6 offset:256
    ds_read_b64_tr_b16 v[246:247], v6 offset:288
    ds_read_b64_tr_b16 v[250:251], v6 offset:320
    ds_read_b64_tr_b16 v[254:255], v6 offset:352
    s_branch ATT_LAST
LOOP:
    s_cmp_lt_u32 s69, 20
    s_cselect_b32 s5, s72, 4
    s_add_u32 s96, s3, 819200
    s_add_u32 s97, s96, 4096
    buffer_load_dwordx4 v[88:91], v11, s[16:19], s96 offen sc1
    buffer_load_dwordx4 v[92:95], v11, s[16:19], s97 offen sc1
    ds_read_b64_tr_b16 v[40:41], v16 offset:0
    ds_read_b64_tr_b16 v[42:43], v16 offset:1536
    ds_read_b64_tr_b16 v[44:45], v16 offset:12288
    ds_read_b64_tr_b16 v[46:47], v16 offset:13824
    ds_read_b64_tr_b16 v[48:49], v17 offset:24576
    ds_read_b64_tr_b16 v[50:51], v16 offset:32
    ds_read_b64_tr_b16 v[52:53], v16 offset:1568
    ds_read_b64_tr_b16 v[54:55], v16 offset:12320
    ds_read_b64_tr_b16 v[56:57], v16 offset:13856
    ds_read_b64_tr_b16 v[58:59], v17 offset:24608
    ds_read_b64_tr_b16 v[60:61], v16 offset:64
    ds_read_b64_tr_b16 v[62:63], v16 offset:1600
    ds_read_b64_tr_b16 v[64:65], v16 offset:12352
    ds_read_b64_tr_b16 v[66:67], v16 offset:13888
    ds_read_b64_tr_b16 v[68:69], v17 offset:24640
    v_and_b32 v25, 15, v0
    v_cmp_eq_u32 vcc, 12, v25
    v_mov_b32 v36, 0x3f803f80
    s_nop 0
    v_cndmask_b32 v70, 0, v36, vcc
    v_mov_b32 v71, v70
    v_mov_b32 v72, v70
    v_mov_b32 v73, v70
    v_mov_b32 v74, v70
    v_mov_b32 v75, v70
    v_mov_b32 v76, v70
    v_mov_b32 v77, v70
    v_mov_b32 v78, v70
    v_mov_b32 v79, v70
    s_add_u32 s79, s3, 4096
    s_mul_i32 s77, s72, 6656
    v_mul_u32_u24 v26, 103, v0
    v_lshrrev_b32 v26, 10, v26
    v_lshl_add_u32 v26, v26, 4, v1
    v_add_u32 v26, s77, v26
    v_mul_u32_u24 v27, 176, v25
    v_add_u32 v27, s77, v27
    v_lshrrev_b32 v28, 4, v0
    v_lshl_add_u32 v29, v28, 3, v27
    v_lshl_add_u32 v27, v28, 4, v27
    s_mul_i32 s77, s71, 160
    s_add_u32 s77, s77, s3
    s_sub_u32 s77, s77, 772608
    s_waitcnt lgkmcnt(0)
    s_mov_b32 exec_lo, 0x3ff
    s_mov_b32 exec_hi, 0x0
    s_mov_b32 s76, 1
POLL2:
    buffer_load_dword v24, v1, s[16:19], s77 offen sc1
POLLW2:
    s_waitcnt vmcnt(0)
    v_cmp_eq_u32 vcc, -1, v24
    s_cbranch_vccnz AGAIN2
POLLX2:
    s_mov_b64 exec, s[86:87]
    buffer_load_dwordx4 v[80:83], v8, s[16:19], 0 offen sc1
    buffer_load_dwordx4 v[84:87], v9, s[16:19], 0 offen sc1
    buffer_load_dwordx4 v[88:91], v11, s[16:19], s96 offen sc1
    buffer_load_dwordx4 v[92:95], v11, s[16:19], s97 offen sc1
    s_waitcnt vmcnt(2)
BW3:
    ds_write_b128 v26, v[80:83]
    ds_write_b128 v26, v[84:87] offset:1056
    v_max_u32 v24, v80, v84
    v_cmp_eq_u32 vcc, -1, v24
    s_mov_b64 exec, s[84:85]
    ds_read_b128 v[70:73], v27
    ds_read_b128 v[74:77], v27 offset:64
    ds_read_b64 v[78:79], v29 offset:128
    s_mov_b64 exec, -1
    s_cbranch_vccnz BR3
BX3:
    s_cmp_lg_u32 s5, 1
    s_cbranch_scc1 NOOWL
    buffer_load_dword a244, v20, s[16:19], 0 offen sc1
    buffer_load_dword a245, v21, s[16:19], 0 offen sc1
NOOWL:
    s_waitcnt lgkmcnt(2)
    v_mfma_f32_16x16x32_bf16 v[24:27], v[70:73], v[40:43], 0
    v_mfma_f32_16x16x32_bf16 v[32:35], v[70:73], v[60:63], 0
    s_waitcnt lgkmcnt(0)
    v_mfma_f32_16x16x32_bf16 v[24:27], v[74:77], v[44:47], v[24:27]
    v_mfma_f32_16x16x32_bf16 v[32:35], v[74:77], v[64:67], v[32:35]
    v_mfma_f32_16x16x16_bf16 v[24:27], v[78:79], v[48:49], v[24:27]
    v_mfma_f32_16x16x16_bf16 v[32:35], v[78:79], v[68:69], v[32:35]
    v_mfma_f32_16x16x32_bf16 v[28:31], v[70:73], v[50:53], 0
    v_mfma_f32_16x16x32_bf16 v[36:39], v[70:73], v[70:73], 0
    v_mfma_f32_16x16x32_bf16 v[28:31], v[74:77], v[54:57], v[28:31]
    v_mfma_f32_16x16x32_bf16 v[36:39], v[74:77], v[74:77], v[36:39]
    v_mfma_f32_16x16x16_bf16 v[28:31], v[78:79], v[58:59], v[28:31]
    v_mfma_f32_16x16x16_bf16 v[36:39], v[78:79], v[78:79], v[36:39]
    s_nop 0
    v_add_f32 v24, v24, v25
    v_add_f32 v26, v26, v27
    v_add_f32 v24, v24, v26
    v_add_f32 v32, v32, v33
    v_add_f32 v34, v34, v35
    v_add_f32 v32, v32, v34
    s_nop 1
    v_permlane32_swap_b32 v24, v32
    v_add_f32 v28, v28, v29
    v_add_f32 v30, v30, v31
    v_add_f32 v36, v36, v37
    v_add_f32 v38, v38, v39
    v_add_f32 v24, v24, v32
    v_add_f32 v28, v28, v30
    v_add_f32 v36, v36, v38
    s_nop 1
    v_permlane32_swap_b32 v28, v36
    v_add_f32 v28, v28, v36
    s_nop 1
    v_permlane16_swap_b32 v24, v28
    v_add_f32 v24, v24, v28
    buffer_store_dword v24, v10, s[8:11], s3 offen
    s_cmp_eq_u32 s10, 0
    s_cbranch_scc1 SLOW4
BACK4:
    v_mov_b32 v40, 0
    v_mov_b32 v41, 0
    v_mov_b32 v44, 0
    v_mov_b32 v45, 0
    v_mov_b32 v48, 0
    v_mov_b32 v49, 0
    v_mov_b32 v52, 0
    v_mov_b32 v53, 0
    v_mov_b32 v56, 0
    v_mov_b32 v57, 0
    v_mov_b32 v60, 0
    v_mov_b32 v61, 0
    v_mov_b32 v64, 0
    v_mov_b32 v65, 0
    v_mov_b32 v68, 0
    v_mov_b32 v69, 0
    v_mov_b32 v72, 0
    v_mov_b32 v73, 0
    v_mov_b32 v74, 0
    v_mov_b32 v75, 0
    v_mov_b32 v76, 0
    v_mov_b32 v77, 0
    v_mov_b32 v78, 0
    v_mov_b32 v79, 0
    v_mov_b32 v80, 0
    v_mov_b32 v81, 0
    v_mov_b32 v82, 0
    v_mov_b32 v83, 0
    v_mov_b32 v84, 0
    v_mov_b32 v85, 0
    v_mov_b32 v86, 0
    v_mov_b32 v87, 0
    s_waitcnt vmcnt(1)
    v_add_f32 v88, v88, v92
    v_add_f32 v89, v89, v93
    v_add_f32 v90, v90, v94
    v_add_f32 v91, v91, v95
    s_nop 0
    v_permlane32_swap_b32 v88, v90
    v_permlane32_swap_b32 v89, v91
    v_add_f32 v88, v88, v90
    v_add_f32 v89, v89, v91
    s_nop 1
    v_permlane16_swap_b32 v88, v89
    v_add_f32 v88, v88, v89
    v_mul_f32 v7, 0x3acccccd, v88
    s_mov_b32 s76, 1
POLL5:
    buffer_load_dwordx4 v[24:27], v11, s[16:19], s3 offen sc1
    buffer_load_dwordx4 v[28:31], v11, s[16:19], s79 offen sc1
    s_waitcnt vmcnt(0)
    v_add_f32 v24, v24, v28
    v_add_f32 v25, v25, v29
    v_add_f32 v26, v26, v30
    v_add_f32 v27, v27, v31
    s_nop 0
    v_permlane32_swap_b32 v24, v26
    v_permlane32_swap_b32 v25, v27
    v_add_f32 v24, v24, v26
    v_add_f32 v25, v25, v27
    s_nop 1
    v_permlane16_swap_b32 v24, v25
    v_add_f32 v24, v24, v25
    v_cmp_u_f32 vcc, v24, v24
    s_cbranch_vccnz AGAIN5
POLLX5:
    v_readlane_b32 s77, v24, 15
    s_mov_b32 vcc_lo, 0x70007000
    s_mov_b32 vcc_hi, 0x70007000
    v_fma_f32 v25, -s77, v7, v24
    v_cvt_pk_bf16_f32 v25, v25, v25
    ds_write_b16 v12, v25
    v_cndmask_b32 v26, 0, v24, vcc
    s_nop 1
    v_add_f32_dpp v26, v26, v26 quad_perm:[1,0,3,2] row_mask:0xf bank_mask:0xf
    s_nop 1
    v_add_f32_dpp v26, v26, v26 quad_perm:[2,3,0,1] row_mask:0xf bank_mask:0xf
    v_mov_b32 v27, v26
    s_nop 1
    v_permlane32_swap_b32 v26, v27
    v_add_f32 v26, v26, v27
    s_waitcnt lgkmcnt(0)
    s_barrier
    ds_read_b128 v[28:31], v13 offset:0
    ds_read_b128 v[32:35], v13 offset:128
    ds_read_b128 v[36:39], v13 offset:256
    v_mov_b32 v27, v26
    v_mov_b32 v25, s77
    v_subrev_f32 v25, 0x44200000, v25
    v_permlane16_swap_b32 v26, v27
    v_add_f32 v26, v26, v27
    v_mul_f32 v24, 0x3acccccd, v25
    v_readlane_b32 s77, v26, 15
    v_mul_f32 v24, v24, v24
    s_mov_b32 s78, 0x3acccccd
    v_sub_f32 v26, s77, v25
    v_fma_f32 v26, v26, s78, -v24
    v_max_f32 v26, 0, v26
    v_add_f32 v26, 0x3727c5ac, v26
    v_rsq_f32 v26, v26
    s_nop 0
    v_mul_f32 v18, 0x3dd53b94, v26
    s_waitcnt lgkmcnt(2)
    v_smfmac_f32_16x16x64_bf16 v[40:43], v[28:31], a[0:7], v14
    v_smfmac_f32_16x16x64_bf16 v[44:47], v[28:31], a[24:31], v14
    v_smfmac_f32_16x16x64_bf16 v[48:51], v[28:31], a[48:55], v14
    v_smfmac_f32_16x16x64_bf16 v[52:55], v[28:31], a[72:79], v14
    v_smfmac_f32_16x16x64_bf16 v[56:59], v[28:31], a[96:103], v14
    v_smfmac_f32_16x16x64_bf16 v[60:63], v[28:31], a[120:127], v14
    v_smfmac_f32_16x16x64_bf16 v[64:67], v[28:31], a[144:151], v14
    v_smfmac_f32_16x16x64_bf16 v[68:71], v[28:31], a[168:175], v14
    s_waitcnt lgkmcnt(1)
    v_smfmac_f32_16x16x64_bf16 v[40:43], v[32:35], a[8:15], v14
    v_smfmac_f32_16x16x64_bf16 v[44:47], v[32:35], a[32:39], v14
    v_smfmac_f32_16x16x64_bf16 v[48:51], v[32:35], a[56:63], v14
    v_smfmac_f32_16x16x64_bf16 v[52:55], v[32:35], a[80:87], v14
    v_smfmac_f32_16x16x64_bf16 v[56:59], v[32:35], a[104:111], v14
    v_smfmac_f32_16x16x64_bf16 v[60:63], v[32:35], a[128:135], v14
    v_smfmac_f32_16x16x64_bf16 v[64:67], v[32:35], a[152:159], v14
    v_smfmac_f32_16x16x64_bf16 v[68:71], v[32:35], a[176:183], v14
    s_waitcnt lgkmcnt(0)
    v_smfmac_f32_16x16x64_bf16 v[40:43], v[36:39], a[16:23], v14
    v_smfmac_f32_16x16x64_bf16 v[44:47], v[36:39], a[40:47], v14
    v_smfmac_f32_16x16x64_bf16 v[48:51], v[36:39], a[64:71], v14
    v_smfmac_f32_16x16x64_bf16 v[52:55], v[36:39], a[88:95], v14
    v_smfmac_f32_16x16x64_bf16 v[56:59], v[36:39], a[112:119], v14
    v_smfmac_f32_16x16x64_bf16 v[60:63], v[36:39], a[136:143], v14
    v_smfmac_f32_16x16x64_bf16 v[64:67], v[36:39], a[160:167], v14
    v_smfmac_f32_16x16x64_bf16 v[68:71], v[36:39], a[184:191], v14
    s_nop 0
    v_add_f32 v24, v40, v41
    v_add_f32 v44, v44, v45
    v_add_f32 v48, v48, v49
    v_max3_f32 v26, v24, v44, v48
    v_add_f32 v52, v52, v53
    v_add_f32 v25, v56, v57
    v_max3_f32 v26, v26, v52, v25
    v_add_f32 v60, v60, v61
    v_add_f32 v64, v64, v65
    v_max3_f32 v26, v26, v60, v64
    v_add_f32 v68, v68, v69
    v_max_f32 v26, v26, v68
    v_mov_b32_dpp v24, v44 quad_perm:[0,1,2,3] row_mask:0x2 bank_mask:0xf
    v_mov_b32_dpp v25, v60 quad_perm:[0,1,2,3] row_mask:0x2 bank_mask:0xf
    v_max_f32_dpp v26, v26, v26 row_ror:8 row_mask:0xf bank_mask:0xf
    v_mov_b32_dpp v24, v48 quad_perm:[0,1,2,3] row_mask:0x4 bank_mask:0xf
    v_mov_b32_dpp v25, v64 quad_perm:[0,1,2,3] row_mask:0x4 bank_mask:0xf
    v_max_f32_dpp v26, v26, v26 row_ror:4 row_mask:0xf bank_mask:0xf
    v_mov_b32_dpp v24, v52 quad_perm:[0,1,2,3] row_mask:0x8 bank_mask:0xf
    v_mov_b32_dpp v25, v68 quad_perm:[0,1,2,3] row_mask:0x8 bank_mask:0xf
    v_max_f32_dpp v26, v26, v26 row_ror:2 row_mask:0xf bank_mask:0xf
    v_accvgpr_read_b32 v27, a252
    s_nop 0
    v_max_f32_dpp v26, v26, v26 row_ror:1 row_mask:0xf bank_mask:0xf
    v_mul_f32 v26, v26, v18
    v_fma_f32 v24, v24, v18, -v26
    v_fma_f32 v25, v25, v18, -v26
    v_exp_f32 v24, v24
    v_exp_f32 v25, v25
    s_nop 0
    v_cvt_pk_bf16_f32 v28, v24, v25
    ds_write_b16 v19, v28
    ds_write_b16_d16_hi v19, v28 offset:128
    s_mov_b64 exec, s[88:89]
    ds_read_b128 v[72:75], v27 offset:0
    ds_read_b128 v[76:79], v27 offset:64
    ds_read_b128 v[80:83], v27 offset:128
    ds_read_b128 v[84:87], v27 offset:192
    s_mov_b64 exec, -1
    v_add_f32 v27, v24, v25
    v_mov_b32 v40, 0
    v_mov_b32 v44, 0
    v_add_f32_dpp v27, v27, v27 row_ror:8 row_mask:0xf bank_mask:0xf
    v_mov_b32 v48, 0
    v_mov_b32 v52, 0
    v_add_f32_dpp v27, v27, v27 row_ror:4 row_mask:0xf bank_mask:0xf
    v_mov_b32 v56, 0
    v_mov_b32 v60, 0
    v_add_f32_dpp v27, v27, v27 row_ror:2 row_mask:0xf bank_mask:0xf
    s_lshl_b32 s78, s72, 3
    s_add_u32 s78, s78, 125440
    v_add_f32_dpp v27, v27, v27 row_ror:1 row_mask:0xf bank_mask:0xf
    v_mov_b32 v28, v27
    s_nop 1
    v_permlane32_swap_b32 v27, v28
    v_add_f32 v27, v27, v28
    v_mov_b32 v28, v27
    s_nop 1
    v_permlane16_swap_b32 v27, v28
    v_add_f32 v27, v27, v28
    v_mov_b32 v28, s78
    ds_write_b64 v28, v[26:27]
    s_waitcnt lgkmcnt(4)
    v_smfmac_f32_16x16x64_bf16 v[40:43], v[72:75], a[192:199], v14 abid:1
    v_smfmac_f32_16x16x64_bf16 v[44:47], v[72:75], a[200:207], v14 abid:1
    v_smfmac_f32_16x16x64_bf16 v[48:51], v[72:75], a[208:215], v14 abid:1
    v_smfmac_f32_16x16x64_bf16 v[52:55], v[72:75], a[216:223], v14 abid:1
    v_smfmac_f32_16x16x64_bf16 v[56:59], v[72:75], a[224:231], v14 abid:1
    v_smfmac_f32_16x16x64_bf16 v[60:63], v[72:75], a[232:239], v14 abid:1
    s_waitcnt lgkmcnt(3)
    v_smfmac_f32_16x16x64_bf16 v[40:43], v[76:79], v[112:119], v14 abid:1
    v_smfmac_f32_16x16x64_bf16 v[44:47], v[76:79], v[120:127], v14 abid:1
    v_smfmac_f32_16x16x64_bf16 v[48:51], v[76:79], v[128:135], v14 abid:1
    v_smfmac_f32_16x16x64_bf16 v[52:55], v[76:79], v[136:143], v14 abid:1
    v_smfmac_f32_16x16x64_bf16 v[56:59], v[76:79], v[144:151], v14 abid:1
    v_smfmac_f32_16x16x64_bf16 v[60:63], v[76:79], v[152:159], v14 abid:1
    s_waitcnt lgkmcnt(2)
    v_smfmac_f32_16x16x64_bf16 v[40:43], v[80:83], v[160:167], v14 abid:1
    v_smfmac_f32_16x16x64_bf16 v[44:47], v[80:83], v[168:175], v14 abid:1
    v_smfmac_f32_16x16x64_bf16 v[48:51], v[80:83], v[176:183], v14 abid:1
    v_smfmac_f32_16x16x64_bf16 v[52:55], v[80:83], v[184:191], v14 abid:1
    v_smfmac_f32_16x16x64_bf16 v[56:59], v[80:83], v[192:199], v14 abid:1
    v_smfmac_f32_16x16x64_bf16 v[60:63], v[80:83], v[200:207], v14 abid:1
    s_waitcnt lgkmcnt(0)
ATT_LAST:
    s_waitcnt lgkmcnt(8)
    v_smfmac_f32_16x16x64_bf16 v[40:43], v[84:87], v[208:215], v14 abid:1
    v_smfmac_f32_16x16x64_bf16 v[44:47], v[84:87], v[216:223], v14 abid:1
    s_waitcnt lgkmcnt(4)
    v_smfmac_f32_16x16x64_bf16 v[48:51], v[84:87], v[224:231], v14 abid:1
    v_smfmac_f32_16x16x64_bf16 v[52:55], v[84:87], v[232:239], v14 abid:1
    s_waitcnt lgkmcnt(0)
    v_smfmac_f32_16x16x64_bf16 v[56:59], v[84:87], v[240:247], v14 abid:1
    v_smfmac_f32_16x16x64_bf16 v[60:63], v[84:87], v[248:255], v14 abid:1
    s_lshl_b32 s77, s72, 8
    s_add_u32 s77, s77, 119296
    v_lshl_add_u32 v24, v0, 2, s77
    v_permlane16_swap_b32 v40, v44
    v_add_f32 v40, v40, v44
    ds_write_b32 v15, v40 offset:0
    v_permlane16_swap_b32 v48, v52
    v_add_f32 v48, v48, v52
    ds_write_b32 v15, v48 offset:256
    v_permlane16_swap_b32 v56, v60
    v_add_f32 v56, v56, v60
    ds_write_b32 v15, v56 offset:512
    v_and_b32 v25, 3, v0
    v_lshlrev_b32 v25, 3, v25
    v_add_u32 v25, 125440, v25
    s_waitcnt lgkmcnt(0)
    s_barrier
    ds_read_b64 v[32:33], v25
    ds_read2st64_b32 v[40:41], v24 offset0:0 offset1:3
    ds_read2st64_b32 v[42:43], v24 offset0:6 offset1:9
    s_mul_i32 s77, s70, 3072
    s_lshl_b32 s78, s71, 4
    s_add_u32 s77, s77, s78
    s_lshl_b32 s78, s72, 10
    s_add_u32 s77, s77, s78
    s_add_u32 s77, s77, s3
    s_add_u32 s77, s77, 32768
    s_lshl_b32 s78, s69, 3
    s_add_u32 s78, s78, s3
    s_add_u32 s78, s78, 45056
    s_cmp_eq_u32 s72, 3
    s_waitcnt lgkmcnt(2)
    v_max_f32_dpp v34, v32, v32 quad_perm:[1,0,3,2] row_mask:0xf bank_mask:0xf
    s_nop 1
    v_max_f32_dpp v34, v34, v34 quad_perm:[2,3,0,1] row_mask:0xf bank_mask:0xf
    v_sub_f32 v32, v32, v34
    v_exp_f32 v32, v32
    s_cbranch_scc1 OML
    s_waitcnt lgkmcnt(0)
    v_mul_f32_dpp v28, v32, v40 quad_perm:[0,0,0,0] row_mask:0xf bank_mask:0xf
    v_mul_f32_dpp v29, v32, v41 quad_perm:[1,1,1,1] row_mask:0xf bank_mask:0xf
    v_mul_f32_dpp v30, v32, v42 quad_perm:[2,2,2,2] row_mask:0xf bank_mask:0xf
    v_fmac_f32_dpp v28, v32, v43 quad_perm:[3,3,3,3] row_mask:0xf bank_mask:0xf
    v_add_f32 v29, v29, v30
    v_add_f32 v28, v28, v29
    s_nop 1
    v_mov_b32_dpp v29, v28 row_shl:1 row_mask:0xf bank_mask:0xf
    v_cvt_pk_bf16_f32 v28, v28, v29
    s_nop 1
    v_mov_b32_dpp v29, v28 row_shl:2 row_mask:0xf bank_mask:0xf
    v_mov_b32_dpp v30, v28 row_shl:4 row_mask:0xf bank_mask:0xf
    v_mov_b32_dpp v31, v28 row_shl:6 row_mask:0xf bank_mask:0xf
    s_mov_b64 exec, s[82:83]
    buffer_store_dwordx4 v[28:31], v1, s[8:11], s77 offen
    s_cmp_eq_u32 s10, 0
    s_cbranch_scc1 SLOW6
BACK6:
    s_mov_b64 exec, -1
ODONE:
    s_cmp_ge_u32 s69, 20
    s_cbranch_scc1 ROLEF
    s_cmp_eq_u32 s74, 0
    s_cbranch_scc1 WLATE
    v_accvgpr_read_b32 v2, a246
    v_accvgpr_read_b32 v3, a247
    v_accvgpr_read_b32 v4, a248
    v_mov_b32 v88, 0
    v_mov_b32 v92, 0
    v_mov_b32 v96, 0
    v_mov_b32 v100, 0
    v_mov_b32 v104, 0
    v_mov_b32 v108, 0
    ds_read_b64_tr_b16 v[40:41], v2 offset:0
    ds_read_b64_tr_b16 v[42:43], v2 offset:256
    ds_read_b64_tr_b16 v[64:65], v2 offset:32
    ds_read_b64_tr_b16 v[66:67], v2 offset:288
    ds_read_b64_tr_b16 v[44:45], v2 offset:2048
    ds_read_b64_tr_b16 v[46:47], v2 offset:2304
    ds_read_b64_tr_b16 v[68:69], v2 offset:2080
    ds_read_b64_tr_b16 v[70:71], v2 offset:2336
    ds_read_b64_tr_b16 v[48:49], v2 offset:4096
    ds_read_b64_tr_b16 v[50:51], v2 offset:4352
    s_cmp_lg_u32 s72, 1
    s_cbranch_scc1 NOOWN0
    v_accvgpr_read_b32 v28, a244
    v_accvgpr_read_b32 v29, a245
    v_max_u32 v30, v28, v29
    v_cmp_eq_u32 vcc, -1, v30
    s_cbranch_vccnz RETRY7
OK7:
    v_lshlrev_b32 v30, 16, v28
    v_and_b32 v28, 0xffff0000, v28
    v_lshlrev_b32 v31, 16, v29
    v_and_b32 v29, 0xffff0000, v29
    v_add_f32 v30, v30, v31
    v_add_f32 v28, v28, v29
    v_mov_b32 v31, v30
    v_mov_b32 v29, v28
    s_nop 0
    v_permlane32_swap_b32 v30, v31
    v_permlane32_swap_b32 v28, v29
    v_add_f32 v30, v30, v31
    v_add_f32 v28, v28, v29
    v_mov_b32 v31, v30
    v_mov_b32 v29, v28
    s_nop 0
    v_permlane16_swap_b32 v30, v31
    v_permlane16_swap_b32 v28, v29
    v_add_f32 v30, v30, v31
    v_add_f32 v28, v28, v29
    v_add_f32 v22, v22, v30
    v_add_f32 v23, v23, v28
    v_cvt_pk_bf16_f32 v28, v22, v23
    s_lshl_b32 s77, s69, 6
    s_add_u32 s77, s77, s3
    s_add_u32 s77, s77, 47872
    v_lshlrev_b32 v32, 2, v0
    v_mov_b32_dpp v29, v28 quad_perm:[1,1,1,1] row_mask:0xf bank_mask:0xf
    v_mov_b32_dpp v30, v28 quad_perm:[2,2,2,2] row_mask:0xf bank_mask:0xf
    v_mov_b32_dpp v31, v28 quad_perm:[3,3,3,3] row_mask:0xf bank_mask:0xf
    s_mov_b32 exec_lo, 0x1111
    s_mov_b32 exec_hi, 0x0
    buffer_store_dwordx4 v[28:31], v32, s[8:11], s77 offen
    s_cmp_eq_u32 s10, 0
    s_cbranch_scc1 SLOW8
BACK8:
    s_mov_b64 exec, -1
NOOWN0:
    v_mov_b32 v25, 0
    v_mov_b32 v27, 0
    v_mov_b32 v37, 0
    v_mov_b32 v39, 0
    s_mov_b32 exec_lo, 0x00ff00ff
    s_mov_b32 exec_hi, 0x00ff00ff
    buffer_load_dwordx4 v[88:91], v3, s[16:19], s3 offen offset:0 sc1
    buffer_load_dwordx4 v[92:95], v3, s[16:19], s3 offen offset:512 sc1
    buffer_load_dwordx4 v[96:99], v3, s[16:19], s3 offen offset:1024 sc1
    buffer_load_dwordx4 v[100:103], v3, s[16:19], s3 offen offset:1536 sc1
    buffer_load_dwordx4 v[104:107], v3, s[16:19], s3 offen offset:2048 sc1
    buffer_load_dwordx4 v[108:111], v3, s[16:19], s3 offen offset:2560 sc1
    s_mov_b32 exec_lo, -1
    s_mov_b32 exec_hi, 0
    buffer_load_dwordx4 v[24:27], v4, s[16:19], s3 offen offset:0 sc1
    buffer_load_dwordx4 v[36:39], v4, s[16:19], s3 offen offset:16 sc1
    s_mov_b64 exec, -1
    ds_read_b64_tr_b16 v[72:73], v2 offset:4128
    ds_read_b64_tr_b16 v[74:75], v2 offset:4384
    ds_read_b64_tr_b16 v[52:53], v2 offset:6144
    ds_read_b64_tr_b16 v[54:55], v2 offset:6400
    ds_read_b64_tr_b16 v[76:77], v2 offset:6176
    ds_read_b64_tr_b16 v[78:79], v2 offset:6432
    ds_read_b64_tr_b16 v[56:57], v2 offset:8192
    ds_read_b64_tr_b16 v[58:59], v2 offset:8448
    ds_read_b64_tr_b16 v[80:81], v2 offset:8224
    ds_read_b64_tr_b16 v[82:83], v2 offset:8480
    ds_read_b64_tr_b16 v[60:61], v2 offset:10240
    ds_read_b64_tr_b16 v[62:63], v2 offset:10496
    ds_read_b64_tr_b16 v[84:85], v2 offset:10272
    ds_read_b64_tr_b16 v[86:87], v2 offset:10528
    v_accvgpr_read_b32 v5, a249
    v_and_b32 v18, 3, v0
    v_lshrrev_b32 v6, 5, v0
    v_lshl_add_u32 v18, v6, 2, v18
    v_mul_u32_u24 v18, 10240, v18
    v_bfe_u32 v6, v0, 3, 2
    v_lshl_add_u32 v18, v6, 4, v18
    v_and_b32 v6, 0xffffff7f, v5
WCHK:
    s_waitcnt vmcnt(0)
    v_max3_u32 v28, v88, v92, v96
    v_max3_u32 v28, v28, v100, v104
    v_max3_u32 v28, v28, v108, v25
    v_max3_u32 v28, v28, v27, v37
    v_max_u32 v28, v28, v39
    v_cmp_eq_u32 vcc, -1, v28
    s_cbranch_vccnz AGAIN9
POLLX9:
    s_waitcnt lgkmcnt(0)
    v_mfma_f32_16x16x32_bf16 v[28:31], v[88:91], v[40:43], 0
    v_mfma_f32_16x16x32_bf16 v[32:35], v[88:91], v[64:67], 0
    v_max3_f32 v88, v24, v26, v36
    v_max_f32 v88, v88, v38
    v_mfma_f32_16x16x32_bf16 v[28:31], v[92:95], v[44:47], v[28:31]
    v_mov_b32 v89, v88
    v_mfma_f32_16x16x32_bf16 v[32:35], v[92:95], v[68:71], v[32:35]
    s_nop 0
    v_permlane16_swap_b32 v88, v89
    v_max_f32 v88, v88, v89
    v_mfma_f32_16x16x32_bf16 v[28:31], v[96:99], v[48:51], v[28:31]
    v_sub_f32 v24, v24, v88
    v_sub_f32 v26, v26, v88
    v_mfma_f32_16x16x32_bf16 v[32:35], v[96:99], v[72:75], v[32:35]
    v_sub_f32 v36, v36, v88
    v_sub_f32 v38, v38, v88
    v_mfma_f32_16x16x32_bf16 v[28:31], v[100:103], v[52:55], v[28:31]
    v_exp_f32 v24, v24
    v_mfma_f32_16x16x32_bf16 v[32:35], v[100:103], v[76:79], v[32:35]
    v_exp_f32 v26, v26
    v_mfma_f32_16x16x32_bf16 v[28:31], v[104:107], v[56:59], v[28:31]
    v_exp_f32 v36, v36
    v_mfma_f32_16x16x32_bf16 v[32:35], v[104:107], v[80:83], v[32:35]
    v_exp_f32 v38, v38
    v_mfma_f32_16x16x32_bf16 v[28:31], v[108:111], v[60:63], v[28:31]
    v_mul_f32 v90, v24, v25
    v_fmac_f32 v90, v26, v27
    v_mfma_f32_16x16x32_bf16 v[32:35], v[108:111], v[84:87], v[32:35]
    v_fmac_f32 v90, v36, v37
    v_fmac_f32 v90, v38, v39
    v_mov_b32 v89, v90
    s_cmp_lg_u32 s72, 0
    s_nop 0
    v_permlane16_swap_b32 v90, v89
    v_add_f32 v90, v90, v89
    v_rcp_f32 v90, v90
    v_mul_f32 v28, v24, v28
    v_mul_f32 v32, v24, v32
    v_fmac_f32 v28, v26, v29
    v_fmac_f32 v32, v26, v33
    v_fmac_f32 v28, v36, v30
    v_fmac_f32 v32, v36, v34
    v_fmac_f32 v28, v38, v31
    v_fmac_f32 v32, v38, v35
    s_nop 1
    v_permlane16_swap_b32 v28, v32
    v_add_f32 v28, v28, v32
    v_mul_f32 v28, v28, v90
    ds_write_b32 v5, v28
    s_waitcnt lgkmcnt(0)
    s_barrier
    s_cbranch_scc1 WNOT0
    ds_read2st64_b32 v[28:29], v6 offset0:0 offset1:1
    ds_read2st64_b32 v[30:31], v6 offset0:2 offset1:3
    s_waitcnt lgkmcnt(1)
    v_add_f32 v28, v28, v29
    s_waitcnt lgkmcnt(0)
    v_add_f32 v30, v30, v31
    v_add_f32 v28, v28, v30
    s_nop 1
    v_mov_b32_dpp v29, v28 row_shl:1 row_mask:0xf bank_mask:0xf
    v_cvt_pk_bf16_f32 v32, v28, v29
    s_nop 1
    v_mov_b32_dpp v28, v32 quad_perm:[0,0,0,0] row_mask:0xf bank_mask:0xf
    v_mov_b32_dpp v29, v32 quad_perm:[2,2,2,2] row_mask:0xf bank_mask:0xf
    s_nop 0
    v_mov_b32_dpp v30, v28 row_shl:4 row_mask:0xf bank_mask:0xf
    v_mov_b32_dpp v31, v29 row_shl:4 row_mask:0xf bank_mask:0xf
    s_mov_b64 exec, s[46:47]
    buffer_store_dwordx4 v[28:31], v18, s[16:19], s80 offen sc1
    s_mov_b64 exec, s[92:93]
    buffer_store_dwordx4 v[28:31], v18, s[8:11], s81 offen
    s_cmp_eq_u32 s10, 0
    s_cbranch_scc1 SLOW10
BACK10:
    s_mov_b64 exec, -1
    v_lshrrev_b32 v37, 5, v0
    v_mul_u32_u24 v37, 2560, v37
    v_and_b32 v38, 31, v0
    v_lshl_add_u32 v37, v38, 2, v37
    v_add_u32 v41, 5120, v37
    v_add_u32 v42, 10240, v37
    v_add_u32 v43, 15360, v37
    v_add_u32 v44, 20480, v37
    v_add_u32 v45, 25600, v37
    s_lshl_b32 s79, s69, 7
    s_add_u32 s79, s79, s3
    s_add_u32 s79, s79, 51200
    s_add_u32 s96, s80, 81920
    s_add_u32 s97, s81, 1280
    s_cmp_lg_u32 s74, 0
    s_cbranch_scc1 NOLC
    s_mul_i32 s77, s69, 2464
    s_add_u32 s78, s3, 851968
    v_add_u32 v48, s77, v1
    v_min_u32 v48, 49136, v48
    s_add_u32 s77, s77, 1024
    v_add_u32 v49, s77, v1
    v_min_u32 v49, 49136, v49
    s_add_u32 s77, s77, 1024
    v_add_u32 v50, s77, v1
    v_min_u32 v50, 49136, v50
    s_add_u32 s77, s77, 1024
    buffer_load_dwordx4 a[240:243], v48, s[16:19], s78 offen sc1
    buffer_load_dwordx4 a[240:243], v49, s[16:19], s78 offen sc1
    buffer_load_dwordx4 a[240:243], v50, s[16:19], s78 offen sc1
    v_mov_b32 v52, -1
    v_mov_b32 v53, -1
    v_mov_b32 v54, -1
    v_mov_b32 v55, -1
    s_add_u32 s77, s80, 819200
    s_add_u32 s7, s96, 819200
    s_waitcnt vmcnt(0)
    buffer_store_dwordx4 v[52:55], v48, s[8:11], s78 offen
    s_cmp_eq_u32 s10, 0
    s_cbranch_scc1 SLOW11
BACK11:
    buffer_store_dwordx4 v[52:55], v49, s[8:11], s78 offen
    s_cmp_eq_u32 s10, 0
    s_cbranch_scc1 SLOW12
BACK12:
    buffer_store_dwordx4 v[52:55], v50, s[8:11], s78 offen
    s_cmp_eq_u32 s10, 0
    s_cbranch_scc1 SLOW13
BACK13:
    s_mov_b64 exec, s[44:45]
    buffer_store_dwordx4 v[52:55], v18, s[16:19], s77 offen sc1
    s_mov_b64 exec, s[92:93]
    buffer_store_dwordx4 v[52:55], v18, s[16:19], s7 offen sc1
    s_mov_b64 exec, -1
NOLC:
    s_mov_b32 s76, 1
POLL14:
    buffer_load_dword v28, v37, s[16:19], s79 offen sc1
    buffer_load_dword v29, v41, s[16:19], s79 offen sc1
    buffer_load_dword v30, v42, s[16:19], s79 offen sc1
    buffer_load_dword v31, v43, s[16:19], s79 offen sc1
    buffer_load_dword v32, v44, s[16:19], s79 offen sc1
    buffer_load_dword v33, v45, s[16:19], s79 offen sc1
    s_waitcnt vmcnt(0)
    v_add_f32 v28, v28, v29
    v_add_f32 v30, v30, v31
    v_add_f32 v32, v32, v33
    v_add_f32 v28, v28, v30
    v_add_f32 v29, v28, v32
    v_add_f32 v28, v28, v32
    v_cmp_u_f32 vcc, v28, v28
    s_cbranch_vccnz AGAIN14
POLLX14:
    v_permlane32_swap_b32 v28, v29
    v_add_f32 v28, v28, v29
    s_nop 1
    v_mov_b32_dpp v29, v28 row_shl:1 row_mask:0xf bank_mask:0xf
    v_cvt_pk_bf16_f32 v32, v28, v29
    s_nop 1
    v_mov_b32_dpp v28, v32 quad_perm:[0,0,0,0] row_mask:0xf bank_mask:0xf
    v_mov_b32_dpp v29, v32 quad_perm:[2,2,2,2] row_mask:0xf bank_mask:0xf
    s_nop 0
    v_mov_b32_dpp v30, v28 row_shl:4 row_mask:0xf bank_mask:0xf
    v_mov_b32_dpp v31, v29 row_shl:4 row_mask:0xf bank_mask:0xf
    s_mov_b64 exec, s[48:49]
    buffer_store_dwordx4 v[28:31], v18, s[16:19], s96 offen sc1
    s_mov_b64 exec, s[92:93]
    buffer_store_dwordx4 v[28:31], v18, s[8:11], s97 offen
    s_cmp_eq_u32 s10, 0
    s_cbranch_scc1 SLOW15
BACK15:
    s_mov_b64 exec, -1
    s_branch NEXT
AGAIN2:
    s_add_u32 s76, s76, 1
    s_cmp_lt_u32 s76, 32768
    s_cbranch_scc1 POLL2
    s_branch POLLX2
BR3:
    s_cmp_ge_u32 s76, 32768
    s_cbranch_scc1 BX3
BL3:
    s_mov_b64 exec, s[86:87]
    v_cmp_eq_u32 vcc, -1, v80
    s_nop 0
    s_mov_b64 exec, vcc
    s_cbranch_execz BS3_0
    buffer_load_dwordx4 v[80:83], v8, s[16:19], 0 offen sc1
BS3_0:
    s_mov_b64 exec, s[86:87]
    v_cmp_eq_u32 vcc, -1, v84
    s_nop 0
    s_mov_b64 exec, vcc
    s_cbranch_execz BS3_1
    buffer_load_dwordx4 v[84:87], v9, s[16:19], 0 offen sc1
BS3_1:
    s_mov_b64 exec, s[86:87]
    s_add_u32 s76, s76, 1
    s_cmp_ge_u32 s76, 32768
    s_waitcnt vmcnt(0)
    v_max_u32 v24, v80, v84
    v_cmp_eq_u32 vcc, -1, v24
    s_cbranch_vccz BW3
    s_cbranch_scc0 BL3
    s_branch BW3
AGAIN5:
    s_add_u32 s76, s76, 1
    s_cmp_lt_u32 s76, 32768
    s_cbranch_scc1 POLL5
    s_branch POLLX5
OML:
    v_mul_f32 v35, v32, v33
    s_nop 1
    v_add_f32_dpp v35, v35, v35 quad_perm:[1,0,3,2] row_mask:0xf bank_mask:0xf
    s_nop 1
    v_add_f32_dpp v35, v35, v35 quad_perm:[2,3,0,1] row_mask:0xf bank_mask:0xf
    s_mov_b64 exec, 1
    buffer_store_dwordx2 v[34:35], v1, s[8:11], s78 offen
    s_cmp_eq_u32 s10, 0
    s_cbranch_scc1 SLOW16
BACK16:
    s_mov_b64 exec, -1
    s_waitcnt lgkmcnt(0)
    s_branch ODONE
WLATE:
    v_lshrrev_b32 v38, 2, v0
    v_mul_u32_u24 v38, 1280, v38
    v_and_b32 v39, 3, v0
    v_lshl_add_u32 v39, v39, 4, v38
    s_mov_b32 m0, s67
    s_add_u32 s67, s67, 1024
    buffer_load_dwordx4 v39, s[24:27], s66 offen  lds
    s_add_u32 s66, s66, 20480
    s_mov_b32 m0, s67
    s_add_u32 s67, s67, 1024
    buffer_load_dwordx4 v39, s[24:27], s66 offen  lds
    s_add_u32 s66, s66, 20480
    s_mov_b32 m0, s67
    s_add_u32 s67, s67, 1024
    buffer_load_dwordx4 v39, s[24:27], s66 offen  lds
    s_add_u32 s66, s66, 20480
    s_mov_b32 m0, s67
    s_add_u32 s67, s67, 1024
    buffer_load_dwordx4 v39, s[24:27], s66 offen  lds
    s_add_u32 s66, s66, 20480
    s_add_u32 s77, s3, 1638400
    buffer_store_dword v7, v10, s[8:11], s77 offen
    s_cmp_eq_u32 s10, 0
    s_cbranch_scc1 SLOW17
BACK17:
    s_cmp_lg_u32 s72, 3
    s_cbranch_scc1 NOFPC
    v_mov_b32 v24, -1
    v_mov_b32 v25, -1
    v_mov_b32 v26, -1
    v_mov_b32 v27, -1
    v_accvgpr_read_b32 v28, a250
    buffer_store_dwordx4 v[24:27], v28, s[8:11], 0 offen
    s_cmp_eq_u32 s10, 0
    s_cbranch_scc1 SLOW18
BACK18:
    v_accvgpr_read_b32 v29, a251
    buffer_store_dwordx4 v[24:27], v29, s[8:11], 0 offen
    s_cmp_eq_u32 s10, 0
    s_cbranch_scc1 SLOW19
BACK19:
NOFPC:
    v_accvgpr_read_b32 v2, a246
    v_accvgpr_read_b32 v3, a247
    v_accvgpr_read_b32 v4, a248
    v_mov_b32 v88, 0
    v_mov_b32 v92, 0
    v_mov_b32 v96, 0
    v_mov_b32 v100, 0
    v_mov_b32 v104, 0
    v_mov_b32 v108, 0
    v_mov_b32 v25, 0
    v_mov_b32 v27, 0
    v_mov_b32 v37, 0
    v_mov_b32 v39, 0
    s_mov_b32 exec_lo, 0x00ff00ff
    s_mov_b32 exec_hi, 0x00ff00ff
    buffer_load_dwordx4 v[88:91], v3, s[16:19], s3 offen offset:0 sc1
    buffer_load_dwordx4 v[92:95], v3, s[16:19], s3 offen offset:512 sc1
    buffer_load_dwordx4 v[96:99], v3, s[16:19], s3 offen offset:1024 sc1
    buffer_load_dwordx4 v[100:103], v3, s[16:19], s3 offen offset:1536 sc1
    buffer_load_dwordx4 v[104:107], v3, s[16:19], s3 offen offset:2048 sc1
    buffer_load_dwordx4 v[108:111], v3, s[16:19], s3 offen offset:2560 sc1
    s_mov_b32 exec_lo, -1
    s_mov_b32 exec_hi, 0
    buffer_load_dwordx4 v[24:27], v4, s[16:19], s3 offen offset:0 sc1
    buffer_load_dwordx4 v[36:39], v4, s[16:19], s3 offen offset:16 sc1
    s_mov_b64 exec, -1
    s_waitcnt vmcnt(8)
    ds_read_b64_tr_b16 v[40:41], v2 offset:0
    ds_read_b64_tr_b16 v[42:43], v2 offset:256
    ds_read_b64_tr_b16 v[64:65], v2 offset:32
    ds_read_b64_tr_b16 v[66:67], v2 offset:288
    ds_read_b64_tr_b16 v[44:45], v2 offset:2048
    ds_read_b64_tr_b16 v[46:47], v2 offset:2304
    ds_read_b64_tr_b16 v[68:69], v2 offset:2080
    ds_read_b64_tr_b16 v[70:71], v2 offset:2336
    ds_read_b64_tr_b16 v[48:49], v2 offset:4096
    ds_read_b64_tr_b16 v[50:51], v2 offset:4352
    ds_read_b64_tr_b16 v[72:73], v2 offset:4128
    ds_read_b64_tr_b16 v[74:75], v2 offset:4384
    ds_read_b64_tr_b16 v[52:53], v2 offset:6144
    ds_read_b64_tr_b16 v[54:55], v2 offset:6400
    ds_read_b64_tr_b16 v[76:77], v2 offset:6176
    ds_read_b64_tr_b16 v[78:79], v2 offset:6432
    ds_read_b64_tr_b16 v[56:57], v2 offset:8192
    ds_read_b64_tr_b16 v[58:59], v2 offset:8448
    ds_read_b64_tr_b16 v[80:81], v2 offset:8224
    ds_read_b64_tr_b16 v[82:83], v2 offset:8480
    ds_read_b64_tr_b16 v[60:61], v2 offset:10240
    ds_read_b64_tr_b16 v[62:63], v2 offset:10496
    ds_read_b64_tr_b16 v[84:85], v2 offset:10272
    ds_read_b64_tr_b16 v[86:87], v2 offset:10528
    v_accvgpr_read_b32 v5, a249
    v_and_b32 v18, 3, v0
    v_lshrrev_b32 v6, 5, v0
    v_lshl_add_u32 v18, v6, 2, v18
    v_mul_u32_u24 v18, 10240, v18
    v_bfe_u32 v6, v0, 3, 2
    v_lshl_add_u32 v18, v6, 4, v18
    v_and_b32 v6, 0xffffff7f, v5
    s_branch WCHK
AGAIN9:
    s_mov_b64 s[94:95], exec
    s_mov_b32 s76, 1
AG29:
    v_max3_u32 v28, v88, v92, v96
    v_max3_u32 v28, v28, v100, v104
    v_max_u32 v28, v28, v108
    v_cmp_eq_u32 vcc, -1, v28
    s_nop 0
    s_mov_b64 exec, vcc
    s_cbranch_execz AG39_0
    buffer_load_dwordx4 v[88:91], v3, s[16:19], s3 offen offset:0 sc1
    buffer_load_dwordx4 v[92:95], v3, s[16:19], s3 offen offset:512 sc1
    buffer_load_dwordx4 v[96:99], v3, s[16:19], s3 offen offset:1024 sc1
    buffer_load_dwordx4 v[100:103], v3, s[16:19], s3 offen offset:1536 sc1
    buffer_load_dwordx4 v[104:107], v3, s[16:19], s3 offen offset:2048 sc1
    buffer_load_dwordx4 v[108:111], v3, s[16:19], s3 offen offset:2560 sc1
AG39_0:
    s_mov_b64 exec, s[94:95]
    v_max3_u32 v28, v25, v27, v37
    v_max_u32 v28, v28, v39
    v_cmp_eq_u32 vcc, -1, v28
    s_nop 0
    s_mov_b64 exec, vcc
    s_cbranch_execz AG39_1
    buffer_load_dwordx4 v[24:27], v4, s[16:19], s3 offen offset:0 sc1
    buffer_load_dwordx4 v[36:39], v4, s[16:19], s3 offen offset:16 sc1
AG39_1:
    s_mov_b64 exec, s[94:95]
    s_add_u32 s76, s76, 1
    s_cmp_ge_u32 s76, 32768
    s_waitcnt vmcnt(0)
    v_max3_u32 v28, v88, v92, v96
    v_max3_u32 v28, v28, v100, v104
    v_max3_u32 v28, v28, v108, v25
    v_max3_u32 v28, v28, v27, v37
    v_max_u32 v28, v28, v39
    v_cmp_eq_u32 vcc, -1, v28
    s_cbranch_vccz POLLX9
    s_cbranch_scc0 AG29
    s_branch POLLX9
AGAIN14:
    s_add_u32 s76, s76, 1
    s_cmp_lt_u32 s76, 32768
    s_cbranch_scc1 POLL14
    s_branch POLLX14
WNOT0:
    s_cmp_lg_u32 s72, 1
    s_cbranch_scc1 NEXT
    v_and_b32 v25, 15, v0
    v_lshrrev_b32 v26, 4, v0
    s_mul_i32 s7, s68, 10240
    s_cmp_eq_u32 s74, 0
    s_cselect_b32 s7, 0, s7
    s_add_u32 s7, s7, 655360
    v_mul_u32_u24 v37, 1280, v26
    v_add_u32 v37, s7, v37
    s_mul_i32 s7, s68, 81920
    s_add_u32 s7, s7, 45312
    v_mov_b32 v38, s7
    v_cmp_eq_u32 vcc, s68, v26
    s_nop 1
    v_cndmask_b32 v37, v37, v38, vcc
    v_add_u32 v39, 4, v26
    s_mul_i32 s7, s68, 10240
    s_cmp_eq_u32 s74, 0
    s_cselect_b32 s7, 0, s7
    s_add_u32 s7, s7, 655360
    v_mul_u32_u24 v38, 1280, v39
    v_add_u32 v38, s7, v38
    s_mul_i32 s7, s68, 81920
    s_add_u32 s7, s7, 45312
    v_mov_b32 v28, s7
    v_cmp_eq_u32 vcc, s68, v39
    s_nop 1
    v_cndmask_b32 v38, v38, v28, vcc
    s_lshl_b32 s77, s69, 6
    s_add_u32 s77, s77, s74
    v_lshl_add_u32 v37, v25, 2, v37
    v_lshl_add_u32 v38, v25, 2, v38
    s_sleep 16
    s_mov_b32 s76, 1
POLL20:
    buffer_load_dword v28, v37, s[16:19], s77 offen sc1
    buffer_load_dword v29, v38, s[16:19], s77 offen sc1
POLLW20:
    s_waitcnt vmcnt(0)
    v_max_u32 v30, v28, v29
    v_cmp_eq_u32 vcc, -1, v30
    s_cbranch_vccnz AGAIN20
POLLX20:
    v_lshlrev_b32 v30, 16, v28
    v_and_b32 v28, 0xffff0000, v28
    v_lshlrev_b32 v31, 16, v29
    v_and_b32 v29, 0xffff0000, v29
    v_add_f32 v30, v30, v31
    v_add_f32 v28, v28, v29
    v_mov_b32 v31, v30
    v_mov_b32 v29, v28
    s_nop 0
    v_permlane32_swap_b32 v30, v31
    v_permlane32_swap_b32 v28, v29
    v_add_f32 v30, v30, v31
    v_add_f32 v28, v28, v29
    v_mov_b32 v31, v30
    v_mov_b32 v29, v28
    s_nop 0
    v_permlane16_swap_b32 v30, v31
    v_permlane16_swap_b32 v28, v29
    v_add_f32 v30, v30, v31
    v_add_f32 v28, v28, v29
    v_add_f32 v22, v22, v30
    v_add_f32 v23, v23, v28
    v_cvt_pk_bf16_f32 v28, v22, v23
    s_cmp_lg_u32 s74, 0
    s_cbranch_scc1 FINAL
    s_lshl_b32 s77, s69, 6
    s_add_u32 s77, s77, s3
    s_add_u32 s77, s77, 49152
    v_lshlrev_b32 v32, 2, v0
    v_mov_b32_dpp v29, v28 quad_perm:[1,1,1,1] row_mask:0xf bank_mask:0xf
    v_mov_b32_dpp v30, v28 quad_perm:[2,2,2,2] row_mask:0xf bank_mask:0xf
    v_mov_b32_dpp v31, v28 quad_perm:[3,3,3,3] row_mask:0xf bank_mask:0xf
    s_mov_b32 exec_lo, 0x1111
    s_mov_b32 exec_hi, 0x0
    buffer_store_dwordx4 v[28:31], v32, s[8:11], s77 offen
    s_cmp_eq_u32 s10, 0
    s_cbranch_scc1 SLOW21
BACK21:
    s_mov_b64 exec, -1
    s_branch NEXT
FINAL:
    s_cmp_lg_u32 s68, 0
    s_cbranch_scc1 DONE
    s_lshl_b32 s77, s69, 6
    v_lshlrev_b32 v37, 2, v0
    s_add_u32 s79, s77, s3
    s_add_u32 s79, s79, 46592
    s_mov_b64 exec, 15
    s_mov_b32 s76, 1
POLL22:
    buffer_load_dword v28, v1, s[16:19], s79 offen sc1
POLLW22:
    s_waitcnt vmcnt(0)
    v_cmp_eq_u32 vcc, -1, v28
    s_cbranch_vccnz AGAIN22
POLLX22:
    s_mov_b64 exec, -1
    s_mov_b32 s76, 1
POLL23:
    buffer_load_dword v28, v20, s[16:19], s74 offen sc1
    buffer_load_dword v29, v21, s[16:19], s74 offen sc1
POLLW23:
    s_waitcnt vmcnt(0)
    v_max_u32 v30, v28, v29
    v_cmp_eq_u32 vcc, -1, v30
    s_cbranch_vccnz AGAIN23
POLLX23:
    v_lshlrev_b32 v30, 16, v28
    v_and_b32 v28, 0xffff0000, v28
    v_lshlrev_b32 v31, 16, v29
    v_and_b32 v29, 0xffff0000, v29
    v_add_f32 v30, v30, v31
    v_add_f32 v28, v28, v29
    v_mov_b32 v31, v30
    v_mov_b32 v29, v28
    s_nop 0
    v_permlane32_swap_b32 v30, v31
    v_permlane32_swap_b32 v28, v29
    v_add_f32 v30, v30, v31
    v_add_f32 v28, v28, v29
    v_mov_b32 v31, v30
    v_mov_b32 v29, v28
    s_nop 0
    v_permlane16_swap_b32 v30, v31
    v_permlane16_swap_b32 v28, v29
    v_add_f32 v30, v30, v31
    v_add_f32 v28, v28, v29
    v_add_f32 v22, v22, v30
    v_add_f32 v23, v23, v28
    v_cvt_pk_bf16_f32 v28, v22, v23
    s_mov_b32 exec_lo, 0xffff
    s_mov_b32 exec_hi, 0x0
    buffer_store_dword v28, v37, s[40:43], s77 offen
    s_mov_b64 exec, -1
    s_endpgm
AGAIN20:
    s_sleep 4
    s_add_u32 s76, s76, 1
    s_cmp_lt_u32 s76, 32768
    s_cbranch_scc1 POLL20
    s_branch POLLX20
AGAIN22:
    s_add_u32 s76, s76, 1
    s_cmp_lt_u32 s76, 32768
    s_cbranch_scc1 POLL22
    s_branch POLLX22
AGAIN23:
    s_add_u32 s76, s76, 1
    s_cmp_lt_u32 s76, 32768
    s_cbranch_scc1 POLL23
    s_branch POLLX23
ROLEF:
    v_and_b32 v25, 15, v0
    v_lshrrev_b32 v26, 4, v0
    v_bfe_u32 v27, v0, 2, 2
    v_and_b32 v36, 3, v0
    s_mov_b32 s4, 1
    s_cmp_lg_u32 s74, 0
    s_cbranch_scc1 FW
    s_mov_b32 s4, 0
    s_mul_i32 s79, s68, 12
    s_add_u32 s79, s79, s69
    s_sub_u32 s79, s79, 20
    s_mul_i32 s97, s72, 5120
    s_mul_i32 s96, s79, 20480
    s_add_u32 s96, s96, s97
    s_add_u32 m0, s97, 98304
    s_nop 0
    buffer_load_dwordx4 v1, s[32:35], s96 offen nt lds
    s_add_u32 s96, s96, 1024
    s_add_u32 m0, s97, 99328
    s_nop 0
    buffer_load_dwordx4 v1, s[32:35], s96 offen nt lds
    s_add_u32 s96, s96, 1024
    s_add_u32 m0, s97, 100352
    s_nop 0
    buffer_load_dwordx4 v1, s[32:35], s96 offen nt lds
    s_add_u32 s96, s96, 1024
    s_add_u32 m0, s97, 101376
    s_nop 0
    buffer_load_dwordx4 v1, s[32:35], s96 offen nt lds
    s_add_u32 s96, s96, 1024
    s_add_u32 m0, s97, 102400
    s_nop 0
    buffer_load_dwordx4 v1, s[32:35], s96 offen nt lds
    s_sub_u32 s96, s69, 20
    s_lshl_b32 s96, s96, 2
    s_add_u32 s96, s96, s72
    s_mul_i32 s96, s96, 688
    v_add_u32 v21, s96, v1
    v_min_u32 v21, 32752, v21
    s_add_u32 s97, s3, 819200
    buffer_load_dwordx4 a[240:243], v21, s[16:19], s97 offen sc1
FW:
    s_mul_i32 s77, s72, 5120
    s_add_u32 s77, s77, 57344
    v_lshl_add_u32 v37, v26, 3, v27
    v_lshlrev_b32 v37, 5, v37
    v_lshl_add_u32 v37, v36, 3, v37
    v_add_u32 v37, s77, v37
    ds_read_b64_tr_b16 v[40:41], v37 offset:0
    ds_read_b64_tr_b16 v[42:43], v37 offset:128
    ds_read_b64_tr_b16 v[44:45], v37 offset:1024
    ds_read_b64_tr_b16 v[46:47], v37 offset:1152
    ds_read_b64_tr_b16 v[48:49], v37 offset:2048
    ds_read_b64_tr_b16 v[50:51], v37 offset:2176
    ds_read_b64_tr_b16 v[52:53], v37 offset:3072
    ds_read_b64_tr_b16 v[54:55], v37 offset:3200
    ds_read_b64_tr_b16 v[56:57], v37 offset:4096
    ds_read_b64_tr_b16 v[58:59], v37 offset:4224
    ds_read_b64_tr_b16 v[60:61], v37 offset:20480
    ds_read_b64_tr_b16 v[62:63], v37 offset:20608
    ds_read_b64_tr_b16 v[64:65], v37 offset:21504
    ds_read_b64_tr_b16 v[66:67], v37 offset:21632
    ds_read_b64_tr_b16 v[68:69], v37 offset:22528
    ds_read_b64_tr_b16 v[70:71], v37 offset:22656
    ds_read_b64_tr_b16 v[72:73], v37 offset:23552
    ds_read_b64_tr_b16 v[74:75], v37 offset:23680
    ds_read_b64_tr_b16 v[76:77], v37 offset:24576
    ds_read_b64_tr_b16 v[78:79], v37 offset:24704
    s_mul_i32 s77, s72, 320
    s_add_u32 s77, s77, 98304
    v_lshrrev_b32 v80, 2, v0
    v_mul_u32_u24 v80, 1280, v80
    v_lshl_add_u32 v80, v36, 3, v80
    v_add_u32 v80, s77, v80
    s_lshl_b32 s79, s72, 2
    s_add_u32 s79, s79, 123392
    v_add_u32 v81, s79, v1
    v_lshl_add_u32 v82, v26, 2, v36
    v_lshlrev_b32 v82, 4, v82
    v_add_u32 v82, 123392, v82
    v_cmp_eq_u32 vcc, 12, v25
    v_mov_b32 v83, 123904
    v_mov_b32 v85, 0x3727c5ac
    v_lshlrev_b32 v84, 6, v25
    v_lshl_add_u32 v84, v26, 4, v84
    s_mov_b32 s64, 0x03ff03ff
    s_mov_b32 s65, 0x03ff03ff
    s_mov_b32 s66, 0x3acccccd
    s_mov_b32 s44, 0x10001
    s_mov_b32 s45, 0x10001
    s_mov_b32 s46, 0x20002
    s_mov_b32 s47, 0x20002
    s_mov_b32 s48, 0x40004
    s_mov_b32 s49, 0x40004
    s_mov_b32 s50, 0x80008
    s_mov_b32 s51, 0x80008
    s_mov_b32 s52, 0x100010
    s_mov_b32 s53, 0x100010
    s_mov_b32 s54, 0x200020
    s_mov_b32 s55, 0x200020
    s_mov_b32 s56, 0x400040
    s_mov_b32 s57, 0x400040
    s_mov_b32 s58, 0x800080
    s_mov_b32 s59, 0x800080
    s_mov_b32 s60, 0x1000100
    s_mov_b32 s61, 0x1000100
    s_mov_b32 s62, 0x2000200
    s_mov_b32 s63, 0x2000200
    v_mov_b32 v38, 0x3f803f80
    v_cndmask_b32 v88, 0, v38, vcc
    v_mov_b32 v89, v88
    v_mov_b32 v90, v88
    v_mov_b32 v91, v88
    v_mov_b32 v92, v88
    v_mov_b32 v93, v88
    v_mov_b32 v94, v88
    v_mov_b32 v95, v88
    v_mov_b32 v96, v88
    v_mov_b32 v97, v88
    v_mov_b32 v98, v88
    v_mov_b32 v99, v88
    v_mov_b32 v100, v88
    v_mov_b32 v101, v88
    v_mov_b32 v102, v88
    v_mov_b32 v103, v88
    v_mov_b32 v104, v88
    v_mov_b32 v105, v88
    v_mov_b32 v106, v88
    v_mov_b32 v107, v88
    s_mul_i32 s77, s72, 6656
    v_mul_u32_u24 v6, 336, v25
    v_lshl_add_u32 v6, v26, 4, v6
    v_add_u32 v6, s77, v6
    v_mul_u32_u24 v37, 52, v0
    v_lshrrev_b32 v37, 10, v37
    v_lshl_add_u32 v87, v37, 4, v1
    v_add_u32 v87, s77, v87
    v_mul_u32_u24 v27, 320, v37
    v_sub_u32 v27, v1, v27
    s_mul_i32 s7, s68, 10240
    s_cmp_eq_u32 s74, 0
    s_cselect_b32 s7, 0, s7
    s_add_u32 s7, s7, 655360
    v_mul_u32_u24 v86, 1280, v37
    v_add_u32 v86, s7, v86
    s_mul_i32 s7, s68, 81920
    s_add_u32 s7, s7, 45312
    v_mov_b32 v38, s7
    v_cmp_eq_u32 vcc, s68, v37
    s_nop 1
    v_cndmask_b32 v86, v86, v38, vcc
    v_add_u32 v38, 2560, v38
    v_cmp_le_u32 vcc, 8, v37
    s_nop 1
    v_cndmask_b32 v86, v86, v38, vcc
    v_add_u32 v86, v86, v27
    v_add_u32 v37, 3, v37
    s_mul_i32 s7, s68, 10240
    s_cmp_eq_u32 s74, 0
    s_cselect_b32 s7, 0, s7
    s_add_u32 s7, s7, 655360
    v_mul_u32_u24 v18, 1280, v37
    v_add_u32 v18, s7, v18
    s_mul_i32 s7, s68, 81920
    s_add_u32 s7, s7, 45312
    v_mov_b32 v38, s7
    v_cmp_eq_u32 vcc, s68, v37
    s_nop 1
    v_cndmask_b32 v18, v18, v38, vcc
    v_add_u32 v38, 2560, v38
    v_cmp_le_u32 vcc, 8, v37
    s_nop 1
    v_cndmask_b32 v18, v18, v38, vcc
    v_add_u32 v18, v18, v27
    v_add_u32 v37, 3, v37
    s_mul_i32 s7, s68, 10240
    s_cmp_eq_u32 s74, 0
    s_cselect_b32 s7, 0, s7
    s_add_u32 s7, s7, 655360
    v_mul_u32_u24 v20, 1280, v37
    v_add_u32 v20, s7, v20
    s_mul_i32 s7, s68, 81920
    s_add_u32 s7, s7, 45312
    v_mov_b32 v38, s7
    v_cmp_eq_u32 vcc, s68, v37
    s_nop 1
    v_cndmask_b32 v20, v20, v38, vcc
    v_add_u32 v38, 2560, v38
    v_cmp_le_u32 vcc, 8, v37
    s_nop 1
    v_cndmask_b32 v20, v20, v38, vcc
    v_add_u32 v20, v20, v27
    s_mul_i32 s77, s72, 320
    s_add_u32 s77, s77, s74
    s_sub_u32 s78, s69, 20
    s_mul_i32 s78, s78, 2560
    s_mul_i32 s7, s72, 640
    s_add_u32 s78, s78, s7
    s_add_u32 s78, s78, s3
    s_add_u32 s78, s78, 51200
    s_waitcnt lgkmcnt(0)
    s_cmp_eq_u32 s4, 0
    s_cbranch_scc1 FW2
FPOLL:
    ds_read_b64_tr_b16 a[240:241], v80 offset:0
    ds_read_b64_tr_b16 a[242:243], v80 offset:32
    ds_read_b64_tr_b16 a[244:245], v80 offset:64
    ds_read_b64_tr_b16 a[246:247], v80 offset:96
    ds_read_b64_tr_b16 a[248:249], v80 offset:128
    ds_read_b64_tr_b16 a[250:251], v80 offset:160
    ds_read_b64_tr_b16 v[108:109], v80 offset:192
    ds_read_b64_tr_b16 v[110:111], v80 offset:224
    ds_read_b64_tr_b16 v[2:3], v80 offset:256
    ds_read_b64_tr_b16 v[4:5], v80 offset:288
    s_waitcnt lgkmcnt(0)
    s_mul_i32 s79, s72, 320
    s_add_u32 s79, s79, s3
    s_add_u32 s79, s79, 45312
    s_mov_b32 exec_lo, 0xfffff
    s_mov_b32 exec_hi, 0x0
    s_mov_b32 s76, 1
POLL24:
    buffer_load_dword v36, v1, s[16:19], s79 offen sc1
POLLW24:
    s_waitcnt vmcnt(0)
    v_cmp_eq_u32 vcc, -1, v36
    s_cbranch_vccnz AGAIN24
POLLX24:
    s_mov_b64 exec, s[86:87]
    buffer_load_dwordx4 v[24:27], v86, s[16:19], s77 offen sc1
    buffer_load_dwordx4 v[28:31], v18, s[16:19], s77 offen sc1
    buffer_load_dwordx4 v[32:35], v20, s[16:19], s77 offen sc1
    s_waitcnt vmcnt(0)
BW25:
    ds_write_b128 v87, v[24:27] offset:0
    ds_write_b128 v87, v[28:31] offset:1008
    ds_write_b128 v87, v[32:35] offset:2016
    v_max3_u32 v36, v24, v28, v32
    v_cmp_eq_u32 vcc, -1, v36
    s_mov_b64 exec, s[84:85]
    ds_read_b128 v[88:91], v6 offset:0
    ds_read_b128 v[92:95], v6 offset:64
    ds_read_b128 v[96:99], v6 offset:128
    ds_read_b128 v[100:103], v6 offset:192
    ds_read_b128 v[104:107], v6 offset:256
    s_mov_b64 exec, -1
    s_cbranch_vccnz BR25
BX25:
FMM:
    s_waitcnt lgkmcnt(4)
    v_mfma_f32_16x16x32_bf16 v[32:35], v[88:91], v[88:91], 0
    s_waitcnt lgkmcnt(3)
    v_mfma_f32_16x16x32_bf16 v[32:35], v[92:95], v[92:95], v[32:35]
    s_waitcnt lgkmcnt(2)
    v_mfma_f32_16x16x32_bf16 v[32:35], v[96:99], v[96:99], v[32:35]
    s_waitcnt lgkmcnt(1)
    v_mfma_f32_16x16x32_bf16 v[32:35], v[100:103], v[100:103], v[32:35]
    s_waitcnt lgkmcnt(0)
    v_mfma_f32_16x16x32_bf16 v[32:35], v[104:107], v[104:107], v[32:35]
    v_mfma_f32_16x16x32_bf16 v[24:27], v[88:91], v[40:43], 0
    v_mov_b32 v36, 0
    v_mov_b32 v37, 0
    v_mfma_f32_16x16x32_bf16 v[24:27], v[92:95], v[44:47], v[24:27]
    v_mov_b32 v38, 0
    s_cmp_eq_u32 s4, 0
    v_mfma_f32_16x16x32_bf16 v[24:27], v[96:99], v[48:51], v[24:27]
    v_mfma_f32_16x16x32_bf16 v[24:27], v[100:103], v[52:55], v[24:27]
    v_add_f32 v32, v32, v33
    v_add_f32 v34, v34, v35
    v_mfma_f32_16x16x32_bf16 v[24:27], v[104:107], v[56:59], v[24:27]
    v_mfma_f32_16x16x32_bf16 v[28:31], v[88:91], v[60:63], 0
    v_add_f32_dpp v36, v32, v34 quad_perm:[0,1,2,3] row_mask:0xf bank_mask:0x7
    v_mfma_f32_16x16x32_bf16 v[28:31], v[92:95], v[64:67], v[28:31]
    s_nop 0
    v_add_f32_dpp v36, v36, v36 row_ror:8 row_mask:0xf bank_mask:0xf
    v_mfma_f32_16x16x32_bf16 v[28:31], v[96:99], v[68:71], v[28:31]
    s_nop 0
    v_add_f32_dpp v36, v36, v36 row_ror:4 row_mask:0xf bank_mask:0xf
    v_mfma_f32_16x16x32_bf16 v[28:31], v[100:103], v[72:75], v[28:31]
    s_nop 0
    v_add_f32_dpp v36, v36, v36 row_ror:2 row_mask:0xf bank_mask:0xf
    v_mfma_f32_16x16x32_bf16 v[28:31], v[104:107], v[76:79], v[28:31]
    v_add_f32 v24, v24, v25
    v_add_f32_dpp v37, v36, v36 row_ror:1 row_mask:0x7 bank_mask:0xf
    v_add_f32_dpp v38, v36, v36 row_ror:1 row_mask:0x8 bank_mask:0xf
    v_add_f32 v26, v26, v27
    v_add_f32 v24, v24, v26
    s_nop 1
    v_permlane32_swap_b32 v24, v37
    v_add_f32 v28, v28, v29
    v_add_f32 v30, v30, v31
    v_add_f32 v28, v28, v30
    v_add_f32 v24, v24, v37
    s_nop 0
    v_permlane32_swap_b32 v28, v38
    v_add_f32 v28, v28, v38
    s_nop 1
    v_permlane16_swap_b32 v24, v28
    v_add_f32 v24, v24, v28
    ds_write_b32 v81, v24
    s_waitcnt lgkmcnt(0)
    s_barrier
    ds_read_b128 v[28:31], v83 offset:256
    ds_read_b128 v[24:27], v83
    ds_read_b128 v[32:35], v82
    ds_read_b128 v[36:39], v82 offset:256
    s_cbranch_scc1 FCS
    s_waitcnt lgkmcnt(3)
    v_add_f32 v28, v28, v29
    v_add_f32 v30, v30, v31
    v_add_f32 v28, v28, v30
    v_mul_f32 v28, s66, v28
    s_waitcnt lgkmcnt(2)
    v_add_f32 v24, v24, v25
    v_add_f32 v26, v26, v27
    v_add_f32 v24, v24, v26
    v_fma_f32 v24, v24, s66, v85
    v_fma_f32 v24, -v28, v28, v24
    v_add_f32 v28, 1.0, v28
    v_max_f32 v24, v24, v85
    s_waitcnt lgkmcnt(1)
    v_rsq_f32 v25, v24
    v_add_f32 v32, v32, v33
    v_add_f32 v34, v34, v35
    v_add_f32 v32, v32, v34
    v_mul_f32 v25, 0xbfb8aa3b, v25
    v_fma_f32 v32, -v28, v22, v32
    v_mul_f32 v33, v32, v25
    v_exp_f32 v33, v33
    s_waitcnt lgkmcnt(0)
    v_add_f32 v36, v36, v37
    v_fma_f32 v33, v33, v24, v24
    v_rcp_f32 v33, v33
    v_add_f32 v38, v38, v39
    v_add_f32 v36, v36, v38
    v_mul_f32 v33, v33, v32
    v_fma_f32 v36, -v28, v23, v36
    v_mul_f32 v36, v36, v33
    s_nop 1
    v_mov_b32_dpp v28, v36 quad_perm:[0,0,0,0] row_mask:0xf bank_mask:0xf
    v_mov_b32_dpp v29, v36 quad_perm:[1,1,1,1] row_mask:0xf bank_mask:0xf
    v_mov_b32_dpp v30, v36 quad_perm:[2,2,2,2] row_mask:0xf bank_mask:0xf
    v_mov_b32_dpp v31, v36 quad_perm:[3,3,3,3] row_mask:0xf bank_mask:0xf
    v_cvt_pk_bf16_f32 v28, v28, v29
    v_cvt_pk_bf16_f32 v29, v30, v31
    v_cndmask_b32 v60, 0, v28, s[44:45]
    v_cndmask_b32 v61, 0, v29, s[44:45]
    v_cndmask_b32 v62, 0, v28, s[46:47]
    v_cndmask_b32 v63, 0, v29, s[46:47]
    v_cndmask_b32 v64, 0, v28, s[48:49]
    v_cndmask_b32 v65, 0, v29, s[48:49]
    v_mfma_f32_16x16x32_bf16 v[24:27], a[240:243], v[60:63], 0
    v_cndmask_b32 v66, 0, v28, s[50:51]
    v_cndmask_b32 v67, 0, v29, s[50:51]
    v_cndmask_b32 v68, 0, v28, s[52:53]
    v_cndmask_b32 v69, 0, v29, s[52:53]
    v_mfma_f32_16x16x32_bf16 v[24:27], a[244:247], v[64:67], v[24:27]
    v_cndmask_b32 v70, 0, v28, s[54:55]
    v_cndmask_b32 v71, 0, v29, s[54:55]
    v_cndmask_b32 v72, 0, v28, s[56:57]
    v_cndmask_b32 v73, 0, v29, s[56:57]
    v_mfma_f32_16x16x32_bf16 v[24:27], a[248:251], v[68:71], v[24:27]
    v_cndmask_b32 v74, 0, v28, s[58:59]
    v_cndmask_b32 v75, 0, v29, s[58:59]
    v_cndmask_b32 v76, 0, v28, s[60:61]
    v_cndmask_b32 v77, 0, v29, s[60:61]
    v_mfma_f32_16x16x32_bf16 v[24:27], v[108:111], v[72:75], v[24:27]
    v_cndmask_b32 v78, 0, v28, s[62:63]
    v_cndmask_b32 v79, 0, v29, s[62:63]
    s_nop 1
    v_mfma_f32_16x16x32_bf16 v[24:27], v[2:5], v[76:79], v[24:27]
    s_mov_b64 exec, s[64:65]
    s_nop 6
    buffer_store_dwordx4 v[24:27], v84, s[8:11], s78 offen
    s_cmp_eq_u32 s10, 0
    s_cbranch_scc1 SLOW26
BACK26:
    s_mov_b64 exec, -1
NEXT:
    s_cmp_lg_u32 s74, 0
    s_cbranch_scc1 DONE
    s_mov_b32 s74, 819200
    s_add_u32 s3, s3, 819200
    s_add_u32 s80, s80, 819200
    s_add_u32 s81, s81, 819200
    s_mov_b64 s[46:47], s[44:45]
    s_mov_b64 s[48:49], s[92:93]
    s_branch LOOP
AGAIN24:
    s_add_u32 s76, s76, 1
    s_cmp_lt_u32 s76, 32768
    s_cbranch_scc1 POLL24
    s_branch POLLX24
BR25:
    s_cmp_ge_u32 s76, 32768
    s_cbranch_scc1 BX25
BL25:
    s_mov_b64 exec, s[86:87]
    v_cmp_eq_u32 vcc, -1, v24
    s_nop 0
    s_mov_b64 exec, vcc
    s_cbranch_execz BS25_0
    buffer_load_dwordx4 v[24:27], v86, s[16:19], s77 offen sc1
BS25_0:
    s_mov_b64 exec, s[86:87]
    v_cmp_eq_u32 vcc, -1, v28
    s_nop 0
    s_mov_b64 exec, vcc
    s_cbranch_execz BS25_1
    buffer_load_dwordx4 v[28:31], v18, s[16:19], s77 offen sc1
BS25_1:
    s_mov_b64 exec, s[86:87]
    v_cmp_eq_u32 vcc, -1, v32
    s_nop 0
    s_mov_b64 exec, vcc
    s_cbranch_execz BS25_2
    buffer_load_dwordx4 v[32:35], v20, s[16:19], s77 offen sc1
BS25_2:
    s_mov_b64 exec, s[86:87]
    s_add_u32 s76, s76, 1
    s_cmp_ge_u32 s76, 32768
    s_waitcnt vmcnt(0)
    v_max3_u32 v36, v24, v28, v32
    v_cmp_eq_u32 vcc, -1, v36
    s_cbranch_vccz BW25
    s_cbranch_scc0 BL25
    s_branch BW25
DONE:
    s_endpgm
TAGLOOP:
    s_mov_b32 s76, 0
TAGL2:
    s_sleep 8
    global_load_dword v98, v100, s[64:65] sc1
    s_waitcnt vmcnt(0)
    v_readfirstlane_b32 s96, v98
    s_nop 0
    s_cmp_lg_u32 s96, 0
    s_cbranch_scc1 TAGOK
    s_add_u32 s76, s76, 1
    s_cmp_lt_u32 s76, 32768
    s_cbranch_scc1 TAGL2
    s_branch TAGOK
DMAF:
    v_lshrrev_b32 v38, 1, v0
    v_mul_u32_u24 v38, 3072, v38
    v_and_b32 v39, 1, v0
    v_lshl_add_u32 v38, v39, 4, v38
    s_mul_i32 s79, s68, 12
    s_add_u32 s79, s79, s69
    s_sub_u32 s79, s79, 20
    s_mul_i32 s77, s72, 491520
    s_lshl_b32 s78, s79, 5
    s_add_u32 s77, s77, s78
    s_mul_i32 s78, s72, 5120
    s_add_u32 m0, s78, 57344
    s_nop 0
    buffer_load_dwordx4 v38, s[24:27], s77 offen  lds
    s_add_u32 m0, s78, 77824
    s_nop 0
    buffer_load_dwordx4 v38, s[28:31], s77 offen  lds
    s_add_u32 s77, s77, 98304
    s_add_u32 m0, s78, 58368
    s_nop 0
    buffer_load_dwordx4 v38, s[24:27], s77 offen  lds
    s_add_u32 m0, s78, 78848
    s_nop 0
    buffer_load_dwordx4 v38, s[28:31], s77 offen  lds
    s_add_u32 s77, s77, 98304
    s_add_u32 m0, s78, 59392
    s_nop 0
    buffer_load_dwordx4 v38, s[24:27], s77 offen  lds
    s_add_u32 m0, s78, 79872
    s_nop 0
    buffer_load_dwordx4 v38, s[28:31], s77 offen  lds
    s_add_u32 s77, s77, 98304
    s_add_u32 m0, s78, 60416
    s_nop 0
    buffer_load_dwordx4 v38, s[24:27], s77 offen  lds
    s_add_u32 m0, s78, 80896
    s_nop 0
    buffer_load_dwordx4 v38, s[28:31], s77 offen  lds
    s_add_u32 s77, s77, 98304
    s_add_u32 m0, s78, 61440
    s_nop 0
    buffer_load_dwordx4 v38, s[24:27], s77 offen  lds
    s_add_u32 m0, s78, 81920
    s_nop 0
    buffer_load_dwordx4 v38, s[28:31], s77 offen  lds
    s_branch DMAX
RDYLOOP:
    s_mov_b32 s76, 0
RDYL2:
    s_sleep 8
    buffer_load_dwordx2 v[98:99], v100, s[16:19], 0 offen offset:384 sc1
    s_waitcnt vmcnt(0)
    v_cmp_ne_u32 vcc, s96, v98
    s_cbranch_vccz RDYOK
    s_add_u32 s76, s76, 1
    s_cmp_lt_u32 s76, 32768
    s_cbranch_scc1 RDYL2
    s_branch RDYOK
SLOW1:
    buffer_store_dwordx4 v[28:31], v27, s[16:19], s77 offen sc1
    s_branch BACK1
SLOW4:
    buffer_store_dword v24, v10, s[16:19], s3 offen sc1
    s_branch BACK4
SLOW6:
    buffer_store_dwordx4 v[28:31], v1, s[16:19], s77 offen sc1
    s_branch BACK6
RETRY7:
    s_mov_b32 s76, 1
POLL27:
    buffer_load_dword v28, v20, s[16:19], 0 offen sc1
    buffer_load_dword v29, v21, s[16:19], 0 offen sc1
POLLW27:
    s_waitcnt vmcnt(0)
    v_max_u32 v30, v28, v29
    v_cmp_eq_u32 vcc, -1, v30
    s_cbranch_vccnz AGAIN27
POLLX27:
    s_branch OK7
AGAIN27:
    s_add_u32 s76, s76, 1
    s_cmp_lt_u32 s76, 32768
    s_cbranch_scc1 POLL27
    s_branch POLLX27
SLOW8:
    buffer_store_dwordx4 v[28:31], v32, s[16:19], s77 offen sc1
    s_branch BACK8
SLOW10:
    buffer_store_dwordx4 v[28:31], v18, s[16:19], s81 offen sc1
    s_branch BACK10
SLOW11:
    buffer_store_dwordx4 v[52:55], v48, s[16:19], s78 offen sc1
    s_branch BACK11
SLOW12:
    buffer_store_dwordx4 v[52:55], v49, s[16:19], s78 offen sc1
    s_branch BACK12
SLOW13:
    buffer_store_dwordx4 v[52:55], v50, s[16:19], s78 offen sc1
    s_branch BACK13
SLOW15:
    buffer_store_dwordx4 v[28:31], v18, s[16:19], s97 offen sc1
    s_branch BACK15
SLOW16:
    buffer_store_dwordx2 v[34:35], v1, s[16:19], s78 offen sc1
    s_branch BACK16
SLOW17:
    buffer_store_dword v7, v10, s[16:19], s77 offen sc1
    s_branch BACK17
SLOW18:
    buffer_store_dwordx4 v[24:27], v28, s[16:19], 0 offen sc1
    s_branch BACK18
SLOW19:
    buffer_store_dwordx4 v[24:27], v29, s[16:19], 0 offen sc1
    s_branch BACK19
SLOW21:
    buffer_store_dwordx4 v[28:31], v32, s[16:19], s77 offen sc1
    s_branch BACK21
FW2:
    s_add_u32 s96, s3, 1638400
    buffer_store_dword v7, v10, s[8:11], s96 offen
    s_cmp_eq_u32 s10, 0
    s_cbranch_scc1 SLOW28
BACK28:
    s_branch FMM
SLOW26:
    buffer_store_dwordx4 v[24:27], v84, s[16:19], s78 offen sc1
    s_branch BACK26
FCS:
    s_waitcnt lgkmcnt(0)
    v_add_f32 v32, v32, v33
    v_add_f32 v34, v34, v35
    v_add_f32 v32, v32, v34
    v_add_f32 v36, v36, v37
    v_add_f32 v38, v38, v39
    v_add_f32 v36, v36, v38
    v_mov_b32 v22, v32
    v_mov_b32 v23, v36
    s_mov_b32 s4, 1
    s_waitcnt vmcnt(0)
    v_mov_b32 v24, -1
    v_mov_b32 v25, -1
    v_mov_b32 v26, -1
    v_mov_b32 v27, -1
    buffer_store_dwordx4 v[24:27], v21, s[8:11], s97 offen
    s_cmp_eq_u32 s10, 0
    s_cbranch_scc1 SLOW29
BACK29:
    s_barrier
    s_branch FPOLL
SLOW28:
    buffer_store_dword v7, v10, s[16:19], s96 offen sc1
    s_branch BACK28
SLOW29:
    buffer_store_dwordx4 v[24:27], v21, s[16:19], s97 offen sc1
    s_branch BACK29
CODE_END:
    s_endpgm
.section .rodata,"a"
.p2align 6
.amdhsa_kernel interleave_layers__sliding_block_cached__glu_gated_swiglu__decode_kernel
  .amdhsa_next_free_vgpr 512
  .amdhsa_next_free_sgpr 102
  .amdhsa_accum_offset 256
  .amdhsa_group_segment_fixed_size 0
  .amdhsa_kernarg_size 96
  .amdhsa_user_sgpr_count 2
  .amdhsa_user_sgpr_kernarg_segment_ptr 1
  .amdhsa_system_sgpr_workgroup_id_x 1
.end_amdhsa_kernel
```

```asm
; @launch grid=(256,1,1) block=(256,1,1) lds=125568
.amdgcn_target "amdgcn-amd-amdhsa--gfx950"
.text
.globl interleave_layers__sliding_block_cached__glu_gated_swiglu__decode_kernel
.p2align 8
.type interleave_layers__sliding_block_cached__glu_gated_swiglu__decode_kernel,@function
interleave_layers__sliding_block_cached__glu_gated_swiglu__decode_kernel:
    s_load_dwordx16 s[44:59], s[0:1], 0
    s_load_dwordx8 s[60:67], s[0:1], 64
    s_cmp_ge_u32 s2, 256
    s_cbranch_scc1 CODE_END
    s_memrealtime s[96:97]
    v_lshrrev_b32 v2, 6, v0
    v_and_b32 v24, 63, v0
    v_readfirstlane_b32 s72, v2
    s_and_b32 s68, s2, 7
    s_lshr_b32 s69, s2, 3
    s_lshr_b32 s70, s69, 3
    s_and_b32 s71, s69, 7
    v_lshlrev_b32 v1, 4, v24
    s_lshl_b32 s77, s70, 3
    s_add_u32 s77, s77, s68
    s_mul_i32 s73, s77, 12582912
    s_lshl_b32 s78, s71, 2
    s_add_u32 s78, s78, s72
    s_mul_i32 s78, s78, 6144
    s_add_u32 s73, s73, s78
    s_add_u32 s73, s73, 11010048
    v_add_u32 v23, 4096, v1
    s_mov_b32 s10, 402653184
    s_mov_b32 s11, 0x20000
    s_getpc_b64 s[100:101]
PCREF:
    s_sub_u32 s100, s100, PCREF-interleave_layers__sliding_block_cached__glu_gated_swiglu__decode_kernel
    s_subb_u32 s101, s101, 0
    s_lshl_b32 s78, s71, 12
    v_lshl_add_u32 v25, v0, 4, s78
    v_cmp_gt_u32 vcc, CODE_END-interleave_layers__sliding_block_cached__glu_gated_swiglu__decode_kernel-16, v25
    s_nop 0
    s_and_saveexec_b64 s[98:99], vcc
    s_cbranch_execz NOCPF
    global_load_dwordx4 a[240:243], v25, s[100:101]
NOCPF:
    s_mov_b64 exec, -1
    s_mul_i32 s79, s77, 384
    s_mov_b32 s74, 0
    s_mul_i32 s3, s68, 81920
    s_getreg_b32 s75, hwreg(HW_REG_XCC_ID, 0, 4)
    s_lshl_b32 s77, s69, 9
    s_add_u32 s77, s77, s3
    s_add_u32 s77, s77, 32768
    v_add_u32 v20, s77, v1
    s_lshl_b32 s77, s68, 2
    s_add_u32 s77, s77, s69
    s_mul_i32 s77, s77, 320
    s_add_u32 s77, s77, 654848
    v_add_u32 v25, s77, v1
    v_cmp_le_u32 vcc, 32, v0
    s_nop 1
    v_cndmask_b32 v21, v20, v25, vcc
    v_mov_b32 v25, 2147483632
    v_cndmask_b32 v20, v20, v25, vcc
    s_cmp_lt_u32 s69, 4
    s_cselect_b32 s77, 52, 32
    v_cmp_le_u32 vcc, s77, v0
    s_nop 1
    v_cndmask_b32 v21, v21, v25, vcc
    s_mov_b32 s18, 1610612736
    s_mov_b32 s19, 0x20000
    s_waitcnt lgkmcnt(0)
    s_mov_b32 s8, s46
    s_and_b32 s9, s47, 0xffff
    s_mov_b32 s16, s66
    s_and_b32 s17, s67, 0xffff
    buffer_load_dwordx4 a[0:3], v1, s[8:11], s73 offen offset:0 nt
    buffer_load_dwordx4 a[4:7], v1, s[8:11], s73 offen offset:1024 nt
    s_or_b32 s77, s2, s72
    s_cbranch_scc1 NOTAG
    s_or_b32 s77, s96, 1
    v_mov_b32 v26, s77
    s_mov_b64 exec, 1
    global_store_dword v1, v26, s[64:65] sc1
    s_mov_b64 exec, -1
NOTAG:
    s_add_u32 s83, s73, 196608
    s_mov_b32 s12, s48
    s_and_b32 s13, s49, 0xffff
    s_mov_b32 s14, 402653184
    s_mov_b32 s15, 0x20000
    s_mov_b32 s20, s50
    s_and_b32 s21, s51, 0xffff
    s_mov_b32 s22, 7864320
    s_mov_b32 s23, 0x20000
    s_mov_b32 s36, s44
    s_and_b32 s37, s45, 0xffff
    s_mov_b32 s38, 1280
    s_mov_b32 s39, 0x20000
    s_mov_b32 s40, s62
    s_and_b32 s41, s63, 0xffff
    s_mov_b32 s42, 1280
    s_mov_b32 s43, 0x20000
    s_mov_b32 s28, s58
    s_and_b32 s29, s59, 0xffff
    s_mov_b32 s30, 1966080
    s_mov_b32 s31, 0x20000
    s_mov_b32 s32, s60
    s_and_b32 s33, s61, 0xffff
    s_mov_b32 s34, 1966080
    s_mov_b32 s35, 0x20000
    s_cmp_lt_u32 s69, 20
    s_cselect_b32 s24, s52, s56
    s_cselect_b32 s25, s53, s57
    s_cselect_b32 s26, s22, s30
    s_and_b32 s25, s25, 0xffff
    s_mov_b32 s27, 0x20000
    s_add_u32 s84, s83, 196608
    s_add_u32 s85, s84, 196608
    s_add_u32 s86, s85, 196608
    s_add_u32 s87, s86, 196608
    s_add_u32 s88, s87, 196608
    s_add_u32 s89, s88, 196608
    v_mov_b32 v0, v24
    s_mul_i32 s77, s72, 6656
    v_add_u32 v25, 0, v0
    v_mul_u32_u24 v26, 171, v25
    v_lshrrev_b32 v26, 12, v26
    v_mul_u32_u24 v27, 24, v26
    v_sub_u32 v27, v25, v27
    v_lshlrev_b32 v27, 4, v27
    v_mul_u32_u24 v25, 416, v26
    v_add3_u32 v2, v25, v27, s77
    v_mul_u32_u24 v25, 12288, v26
    v_add_u32 v40, v25, v27
    v_add_u32 v25, 64, v0
    v_mul_u32_u24 v26, 171, v25
    v_lshrrev_b32 v26, 12, v26
    v_mul_u32_u24 v27, 24, v26
    v_sub_u32 v27, v25, v27
    v_lshlrev_b32 v27, 4, v27
    v_mul_u32_u24 v25, 416, v26
    v_add3_u32 v3, v25, v27, s77
    v_mul_u32_u24 v25, 12288, v26
    v_add_u32 v41, v25, v27
    v_add_u32 v25, 128, v0
    v_mul_u32_u24 v26, 171, v25
    v_lshrrev_b32 v26, 12, v26
    v_mul_u32_u24 v27, 24, v26
    v_sub_u32 v27, v25, v27
    v_lshlrev_b32 v27, 4, v27
    v_mul_u32_u24 v25, 416, v26
    v_add3_u32 v4, v25, v27, s77
    v_mul_u32_u24 v25, 12288, v26
    v_add_u32 v42, v25, v27
    v_and_b32 v25, 15, v0
    v_lshrrev_b32 v26, 4, v0
    v_bfe_u32 v27, v0, 2, 2
    v_and_b32 v28, 3, v0
    s_mul_i32 s78, s71, 160
    v_lshlrev_b32 v36, 4, v26
    v_lshlrev_b32 v37, 3, v26
    v_lshlrev_b32 v39, 2, v0
    buffer_load_dwordx4 v[70:73], v36, s[36:39], s78 offen
    buffer_load_dwordx4 v[74:77], v36, s[36:39], s78 offen offset:64
    buffer_load_dwordx2 v[78:79], v37, s[36:39], s78 offen offset:128
    buffer_load_dwordx4 v[80:83], v1, s[36:39], 0 offen
    buffer_load_dword v84, v39, s[36:39], 0 offen offset:1024
    s_lshl_b32 s7, s69, 6
    v_lshlrev_b32 v38, 2, v25
    buffer_load_dword v22, v38, s[36:39], s7 offen
    s_mul_i32 s78, s71, 983040
    s_add_u32 s79, s79, s78
    s_mul_i32 s78, s72, 98304
    s_add_u32 s79, s79, s78
    s_mul_i32 s78, s72, 3072
    s_add_u32 s78, s78, 26624
    s_add_u32 m0, s78, 0
    s_nop 0
    buffer_load_dwordx4 v40, s[20:23], s79 offen nt lds
    s_add_u32 m0, s78, 1024
    s_nop 0
    buffer_load_dwordx4 v41, s[20:23], s79 offen nt lds
    s_add_u32 m0, s78, 2048
    s_nop 0
    buffer_load_dwordx4 v42, s[20:23], s79 offen nt lds
    s_add_u32 s79, s79, 393216
    s_add_u32 m0, s78, 12288
    s_nop 0
    buffer_load_dwordx4 v40, s[20:23], s79 offen nt lds
    s_add_u32 m0, s78, 13312
    s_nop 0
    buffer_load_dwordx4 v41, s[20:23], s79 offen nt lds
    s_add_u32 m0, s78, 14336
    s_nop 0
    buffer_load_dwordx4 v42, s[20:23], s79 offen nt lds
    s_add_u32 s79, s79, 393216
    s_cmp_ge_u32 s72, 2
    s_cbranch_scc1 NOWQ3
    s_add_u32 m0, s78, 24576
    s_nop 0
    buffer_load_dwordx4 v40, s[20:23], s79 offen nt lds
    s_add_u32 m0, s78, 25600
    s_nop 0
    buffer_load_dwordx4 v41, s[20:23], s79 offen nt lds
    s_add_u32 m0, s78, 26624
    s_nop 0
    buffer_load_dwordx4 v42, s[20:23], s79 offen nt lds
NOWQ3:
    s_mul_i32 s78, s71, 160
    s_mov_b32 s20, s52
    s_and_b32 s21, s53, 0xffff
    s_mov_b32 s22, 7864320
    s_mov_b32 s23, 0x20000
    s_cmp_lt_u32 s72, 2
    s_cselect_b32 s36, s56, s58
    s_cselect_b32 s37, s57, s59
    s_and_b32 s37, s37, 0xffff
    s_mov_b32 s38, 1966080
    buffer_load_dwordx4 a[8:11], v1, s[8:11], s73 offen offset:2048 nt
    buffer_load_dwordx4 a[12:15], v1, s[8:11], s73 offen offset:3072 nt
    buffer_load_dwordx4 a[16:19], v23, s[8:11], s73 offen offset:0 nt
    v_mul_u32_u24 v29, 416, v25
    v_lshl_add_u32 v29, v26, 4, v29
    v_add_u32 v5, s77, v29
    v_lshrrev_b32 v29, 2, v0
    v_mul_u32_u24 v29, 416, v29
    v_lshl_add_u32 v29, v28, 3, v29
    v_add_u32 v6, s77, v29
    s_mul_i32 s79, s72, 96
    s_add_u32 s79, s79, 26624
    v_lshl_add_u32 v29, v26, 3, v27
    v_mul_u32_u24 v29, 384, v29
    v_lshl_add_u32 v29, v28, 3, v29
    v_add_u32 v16, s79, v29
    v_lshl_add_u32 v29, v26, 2, v27
    v_mul_u32_u24 v29, 384, v29
    v_lshl_add_u32 v29, v28, 3, v29
    v_add_u32 v17, s79, v29
    buffer_load_dwordx4 a[20:23], v23, s[8:11], s73 offen offset:1024 nt
    v_mul_u32_u24 v31, 103, v0
    v_lshrrev_b32 v31, 10, v31
    v_mul_u32_u24 v30, 10, v31
    v_sub_u32 v30, v0, v30
    v_lshl_add_u32 v29, v30, 4, s78
    s_mul_i32 s7, s68, 10240
    s_add_u32 s7, s7, 737280
    v_mul_u32_u24 v8, 1280, v31
    v_add_u32 v8, s7, v8
    s_mul_i32 s7, s68, 81920
    s_add_u32 s7, s7, 46592
    v_mov_b32 v30, s7
    v_cmp_eq_u32 vcc, s68, v31
    s_nop 1
    v_cndmask_b32 v8, v8, v30, vcc
    v_add_u32 v30, 2560, v30
    v_cmp_le_u32 vcc, 8, v31
    s_nop 1
    v_cndmask_b32 v8, v8, v30, vcc
    v_add_u32 v8, v8, v29
    v_add_u32 v31, 6, v31
    s_mul_i32 s7, s68, 10240
    s_add_u32 s7, s7, 737280
    v_mul_u32_u24 v9, 1280, v31
    v_add_u32 v9, s7, v9
    s_mul_i32 s7, s68, 81920
    s_add_u32 s7, s7, 46592
    v_mov_b32 v30, s7
    v_cmp_eq_u32 vcc, s68, v31
    s_nop 1
    v_cndmask_b32 v9, v9, v30, vcc
    v_add_u32 v30, 2560, v30
    v_cmp_le_u32 vcc, 8, v31
    s_nop 1
    v_cndmask_b32 v9, v9, v30, vcc
    v_add_u32 v9, v9, v29
    v_mov_b32 v30, 2147483632
    v_cmp_le_u32 vcc, 30, v0
    s_nop 1
    v_cndmask_b32 v9, v9, v30, vcc
    s_lshl_b32 s78, s69, 10
    s_lshl_b32 s79, s72, 8
    s_add_u32 s78, s78, s79
    v_lshl_add_u32 v10, v0, 2, s78
    s_lshl_b32 s78, s70, 13
    s_add_u32 s78, s78, s79
    v_lshlrev_b32 v29, 10, v26
    v_lshl_add_u32 v29, v25, 4, v29
    v_add_u32 v11, s78, v29
    buffer_load_dwordx4 a[24:27], v1, s[8:11], s83 offen offset:0 nt
    s_mul_i32 s78, s72, 96
    s_add_u32 s78, s78, 118784
    v_lshl_add_u32 v29, v27, 5, s78
    v_lshl_add_u32 v29, v28, 2, v29
    v_lshrrev_b32 v30, 1, v26
    v_lshl_add_u32 v29, v30, 4, v29
    v_and_b32 v30, 1, v26
    v_lshl_add_u32 v29, v30, 1, v29
    v_mov_b32 v30, 119168
    v_cmp_le_u32 vcc, 12, v25
    s_nop 1
    v_cndmask_b32 v12, v29, v30, vcc
    v_and_b32 v30, 1, v0
    v_lshlrev_b32 v29, 5, v26
    v_lshl_add_u32 v29, v30, 4, v29
    v_add_u32 v13, 118784, v29
    v_mul_u32_u24 v30, 0xaaaa, v30
    v_and_b32 v29, 1, v27
    v_mul_u32_u24 v29, 0xaaaa, v29
    v_lshl_or_b32 v29, v29, 16, v30
    v_add_u32 v14, 0x44444444, v29
    buffer_load_dwordx4 a[28:31], v1, s[8:11], s83 offen offset:1024 nt
    s_lshl_b32 s78, s72, 8
    s_add_u32 s78, s78, 124416
    v_lshrrev_b32 v29, 5, v0
    v_lshl_add_u32 v29, v29, 6, s78
    v_bfe_u32 v30, v0, 3, 1
    v_lshl_add_u32 v29, v30, 5, v29
    v_bfe_u32 v30, v0, 1, 1
    v_lshl_add_u32 v29, v30, 4, v29
    v_bfe_u32 v30, v0, 2, 1
    v_lshl_add_u32 v29, v30, 3, v29
    v_bfe_u32 v30, v0, 4, 1
    v_lshl_add_u32 v29, v30, 2, v29
    v_bfe_u32 v30, v0, 0, 1
    v_lshl_add_u32 v29, v30, 1, v29
    v_mov_b32 v19, v29
    v_bfe_u32 v29, v0, 4, 1
    v_bfe_u32 v30, v0, 2, 1
    v_lshl_add_u32 v29, v29, 5, s78
    v_lshl_add_u32 v29, v30, 4, v29
    v_accvgpr_write_b32 a252, v29
    s_mul_i32 s78, s72, 768
    s_add_u32 s78, s78, 119296
    v_lshl_add_u32 v29, v25, 2, s78
    v_bfe_u32 v30, v0, 4, 1
    v_lshl_add_u32 v29, v30, 7, v29
    v_lshrrev_b32 v30, 5, v0
    v_lshl_add_u32 v15, v30, 6, v29
    s_waitcnt vmcnt(12)
    v_lshlrev_b32 v88, 16, v80
    v_and_b32 v89, 0xffff0000, v80
    v_lshlrev_b32 v90, 16, v81
    v_and_b32 v91, 0xffff0000, v81
    v_lshlrev_b32 v92, 16, v82
    v_and_b32 v93, 0xffff0000, v82
    v_lshlrev_b32 v94, 16, v83
    v_and_b32 v95, 0xffff0000, v83
    v_lshlrev_b32 v96, 16, v84
    v_and_b32 v97, 0xffff0000, v84
    v_add_f32 v80, v88, v89
    v_add_f32 v80, v80, v90
    v_add_f32 v80, v80, v91
    v_add_f32 v80, v80, v92
    v_add_f32 v80, v80, v93
    v_add_f32 v80, v80, v94
    v_add_f32 v80, v80, v95
    v_add_f32 v80, v80, v96
    v_add_f32 v80, v80, v97
    s_nop 1
    v_add_f32_dpp v80, v80, v80 row_ror:8 row_mask:0xf bank_mask:0xf
    s_nop 1
    v_add_f32_dpp v80, v80, v80 row_ror:4 row_mask:0xf bank_mask:0xf
    s_nop 1
    v_add_f32_dpp v80, v80, v80 row_ror:2 row_mask:0xf bank_mask:0xf
    s_nop 1
    v_add_f32_dpp v80, v80, v80 row_ror:1 row_mask:0xf bank_mask:0xf
    v_mov_b32 v81, v80
    s_nop 1
    v_permlane32_swap_b32 v80, v81
    v_add_f32 v80, v80, v81
    v_mov_b32 v81, v80
    s_nop 1
    v_permlane16_swap_b32 v80, v81
    v_add_f32 v80, v80, v81
    v_mul_f32 v80, 0x3acccccd, v80
    v_sub_f32 v88, v88, v80
    v_sub_f32 v89, v89, v80
    v_sub_f32 v90, v90, v80
    v_sub_f32 v91, v91, v80
    v_sub_f32 v92, v92, v80
    v_sub_f32 v93, v93, v80
    v_sub_f32 v94, v94, v80
    v_sub_f32 v95, v95, v80
    v_sub_f32 v96, v96, v80
    v_sub_f32 v97, v97, v80
    v_mul_f32 v82, v88, v88
    v_fmac_f32 v82, v89, v89
    v_fmac_f32 v82, v90, v90
    v_fmac_f32 v82, v91, v91
    v_fmac_f32 v82, v92, v92
    v_fmac_f32 v82, v93, v93
    v_fmac_f32 v82, v94, v94
    v_fmac_f32 v82, v95, v95
    v_fmac_f32 v82, v96, v96
    v_fmac_f32 v82, v97, v97
    buffer_load_dwordx4 a[32:35], v1, s[8:11], s83 offen offset:2048 nt
    s_nop 0
    v_add_f32_dpp v82, v82, v82 row_ror:8 row_mask:0xf bank_mask:0xf
    s_nop 1
    v_add_f32_dpp v82, v82, v82 row_ror:4 row_mask:0xf bank_mask:0xf
    s_nop 1
    v_add_f32_dpp v82, v82, v82 row_ror:2 row_mask:0xf bank_mask:0xf
    s_nop 1
    v_add_f32_dpp v82, v82, v82 row_ror:1 row_mask:0xf bank_mask:0xf
    v_mov_b32 v81, v82
    s_nop 1
    v_permlane32_swap_b32 v82, v81
    v_add_f32 v82, v82, v81
    v_mov_b32 v81, v82
    s_nop 1
    v_permlane16_swap_b32 v82, v81
    v_add_f32 v82, v82, v81
    v_mul_f32 v82, 0x3acccccd, v82
    v_add_f32 v82, 0x3727c5ac, v82
    v_rsq_f32 v82, v82
    s_mov_b32 vcc_lo, 0xaaaaaaaa
    s_mov_b32 vcc_hi, 0xaaaaaaaa
    v_mov_b32 v85, 0x3f803f80
    v_lshlrev_b32 v83, 16, v70
    v_and_b32 v84, 0xffff0000, v70
    v_sub_f32 v83, v83, v80
    v_sub_f32 v84, v84, v80
    v_mul_f32 v83, v83, v82
    v_mul_f32 v84, v84, v82
    v_cvt_pk_bf16_f32 v83, v83, v84
    v_cndmask_b32 v70, v83, v85, vcc
    v_lshlrev_b32 v83, 16, v71
    v_and_b32 v84, 0xffff0000, v71
    v_sub_f32 v83, v83, v80
    v_sub_f32 v84, v84, v80
    v_mul_f32 v83, v83, v82
    v_mul_f32 v84, v84, v82
    v_cvt_pk_bf16_f32 v83, v83, v84
    v_cndmask_b32 v71, v83, v85, vcc
    v_lshlrev_b32 v83, 16, v72
    v_and_b32 v84, 0xffff0000, v72
    v_sub_f32 v83, v83, v80
    v_sub_f32 v84, v84, v80
    v_mul_f32 v83, v83, v82
    v_mul_f32 v84, v84, v82
    v_cvt_pk_bf16_f32 v83, v83, v84
    v_cndmask_b32 v72, v83, v85, vcc
    v_lshlrev_b32 v83, 16, v73
    v_and_b32 v84, 0xffff0000, v73
    v_sub_f32 v83, v83, v80
    v_sub_f32 v84, v84, v80
    v_mul_f32 v83, v83, v82
    v_mul_f32 v84, v84, v82
    v_cvt_pk_bf16_f32 v83, v83, v84
    v_cndmask_b32 v73, v83, v85, vcc
    v_lshlrev_b32 v83, 16, v74
    v_and_b32 v84, 0xffff0000, v74
    v_sub_f32 v83, v83, v80
    v_sub_f32 v84, v84, v80
    v_mul_f32 v83, v83, v82
    v_mul_f32 v84, v84, v82
    v_cvt_pk_bf16_f32 v83, v83, v84
    v_cndmask_b32 v74, v83, v85, vcc
    v_lshlrev_b32 v83, 16, v75
    v_and_b32 v84, 0xffff0000, v75
    v_sub_f32 v83, v83, v80
    v_sub_f32 v84, v84, v80
    v_mul_f32 v83, v83, v82
    v_mul_f32 v84, v84, v82
    v_cvt_pk_bf16_f32 v83, v83, v84
    v_cndmask_b32 v75, v83, v85, vcc
    buffer_load_dwordx4 a[36:39], v1, s[8:11], s83 offen offset:3072 nt
    v_lshlrev_b32 v83, 16, v76
    v_and_b32 v84, 0xffff0000, v76
    v_sub_f32 v83, v83, v80
    v_sub_f32 v84, v84, v80
    v_mul_f32 v83, v83, v82
    v_mul_f32 v84, v84, v82
    v_cvt_pk_bf16_f32 v83, v83, v84
    v_cndmask_b32 v76, v83, v85, vcc
    v_lshlrev_b32 v83, 16, v77
    v_and_b32 v84, 0xffff0000, v77
    v_sub_f32 v83, v83, v80
    v_sub_f32 v84, v84, v80
    v_mul_f32 v83, v83, v82
    v_mul_f32 v84, v84, v82
    v_cvt_pk_bf16_f32 v83, v83, v84
    v_cndmask_b32 v77, v83, v85, vcc
    v_lshlrev_b32 v83, 16, v78
    v_and_b32 v84, 0xffff0000, v78
    v_sub_f32 v83, v83, v80
    v_sub_f32 v84, v84, v80
    v_mul_f32 v83, v83, v82
    v_mul_f32 v84, v84, v82
    v_cvt_pk_bf16_f32 v83, v83, v84
    v_cndmask_b32 v78, v83, v85, vcc
    v_lshlrev_b32 v83, 16, v79
    v_and_b32 v84, 0xffff0000, v79
    v_sub_f32 v83, v83, v80
    v_sub_f32 v84, v84, v80
    v_mul_f32 v83, v83, v82
    v_mul_f32 v84, v84, v82
    v_cvt_pk_bf16_f32 v83, v83, v84
    v_cndmask_b32 v79, v83, v85, vcc
    s_waitcnt vmcnt(8)
    s_barrier
    ds_read_b64_tr_b16 v[40:41], v16 offset:0
    ds_read_b64_tr_b16 v[42:43], v16 offset:1536
    ds_read_b64_tr_b16 v[44:45], v16 offset:12288
    ds_read_b64_tr_b16 v[46:47], v16 offset:13824
    ds_read_b64_tr_b16 v[48:49], v17 offset:24576
    ds_read_b64_tr_b16 v[50:51], v16 offset:32
    ds_read_b64_tr_b16 v[52:53], v16 offset:1568
    ds_read_b64_tr_b16 v[54:55], v16 offset:12320
    ds_read_b64_tr_b16 v[56:57], v16 offset:13856
    ds_read_b64_tr_b16 v[58:59], v17 offset:24608
    ds_read_b64_tr_b16 v[60:61], v16 offset:64
    ds_read_b64_tr_b16 v[62:63], v16 offset:1600
    ds_read_b64_tr_b16 v[64:65], v16 offset:12352
    ds_read_b64_tr_b16 v[66:67], v16 offset:13888
    ds_read_b64_tr_b16 v[68:69], v17 offset:24640
    v_mov_b32 v100, 0
    s_cmp_lg_u32 s72, 0
    s_cbranch_scc1 NOTL
    s_mov_b64 exec, 1
    global_load_dword v98, v100, s[64:65] sc1
    s_mov_b64 exec, -1
NOTL:
    buffer_load_dwordx4 a[40:43], v23, s[8:11], s83 offen offset:0 nt
    buffer_load_dwordx4 a[44:47], v23, s[8:11], s83 offen offset:1024 nt
    s_mul_i32 s79, s72, 96
    s_add_u32 s79, s79, 119296
    v_min_u32 v36, 48, v0
    v_lshl_add_u32 v36, v36, 1, s79
    v_mov_b32 v37, 119808
    v_cmp_le_u32 vcc, 48, v0
    s_nop 1
    v_cndmask_b32 v36, v36, v37, vcc
    v_add_u32 v37, 119296, v1
    s_waitcnt lgkmcnt(0)
    v_mfma_f32_16x16x32_bf16 v[24:27], v[70:73], v[40:43], 0
    v_mfma_f32_16x16x32_bf16 v[28:31], v[70:73], v[50:53], 0
    v_mfma_f32_16x16x32_bf16 v[32:35], v[70:73], v[60:63], 0
    v_mfma_f32_16x16x32_bf16 v[24:27], v[74:77], v[44:47], v[24:27]
    v_mfma_f32_16x16x32_bf16 v[28:31], v[74:77], v[54:57], v[28:31]
    v_mfma_f32_16x16x32_bf16 v[32:35], v[74:77], v[64:67], v[32:35]
    v_mfma_f32_16x16x16_bf16 v[24:27], v[78:79], v[48:49], v[24:27]
    v_mfma_f32_16x16x16_bf16 v[28:31], v[78:79], v[58:59], v[28:31]
    v_mfma_f32_16x16x16_bf16 v[32:35], v[78:79], v[68:69], v[32:35]
    buffer_load_dwordx4 a[48:51], v1, s[8:11], s84 offen offset:0 nt
    s_nop 4
    v_mov_b32 v7, v25
    v_mov_b32_dpp v24, v28 quad_perm:[0,1,2,3] row_mask:0x2 bank_mask:0xf
    s_nop 0
    v_mov_b32_dpp v7, v29 quad_perm:[0,1,2,3] row_mask:0x2 bank_mask:0xf
    v_mov_b32_dpp v24, v32 quad_perm:[0,1,2,3] row_mask:0x4 bank_mask:0xf
    s_nop 0
    v_mov_b32_dpp v7, v33 quad_perm:[0,1,2,3] row_mask:0x4 bank_mask:0xf
    v_cvt_pk_bf16_f32 v24, v24, v24
    ds_write_b16 v36, v24
    buffer_load_dwordx4 a[52:55], v1, s[8:11], s84 offen offset:1024 nt
    buffer_load_dwordx4 a[56:59], v1, s[8:11], s84 offen offset:2048 nt
    s_waitcnt lgkmcnt(0)
    s_barrier
    ds_read_b128 v[28:31], v37
    s_lshl_b32 s79, s69, 9
    s_add_u32 s79, s79, s3
    s_cmp_eq_u32 s72, 0
    s_cselect_b32 exec_lo, 0xffffff, 1
    s_mov_b32 exec_hi, 0
    s_cselect_b32 s78, 0, 1879048176
    v_add_u32 v37, s78, v1
    s_waitcnt lgkmcnt(0)
    buffer_store_dwordx4 v[28:31], v37, s[16:19], s79 offen sc1
    s_mov_b64 exec, -1
    v_mov_b32 v32, -1
    v_mov_b32 v33, -1
    v_mov_b32 v34, -1
    v_mov_b32 v35, -1
    buffer_store_dwordx4 v[32:35], v21, s[16:19], 0 offen sc1
    buffer_load_dwordx4 a[60:63], v1, s[8:11], s84 offen offset:3072 nt
    s_waitcnt vmcnt(12)
    ds_write_b128 v2, a[0:3] offset:0
    ds_write_b128 v3, a[4:7] offset:0
    ds_write_b128 v4, a[8:11] offset:0
    ds_write_b128 v2, a[12:15] offset:3328
    ds_write_b128 v3, a[16:19] offset:3328
    ds_write_b128 v4, a[20:23] offset:3328
    ds_read_b128 a[0:3], v5 offset:0
    ds_read_b128 a[4:7], v5 offset:64
    ds_read_b128 a[8:11], v5 offset:128
    ds_read_b128 a[12:15], v5 offset:192
    ds_read_b128 a[16:19], v5 offset:256
    ds_read_b128 a[20:23], v5 offset:320
    buffer_load_dwordx4 a[64:67], v23, s[8:11], s84 offen offset:0 nt
    buffer_load_dwordx4 a[68:71], v23, s[8:11], s84 offen offset:1024 nt
    s_barrier
    buffer_load_dwordx4 a[72:75], v1, s[8:11], s85 offen offset:0 nt
    buffer_load_dwordx4 a[76:79], v1, s[8:11], s85 offen offset:1024 nt
    buffer_load_dwordx4 a[80:83], v1, s[8:11], s85 offen offset:2048 nt
    buffer_load_dwordx4 a[84:87], v1, s[8:11], s85 offen offset:3072 nt
    buffer_load_dwordx4 a[88:91], v23, s[8:11], s85 offen offset:0 nt
    buffer_load_dwordx4 a[92:95], v23, s[8:11], s85 offen offset:1024 nt
    s_barrier
    s_getreg_b32 s5, hwreg(HW_REG_XCC_ID, 0, 4)
    s_cmp_lg_u32 s72, 0
    s_cbranch_scc1 NOHDR
    s_waitcnt vmcnt(9)
    v_readfirstlane_b32 s96, v98
    s_nop 0
    s_cmp_eq_u32 s96, 0
    s_cbranch_scc1 TAGLOOP
TAGOK:
    v_mov_b32 v99, s5
    s_mov_b64 exec, 1
    buffer_store_dwordx2 v[98:99], v1, s[16:19], s79 offen offset:384 sc1
    s_mov_b64 exec, -1
NOHDR:
    s_waitcnt vmcnt(14)
    ds_write_b128 v2, a[24:27] offset:0
    ds_write_b128 v3, a[28:31] offset:0
    ds_write_b128 v4, a[32:35] offset:0
    ds_write_b128 v2, a[36:39] offset:3328
    ds_write_b128 v3, a[40:43] offset:3328
    ds_write_b128 v4, a[44:47] offset:3328
    ds_read_b128 a[24:27], v5 offset:0
    ds_read_b128 a[28:31], v5 offset:64
    ds_read_b128 a[32:35], v5 offset:128
    ds_read_b128 a[36:39], v5 offset:192
    ds_read_b128 a[40:43], v5 offset:256
    ds_read_b128 a[44:47], v5 offset:320
    buffer_load_dwordx4 a[96:99], v1, s[8:11], s86 offen offset:0 nt
    buffer_load_dwordx4 a[100:103], v1, s[8:11], s86 offen offset:1024 nt
    buffer_load_dwordx4 a[104:107], v1, s[8:11], s86 offen offset:2048 nt
    buffer_load_dwordx4 a[108:111], v1, s[8:11], s86 offen offset:3072 nt
    buffer_load_dwordx4 a[112:115], v23, s[8:11], s86 offen offset:0 nt
    buffer_load_dwordx4 a[116:119], v23, s[8:11], s86 offen offset:1024 nt
    s_barrier
    s_waitcnt vmcnt(12)
    ds_write_b128 v2, a[48:51] offset:0
    ds_write_b128 v3, a[52:55] offset:0
    ds_write_b128 v4, a[56:59] offset:0
    ds_write_b128 v2, a[60:63] offset:3328
    ds_write_b128 v3, a[64:67] offset:3328
    ds_write_b128 v4, a[68:71] offset:3328
    ds_read_b128 a[48:51], v5 offset:0
    ds_read_b128 a[52:55], v5 offset:64
    ds_read_b128 a[56:59], v5 offset:128
    ds_read_b128 a[60:63], v5 offset:192
    ds_read_b128 a[64:67], v5 offset:256
    ds_read_b128 a[68:71], v5 offset:320
    v_lshlrev_b32 v100, 9, v0
    v_add_u32 v100, s3, v100
    v_bfe_u32 v96, v0, 2, 3
    v_mul_u32_u24 v96, 81920, v96
    v_and_b32 v97, 3, v0
    v_lshl_add_u32 v96, v97, 9, v96
    v_cmp_le_u32 vcc, 32, v0
    s_nop 1
    v_cndmask_b32 v100, v100, v96, vcc
    s_cmp_eq_u32 s72, 0
    s_cselect_b32 s77, 0, 1879048176
    v_add_u32 v100, s77, v100
    buffer_load_dwordx4 a[120:123], v1, s[8:11], s87 offen offset:0 nt
    buffer_load_dwordx4 a[124:127], v1, s[8:11], s87 offen offset:1024 nt
    buffer_load_dwordx4 a[128:131], v1, s[8:11], s87 offen offset:2048 nt
    buffer_load_dwordx4 a[132:135], v1, s[8:11], s87 offen offset:3072 nt
    buffer_load_dwordx4 a[136:139], v23, s[8:11], s87 offen offset:0 nt
    buffer_load_dwordx4 a[140:143], v23, s[8:11], s87 offen offset:1024 nt
    s_barrier
    s_waitcnt vmcnt(12)
    ds_write_b128 v2, a[72:75] offset:0
    ds_write_b128 v3, a[76:79] offset:0
    ds_write_b128 v4, a[80:83] offset:0
    ds_write_b128 v2, a[84:87] offset:3328
    ds_write_b128 v3, a[88:91] offset:3328
    ds_write_b128 v4, a[92:95] offset:3328
    ds_read_b128 a[72:75], v5 offset:0
    ds_read_b128 a[76:79], v5 offset:64
    ds_read_b128 a[80:83], v5 offset:128
    ds_read_b128 a[84:87], v5 offset:192
    ds_read_b128 a[88:91], v5 offset:256
    ds_read_b128 a[92:95], v5 offset:320
    buffer_load_dwordx4 a[144:147], v1, s[8:11], s88 offen offset:0 nt
    buffer_load_dwordx4 a[148:151], v1, s[8:11], s88 offen offset:1024 nt
    buffer_load_dwordx4 a[152:155], v1, s[8:11], s88 offen offset:2048 nt
    buffer_load_dwordx4 a[156:159], v1, s[8:11], s88 offen offset:3072 nt
    buffer_load_dwordx4 a[160:163], v23, s[8:11], s88 offen offset:0 nt
    buffer_load_dwordx4 a[164:167], v23, s[8:11], s88 offen offset:1024 nt
    s_barrier
    s_waitcnt vmcnt(12)
    ds_write_b128 v2, a[96:99] offset:0
    ds_write_b128 v3, a[100:103] offset:0
    ds_write_b128 v4, a[104:107] offset:0
    ds_write_b128 v2, a[108:111] offset:3328
    ds_write_b128 v3, a[112:115] offset:3328
    ds_write_b128 v4, a[116:119] offset:3328
    ds_read_b128 a[96:99], v5 offset:0
    ds_read_b128 a[100:103], v5 offset:64
    ds_read_b128 a[104:107], v5 offset:128
    ds_read_b128 a[108:111], v5 offset:192
    ds_read_b128 a[112:115], v5 offset:256
    ds_read_b128 a[116:119], v5 offset:320
    buffer_load_dwordx4 a[168:171], v1, s[8:11], s89 offen offset:0 nt
    buffer_load_dwordx4 a[172:175], v1, s[8:11], s89 offen offset:1024 nt
    buffer_load_dwordx4 a[176:179], v1, s[8:11], s89 offen offset:2048 nt
    buffer_load_dwordx4 a[180:183], v1, s[8:11], s89 offen offset:3072 nt
    buffer_load_dwordx4 a[184:187], v23, s[8:11], s89 offen offset:0 nt
    buffer_load_dwordx4 a[188:191], v23, s[8:11], s89 offen offset:1024 nt
    s_barrier
    s_cmp_ge_u32 s69, 20
    s_cbranch_scc1 DMAF
    s_lshl_b32 s66, s72, 3
    s_add_u32 s66, s66, s68
    s_mul_i32 s66, s66, 245760
    s_lshl_b32 s78, s69, 6
    s_add_u32 s66, s66, s78
    s_mul_i32 s67, s72, 12288
    s_add_u32 s67, s67, 57344
DMAX:
    v_mov_b32 v109, v20
    v_and_b32 v25, 15, v0
    v_lshrrev_b32 v26, 4, v0
    v_add_u32 v27, 4, v26
    s_mul_i32 s7, s68, 10240
    s_add_u32 s7, s7, 737280
    v_mul_u32_u24 v20, 1280, v26
    v_add_u32 v20, s7, v20
    s_mul_i32 s7, s68, 81920
    s_add_u32 s7, s7, 46592
    v_mov_b32 v28, s7
    v_cmp_eq_u32 vcc, s68, v26
    s_nop 1
    v_cndmask_b32 v20, v20, v28, vcc
    s_mul_i32 s7, s68, 10240
    s_add_u32 s7, s7, 737280
    v_mul_u32_u24 v21, 1280, v27
    v_add_u32 v21, s7, v21
    s_mul_i32 s7, s68, 81920
    s_add_u32 s7, s7, 46592
    v_mov_b32 v28, s7
    v_cmp_eq_u32 vcc, s68, v27
    s_nop 1
    v_cndmask_b32 v21, v21, v28, vcc
    s_min_u32 s7, s69, 19
    s_lshl_b32 s7, s7, 6
    v_lshl_add_u32 v25, v25, 2, s7
    v_add_u32 v20, v20, v25
    v_add_u32 v21, v21, v25
    buffer_load_dwordx4 a[216:219], v1, s[12:15], s73 offen offset:0 nt
    v_and_b32 v25, 15, v0
    v_bfe_u32 v27, v0, 2, 2
    v_and_b32 v28, 3, v0
    s_mul_i32 s7, s72, 12288
    s_add_u32 s7, s7, 57344
    v_lshl_add_u32 v29, v26, 3, v27
    v_lshlrev_b32 v29, 6, v29
    v_lshl_add_u32 v29, v28, 3, v29
    v_add_u32 v29, s7, v29
    v_accvgpr_write_b32 a246, v29
    s_mul_i32 s7, s72, 3072
    s_add_u32 s7, s7, 32768
    v_lshl_add_u32 v29, v25, 4, s7
    v_lshl_add_u32 v29, v26, 7, v29
    v_accvgpr_write_b32 a247, v29
    s_lshl_b32 s7, s72, 6
    s_add_u32 s7, s7, 45056
    v_and_b32 v29, 1, v26
    v_lshl_add_u32 v29, v29, 5, s7
    v_accvgpr_write_b32 a248, v29
    s_lshl_b32 s7, s72, 8
    s_add_u32 s7, s7, 122368
    v_lshl_add_u32 v29, v0, 2, s7
    v_accvgpr_write_b32 a249, v29
    s_lshl_b32 s81, s69, 6
    s_mul_i32 s80, s68, 1280
    s_add_u32 s80, s80, s81
    s_add_u32 s80, s80, 655360
    s_add_u32 s81, s81, s3
    s_add_u32 s81, s81, 45312
    s_waitcnt vmcnt(13)
    ds_write_b128 v2, a[120:123] offset:0
    ds_write_b128 v3, a[124:127] offset:0
    ds_write_b128 v4, a[128:131] offset:0
    ds_write_b128 v2, a[132:135] offset:3328
    ds_write_b128 v3, a[136:139] offset:3328
    ds_write_b128 v4, a[140:143] offset:3328
    ds_read_b128 a[120:123], v5 offset:0
    ds_read_b128 a[124:127], v5 offset:64
    ds_read_b128 a[128:131], v5 offset:128
    ds_read_b128 a[132:135], v5 offset:192
    ds_read_b128 a[136:139], v5 offset:256
    ds_read_b128 a[140:143], v5 offset:320
    buffer_load_dwordx4 a[220:223], v1, s[12:15], s73 offen offset:1024 nt
    buffer_load_dwordx4 a[224:227], v1, s[12:15], s73 offen offset:2048 nt
    buffer_load_dwordx4 a[228:231], v1, s[12:15], s73 offen offset:3072 nt
    buffer_load_dwordx4 a[232:235], v23, s[12:15], s73 offen offset:0 nt
    buffer_load_dwordx4 a[236:239], v23, s[12:15], s73 offen offset:1024 nt
    s_barrier
    buffer_load_dwordx2 v[98:99], v100, s[16:19], 0 offen offset:384 sc1
    s_waitcnt vmcnt(13)
    ds_write_b128 v2, a[144:147] offset:0
    ds_write_b128 v3, a[148:151] offset:0
    ds_write_b128 v4, a[152:155] offset:0
    ds_write_b128 v2, a[156:159] offset:3328
    ds_write_b128 v3, a[160:163] offset:3328
    ds_write_b128 v4, a[164:167] offset:3328
    ds_read_b128 a[144:147], v5 offset:0
    ds_read_b128 a[148:151], v5 offset:64
    ds_read_b128 a[152:155], v5 offset:128
    ds_read_b128 a[156:159], v5 offset:192
    ds_read_b128 a[160:163], v5 offset:256
    ds_read_b128 a[164:167], v5 offset:320
    buffer_load_dwordx4 v[112:115], v1, s[12:15], s83 offen offset:0 nt
    buffer_load_dwordx4 v[116:119], v1, s[12:15], s83 offen offset:1024 nt
    buffer_load_dwordx4 v[120:123], v1, s[12:15], s83 offen offset:2048 nt
    buffer_load_dwordx4 v[124:127], v1, s[12:15], s83 offen offset:3072 nt
    buffer_load_dwordx4 v[128:131], v23, s[12:15], s83 offen offset:0 nt
    buffer_load_dwordx4 v[132:135], v23, s[12:15], s83 offen offset:1024 nt
    s_barrier
    s_waitcnt vmcnt(13)
    ds_write_b128 v2, a[168:171] offset:0
    ds_write_b128 v3, a[172:175] offset:0
    ds_write_b128 v4, a[176:179] offset:0
    ds_write_b128 v2, a[180:183] offset:3328
    ds_write_b128 v3, a[184:187] offset:3328
    ds_write_b128 v4, a[188:191] offset:3328
    ds_read_b128 a[168:171], v5 offset:0
    ds_read_b128 a[172:175], v5 offset:64
    ds_read_b128 a[176:179], v5 offset:128
    ds_read_b128 a[180:183], v5 offset:192
    ds_read_b128 a[184:187], v5 offset:256
    ds_read_b128 a[188:191], v5 offset:320
    buffer_load_dwordx4 v[136:139], v1, s[12:15], s84 offen offset:0 nt
    buffer_load_dwordx4 v[140:143], v1, s[12:15], s84 offen offset:1024 nt
    buffer_load_dwordx4 v[144:147], v1, s[12:15], s84 offen offset:2048 nt
    buffer_load_dwordx4 v[148:151], v1, s[12:15], s84 offen offset:3072 nt
    buffer_load_dwordx4 v[152:155], v23, s[12:15], s84 offen offset:0 nt
    buffer_load_dwordx4 v[156:159], v23, s[12:15], s84 offen offset:1024 nt
    s_barrier
    s_waitcnt vmcnt(12)
    s_mov_b32 s76, -1
    v_mov_b32 v97, 125504
    s_cmp_lg_u32 s72, 0
    s_cbranch_scc1 RDYX
    v_cmp_ne_u32 vcc, s96, v98
    s_cbranch_vccnz RDYLOOP
RDYOK:
    v_cmp_ne_u32 vcc, s5, v99
    s_nop 1
    v_mov_b32 v96, vcc_lo
    ds_write_b32 v97, v96
RDYX:
    buffer_load_dwordx4 v[160:163], v1, s[12:15], s85 offen offset:0 nt
    buffer_load_dwordx4 v[164:167], v1, s[12:15], s85 offen offset:1024 nt
    s_waitcnt lgkmcnt(0)
    s_barrier
    ds_read_b32 v96, v97
    s_waitcnt lgkmcnt(0)
    v_readfirstlane_b32 s77, v96
    s_nop 0
    s_cmp_eq_u32 s77, 0
    s_cselect_b32 s10, s18, 0
    s_mov_b32 s8, s16
    s_mov_b32 s9, s17
    s_mov_b32 s11, 0x20000
    buffer_load_dwordx4 a[240:243], v109, s[16:19], 0 offen sc1
    s_mul_i32 s77, s69, 432
    s_add_u32 s77, s77, s3
    s_add_u32 s77, s77, 49152
    s_cmp_eq_u32 s72, 3
    s_cselect_b32 s77, s77, 1879048176
    v_add_u32 v106, s77, v1
    v_mov_b32 v107, 2147483632
    v_cmp_le_u32 vcc, 27, v0
    s_nop 1
    v_cndmask_b32 v106, v106, v107, vcc
    buffer_load_dwordx4 a[240:243], v106, s[16:19], 0 offen sc1
    s_lshl_b32 s77, s70, 12
    s_mul_i32 s78, s72, 96
    s_add_u32 s77, s77, s78
    s_add_u32 s77, s77, s3
    v_lshrrev_b32 v24, 4, v0
    v_lshlrev_b32 v24, 9, v24
    v_and_b32 v25, 15, v0
    v_min_u32 v25, 11, v25
    v_lshl_add_u32 v24, v25, 3, v24
    buffer_load_dwordx2 v[64:65], v24, s[16:19], s77 offen offset:0 sc1
    buffer_load_dwordx2 v[66:67], v24, s[16:19], s77 offen offset:2048 sc1
    s_cmp_lg_u32 s72, 1
    s_cbranch_scc1 NOBASE0
    s_cmp_ge_u32 s69, 20
    s_cbranch_scc1 NOBASE0
    v_mov_b32 v28, v22
    s_lshl_b32 s77, s69, 6
    s_add_u32 s77, s77, s3
    s_add_u32 s77, s77, 47872
    v_lshlrev_b32 v27, 2, v0
    v_mov_b32_dpp v29, v28 quad_perm:[1,1,1,1] row_mask:0xf bank_mask:0xf
    v_mov_b32_dpp v30, v28 quad_perm:[2,2,2,2] row_mask:0xf bank_mask:0xf
    v_mov_b32_dpp v31, v28 quad_perm:[3,3,3,3] row_mask:0xf bank_mask:0xf
    s_mov_b32 exec_lo, 0x1111
    s_mov_b32 exec_hi, 0x0
    buffer_store_dwordx4 v[28:31], v27, s[8:11], s77 offen
    s_cmp_eq_u32 s10, 0
    s_cbranch_scc1 SLOW1
BACK1:
    s_mov_b64 exec, -1
NOBASE0:
    ds_write_b128 v2, a[216:219] offset:0
    ds_write_b128 v3, a[220:223] offset:0
    ds_write_b128 v4, a[224:227] offset:0
    ds_write_b128 v2, a[228:231] offset:3328
    ds_write_b128 v3, a[232:235] offset:3328
    ds_write_b128 v4, a[236:239] offset:3328
    ds_read_b64_tr_b16 a[192:193], v6 offset:0
    ds_read_b64_tr_b16 a[196:197], v6 offset:32
    ds_read_b64_tr_b16 a[200:201], v6 offset:64
    ds_read_b64_tr_b16 a[204:205], v6 offset:96
    ds_read_b64_tr_b16 a[208:209], v6 offset:128
    ds_read_b64_tr_b16 a[212:213], v6 offset:160
    ds_read_b64_tr_b16 a[216:217], v6 offset:192
    ds_read_b64_tr_b16 a[220:221], v6 offset:224
    ds_read_b64_tr_b16 a[224:225], v6 offset:256
    ds_read_b64_tr_b16 a[228:229], v6 offset:288
    ds_read_b64_tr_b16 a[232:233], v6 offset:320
    ds_read_b64_tr_b16 a[236:237], v6 offset:352
    s_waitcnt vmcnt(12)
    ds_write_b128 v2, v[112:115] offset:0
    ds_write_b128 v3, v[116:119] offset:0
    ds_write_b128 v4, v[120:123] offset:0
    ds_write_b128 v2, v[124:127] offset:3328
    ds_write_b128 v3, v[128:131] offset:3328
    ds_write_b128 v4, v[132:135] offset:3328
    ds_read_b64_tr_b16 a[194:195], v6 offset:0
    ds_read_b64_tr_b16 a[198:199], v6 offset:32
    ds_read_b64_tr_b16 a[202:203], v6 offset:64
    ds_read_b64_tr_b16 a[206:207], v6 offset:96
    ds_read_b64_tr_b16 a[210:211], v6 offset:128
    ds_read_b64_tr_b16 a[214:215], v6 offset:160
    ds_read_b64_tr_b16 a[218:219], v6 offset:192
    ds_read_b64_tr_b16 a[222:223], v6 offset:224
    ds_read_b64_tr_b16 a[226:227], v6 offset:256
    ds_read_b64_tr_b16 a[230:231], v6 offset:288
    ds_read_b64_tr_b16 a[234:235], v6 offset:320
    ds_read_b64_tr_b16 a[238:239], v6 offset:352
    buffer_load_dwordx4 v[168:171], v1, s[12:15], s85 offen offset:2048 nt
    buffer_load_dwordx4 v[172:175], v1, s[12:15], s85 offen offset:3072 nt
    buffer_load_dwordx4 v[176:179], v23, s[12:15], s85 offen offset:0 nt
    buffer_load_dwordx4 v[180:183], v23, s[12:15], s85 offen offset:1024 nt
    s_barrier
    buffer_load_dwordx4 v[184:187], v1, s[12:15], s86 offen offset:0 nt
    buffer_load_dwordx4 v[188:191], v1, s[12:15], s86 offen offset:1024 nt
    s_waitcnt vmcnt(12)
    ds_write_b128 v2, v[136:139] offset:0
    ds_write_b128 v3, v[140:143] offset:0
    ds_write_b128 v4, v[144:147] offset:0
    ds_write_b128 v2, v[148:151] offset:3328
    ds_write_b128 v3, v[152:155] offset:3328
    ds_write_b128 v4, v[156:159] offset:3328
    ds_read_b64_tr_b16 v[112:113], v6 offset:0
    ds_read_b64_tr_b16 v[116:117], v6 offset:32
    ds_read_b64_tr_b16 v[120:121], v6 offset:64
    ds_read_b64_tr_b16 v[124:125], v6 offset:96
    ds_read_b64_tr_b16 v[128:129], v6 offset:128
    ds_read_b64_tr_b16 v[132:133], v6 offset:160
    ds_read_b64_tr_b16 v[136:137], v6 offset:192
    ds_read_b64_tr_b16 v[140:141], v6 offset:224
    ds_read_b64_tr_b16 v[144:145], v6 offset:256
    ds_read_b64_tr_b16 v[148:149], v6 offset:288
    ds_read_b64_tr_b16 v[152:153], v6 offset:320
    ds_read_b64_tr_b16 v[156:157], v6 offset:352
    buffer_load_dwordx4 v[192:195], v1, s[12:15], s86 offen offset:2048 nt
    buffer_load_dwordx4 v[196:199], v1, s[12:15], s86 offen offset:3072 nt
    buffer_load_dwordx4 v[200:203], v23, s[12:15], s86 offen offset:0 nt
    buffer_load_dwordx4 v[204:207], v23, s[12:15], s86 offen offset:1024 nt
    s_barrier
    buffer_load_dwordx4 v[208:211], v1, s[12:15], s87 offen offset:0 nt
    buffer_load_dwordx4 v[212:215], v1, s[12:15], s87 offen offset:1024 nt
    s_waitcnt vmcnt(12)
    v_lshlrev_b32 v24, 16, v64
    v_and_b32 v25, 0xffff0000, v64
    v_lshlrev_b32 v26, 16, v65
    v_and_b32 v27, 0xffff0000, v65
    v_lshlrev_b32 v28, 16, v66
    v_and_b32 v29, 0xffff0000, v66
    v_lshlrev_b32 v30, 16, v67
    v_and_b32 v31, 0xffff0000, v67
    v_add_f32 v24, v24, v28
    v_add_f32 v25, v25, v29
    v_add_f32 v26, v26, v30
    v_add_f32 v27, v27, v31
    s_nop 0
    v_permlane32_swap_b32 v24, v26
    v_permlane32_swap_b32 v25, v27
    v_add_f32 v24, v24, v26
    v_add_f32 v25, v25, v27
    s_nop 1
    v_permlane16_swap_b32 v24, v25
    v_add_f32 v24, v24, v25
    v_cvt_pk_bf16_f32 v24, v24, v24
    ds_write_b16 v12, v24
    buffer_load_dwordx4 v[216:219], v1, s[12:15], s87 offen offset:2048 nt
    v_mov_b32 v40, 0
    v_mov_b32 v41, 0
    v_mov_b32 v44, 0
    v_mov_b32 v45, 0
    v_mov_b32 v48, 0
    v_mov_b32 v49, 0
    v_mov_b32 v52, 0
    v_mov_b32 v53, 0
    v_mov_b32 v56, 0
    v_mov_b32 v57, 0
    v_mov_b32 v60, 0
    v_mov_b32 v61, 0
    v_mov_b32 v64, 0
    v_mov_b32 v65, 0
    v_mov_b32 v68, 0
    v_mov_b32 v69, 0
    v_mov_b32 v72, 0
    v_mov_b32 v73, 0
    v_mov_b32 v74, 0
    v_mov_b32 v75, 0
    v_mov_b32 v76, 0
    v_mov_b32 v77, 0
    v_mov_b32 v78, 0
    v_mov_b32 v79, 0
    v_mov_b32 v80, 0
    v_mov_b32 v81, 0
    v_mov_b32 v82, 0
    v_mov_b32 v83, 0
    v_mov_b32 v84, 0
    v_mov_b32 v85, 0
    v_mov_b32 v86, 0
    v_mov_b32 v87, 0
    buffer_load_dwordx4 v[220:223], v1, s[12:15], s87 offen offset:3072 nt
    buffer_load_dwordx4 v[224:227], v23, s[12:15], s87 offen offset:0 nt
    s_waitcnt lgkmcnt(0)
    s_barrier
    ds_read_b128 v[28:31], v13 offset:0
    ds_read_b128 v[32:35], v13 offset:128
    ds_read_b128 v[36:39], v13 offset:256
    v_mov_b32 v18, 0x3dd53b94
    s_waitcnt lgkmcnt(2)
    v_smfmac_f32_16x16x64_bf16 v[40:43], v[28:31], a[0:7], v14
    v_smfmac_f32_16x16x64_bf16 v[44:47], v[28:31], a[24:31], v14
    v_smfmac_f32_16x16x64_bf16 v[48:51], v[28:31], a[48:55], v14
    v_smfmac_f32_16x16x64_bf16 v[52:55], v[28:31], a[72:79], v14
    v_smfmac_f32_16x16x64_bf16 v[56:59], v[28:31], a[96:103], v14
    v_smfmac_f32_16x16x64_bf16 v[60:63], v[28:31], a[120:127], v14
    v_smfmac_f32_16x16x64_bf16 v[64:67], v[28:31], a[144:151], v14
    v_smfmac_f32_16x16x64_bf16 v[68:71], v[28:31], a[168:175], v14
    buffer_load_dwordx4 v[228:231], v23, s[12:15], s87 offen offset:1024 nt
    s_barrier
    s_waitcnt lgkmcnt(1)
    v_smfmac_f32_16x16x64_bf16 v[40:43], v[32:35], a[8:15], v14
    v_smfmac_f32_16x16x64_bf16 v[44:47], v[32:35], a[32:39], v14
    v_smfmac_f32_16x16x64_bf16 v[48:51], v[32:35], a[56:63], v14
    v_smfmac_f32_16x16x64_bf16 v[52:55], v[32:35], a[80:87], v14
    v_smfmac_f32_16x16x64_bf16 v[56:59], v[32:35], a[104:111], v14
    v_smfmac_f32_16x16x64_bf16 v[60:63], v[32:35], a[128:135], v14
    v_smfmac_f32_16x16x64_bf16 v[64:67], v[32:35], a[152:159], v14
    v_smfmac_f32_16x16x64_bf16 v[68:71], v[32:35], a[176:183], v14
    s_waitcnt lgkmcnt(0)
    v_smfmac_f32_16x16x64_bf16 v[40:43], v[36:39], a[16:23], v14
    v_smfmac_f32_16x16x64_bf16 v[44:47], v[36:39], a[40:47], v14
    v_smfmac_f32_16x16x64_bf16 v[48:51], v[36:39], a[64:71], v14
    v_smfmac_f32_16x16x64_bf16 v[52:55], v[36:39], a[88:95], v14
    v_smfmac_f32_16x16x64_bf16 v[56:59], v[36:39], a[112:119], v14
    v_smfmac_f32_16x16x64_bf16 v[60:63], v[36:39], a[136:143], v14
    v_smfmac_f32_16x16x64_bf16 v[64:67], v[36:39], a[160:167], v14
    v_smfmac_f32_16x16x64_bf16 v[68:71], v[36:39], a[184:191], v14
    buffer_load_dwordx4 v[232:235], v1, s[12:15], s88 offen offset:0 nt
    v_add_f32 v24, v40, v41
    v_add_f32 v44, v44, v45
    v_add_f32 v48, v48, v49
    v_max3_f32 v26, v24, v44, v48
    v_add_f32 v52, v52, v53
    v_add_f32 v25, v56, v57
    v_max3_f32 v26, v26, v52, v25
    v_add_f32 v60, v60, v61
    v_add_f32 v64, v64, v65
    v_max3_f32 v26, v26, v60, v64
    v_add_f32 v68, v68, v69
    v_max_f32 v26, v26, v68
    v_mov_b32_dpp v24, v44 quad_perm:[0,1,2,3] row_mask:0x2 bank_mask:0xf
    v_mov_b32_dpp v25, v60 quad_perm:[0,1,2,3] row_mask:0x2 bank_mask:0xf
    v_max_f32_dpp v26, v26, v26 row_ror:8 row_mask:0xf bank_mask:0xf
    v_mov_b32_dpp v24, v48 quad_perm:[0,1,2,3] row_mask:0x4 bank_mask:0xf
    v_mov_b32_dpp v25, v64 quad_perm:[0,1,2,3] row_mask:0x4 bank_mask:0xf
    v_max_f32_dpp v26, v26, v26 row_ror:4 row_mask:0xf bank_mask:0xf
    v_mov_b32_dpp v24, v52 quad_perm:[0,1,2,3] row_mask:0x8 bank_mask:0xf
    v_mov_b32_dpp v25, v68 quad_perm:[0,1,2,3] row_mask:0x8 bank_mask:0xf
    v_max_f32_dpp v26, v26, v26 row_ror:2 row_mask:0xf bank_mask:0xf
    v_accvgpr_read_b32 v27, a252
    s_nop 0
    v_max_f32_dpp v26, v26, v26 row_ror:1 row_mask:0xf bank_mask:0xf
    buffer_load_dwordx4 v[236:239], v1, s[12:15], s88 offen offset:1024 nt
    v_mul_f32 v26, v26, v18
    v_fma_f32 v24, v24, v18, -v26
    v_fma_f32 v25, v25, v18, -v26
    v_exp_f32 v24, v24
    v_exp_f32 v25, v25
    s_nop 0
    v_cvt_pk_bf16_f32 v28, v24, v25
    ds_write_b16 v19, v28
    ds_write_b16_d16_hi v19, v28 offset:128
    s_mov_b32 exec_lo, 0xff00ff
    s_mov_b32 exec_hi, 0xff00ff00
    ds_read_b128 v[72:75], v27 offset:0
    ds_read_b128 v[76:79], v27 offset:64
    ds_read_b128 v[80:83], v27 offset:128
    ds_read_b128 v[84:87], v27 offset:192
    s_mov_b64 exec, -1
    v_add_f32 v27, v24, v25
    v_mov_b32 v40, 0
    v_mov_b32 v44, 0
    v_add_f32_dpp v27, v27, v27 row_ror:8 row_mask:0xf bank_mask:0xf
    v_mov_b32 v48, 0
    v_mov_b32 v52, 0
    v_add_f32_dpp v27, v27, v27 row_ror:4 row_mask:0xf bank_mask:0xf
    v_mov_b32 v56, 0
    v_mov_b32 v60, 0
    v_add_f32_dpp v27, v27, v27 row_ror:2 row_mask:0xf bank_mask:0xf
    s_lshl_b32 s78, s72, 3
    s_add_u32 s78, s78, 125440
    v_add_f32_dpp v27, v27, v27 row_ror:1 row_mask:0xf bank_mask:0xf
    v_mov_b32 v28, v27
    s_nop 1
    v_permlane32_swap_b32 v27, v28
    v_add_f32 v27, v27, v28
    v_mov_b32 v28, v27
    s_nop 1
    v_permlane16_swap_b32 v27, v28
    v_add_f32 v27, v27, v28
    v_mov_b32 v28, s78
    ds_write_b64 v28, v[26:27]
    s_waitcnt vmcnt(14)
    ds_write_b128 v2, v[160:163] offset:0
    ds_write_b128 v3, v[164:167] offset:0
    ds_write_b128 v4, v[168:171] offset:0
    ds_write_b128 v2, v[172:175] offset:3328
    ds_write_b128 v3, v[176:179] offset:3328
    ds_write_b128 v4, v[180:183] offset:3328
    ds_read_b64_tr_b16 v[114:115], v6 offset:0
    ds_read_b64_tr_b16 v[118:119], v6 offset:32
    ds_read_b64_tr_b16 v[122:123], v6 offset:64
    ds_read_b64_tr_b16 v[126:127], v6 offset:96
    ds_read_b64_tr_b16 v[130:131], v6 offset:128
    ds_read_b64_tr_b16 v[134:135], v6 offset:160
    ds_read_b64_tr_b16 v[138:139], v6 offset:192
    ds_read_b64_tr_b16 v[142:143], v6 offset:224
    ds_read_b64_tr_b16 v[146:147], v6 offset:256
    ds_read_b64_tr_b16 v[150:151], v6 offset:288
    ds_read_b64_tr_b16 v[154:155], v6 offset:320
    ds_read_b64_tr_b16 v[158:159], v6 offset:352
    buffer_load_dwordx4 v[240:243], v1, s[12:15], s88 offen offset:2048 nt
    buffer_load_dwordx4 v[244:247], v1, s[12:15], s88 offen offset:3072 nt
    s_waitcnt lgkmcnt(0)
    v_smfmac_f32_16x16x64_bf16 v[40:43], v[72:75], a[192:199], v14 abid:1
    v_smfmac_f32_16x16x64_bf16 v[44:47], v[72:75], a[200:207], v14 abid:1
    v_smfmac_f32_16x16x64_bf16 v[48:51], v[72:75], a[208:215], v14 abid:1
    v_smfmac_f32_16x16x64_bf16 v[52:55], v[72:75], a[216:223], v14 abid:1
    v_smfmac_f32_16x16x64_bf16 v[56:59], v[72:75], a[224:231], v14 abid:1
    v_smfmac_f32_16x16x64_bf16 v[60:63], v[72:75], a[232:239], v14 abid:1
    buffer_load_dwordx4 v[248:251], v23, s[12:15], s88 offen offset:0 nt
    v_smfmac_f32_16x16x64_bf16 v[40:43], v[76:79], v[112:119], v14 abid:1
    v_smfmac_f32_16x16x64_bf16 v[44:47], v[76:79], v[120:127], v14 abid:1
    v_smfmac_f32_16x16x64_bf16 v[48:51], v[76:79], v[128:135], v14 abid:1
    v_smfmac_f32_16x16x64_bf16 v[52:55], v[76:79], v[136:143], v14 abid:1
    v_smfmac_f32_16x16x64_bf16 v[56:59], v[76:79], v[144:151], v14 abid:1
    v_smfmac_f32_16x16x64_bf16 v[60:63], v[76:79], v[152:159], v14 abid:1
    buffer_load_dwordx4 v[252:255], v23, s[12:15], s88 offen offset:1024 nt
    s_barrier
    s_waitcnt vmcnt(12)
    ds_write_b128 v2, v[184:187] offset:0
    ds_write_b128 v3, v[188:191] offset:0
    ds_write_b128 v4, v[192:195] offset:0
    ds_write_b128 v2, v[196:199] offset:3328
    ds_write_b128 v3, v[200:203] offset:3328
    ds_write_b128 v4, v[204:207] offset:3328
    ds_read_b64_tr_b16 v[160:161], v6 offset:0
    ds_read_b64_tr_b16 v[164:165], v6 offset:32
    ds_read_b64_tr_b16 v[168:169], v6 offset:64
    ds_read_b64_tr_b16 v[172:173], v6 offset:96
    ds_read_b64_tr_b16 v[176:177], v6 offset:128
    ds_read_b64_tr_b16 v[180:181], v6 offset:160
    ds_read_b64_tr_b16 v[184:185], v6 offset:192
    ds_read_b64_tr_b16 v[188:189], v6 offset:224
    ds_read_b64_tr_b16 v[192:193], v6 offset:256
    ds_read_b64_tr_b16 v[196:197], v6 offset:288
    ds_read_b64_tr_b16 v[200:201], v6 offset:320
    ds_read_b64_tr_b16 v[204:205], v6 offset:352
    v_mov_b32 v24, -1
    v_mov_b32 v25, -1
    v_mov_b32 v26, -1
    v_mov_b32 v27, -1
    buffer_store_dwordx4 v[24:27], v106, s[8:11], 0 offen
    s_cmp_eq_u32 s10, 0
    s_cbranch_scc1 SLOW2
BACK2:
    buffer_load_dwordx4 v[88:91], v1, s[12:15], s89 offen offset:0 nt
    buffer_load_dwordx4 v[92:95], v1, s[12:15], s89 offen offset:1024 nt
    buffer_load_dwordx4 v[96:99], v1, s[12:15], s89 offen offset:2048 nt
    buffer_load_dwordx4 v[100:103], v1, s[12:15], s89 offen offset:3072 nt
    buffer_load_dwordx4 v[104:107], v23, s[12:15], s89 offen offset:0 nt
    buffer_load_dwordx4 v[108:111], v23, s[12:15], s89 offen offset:1024 nt
    s_waitcnt vmcnt(13)
    ds_write_b128 v2, v[208:211] offset:0
    ds_write_b128 v3, v[212:215] offset:0
    ds_write_b128 v4, v[216:219] offset:0
    ds_write_b128 v2, v[220:223] offset:3328
    ds_write_b128 v3, v[224:227] offset:3328
    ds_write_b128 v4, v[228:231] offset:3328
    ds_read_b64_tr_b16 v[162:163], v6 offset:0
    ds_read_b64_tr_b16 v[166:167], v6 offset:32
    ds_read_b64_tr_b16 v[170:171], v6 offset:64
    ds_read_b64_tr_b16 v[174:175], v6 offset:96
    ds_read_b64_tr_b16 v[178:179], v6 offset:128
    ds_read_b64_tr_b16 v[182:183], v6 offset:160
    ds_read_b64_tr_b16 v[186:187], v6 offset:192
    ds_read_b64_tr_b16 v[190:191], v6 offset:224
    ds_read_b64_tr_b16 v[194:195], v6 offset:256
    ds_read_b64_tr_b16 v[198:199], v6 offset:288
    ds_read_b64_tr_b16 v[202:203], v6 offset:320
    ds_read_b64_tr_b16 v[206:207], v6 offset:352
    v_and_b32 v23, 0xffff0000, v22
    v_lshlrev_b32 v22, 16, v22
    s_mov_b32 s82, 0x1010101
    s_mov_b32 s83, 0x1010101
    s_mov_b32 s84, 0x1ff01ff
    s_mov_b32 s85, 0x1ff01ff
    s_mov_b32 s86, 0xffffffff
    s_mov_b32 s87, 0xfffffff
    s_mov_b32 s88, 0xff00ff
    s_mov_b32 s89, 0xff00ff00
    s_mov_b32 s92, 0x1010101
    s_mov_b32 s93, 0x0
    s_mov_b32 s44, 0xf0f0f0f
    s_mov_b32 s45, 0xf0f0f0f
    s_mov_b64 s[46:47], s[92:93]
    s_mov_b64 s[48:49], s[44:45]
    s_cmp_ge_u32 s69, 20
    s_cbranch_scc1 TAILF
    v_mov_b32 v24, -1
    v_mov_b32 v25, -1
    v_mov_b32 v26, -1
    v_mov_b32 v27, -1
    v_and_b32 v28, 3, v0
    v_lshrrev_b32 v29, 5, v0
    v_lshl_add_u32 v28, v29, 2, v28
    v_mul_u32_u24 v28, 10240, v28
    v_bfe_u32 v29, v0, 3, 2
    v_lshl_add_u32 v28, v29, 4, v28
    s_cmp_eq_u32 s72, 3
    s_cselect_b32 s77, 0, 1879048176
    v_add_u32 v28, s77, v28
    s_add_u32 s77, s80, 81920
    s_mov_b64 exec, s[44:45]
    buffer_store_dwordx4 v[24:27], v28, s[16:19], s77 offen sc1
    s_mov_b64 exec, -1
    v_lshrrev_b32 v38, 2, v0
    v_mul_u32_u24 v38, 1280, v38
    v_and_b32 v39, 3, v0
    v_lshl_add_u32 v39, v39, 4, v38
    s_mov_b32 m0, s67
    s_add_u32 s67, s67, 1024
    buffer_load_dwordx4 v39, s[24:27], s66 offen  lds
    s_add_u32 s66, s66, 20480
    s_mov_b32 m0, s67
    s_add_u32 s67, s67, 1024
    buffer_load_dwordx4 v39, s[24:27], s66 offen  lds
    s_add_u32 s66, s66, 20480
    s_mov_b32 m0, s67
    s_add_u32 s67, s67, 1024
    buffer_load_dwordx4 v39, s[24:27], s66 offen  lds
    s_add_u32 s66, s66, 20480
    s_waitcnt lgkmcnt(0)
    v_smfmac_f32_16x16x64_bf16 v[40:43], v[80:83], v[160:167], v14 abid:1
    v_smfmac_f32_16x16x64_bf16 v[44:47], v[80:83], v[168:175], v14 abid:1
    v_smfmac_f32_16x16x64_bf16 v[48:51], v[80:83], v[176:183], v14 abid:1
    v_smfmac_f32_16x16x64_bf16 v[52:55], v[80:83], v[184:191], v14 abid:1
    v_smfmac_f32_16x16x64_bf16 v[56:59], v[80:83], v[192:199], v14 abid:1
    v_smfmac_f32_16x16x64_bf16 v[60:63], v[80:83], v[200:207], v14 abid:1
    s_waitcnt vmcnt(11)
    ds_write_b128 v2, v[232:235] offset:0
    ds_write_b128 v3, v[236:239] offset:0
    ds_write_b128 v4, v[240:243] offset:0
    ds_write_b128 v2, v[244:247] offset:3328
    ds_write_b128 v3, v[248:251] offset:3328
    ds_write_b128 v4, v[252:255] offset:3328
    ds_read_b64_tr_b16 v[208:209], v6 offset:0
    ds_read_b64_tr_b16 v[212:213], v6 offset:32
    ds_read_b64_tr_b16 v[216:217], v6 offset:64
    ds_read_b64_tr_b16 v[220:221], v6 offset:96
    ds_read_b64_tr_b16 v[224:225], v6 offset:128
    ds_read_b64_tr_b16 v[228:229], v6 offset:160
    ds_read_b64_tr_b16 v[232:233], v6 offset:192
    ds_read_b64_tr_b16 v[236:237], v6 offset:224
    ds_read_b64_tr_b16 v[240:241], v6 offset:256
    ds_read_b64_tr_b16 v[244:245], v6 offset:288
    ds_read_b64_tr_b16 v[248:249], v6 offset:320
    ds_read_b64_tr_b16 v[252:253], v6 offset:352
    s_mov_b32 m0, s67
    s_add_u32 s67, s67, 1024
    buffer_load_dwordx4 v39, s[24:27], s66 offen  lds
    s_add_u32 s66, s66, 20480
    s_mov_b32 m0, s67
    s_add_u32 s67, s67, 1024
    buffer_load_dwordx4 v39, s[24:27], s66 offen  lds
    s_add_u32 s66, s66, 20480
    s_mov_b32 m0, s67
    s_add_u32 s67, s67, 1024
    buffer_load_dwordx4 v39, s[24:27], s66 offen  lds
    s_add_u32 s66, s66, 20480
    s_waitcnt vmcnt(12)
    ds_write_b128 v2, v[88:91] offset:0
    s_waitcnt vmcnt(11)
    ds_write_b128 v3, v[92:95] offset:0
    s_waitcnt vmcnt(10)
    ds_write_b128 v4, v[96:99] offset:0
    s_waitcnt vmcnt(9)
    ds_write_b128 v2, v[100:103] offset:3328
    s_waitcnt vmcnt(8)
    ds_write_b128 v3, v[104:107] offset:3328
    s_waitcnt vmcnt(7)
    ds_write_b128 v4, v[108:111] offset:3328
    ds_read_b64_tr_b16 v[210:211], v6 offset:0
    ds_read_b64_tr_b16 v[214:215], v6 offset:32
    ds_read_b64_tr_b16 v[218:219], v6 offset:64
    ds_read_b64_tr_b16 v[222:223], v6 offset:96
    ds_read_b64_tr_b16 v[226:227], v6 offset:128
    ds_read_b64_tr_b16 v[230:231], v6 offset:160
    ds_read_b64_tr_b16 v[234:235], v6 offset:192
    ds_read_b64_tr_b16 v[238:239], v6 offset:224
    ds_read_b64_tr_b16 v[242:243], v6 offset:256
    ds_read_b64_tr_b16 v[246:247], v6 offset:288
    ds_read_b64_tr_b16 v[250:251], v6 offset:320
    ds_read_b64_tr_b16 v[254:255], v6 offset:352
    s_branch ATT_LAST
TAILF:
    s_lshl_b32 s90, s72, 3
    s_add_u32 s90, s90, s68
    s_mul_i32 s90, s90, 24
    s_add_u32 s90, s90, s69
    s_sub_u32 s90, s90, 8
    s_mul_i32 s90, s90, 10240
    buffer_load_dwordx4 a[240:243], v1, s[20:23], s90 offen offset:0
    buffer_load_dwordx4 a[240:243], v1, s[20:23], s90 offen offset:1024
    buffer_load_dwordx4 a[240:243], v1, s[20:23], s90 offen offset:2048
    buffer_load_dwordx4 a[240:243], v1, s[20:23], s90 offen offset:3072
    s_add_u32 s90, s90, 4096
    buffer_load_dwordx4 a[240:243], v1, s[20:23], s90 offen offset:0
    buffer_load_dwordx4 a[240:243], v1, s[20:23], s90 offen offset:1024
    buffer_load_dwordx4 a[240:243], v1, s[20:23], s90 offen offset:2048
    v_lshrrev_b32 v38, 3, v0
    v_mul_u32_u24 v38, 3072, v38
    v_and_b32 v39, 7, v0
    v_lshl_add_u32 v38, v39, 4, v38
    v_bfe_u32 v39, v0, 4, 1
    v_lshlrev_b32 v39, 5, v39
    v_xor_b32 v38, v38, v39
    v_xor_b32 v39, 64, v38
    s_waitcnt lgkmcnt(0)
    v_smfmac_f32_16x16x64_bf16 v[40:43], v[80:83], v[160:167], v14 abid:1
    v_smfmac_f32_16x16x64_bf16 v[44:47], v[80:83], v[168:175], v14 abid:1
    v_smfmac_f32_16x16x64_bf16 v[48:51], v[80:83], v[176:183], v14 abid:1
    v_smfmac_f32_16x16x64_bf16 v[52:55], v[80:83], v[184:191], v14 abid:1
    v_smfmac_f32_16x16x64_bf16 v[56:59], v[80:83], v[192:199], v14 abid:1
    v_smfmac_f32_16x16x64_bf16 v[60:63], v[80:83], v[200:207], v14 abid:1
    s_waitcnt vmcnt(14)
    ds_write_b128 v2, v[232:235] offset:0
    ds_write_b128 v3, v[236:239] offset:0
    ds_write_b128 v4, v[240:243] offset:0
    ds_write_b128 v2, v[244:247] offset:3328
    ds_write_b128 v3, v[248:251] offset:3328
    ds_write_b128 v4, v[252:255] offset:3328
    ds_read_b64_tr_b16 v[208:209], v6 offset:0
    ds_read_b64_tr_b16 v[212:213], v6 offset:32
    ds_read_b64_tr_b16 v[216:217], v6 offset:64
    ds_read_b64_tr_b16 v[220:221], v6 offset:96
    ds_read_b64_tr_b16 v[224:225], v6 offset:128
    ds_read_b64_tr_b16 v[228:229], v6 offset:160
    ds_read_b64_tr_b16 v[232:233], v6 offset:192
    ds_read_b64_tr_b16 v[236:237], v6 offset:224
    ds_read_b64_tr_b16 v[240:241], v6 offset:256
    ds_read_b64_tr_b16 v[244:245], v6 offset:288
    ds_read_b64_tr_b16 v[248:249], v6 offset:320
    ds_read_b64_tr_b16 v[252:253], v6 offset:352
    buffer_load_dwordx4 a[240:243], v1, s[20:23], s90 offen offset:3072
    s_add_u32 s90, s90, 4096
    buffer_load_dwordx4 a[240:243], v1, s[20:23], s90 offen offset:0
    buffer_load_dwordx4 a[240:243], v1, s[20:23], s90 offen offset:1024
    s_waitcnt vmcnt(15)
    ds_write_b128 v2, v[88:91] offset:0
    s_waitcnt vmcnt(14)
    ds_write_b128 v3, v[92:95] offset:0
    s_waitcnt vmcnt(13)
    ds_write_b128 v4, v[96:99] offset:0
    s_waitcnt vmcnt(12)
    ds_write_b128 v2, v[100:103] offset:3328
    s_waitcnt vmcnt(11)
    ds_write_b128 v3, v[104:107] offset:3328
    s_waitcnt vmcnt(10)
    ds_write_b128 v4, v[108:111] offset:3328
    ds_read_b64_tr_b16 v[210:211], v6 offset:0
    ds_read_b64_tr_b16 v[214:215], v6 offset:32
    ds_read_b64_tr_b16 v[218:219], v6 offset:64
    ds_read_b64_tr_b16 v[222:223], v6 offset:96
    ds_read_b64_tr_b16 v[226:227], v6 offset:128
    ds_read_b64_tr_b16 v[230:231], v6 offset:160
    ds_read_b64_tr_b16 v[234:235], v6 offset:192
    ds_read_b64_tr_b16 v[238:239], v6 offset:224
    ds_read_b64_tr_b16 v[242:243], v6 offset:256
    ds_read_b64_tr_b16 v[246:247], v6 offset:288
    ds_read_b64_tr_b16 v[250:251], v6 offset:320
    ds_read_b64_tr_b16 v[254:255], v6 offset:352
    s_branch ATT_LAST
LOOP:
    s_cmp_lt_u32 s69, 20
    s_cselect_b32 s5, s72, 4
    s_add_u32 s96, s3, 819200
    s_add_u32 s97, s96, 4096
    buffer_load_dwordx4 v[88:91], v11, s[16:19], s96 offen sc1
    buffer_load_dwordx4 v[92:95], v11, s[16:19], s97 offen sc1
    ds_read_b64_tr_b16 v[40:41], v16 offset:0
    ds_read_b64_tr_b16 v[42:43], v16 offset:1536
    ds_read_b64_tr_b16 v[44:45], v16 offset:12288
    ds_read_b64_tr_b16 v[46:47], v16 offset:13824
    ds_read_b64_tr_b16 v[48:49], v17 offset:24576
    ds_read_b64_tr_b16 v[50:51], v16 offset:32
    ds_read_b64_tr_b16 v[52:53], v16 offset:1568
    ds_read_b64_tr_b16 v[54:55], v16 offset:12320
    ds_read_b64_tr_b16 v[56:57], v16 offset:13856
    ds_read_b64_tr_b16 v[58:59], v17 offset:24608
    ds_read_b64_tr_b16 v[60:61], v16 offset:64
    ds_read_b64_tr_b16 v[62:63], v16 offset:1600
    ds_read_b64_tr_b16 v[64:65], v16 offset:12352
    ds_read_b64_tr_b16 v[66:67], v16 offset:13888
    ds_read_b64_tr_b16 v[68:69], v17 offset:24640
    v_and_b32 v25, 15, v0
    v_cmp_eq_u32 vcc, 12, v25
    v_mov_b32 v36, 0x3f803f80
    s_nop 0
    v_cndmask_b32 v70, 0, v36, vcc
    v_mov_b32 v71, v70
    v_mov_b32 v72, v70
    v_mov_b32 v73, v70
    v_mov_b32 v74, v70
    v_mov_b32 v75, v70
    v_mov_b32 v76, v70
    v_mov_b32 v77, v70
    v_mov_b32 v78, v70
    v_mov_b32 v79, v70
    s_add_u32 s79, s3, 4096
    s_mul_i32 s77, s72, 6656
    v_mul_u32_u24 v26, 103, v0
    v_lshrrev_b32 v26, 10, v26
    v_lshl_add_u32 v26, v26, 4, v1
    v_add_u32 v26, s77, v26
    v_mul_u32_u24 v27, 176, v25
    v_add_u32 v27, s77, v27
    v_lshrrev_b32 v28, 4, v0
    v_lshl_add_u32 v29, v28, 3, v27
    v_lshl_add_u32 v27, v28, 4, v27
    s_mul_i32 s77, s71, 160
    s_add_u32 s77, s77, s3
    s_sub_u32 s77, s77, 772608
    s_waitcnt lgkmcnt(0)
    s_mov_b32 exec_lo, 0x3ff
    s_mov_b32 exec_hi, 0x0
    s_mov_b32 s76, 1
POLL3:
    buffer_load_dword v24, v1, s[16:19], s77 offen sc1
POLLW3:
    s_waitcnt vmcnt(0)
    v_cmp_eq_u32 vcc, -1, v24
    s_cbranch_vccnz AGAIN3
POLLX3:
    s_mov_b64 exec, s[86:87]
    buffer_load_dwordx4 v[80:83], v8, s[16:19], 0 offen sc1
    buffer_load_dwordx4 v[84:87], v9, s[16:19], 0 offen sc1
    buffer_load_dwordx4 v[88:91], v11, s[16:19], s96 offen sc1
    buffer_load_dwordx4 v[92:95], v11, s[16:19], s97 offen sc1
    s_waitcnt vmcnt(2)
BW4:
    ds_write_b128 v26, v[80:83]
    ds_write_b128 v26, v[84:87] offset:1056
    v_max_u32 v24, v80, v84
    v_cmp_eq_u32 vcc, -1, v24
    s_mov_b64 exec, s[84:85]
    ds_read_b128 v[70:73], v27
    ds_read_b128 v[74:77], v27 offset:64
    ds_read_b64 v[78:79], v29 offset:128
    s_mov_b64 exec, -1
    s_cbranch_vccnz BR4
BX4:
    s_cmp_lg_u32 s5, 1
    s_cbranch_scc1 NOOWL
    buffer_load_dword a244, v20, s[16:19], 0 offen sc1
    buffer_load_dword a245, v21, s[16:19], 0 offen sc1
NOOWL:
    s_waitcnt lgkmcnt(2)
    v_mfma_f32_16x16x32_bf16 v[24:27], v[70:73], v[40:43], 0
    v_mfma_f32_16x16x32_bf16 v[32:35], v[70:73], v[60:63], 0
    s_waitcnt lgkmcnt(0)
    v_mfma_f32_16x16x32_bf16 v[24:27], v[74:77], v[44:47], v[24:27]
    v_mfma_f32_16x16x32_bf16 v[32:35], v[74:77], v[64:67], v[32:35]
    v_mfma_f32_16x16x16_bf16 v[24:27], v[78:79], v[48:49], v[24:27]
    v_mfma_f32_16x16x16_bf16 v[32:35], v[78:79], v[68:69], v[32:35]
    v_mfma_f32_16x16x32_bf16 v[28:31], v[70:73], v[50:53], 0
    v_mfma_f32_16x16x32_bf16 v[36:39], v[70:73], v[70:73], 0
    v_mfma_f32_16x16x32_bf16 v[28:31], v[74:77], v[54:57], v[28:31]
    v_mfma_f32_16x16x32_bf16 v[36:39], v[74:77], v[74:77], v[36:39]
    v_mfma_f32_16x16x16_bf16 v[28:31], v[78:79], v[58:59], v[28:31]
    v_mfma_f32_16x16x16_bf16 v[36:39], v[78:79], v[78:79], v[36:39]
    s_nop 0
    v_add_f32 v24, v24, v25
    v_add_f32 v26, v26, v27
    v_add_f32 v24, v24, v26
    v_add_f32 v32, v32, v33
    v_add_f32 v34, v34, v35
    v_add_f32 v32, v32, v34
    s_nop 1
    v_permlane32_swap_b32 v24, v32
    v_add_f32 v28, v28, v29
    v_add_f32 v30, v30, v31
    v_add_f32 v36, v36, v37
    v_add_f32 v38, v38, v39
    v_add_f32 v24, v24, v32
    v_add_f32 v28, v28, v30
    v_add_f32 v36, v36, v38
    s_nop 1
    v_permlane32_swap_b32 v28, v36
    v_add_f32 v28, v28, v36
    s_nop 1
    v_permlane16_swap_b32 v24, v28
    v_add_f32 v24, v24, v28
    buffer_store_dword v24, v10, s[8:11], s3 offen
    s_cmp_eq_u32 s10, 0
    s_cbranch_scc1 SLOW5
BACK5:
    v_mov_b32 v40, 0
    v_mov_b32 v41, 0
    v_mov_b32 v44, 0
    v_mov_b32 v45, 0
    v_mov_b32 v48, 0
    v_mov_b32 v49, 0
    v_mov_b32 v52, 0
    v_mov_b32 v53, 0
    v_mov_b32 v56, 0
    v_mov_b32 v57, 0
    v_mov_b32 v60, 0
    v_mov_b32 v61, 0
    v_mov_b32 v64, 0
    v_mov_b32 v65, 0
    v_mov_b32 v68, 0
    v_mov_b32 v69, 0
    v_mov_b32 v72, 0
    v_mov_b32 v73, 0
    v_mov_b32 v74, 0
    v_mov_b32 v75, 0
    v_mov_b32 v76, 0
    v_mov_b32 v77, 0
    v_mov_b32 v78, 0
    v_mov_b32 v79, 0
    v_mov_b32 v80, 0
    v_mov_b32 v81, 0
    v_mov_b32 v82, 0
    v_mov_b32 v83, 0
    v_mov_b32 v84, 0
    v_mov_b32 v85, 0
    v_mov_b32 v86, 0
    v_mov_b32 v87, 0
    s_waitcnt vmcnt(1)
    v_add_f32 v88, v88, v92
    v_add_f32 v89, v89, v93
    v_add_f32 v90, v90, v94
    v_add_f32 v91, v91, v95
    s_nop 0
    v_permlane32_swap_b32 v88, v90
    v_permlane32_swap_b32 v89, v91
    v_add_f32 v88, v88, v90
    v_add_f32 v89, v89, v91
    s_nop 1
    v_permlane16_swap_b32 v88, v89
    v_add_f32 v88, v88, v89
    v_mul_f32 v7, 0x3acccccd, v88
    s_mov_b32 s76, 1
POLL6:
    buffer_load_dwordx4 v[24:27], v11, s[16:19], s3 offen sc1
    buffer_load_dwordx4 v[28:31], v11, s[16:19], s79 offen sc1
    s_waitcnt vmcnt(0)
    v_add_f32 v24, v24, v28
    v_add_f32 v25, v25, v29
    v_add_f32 v26, v26, v30
    v_add_f32 v27, v27, v31
    s_nop 0
    v_permlane32_swap_b32 v24, v26
    v_permlane32_swap_b32 v25, v27
    v_add_f32 v24, v24, v26
    v_add_f32 v25, v25, v27
    s_nop 1
    v_permlane16_swap_b32 v24, v25
    v_add_f32 v24, v24, v25
    v_cmp_u_f32 vcc, v24, v24
    s_cbranch_vccnz AGAIN6
POLLX6:
    v_readlane_b32 s77, v24, 15
    s_mov_b32 vcc_lo, 0x70007000
    s_mov_b32 vcc_hi, 0x70007000
    v_fma_f32 v25, -s77, v7, v24
    v_cvt_pk_bf16_f32 v25, v25, v25
    ds_write_b16 v12, v25
    v_cndmask_b32 v26, 0, v24, vcc
    s_nop 1
    v_add_f32_dpp v26, v26, v26 quad_perm:[1,0,3,2] row_mask:0xf bank_mask:0xf
    s_nop 1
    v_add_f32_dpp v26, v26, v26 quad_perm:[2,3,0,1] row_mask:0xf bank_mask:0xf
    v_mov_b32 v27, v26
    s_nop 1
    v_permlane32_swap_b32 v26, v27
    v_add_f32 v26, v26, v27
    s_waitcnt lgkmcnt(0)
    s_barrier
    ds_read_b128 v[28:31], v13 offset:0
    ds_read_b128 v[32:35], v13 offset:128
    ds_read_b128 v[36:39], v13 offset:256
    v_mov_b32 v27, v26
    v_mov_b32 v25, s77
    v_subrev_f32 v25, 0x44200000, v25
    v_permlane16_swap_b32 v26, v27
    v_add_f32 v26, v26, v27
    v_mul_f32 v24, 0x3acccccd, v25
    v_readlane_b32 s77, v26, 15
    v_mul_f32 v24, v24, v24
    s_mov_b32 s78, 0x3acccccd
    v_sub_f32 v26, s77, v25
    v_fma_f32 v26, v26, s78, -v24
    v_max_f32 v26, 0, v26
    v_add_f32 v26, 0x3727c5ac, v26
    v_rsq_f32 v26, v26
    s_nop 0
    v_mul_f32 v18, 0x3dd53b94, v26
    s_waitcnt lgkmcnt(2)
    v_smfmac_f32_16x16x64_bf16 v[40:43], v[28:31], a[0:7], v14
    v_smfmac_f32_16x16x64_bf16 v[44:47], v[28:31], a[24:31], v14
    v_smfmac_f32_16x16x64_bf16 v[48:51], v[28:31], a[48:55], v14
    v_smfmac_f32_16x16x64_bf16 v[52:55], v[28:31], a[72:79], v14
    v_smfmac_f32_16x16x64_bf16 v[56:59], v[28:31], a[96:103], v14
    v_smfmac_f32_16x16x64_bf16 v[60:63], v[28:31], a[120:127], v14
    v_smfmac_f32_16x16x64_bf16 v[64:67], v[28:31], a[144:151], v14
    v_smfmac_f32_16x16x64_bf16 v[68:71], v[28:31], a[168:175], v14
    s_waitcnt lgkmcnt(1)
    v_smfmac_f32_16x16x64_bf16 v[40:43], v[32:35], a[8:15], v14
    v_smfmac_f32_16x16x64_bf16 v[44:47], v[32:35], a[32:39], v14
    v_smfmac_f32_16x16x64_bf16 v[48:51], v[32:35], a[56:63], v14
    v_smfmac_f32_16x16x64_bf16 v[52:55], v[32:35], a[80:87], v14
    v_smfmac_f32_16x16x64_bf16 v[56:59], v[32:35], a[104:111], v14
    v_smfmac_f32_16x16x64_bf16 v[60:63], v[32:35], a[128:135], v14
    v_smfmac_f32_16x16x64_bf16 v[64:67], v[32:35], a[152:159], v14
    v_smfmac_f32_16x16x64_bf16 v[68:71], v[32:35], a[176:183], v14
    s_waitcnt lgkmcnt(0)
    v_smfmac_f32_16x16x64_bf16 v[40:43], v[36:39], a[16:23], v14
    v_smfmac_f32_16x16x64_bf16 v[44:47], v[36:39], a[40:47], v14
    v_smfmac_f32_16x16x64_bf16 v[48:51], v[36:39], a[64:71], v14
    v_smfmac_f32_16x16x64_bf16 v[52:55], v[36:39], a[88:95], v14
    v_smfmac_f32_16x16x64_bf16 v[56:59], v[36:39], a[112:119], v14
    v_smfmac_f32_16x16x64_bf16 v[60:63], v[36:39], a[136:143], v14
    v_smfmac_f32_16x16x64_bf16 v[64:67], v[36:39], a[160:167], v14
    v_smfmac_f32_16x16x64_bf16 v[68:71], v[36:39], a[184:191], v14
    s_nop 0
    v_add_f32 v24, v40, v41
    v_add_f32 v44, v44, v45
    v_add_f32 v48, v48, v49
    v_max3_f32 v26, v24, v44, v48
    v_add_f32 v52, v52, v53
    v_add_f32 v25, v56, v57
    v_max3_f32 v26, v26, v52, v25
    v_add_f32 v60, v60, v61
    v_add_f32 v64, v64, v65
    v_max3_f32 v26, v26, v60, v64
    v_add_f32 v68, v68, v69
    v_max_f32 v26, v26, v68
    v_mov_b32_dpp v24, v44 quad_perm:[0,1,2,3] row_mask:0x2 bank_mask:0xf
    v_mov_b32_dpp v25, v60 quad_perm:[0,1,2,3] row_mask:0x2 bank_mask:0xf
    v_max_f32_dpp v26, v26, v26 row_ror:8 row_mask:0xf bank_mask:0xf
    v_mov_b32_dpp v24, v48 quad_perm:[0,1,2,3] row_mask:0x4 bank_mask:0xf
    v_mov_b32_dpp v25, v64 quad_perm:[0,1,2,3] row_mask:0x4 bank_mask:0xf
    v_max_f32_dpp v26, v26, v26 row_ror:4 row_mask:0xf bank_mask:0xf
    v_mov_b32_dpp v24, v52 quad_perm:[0,1,2,3] row_mask:0x8 bank_mask:0xf
    v_mov_b32_dpp v25, v68 quad_perm:[0,1,2,3] row_mask:0x8 bank_mask:0xf
    v_max_f32_dpp v26, v26, v26 row_ror:2 row_mask:0xf bank_mask:0xf
    v_accvgpr_read_b32 v27, a252
    s_nop 0
    v_max_f32_dpp v26, v26, v26 row_ror:1 row_mask:0xf bank_mask:0xf
    v_mul_f32 v26, v26, v18
    v_fma_f32 v24, v24, v18, -v26
    v_fma_f32 v25, v25, v18, -v26
    v_exp_f32 v24, v24
    v_exp_f32 v25, v25
    s_nop 0
    v_cvt_pk_bf16_f32 v28, v24, v25
    ds_write_b16 v19, v28
    ds_write_b16_d16_hi v19, v28 offset:128
    s_mov_b64 exec, s[88:89]
    ds_read_b128 v[72:75], v27 offset:0
    ds_read_b128 v[76:79], v27 offset:64
    ds_read_b128 v[80:83], v27 offset:128
    ds_read_b128 v[84:87], v27 offset:192
    s_mov_b64 exec, -1
    v_add_f32 v27, v24, v25
    v_mov_b32 v40, 0
    v_mov_b32 v44, 0
    v_add_f32_dpp v27, v27, v27 row_ror:8 row_mask:0xf bank_mask:0xf
    v_mov_b32 v48, 0
    v_mov_b32 v52, 0
    v_add_f32_dpp v27, v27, v27 row_ror:4 row_mask:0xf bank_mask:0xf
    v_mov_b32 v56, 0
    v_mov_b32 v60, 0
    v_add_f32_dpp v27, v27, v27 row_ror:2 row_mask:0xf bank_mask:0xf
    s_lshl_b32 s78, s72, 3
    s_add_u32 s78, s78, 125440
    v_add_f32_dpp v27, v27, v27 row_ror:1 row_mask:0xf bank_mask:0xf
    v_mov_b32 v28, v27
    s_nop 1
    v_permlane32_swap_b32 v27, v28
    v_add_f32 v27, v27, v28
    v_mov_b32 v28, v27
    s_nop 1
    v_permlane16_swap_b32 v27, v28
    v_add_f32 v27, v27, v28
    v_mov_b32 v28, s78
    ds_write_b64 v28, v[26:27]
    s_waitcnt lgkmcnt(4)
    v_smfmac_f32_16x16x64_bf16 v[40:43], v[72:75], a[192:199], v14 abid:1
    v_smfmac_f32_16x16x64_bf16 v[44:47], v[72:75], a[200:207], v14 abid:1
    v_smfmac_f32_16x16x64_bf16 v[48:51], v[72:75], a[208:215], v14 abid:1
    v_smfmac_f32_16x16x64_bf16 v[52:55], v[72:75], a[216:223], v14 abid:1
    v_smfmac_f32_16x16x64_bf16 v[56:59], v[72:75], a[224:231], v14 abid:1
    v_smfmac_f32_16x16x64_bf16 v[60:63], v[72:75], a[232:239], v14 abid:1
    s_waitcnt lgkmcnt(3)
    v_smfmac_f32_16x16x64_bf16 v[40:43], v[76:79], v[112:119], v14 abid:1
    v_smfmac_f32_16x16x64_bf16 v[44:47], v[76:79], v[120:127], v14 abid:1
    v_smfmac_f32_16x16x64_bf16 v[48:51], v[76:79], v[128:135], v14 abid:1
    v_smfmac_f32_16x16x64_bf16 v[52:55], v[76:79], v[136:143], v14 abid:1
    v_smfmac_f32_16x16x64_bf16 v[56:59], v[76:79], v[144:151], v14 abid:1
    v_smfmac_f32_16x16x64_bf16 v[60:63], v[76:79], v[152:159], v14 abid:1
    s_waitcnt lgkmcnt(2)
    v_smfmac_f32_16x16x64_bf16 v[40:43], v[80:83], v[160:167], v14 abid:1
    v_smfmac_f32_16x16x64_bf16 v[44:47], v[80:83], v[168:175], v14 abid:1
    v_smfmac_f32_16x16x64_bf16 v[48:51], v[80:83], v[176:183], v14 abid:1
    v_smfmac_f32_16x16x64_bf16 v[52:55], v[80:83], v[184:191], v14 abid:1
    v_smfmac_f32_16x16x64_bf16 v[56:59], v[80:83], v[192:199], v14 abid:1
    v_smfmac_f32_16x16x64_bf16 v[60:63], v[80:83], v[200:207], v14 abid:1
    s_waitcnt lgkmcnt(0)
ATT_LAST:
    s_waitcnt lgkmcnt(8)
    v_smfmac_f32_16x16x64_bf16 v[40:43], v[84:87], v[208:215], v14 abid:1
    v_smfmac_f32_16x16x64_bf16 v[44:47], v[84:87], v[216:223], v14 abid:1
    s_waitcnt lgkmcnt(4)
    v_smfmac_f32_16x16x64_bf16 v[48:51], v[84:87], v[224:231], v14 abid:1
    v_smfmac_f32_16x16x64_bf16 v[52:55], v[84:87], v[232:239], v14 abid:1
    s_waitcnt lgkmcnt(0)
    v_smfmac_f32_16x16x64_bf16 v[56:59], v[84:87], v[240:247], v14 abid:1
    v_smfmac_f32_16x16x64_bf16 v[60:63], v[84:87], v[248:255], v14 abid:1
    s_lshl_b32 s77, s72, 8
    s_add_u32 s77, s77, 119296
    v_lshl_add_u32 v24, v0, 2, s77
    v_permlane16_swap_b32 v40, v44
    v_add_f32 v40, v40, v44
    ds_write_b32 v15, v40 offset:0
    v_permlane16_swap_b32 v48, v52
    v_add_f32 v48, v48, v52
    ds_write_b32 v15, v48 offset:256
    v_permlane16_swap_b32 v56, v60
    v_add_f32 v56, v56, v60
    ds_write_b32 v15, v56 offset:512
    v_and_b32 v25, 3, v0
    v_lshlrev_b32 v25, 3, v25
    v_add_u32 v25, 125440, v25
    s_waitcnt lgkmcnt(0)
    s_barrier
    ds_read_b64 v[32:33], v25
    ds_read2st64_b32 v[40:41], v24 offset0:0 offset1:3
    ds_read2st64_b32 v[42:43], v24 offset0:6 offset1:9
    s_mul_i32 s77, s70, 3072
    s_lshl_b32 s78, s71, 4
    s_add_u32 s77, s77, s78
    s_lshl_b32 s78, s72, 10
    s_add_u32 s77, s77, s78
    s_add_u32 s77, s77, s3
    s_add_u32 s77, s77, 32768
    s_lshl_b32 s78, s69, 3
    s_add_u32 s78, s78, s3
    s_add_u32 s78, s78, 45056
    s_cmp_eq_u32 s72, 3
    s_waitcnt lgkmcnt(2)
    v_max_f32_dpp v34, v32, v32 quad_perm:[1,0,3,2] row_mask:0xf bank_mask:0xf
    s_nop 1
    v_max_f32_dpp v34, v34, v34 quad_perm:[2,3,0,1] row_mask:0xf bank_mask:0xf
    v_sub_f32 v32, v32, v34
    v_exp_f32 v32, v32
    s_cbranch_scc1 OML
    s_waitcnt lgkmcnt(0)
    v_mul_f32_dpp v28, v32, v40 quad_perm:[0,0,0,0] row_mask:0xf bank_mask:0xf
    v_mul_f32_dpp v29, v32, v41 quad_perm:[1,1,1,1] row_mask:0xf bank_mask:0xf
    v_mul_f32_dpp v30, v32, v42 quad_perm:[2,2,2,2] row_mask:0xf bank_mask:0xf
    v_fmac_f32_dpp v28, v32, v43 quad_perm:[3,3,3,3] row_mask:0xf bank_mask:0xf
    v_add_f32 v29, v29, v30
    v_add_f32 v28, v28, v29
    s_nop 1
    v_mov_b32_dpp v29, v28 row_shl:1 row_mask:0xf bank_mask:0xf
    v_cvt_pk_bf16_f32 v28, v28, v29
    s_nop 1
    v_mov_b32_dpp v29, v28 row_shl:2 row_mask:0xf bank_mask:0xf
    v_mov_b32_dpp v30, v28 row_shl:4 row_mask:0xf bank_mask:0xf
    v_mov_b32_dpp v31, v28 row_shl:6 row_mask:0xf bank_mask:0xf
    s_mov_b64 exec, s[82:83]
    buffer_store_dwordx4 v[28:31], v1, s[8:11], s77 offen
    s_cmp_eq_u32 s10, 0
    s_cbranch_scc1 SLOW7
BACK7:
    s_mov_b64 exec, -1
ODONE:
    s_cmp_ge_u32 s69, 20
    s_cbranch_scc1 ROLEF
    s_cmp_eq_u32 s74, 0
    s_cbranch_scc1 WLATE
    v_accvgpr_read_b32 v2, a246
    v_accvgpr_read_b32 v3, a247
    v_accvgpr_read_b32 v4, a248
    v_mov_b32 v88, 0
    v_mov_b32 v92, 0
    v_mov_b32 v96, 0
    v_mov_b32 v100, 0
    v_mov_b32 v104, 0
    v_mov_b32 v108, 0
    ds_read_b64_tr_b16 v[40:41], v2 offset:0
    ds_read_b64_tr_b16 v[42:43], v2 offset:256
    ds_read_b64_tr_b16 v[64:65], v2 offset:32
    ds_read_b64_tr_b16 v[66:67], v2 offset:288
    ds_read_b64_tr_b16 v[44:45], v2 offset:2048
    ds_read_b64_tr_b16 v[46:47], v2 offset:2304
    ds_read_b64_tr_b16 v[68:69], v2 offset:2080
    ds_read_b64_tr_b16 v[70:71], v2 offset:2336
    ds_read_b64_tr_b16 v[48:49], v2 offset:4096
    ds_read_b64_tr_b16 v[50:51], v2 offset:4352
    s_cmp_lg_u32 s72, 1
    s_cbranch_scc1 NOOWN0
    v_accvgpr_read_b32 v28, a244
    v_accvgpr_read_b32 v29, a245
    v_max_u32 v30, v28, v29
    v_cmp_eq_u32 vcc, -1, v30
    s_cbranch_vccnz RETRY8
OK8:
    v_lshlrev_b32 v30, 16, v28
    v_and_b32 v28, 0xffff0000, v28
    v_lshlrev_b32 v31, 16, v29
    v_and_b32 v29, 0xffff0000, v29
    v_add_f32 v30, v30, v31
    v_add_f32 v28, v28, v29
    v_mov_b32 v31, v30
    v_mov_b32 v29, v28
    s_nop 0
    v_permlane32_swap_b32 v30, v31
    v_permlane32_swap_b32 v28, v29
    v_add_f32 v30, v30, v31
    v_add_f32 v28, v28, v29
    v_mov_b32 v31, v30
    v_mov_b32 v29, v28
    s_nop 0
    v_permlane16_swap_b32 v30, v31
    v_permlane16_swap_b32 v28, v29
    v_add_f32 v30, v30, v31
    v_add_f32 v28, v28, v29
    v_add_f32 v22, v22, v30
    v_add_f32 v23, v23, v28
    v_cvt_pk_bf16_f32 v28, v22, v23
    s_lshl_b32 s77, s69, 6
    s_add_u32 s77, s77, s3
    s_add_u32 s77, s77, 47872
    v_lshlrev_b32 v32, 2, v0
    v_mov_b32_dpp v29, v28 quad_perm:[1,1,1,1] row_mask:0xf bank_mask:0xf
    v_mov_b32_dpp v30, v28 quad_perm:[2,2,2,2] row_mask:0xf bank_mask:0xf
    v_mov_b32_dpp v31, v28 quad_perm:[3,3,3,3] row_mask:0xf bank_mask:0xf
    s_mov_b32 exec_lo, 0x1111
    s_mov_b32 exec_hi, 0x0
    buffer_store_dwordx4 v[28:31], v32, s[8:11], s77 offen
    s_cmp_eq_u32 s10, 0
    s_cbranch_scc1 SLOW9
BACK9:
    s_mov_b64 exec, -1
NOOWN0:
    v_mov_b32 v25, 0
    v_mov_b32 v27, 0
    v_mov_b32 v37, 0
    v_mov_b32 v39, 0
    s_mov_b32 exec_lo, 0x00ff00ff
    s_mov_b32 exec_hi, 0x00ff00ff
    buffer_load_dwordx4 v[88:91], v3, s[16:19], s3 offen offset:0 sc1
    buffer_load_dwordx4 v[92:95], v3, s[16:19], s3 offen offset:512 sc1
    buffer_load_dwordx4 v[96:99], v3, s[16:19], s3 offen offset:1024 sc1
    buffer_load_dwordx4 v[100:103], v3, s[16:19], s3 offen offset:1536 sc1
    buffer_load_dwordx4 v[104:107], v3, s[16:19], s3 offen offset:2048 sc1
    buffer_load_dwordx4 v[108:111], v3, s[16:19], s3 offen offset:2560 sc1
    s_mov_b32 exec_lo, -1
    s_mov_b32 exec_hi, 0
    buffer_load_dwordx4 v[24:27], v4, s[16:19], s3 offen offset:0 sc1
    buffer_load_dwordx4 v[36:39], v4, s[16:19], s3 offen offset:16 sc1
    s_mov_b64 exec, -1
    ds_read_b64_tr_b16 v[72:73], v2 offset:4128
    ds_read_b64_tr_b16 v[74:75], v2 offset:4384
    ds_read_b64_tr_b16 v[52:53], v2 offset:6144
    ds_read_b64_tr_b16 v[54:55], v2 offset:6400
    ds_read_b64_tr_b16 v[76:77], v2 offset:6176
    ds_read_b64_tr_b16 v[78:79], v2 offset:6432
    ds_read_b64_tr_b16 v[56:57], v2 offset:8192
    ds_read_b64_tr_b16 v[58:59], v2 offset:8448
    ds_read_b64_tr_b16 v[80:81], v2 offset:8224
    ds_read_b64_tr_b16 v[82:83], v2 offset:8480
    ds_read_b64_tr_b16 v[60:61], v2 offset:10240
    ds_read_b64_tr_b16 v[62:63], v2 offset:10496
    ds_read_b64_tr_b16 v[84:85], v2 offset:10272
    ds_read_b64_tr_b16 v[86:87], v2 offset:10528
    v_accvgpr_read_b32 v5, a249
    v_and_b32 v18, 3, v0
    v_lshrrev_b32 v6, 5, v0
    v_lshl_add_u32 v18, v6, 2, v18
    v_mul_u32_u24 v18, 10240, v18
    v_bfe_u32 v6, v0, 3, 2
    v_lshl_add_u32 v18, v6, 4, v18
    v_and_b32 v6, 0xffffff7f, v5
WCHK:
    s_waitcnt vmcnt(0)
    v_max3_u32 v28, v88, v92, v96
    v_max3_u32 v28, v28, v100, v104
    v_max3_u32 v28, v28, v108, v25
    v_max3_u32 v28, v28, v27, v37
    v_max_u32 v28, v28, v39
    v_cmp_eq_u32 vcc, -1, v28
    s_cbranch_vccnz AGAIN10
POLLX10:
    s_waitcnt lgkmcnt(0)
    v_mfma_f32_16x16x32_bf16 v[28:31], v[88:91], v[40:43], 0
    v_mfma_f32_16x16x32_bf16 v[32:35], v[88:91], v[64:67], 0
    v_max3_f32 v88, v24, v26, v36
    v_max_f32 v88, v88, v38
    v_mfma_f32_16x16x32_bf16 v[28:31], v[92:95], v[44:47], v[28:31]
    v_mov_b32 v89, v88
    v_mfma_f32_16x16x32_bf16 v[32:35], v[92:95], v[68:71], v[32:35]
    s_nop 0
    v_permlane16_swap_b32 v88, v89
    v_max_f32 v88, v88, v89
    v_mfma_f32_16x16x32_bf16 v[28:31], v[96:99], v[48:51], v[28:31]
    v_sub_f32 v24, v24, v88
    v_sub_f32 v26, v26, v88
    v_mfma_f32_16x16x32_bf16 v[32:35], v[96:99], v[72:75], v[32:35]
    v_sub_f32 v36, v36, v88
    v_sub_f32 v38, v38, v88
    v_mfma_f32_16x16x32_bf16 v[28:31], v[100:103], v[52:55], v[28:31]
    v_exp_f32 v24, v24
    v_mfma_f32_16x16x32_bf16 v[32:35], v[100:103], v[76:79], v[32:35]
    v_exp_f32 v26, v26
    v_mfma_f32_16x16x32_bf16 v[28:31], v[104:107], v[56:59], v[28:31]
    v_exp_f32 v36, v36
    v_mfma_f32_16x16x32_bf16 v[32:35], v[104:107], v[80:83], v[32:35]
    v_exp_f32 v38, v38
    v_mfma_f32_16x16x32_bf16 v[28:31], v[108:111], v[60:63], v[28:31]
    v_mul_f32 v90, v24, v25
    v_fmac_f32 v90, v26, v27
    v_mfma_f32_16x16x32_bf16 v[32:35], v[108:111], v[84:87], v[32:35]
    v_fmac_f32 v90, v36, v37
    v_fmac_f32 v90, v38, v39
    v_mov_b32 v89, v90
    s_cmp_lg_u32 s72, 0
    s_nop 0
    v_permlane16_swap_b32 v90, v89
    v_add_f32 v90, v90, v89
    v_rcp_f32 v90, v90
    v_mul_f32 v28, v24, v28
    v_mul_f32 v32, v24, v32
    v_fmac_f32 v28, v26, v29
    v_fmac_f32 v32, v26, v33
    v_fmac_f32 v28, v36, v30
    v_fmac_f32 v32, v36, v34
    v_fmac_f32 v28, v38, v31
    v_fmac_f32 v32, v38, v35
    s_nop 1
    v_permlane16_swap_b32 v28, v32
    v_add_f32 v28, v28, v32
    v_mul_f32 v28, v28, v90
    ds_write_b32 v5, v28
    s_waitcnt lgkmcnt(0)
    s_barrier
    s_cbranch_scc1 WNOT0
    ds_read2st64_b32 v[28:29], v6 offset0:0 offset1:1
    ds_read2st64_b32 v[30:31], v6 offset0:2 offset1:3
    s_waitcnt lgkmcnt(1)
    v_add_f32 v28, v28, v29
    s_waitcnt lgkmcnt(0)
    v_add_f32 v30, v30, v31
    v_add_f32 v28, v28, v30
    s_nop 1
    v_mov_b32_dpp v29, v28 row_shl:1 row_mask:0xf bank_mask:0xf
    v_cvt_pk_bf16_f32 v32, v28, v29
    s_nop 1
    v_mov_b32_dpp v28, v32 quad_perm:[0,0,0,0] row_mask:0xf bank_mask:0xf
    v_mov_b32_dpp v29, v32 quad_perm:[2,2,2,2] row_mask:0xf bank_mask:0xf
    s_nop 0
    v_mov_b32_dpp v30, v28 row_shl:4 row_mask:0xf bank_mask:0xf
    v_mov_b32_dpp v31, v29 row_shl:4 row_mask:0xf bank_mask:0xf
    s_mov_b64 exec, s[46:47]
    buffer_store_dwordx4 v[28:31], v18, s[16:19], s80 offen sc1
    s_mov_b64 exec, s[92:93]
    buffer_store_dwordx4 v[28:31], v18, s[8:11], s81 offen
    s_cmp_eq_u32 s10, 0
    s_cbranch_scc1 SLOW11
BACK11:
    s_mov_b64 exec, -1
    s_cmp_lg_u32 s74, 0
    s_cbranch_scc1 W2OK
    v_lshrrev_b32 v38, 2, v0
    v_mul_u32_u24 v38, 1280, v38
    v_and_b32 v39, 3, v0
    v_lshl_add_u32 v39, v39, 4, v38
    s_mul_i32 s77, s68, 245760
    s_lshl_b32 s78, s69, 6
    s_add_u32 s77, s77, s78
    s_mov_b32 m0, 106496
    s_nop 0
    buffer_load_dwordx4 v39, s[32:35], s77 offen lds
    s_add_u32 s77, s77, 20480
    s_mov_b32 m0, 107520
    s_nop 0
    buffer_load_dwordx4 v39, s[32:35], s77 offen lds
    s_add_u32 s77, s77, 20480
    s_mov_b32 m0, 108544
    s_nop 0
    buffer_load_dwordx4 v39, s[32:35], s77 offen lds
    s_add_u32 s77, s77, 20480
    s_mov_b32 m0, 109568
    s_nop 0
    buffer_load_dwordx4 v39, s[32:35], s77 offen lds
    s_add_u32 s77, s77, 20480
    s_mov_b32 m0, 110592
    s_nop 0
    buffer_load_dwordx4 v39, s[32:35], s77 offen lds
    s_add_u32 s77, s77, 20480
    s_mov_b32 m0, 111616
    s_nop 0
    buffer_load_dwordx4 v39, s[32:35], s77 offen lds
    s_add_u32 s77, s77, 20480
    s_mov_b32 m0, 112640
    s_nop 0
    buffer_load_dwordx4 v39, s[32:35], s77 offen lds
    s_add_u32 s77, s77, 20480
    s_mov_b32 m0, 113664
    s_nop 0
    buffer_load_dwordx4 v39, s[32:35], s77 offen lds
    s_add_u32 s77, s77, 20480
    s_mov_b32 m0, 114688
    s_nop 0
    buffer_load_dwordx4 v39, s[32:35], s77 offen lds
    s_add_u32 s77, s77, 20480
    s_mov_b32 m0, 115712
    s_nop 0
    buffer_load_dwordx4 v39, s[32:35], s77 offen lds
    s_add_u32 s77, s77, 20480
    s_mov_b32 m0, 116736
    s_nop 0
    buffer_load_dwordx4 v39, s[32:35], s77 offen lds
    s_add_u32 s77, s77, 20480
    s_mov_b32 m0, 117760
    s_nop 0
    buffer_load_dwordx4 v39, s[32:35], s77 offen lds
    s_add_u32 s77, s77, 20480
    s_waitcnt vmcnt(0)
W2OK:
    v_add_u32 v2, 49152, v2
    ds_read_b64_tr_b16 v[40:41], v2 offset:0
    ds_read_b64_tr_b16 v[42:43], v2 offset:256
    ds_read_b64_tr_b16 v[64:65], v2 offset:32
    ds_read_b64_tr_b16 v[66:67], v2 offset:288
    ds_read_b64_tr_b16 v[44:45], v2 offset:2048
    ds_read_b64_tr_b16 v[46:47], v2 offset:2304
    ds_read_b64_tr_b16 v[68:69], v2 offset:2080
    ds_read_b64_tr_b16 v[70:71], v2 offset:2336
    ds_read_b64_tr_b16 v[48:49], v2 offset:4096
    ds_read_b64_tr_b16 v[50:51], v2 offset:4352
    ds_read_b64_tr_b16 v[72:73], v2 offset:4128
    ds_read_b64_tr_b16 v[74:75], v2 offset:4384
    ds_read_b64_tr_b16 v[52:53], v2 offset:6144
    ds_read_b64_tr_b16 v[54:55], v2 offset:6400
    ds_read_b64_tr_b16 v[76:77], v2 offset:6176
    ds_read_b64_tr_b16 v[78:79], v2 offset:6432
    ds_read_b64_tr_b16 v[56:57], v2 offset:8192
    ds_read_b64_tr_b16 v[58:59], v2 offset:8448
    ds_read_b64_tr_b16 v[80:81], v2 offset:8224
    ds_read_b64_tr_b16 v[82:83], v2 offset:8480
    ds_read_b64_tr_b16 v[60:61], v2 offset:10240
    ds_read_b64_tr_b16 v[62:63], v2 offset:10496
    ds_read_b64_tr_b16 v[84:85], v2 offset:10272
    ds_read_b64_tr_b16 v[86:87], v2 offset:10528
    v_mov_b32 v100, 0
    v_mov_b32 v101, 0
    v_mov_b32 v104, 0
    v_mov_b32 v105, 0
    s_add_u32 s96, s80, 81920
    s_add_u32 s97, s81, 1280
STB:
    s_mul_i32 s77, s72, 48
    v_min_u32 v6, 47, v0
    v_add_u32 v6, s77, v6
    v_lshlrev_b32 v4, 4, v6
    v_add_u32 v5, 3072, v4
    v_add_u32 v108, 6400, v4
    v_cmp_le_u32 vcc, 48, v0
    v_mov_b32 v24, 6144
    v_mov_b32 v25, 6160
    v_cndmask_b32 v4, v4, v24, vcc
    v_cndmask_b32 v5, v5, v25, vcc
    v_lshrrev_b32 v24, 4, v6
    v_lshlrev_b32 v24, 5, v24
    v_bfe_u32 v25, v6, 1, 1
    v_lshl_add_u32 v24, v25, 4, v24
    v_bfe_u32 v25, v6, 2, 2
    v_lshl_add_u32 v24, v25, 2, v24
    v_and_b32 v25, 1, v6
    v_lshl_add_u32 v24, v25, 1, v24
    v_add_u32 v24, 118784, v24
    v_mov_b32 v25, 119168
    v_cndmask_b32 v6, v24, v25, vcc
    v_mov_b32 v109, 0x3727c5ac
    v_mov_b32 v110, 0x3acccccd
    s_add_u32 s79, s3, 50432
    v_accvgpr_read_b32 v2, a250
    v_accvgpr_read_b32 v3, a251
    s_mov_b32 s76, 1
    s_cmp_eq_u32 s74, 0
    s_cbranch_scc1 GPRE
GP1:
    buffer_load_dwordx4 v[24:27], v4, s[16:19], s79 offen sc1
    buffer_load_dwordx4 v[28:31], v5, s[16:19], s79 offen sc1
    s_waitcnt vmcnt(0)
    v_add_f32 v24, v24, v25
    v_add_f32 v28, v28, v29
    v_add_f32 v26, v26, v27
    v_add_f32 v30, v30, v31
    v_add_f32 v28, v28, v30
    v_add_f32 v24, v24, v26
    v_cmp_u_f32 vcc, v24, v28
    s_cbranch_vccnz GA1
GPX:
    v_readlane_b32 s77, v28, 48
    v_readlane_b32 s78, v24, 48
    s_cmp_lg_u32 s72, 0
    v_mul_f32 v25, s77, v110
    v_fma_f32 v26, s78, v110, v109
    v_fma_f32 v26, -v25, v25, v26
    v_add_f32 v25, 1.0, v25
    v_max_f32 v26, v26, v109
    v_fma_f32 v24, -v25, v2, v24
    v_rsq_f32 v27, v26
    v_mul_f32 v29, 0xbfb8aa3b, v24
    v_mul_f32 v29, v29, v27
    v_exp_f32 v29, v29
    v_fma_f32 v28, -v25, v3, v28
    v_fma_f32 v29, v29, v26, v26
    v_rcp_f32 v29, v29
    v_mul_f32 v28, v28, v24
    v_mul_f32 v28, v28, v29
    v_cvt_pk_bf16_f32 v28, v28, v28
    ds_write_b16 v6, v28
    v_accvgpr_write_b32 a250, v2
    v_accvgpr_write_b32 a251, v3
    s_waitcnt lgkmcnt(0)
    s_barrier
    s_cbranch_scc1 STBX
    ds_read_b128 v[88:91], v13 offset:0
    ds_read_b128 v[92:95], v13 offset:128
    ds_read_b128 v[96:99], v13 offset:256
    s_waitcnt lgkmcnt(2)
    v_smfmac_f32_16x16x64_bf16 v[100:103], v[88:91], v[40:47], v14
    v_smfmac_f32_16x16x64_bf16 v[104:107], v[88:91], v[64:71], v14
    s_waitcnt lgkmcnt(1)
    v_smfmac_f32_16x16x64_bf16 v[100:103], v[92:95], v[48:55], v14
    v_smfmac_f32_16x16x64_bf16 v[104:107], v[92:95], v[72:79], v14
    s_waitcnt lgkmcnt(0)
    v_smfmac_f32_16x16x64_bf16 v[100:103], v[96:99], v[56:63], v14
    v_smfmac_f32_16x16x64_bf16 v[104:107], v[96:99], v[80:87], v14
    s_nop 6
    v_add_f32 v28, v100, v101
    s_nop 1
    v_add_f32_dpp v28, v104, v105 quad_perm:[0,1,2,3] row_mask:0xa bank_mask:0xf
    s_nop 1
    v_mov_b32_dpp v29, v28 row_shl:1 row_mask:0xf bank_mask:0xf
    v_cvt_pk_bf16_f32 v32, v28, v29
    s_nop 1
    v_mov_b32_dpp v28, v32 quad_perm:[0,0,0,0] row_mask:0xf bank_mask:0xf
    v_mov_b32_dpp v29, v32 quad_perm:[2,2,2,2] row_mask:0xf bank_mask:0xf
    s_nop 0
    v_mov_b32_dpp v30, v28 row_shl:4 row_mask:0xf bank_mask:0xf
    v_mov_b32_dpp v31, v29 row_shl:4 row_mask:0xf bank_mask:0xf
    s_mov_b64 exec, s[48:49]
    buffer_store_dwordx4 v[28:31], v18, s[16:19], s96 offen sc1
    s_mov_b64 exec, s[92:93]
    buffer_store_dwordx4 v[28:31], v18, s[8:11], s97 offen
    s_cmp_eq_u32 s10, 0
    s_cbranch_scc1 SLOW12
BACK12:
    s_mov_b64 exec, -1
    s_branch NEXT
AGAIN3:
    s_add_u32 s76, s76, 1
    s_cmp_lt_u32 s76, 32768
    s_cbranch_scc1 POLL3
    s_branch POLLX3
BR4:
    s_cmp_ge_u32 s76, 32768
    s_cbranch_scc1 BX4
BL4:
    s_mov_b64 exec, s[86:87]
    v_cmp_eq_u32 vcc, -1, v80
    s_nop 0
    s_mov_b64 exec, vcc
    s_cbranch_execz BS4_0
    buffer_load_dwordx4 v[80:83], v8, s[16:19], 0 offen sc1
BS4_0:
    s_mov_b64 exec, s[86:87]
    v_cmp_eq_u32 vcc, -1, v84
    s_nop 0
    s_mov_b64 exec, vcc
    s_cbranch_execz BS4_1
    buffer_load_dwordx4 v[84:87], v9, s[16:19], 0 offen sc1
BS4_1:
    s_mov_b64 exec, s[86:87]
    s_add_u32 s76, s76, 1
    s_cmp_ge_u32 s76, 32768
    s_waitcnt vmcnt(0)
    v_max_u32 v24, v80, v84
    v_cmp_eq_u32 vcc, -1, v24
    s_cbranch_vccz BW4
    s_cbranch_scc0 BL4
    s_branch BW4
AGAIN6:
    s_add_u32 s76, s76, 1
    s_cmp_lt_u32 s76, 32768
    s_cbranch_scc1 POLL6
    s_branch POLLX6
OML:
    v_mul_f32 v35, v32, v33
    s_nop 1
    v_add_f32_dpp v35, v35, v35 quad_perm:[1,0,3,2] row_mask:0xf bank_mask:0xf
    s_nop 1
    v_add_f32_dpp v35, v35, v35 quad_perm:[2,3,0,1] row_mask:0xf bank_mask:0xf
    s_mov_b64 exec, 1
    buffer_store_dwordx2 v[34:35], v1, s[8:11], s78 offen
    s_cmp_eq_u32 s10, 0
    s_cbranch_scc1 SLOW13
BACK13:
    s_mov_b64 exec, -1
    s_waitcnt lgkmcnt(0)
    s_branch ODONE
WLATE:
    v_lshrrev_b32 v38, 2, v0
    v_mul_u32_u24 v38, 1280, v38
    v_and_b32 v39, 3, v0
    v_lshl_add_u32 v39, v39, 4, v38
    s_mov_b32 m0, s67
    s_add_u32 s67, s67, 1024
    buffer_load_dwordx4 v39, s[24:27], s66 offen  lds
    s_add_u32 s66, s66, 20480
    s_mov_b32 m0, s67
    s_add_u32 s67, s67, 1024
    buffer_load_dwordx4 v39, s[24:27], s66 offen  lds
    s_add_u32 s66, s66, 20480
    s_mov_b32 m0, s67
    s_add_u32 s67, s67, 1024
    buffer_load_dwordx4 v39, s[24:27], s66 offen  lds
    s_add_u32 s66, s66, 20480
    s_mov_b32 m0, s67
    s_add_u32 s67, s67, 1024
    buffer_load_dwordx4 v39, s[24:27], s66 offen  lds
    s_add_u32 s66, s66, 20480
    s_mov_b32 m0, s67
    s_add_u32 s67, s67, 1024
    buffer_load_dwordx4 v39, s[24:27], s66 offen  lds
    s_add_u32 s66, s66, 20480
    s_mov_b32 m0, s67
    s_add_u32 s67, s67, 1024
    buffer_load_dwordx4 v39, s[24:27], s66 offen  lds
    s_add_u32 s66, s66, 20480
    s_add_u32 s77, s3, 1638400
    buffer_store_dword v7, v10, s[8:11], s77 offen
    s_cmp_eq_u32 s10, 0
    s_cbranch_scc1 SLOW14
BACK14:
    v_accvgpr_read_b32 v2, a246
    v_accvgpr_read_b32 v3, a247
    v_accvgpr_read_b32 v4, a248
    v_mov_b32 v88, 0
    v_mov_b32 v92, 0
    v_mov_b32 v96, 0
    v_mov_b32 v100, 0
    v_mov_b32 v104, 0
    v_mov_b32 v108, 0
    v_mov_b32 v25, 0
    v_mov_b32 v27, 0
    v_mov_b32 v37, 0
    v_mov_b32 v39, 0
    s_mov_b32 exec_lo, 0x00ff00ff
    s_mov_b32 exec_hi, 0x00ff00ff
    buffer_load_dwordx4 v[88:91], v3, s[16:19], s3 offen offset:0 sc1
    buffer_load_dwordx4 v[92:95], v3, s[16:19], s3 offen offset:512 sc1
    buffer_load_dwordx4 v[96:99], v3, s[16:19], s3 offen offset:1024 sc1
    buffer_load_dwordx4 v[100:103], v3, s[16:19], s3 offen offset:1536 sc1
    buffer_load_dwordx4 v[104:107], v3, s[16:19], s3 offen offset:2048 sc1
    buffer_load_dwordx4 v[108:111], v3, s[16:19], s3 offen offset:2560 sc1
    s_mov_b32 exec_lo, -1
    s_mov_b32 exec_hi, 0
    buffer_load_dwordx4 v[24:27], v4, s[16:19], s3 offen offset:0 sc1
    buffer_load_dwordx4 v[36:39], v4, s[16:19], s3 offen offset:16 sc1
    s_mov_b64 exec, -1
    s_waitcnt vmcnt(8)
    ds_read_b64_tr_b16 v[40:41], v2 offset:0
    ds_read_b64_tr_b16 v[42:43], v2 offset:256
    ds_read_b64_tr_b16 v[64:65], v2 offset:32
    ds_read_b64_tr_b16 v[66:67], v2 offset:288
    ds_read_b64_tr_b16 v[44:45], v2 offset:2048
    ds_read_b64_tr_b16 v[46:47], v2 offset:2304
    ds_read_b64_tr_b16 v[68:69], v2 offset:2080
    ds_read_b64_tr_b16 v[70:71], v2 offset:2336
    ds_read_b64_tr_b16 v[48:49], v2 offset:4096
    ds_read_b64_tr_b16 v[50:51], v2 offset:4352
    ds_read_b64_tr_b16 v[72:73], v2 offset:4128
    ds_read_b64_tr_b16 v[74:75], v2 offset:4384
    ds_read_b64_tr_b16 v[52:53], v2 offset:6144
    ds_read_b64_tr_b16 v[54:55], v2 offset:6400
    ds_read_b64_tr_b16 v[76:77], v2 offset:6176
    ds_read_b64_tr_b16 v[78:79], v2 offset:6432
    ds_read_b64_tr_b16 v[56:57], v2 offset:8192
    ds_read_b64_tr_b16 v[58:59], v2 offset:8448
    ds_read_b64_tr_b16 v[80:81], v2 offset:8224
    ds_read_b64_tr_b16 v[82:83], v2 offset:8480
    ds_read_b64_tr_b16 v[60:61], v2 offset:10240
    ds_read_b64_tr_b16 v[62:63], v2 offset:10496
    ds_read_b64_tr_b16 v[84:85], v2 offset:10272
    ds_read_b64_tr_b16 v[86:87], v2 offset:10528
    v_accvgpr_read_b32 v5, a249
    v_and_b32 v18, 3, v0
    v_lshrrev_b32 v6, 5, v0
    v_lshl_add_u32 v18, v6, 2, v18
    v_mul_u32_u24 v18, 10240, v18
    v_bfe_u32 v6, v0, 3, 2
    v_lshl_add_u32 v18, v6, 4, v18
    v_and_b32 v6, 0xffffff7f, v5
    s_branch WCHK
AGAIN10:
    s_mov_b64 s[94:95], exec
    s_mov_b32 s76, 1
AG210:
    v_max3_u32 v28, v88, v92, v96
    v_max3_u32 v28, v28, v100, v104
    v_max_u32 v28, v28, v108
    v_cmp_eq_u32 vcc, -1, v28
    s_nop 0
    s_mov_b64 exec, vcc
    s_cbranch_execz AG310_0
    buffer_load_dwordx4 v[88:91], v3, s[16:19], s3 offen offset:0 sc1
    buffer_load_dwordx4 v[92:95], v3, s[16:19], s3 offen offset:512 sc1
    buffer_load_dwordx4 v[96:99], v3, s[16:19], s3 offen offset:1024 sc1
    buffer_load_dwordx4 v[100:103], v3, s[16:19], s3 offen offset:1536 sc1
    buffer_load_dwordx4 v[104:107], v3, s[16:19], s3 offen offset:2048 sc1
    buffer_load_dwordx4 v[108:111], v3, s[16:19], s3 offen offset:2560 sc1
AG310_0:
    s_mov_b64 exec, s[94:95]
    v_max3_u32 v28, v25, v27, v37
    v_max_u32 v28, v28, v39
    v_cmp_eq_u32 vcc, -1, v28
    s_nop 0
    s_mov_b64 exec, vcc
    s_cbranch_execz AG310_1
    buffer_load_dwordx4 v[24:27], v4, s[16:19], s3 offen offset:0 sc1
    buffer_load_dwordx4 v[36:39], v4, s[16:19], s3 offen offset:16 sc1
AG310_1:
    s_mov_b64 exec, s[94:95]
    s_add_u32 s76, s76, 1
    s_cmp_ge_u32 s76, 32768
    s_waitcnt vmcnt(0)
    v_max3_u32 v28, v88, v92, v96
    v_max3_u32 v28, v28, v100, v104
    v_max3_u32 v28, v28, v108, v25
    v_max3_u32 v28, v28, v27, v37
    v_max_u32 v28, v28, v39
    v_cmp_eq_u32 vcc, -1, v28
    s_cbranch_vccz POLLX10
    s_cbranch_scc0 AG210
    s_branch POLLX10
GA1:
    s_add_u32 s76, s76, 1
    s_cmp_lt_u32 s76, 32768
    s_cbranch_scc1 GP1
    s_branch GPX
GPRE:
    s_add_u32 s77, s3, 1638400
    s_add_u32 s78, s77, 4096
    buffer_load_dwordx4 v[24:27], v11, s[16:19], s77 offen sc1
    buffer_load_dwordx4 v[28:31], v11, s[16:19], s78 offen sc1
GP0:
    buffer_load_dwordx4 v[24:27], v4, s[16:19], s79 offen sc1
    buffer_load_dwordx4 v[28:31], v5, s[16:19], s79 offen sc1
    buffer_load_dwordx4 v[32:35], v108, s[16:19], s79 offen sc1
    buffer_load_dwordx4 v[36:39], v108, s[16:19], s79 offen offset:3072 sc1
    s_add_u32 s76, s76, 1
    s_cmp_ge_u32 s76, 32768
    s_waitcnt vmcnt(2)
    v_add_f32 v24, v24, v25
    v_add_f32 v28, v28, v29
    v_add_f32 v26, v26, v27
    v_add_f32 v30, v30, v31
    v_add_f32 v28, v28, v30
    v_add_f32 v24, v24, v26
    v_cmp_u_f32 s[94:95], v24, v28
    s_waitcnt vmcnt(0)
    v_add_f32 v2, v32, v33
    v_add_f32 v3, v36, v37
    v_add_f32 v34, v34, v35
    v_add_f32 v38, v38, v39
    v_add_f32 v2, v2, v34
    v_add_f32 v3, v3, v38
    v_cmp_u_f32 vcc, v2, v3
    s_cbranch_scc1 GPX
    s_or_b64 vcc, vcc, s[94:95]
    s_cbranch_scc1 GP0
    s_branch GPX
WNOT0:
    s_cmp_eq_u32 s72, 1
    s_cbranch_scc1 WOWN
    s_cmp_lg_u32 s74, 0
    s_cbranch_scc1 STB
    s_cmp_eq_u32 s72, 3
    s_cbranch_scc1 WLC
    v_mov_b32 v52, -1
    v_mov_b32 v53, -1
    v_mov_b32 v54, -1
    v_mov_b32 v55, -1
    s_add_u32 s77, s80, 819200
    s_add_u32 s7, s77, 81920
    s_sleep 8
    s_mov_b64 exec, s[44:45]
    buffer_store_dwordx4 v[52:55], v18, s[16:19], s77 offen sc1
    s_mov_b64 exec, s[92:93]
    buffer_store_dwordx4 v[52:55], v18, s[16:19], s7 offen sc1
    s_mov_b64 exec, -1
    s_branch STB
WLC:
    s_mul_i32 s77, s69, 1216
    s_add_u32 s78, s3, 851968
    v_add_u32 v48, s77, v1
    v_min_u32 v48, 24048, v48
    s_add_u32 s77, s77, 1024
    v_add_u32 v49, s77, v1
    v_min_u32 v49, 24048, v49
    s_add_u32 s77, s77, 1024
    buffer_load_dwordx4 a[240:243], v48, s[16:19], s78 offen sc1
    buffer_load_dwordx4 a[240:243], v49, s[16:19], s78 offen sc1
    v_mov_b32 v52, -1
    v_mov_b32 v53, -1
    v_mov_b32 v54, -1
    v_mov_b32 v55, -1
    s_waitcnt vmcnt(0)
    buffer_store_dwordx4 v[52:55], v48, s[8:11], s78 offen
    s_cmp_eq_u32 s10, 0
    s_cbranch_scc1 SLOW15
BACK15:
    buffer_store_dwordx4 v[52:55], v49, s[8:11], s78 offen
    s_cmp_eq_u32 s10, 0
    s_cbranch_scc1 SLOW16
BACK16:
    s_branch STB
WOWN:
    v_and_b32 v25, 15, v0
    v_lshrrev_b32 v26, 4, v0
    s_mul_i32 s7, s68, 10240
    s_cmp_eq_u32 s74, 0
    s_cselect_b32 s7, 0, s7
    s_add_u32 s7, s7, 655360
    v_mul_u32_u24 v37, 1280, v26
    v_add_u32 v37, s7, v37
    s_mul_i32 s7, s68, 81920
    s_add_u32 s7, s7, 45312
    v_mov_b32 v38, s7
    v_cmp_eq_u32 vcc, s68, v26
    s_nop 1
    v_cndmask_b32 v37, v37, v38, vcc
    v_add_u32 v39, 4, v26
    s_mul_i32 s7, s68, 10240
    s_cmp_eq_u32 s74, 0
    s_cselect_b32 s7, 0, s7
    s_add_u32 s7, s7, 655360
    v_mul_u32_u24 v38, 1280, v39
    v_add_u32 v38, s7, v38
    s_mul_i32 s7, s68, 81920
    s_add_u32 s7, s7, 45312
    v_mov_b32 v28, s7
    v_cmp_eq_u32 vcc, s68, v39
    s_nop 1
    v_cndmask_b32 v38, v38, v28, vcc
    s_lshl_b32 s77, s69, 6
    s_add_u32 s77, s77, s74
    v_lshl_add_u32 v37, v25, 2, v37
    v_lshl_add_u32 v38, v25, 2, v38
    s_sleep 16
    s_mov_b32 s76, 1
POLL17:
    buffer_load_dword v28, v37, s[16:19], s77 offen sc1
    buffer_load_dword v29, v38, s[16:19], s77 offen sc1
POLLW17:
    s_waitcnt vmcnt(0)
    v_max_u32 v30, v28, v29
    v_cmp_eq_u32 vcc, -1, v30
    s_cbranch_vccnz AGAIN17
POLLX17:
    v_lshlrev_b32 v30, 16, v28
    v_and_b32 v28, 0xffff0000, v28
    v_lshlrev_b32 v31, 16, v29
    v_and_b32 v29, 0xffff0000, v29
    v_add_f32 v30, v30, v31
    v_add_f32 v28, v28, v29
    v_mov_b32 v31, v30
    v_mov_b32 v29, v28
    s_nop 0
    v_permlane32_swap_b32 v30, v31
    v_permlane32_swap_b32 v28, v29
    v_add_f32 v30, v30, v31
    v_add_f32 v28, v28, v29
    v_mov_b32 v31, v30
    v_mov_b32 v29, v28
    s_nop 0
    v_permlane16_swap_b32 v30, v31
    v_permlane16_swap_b32 v28, v29
    v_add_f32 v30, v30, v31
    v_add_f32 v28, v28, v29
    v_add_f32 v22, v22, v30
    v_add_f32 v23, v23, v28
    v_cvt_pk_bf16_f32 v28, v22, v23
    s_cmp_lg_u32 s74, 0
    s_cbranch_scc1 STB
    s_lshl_b32 s77, s69, 6
    s_add_u32 s77, s77, s3
    s_add_u32 s77, s77, 49152
    v_lshlrev_b32 v32, 2, v0
    v_mov_b32_dpp v29, v28 quad_perm:[1,1,1,1] row_mask:0xf bank_mask:0xf
    v_mov_b32_dpp v30, v28 quad_perm:[2,2,2,2] row_mask:0xf bank_mask:0xf
    v_mov_b32_dpp v31, v28 quad_perm:[3,3,3,3] row_mask:0xf bank_mask:0xf
    s_mov_b32 exec_lo, 0x1111
    s_mov_b32 exec_hi, 0x0
    buffer_store_dwordx4 v[28:31], v32, s[8:11], s77 offen
    s_cmp_eq_u32 s10, 0
    s_cbranch_scc1 SLOW18
BACK18:
    s_mov_b64 exec, -1
    s_branch STB
STBX:
    s_cmp_lg_u32 s72, 1
    s_cbranch_scc1 NEXT
    s_cmp_eq_u32 s74, 0
    s_cbranch_scc1 NEXT
FINAL:
    s_cmp_lg_u32 s68, 0
    s_cbranch_scc1 DONE
    s_lshl_b32 s77, s69, 6
    v_lshlrev_b32 v37, 2, v0
    s_add_u32 s79, s77, s3
    s_add_u32 s79, s79, 46592
    s_mov_b64 exec, 15
    s_mov_b32 s76, 1
POLL19:
    buffer_load_dword v28, v1, s[16:19], s79 offen sc1
POLLW19:
    s_waitcnt vmcnt(0)
    v_cmp_eq_u32 vcc, -1, v28
    s_cbranch_vccnz AGAIN19
POLLX19:
    s_mov_b64 exec, -1
    s_mov_b32 s76, 1
POLL20:
    buffer_load_dword v28, v20, s[16:19], s74 offen sc1
    buffer_load_dword v29, v21, s[16:19], s74 offen sc1
POLLW20:
    s_waitcnt vmcnt(0)
    v_max_u32 v30, v28, v29
    v_cmp_eq_u32 vcc, -1, v30
    s_cbranch_vccnz AGAIN20
POLLX20:
    v_lshlrev_b32 v30, 16, v28
    v_and_b32 v28, 0xffff0000, v28
    v_lshlrev_b32 v31, 16, v29
    v_and_b32 v29, 0xffff0000, v29
    v_add_f32 v30, v30, v31
    v_add_f32 v28, v28, v29
    v_mov_b32 v31, v30
    v_mov_b32 v29, v28
    s_nop 0
    v_permlane32_swap_b32 v30, v31
    v_permlane32_swap_b32 v28, v29
    v_add_f32 v30, v30, v31
    v_add_f32 v28, v28, v29
    v_mov_b32 v31, v30
    v_mov_b32 v29, v28
    s_nop 0
    v_permlane16_swap_b32 v30, v31
    v_permlane16_swap_b32 v28, v29
    v_add_f32 v30, v30, v31
    v_add_f32 v28, v28, v29
    v_add_f32 v22, v22, v30
    v_add_f32 v23, v23, v28
    v_cvt_pk_bf16_f32 v28, v22, v23
    s_mov_b32 exec_lo, 0xffff
    s_mov_b32 exec_hi, 0x0
    buffer_store_dword v28, v37, s[40:43], s77 offen
    s_mov_b64 exec, -1
    s_endpgm
AGAIN17:
    s_sleep 2
    s_add_u32 s76, s76, 1
    s_cmp_lt_u32 s76, 32768
    s_cbranch_scc1 POLL17
    s_branch POLLX17
AGAIN19:
    s_add_u32 s76, s76, 1
    s_cmp_lt_u32 s76, 32768
    s_cbranch_scc1 POLL19
    s_branch POLLX19
AGAIN20:
    s_add_u32 s76, s76, 1
    s_cmp_lt_u32 s76, 32768
    s_cbranch_scc1 POLL20
    s_branch POLLX20
ROLEF:
    v_and_b32 v25, 15, v0
    v_lshrrev_b32 v26, 4, v0
    v_bfe_u32 v27, v0, 2, 2
    v_and_b32 v36, 3, v0
    s_cmp_lg_u32 s74, 0
    s_cbranch_scc1 FW
    v_lshrrev_b32 v38, 3, v0
    v_mul_u32_u24 v38, 3072, v38
    v_and_b32 v39, 7, v0
    v_lshl_add_u32 v38, v39, 4, v38
    v_bfe_u32 v39, v0, 4, 1
    v_lshlrev_b32 v39, 5, v39
    v_xor_b32 v38, v38, v39
    v_xor_b32 v39, 64, v38
    s_mov_b32 m0, s67
    s_add_u32 s67, s67, 1024
    buffer_load_dwordx4 v38, s[36:39], s66 offen nt lds
    s_add_u32 s66, s66, 24576
    s_mov_b32 m0, s67
    s_add_u32 s67, s67, 1024
    buffer_load_dwordx4 v39, s[36:39], s66 offen nt lds
    s_add_u32 s66, s66, 24576
    s_mov_b32 m0, s67
    s_add_u32 s67, s67, 1024
    buffer_load_dwordx4 v38, s[36:39], s66 offen nt lds
    s_add_u32 s66, s66, 24576
    s_mov_b32 m0, s67
    s_add_u32 s67, s67, 1024
    buffer_load_dwordx4 v39, s[36:39], s66 offen nt lds
    s_add_u32 s66, s66, 24576
    s_mov_b32 m0, s67
    s_add_u32 s67, s67, 1024
    buffer_load_dwordx4 v38, s[36:39], s66 offen nt lds
    s_add_u32 s66, s66, 24576
    s_mov_b32 m0, s67
    s_add_u32 s67, s67, 1024
    buffer_load_dwordx4 v39, s[36:39], s66 offen nt lds
    s_add_u32 s66, s66, 24576
    s_mov_b32 m0, s67
    s_add_u32 s67, s67, 1024
    buffer_load_dwordx4 v38, s[36:39], s66 offen nt lds
    s_add_u32 s66, s66, 24576
    s_mov_b32 m0, s67
    s_add_u32 s67, s67, 1024
    buffer_load_dwordx4 v39, s[36:39], s66 offen nt lds
    s_add_u32 s66, s66, 24576
    s_mov_b32 m0, s67
    s_add_u32 s67, s67, 1024
    buffer_load_dwordx4 v38, s[36:39], s66 offen nt lds
    s_add_u32 s66, s66, 24576
    s_mov_b32 m0, s67
    s_add_u32 s67, s67, 1024
    buffer_load_dwordx4 v39, s[36:39], s66 offen nt lds
    s_add_u32 s66, s66, 24576
    s_sub_u32 s96, s69, 20
    s_lshl_b32 s96, s96, 2
    s_add_u32 s96, s96, s72
    s_mul_i32 s96, s96, 688
    v_add_u32 v21, s96, v1
    v_min_u32 v21, 32752, v21
    s_add_u32 s97, s3, 819200
    buffer_load_dwordx4 a[240:243], v21, s[16:19], s97 offen sc1
    s_add_u32 s77, s3, 1638400
    buffer_store_dword v7, v10, s[8:11], s77 offen
    s_cmp_eq_u32 s10, 0
    s_cbranch_scc1 SLOW21
BACK21:
FW:
    s_lshl_b32 s77, s72, 5
    v_lshl_add_u32 v80, v36, 3, s77
    v_lshrrev_b32 v37, 1, v27
    v_and_b32 v38, 1, v26
    v_lshl_add_u32 v37, v38, 1, v37
    v_lshlrev_b32 v37, 5, v37
    v_xor_b32 v80, v80, v37
    v_lshl_add_u32 v37, v26, 3, v27
    v_lshl_add_u32 v80, v37, 7, v80
    v_add_u32 v80, 57344, v80
    s_sub_u32 s79, s69, 20
    s_and_b32 s7, s79, 12
    s_add_u32 s7, s7, s72
    s_lshl_b32 s78, s7, 8
    v_lshl_add_u32 v83, v25, 4, s78
    v_mul_u32_u24 v37, 3072, v26
    v_add_u32 v84, v83, v37
    v_add_u32 v83, 6400, v83
    v_lshlrev_b32 v37, 4, v26
    v_add_u32 v37, 6112, v37
    v_or_b32 v38, s7, v25
    v_mov_b32 v39, 1879048176
    v_cmp_eq_u32 vcc, 0, v38
    s_nop 1
    v_cndmask_b32 v37, v39, v37, vcc
    v_cmp_le_u32 vcc, 2, v26
    s_nop 1
    v_cndmask_b32 v84, v84, v37, vcc
    s_and_b32 s79, s79, 3
    s_lshl_b32 s78, s79, 2
    s_add_u32 s78, s78, s3
    s_add_u32 s78, s78, 50432
    s_mul_i32 s79, s79, 320
    v_cmp_eq_u32 vcc, 12, v25
    v_mov_b32 v38, 0x3f803f80
    s_nop 0
    v_cndmask_b32 v88, 0, v38, vcc
    v_mov_b32 v89, v88
    v_mov_b32 v90, v88
    v_mov_b32 v91, v88
    v_mov_b32 v92, v88
    v_mov_b32 v93, v88
    v_mov_b32 v94, v88
    v_mov_b32 v95, v88
    v_mov_b32 v96, v88
    v_mov_b32 v97, v88
    v_mov_b32 v98, v88
    v_mov_b32 v99, v88
    v_mov_b32 v100, v88
    v_mov_b32 v101, v88
    v_mov_b32 v102, v88
    v_mov_b32 v103, v88
    v_mov_b32 v104, v88
    v_mov_b32 v105, v88
    v_mov_b32 v106, v88
    v_mov_b32 v107, v88
    s_mul_i32 s77, s72, 6656
    v_mul_u32_u24 v6, 336, v25
    v_lshl_add_u32 v6, v26, 4, v6
    v_add_u32 v6, s77, v6
    v_mul_u32_u24 v37, 52, v0
    v_lshrrev_b32 v37, 10, v37
    v_lshl_add_u32 v87, v37, 4, v1
    v_add_u32 v87, s77, v87
    v_mul_u32_u24 v27, 320, v37
    v_sub_u32 v27, v1, v27
    s_mul_i32 s7, s68, 10240
    s_cmp_eq_u32 s74, 0
    s_cselect_b32 s7, 0, s7
    s_add_u32 s7, s7, 655360
    v_mul_u32_u24 v86, 1280, v37
    v_add_u32 v86, s7, v86
    s_mul_i32 s7, s68, 81920
    s_add_u32 s7, s7, 45312
    v_mov_b32 v38, s7
    v_cmp_eq_u32 vcc, s68, v37
    s_nop 1
    v_cndmask_b32 v86, v86, v38, vcc
    v_add_u32 v38, 2560, v38
    v_cmp_le_u32 vcc, 8, v37
    s_nop 1
    v_cndmask_b32 v86, v86, v38, vcc
    v_add_u32 v86, v86, v27
    v_add_u32 v37, 3, v37
    s_mul_i32 s7, s68, 10240
    s_cmp_eq_u32 s74, 0
    s_cselect_b32 s7, 0, s7
    s_add_u32 s7, s7, 655360
    v_mul_u32_u24 v18, 1280, v37
    v_add_u32 v18, s7, v18
    s_mul_i32 s7, s68, 81920
    s_add_u32 s7, s7, 45312
    v_mov_b32 v38, s7
    v_cmp_eq_u32 vcc, s68, v37
    s_nop 1
    v_cndmask_b32 v18, v18, v38, vcc
    v_add_u32 v38, 2560, v38
    v_cmp_le_u32 vcc, 8, v37
    s_nop 1
    v_cndmask_b32 v18, v18, v38, vcc
    v_add_u32 v18, v18, v27
    v_add_u32 v37, 3, v37
    s_mul_i32 s7, s68, 10240
    s_cmp_eq_u32 s74, 0
    s_cselect_b32 s7, 0, s7
    s_add_u32 s7, s7, 655360
    v_mul_u32_u24 v20, 1280, v37
    v_add_u32 v20, s7, v20
    s_mul_i32 s7, s68, 81920
    s_add_u32 s7, s7, 45312
    v_mov_b32 v38, s7
    v_cmp_eq_u32 vcc, s68, v37
    s_nop 1
    v_cndmask_b32 v20, v20, v38, vcc
    v_add_u32 v38, 2560, v38
    v_cmp_le_u32 vcc, 8, v37
    s_nop 1
    v_cndmask_b32 v20, v20, v38, vcc
    v_add_u32 v20, v20, v27
    s_add_u32 s77, s79, s74
    s_add_u32 s79, s79, s3
    s_add_u32 s79, s79, 45312
    s_cmp_lg_u32 s74, 0
    s_cbranch_scc1 FW1
    v_mov_b32 v24, -1
    v_mov_b32 v25, -1
    v_mov_b32 v26, -1
    v_mov_b32 v27, -1
    s_waitcnt vmcnt(0)
    buffer_store_dwordx4 v[24:27], v21, s[8:11], s97 offen
    s_cmp_eq_u32 s10, 0
    s_cbranch_scc1 SLOW22
BACK22:
    s_barrier
FW1:
    ds_read_b64_tr_b16 v[40:41], v80 offset:0
    ds_read_b64_tr_b16 v[42:43], v80 offset:512
    ds_read_b64_tr_b16 v[44:45], v80 offset:4096
    ds_read_b64_tr_b16 v[46:47], v80 offset:4608
    ds_read_b64_tr_b16 v[48:49], v80 offset:8192
    ds_read_b64_tr_b16 v[50:51], v80 offset:8704
    ds_read_b64_tr_b16 v[52:53], v80 offset:12288
    ds_read_b64_tr_b16 v[54:55], v80 offset:12800
    ds_read_b64_tr_b16 v[56:57], v80 offset:16384
    ds_read_b64_tr_b16 v[58:59], v80 offset:16896
    ds_read_b64_tr_b16 v[60:61], v80 offset:20480
    ds_read_b64_tr_b16 v[62:63], v80 offset:20992
    ds_read_b64_tr_b16 v[64:65], v80 offset:24576
    ds_read_b64_tr_b16 v[66:67], v80 offset:25088
    ds_read_b64_tr_b16 v[68:69], v80 offset:28672
    ds_read_b64_tr_b16 v[70:71], v80 offset:29184
    ds_read_b64_tr_b16 v[72:73], v80 offset:32768
    ds_read_b64_tr_b16 v[74:75], v80 offset:33280
    ds_read_b64_tr_b16 v[76:77], v80 offset:36864
    ds_read_b64_tr_b16 v[78:79], v80 offset:37376
    s_mov_b32 exec_lo, 0xfffff
    s_mov_b32 exec_hi, 0x0
    s_mov_b32 s76, 1
POLL23:
    buffer_load_dword v36, v1, s[16:19], s79 offen sc1
POLLW23:
    s_waitcnt vmcnt(0)
    v_cmp_eq_u32 vcc, -1, v36
    s_cbranch_vccnz AGAIN23
POLLX23:
    s_mov_b64 exec, s[86:87]
    buffer_load_dwordx4 v[24:27], v86, s[16:19], s77 offen sc1
    buffer_load_dwordx4 v[28:31], v18, s[16:19], s77 offen sc1
    buffer_load_dwordx4 v[32:35], v20, s[16:19], s77 offen sc1
    s_waitcnt vmcnt(0)
BW24:
    ds_write_b128 v87, v[24:27] offset:0
    ds_write_b128 v87, v[28:31] offset:1008
    ds_write_b128 v87, v[32:35] offset:2016
    v_max3_u32 v36, v24, v28, v32
    v_cmp_eq_u32 vcc, -1, v36
    s_mov_b64 exec, s[84:85]
    ds_read_b128 v[88:91], v6 offset:0
    ds_read_b128 v[92:95], v6 offset:64
    ds_read_b128 v[96:99], v6 offset:128
    ds_read_b128 v[100:103], v6 offset:192
    ds_read_b128 v[104:107], v6 offset:256
    s_mov_b64 exec, -1
    s_cbranch_vccnz BR24
BX24:
    s_waitcnt lgkmcnt(4)
    v_mfma_f32_16x16x32_bf16 v[32:35], v[88:91], v[88:91], 0
    s_waitcnt lgkmcnt(3)
    v_mfma_f32_16x16x32_bf16 v[32:35], v[92:95], v[92:95], v[32:35]
    s_waitcnt lgkmcnt(2)
    v_mfma_f32_16x16x32_bf16 v[32:35], v[96:99], v[96:99], v[32:35]
    s_waitcnt lgkmcnt(1)
    v_mfma_f32_16x16x32_bf16 v[32:35], v[100:103], v[100:103], v[32:35]
    s_waitcnt lgkmcnt(0)
    v_mfma_f32_16x16x32_bf16 v[32:35], v[104:107], v[104:107], v[32:35]
    v_mfma_f32_16x16x32_bf16 v[24:27], v[88:91], v[40:43], 0
    v_mov_b32 v36, 0
    v_mov_b32 v37, 0
    v_mfma_f32_16x16x32_bf16 v[24:27], v[92:95], v[44:47], v[24:27]
    v_mov_b32 v38, 0
    s_nop 0
    v_mfma_f32_16x16x32_bf16 v[24:27], v[96:99], v[48:51], v[24:27]
    v_mfma_f32_16x16x32_bf16 v[24:27], v[100:103], v[52:55], v[24:27]
    v_add_f32 v32, v32, v33
    v_add_f32 v34, v34, v35
    v_mfma_f32_16x16x32_bf16 v[24:27], v[104:107], v[56:59], v[24:27]
    v_mfma_f32_16x16x32_bf16 v[28:31], v[88:91], v[60:63], 0
    v_add_f32_dpp v36, v32, v34 quad_perm:[0,1,2,3] row_mask:0xf bank_mask:0x7
    v_mfma_f32_16x16x32_bf16 v[28:31], v[92:95], v[64:67], v[28:31]
    s_nop 0
    v_add_f32_dpp v36, v36, v36 row_ror:8 row_mask:0xf bank_mask:0xf
    v_mfma_f32_16x16x32_bf16 v[28:31], v[96:99], v[68:71], v[28:31]
    s_nop 0
    v_add_f32_dpp v36, v36, v36 row_ror:4 row_mask:0xf bank_mask:0xf
    v_mfma_f32_16x16x32_bf16 v[28:31], v[100:103], v[72:75], v[28:31]
    s_nop 0
    v_add_f32_dpp v36, v36, v36 row_ror:2 row_mask:0xf bank_mask:0xf
    v_mfma_f32_16x16x32_bf16 v[28:31], v[104:107], v[76:79], v[28:31]
    v_add_f32 v25, v24, v25
    v_add_f32_dpp v37, v36, v36 row_ror:1 row_mask:0x7 bank_mask:0xf
    v_add_f32_dpp v38, v36, v36 row_ror:1 row_mask:0x8 bank_mask:0xf
    v_add_f32 v26, v26, v27
    v_add_f32 v25, v25, v26
    s_nop 1
    v_permlane32_swap_b32 v25, v37
    v_add_f32 v29, v28, v29
    v_add_f32 v30, v30, v31
    v_add_f32 v29, v29, v30
    v_add_f32 v25, v25, v37
    s_nop 0
    v_permlane32_swap_b32 v29, v38
    v_add_f32 v29, v29, v38
    s_nop 1
    v_permlane16_swap_b32 v25, v29
    v_add_f32 v25, v25, v29
    buffer_store_dword v25, v84, s[8:11], s78 offen
    s_cmp_eq_u32 s10, 0
    s_cbranch_scc1 SLOW25
BACK25:
    s_cmp_lg_u32 s74, 0
    s_cbranch_scc1 FDONE
    s_mov_b32 exec_lo, 0x0
    s_mov_b32 exec_hi, 0xffff0000
    buffer_store_dword v24, v83, s[8:11], s78 offen
    s_cmp_eq_u32 s10, 0
    s_cbranch_scc1 SLOW26
BACK26:
    buffer_store_dword v28, v83, s[8:11], s78 offen offset:3072
    s_cmp_eq_u32 s10, 0
    s_cbranch_scc1 SLOW27
BACK27:
    s_mov_b64 exec, -1
FDONE:
NEXT:
    s_cmp_lg_u32 s74, 0
    s_cbranch_scc1 DONE
    s_mov_b32 s74, 819200
    s_add_u32 s3, s3, 819200
    s_add_u32 s80, s80, 819200
    s_add_u32 s81, s81, 819200
    s_mov_b64 s[46:47], s[44:45]
    s_mov_b64 s[48:49], s[92:93]
    s_branch LOOP
AGAIN23:
    s_add_u32 s76, s76, 1
    s_cmp_lt_u32 s76, 32768
    s_cbranch_scc1 POLL23
    s_branch POLLX23
BR24:
    s_cmp_ge_u32 s76, 32768
    s_cbranch_scc1 BX24
BL24:
    s_mov_b64 exec, s[86:87]
    v_cmp_eq_u32 vcc, -1, v24
    s_nop 0
    s_mov_b64 exec, vcc
    s_cbranch_execz BS24_0
    buffer_load_dwordx4 v[24:27], v86, s[16:19], s77 offen sc1
BS24_0:
    s_mov_b64 exec, s[86:87]
    v_cmp_eq_u32 vcc, -1, v28
    s_nop 0
    s_mov_b64 exec, vcc
    s_cbranch_execz BS24_1
    buffer_load_dwordx4 v[28:31], v18, s[16:19], s77 offen sc1
BS24_1:
    s_mov_b64 exec, s[86:87]
    v_cmp_eq_u32 vcc, -1, v32
    s_nop 0
    s_mov_b64 exec, vcc
    s_cbranch_execz BS24_2
    buffer_load_dwordx4 v[32:35], v20, s[16:19], s77 offen sc1
BS24_2:
    s_mov_b64 exec, s[86:87]
    s_add_u32 s76, s76, 1
    s_cmp_ge_u32 s76, 32768
    s_waitcnt vmcnt(0)
    v_max3_u32 v36, v24, v28, v32
    v_cmp_eq_u32 vcc, -1, v36
    s_cbranch_vccz BW24
    s_cbranch_scc0 BL24
    s_branch BW24
DONE:
    s_endpgm
TAGLOOP:
    s_mov_b32 s76, 0
TAGL2:
    s_sleep 8
    global_load_dword v98, v100, s[64:65] sc1
    s_waitcnt vmcnt(0)
    v_readfirstlane_b32 s96, v98
    s_nop 0
    s_cmp_lg_u32 s96, 0
    s_cbranch_scc1 TAGOK
    s_add_u32 s76, s76, 1
    s_cmp_lt_u32 s76, 32768
    s_cbranch_scc1 TAGL2
    s_branch TAGOK
DMAF:
    s_sub_u32 s78, s69, 20
    s_and_b32 s66, s78, 3
    s_lshl_b32 s66, s66, 1
    s_and_b32 s79, s72, 1
    s_add_u32 s66, s66, s79
    s_mul_i32 s66, s66, 245760
    s_lshr_b32 s78, s78, 2
    s_lshl_b32 s78, s78, 7
    s_add_u32 s66, s66, s78
    s_mul_i32 s78, s68, 384
    s_add_u32 s66, s66, s78
    s_mul_i32 s67, s72, 10240
    s_add_u32 s67, s67, 57344
    s_branch DMAX
RDYLOOP:
    s_mov_b32 s76, 0
RDYL2:
    s_sleep 8
    buffer_load_dwordx2 v[98:99], v100, s[16:19], 0 offen offset:384 sc1
    s_waitcnt vmcnt(0)
    v_cmp_ne_u32 vcc, s96, v98
    s_cbranch_vccz RDYOK
    s_add_u32 s76, s76, 1
    s_cmp_lt_u32 s76, 32768
    s_cbranch_scc1 RDYL2
    s_branch RDYOK
SLOW1:
    buffer_store_dwordx4 v[28:31], v27, s[16:19], s77 offen sc1
    s_branch BACK1
SLOW2:
    buffer_store_dwordx4 v[24:27], v106, s[16:19], 0 offen sc1
    s_branch BACK2
SLOW5:
    buffer_store_dword v24, v10, s[16:19], s3 offen sc1
    s_branch BACK5
SLOW7:
    buffer_store_dwordx4 v[28:31], v1, s[16:19], s77 offen sc1
    s_branch BACK7
RETRY8:
    s_mov_b32 s76, 1
POLL28:
    buffer_load_dword v28, v20, s[16:19], 0 offen sc1
    buffer_load_dword v29, v21, s[16:19], 0 offen sc1
POLLW28:
    s_waitcnt vmcnt(0)
    v_max_u32 v30, v28, v29
    v_cmp_eq_u32 vcc, -1, v30
    s_cbranch_vccnz AGAIN28
POLLX28:
    s_branch OK8
AGAIN28:
    s_add_u32 s76, s76, 1
    s_cmp_lt_u32 s76, 32768
    s_cbranch_scc1 POLL28
    s_branch POLLX28
SLOW9:
    buffer_store_dwordx4 v[28:31], v32, s[16:19], s77 offen sc1
    s_branch BACK9
SLOW11:
    buffer_store_dwordx4 v[28:31], v18, s[16:19], s81 offen sc1
    s_branch BACK11
SLOW12:
    buffer_store_dwordx4 v[28:31], v18, s[16:19], s97 offen sc1
    s_branch BACK12
SLOW13:
    buffer_store_dwordx2 v[34:35], v1, s[16:19], s78 offen sc1
    s_branch BACK13
SLOW14:
    buffer_store_dword v7, v10, s[16:19], s77 offen sc1
    s_branch BACK14
SLOW15:
    buffer_store_dwordx4 v[52:55], v48, s[16:19], s78 offen sc1
    s_branch BACK15
SLOW16:
    buffer_store_dwordx4 v[52:55], v49, s[16:19], s78 offen sc1
    s_branch BACK16
SLOW18:
    buffer_store_dwordx4 v[28:31], v32, s[16:19], s77 offen sc1
    s_branch BACK18
SLOW21:
    buffer_store_dword v7, v10, s[16:19], s77 offen sc1
    s_branch BACK21
SLOW22:
    buffer_store_dwordx4 v[24:27], v21, s[16:19], s97 offen sc1
    s_branch BACK22
SLOW25:
    buffer_store_dword v25, v84, s[16:19], s78 offen sc1
    s_branch BACK25
SLOW26:
    buffer_store_dword v24, v83, s[16:19], s78 offen sc1
    s_branch BACK26
SLOW27:
    buffer_store_dword v28, v83, s[16:19], s78 offen offset:3072 sc1
    s_branch BACK27
CODE_END:
    s_endpgm
.section .rodata,"a"
.p2align 6
.amdhsa_kernel interleave_layers__sliding_block_cached__glu_gated_swiglu__decode_kernel
  .amdhsa_next_free_vgpr 512
  .amdhsa_next_free_sgpr 102
  .amdhsa_accum_offset 256
  .amdhsa_group_segment_fixed_size 0
  .amdhsa_kernarg_size 96
  .amdhsa_user_sgpr_count 2
  .amdhsa_user_sgpr_kernarg_segment_ptr 1
  .amdhsa_system_sgpr_workgroup_id_x 1
.end_amdhsa_kernel
```

```asm
; @launch grid=(256,1,1) block=(256,1,1) lds=125568
.amdgcn_target "amdgcn-amd-amdhsa--gfx950"
.text
.globl interleave_layers__sliding_block_cached__glu_gated_swiglu__decode_kernel
.p2align 8
.type interleave_layers__sliding_block_cached__glu_gated_swiglu__decode_kernel,@function
interleave_layers__sliding_block_cached__glu_gated_swiglu__decode_kernel:
    s_load_dwordx16 s[44:59], s[0:1], 0
    s_load_dwordx8 s[60:67], s[0:1], 64
    s_cmp_ge_u32 s2, 256
    s_cbranch_scc1 CODE_END
    s_memrealtime s[96:97]
    v_lshrrev_b32 v2, 6, v0
    v_and_b32 v24, 63, v0
    v_readfirstlane_b32 s72, v2
    s_and_b32 s68, s2, 7
    s_lshr_b32 s69, s2, 3
    s_lshr_b32 s70, s69, 3
    s_and_b32 s71, s69, 7
    v_lshlrev_b32 v1, 4, v24
    s_lshl_b32 s77, s70, 3
    s_add_u32 s77, s77, s68
    s_mul_i32 s73, s77, 12582912
    s_lshl_b32 s78, s71, 2
    s_add_u32 s78, s78, s72
    s_mul_i32 s78, s78, 6144
    s_add_u32 s73, s73, s78
    s_add_u32 s73, s73, 11010048
    v_add_u32 v23, 4096, v1
    s_mov_b32 s10, 402653184
    s_mov_b32 s11, 0x20000
    s_getpc_b64 s[100:101]
PCREF:
    s_sub_u32 s100, s100, PCREF-interleave_layers__sliding_block_cached__glu_gated_swiglu__decode_kernel
    s_subb_u32 s101, s101, 0
    s_lshl_b32 s78, s71, 12
    v_lshl_add_u32 v25, v0, 4, s78
    v_cmp_gt_u32 vcc, CODE_END-interleave_layers__sliding_block_cached__glu_gated_swiglu__decode_kernel-16, v25
    s_nop 0
    s_and_saveexec_b64 s[98:99], vcc
    s_cbranch_execz NOCPF
    global_load_dwordx4 a[240:243], v25, s[100:101]
NOCPF:
    s_mov_b64 exec, -1
    s_mul_i32 s79, s77, 384
    s_mov_b32 s74, 0
    s_mul_i32 s3, s68, 81920
    s_getreg_b32 s75, hwreg(HW_REG_XCC_ID, 0, 4)
    s_lshl_b32 s77, s69, 9
    s_add_u32 s77, s77, s3
    s_add_u32 s77, s77, 32768
    v_add_u32 v20, s77, v1
    s_lshl_b32 s77, s68, 2
    s_add_u32 s77, s77, s69
    s_mul_i32 s77, s77, 320
    s_add_u32 s77, s77, 654848
    s_add_u32 s4, s77, 1024
    v_add_u32 v25, s77, v1
    v_cmp_le_u32 vcc, 32, v0
    s_nop 1
    v_cndmask_b32 v21, v20, v25, vcc
    v_mov_b32 v25, 2147483632
    v_cndmask_b32 v20, v20, v25, vcc
    s_cmp_lt_u32 s69, 4
    s_cselect_b32 s77, 52, 32
    v_cmp_le_u32 vcc, s77, v0
    s_nop 1
    v_cndmask_b32 v21, v21, v25, vcc
    s_mov_b32 s18, 1610612736
    s_mov_b32 s19, 0x20000
    s_waitcnt lgkmcnt(0)
    s_mov_b32 s8, s46
    s_and_b32 s9, s47, 0xffff
    s_mov_b32 s16, s66
    s_and_b32 s17, s67, 0xffff
    buffer_load_dwordx4 a[0:3], v1, s[8:11], s73 offen offset:0 nt
    buffer_load_dwordx4 a[4:7], v1, s[8:11], s73 offen offset:1024 nt
    s_or_b32 s77, s2, s72
    s_cbranch_scc1 NOTAG
    s_or_b32 s77, s96, 1
    v_mov_b32 v26, s77
    s_mov_b64 exec, 1
    global_store_dword v1, v26, s[64:65] sc1
    s_mov_b64 exec, -1
NOTAG:
    s_add_u32 s83, s73, 196608
    s_mov_b32 s12, s48
    s_and_b32 s13, s49, 0xffff
    s_mov_b32 s14, 402653184
    s_mov_b32 s15, 0x20000
    s_mov_b32 s20, s50
    s_and_b32 s21, s51, 0xffff
    s_mov_b32 s22, 7864320
    s_mov_b32 s23, 0x20000
    s_mov_b32 s36, s44
    s_and_b32 s37, s45, 0xffff
    s_mov_b32 s38, 1280
    s_mov_b32 s39, 0x20000
    s_mov_b32 s40, s62
    s_and_b32 s41, s63, 0xffff
    s_mov_b32 s42, 1280
    s_mov_b32 s43, 0x20000
    s_mov_b32 s28, s58
    s_and_b32 s29, s59, 0xffff
    s_mov_b32 s30, 1966080
    s_mov_b32 s31, 0x20000
    s_mov_b32 s32, s60
    s_and_b32 s33, s61, 0xffff
    s_mov_b32 s34, 1966080
    s_mov_b32 s35, 0x20000
    s_cmp_lt_u32 s69, 20
    s_cselect_b32 s24, s52, s56
    s_cselect_b32 s25, s53, s57
    s_cselect_b32 s26, s22, s30
    s_and_b32 s25, s25, 0xffff
    s_mov_b32 s27, 0x20000
    s_add_u32 s84, s83, 196608
    s_add_u32 s85, s84, 196608
    s_add_u32 s86, s85, 196608
    s_add_u32 s87, s86, 196608
    s_add_u32 s88, s87, 196608
    s_add_u32 s89, s88, 196608
    v_mov_b32 v0, v24
    s_mul_i32 s77, s72, 6656
    v_add_u32 v25, 0, v0
    v_mul_u32_u24 v26, 171, v25
    v_lshrrev_b32 v26, 12, v26
    v_mul_u32_u24 v27, 24, v26
    v_sub_u32 v27, v25, v27
    v_lshlrev_b32 v27, 4, v27
    v_mul_u32_u24 v25, 416, v26
    v_add3_u32 v2, v25, v27, s77
    v_mul_u32_u24 v25, 12288, v26
    v_add_u32 v40, v25, v27
    v_add_u32 v25, 64, v0
    v_mul_u32_u24 v26, 171, v25
    v_lshrrev_b32 v26, 12, v26
    v_mul_u32_u24 v27, 24, v26
    v_sub_u32 v27, v25, v27
    v_lshlrev_b32 v27, 4, v27
    v_mul_u32_u24 v25, 416, v26
    v_add3_u32 v3, v25, v27, s77
    v_mul_u32_u24 v25, 12288, v26
    v_add_u32 v41, v25, v27
    v_add_u32 v25, 128, v0
    v_mul_u32_u24 v26, 171, v25
    v_lshrrev_b32 v26, 12, v26
    v_mul_u32_u24 v27, 24, v26
    v_sub_u32 v27, v25, v27
    v_lshlrev_b32 v27, 4, v27
    v_mul_u32_u24 v25, 416, v26
    v_add3_u32 v4, v25, v27, s77
    v_mul_u32_u24 v25, 12288, v26
    v_add_u32 v42, v25, v27
    v_and_b32 v25, 15, v0
    v_lshrrev_b32 v26, 4, v0
    v_bfe_u32 v27, v0, 2, 2
    v_and_b32 v28, 3, v0
    s_mul_i32 s78, s71, 160
    v_lshlrev_b32 v36, 4, v26
    v_lshlrev_b32 v37, 3, v26
    v_lshlrev_b32 v39, 2, v0
    buffer_load_dwordx4 v[70:73], v36, s[36:39], s78 offen
    buffer_load_dwordx4 v[74:77], v36, s[36:39], s78 offen offset:64
    buffer_load_dwordx2 v[78:79], v37, s[36:39], s78 offen offset:128
    buffer_load_dwordx4 v[80:83], v1, s[36:39], 0 offen
    buffer_load_dword v84, v39, s[36:39], 0 offen offset:1024
    s_lshl_b32 s7, s69, 6
    v_lshlrev_b32 v38, 2, v25
    buffer_load_dword v22, v38, s[36:39], s7 offen
    s_mul_i32 s78, s71, 983040
    s_add_u32 s79, s79, s78
    s_mul_i32 s78, s72, 98304
    s_add_u32 s79, s79, s78
    s_mul_i32 s78, s72, 3072
    s_add_u32 s78, s78, 26624
    s_add_u32 m0, s78, 0
    s_nop 0
    buffer_load_dwordx4 v40, s[20:23], s79 offen nt lds
    s_add_u32 m0, s78, 1024
    s_nop 0
    buffer_load_dwordx4 v41, s[20:23], s79 offen nt lds
    s_add_u32 m0, s78, 2048
    s_nop 0
    buffer_load_dwordx4 v42, s[20:23], s79 offen nt lds
    s_add_u32 s79, s79, 393216
    s_add_u32 m0, s78, 12288
    s_nop 0
    buffer_load_dwordx4 v40, s[20:23], s79 offen nt lds
    s_add_u32 m0, s78, 13312
    s_nop 0
    buffer_load_dwordx4 v41, s[20:23], s79 offen nt lds
    s_add_u32 m0, s78, 14336
    s_nop 0
    buffer_load_dwordx4 v42, s[20:23], s79 offen nt lds
    s_add_u32 s79, s79, 393216
    s_cmp_ge_u32 s72, 2
    s_cbranch_scc1 NOWQ3
    s_add_u32 m0, s78, 24576
    s_nop 0
    buffer_load_dwordx4 v40, s[20:23], s79 offen nt lds
    s_add_u32 m0, s78, 25600
    s_nop 0
    buffer_load_dwordx4 v41, s[20:23], s79 offen nt lds
    s_add_u32 m0, s78, 26624
    s_nop 0
    buffer_load_dwordx4 v42, s[20:23], s79 offen nt lds
NOWQ3:
    s_mul_i32 s78, s71, 160
    s_mov_b32 s20, s52
    s_and_b32 s21, s53, 0xffff
    s_mov_b32 s22, 7864320
    s_mov_b32 s23, 0x20000
    s_cmp_lt_u32 s72, 2
    s_cselect_b32 s36, s56, s58
    s_cselect_b32 s37, s57, s59
    s_and_b32 s37, s37, 0xffff
    s_mov_b32 s38, 1966080
    buffer_load_dwordx4 a[8:11], v1, s[8:11], s73 offen offset:2048 nt
    buffer_load_dwordx4 a[12:15], v1, s[8:11], s73 offen offset:3072 nt
    buffer_load_dwordx4 a[16:19], v23, s[8:11], s73 offen offset:0 nt
    v_mul_u32_u24 v29, 416, v25
    v_lshl_add_u32 v29, v26, 4, v29
    v_add_u32 v5, s77, v29
    v_lshrrev_b32 v29, 2, v0
    v_mul_u32_u24 v29, 416, v29
    v_lshl_add_u32 v29, v28, 3, v29
    v_add_u32 v6, s77, v29
    s_mul_i32 s79, s72, 96
    s_add_u32 s79, s79, 26624
    v_lshl_add_u32 v29, v26, 3, v27
    v_mul_u32_u24 v29, 384, v29
    v_lshl_add_u32 v29, v28, 3, v29
    v_add_u32 v16, s79, v29
    v_lshl_add_u32 v29, v26, 2, v27
    v_mul_u32_u24 v29, 384, v29
    v_lshl_add_u32 v29, v28, 3, v29
    v_add_u32 v17, s79, v29
    buffer_load_dwordx4 a[20:23], v23, s[8:11], s73 offen offset:1024 nt
    v_mul_u32_u24 v31, 103, v0
    v_lshrrev_b32 v31, 10, v31
    v_mul_u32_u24 v30, 10, v31
    v_sub_u32 v30, v0, v30
    v_lshl_add_u32 v29, v30, 4, s78
    s_mul_i32 s7, s68, 10240
    s_add_u32 s7, s7, 737280
    v_mul_u32_u24 v8, 1280, v31
    v_add_u32 v8, s7, v8
    s_mul_i32 s7, s68, 81920
    s_add_u32 s7, s7, 46592
    v_mov_b32 v30, s7
    v_cmp_eq_u32 vcc, s68, v31
    s_nop 1
    v_cndmask_b32 v8, v8, v30, vcc
    v_add_u32 v30, 2560, v30
    v_cmp_le_u32 vcc, 8, v31
    s_nop 1
    v_cndmask_b32 v8, v8, v30, vcc
    v_add_u32 v8, v8, v29
    v_add_u32 v31, 6, v31
    s_mul_i32 s7, s68, 10240
    s_add_u32 s7, s7, 737280
    v_mul_u32_u24 v9, 1280, v31
    v_add_u32 v9, s7, v9
    s_mul_i32 s7, s68, 81920
    s_add_u32 s7, s7, 46592
    v_mov_b32 v30, s7
    v_cmp_eq_u32 vcc, s68, v31
    s_nop 1
    v_cndmask_b32 v9, v9, v30, vcc
    v_add_u32 v30, 2560, v30
    v_cmp_le_u32 vcc, 8, v31
    s_nop 1
    v_cndmask_b32 v9, v9, v30, vcc
    v_add_u32 v9, v9, v29
    v_mov_b32 v30, 2147483632
    v_cmp_le_u32 vcc, 30, v0
    s_nop 1
    v_cndmask_b32 v9, v9, v30, vcc
    s_lshl_b32 s78, s69, 10
    s_lshl_b32 s79, s72, 8
    s_add_u32 s78, s78, s79
    v_lshl_add_u32 v10, v0, 2, s78
    s_lshl_b32 s78, s70, 13
    s_add_u32 s78, s78, s79
    v_lshlrev_b32 v29, 10, v26
    v_lshl_add_u32 v29, v25, 4, v29
    v_add_u32 v11, s78, v29
    buffer_load_dwordx4 a[24:27], v1, s[8:11], s83 offen offset:0 nt
    s_mul_i32 s78, s72, 96
    s_add_u32 s78, s78, 118784
    v_lshl_add_u32 v29, v27, 5, s78
    v_lshl_add_u32 v29, v28, 2, v29
    v_lshrrev_b32 v30, 1, v26
    v_lshl_add_u32 v29, v30, 4, v29
    v_and_b32 v30, 1, v26
    v_lshl_add_u32 v29, v30, 1, v29
    v_mov_b32 v30, 119168
    v_cmp_le_u32 vcc, 12, v25
    s_nop 1
    v_cndmask_b32 v12, v29, v30, vcc
    v_and_b32 v30, 1, v0
    v_lshlrev_b32 v29, 5, v26
    v_lshl_add_u32 v29, v30, 4, v29
    v_add_u32 v13, 118784, v29
    v_mul_u32_u24 v30, 0xaaaa, v30
    v_and_b32 v29, 1, v27
    v_mul_u32_u24 v29, 0xaaaa, v29
    v_lshl_or_b32 v29, v29, 16, v30
    v_add_u32 v14, 0x44444444, v29
    buffer_load_dwordx4 a[28:31], v1, s[8:11], s83 offen offset:1024 nt
    s_lshl_b32 s78, s72, 8
    s_add_u32 s78, s78, 124416
    v_lshrrev_b32 v29, 5, v0
    v_lshl_add_u32 v29, v29, 6, s78
    v_bfe_u32 v30, v0, 3, 1
    v_lshl_add_u32 v29, v30, 5, v29
    v_bfe_u32 v30, v0, 1, 1
    v_lshl_add_u32 v29, v30, 4, v29
    v_bfe_u32 v30, v0, 2, 1
    v_lshl_add_u32 v29, v30, 3, v29
    v_bfe_u32 v30, v0, 4, 1
    v_lshl_add_u32 v29, v30, 2, v29
    v_bfe_u32 v30, v0, 0, 1
    v_lshl_add_u32 v29, v30, 1, v29
    v_mov_b32 v19, v29
    v_bfe_u32 v29, v0, 4, 1
    v_bfe_u32 v30, v0, 2, 1
    v_lshl_add_u32 v29, v29, 5, s78
    v_lshl_add_u32 v29, v30, 4, v29
    v_accvgpr_write_b32 a252, v29
    s_mul_i32 s78, s72, 768
    s_add_u32 s78, s78, 119296
    v_lshl_add_u32 v29, v25, 2, s78
    v_bfe_u32 v30, v0, 4, 1
    v_lshl_add_u32 v29, v30, 7, v29
    v_lshrrev_b32 v30, 5, v0
    v_lshl_add_u32 v15, v30, 6, v29
    s_waitcnt vmcnt(12)
    v_lshlrev_b32 v88, 16, v80
    v_and_b32 v89, 0xffff0000, v80
    v_lshlrev_b32 v90, 16, v81
    v_and_b32 v91, 0xffff0000, v81
    v_lshlrev_b32 v92, 16, v82
    v_and_b32 v93, 0xffff0000, v82
    v_lshlrev_b32 v94, 16, v83
    v_and_b32 v95, 0xffff0000, v83
    v_lshlrev_b32 v96, 16, v84
    v_and_b32 v97, 0xffff0000, v84
    v_add_f32 v80, v88, v89
    v_add_f32 v80, v80, v90
    v_add_f32 v80, v80, v91
    v_add_f32 v80, v80, v92
    v_add_f32 v80, v80, v93
    v_add_f32 v80, v80, v94
    v_add_f32 v80, v80, v95
    v_add_f32 v80, v80, v96
    v_add_f32 v80, v80, v97
    s_nop 1
    v_add_f32_dpp v80, v80, v80 row_ror:8 row_mask:0xf bank_mask:0xf
    s_nop 1
    v_add_f32_dpp v80, v80, v80 row_ror:4 row_mask:0xf bank_mask:0xf
    s_nop 1
    v_add_f32_dpp v80, v80, v80 row_ror:2 row_mask:0xf bank_mask:0xf
    s_nop 1
    v_add_f32_dpp v80, v80, v80 row_ror:1 row_mask:0xf bank_mask:0xf
    v_mov_b32 v81, v80
    s_nop 1
    v_permlane32_swap_b32 v80, v81
    v_add_f32 v80, v80, v81
    v_mov_b32 v81, v80
    s_nop 1
    v_permlane16_swap_b32 v80, v81
    v_add_f32 v80, v80, v81
    v_mul_f32 v80, 0x3acccccd, v80
    v_sub_f32 v88, v88, v80
    v_sub_f32 v89, v89, v80
    v_sub_f32 v90, v90, v80
    v_sub_f32 v91, v91, v80
    v_sub_f32 v92, v92, v80
    v_sub_f32 v93, v93, v80
    v_sub_f32 v94, v94, v80
    v_sub_f32 v95, v95, v80
    v_sub_f32 v96, v96, v80
    v_sub_f32 v97, v97, v80
    v_mul_f32 v82, v88, v88
    v_fmac_f32 v82, v89, v89
    v_fmac_f32 v82, v90, v90
    v_fmac_f32 v82, v91, v91
    v_fmac_f32 v82, v92, v92
    v_fmac_f32 v82, v93, v93
    v_fmac_f32 v82, v94, v94
    v_fmac_f32 v82, v95, v95
    v_fmac_f32 v82, v96, v96
    v_fmac_f32 v82, v97, v97
    buffer_load_dwordx4 a[32:35], v1, s[8:11], s83 offen offset:2048 nt
    s_nop 0
    v_add_f32_dpp v82, v82, v82 row_ror:8 row_mask:0xf bank_mask:0xf
    s_nop 1
    v_add_f32_dpp v82, v82, v82 row_ror:4 row_mask:0xf bank_mask:0xf
    s_nop 1
    v_add_f32_dpp v82, v82, v82 row_ror:2 row_mask:0xf bank_mask:0xf
    s_nop 1
    v_add_f32_dpp v82, v82, v82 row_ror:1 row_mask:0xf bank_mask:0xf
    v_mov_b32 v81, v82
    s_nop 1
    v_permlane32_swap_b32 v82, v81
    v_add_f32 v82, v82, v81
    v_mov_b32 v81, v82
    s_nop 1
    v_permlane16_swap_b32 v82, v81
    v_add_f32 v82, v82, v81
    v_mul_f32 v82, 0x3acccccd, v82
    v_add_f32 v82, 0x3727c5ac, v82
    v_rsq_f32 v82, v82
    s_mov_b32 vcc_lo, 0xaaaaaaaa
    s_mov_b32 vcc_hi, 0xaaaaaaaa
    v_mov_b32 v85, 0x3f803f80
    v_lshlrev_b32 v83, 16, v70
    v_and_b32 v84, 0xffff0000, v70
    v_sub_f32 v83, v83, v80
    v_sub_f32 v84, v84, v80
    v_mul_f32 v83, v83, v82
    v_mul_f32 v84, v84, v82
    v_cvt_pk_bf16_f32 v83, v83, v84
    v_cndmask_b32 v70, v83, v85, vcc
    v_lshlrev_b32 v83, 16, v71
    v_and_b32 v84, 0xffff0000, v71
    v_sub_f32 v83, v83, v80
    v_sub_f32 v84, v84, v80
    v_mul_f32 v83, v83, v82
    v_mul_f32 v84, v84, v82
    v_cvt_pk_bf16_f32 v83, v83, v84
    v_cndmask_b32 v71, v83, v85, vcc
    v_lshlrev_b32 v83, 16, v72
    v_and_b32 v84, 0xffff0000, v72
    v_sub_f32 v83, v83, v80
    v_sub_f32 v84, v84, v80
    v_mul_f32 v83, v83, v82
    v_mul_f32 v84, v84, v82
    v_cvt_pk_bf16_f32 v83, v83, v84
    v_cndmask_b32 v72, v83, v85, vcc
    v_lshlrev_b32 v83, 16, v73
    v_and_b32 v84, 0xffff0000, v73
    v_sub_f32 v83, v83, v80
    v_sub_f32 v84, v84, v80
    v_mul_f32 v83, v83, v82
    v_mul_f32 v84, v84, v82
    v_cvt_pk_bf16_f32 v83, v83, v84
    v_cndmask_b32 v73, v83, v85, vcc
    v_lshlrev_b32 v83, 16, v74
    v_and_b32 v84, 0xffff0000, v74
    v_sub_f32 v83, v83, v80
    v_sub_f32 v84, v84, v80
    v_mul_f32 v83, v83, v82
    v_mul_f32 v84, v84, v82
    v_cvt_pk_bf16_f32 v83, v83, v84
    v_cndmask_b32 v74, v83, v85, vcc
    v_lshlrev_b32 v83, 16, v75
    v_and_b32 v84, 0xffff0000, v75
    v_sub_f32 v83, v83, v80
    v_sub_f32 v84, v84, v80
    v_mul_f32 v83, v83, v82
    v_mul_f32 v84, v84, v82
    v_cvt_pk_bf16_f32 v83, v83, v84
    v_cndmask_b32 v75, v83, v85, vcc
    buffer_load_dwordx4 a[36:39], v1, s[8:11], s83 offen offset:3072 nt
    v_lshlrev_b32 v83, 16, v76
    v_and_b32 v84, 0xffff0000, v76
    v_sub_f32 v83, v83, v80
    v_sub_f32 v84, v84, v80
    v_mul_f32 v83, v83, v82
    v_mul_f32 v84, v84, v82
    v_cvt_pk_bf16_f32 v83, v83, v84
    v_cndmask_b32 v76, v83, v85, vcc
    v_lshlrev_b32 v83, 16, v77
    v_and_b32 v84, 0xffff0000, v77
    v_sub_f32 v83, v83, v80
    v_sub_f32 v84, v84, v80
    v_mul_f32 v83, v83, v82
    v_mul_f32 v84, v84, v82
    v_cvt_pk_bf16_f32 v83, v83, v84
    v_cndmask_b32 v77, v83, v85, vcc
    v_lshlrev_b32 v83, 16, v78
    v_and_b32 v84, 0xffff0000, v78
    v_sub_f32 v83, v83, v80
    v_sub_f32 v84, v84, v80
    v_mul_f32 v83, v83, v82
    v_mul_f32 v84, v84, v82
    v_cvt_pk_bf16_f32 v83, v83, v84
    v_cndmask_b32 v78, v83, v85, vcc
    v_lshlrev_b32 v83, 16, v79
    v_and_b32 v84, 0xffff0000, v79
    v_sub_f32 v83, v83, v80
    v_sub_f32 v84, v84, v80
    v_mul_f32 v83, v83, v82
    v_mul_f32 v84, v84, v82
    v_cvt_pk_bf16_f32 v83, v83, v84
    v_cndmask_b32 v79, v83, v85, vcc
    s_waitcnt vmcnt(8)
    s_barrier
    ds_read_b64_tr_b16 v[40:41], v16 offset:0
    ds_read_b64_tr_b16 v[42:43], v16 offset:1536
    ds_read_b64_tr_b16 v[44:45], v16 offset:12288
    ds_read_b64_tr_b16 v[46:47], v16 offset:13824
    ds_read_b64_tr_b16 v[48:49], v17 offset:24576
    ds_read_b64_tr_b16 v[50:51], v16 offset:32
    ds_read_b64_tr_b16 v[52:53], v16 offset:1568
    ds_read_b64_tr_b16 v[54:55], v16 offset:12320
    ds_read_b64_tr_b16 v[56:57], v16 offset:13856
    ds_read_b64_tr_b16 v[58:59], v17 offset:24608
    ds_read_b64_tr_b16 v[60:61], v16 offset:64
    ds_read_b64_tr_b16 v[62:63], v16 offset:1600
    ds_read_b64_tr_b16 v[64:65], v16 offset:12352
    ds_read_b64_tr_b16 v[66:67], v16 offset:13888
    ds_read_b64_tr_b16 v[68:69], v17 offset:24640
    v_mov_b32 v100, 0
    s_cmp_lg_u32 s72, 0
    s_cbranch_scc1 NOTL
    s_mov_b64 exec, 1
    global_load_dword v98, v100, s[64:65] sc1
    s_mov_b64 exec, -1
NOTL:
    buffer_load_dwordx4 a[40:43], v23, s[8:11], s83 offen offset:0 nt
    buffer_load_dwordx4 a[44:47], v23, s[8:11], s83 offen offset:1024 nt
    s_mul_i32 s79, s72, 96
    s_add_u32 s79, s79, 119296
    v_min_u32 v36, 48, v0
    v_lshl_add_u32 v36, v36, 1, s79
    v_mov_b32 v37, 119808
    v_cmp_le_u32 vcc, 48, v0
    s_nop 1
    v_cndmask_b32 v36, v36, v37, vcc
    v_add_u32 v37, 119296, v1
    s_waitcnt lgkmcnt(0)
    v_mfma_f32_16x16x32_bf16 v[24:27], v[70:73], v[40:43], 0
    v_mfma_f32_16x16x32_bf16 v[28:31], v[70:73], v[50:53], 0
    v_mfma_f32_16x16x32_bf16 v[32:35], v[70:73], v[60:63], 0
    v_mfma_f32_16x16x32_bf16 v[24:27], v[74:77], v[44:47], v[24:27]
    v_mfma_f32_16x16x32_bf16 v[28:31], v[74:77], v[54:57], v[28:31]
    v_mfma_f32_16x16x32_bf16 v[32:35], v[74:77], v[64:67], v[32:35]
    v_mfma_f32_16x16x16_bf16 v[24:27], v[78:79], v[48:49], v[24:27]
    v_mfma_f32_16x16x16_bf16 v[28:31], v[78:79], v[58:59], v[28:31]
    v_mfma_f32_16x16x16_bf16 v[32:35], v[78:79], v[68:69], v[32:35]
    buffer_load_dwordx4 a[48:51], v1, s[8:11], s84 offen offset:0 nt
    s_nop 4
    v_mov_b32 v7, v25
    v_mov_b32_dpp v24, v28 quad_perm:[0,1,2,3] row_mask:0x2 bank_mask:0xf
    s_nop 0
    v_mov_b32_dpp v7, v29 quad_perm:[0,1,2,3] row_mask:0x2 bank_mask:0xf
    v_mov_b32_dpp v24, v32 quad_perm:[0,1,2,3] row_mask:0x4 bank_mask:0xf
    s_nop 0
    v_mov_b32_dpp v7, v33 quad_perm:[0,1,2,3] row_mask:0x4 bank_mask:0xf
    v_cvt_pk_bf16_f32 v24, v24, v24
    ds_write_b16 v36, v24
    buffer_load_dwordx4 a[52:55], v1, s[8:11], s84 offen offset:1024 nt
    buffer_load_dwordx4 a[56:59], v1, s[8:11], s84 offen offset:2048 nt
    s_waitcnt lgkmcnt(0)
    s_barrier
    ds_read_b128 v[28:31], v37
    s_lshl_b32 s79, s69, 9
    s_add_u32 s79, s79, s3
    s_cmp_eq_u32 s72, 0
    s_cselect_b32 exec_lo, 0xffffff, 1
    s_mov_b32 exec_hi, 0
    s_cselect_b32 s78, 0, 1879048176
    v_add_u32 v37, s78, v1
    s_waitcnt lgkmcnt(0)
    buffer_store_dwordx4 v[28:31], v37, s[16:19], s79 offen sc1
    s_mov_b64 exec, -1
    v_mov_b32 v32, -1
    v_mov_b32 v33, -1
    v_mov_b32 v34, -1
    v_mov_b32 v35, -1
    buffer_store_dwordx4 v[32:35], v21, s[16:19], 0 offen sc1
    buffer_load_dwordx4 a[60:63], v1, s[8:11], s84 offen offset:3072 nt
    s_waitcnt vmcnt(12)
    ds_write_b128 v2, a[0:3] offset:0
    ds_write_b128 v3, a[4:7] offset:0
    ds_write_b128 v4, a[8:11] offset:0
    ds_write_b128 v2, a[12:15] offset:3328
    ds_write_b128 v3, a[16:19] offset:3328
    ds_write_b128 v4, a[20:23] offset:3328
    ds_read_b128 a[0:3], v5 offset:0
    ds_read_b128 a[4:7], v5 offset:64
    ds_read_b128 a[8:11], v5 offset:128
    ds_read_b128 a[12:15], v5 offset:192
    ds_read_b128 a[16:19], v5 offset:256
    ds_read_b128 a[20:23], v5 offset:320
    buffer_load_dwordx4 a[64:67], v23, s[8:11], s84 offen offset:0 nt
    buffer_load_dwordx4 a[68:71], v23, s[8:11], s84 offen offset:1024 nt
    s_barrier
    buffer_load_dwordx4 a[72:75], v1, s[8:11], s85 offen offset:0 nt
    buffer_load_dwordx4 a[76:79], v1, s[8:11], s85 offen offset:1024 nt
    buffer_load_dwordx4 a[80:83], v1, s[8:11], s85 offen offset:2048 nt
    buffer_load_dwordx4 a[84:87], v1, s[8:11], s85 offen offset:3072 nt
    buffer_load_dwordx4 a[88:91], v23, s[8:11], s85 offen offset:0 nt
    buffer_load_dwordx4 a[92:95], v23, s[8:11], s85 offen offset:1024 nt
    s_barrier
    s_getreg_b32 s5, hwreg(HW_REG_XCC_ID, 0, 4)
    s_cmp_lg_u32 s72, 0
    s_cbranch_scc1 NOHDR
    s_waitcnt vmcnt(9)
    v_readfirstlane_b32 s96, v98
    s_nop 0
    s_cmp_eq_u32 s96, 0
    s_cbranch_scc1 TAGLOOP
TAGOK:
    v_mov_b32 v99, s5
    s_mov_b64 exec, 1
    buffer_store_dwordx2 v[98:99], v1, s[16:19], s79 offen offset:384 sc1
    s_mov_b64 exec, -1
NOHDR:
    s_waitcnt vmcnt(14)
    ds_write_b128 v2, a[24:27] offset:0
    ds_write_b128 v3, a[28:31] offset:0
    ds_write_b128 v4, a[32:35] offset:0
    ds_write_b128 v2, a[36:39] offset:3328
    ds_write_b128 v3, a[40:43] offset:3328
    ds_write_b128 v4, a[44:47] offset:3328
    ds_read_b128 a[24:27], v5 offset:0
    ds_read_b128 a[28:31], v5 offset:64
    ds_read_b128 a[32:35], v5 offset:128
    ds_read_b128 a[36:39], v5 offset:192
    ds_read_b128 a[40:43], v5 offset:256
    ds_read_b128 a[44:47], v5 offset:320
    buffer_load_dwordx4 a[96:99], v1, s[8:11], s86 offen offset:0 nt
    buffer_load_dwordx4 a[100:103], v1, s[8:11], s86 offen offset:1024 nt
    buffer_load_dwordx4 a[104:107], v1, s[8:11], s86 offen offset:2048 nt
    buffer_load_dwordx4 a[108:111], v1, s[8:11], s86 offen offset:3072 nt
    buffer_load_dwordx4 a[112:115], v23, s[8:11], s86 offen offset:0 nt
    buffer_load_dwordx4 a[116:119], v23, s[8:11], s86 offen offset:1024 nt
    s_barrier
    s_waitcnt vmcnt(12)
    ds_write_b128 v2, a[48:51] offset:0
    ds_write_b128 v3, a[52:55] offset:0
    ds_write_b128 v4, a[56:59] offset:0
    ds_write_b128 v2, a[60:63] offset:3328
    ds_write_b128 v3, a[64:67] offset:3328
    ds_write_b128 v4, a[68:71] offset:3328
    ds_read_b128 a[48:51], v5 offset:0
    ds_read_b128 a[52:55], v5 offset:64
    ds_read_b128 a[56:59], v5 offset:128
    ds_read_b128 a[60:63], v5 offset:192
    ds_read_b128 a[64:67], v5 offset:256
    ds_read_b128 a[68:71], v5 offset:320
    v_lshlrev_b32 v100, 9, v0
    v_add_u32 v100, s3, v100
    v_bfe_u32 v96, v0, 2, 3
    v_mul_u32_u24 v96, 81920, v96
    v_and_b32 v97, 3, v0
    v_lshl_add_u32 v96, v97, 9, v96
    v_cmp_le_u32 vcc, 32, v0
    s_nop 1
    v_cndmask_b32 v100, v100, v96, vcc
    s_cmp_eq_u32 s72, 0
    s_cselect_b32 s77, 0, 1879048176
    v_add_u32 v100, s77, v100
    buffer_load_dwordx4 a[120:123], v1, s[8:11], s87 offen offset:0 nt
    buffer_load_dwordx4 a[124:127], v1, s[8:11], s87 offen offset:1024 nt
    buffer_load_dwordx4 a[128:131], v1, s[8:11], s87 offen offset:2048 nt
    buffer_load_dwordx4 a[132:135], v1, s[8:11], s87 offen offset:3072 nt
    buffer_load_dwordx4 a[136:139], v23, s[8:11], s87 offen offset:0 nt
    buffer_load_dwordx4 a[140:143], v23, s[8:11], s87 offen offset:1024 nt
    s_barrier
    s_waitcnt vmcnt(12)
    ds_write_b128 v2, a[72:75] offset:0
    ds_write_b128 v3, a[76:79] offset:0
    ds_write_b128 v4, a[80:83] offset:0
    ds_write_b128 v2, a[84:87] offset:3328
    ds_write_b128 v3, a[88:91] offset:3328
    ds_write_b128 v4, a[92:95] offset:3328
    ds_read_b128 a[72:75], v5 offset:0
    ds_read_b128 a[76:79], v5 offset:64
    ds_read_b128 a[80:83], v5 offset:128
    ds_read_b128 a[84:87], v5 offset:192
    ds_read_b128 a[88:91], v5 offset:256
    ds_read_b128 a[92:95], v5 offset:320
    buffer_load_dwordx4 a[144:147], v1, s[8:11], s88 offen offset:0 nt
    buffer_load_dwordx4 a[148:151], v1, s[8:11], s88 offen offset:1024 nt
    buffer_load_dwordx4 a[152:155], v1, s[8:11], s88 offen offset:2048 nt
    buffer_load_dwordx4 a[156:159], v1, s[8:11], s88 offen offset:3072 nt
    buffer_load_dwordx4 a[160:163], v23, s[8:11], s88 offen offset:0 nt
    buffer_load_dwordx4 a[164:167], v23, s[8:11], s88 offen offset:1024 nt
    s_barrier
    s_waitcnt vmcnt(12)
    ds_write_b128 v2, a[96:99] offset:0
    ds_write_b128 v3, a[100:103] offset:0
    ds_write_b128 v4, a[104:107] offset:0
    ds_write_b128 v2, a[108:111] offset:3328
    ds_write_b128 v3, a[112:115] offset:3328
    ds_write_b128 v4, a[116:119] offset:3328
    ds_read_b128 a[96:99], v5 offset:0
    ds_read_b128 a[100:103], v5 offset:64
    ds_read_b128 a[104:107], v5 offset:128
    ds_read_b128 a[108:111], v5 offset:192
    ds_read_b128 a[112:115], v5 offset:256
    ds_read_b128 a[116:119], v5 offset:320
    buffer_load_dwordx4 a[168:171], v1, s[8:11], s89 offen offset:0 nt
    buffer_load_dwordx4 a[172:175], v1, s[8:11], s89 offen offset:1024 nt
    buffer_load_dwordx4 a[176:179], v1, s[8:11], s89 offen offset:2048 nt
    buffer_load_dwordx4 a[180:183], v1, s[8:11], s89 offen offset:3072 nt
    buffer_load_dwordx4 a[184:187], v23, s[8:11], s89 offen offset:0 nt
    buffer_load_dwordx4 a[188:191], v23, s[8:11], s89 offen offset:1024 nt
    s_barrier
    s_cmp_ge_u32 s69, 20
    s_cbranch_scc1 DMAF
    s_lshl_b32 s66, s72, 3
    s_add_u32 s66, s66, s68
    s_mul_i32 s66, s66, 245760
    s_lshl_b32 s78, s69, 6
    s_add_u32 s66, s66, s78
    s_mul_i32 s67, s72, 12288
    s_add_u32 s67, s67, 57344
DMAX:
    v_mov_b32 v109, v20
    v_and_b32 v25, 15, v0
    v_lshrrev_b32 v26, 4, v0
    v_add_u32 v27, 4, v26
    s_mul_i32 s7, s68, 10240
    s_add_u32 s7, s7, 737280
    v_mul_u32_u24 v20, 1280, v26
    v_add_u32 v20, s7, v20
    s_mul_i32 s7, s68, 81920
    s_add_u32 s7, s7, 46592
    v_mov_b32 v28, s7
    v_cmp_eq_u32 vcc, s68, v26
    s_nop 1
    v_cndmask_b32 v20, v20, v28, vcc
    s_mul_i32 s7, s68, 10240
    s_add_u32 s7, s7, 737280
    v_mul_u32_u24 v21, 1280, v27
    v_add_u32 v21, s7, v21
    s_mul_i32 s7, s68, 81920
    s_add_u32 s7, s7, 46592
    v_mov_b32 v28, s7
    v_cmp_eq_u32 vcc, s68, v27
    s_nop 1
    v_cndmask_b32 v21, v21, v28, vcc
    s_min_u32 s7, s69, 19
    s_lshl_b32 s7, s7, 6
    v_lshl_add_u32 v25, v25, 2, s7
    v_add_u32 v20, v20, v25
    v_add_u32 v21, v21, v25
    buffer_load_dwordx4 a[216:219], v1, s[12:15], s73 offen offset:0 nt
    v_and_b32 v25, 15, v0
    v_bfe_u32 v27, v0, 2, 2
    v_and_b32 v28, 3, v0
    s_mul_i32 s7, s72, 12288
    s_add_u32 s7, s7, 57344
    v_lshl_add_u32 v29, v26, 3, v27
    v_lshlrev_b32 v29, 6, v29
    v_lshl_add_u32 v29, v28, 3, v29
    v_add_u32 v29, s7, v29
    v_accvgpr_write_b32 a246, v29
    s_mul_i32 s7, s72, 3072
    s_add_u32 s7, s7, 32768
    v_lshl_add_u32 v29, v25, 4, s7
    v_lshl_add_u32 v29, v26, 7, v29
    v_accvgpr_write_b32 a247, v29
    s_lshl_b32 s7, s72, 6
    s_add_u32 s7, s7, 45056
    v_and_b32 v29, 1, v26
    v_lshl_add_u32 v29, v29, 5, s7
    v_accvgpr_write_b32 a248, v29
    s_lshl_b32 s7, s72, 8
    s_add_u32 s7, s7, 122368
    v_lshl_add_u32 v29, v0, 2, s7
    v_accvgpr_write_b32 a249, v29
    s_lshl_b32 s81, s69, 6
    s_mul_i32 s80, s68, 1280
    s_add_u32 s80, s80, s81
    s_add_u32 s80, s80, 655360
    s_add_u32 s81, s81, s3
    s_add_u32 s81, s81, 45312
    s_waitcnt vmcnt(13)
    ds_write_b128 v2, a[120:123] offset:0
    ds_write_b128 v3, a[124:127] offset:0
    ds_write_b128 v4, a[128:131] offset:0
    ds_write_b128 v2, a[132:135] offset:3328
    ds_write_b128 v3, a[136:139] offset:3328
    ds_write_b128 v4, a[140:143] offset:3328
    ds_read_b128 a[120:123], v5 offset:0
    ds_read_b128 a[124:127], v5 offset:64
    ds_read_b128 a[128:131], v5 offset:128
    ds_read_b128 a[132:135], v5 offset:192
    ds_read_b128 a[136:139], v5 offset:256
    ds_read_b128 a[140:143], v5 offset:320
    buffer_load_dwordx4 a[220:223], v1, s[12:15], s73 offen offset:1024 nt
    buffer_load_dwordx4 a[224:227], v1, s[12:15], s73 offen offset:2048 nt
    buffer_load_dwordx4 a[228:231], v1, s[12:15], s73 offen offset:3072 nt
    buffer_load_dwordx4 a[232:235], v23, s[12:15], s73 offen offset:0 nt
    buffer_load_dwordx4 a[236:239], v23, s[12:15], s73 offen offset:1024 nt
    s_barrier
    buffer_load_dwordx2 v[98:99], v100, s[16:19], 0 offen offset:384 sc1
    s_waitcnt vmcnt(13)
    ds_write_b128 v2, a[144:147] offset:0
    ds_write_b128 v3, a[148:151] offset:0
    ds_write_b128 v4, a[152:155] offset:0
    ds_write_b128 v2, a[156:159] offset:3328
    ds_write_b128 v3, a[160:163] offset:3328
    ds_write_b128 v4, a[164:167] offset:3328
    ds_read_b128 a[144:147], v5 offset:0
    ds_read_b128 a[148:151], v5 offset:64
    ds_read_b128 a[152:155], v5 offset:128
    ds_read_b128 a[156:159], v5 offset:192
    ds_read_b128 a[160:163], v5 offset:256
    ds_read_b128 a[164:167], v5 offset:320
    buffer_load_dwordx4 v[112:115], v1, s[12:15], s83 offen offset:0 nt
    buffer_load_dwordx4 v[116:119], v1, s[12:15], s83 offen offset:1024 nt
    buffer_load_dwordx4 v[120:123], v1, s[12:15], s83 offen offset:2048 nt
    buffer_load_dwordx4 v[124:127], v1, s[12:15], s83 offen offset:3072 nt
    buffer_load_dwordx4 v[128:131], v23, s[12:15], s83 offen offset:0 nt
    buffer_load_dwordx4 v[132:135], v23, s[12:15], s83 offen offset:1024 nt
    s_barrier
    s_waitcnt vmcnt(13)
    ds_write_b128 v2, a[168:171] offset:0
    ds_write_b128 v3, a[172:175] offset:0
    ds_write_b128 v4, a[176:179] offset:0
    ds_write_b128 v2, a[180:183] offset:3328
    ds_write_b128 v3, a[184:187] offset:3328
    ds_write_b128 v4, a[188:191] offset:3328
    ds_read_b128 a[168:171], v5 offset:0
    ds_read_b128 a[172:175], v5 offset:64
    ds_read_b128 a[176:179], v5 offset:128
    ds_read_b128 a[180:183], v5 offset:192
    ds_read_b128 a[184:187], v5 offset:256
    ds_read_b128 a[188:191], v5 offset:320
    buffer_load_dwordx4 v[136:139], v1, s[12:15], s84 offen offset:0 nt
    buffer_load_dwordx4 v[140:143], v1, s[12:15], s84 offen offset:1024 nt
    buffer_load_dwordx4 v[144:147], v1, s[12:15], s84 offen offset:2048 nt
    buffer_load_dwordx4 v[148:151], v1, s[12:15], s84 offen offset:3072 nt
    buffer_load_dwordx4 v[152:155], v23, s[12:15], s84 offen offset:0 nt
    buffer_load_dwordx4 v[156:159], v23, s[12:15], s84 offen offset:1024 nt
    s_barrier
    s_waitcnt vmcnt(12)
    s_mov_b32 s76, -1
    v_mov_b32 v97, 125504
    s_cmp_lg_u32 s72, 0
    s_cbranch_scc1 RDYX
    v_cmp_ne_u32 vcc, s96, v98
    s_cbranch_vccnz RDYLOOP
RDYOK:
    v_cmp_ne_u32 vcc, s5, v99
    s_nop 1
    v_mov_b32 v96, vcc_lo
    ds_write_b32 v97, v96
RDYX:
    buffer_load_dwordx4 v[160:163], v1, s[12:15], s85 offen offset:0 nt
    buffer_load_dwordx4 v[164:167], v1, s[12:15], s85 offen offset:1024 nt
    s_waitcnt lgkmcnt(0)
    s_barrier
    ds_read_b32 v96, v97
    s_waitcnt lgkmcnt(0)
    v_readfirstlane_b32 s77, v96
    s_nop 0
    s_cmp_eq_u32 s77, 0
    s_cselect_b32 s10, s18, 0
    s_mov_b32 s8, s16
    s_mov_b32 s9, s17
    s_mov_b32 s11, 0x20000
    buffer_load_dwordx4 a[240:243], v109, s[16:19], 0 offen sc1
    s_mul_i32 s77, s69, 432
    s_add_u32 s77, s77, s3
    s_add_u32 s77, s77, 49152
    s_cmp_eq_u32 s72, 3
    s_cselect_b32 s77, s77, 1879048176
    v_add_u32 v106, s77, v1
    v_mov_b32 v107, 2147483632
    v_cmp_le_u32 vcc, 27, v0
    s_nop 1
    v_cndmask_b32 v106, v106, v107, vcc
    buffer_load_dwordx4 a[240:243], v106, s[16:19], 0 offen sc1
    s_lshl_b32 s77, s69, 2
    s_add_u32 s77, s77, s72
    s_lshl_b32 s78, s77, 8
    s_add_u32 s78, s78, 819200
    s_lshl_b32 s77, s77, 9
    s_sub_u32 s77, s77, 256
    v_lshlrev_b32 v24, 7, v0
    v_add_u32 v25, s77, v24
    v_min_u32 v25, 56704, v25
    v_add_u32 v24, s78, v24
    v_cmp_gt_u32 vcc, 2, v0
    s_nop 1
    v_cndmask_b32 v24, v25, v24, vcc
    s_add_u32 s77, s3, 819200
    s_mov_b64 exec, 63
    buffer_load_dword a243, v24, s[16:19], s77 offen sc1
    s_mov_b64 exec, -1
    s_lshl_b32 s77, s70, 12
    s_mul_i32 s78, s72, 96
    s_add_u32 s77, s77, s78
    s_add_u32 s77, s77, s3
    v_lshrrev_b32 v24, 4, v0
    v_lshlrev_b32 v24, 9, v24
    v_and_b32 v25, 15, v0
    v_min_u32 v25, 11, v25
    v_lshl_add_u32 v24, v25, 3, v24
    buffer_load_dwordx2 v[64:65], v24, s[16:19], s77 offen offset:0 sc1
    buffer_load_dwordx2 v[66:67], v24, s[16:19], s77 offen offset:2048 sc1
    s_cmp_lg_u32 s72, 1
    s_cbranch_scc1 NOBASE0
    s_cmp_ge_u32 s69, 20
    s_cbranch_scc1 NOBASE0
    v_mov_b32 v28, v22
    s_lshl_b32 s77, s69, 6
    s_add_u32 s77, s77, s3
    s_add_u32 s77, s77, 47872
    v_lshlrev_b32 v27, 2, v0
    v_mov_b32_dpp v29, v28 quad_perm:[1,1,1,1] row_mask:0xf bank_mask:0xf
    v_mov_b32_dpp v30, v28 quad_perm:[2,2,2,2] row_mask:0xf bank_mask:0xf
    v_mov_b32_dpp v31, v28 quad_perm:[3,3,3,3] row_mask:0xf bank_mask:0xf
    s_mov_b32 exec_lo, 0x1111
    s_mov_b32 exec_hi, 0x0
    buffer_store_dwordx4 v[28:31], v27, s[8:11], s77 offen
    s_cmp_eq_u32 s10, 0
    s_cbranch_scc1 SLOW1
BACK1:
    s_mov_b64 exec, -1
NOBASE0:
    ds_write_b128 v2, a[216:219] offset:0
    ds_write_b128 v3, a[220:223] offset:0
    ds_write_b128 v4, a[224:227] offset:0
    ds_write_b128 v2, a[228:231] offset:3328
    ds_write_b128 v3, a[232:235] offset:3328
    ds_write_b128 v4, a[236:239] offset:3328
    ds_read_b64_tr_b16 a[192:193], v6 offset:0
    ds_read_b64_tr_b16 a[196:197], v6 offset:32
    ds_read_b64_tr_b16 a[200:201], v6 offset:64
    ds_read_b64_tr_b16 a[204:205], v6 offset:96
    ds_read_b64_tr_b16 a[208:209], v6 offset:128
    ds_read_b64_tr_b16 a[212:213], v6 offset:160
    ds_read_b64_tr_b16 a[216:217], v6 offset:192
    ds_read_b64_tr_b16 a[220:221], v6 offset:224
    ds_read_b64_tr_b16 a[224:225], v6 offset:256
    ds_read_b64_tr_b16 a[228:229], v6 offset:288
    ds_read_b64_tr_b16 a[232:233], v6 offset:320
    ds_read_b64_tr_b16 a[236:237], v6 offset:352
    s_waitcnt vmcnt(13)
    ds_write_b128 v2, v[112:115] offset:0
    ds_write_b128 v3, v[116:119] offset:0
    ds_write_b128 v4, v[120:123] offset:0
    ds_write_b128 v2, v[124:127] offset:3328
    ds_write_b128 v3, v[128:131] offset:3328
    ds_write_b128 v4, v[132:135] offset:3328
    ds_read_b64_tr_b16 a[194:195], v6 offset:0
    ds_read_b64_tr_b16 a[198:199], v6 offset:32
    ds_read_b64_tr_b16 a[202:203], v6 offset:64
    ds_read_b64_tr_b16 a[206:207], v6 offset:96
    ds_read_b64_tr_b16 a[210:211], v6 offset:128
    ds_read_b64_tr_b16 a[214:215], v6 offset:160
    ds_read_b64_tr_b16 a[218:219], v6 offset:192
    ds_read_b64_tr_b16 a[222:223], v6 offset:224
    ds_read_b64_tr_b16 a[226:227], v6 offset:256
    ds_read_b64_tr_b16 a[230:231], v6 offset:288
    ds_read_b64_tr_b16 a[234:235], v6 offset:320
    ds_read_b64_tr_b16 a[238:239], v6 offset:352
    buffer_load_dwordx4 v[168:171], v1, s[12:15], s85 offen offset:2048 nt
    buffer_load_dwordx4 v[172:175], v1, s[12:15], s85 offen offset:3072 nt
    buffer_load_dwordx4 v[176:179], v23, s[12:15], s85 offen offset:0 nt
    buffer_load_dwordx4 v[180:183], v23, s[12:15], s85 offen offset:1024 nt
    s_barrier
    buffer_load_dwordx4 v[184:187], v1, s[12:15], s86 offen offset:0 nt
    s_waitcnt vmcnt(12)
    ds_write_b128 v2, v[136:139] offset:0
    ds_write_b128 v3, v[140:143] offset:0
    ds_write_b128 v4, v[144:147] offset:0
    ds_write_b128 v2, v[148:151] offset:3328
    ds_write_b128 v3, v[152:155] offset:3328
    ds_write_b128 v4, v[156:159] offset:3328
    ds_read_b64_tr_b16 v[112:113], v6 offset:0
    ds_read_b64_tr_b16 v[116:117], v6 offset:32
    ds_read_b64_tr_b16 v[120:121], v6 offset:64
    ds_read_b64_tr_b16 v[124:125], v6 offset:96
    ds_read_b64_tr_b16 v[128:129], v6 offset:128
    ds_read_b64_tr_b16 v[132:133], v6 offset:160
    ds_read_b64_tr_b16 v[136:137], v6 offset:192
    ds_read_b64_tr_b16 v[140:141], v6 offset:224
    ds_read_b64_tr_b16 v[144:145], v6 offset:256
    ds_read_b64_tr_b16 v[148:149], v6 offset:288
    ds_read_b64_tr_b16 v[152:153], v6 offset:320
    ds_read_b64_tr_b16 v[156:157], v6 offset:352
    buffer_load_dwordx4 v[188:191], v1, s[12:15], s86 offen offset:1024 nt
    buffer_load_dwordx4 v[192:195], v1, s[12:15], s86 offen offset:2048 nt
    buffer_load_dwordx4 v[196:199], v1, s[12:15], s86 offen offset:3072 nt
    buffer_load_dwordx4 v[200:203], v23, s[12:15], s86 offen offset:0 nt
    buffer_load_dwordx4 v[204:207], v23, s[12:15], s86 offen offset:1024 nt
    s_barrier
    buffer_load_dwordx4 v[208:211], v1, s[12:15], s87 offen offset:0 nt
    buffer_load_dwordx4 v[212:215], v1, s[12:15], s87 offen offset:1024 nt
    s_waitcnt vmcnt(12)
    v_lshlrev_b32 v24, 16, v64
    v_and_b32 v25, 0xffff0000, v64
    v_lshlrev_b32 v26, 16, v65
    v_and_b32 v27, 0xffff0000, v65
    v_lshlrev_b32 v28, 16, v66
    v_and_b32 v29, 0xffff0000, v66
    v_lshlrev_b32 v30, 16, v67
    v_and_b32 v31, 0xffff0000, v67
    v_add_f32 v24, v24, v28
    v_add_f32 v25, v25, v29
    v_add_f32 v26, v26, v30
    v_add_f32 v27, v27, v31
    s_nop 0
    v_permlane32_swap_b32 v24, v26
    v_permlane32_swap_b32 v25, v27
    v_add_f32 v24, v24, v26
    v_add_f32 v25, v25, v27
    s_nop 1
    v_permlane16_swap_b32 v24, v25
    v_add_f32 v24, v24, v25
    v_cvt_pk_bf16_f32 v24, v24, v24
    ds_write_b16 v12, v24
    buffer_load_dwordx4 v[216:219], v1, s[12:15], s87 offen offset:2048 nt
    v_mov_b32 v40, 0
    v_mov_b32 v41, 0
    v_mov_b32 v44, 0
    v_mov_b32 v45, 0
    v_mov_b32 v48, 0
    v_mov_b32 v49, 0
    v_mov_b32 v52, 0
    v_mov_b32 v53, 0
    v_mov_b32 v56, 0
    v_mov_b32 v57, 0
    v_mov_b32 v60, 0
    v_mov_b32 v61, 0
    v_mov_b32 v64, 0
    v_mov_b32 v65, 0
    v_mov_b32 v68, 0
    v_mov_b32 v69, 0
    v_mov_b32 v72, 0
    v_mov_b32 v73, 0
    v_mov_b32 v74, 0
    v_mov_b32 v75, 0
    v_mov_b32 v76, 0
    v_mov_b32 v77, 0
    v_mov_b32 v78, 0
    v_mov_b32 v79, 0
    v_mov_b32 v80, 0
    v_mov_b32 v81, 0
    v_mov_b32 v82, 0
    v_mov_b32 v83, 0
    v_mov_b32 v84, 0
    v_mov_b32 v85, 0
    v_mov_b32 v86, 0
    v_mov_b32 v87, 0
    buffer_load_dwordx4 v[220:223], v1, s[12:15], s87 offen offset:3072 nt
    buffer_load_dwordx4 v[224:227], v23, s[12:15], s87 offen offset:0 nt
    s_waitcnt lgkmcnt(0)
    s_barrier
    ds_read_b128 v[28:31], v13 offset:0
    ds_read_b128 v[32:35], v13 offset:128
    ds_read_b128 v[36:39], v13 offset:256
    v_mov_b32 v18, 0x3dd53b94
    s_waitcnt lgkmcnt(2)
    v_smfmac_f32_16x16x64_bf16 v[40:43], v[28:31], a[0:7], v14
    v_smfmac_f32_16x16x64_bf16 v[44:47], v[28:31], a[24:31], v14
    v_smfmac_f32_16x16x64_bf16 v[48:51], v[28:31], a[48:55], v14
    v_smfmac_f32_16x16x64_bf16 v[52:55], v[28:31], a[72:79], v14
    v_smfmac_f32_16x16x64_bf16 v[56:59], v[28:31], a[96:103], v14
    v_smfmac_f32_16x16x64_bf16 v[60:63], v[28:31], a[120:127], v14
    v_smfmac_f32_16x16x64_bf16 v[64:67], v[28:31], a[144:151], v14
    v_smfmac_f32_16x16x64_bf16 v[68:71], v[28:31], a[168:175], v14
    buffer_load_dwordx4 v[228:231], v23, s[12:15], s87 offen offset:1024 nt
    s_barrier
    s_waitcnt lgkmcnt(1)
    v_smfmac_f32_16x16x64_bf16 v[40:43], v[32:35], a[8:15], v14
    v_smfmac_f32_16x16x64_bf16 v[44:47], v[32:35], a[32:39], v14
    v_smfmac_f32_16x16x64_bf16 v[48:51], v[32:35], a[56:63], v14
    v_smfmac_f32_16x16x64_bf16 v[52:55], v[32:35], a[80:87], v14
    v_smfmac_f32_16x16x64_bf16 v[56:59], v[32:35], a[104:111], v14
    v_smfmac_f32_16x16x64_bf16 v[60:63], v[32:35], a[128:135], v14
    v_smfmac_f32_16x16x64_bf16 v[64:67], v[32:35], a[152:159], v14
    v_smfmac_f32_16x16x64_bf16 v[68:71], v[32:35], a[176:183], v14
    s_waitcnt lgkmcnt(0)
    v_smfmac_f32_16x16x64_bf16 v[40:43], v[36:39], a[16:23], v14
    v_smfmac_f32_16x16x64_bf16 v[44:47], v[36:39], a[40:47], v14
    v_smfmac_f32_16x16x64_bf16 v[48:51], v[36:39], a[64:71], v14
    v_smfmac_f32_16x16x64_bf16 v[52:55], v[36:39], a[88:95], v14
    v_smfmac_f32_16x16x64_bf16 v[56:59], v[36:39], a[112:119], v14
    v_smfmac_f32_16x16x64_bf16 v[60:63], v[36:39], a[136:143], v14
    v_smfmac_f32_16x16x64_bf16 v[64:67], v[36:39], a[160:167], v14
    v_smfmac_f32_16x16x64_bf16 v[68:71], v[36:39], a[184:191], v14
    buffer_load_dwordx4 v[232:235], v1, s[12:15], s88 offen offset:0 nt
    v_add_f32 v24, v40, v41
    v_add_f32 v44, v44, v45
    v_add_f32 v48, v48, v49
    v_max3_f32 v26, v24, v44, v48
    v_add_f32 v52, v52, v53
    v_add_f32 v25, v56, v57
    v_max3_f32 v26, v26, v52, v25
    v_add_f32 v60, v60, v61
    v_add_f32 v64, v64, v65
    v_max3_f32 v26, v26, v60, v64
    v_add_f32 v68, v68, v69
    v_max_f32 v26, v26, v68
    v_mov_b32_dpp v24, v44 quad_perm:[0,1,2,3] row_mask:0x2 bank_mask:0xf
    v_mov_b32_dpp v25, v60 quad_perm:[0,1,2,3] row_mask:0x2 bank_mask:0xf
    v_max_f32_dpp v26, v26, v26 row_ror:8 row_mask:0xf bank_mask:0xf
    v_mov_b32_dpp v24, v48 quad_perm:[0,1,2,3] row_mask:0x4 bank_mask:0xf
    v_mov_b32_dpp v25, v64 quad_perm:[0,1,2,3] row_mask:0x4 bank_mask:0xf
    v_max_f32_dpp v26, v26, v26 row_ror:4 row_mask:0xf bank_mask:0xf
    v_mov_b32_dpp v24, v52 quad_perm:[0,1,2,3] row_mask:0x8 bank_mask:0xf
    v_mov_b32_dpp v25, v68 quad_perm:[0,1,2,3] row_mask:0x8 bank_mask:0xf
    v_max_f32_dpp v26, v26, v26 row_ror:2 row_mask:0xf bank_mask:0xf
    v_accvgpr_read_b32 v27, a252
    s_nop 0
    v_max_f32_dpp v26, v26, v26 row_ror:1 row_mask:0xf bank_mask:0xf
    buffer_load_dwordx4 v[236:239], v1, s[12:15], s88 offen offset:1024 nt
    v_mul_f32 v26, v26, v18
    v_fma_f32 v24, v24, v18, -v26
    v_fma_f32 v25, v25, v18, -v26
    v_exp_f32 v24, v24
    v_exp_f32 v25, v25
    s_nop 0
    v_cvt_pk_bf16_f32 v28, v24, v25
    ds_write_b16 v19, v28
    ds_write_b16_d16_hi v19, v28 offset:128
    s_mov_b32 exec_lo, 0xff00ff
    s_mov_b32 exec_hi, 0xff00ff00
    ds_read_b128 v[72:75], v27 offset:0
    ds_read_b128 v[76:79], v27 offset:64
    ds_read_b128 v[80:83], v27 offset:128
    ds_read_b128 v[84:87], v27 offset:192
    s_mov_b64 exec, -1
    v_add_f32 v27, v24, v25
    v_mov_b32 v40, 0
    v_mov_b32 v44, 0
    v_add_f32_dpp v27, v27, v27 row_ror:8 row_mask:0xf bank_mask:0xf
    v_mov_b32 v48, 0
    v_mov_b32 v52, 0
    v_add_f32_dpp v27, v27, v27 row_ror:4 row_mask:0xf bank_mask:0xf
    v_mov_b32 v56, 0
    v_mov_b32 v60, 0
    v_add_f32_dpp v27, v27, v27 row_ror:2 row_mask:0xf bank_mask:0xf
    s_lshl_b32 s78, s72, 3
    s_add_u32 s78, s78, 125440
    v_add_f32_dpp v27, v27, v27 row_ror:1 row_mask:0xf bank_mask:0xf
    v_mov_b32 v28, v27
    s_nop 1
    v_permlane32_swap_b32 v27, v28
    v_add_f32 v27, v27, v28
    v_mov_b32 v28, v27
    s_nop 1
    v_permlane16_swap_b32 v27, v28
    v_add_f32 v27, v27, v28
    v_mov_b32 v28, s78
    ds_write_b64 v28, v[26:27]
    s_waitcnt vmcnt(14)
    ds_write_b128 v2, v[160:163] offset:0
    ds_write_b128 v3, v[164:167] offset:0
    ds_write_b128 v4, v[168:171] offset:0
    ds_write_b128 v2, v[172:175] offset:3328
    ds_write_b128 v3, v[176:179] offset:3328
    ds_write_b128 v4, v[180:183] offset:3328
    ds_read_b64_tr_b16 v[114:115], v6 offset:0
    ds_read_b64_tr_b16 v[118:119], v6 offset:32
    ds_read_b64_tr_b16 v[122:123], v6 offset:64
    ds_read_b64_tr_b16 v[126:127], v6 offset:96
    ds_read_b64_tr_b16 v[130:131], v6 offset:128
    ds_read_b64_tr_b16 v[134:135], v6 offset:160
    ds_read_b64_tr_b16 v[138:139], v6 offset:192
    ds_read_b64_tr_b16 v[142:143], v6 offset:224
    ds_read_b64_tr_b16 v[146:147], v6 offset:256
    ds_read_b64_tr_b16 v[150:151], v6 offset:288
    ds_read_b64_tr_b16 v[154:155], v6 offset:320
    ds_read_b64_tr_b16 v[158:159], v6 offset:352
    buffer_load_dwordx4 v[240:243], v1, s[12:15], s88 offen offset:2048 nt
    buffer_load_dwordx4 v[244:247], v1, s[12:15], s88 offen offset:3072 nt
    s_waitcnt lgkmcnt(0)
    v_smfmac_f32_16x16x64_bf16 v[40:43], v[72:75], a[192:199], v14 abid:1
    v_smfmac_f32_16x16x64_bf16 v[44:47], v[72:75], a[200:207], v14 abid:1
    v_smfmac_f32_16x16x64_bf16 v[48:51], v[72:75], a[208:215], v14 abid:1
    v_smfmac_f32_16x16x64_bf16 v[52:55], v[72:75], a[216:223], v14 abid:1
    v_smfmac_f32_16x16x64_bf16 v[56:59], v[72:75], a[224:231], v14 abid:1
    v_smfmac_f32_16x16x64_bf16 v[60:63], v[72:75], a[232:239], v14 abid:1
    buffer_load_dwordx4 v[248:251], v23, s[12:15], s88 offen offset:0 nt
    v_smfmac_f32_16x16x64_bf16 v[40:43], v[76:79], v[112:119], v14 abid:1
    v_smfmac_f32_16x16x64_bf16 v[44:47], v[76:79], v[120:127], v14 abid:1
    v_smfmac_f32_16x16x64_bf16 v[48:51], v[76:79], v[128:135], v14 abid:1
    v_smfmac_f32_16x16x64_bf16 v[52:55], v[76:79], v[136:143], v14 abid:1
    v_smfmac_f32_16x16x64_bf16 v[56:59], v[76:79], v[144:151], v14 abid:1
    v_smfmac_f32_16x16x64_bf16 v[60:63], v[76:79], v[152:159], v14 abid:1
    buffer_load_dwordx4 v[252:255], v23, s[12:15], s88 offen offset:1024 nt
    s_barrier
    s_waitcnt vmcnt(12)
    ds_write_b128 v2, v[184:187] offset:0
    ds_write_b128 v3, v[188:191] offset:0
    ds_write_b128 v4, v[192:195] offset:0
    ds_write_b128 v2, v[196:199] offset:3328
    ds_write_b128 v3, v[200:203] offset:3328
    ds_write_b128 v4, v[204:207] offset:3328
    ds_read_b64_tr_b16 v[160:161], v6 offset:0
    ds_read_b64_tr_b16 v[164:165], v6 offset:32
    ds_read_b64_tr_b16 v[168:169], v6 offset:64
    ds_read_b64_tr_b16 v[172:173], v6 offset:96
    ds_read_b64_tr_b16 v[176:177], v6 offset:128
    ds_read_b64_tr_b16 v[180:181], v6 offset:160
    ds_read_b64_tr_b16 v[184:185], v6 offset:192
    ds_read_b64_tr_b16 v[188:189], v6 offset:224
    ds_read_b64_tr_b16 v[192:193], v6 offset:256
    ds_read_b64_tr_b16 v[196:197], v6 offset:288
    ds_read_b64_tr_b16 v[200:201], v6 offset:320
    ds_read_b64_tr_b16 v[204:205], v6 offset:352
    v_mov_b32 v24, -1
    v_mov_b32 v25, -1
    v_mov_b32 v26, -1
    v_mov_b32 v27, -1
    buffer_store_dwordx4 v[24:27], v106, s[8:11], 0 offen
    s_cmp_eq_u32 s10, 0
    s_cbranch_scc1 SLOW2
BACK2:
    buffer_load_dwordx4 v[88:91], v1, s[12:15], s89 offen offset:0 nt
    buffer_load_dwordx4 v[92:95], v1, s[12:15], s89 offen offset:1024 nt
    buffer_load_dwordx4 v[96:99], v1, s[12:15], s89 offen offset:2048 nt
    buffer_load_dwordx4 v[100:103], v1, s[12:15], s89 offen offset:3072 nt
    buffer_load_dwordx4 v[104:107], v23, s[12:15], s89 offen offset:0 nt
    buffer_load_dwordx4 v[108:111], v23, s[12:15], s89 offen offset:1024 nt
    s_waitcnt vmcnt(13)
    ds_write_b128 v2, v[208:211] offset:0
    ds_write_b128 v3, v[212:215] offset:0
    ds_write_b128 v4, v[216:219] offset:0
    ds_write_b128 v2, v[220:223] offset:3328
    ds_write_b128 v3, v[224:227] offset:3328
    ds_write_b128 v4, v[228:231] offset:3328
    ds_read_b64_tr_b16 v[162:163], v6 offset:0
    ds_read_b64_tr_b16 v[166:167], v6 offset:32
    ds_read_b64_tr_b16 v[170:171], v6 offset:64
    ds_read_b64_tr_b16 v[174:175], v6 offset:96
    ds_read_b64_tr_b16 v[178:179], v6 offset:128
    ds_read_b64_tr_b16 v[182:183], v6 offset:160
    ds_read_b64_tr_b16 v[186:187], v6 offset:192
    ds_read_b64_tr_b16 v[190:191], v6 offset:224
    ds_read_b64_tr_b16 v[194:195], v6 offset:256
    ds_read_b64_tr_b16 v[198:199], v6 offset:288
    ds_read_b64_tr_b16 v[202:203], v6 offset:320
    ds_read_b64_tr_b16 v[206:207], v6 offset:352
    v_and_b32 v23, 0xffff0000, v22
    v_lshlrev_b32 v22, 16, v22
    s_mov_b32 s82, 0x1010101
    s_mov_b32 s83, 0x1010101
    s_mov_b32 s84, 0x1ff01ff
    s_mov_b32 s85, 0x1ff01ff
    s_mov_b32 s86, 0xffffffff
    s_mov_b32 s87, 0xfffffff
    s_mov_b32 s88, 0xff00ff
    s_mov_b32 s89, 0xff00ff00
    s_mov_b32 s92, 0x1010101
    s_mov_b32 s93, 0x0
    s_mov_b32 s44, 0xf0f0f0f
    s_mov_b32 s45, 0xf0f0f0f
    s_mov_b64 s[46:47], s[92:93]
    s_mov_b64 s[48:49], s[44:45]
    s_cmp_ge_u32 s69, 20
    s_cbranch_scc1 TAILF
    v_mov_b32 v24, -1
    v_mov_b32 v25, -1
    v_mov_b32 v26, -1
    v_mov_b32 v27, -1
    v_and_b32 v28, 3, v0
    v_lshrrev_b32 v29, 5, v0
    v_lshl_add_u32 v28, v29, 2, v28
    v_mul_u32_u24 v28, 10240, v28
    v_bfe_u32 v29, v0, 3, 2
    v_lshl_add_u32 v28, v29, 4, v28
    s_cmp_eq_u32 s72, 3
    s_cselect_b32 s77, 0, 1879048176
    v_add_u32 v28, s77, v28
    s_add_u32 s77, s80, 81920
    s_mov_b64 exec, s[44:45]
    buffer_store_dwordx4 v[24:27], v28, s[16:19], s77 offen sc1
    s_mov_b64 exec, -1
    v_lshrrev_b32 v38, 2, v0
    v_mul_u32_u24 v38, 1280, v38
    v_and_b32 v39, 3, v0
    v_lshl_add_u32 v39, v39, 4, v38
    s_mov_b32 m0, s67
    s_add_u32 s67, s67, 1024
    buffer_load_dwordx4 v39, s[24:27], s66 offen  lds
    s_add_u32 s66, s66, 20480
    s_mov_b32 m0, s67
    s_add_u32 s67, s67, 1024
    buffer_load_dwordx4 v39, s[24:27], s66 offen  lds
    s_add_u32 s66, s66, 20480
    s_mov_b32 m0, s67
    s_add_u32 s67, s67, 1024
    buffer_load_dwordx4 v39, s[24:27], s66 offen  lds
    s_add_u32 s66, s66, 20480
    s_waitcnt lgkmcnt(0)
    v_smfmac_f32_16x16x64_bf16 v[40:43], v[80:83], v[160:167], v14 abid:1
    v_smfmac_f32_16x16x64_bf16 v[44:47], v[80:83], v[168:175], v14 abid:1
    v_smfmac_f32_16x16x64_bf16 v[48:51], v[80:83], v[176:183], v14 abid:1
    v_smfmac_f32_16x16x64_bf16 v[52:55], v[80:83], v[184:191], v14 abid:1
    v_smfmac_f32_16x16x64_bf16 v[56:59], v[80:83], v[192:199], v14 abid:1
    v_smfmac_f32_16x16x64_bf16 v[60:63], v[80:83], v[200:207], v14 abid:1
    s_waitcnt vmcnt(11)
    ds_write_b128 v2, v[232:235] offset:0
    ds_write_b128 v3, v[236:239] offset:0
    ds_write_b128 v4, v[240:243] offset:0
    ds_write_b128 v2, v[244:247] offset:3328
    ds_write_b128 v3, v[248:251] offset:3328
    ds_write_b128 v4, v[252:255] offset:3328
    ds_read_b64_tr_b16 v[208:209], v6 offset:0
    ds_read_b64_tr_b16 v[212:213], v6 offset:32
    ds_read_b64_tr_b16 v[216:217], v6 offset:64
    ds_read_b64_tr_b16 v[220:221], v6 offset:96
    ds_read_b64_tr_b16 v[224:225], v6 offset:128
    ds_read_b64_tr_b16 v[228:229], v6 offset:160
    ds_read_b64_tr_b16 v[232:233], v6 offset:192
    ds_read_b64_tr_b16 v[236:237], v6 offset:224
    ds_read_b64_tr_b16 v[240:241], v6 offset:256
    ds_read_b64_tr_b16 v[244:245], v6 offset:288
    ds_read_b64_tr_b16 v[248:249], v6 offset:320
    ds_read_b64_tr_b16 v[252:253], v6 offset:352
    s_mov_b32 m0, s67
    s_add_u32 s67, s67, 1024
    buffer_load_dwordx4 v39, s[24:27], s66 offen  lds
    s_add_u32 s66, s66, 20480
    s_mov_b32 m0, s67
    s_add_u32 s67, s67, 1024
    buffer_load_dwordx4 v39, s[24:27], s66 offen  lds
    s_add_u32 s66, s66, 20480
    s_mov_b32 m0, s67
    s_add_u32 s67, s67, 1024
    buffer_load_dwordx4 v39, s[24:27], s66 offen  lds
    s_add_u32 s66, s66, 20480
    s_waitcnt vmcnt(12)
    ds_write_b128 v2, v[88:91] offset:0
    s_waitcnt vmcnt(11)
    ds_write_b128 v3, v[92:95] offset:0
    s_waitcnt vmcnt(10)
    ds_write_b128 v4, v[96:99] offset:0
    s_waitcnt vmcnt(9)
    ds_write_b128 v2, v[100:103] offset:3328
    s_waitcnt vmcnt(8)
    ds_write_b128 v3, v[104:107] offset:3328
    s_waitcnt vmcnt(7)
    ds_write_b128 v4, v[108:111] offset:3328
    ds_read_b64_tr_b16 v[210:211], v6 offset:0
    ds_read_b64_tr_b16 v[214:215], v6 offset:32
    ds_read_b64_tr_b16 v[218:219], v6 offset:64
    ds_read_b64_tr_b16 v[222:223], v6 offset:96
    ds_read_b64_tr_b16 v[226:227], v6 offset:128
    ds_read_b64_tr_b16 v[230:231], v6 offset:160
    ds_read_b64_tr_b16 v[234:235], v6 offset:192
    ds_read_b64_tr_b16 v[238:239], v6 offset:224
    ds_read_b64_tr_b16 v[242:243], v6 offset:256
    ds_read_b64_tr_b16 v[246:247], v6 offset:288
    ds_read_b64_tr_b16 v[250:251], v6 offset:320
    ds_read_b64_tr_b16 v[254:255], v6 offset:352
    s_branch ATT_LAST
TAILF:
    s_lshl_b32 s90, s72, 3
    s_add_u32 s90, s90, s68
    s_mul_i32 s90, s90, 24
    s_add_u32 s90, s90, s69
    s_sub_u32 s90, s90, 8
    s_mul_i32 s90, s90, 10240
    buffer_load_dwordx4 a[240:243], v1, s[20:23], s90 offen offset:0
    buffer_load_dwordx4 a[240:243], v1, s[20:23], s90 offen offset:1024
    buffer_load_dwordx4 a[240:243], v1, s[20:23], s90 offen offset:2048
    buffer_load_dwordx4 a[240:243], v1, s[20:23], s90 offen offset:3072
    s_add_u32 s90, s90, 4096
    buffer_load_dwordx4 a[240:243], v1, s[20:23], s90 offen offset:0
    buffer_load_dwordx4 a[240:243], v1, s[20:23], s90 offen offset:1024
    buffer_load_dwordx4 a[240:243], v1, s[20:23], s90 offen offset:2048
    v_lshrrev_b32 v38, 3, v0
    v_mul_u32_u24 v38, 3072, v38
    v_and_b32 v39, 7, v0
    v_lshl_add_u32 v38, v39, 4, v38
    v_bfe_u32 v39, v0, 4, 1
    v_lshlrev_b32 v39, 5, v39
    v_xor_b32 v38, v38, v39
    v_xor_b32 v39, 64, v38
    s_waitcnt lgkmcnt(0)
    v_smfmac_f32_16x16x64_bf16 v[40:43], v[80:83], v[160:167], v14 abid:1
    v_smfmac_f32_16x16x64_bf16 v[44:47], v[80:83], v[168:175], v14 abid:1
    v_smfmac_f32_16x16x64_bf16 v[48:51], v[80:83], v[176:183], v14 abid:1
    v_smfmac_f32_16x16x64_bf16 v[52:55], v[80:83], v[184:191], v14 abid:1
    v_smfmac_f32_16x16x64_bf16 v[56:59], v[80:83], v[192:199], v14 abid:1
    v_smfmac_f32_16x16x64_bf16 v[60:63], v[80:83], v[200:207], v14 abid:1
    s_waitcnt vmcnt(14)
    ds_write_b128 v2, v[232:235] offset:0
    ds_write_b128 v3, v[236:239] offset:0
    ds_write_b128 v4, v[240:243] offset:0
    ds_write_b128 v2, v[244:247] offset:3328
    ds_write_b128 v3, v[248:251] offset:3328
    ds_write_b128 v4, v[252:255] offset:3328
    ds_read_b64_tr_b16 v[208:209], v6 offset:0
    ds_read_b64_tr_b16 v[212:213], v6 offset:32
    ds_read_b64_tr_b16 v[216:217], v6 offset:64
    ds_read_b64_tr_b16 v[220:221], v6 offset:96
    ds_read_b64_tr_b16 v[224:225], v6 offset:128
    ds_read_b64_tr_b16 v[228:229], v6 offset:160
    ds_read_b64_tr_b16 v[232:233], v6 offset:192
    ds_read_b64_tr_b16 v[236:237], v6 offset:224
    ds_read_b64_tr_b16 v[240:241], v6 offset:256
    ds_read_b64_tr_b16 v[244:245], v6 offset:288
    ds_read_b64_tr_b16 v[248:249], v6 offset:320
    ds_read_b64_tr_b16 v[252:253], v6 offset:352
    buffer_load_dwordx4 a[240:243], v1, s[20:23], s90 offen offset:3072
    s_add_u32 s90, s90, 4096
    buffer_load_dwordx4 a[240:243], v1, s[20:23], s90 offen offset:0
    buffer_load_dwordx4 a[240:243], v1, s[20:23], s90 offen offset:1024
    s_waitcnt vmcnt(15)
    ds_write_b128 v2, v[88:91] offset:0
    s_waitcnt vmcnt(14)
    ds_write_b128 v3, v[92:95] offset:0
    s_waitcnt vmcnt(13)
    ds_write_b128 v4, v[96:99] offset:0
    s_waitcnt vmcnt(12)
    ds_write_b128 v2, v[100:103] offset:3328
    s_waitcnt vmcnt(11)
    ds_write_b128 v3, v[104:107] offset:3328
    s_waitcnt vmcnt(10)
    ds_write_b128 v4, v[108:111] offset:3328
    ds_read_b64_tr_b16 v[210:211], v6 offset:0
    ds_read_b64_tr_b16 v[214:215], v6 offset:32
    ds_read_b64_tr_b16 v[218:219], v6 offset:64
    ds_read_b64_tr_b16 v[222:223], v6 offset:96
    ds_read_b64_tr_b16 v[226:227], v6 offset:128
    ds_read_b64_tr_b16 v[230:231], v6 offset:160
    ds_read_b64_tr_b16 v[234:235], v6 offset:192
    ds_read_b64_tr_b16 v[238:239], v6 offset:224
    ds_read_b64_tr_b16 v[242:243], v6 offset:256
    ds_read_b64_tr_b16 v[246:247], v6 offset:288
    ds_read_b64_tr_b16 v[250:251], v6 offset:320
    ds_read_b64_tr_b16 v[254:255], v6 offset:352
    s_mov_b32 m0, s67
    s_add_u32 s67, s67, 1024
    buffer_load_dwordx4 v38, s[36:39], s66 offen nt lds
    s_add_u32 s66, s66, 24576
    s_mov_b32 m0, s67
    s_add_u32 s67, s67, 1024
    buffer_load_dwordx4 v39, s[36:39], s66 offen nt lds
    s_add_u32 s66, s66, 24576
    s_mov_b32 m0, s67
    s_add_u32 s67, s67, 1024
    buffer_load_dwordx4 v38, s[36:39], s66 offen nt lds
    s_add_u32 s66, s66, 24576
    s_branch ATT_LAST
LOOP:
    s_cmp_lt_u32 s69, 20
    s_cselect_b32 s5, s72, 4
    s_add_u32 s96, s3, 819200
    s_add_u32 s97, s96, 4096
    s_and_b32 s77, s5, 3
    s_cbranch_scc1 LOOP2
    ds_read_b64_tr_b16 v[40:41], v16 offset:0
    ds_read_b64_tr_b16 v[42:43], v16 offset:1536
    ds_read_b64_tr_b16 v[44:45], v16 offset:12288
    ds_read_b64_tr_b16 v[46:47], v16 offset:13824
    ds_read_b64_tr_b16 v[48:49], v17 offset:24576
    ds_read_b64_tr_b16 v[50:51], v16 offset:32
    ds_read_b64_tr_b16 v[52:53], v16 offset:1568
    ds_read_b64_tr_b16 v[54:55], v16 offset:12320
    ds_read_b64_tr_b16 v[56:57], v16 offset:13856
    ds_read_b64_tr_b16 v[58:59], v17 offset:24608
    ds_read_b64_tr_b16 v[60:61], v16 offset:64
    ds_read_b64_tr_b16 v[62:63], v16 offset:1600
    ds_read_b64_tr_b16 v[64:65], v16 offset:12352
    ds_read_b64_tr_b16 v[66:67], v16 offset:13888
    ds_read_b64_tr_b16 v[68:69], v17 offset:24640
    v_and_b32 v25, 15, v0
    v_cmp_eq_u32 vcc, 12, v25
    v_mov_b32 v36, 0x3f803f80
    s_nop 0
    v_cndmask_b32 v70, 0, v36, vcc
    v_mov_b32 v71, v70
    v_mov_b32 v72, v70
    v_mov_b32 v73, v70
    v_mov_b32 v74, v70
    v_mov_b32 v75, v70
    v_mov_b32 v76, v70
    v_mov_b32 v77, v70
    v_mov_b32 v78, v70
    v_mov_b32 v79, v70
    s_mul_i32 s77, s72, 6656
    v_mul_u32_u24 v96, 103, v0
    v_lshrrev_b32 v96, 10, v96
    v_lshl_add_u32 v96, v96, 4, v1
    v_add_u32 v96, s77, v96
    v_mul_u32_u24 v97, 176, v25
    v_add_u32 v97, s77, v97
    v_lshrrev_b32 v28, 4, v0
    v_lshl_add_u32 v98, v28, 3, v97
    v_lshl_add_u32 v97, v28, 4, v97
LOOP2:
    s_add_u32 s79, s3, 4096
    s_mul_i32 s77, s71, 160
    s_add_u32 s77, s77, s3
    s_sub_u32 s77, s77, 772608
    s_mov_b32 exec_lo, 0x3ff
    s_mov_b32 exec_hi, 0x0
    s_mov_b32 s76, 1
POLL3:
    buffer_load_dword v24, v1, s[16:19], s77 offen sc1
POLLW3:
    s_waitcnt vmcnt(0)
    v_cmp_eq_u32 vcc, -1, v24
    s_cbranch_vccnz AGAIN3
POLLX3:
    s_mov_b64 exec, s[86:87]
    buffer_load_dwordx4 v[80:83], v8, s[16:19], 0 offen sc1
    buffer_load_dwordx4 v[84:87], v9, s[16:19], 0 offen sc1
    buffer_load_dwordx4 v[88:91], v11, s[16:19], s96 offen sc1
    buffer_load_dwordx4 v[92:95], v11, s[16:19], s97 offen sc1
    s_waitcnt vmcnt(2)
BW4:
    ds_write_b128 v96, v[80:83]
    ds_write_b128 v96, v[84:87] offset:1056
    v_max_u32 v24, v80, v84
    v_cmp_eq_u32 vcc, -1, v24
    s_mov_b64 exec, s[84:85]
    ds_read_b128 v[70:73], v97
    ds_read_b128 v[74:77], v97 offset:64
    ds_read_b64 v[78:79], v98 offset:128
    s_mov_b64 exec, -1
    s_cbranch_vccnz BR4
BX4:
    s_cmp_lg_u32 s5, 1
    s_cbranch_scc1 NOOWL
    buffer_load_dword a244, v20, s[16:19], 0 offen sc1
    buffer_load_dword a245, v21, s[16:19], 0 offen sc1
NOOWL:
    s_waitcnt lgkmcnt(2)
    v_mfma_f32_16x16x32_bf16 v[24:27], v[70:73], v[40:43], 0
    v_mfma_f32_16x16x32_bf16 v[32:35], v[70:73], v[60:63], 0
    s_waitcnt lgkmcnt(0)
    v_mfma_f32_16x16x32_bf16 v[24:27], v[74:77], v[44:47], v[24:27]
    v_mfma_f32_16x16x32_bf16 v[32:35], v[74:77], v[64:67], v[32:35]
    v_mfma_f32_16x16x16_bf16 v[24:27], v[78:79], v[48:49], v[24:27]
    v_mfma_f32_16x16x16_bf16 v[32:35], v[78:79], v[68:69], v[32:35]
    v_mfma_f32_16x16x32_bf16 v[28:31], v[70:73], v[50:53], 0
    v_mfma_f32_16x16x32_bf16 v[36:39], v[70:73], v[70:73], 0
    v_mfma_f32_16x16x32_bf16 v[28:31], v[74:77], v[54:57], v[28:31]
    v_mfma_f32_16x16x32_bf16 v[36:39], v[74:77], v[74:77], v[36:39]
    v_mfma_f32_16x16x16_bf16 v[28:31], v[78:79], v[58:59], v[28:31]
    v_mfma_f32_16x16x16_bf16 v[36:39], v[78:79], v[78:79], v[36:39]
    s_nop 0
    v_add_f32 v24, v24, v25
    v_add_f32 v26, v26, v27
    v_add_f32 v24, v24, v26
    v_add_f32 v32, v32, v33
    v_add_f32 v34, v34, v35
    v_add_f32 v32, v32, v34
    s_nop 1
    v_permlane32_swap_b32 v24, v32
    v_add_f32 v28, v28, v29
    v_add_f32 v30, v30, v31
    v_add_f32 v36, v36, v37
    v_add_f32 v38, v38, v39
    v_add_f32 v24, v24, v32
    v_add_f32 v28, v28, v30
    v_add_f32 v36, v36, v38
    s_nop 1
    v_permlane32_swap_b32 v28, v36
    v_add_f32 v28, v28, v36
    s_nop 1
    v_permlane16_swap_b32 v24, v28
    v_add_f32 v24, v24, v28
    buffer_store_dword v24, v10, s[8:11], s3 offen
    s_cmp_eq_u32 s10, 0
    s_cbranch_scc1 SLOW5
BACK5:
    v_mov_b32 v40, 0
    v_mov_b32 v41, 0
    v_mov_b32 v44, 0
    v_mov_b32 v45, 0
    v_mov_b32 v48, 0
    v_mov_b32 v49, 0
    v_mov_b32 v52, 0
    v_mov_b32 v53, 0
    v_mov_b32 v56, 0
    v_mov_b32 v57, 0
    v_mov_b32 v60, 0
    v_mov_b32 v61, 0
    v_mov_b32 v64, 0
    v_mov_b32 v65, 0
    v_mov_b32 v68, 0
    v_mov_b32 v69, 0
    v_mov_b32 v72, 0
    v_mov_b32 v73, 0
    v_mov_b32 v74, 0
    v_mov_b32 v75, 0
    v_mov_b32 v76, 0
    v_mov_b32 v77, 0
    v_mov_b32 v78, 0
    v_mov_b32 v79, 0
    v_mov_b32 v80, 0
    v_mov_b32 v81, 0
    v_mov_b32 v82, 0
    v_mov_b32 v83, 0
    v_mov_b32 v84, 0
    v_mov_b32 v85, 0
    v_mov_b32 v86, 0
    v_mov_b32 v87, 0
    s_waitcnt vmcnt(1)
    v_add_f32 v88, v88, v92
    v_add_f32 v89, v89, v93
    v_add_f32 v90, v90, v94
    v_add_f32 v91, v91, v95
    s_nop 0
    v_permlane32_swap_b32 v88, v90
    v_permlane32_swap_b32 v89, v91
    v_add_f32 v88, v88, v90
    v_add_f32 v89, v89, v91
    s_nop 1
    v_permlane16_swap_b32 v88, v89
    v_add_f32 v88, v88, v89
    v_mul_f32 v7, 0x3acccccd, v88
    s_mov_b32 s76, 1
POLL6:
    buffer_load_dwordx4 v[24:27], v11, s[16:19], s3 offen sc1
    buffer_load_dwordx4 v[28:31], v11, s[16:19], s79 offen sc1
    s_waitcnt vmcnt(0)
    v_add_f32 v24, v24, v28
    v_add_f32 v25, v25, v29
    v_add_f32 v26, v26, v30
    v_add_f32 v27, v27, v31
    s_nop 0
    v_permlane32_swap_b32 v24, v26
    v_permlane32_swap_b32 v25, v27
    v_add_f32 v24, v24, v26
    v_add_f32 v25, v25, v27
    s_nop 1
    v_permlane16_swap_b32 v24, v25
    v_add_f32 v24, v24, v25
    v_cmp_u_f32 vcc, v24, v24
    s_cbranch_vccnz AGAIN6
POLLX6:
    v_readlane_b32 s77, v24, 15
    s_mov_b32 vcc_lo, 0x70007000
    s_mov_b32 vcc_hi, 0x70007000
    v_fma_f32 v25, -s77, v7, v24
    v_cvt_pk_bf16_f32 v25, v25, v25
    ds_write_b16 v12, v25
    v_cndmask_b32 v26, 0, v24, vcc
    s_nop 1
    v_add_f32_dpp v26, v26, v26 quad_perm:[1,0,3,2] row_mask:0xf bank_mask:0xf
    s_nop 1
    v_add_f32_dpp v26, v26, v26 quad_perm:[2,3,0,1] row_mask:0xf bank_mask:0xf
    v_mov_b32 v27, v26
    s_nop 1
    v_permlane32_swap_b32 v26, v27
    v_add_f32 v26, v26, v27
    s_waitcnt lgkmcnt(0)
    s_barrier
    ds_read_b128 v[28:31], v13 offset:0
    ds_read_b128 v[32:35], v13 offset:128
    ds_read_b128 v[36:39], v13 offset:256
    v_mov_b32 v27, v26
    v_mov_b32 v25, s77
    v_subrev_f32 v25, 0x44200000, v25
    v_permlane16_swap_b32 v26, v27
    v_add_f32 v26, v26, v27
    v_mul_f32 v24, 0x3acccccd, v25
    v_readlane_b32 s77, v26, 15
    v_mul_f32 v24, v24, v24
    s_mov_b32 s78, 0x3acccccd
    v_sub_f32 v26, s77, v25
    v_fma_f32 v26, v26, s78, -v24
    v_max_f32 v26, 0, v26
    v_add_f32 v26, 0x3727c5ac, v26
    v_rsq_f32 v26, v26
    s_nop 0
    v_mul_f32 v18, 0x3dd53b94, v26
    s_waitcnt lgkmcnt(2)
    v_smfmac_f32_16x16x64_bf16 v[40:43], v[28:31], a[0:7], v14
    v_smfmac_f32_16x16x64_bf16 v[44:47], v[28:31], a[24:31], v14
    v_smfmac_f32_16x16x64_bf16 v[48:51], v[28:31], a[48:55], v14
    v_smfmac_f32_16x16x64_bf16 v[52:55], v[28:31], a[72:79], v14
    v_smfmac_f32_16x16x64_bf16 v[56:59], v[28:31], a[96:103], v14
    v_smfmac_f32_16x16x64_bf16 v[60:63], v[28:31], a[120:127], v14
    v_smfmac_f32_16x16x64_bf16 v[64:67], v[28:31], a[144:151], v14
    v_smfmac_f32_16x16x64_bf16 v[68:71], v[28:31], a[168:175], v14
    s_waitcnt lgkmcnt(1)
    v_smfmac_f32_16x16x64_bf16 v[40:43], v[32:35], a[8:15], v14
    v_smfmac_f32_16x16x64_bf16 v[44:47], v[32:35], a[32:39], v14
    v_smfmac_f32_16x16x64_bf16 v[48:51], v[32:35], a[56:63], v14
    v_smfmac_f32_16x16x64_bf16 v[52:55], v[32:35], a[80:87], v14
    v_smfmac_f32_16x16x64_bf16 v[56:59], v[32:35], a[104:111], v14
    v_smfmac_f32_16x16x64_bf16 v[60:63], v[32:35], a[128:135], v14
    v_smfmac_f32_16x16x64_bf16 v[64:67], v[32:35], a[152:159], v14
    v_smfmac_f32_16x16x64_bf16 v[68:71], v[32:35], a[176:183], v14
    s_waitcnt lgkmcnt(0)
    v_smfmac_f32_16x16x64_bf16 v[40:43], v[36:39], a[16:23], v14
    v_smfmac_f32_16x16x64_bf16 v[44:47], v[36:39], a[40:47], v14
    v_smfmac_f32_16x16x64_bf16 v[48:51], v[36:39], a[64:71], v14
    v_smfmac_f32_16x16x64_bf16 v[52:55], v[36:39], a[88:95], v14
    v_smfmac_f32_16x16x64_bf16 v[56:59], v[36:39], a[112:119], v14
    v_smfmac_f32_16x16x64_bf16 v[60:63], v[36:39], a[136:143], v14
    v_smfmac_f32_16x16x64_bf16 v[64:67], v[36:39], a[160:167], v14
    v_smfmac_f32_16x16x64_bf16 v[68:71], v[36:39], a[184:191], v14
    s_nop 0
    v_add_f32 v24, v40, v41
    v_add_f32 v44, v44, v45
    v_add_f32 v48, v48, v49
    v_max3_f32 v26, v24, v44, v48
    v_add_f32 v52, v52, v53
    v_add_f32 v25, v56, v57
    v_max3_f32 v26, v26, v52, v25
    v_add_f32 v60, v60, v61
    v_add_f32 v64, v64, v65
    v_max3_f32 v26, v26, v60, v64
    v_add_f32 v68, v68, v69
    v_max_f32 v26, v26, v68
    v_mov_b32_dpp v24, v44 quad_perm:[0,1,2,3] row_mask:0x2 bank_mask:0xf
    v_mov_b32_dpp v25, v60 quad_perm:[0,1,2,3] row_mask:0x2 bank_mask:0xf
    v_max_f32_dpp v26, v26, v26 row_ror:8 row_mask:0xf bank_mask:0xf
    v_mov_b32_dpp v24, v48 quad_perm:[0,1,2,3] row_mask:0x4 bank_mask:0xf
    v_mov_b32_dpp v25, v64 quad_perm:[0,1,2,3] row_mask:0x4 bank_mask:0xf
    v_max_f32_dpp v26, v26, v26 row_ror:4 row_mask:0xf bank_mask:0xf
    v_mov_b32_dpp v24, v52 quad_perm:[0,1,2,3] row_mask:0x8 bank_mask:0xf
    v_mov_b32_dpp v25, v68 quad_perm:[0,1,2,3] row_mask:0x8 bank_mask:0xf
    v_max_f32_dpp v26, v26, v26 row_ror:2 row_mask:0xf bank_mask:0xf
    v_accvgpr_read_b32 v27, a252
    s_nop 0
    v_max_f32_dpp v26, v26, v26 row_ror:1 row_mask:0xf bank_mask:0xf
    v_mul_f32 v26, v26, v18
    v_fma_f32 v24, v24, v18, -v26
    v_fma_f32 v25, v25, v18, -v26
    v_exp_f32 v24, v24
    v_exp_f32 v25, v25
    s_nop 0
    v_cvt_pk_bf16_f32 v28, v24, v25
    ds_write_b16 v19, v28
    ds_write_b16_d16_hi v19, v28 offset:128
    s_mov_b64 exec, s[88:89]
    ds_read_b128 v[72:75], v27 offset:0
    ds_read_b128 v[76:79], v27 offset:64
    ds_read_b128 v[80:83], v27 offset:128
    ds_read_b128 v[84:87], v27 offset:192
    s_mov_b64 exec, -1
    v_add_f32 v27, v24, v25
    v_mov_b32 v40, 0
    v_mov_b32 v44, 0
    v_add_f32_dpp v27, v27, v27 row_ror:8 row_mask:0xf bank_mask:0xf
    v_mov_b32 v48, 0
    v_mov_b32 v52, 0
    v_add_f32_dpp v27, v27, v27 row_ror:4 row_mask:0xf bank_mask:0xf
    v_mov_b32 v56, 0
    v_mov_b32 v60, 0
    v_add_f32_dpp v27, v27, v27 row_ror:2 row_mask:0xf bank_mask:0xf
    s_lshl_b32 s78, s72, 3
    s_add_u32 s78, s78, 125440
    v_add_f32_dpp v27, v27, v27 row_ror:1 row_mask:0xf bank_mask:0xf
    v_mov_b32 v28, v27
    s_nop 1
    v_permlane32_swap_b32 v27, v28
    v_add_f32 v27, v27, v28
    v_mov_b32 v28, v27
    s_nop 1
    v_permlane16_swap_b32 v27, v28
    v_add_f32 v27, v27, v28
    v_mov_b32 v28, s78
    ds_write_b64 v28, v[26:27]
    s_waitcnt lgkmcnt(4)
    v_smfmac_f32_16x16x64_bf16 v[40:43], v[72:75], a[192:199], v14 abid:1
    v_smfmac_f32_16x16x64_bf16 v[44:47], v[72:75], a[200:207], v14 abid:1
    v_smfmac_f32_16x16x64_bf16 v[48:51], v[72:75], a[208:215], v14 abid:1
    v_smfmac_f32_16x16x64_bf16 v[52:55], v[72:75], a[216:223], v14 abid:1
    v_smfmac_f32_16x16x64_bf16 v[56:59], v[72:75], a[224:231], v14 abid:1
    v_smfmac_f32_16x16x64_bf16 v[60:63], v[72:75], a[232:239], v14 abid:1
    s_waitcnt lgkmcnt(3)
    v_smfmac_f32_16x16x64_bf16 v[40:43], v[76:79], v[112:119], v14 abid:1
    v_smfmac_f32_16x16x64_bf16 v[44:47], v[76:79], v[120:127], v14 abid:1
    v_smfmac_f32_16x16x64_bf16 v[48:51], v[76:79], v[128:135], v14 abid:1
    v_smfmac_f32_16x16x64_bf16 v[52:55], v[76:79], v[136:143], v14 abid:1
    v_smfmac_f32_16x16x64_bf16 v[56:59], v[76:79], v[144:151], v14 abid:1
    v_smfmac_f32_16x16x64_bf16 v[60:63], v[76:79], v[152:159], v14 abid:1
    s_waitcnt lgkmcnt(2)
    v_smfmac_f32_16x16x64_bf16 v[40:43], v[80:83], v[160:167], v14 abid:1
    v_smfmac_f32_16x16x64_bf16 v[44:47], v[80:83], v[168:175], v14 abid:1
    v_smfmac_f32_16x16x64_bf16 v[48:51], v[80:83], v[176:183], v14 abid:1
    v_smfmac_f32_16x16x64_bf16 v[52:55], v[80:83], v[184:191], v14 abid:1
    v_smfmac_f32_16x16x64_bf16 v[56:59], v[80:83], v[192:199], v14 abid:1
    v_smfmac_f32_16x16x64_bf16 v[60:63], v[80:83], v[200:207], v14 abid:1
    s_waitcnt lgkmcnt(0)
ATT_LAST:
    s_waitcnt lgkmcnt(8)
    v_smfmac_f32_16x16x64_bf16 v[40:43], v[84:87], v[208:215], v14 abid:1
    v_smfmac_f32_16x16x64_bf16 v[44:47], v[84:87], v[216:223], v14 abid:1
    s_waitcnt lgkmcnt(4)
    v_smfmac_f32_16x16x64_bf16 v[48:51], v[84:87], v[224:231], v14 abid:1
    v_smfmac_f32_16x16x64_bf16 v[52:55], v[84:87], v[232:239], v14 abid:1
    s_waitcnt lgkmcnt(0)
    v_smfmac_f32_16x16x64_bf16 v[56:59], v[84:87], v[240:247], v14 abid:1
    v_smfmac_f32_16x16x64_bf16 v[60:63], v[84:87], v[248:255], v14 abid:1
    s_lshl_b32 s77, s72, 8
    s_add_u32 s77, s77, 119296
    v_lshl_add_u32 v24, v0, 2, s77
    v_permlane16_swap_b32 v40, v44
    v_add_f32 v40, v40, v44
    ds_write_b32 v15, v40 offset:0
    v_permlane16_swap_b32 v48, v52
    v_add_f32 v48, v48, v52
    ds_write_b32 v15, v48 offset:256
    v_permlane16_swap_b32 v56, v60
    v_add_f32 v56, v56, v60
    ds_write_b32 v15, v56 offset:512
    v_and_b32 v25, 3, v0
    v_lshlrev_b32 v25, 3, v25
    v_add_u32 v25, 125440, v25
    s_waitcnt lgkmcnt(0)
    s_barrier
    ds_read_b64 v[32:33], v25
    ds_read2st64_b32 v[40:41], v24 offset0:0 offset1:3
    ds_read2st64_b32 v[42:43], v24 offset0:6 offset1:9
    s_mul_i32 s77, s70, 3072
    s_lshl_b32 s78, s71, 4
    s_add_u32 s77, s77, s78
    s_lshl_b32 s78, s72, 10
    s_add_u32 s77, s77, s78
    s_add_u32 s77, s77, s3
    s_add_u32 s77, s77, 32768
    s_lshl_b32 s78, s69, 3
    s_add_u32 s78, s78, s3
    s_add_u32 s78, s78, 45056
    s_cmp_eq_u32 s72, 3
    s_waitcnt lgkmcnt(2)
    v_max_f32_dpp v34, v32, v32 quad_perm:[1,0,3,2] row_mask:0xf bank_mask:0xf
    s_nop 1
    v_max_f32_dpp v34, v34, v34 quad_perm:[2,3,0,1] row_mask:0xf bank_mask:0xf
    v_sub_f32 v32, v32, v34
    v_exp_f32 v32, v32
    s_cbranch_scc1 OML
    s_waitcnt lgkmcnt(0)
    v_mul_f32_dpp v28, v32, v40 quad_perm:[0,0,0,0] row_mask:0xf bank_mask:0xf
    v_mul_f32_dpp v29, v32, v41 quad_perm:[1,1,1,1] row_mask:0xf bank_mask:0xf
    v_mul_f32_dpp v30, v32, v42 quad_perm:[2,2,2,2] row_mask:0xf bank_mask:0xf
    v_fmac_f32_dpp v28, v32, v43 quad_perm:[3,3,3,3] row_mask:0xf bank_mask:0xf
    v_add_f32 v29, v29, v30
    v_add_f32 v28, v28, v29
    s_nop 1
    v_mov_b32_dpp v29, v28 row_shl:1 row_mask:0xf bank_mask:0xf
    v_cvt_pk_bf16_f32 v28, v28, v29
    s_nop 1
    v_mov_b32_dpp v29, v28 row_shl:2 row_mask:0xf bank_mask:0xf
    v_mov_b32_dpp v30, v28 row_shl:4 row_mask:0xf bank_mask:0xf
    v_mov_b32_dpp v31, v28 row_shl:6 row_mask:0xf bank_mask:0xf
    s_mov_b64 exec, s[82:83]
    buffer_store_dwordx4 v[28:31], v1, s[8:11], s77 offen
    s_cmp_eq_u32 s10, 0
    s_cbranch_scc1 SLOW7
BACK7:
    s_mov_b64 exec, -1
ODONE:
    s_cmp_ge_u32 s69, 20
    s_cbranch_scc1 ROLEF
    s_cmp_eq_u32 s74, 0
    s_cbranch_scc1 WLATE
    v_accvgpr_read_b32 v2, a246
    v_accvgpr_read_b32 v3, a247
    v_accvgpr_read_b32 v4, a248
    v_mov_b32 v88, 0
    v_mov_b32 v92, 0
    v_mov_b32 v96, 0
    v_mov_b32 v100, 0
    v_mov_b32 v104, 0
    v_mov_b32 v108, 0
    ds_read_b64_tr_b16 v[40:41], v2 offset:0
    ds_read_b64_tr_b16 v[42:43], v2 offset:256
    ds_read_b64_tr_b16 v[64:65], v2 offset:32
    ds_read_b64_tr_b16 v[66:67], v2 offset:288
    ds_read_b64_tr_b16 v[44:45], v2 offset:2048
    ds_read_b64_tr_b16 v[46:47], v2 offset:2304
    ds_read_b64_tr_b16 v[68:69], v2 offset:2080
    ds_read_b64_tr_b16 v[70:71], v2 offset:2336
    ds_read_b64_tr_b16 v[48:49], v2 offset:4096
    ds_read_b64_tr_b16 v[50:51], v2 offset:4352
    s_cmp_lg_u32 s72, 1
    s_cbranch_scc1 NOOWN0
    v_accvgpr_read_b32 v28, a244
    v_accvgpr_read_b32 v29, a245
    v_max_u32 v30, v28, v29
    v_cmp_eq_u32 vcc, -1, v30
    s_cbranch_vccnz RETRY8
OK8:
    v_lshlrev_b32 v30, 16, v28
    v_and_b32 v28, 0xffff0000, v28
    v_lshlrev_b32 v31, 16, v29
    v_and_b32 v29, 0xffff0000, v29
    v_add_f32 v30, v30, v31
    v_add_f32 v28, v28, v29
    v_mov_b32 v31, v30
    v_mov_b32 v29, v28
    s_nop 0
    v_permlane32_swap_b32 v30, v31
    v_permlane32_swap_b32 v28, v29
    v_add_f32 v30, v30, v31
    v_add_f32 v28, v28, v29
    v_mov_b32 v31, v30
    v_mov_b32 v29, v28
    s_nop 0
    v_permlane16_swap_b32 v30, v31
    v_permlane16_swap_b32 v28, v29
    v_add_f32 v30, v30, v31
    v_add_f32 v28, v28, v29
    v_add_f32 v22, v22, v30
    v_add_f32 v23, v23, v28
    v_cvt_pk_bf16_f32 v28, v22, v23
    s_lshl_b32 s77, s69, 6
    s_add_u32 s77, s77, s3
    s_add_u32 s77, s77, 47872
    v_lshlrev_b32 v32, 2, v0
    v_mov_b32_dpp v29, v28 quad_perm:[1,1,1,1] row_mask:0xf bank_mask:0xf
    v_mov_b32_dpp v30, v28 quad_perm:[2,2,2,2] row_mask:0xf bank_mask:0xf
    v_mov_b32_dpp v31, v28 quad_perm:[3,3,3,3] row_mask:0xf bank_mask:0xf
    s_mov_b32 exec_lo, 0x1111
    s_mov_b32 exec_hi, 0x0
    buffer_store_dwordx4 v[28:31], v32, s[8:11], s77 offen
    s_cmp_eq_u32 s10, 0
    s_cbranch_scc1 SLOW9
BACK9:
    s_mov_b64 exec, -1
NOOWN0:
    v_mov_b32 v25, 0
    v_mov_b32 v27, 0
    v_mov_b32 v37, 0
    v_mov_b32 v39, 0
    s_mov_b32 exec_lo, 0x00ff00ff
    s_mov_b32 exec_hi, 0x00ff00ff
    buffer_load_dwordx4 v[88:91], v3, s[16:19], s3 offen offset:0 sc1
    buffer_load_dwordx4 v[92:95], v3, s[16:19], s3 offen offset:512 sc1
    buffer_load_dwordx4 v[96:99], v3, s[16:19], s3 offen offset:1024 sc1
    buffer_load_dwordx4 v[100:103], v3, s[16:19], s3 offen offset:1536 sc1
    buffer_load_dwordx4 v[104:107], v3, s[16:19], s3 offen offset:2048 sc1
    buffer_load_dwordx4 v[108:111], v3, s[16:19], s3 offen offset:2560 sc1
    s_mov_b32 exec_lo, -1
    s_mov_b32 exec_hi, 0
    buffer_load_dwordx4 v[24:27], v4, s[16:19], s3 offen offset:0 sc1
    buffer_load_dwordx4 v[36:39], v4, s[16:19], s3 offen offset:16 sc1
    s_mov_b64 exec, -1
    ds_read_b64_tr_b16 v[72:73], v2 offset:4128
    ds_read_b64_tr_b16 v[74:75], v2 offset:4384
    ds_read_b64_tr_b16 v[52:53], v2 offset:6144
    ds_read_b64_tr_b16 v[54:55], v2 offset:6400
    ds_read_b64_tr_b16 v[76:77], v2 offset:6176
    ds_read_b64_tr_b16 v[78:79], v2 offset:6432
    ds_read_b64_tr_b16 v[56:57], v2 offset:8192
    ds_read_b64_tr_b16 v[58:59], v2 offset:8448
    ds_read_b64_tr_b16 v[80:81], v2 offset:8224
    ds_read_b64_tr_b16 v[82:83], v2 offset:8480
    ds_read_b64_tr_b16 v[60:61], v2 offset:10240
    ds_read_b64_tr_b16 v[62:63], v2 offset:10496
    ds_read_b64_tr_b16 v[84:85], v2 offset:10272
    ds_read_b64_tr_b16 v[86:87], v2 offset:10528
    v_accvgpr_read_b32 v5, a249
    v_and_b32 v18, 3, v0
    v_lshrrev_b32 v6, 5, v0
    v_lshl_add_u32 v18, v6, 2, v18
    v_mul_u32_u24 v18, 10240, v18
    v_bfe_u32 v6, v0, 3, 2
    v_lshl_add_u32 v18, v6, 4, v18
    v_and_b32 v6, 0xffffff7f, v5
WCHK:
    s_waitcnt vmcnt(0)
    v_max3_u32 v28, v88, v92, v96
    v_max3_u32 v28, v28, v100, v104
    v_max3_u32 v28, v28, v108, v25
    v_max3_u32 v28, v28, v27, v37
    v_max_u32 v28, v28, v39
    v_cmp_eq_u32 vcc, -1, v28
    s_cbranch_vccnz AGAIN10
POLLX10:
    s_waitcnt lgkmcnt(0)
    v_mfma_f32_16x16x32_bf16 v[28:31], v[88:91], v[40:43], 0
    v_mfma_f32_16x16x32_bf16 v[32:35], v[88:91], v[64:67], 0
    v_max3_f32 v88, v24, v26, v36
    v_max_f32 v88, v88, v38
    v_mfma_f32_16x16x32_bf16 v[28:31], v[92:95], v[44:47], v[28:31]
    v_mov_b32 v89, v88
    v_mfma_f32_16x16x32_bf16 v[32:35], v[92:95], v[68:71], v[32:35]
    s_nop 0
    v_permlane16_swap_b32 v88, v89
    v_max_f32 v88, v88, v89
    v_mfma_f32_16x16x32_bf16 v[28:31], v[96:99], v[48:51], v[28:31]
    v_sub_f32 v24, v24, v88
    v_sub_f32 v26, v26, v88
    v_mfma_f32_16x16x32_bf16 v[32:35], v[96:99], v[72:75], v[32:35]
    v_sub_f32 v36, v36, v88
    v_sub_f32 v38, v38, v88
    v_mfma_f32_16x16x32_bf16 v[28:31], v[100:103], v[52:55], v[28:31]
    v_exp_f32 v24, v24
    v_mfma_f32_16x16x32_bf16 v[32:35], v[100:103], v[76:79], v[32:35]
    v_exp_f32 v26, v26
    v_mfma_f32_16x16x32_bf16 v[28:31], v[104:107], v[56:59], v[28:31]
    v_exp_f32 v36, v36
    v_mfma_f32_16x16x32_bf16 v[32:35], v[104:107], v[80:83], v[32:35]
    v_exp_f32 v38, v38
    v_mfma_f32_16x16x32_bf16 v[28:31], v[108:111], v[60:63], v[28:31]
    v_mul_f32 v90, v24, v25
    v_fmac_f32 v90, v26, v27
    v_mfma_f32_16x16x32_bf16 v[32:35], v[108:111], v[84:87], v[32:35]
    v_fmac_f32 v90, v36, v37
    v_fmac_f32 v90, v38, v39
    v_mov_b32 v89, v90
    s_cmp_lg_u32 s72, 0
    s_nop 0
    v_permlane16_swap_b32 v90, v89
    v_add_f32 v90, v90, v89
    v_rcp_f32 v90, v90
    v_mul_f32 v28, v24, v28
    v_mul_f32 v32, v24, v32
    v_fmac_f32 v28, v26, v29
    v_fmac_f32 v32, v26, v33
    v_fmac_f32 v28, v36, v30
    v_fmac_f32 v32, v36, v34
    v_fmac_f32 v28, v38, v31
    v_fmac_f32 v32, v38, v35
    s_nop 1
    v_permlane16_swap_b32 v28, v32
    v_add_f32 v28, v28, v32
    v_mul_f32 v28, v28, v90
    ds_write_b32 v5, v28
    s_waitcnt lgkmcnt(0)
    s_barrier
    s_cbranch_scc1 WNOT0
    ds_read2st64_b32 v[28:29], v6 offset0:0 offset1:1
    ds_read2st64_b32 v[30:31], v6 offset0:2 offset1:3
    s_waitcnt lgkmcnt(1)
    v_add_f32 v28, v28, v29
    s_waitcnt lgkmcnt(0)
    v_add_f32 v30, v30, v31
    v_add_f32 v28, v28, v30
    s_nop 1
    v_mov_b32_dpp v29, v28 row_shl:1 row_mask:0xf bank_mask:0xf
    v_cvt_pk_bf16_f32 v32, v28, v29
    s_nop 1
    v_mov_b32_dpp v28, v32 quad_perm:[0,0,0,0] row_mask:0xf bank_mask:0xf
    v_mov_b32_dpp v29, v32 quad_perm:[2,2,2,2] row_mask:0xf bank_mask:0xf
    s_nop 0
    v_mov_b32_dpp v30, v28 row_shl:4 row_mask:0xf bank_mask:0xf
    v_mov_b32_dpp v31, v29 row_shl:4 row_mask:0xf bank_mask:0xf
    s_mov_b64 exec, s[46:47]
    buffer_store_dwordx4 v[28:31], v18, s[16:19], s80 offen sc1
    s_mov_b64 exec, s[92:93]
    buffer_store_dwordx4 v[28:31], v18, s[8:11], s81 offen
    s_cmp_eq_u32 s10, 0
    s_cbranch_scc1 SLOW11
BACK11:
    s_mov_b64 exec, -1
    v_add_u32 v111, 49152, v2
    s_cmp_lg_u32 s74, 0
    s_cbranch_scc1 W2OK
    v_lshrrev_b32 v38, 2, v0
    v_mul_u32_u24 v38, 1280, v38
    v_and_b32 v39, 3, v0
    v_lshl_add_u32 v39, v39, 4, v38
    s_mul_i32 s77, s68, 245760
    s_lshl_b32 s78, s69, 6
    s_add_u32 s77, s77, s78
    s_mov_b32 m0, 106496
    s_nop 0
    buffer_load_dwordx4 v39, s[32:35], s77 offen lds
    s_add_u32 s77, s77, 20480
    s_mov_b32 m0, 107520
    s_nop 0
    buffer_load_dwordx4 v39, s[32:35], s77 offen lds
    s_add_u32 s77, s77, 20480
    s_mov_b32 m0, 108544
    s_nop 0
    buffer_load_dwordx4 v39, s[32:35], s77 offen lds
    s_add_u32 s77, s77, 20480
    s_mov_b32 m0, 109568
    s_nop 0
    buffer_load_dwordx4 v39, s[32:35], s77 offen lds
    s_add_u32 s77, s77, 20480
    s_mov_b32 m0, 110592
    s_nop 0
    buffer_load_dwordx4 v39, s[32:35], s77 offen lds
    s_add_u32 s77, s77, 20480
    s_mov_b32 m0, 111616
    s_nop 0
    buffer_load_dwordx4 v39, s[32:35], s77 offen lds
    s_add_u32 s77, s77, 20480
    s_mov_b32 m0, 112640
    s_nop 0
    buffer_load_dwordx4 v39, s[32:35], s77 offen lds
    s_add_u32 s77, s77, 20480
    s_mov_b32 m0, 113664
    s_nop 0
    buffer_load_dwordx4 v39, s[32:35], s77 offen lds
    s_add_u32 s77, s77, 20480
    s_mov_b32 m0, 114688
    s_nop 0
    buffer_load_dwordx4 v39, s[32:35], s77 offen lds
    s_add_u32 s77, s77, 20480
    s_mov_b32 m0, 115712
    s_nop 0
    buffer_load_dwordx4 v39, s[32:35], s77 offen lds
    s_add_u32 s77, s77, 20480
    s_mov_b32 m0, 116736
    s_nop 0
    buffer_load_dwordx4 v39, s[32:35], s77 offen lds
    s_add_u32 s77, s77, 20480
    s_mov_b32 m0, 117760
    s_nop 0
    buffer_load_dwordx4 v39, s[32:35], s77 offen lds
    s_add_u32 s77, s77, 20480
    s_branch W2X
W2OK:
    ds_read_b64_tr_b16 v[40:41], v111 offset:0
    ds_read_b64_tr_b16 v[42:43], v111 offset:256
    ds_read_b64_tr_b16 v[64:65], v111 offset:32
    ds_read_b64_tr_b16 v[66:67], v111 offset:288
    ds_read_b64_tr_b16 v[44:45], v111 offset:2048
    ds_read_b64_tr_b16 v[46:47], v111 offset:2304
    ds_read_b64_tr_b16 v[68:69], v111 offset:2080
    ds_read_b64_tr_b16 v[70:71], v111 offset:2336
    ds_read_b64_tr_b16 v[48:49], v111 offset:4096
    ds_read_b64_tr_b16 v[50:51], v111 offset:4352
    ds_read_b64_tr_b16 v[72:73], v111 offset:4128
    ds_read_b64_tr_b16 v[74:75], v111 offset:4384
    ds_read_b64_tr_b16 v[52:53], v111 offset:6144
    ds_read_b64_tr_b16 v[54:55], v111 offset:6400
    ds_read_b64_tr_b16 v[76:77], v111 offset:6176
    ds_read_b64_tr_b16 v[78:79], v111 offset:6432
    ds_read_b64_tr_b16 v[56:57], v111 offset:8192
    ds_read_b64_tr_b16 v[58:59], v111 offset:8448
    ds_read_b64_tr_b16 v[80:81], v111 offset:8224
    ds_read_b64_tr_b16 v[82:83], v111 offset:8480
    ds_read_b64_tr_b16 v[60:61], v111 offset:10240
    ds_read_b64_tr_b16 v[62:63], v111 offset:10496
    ds_read_b64_tr_b16 v[84:85], v111 offset:10272
    ds_read_b64_tr_b16 v[86:87], v111 offset:10528
W2X:
    v_mov_b32 v100, 0
    v_mov_b32 v101, 0
    v_mov_b32 v104, 0
    v_mov_b32 v105, 0
    s_add_u32 s96, s80, 81920
    s_add_u32 s97, s81, 1280
STB:
    s_mul_i32 s77, s72, 48
    v_min_u32 v6, 47, v0
    v_add_u32 v6, s77, v6
    v_lshlrev_b32 v4, 4, v6
    v_add_u32 v5, 3072, v4
    v_add_u32 v108, 6400, v4
    v_cmp_le_u32 vcc, 48, v0
    v_mov_b32 v24, 6144
    v_mov_b32 v25, 6160
    v_cndmask_b32 v4, v4, v24, vcc
    v_cndmask_b32 v5, v5, v25, vcc
    v_lshrrev_b32 v24, 4, v6
    v_lshlrev_b32 v24, 5, v24
    v_bfe_u32 v25, v6, 1, 1
    v_lshl_add_u32 v24, v25, 4, v24
    v_bfe_u32 v25, v6, 2, 2
    v_lshl_add_u32 v24, v25, 2, v24
    v_and_b32 v25, 1, v6
    v_lshl_add_u32 v24, v25, 1, v24
    v_add_u32 v24, 118784, v24
    v_mov_b32 v25, 119168
    v_cndmask_b32 v6, v24, v25, vcc
    v_mov_b32 v109, 0x3727c5ac
    v_mov_b32 v110, 0x3acccccd
    s_add_u32 s79, s3, 50432
    v_accvgpr_read_b32 v2, a250
    v_accvgpr_read_b32 v3, a251
    s_add_u32 s6, s74, s72
    s_mov_b32 s76, 1
    s_cmp_eq_u32 s74, 0
    s_cbranch_scc1 GPF
GPO:
    s_cmp_eq_u32 s72, 1
    s_cbranch_scc1 WOWN
GP1:
    buffer_load_dwordx4 v[24:27], v4, s[16:19], s79 offen sc1
    buffer_load_dwordx4 v[28:31], v5, s[16:19], s79 offen sc1
    s_waitcnt vmcnt(0)
    v_add_f32 v24, v24, v25
    v_add_f32 v28, v28, v29
    v_add_f32 v26, v26, v27
    v_add_f32 v30, v30, v31
    v_add_f32 v28, v28, v30
    v_add_f32 v24, v24, v26
    v_cmp_u_f32 vcc, v24, v28
    s_cbranch_vccnz GA1
GPX:
    v_readlane_b32 s77, v28, 48
    v_readlane_b32 s78, v24, 48
    s_cmp_lg_u32 s6, 1
    s_cbranch_scc0 OWL
OWB:
    v_mul_f32 v25, s77, v110
    v_fma_f32 v26, s78, v110, v109
    v_fma_f32 v26, -v25, v25, v26
    v_add_f32 v25, 1.0, v25
    v_max_f32 v26, v26, v109
    v_fma_f32 v24, -v25, v2, v24
    v_rsq_f32 v27, v26
    v_mul_f32 v29, 0xbfb8aa3b, v24
    v_mul_f32 v29, v29, v27
    v_exp_f32 v29, v29
    v_fma_f32 v28, -v25, v3, v28
    v_fma_f32 v29, v29, v26, v26
    v_rcp_f32 v29, v29
    v_mul_f32 v28, v28, v24
    v_mul_f32 v28, v28, v29
    v_cvt_pk_bf16_f32 v28, v28, v28
    ds_write_b16 v6, v28
    v_accvgpr_write_b32 a250, v2
    v_accvgpr_write_b32 a251, v3
    s_cmp_lg_u32 s72, 0
    s_waitcnt lgkmcnt(0)
    s_barrier
    s_cbranch_scc1 STBX
    ds_read_b128 v[88:91], v13 offset:0
    ds_read_b128 v[92:95], v13 offset:128
    ds_read_b128 v[96:99], v13 offset:256
    s_waitcnt lgkmcnt(2)
    v_smfmac_f32_16x16x64_bf16 v[100:103], v[88:91], v[40:47], v14
    v_smfmac_f32_16x16x64_bf16 v[104:107], v[88:91], v[64:71], v14
    s_waitcnt lgkmcnt(1)
    v_smfmac_f32_16x16x64_bf16 v[100:103], v[92:95], v[48:55], v14
    v_smfmac_f32_16x16x64_bf16 v[104:107], v[92:95], v[72:79], v14
    s_waitcnt lgkmcnt(0)
    v_smfmac_f32_16x16x64_bf16 v[100:103], v[96:99], v[56:63], v14
    v_smfmac_f32_16x16x64_bf16 v[104:107], v[96:99], v[80:87], v14
    s_nop 6
    v_add_f32 v28, v100, v101
    s_nop 1
    v_add_f32_dpp v28, v104, v105 quad_perm:[0,1,2,3] row_mask:0xa bank_mask:0xf
    s_nop 1
    v_mov_b32_dpp v29, v28 row_shl:1 row_mask:0xf bank_mask:0xf
    v_cvt_pk_bf16_f32 v32, v28, v29
    s_nop 1
    v_mov_b32_dpp v28, v32 quad_perm:[0,0,0,0] row_mask:0xf bank_mask:0xf
    v_mov_b32_dpp v29, v32 quad_perm:[2,2,2,2] row_mask:0xf bank_mask:0xf
    s_nop 0
    v_mov_b32_dpp v30, v28 row_shl:4 row_mask:0xf bank_mask:0xf
    v_mov_b32_dpp v31, v29 row_shl:4 row_mask:0xf bank_mask:0xf
    s_mov_b64 exec, s[48:49]
    buffer_store_dwordx4 v[28:31], v18, s[16:19], s96 offen sc1
    s_mov_b64 exec, s[92:93]
    buffer_store_dwordx4 v[28:31], v18, s[8:11], s97 offen
    s_cmp_eq_u32 s10, 0
    s_cbranch_scc1 SLOW12
BACK12:
    s_mov_b64 exec, -1
    s_branch NEXT
AGAIN3:
    s_add_u32 s76, s76, 1
    s_cmp_lt_u32 s76, 32768
    s_cbranch_scc1 POLL3
    s_branch POLLX3
BR4:
    s_cmp_ge_u32 s76, 32768
    s_cbranch_scc1 BX4
BL4:
    s_mov_b64 exec, s[86:87]
    v_cmp_eq_u32 vcc, -1, v80
    s_nop 0
    s_mov_b64 exec, vcc
    s_cbranch_execz BS4_0
    buffer_load_dwordx4 v[80:83], v8, s[16:19], 0 offen sc1
BS4_0:
    s_mov_b64 exec, s[86:87]
    v_cmp_eq_u32 vcc, -1, v84
    s_nop 0
    s_mov_b64 exec, vcc
    s_cbranch_execz BS4_1
    buffer_load_dwordx4 v[84:87], v9, s[16:19], 0 offen sc1
BS4_1:
    s_mov_b64 exec, s[86:87]
    s_add_u32 s76, s76, 1
    s_cmp_ge_u32 s76, 32768
    s_waitcnt vmcnt(0)
    v_max_u32 v24, v80, v84
    v_cmp_eq_u32 vcc, -1, v24
    s_cbranch_vccz BW4
    s_cbranch_scc0 BL4
    s_branch BW4
AGAIN6:
    s_add_u32 s76, s76, 1
    s_cmp_lt_u32 s76, 32768
    s_cbranch_scc1 POLL6
    s_branch POLLX6
OML:
    v_mul_f32 v35, v32, v33
    s_nop 1
    v_add_f32_dpp v35, v35, v35 quad_perm:[1,0,3,2] row_mask:0xf bank_mask:0xf
    s_nop 1
    v_add_f32_dpp v35, v35, v35 quad_perm:[2,3,0,1] row_mask:0xf bank_mask:0xf
    s_mov_b64 exec, 1
    buffer_store_dwordx2 v[34:35], v1, s[8:11], s78 offen
    s_cmp_eq_u32 s10, 0
    s_cbranch_scc1 SLOW13
BACK13:
    s_mov_b64 exec, -1
    s_waitcnt lgkmcnt(0)
    s_branch ODONE
WLATE:
    v_lshrrev_b32 v38, 2, v0
    v_mul_u32_u24 v38, 1280, v38
    v_and_b32 v39, 3, v0
    v_lshl_add_u32 v39, v39, 4, v38
    s_mov_b32 m0, s67
    s_add_u32 s67, s67, 1024
    buffer_load_dwordx4 v39, s[24:27], s66 offen  lds
    s_add_u32 s66, s66, 20480
    s_mov_b32 m0, s67
    s_add_u32 s67, s67, 1024
    buffer_load_dwordx4 v39, s[24:27], s66 offen  lds
    s_add_u32 s66, s66, 20480
    s_mov_b32 m0, s67
    s_add_u32 s67, s67, 1024
    buffer_load_dwordx4 v39, s[24:27], s66 offen  lds
    s_add_u32 s66, s66, 20480
    s_mov_b32 m0, s67
    s_add_u32 s67, s67, 1024
    buffer_load_dwordx4 v39, s[24:27], s66 offen  lds
    s_add_u32 s66, s66, 20480
    s_mov_b32 m0, s67
    s_add_u32 s67, s67, 1024
    buffer_load_dwordx4 v39, s[24:27], s66 offen  lds
    s_add_u32 s66, s66, 20480
    s_mov_b32 m0, s67
    s_add_u32 s67, s67, 1024
    buffer_load_dwordx4 v39, s[24:27], s66 offen  lds
    s_add_u32 s66, s66, 20480
    s_add_u32 s77, s3, 1638400
    buffer_store_dword v7, v10, s[8:11], s77 offen
    s_cmp_eq_u32 s10, 0
    s_cbranch_scc1 SLOW14
BACK14:
    v_accvgpr_read_b32 v2, a246
    v_accvgpr_read_b32 v3, a247
    v_accvgpr_read_b32 v4, a248
    v_mov_b32 v88, 0
    v_mov_b32 v92, 0
    v_mov_b32 v96, 0
    v_mov_b32 v100, 0
    v_mov_b32 v104, 0
    v_mov_b32 v108, 0
    v_mov_b32 v25, 0
    v_mov_b32 v27, 0
    v_mov_b32 v37, 0
    v_mov_b32 v39, 0
    s_mov_b32 exec_lo, 0x00ff00ff
    s_mov_b32 exec_hi, 0x00ff00ff
    buffer_load_dwordx4 v[88:91], v3, s[16:19], s3 offen offset:0 sc1
    buffer_load_dwordx4 v[92:95], v3, s[16:19], s3 offen offset:512 sc1
    buffer_load_dwordx4 v[96:99], v3, s[16:19], s3 offen offset:1024 sc1
    buffer_load_dwordx4 v[100:103], v3, s[16:19], s3 offen offset:1536 sc1
    buffer_load_dwordx4 v[104:107], v3, s[16:19], s3 offen offset:2048 sc1
    buffer_load_dwordx4 v[108:111], v3, s[16:19], s3 offen offset:2560 sc1
    s_mov_b32 exec_lo, -1
    s_mov_b32 exec_hi, 0
    buffer_load_dwordx4 v[24:27], v4, s[16:19], s3 offen offset:0 sc1
    buffer_load_dwordx4 v[36:39], v4, s[16:19], s3 offen offset:16 sc1
    s_mov_b64 exec, -1
    s_waitcnt vmcnt(8)
    ds_read_b64_tr_b16 v[40:41], v2 offset:0
    ds_read_b64_tr_b16 v[42:43], v2 offset:256
    ds_read_b64_tr_b16 v[64:65], v2 offset:32
    ds_read_b64_tr_b16 v[66:67], v2 offset:288
    ds_read_b64_tr_b16 v[44:45], v2 offset:2048
    ds_read_b64_tr_b16 v[46:47], v2 offset:2304
    ds_read_b64_tr_b16 v[68:69], v2 offset:2080
    ds_read_b64_tr_b16 v[70:71], v2 offset:2336
    ds_read_b64_tr_b16 v[48:49], v2 offset:4096
    ds_read_b64_tr_b16 v[50:51], v2 offset:4352
    s_lshl_b32 s77, s68, 2
    s_add_u32 s77, s77, s72
    s_mul_i32 s77, s77, 61440
    s_lshl_b32 s78, s69, 6
    s_add_u32 s77, s77, s78
    v_min_u32 v35, 47, v0
    v_mul_u32_u24 v35, 1280, v35
    v_add_u32 v35, s77, v35
    ds_read_b64_tr_b16 v[72:73], v2 offset:4128
    ds_read_b64_tr_b16 v[74:75], v2 offset:4384
    ds_read_b64_tr_b16 v[52:53], v2 offset:6144
    ds_read_b64_tr_b16 v[54:55], v2 offset:6400
    ds_read_b64_tr_b16 v[76:77], v2 offset:6176
    ds_read_b64_tr_b16 v[78:79], v2 offset:6432
    ds_read_b64_tr_b16 v[56:57], v2 offset:8192
    ds_read_b64_tr_b16 v[58:59], v2 offset:8448
    ds_read_b64_tr_b16 v[80:81], v2 offset:8224
    ds_read_b64_tr_b16 v[82:83], v2 offset:8480
    ds_read_b64_tr_b16 v[60:61], v2 offset:10240
    ds_read_b64_tr_b16 v[62:63], v2 offset:10496
    ds_read_b64_tr_b16 v[84:85], v2 offset:10272
    ds_read_b64_tr_b16 v[86:87], v2 offset:10528
    v_accvgpr_read_b32 v5, a249
    v_and_b32 v18, 3, v0
    v_lshrrev_b32 v6, 5, v0
    v_lshl_add_u32 v18, v6, 2, v18
    v_mul_u32_u24 v18, 10240, v18
    v_bfe_u32 v6, v0, 3, 2
    v_lshl_add_u32 v18, v6, 4, v18
    v_and_b32 v6, 0xffffff7f, v5
    s_branch WCHK
AGAIN10:
    s_mov_b64 s[94:95], exec
    s_mov_b32 s76, 1
AG210:
    v_max3_u32 v28, v88, v92, v96
    v_max3_u32 v28, v28, v100, v104
    v_max_u32 v28, v28, v108
    v_cmp_eq_u32 vcc, -1, v28
    s_nop 0
    s_mov_b64 exec, vcc
    s_cbranch_execz AG310_0
    buffer_load_dwordx4 v[88:91], v3, s[16:19], s3 offen offset:0 sc1
    buffer_load_dwordx4 v[92:95], v3, s[16:19], s3 offen offset:512 sc1
    buffer_load_dwordx4 v[96:99], v3, s[16:19], s3 offen offset:1024 sc1
    buffer_load_dwordx4 v[100:103], v3, s[16:19], s3 offen offset:1536 sc1
    buffer_load_dwordx4 v[104:107], v3, s[16:19], s3 offen offset:2048 sc1
    buffer_load_dwordx4 v[108:111], v3, s[16:19], s3 offen offset:2560 sc1
AG310_0:
    s_mov_b64 exec, s[94:95]
    v_max3_u32 v28, v25, v27, v37
    v_max_u32 v28, v28, v39
    v_cmp_eq_u32 vcc, -1, v28
    s_nop 0
    s_mov_b64 exec, vcc
    s_cbranch_execz AG310_1
    buffer_load_dwordx4 v[24:27], v4, s[16:19], s3 offen offset:0 sc1
    buffer_load_dwordx4 v[36:39], v4, s[16:19], s3 offen offset:16 sc1
AG310_1:
    s_mov_b64 exec, s[94:95]
    s_add_u32 s76, s76, 1
    s_cmp_ge_u32 s76, 32768
    s_waitcnt vmcnt(0)
    v_max3_u32 v28, v88, v92, v96
    v_max3_u32 v28, v28, v100, v104
    v_max3_u32 v28, v28, v108, v25
    v_max3_u32 v28, v28, v27, v37
    v_max_u32 v28, v28, v39
    v_cmp_eq_u32 vcc, -1, v28
    s_cbranch_vccz POLLX10
    s_cbranch_scc0 AG210
    s_branch POLLX10
GA1:
    s_add_u32 s76, s76, 1
    s_cmp_lt_u32 s76, 32768
    s_cbranch_scc1 GP1
    s_branch GPX
GPF:
    s_cmp_lg_u32 s72, 0
    s_cbranch_scc1 GP0
    buffer_load_dwordx4 v[32:35], v108, s[16:19], s79 offen sc1
    buffer_load_dwordx4 v[36:39], v108, s[16:19], s79 offen offset:3072 sc1
    s_waitcnt vmcnt(2)
    ds_read_b64_tr_b16 v[40:41], v111 offset:0
    ds_read_b64_tr_b16 v[42:43], v111 offset:256
    ds_read_b64_tr_b16 v[64:65], v111 offset:32
    ds_read_b64_tr_b16 v[66:67], v111 offset:288
    ds_read_b64_tr_b16 v[44:45], v111 offset:2048
    ds_read_b64_tr_b16 v[46:47], v111 offset:2304
    ds_read_b64_tr_b16 v[68:69], v111 offset:2080
    ds_read_b64_tr_b16 v[70:71], v111 offset:2336
    ds_read_b64_tr_b16 v[48:49], v111 offset:4096
    ds_read_b64_tr_b16 v[50:51], v111 offset:4352
    ds_read_b64_tr_b16 v[72:73], v111 offset:4128
    ds_read_b64_tr_b16 v[74:75], v111 offset:4384
    ds_read_b64_tr_b16 v[52:53], v111 offset:6144
    ds_read_b64_tr_b16 v[54:55], v111 offset:6400
    ds_read_b64_tr_b16 v[76:77], v111 offset:6176
    ds_read_b64_tr_b16 v[78:79], v111 offset:6432
    ds_read_b64_tr_b16 v[56:57], v111 offset:8192
    ds_read_b64_tr_b16 v[58:59], v111 offset:8448
    ds_read_b64_tr_b16 v[80:81], v111 offset:8224
    ds_read_b64_tr_b16 v[82:83], v111 offset:8480
    ds_read_b64_tr_b16 v[60:61], v111 offset:10240
    ds_read_b64_tr_b16 v[62:63], v111 offset:10496
    ds_read_b64_tr_b16 v[84:85], v111 offset:10272
    ds_read_b64_tr_b16 v[86:87], v111 offset:10528
    s_branch GPW
GP0:
    buffer_load_dwordx4 v[32:35], v108, s[16:19], s79 offen sc1
    buffer_load_dwordx4 v[36:39], v108, s[16:19], s79 offen offset:3072 sc1
GPW:
    s_add_u32 s76, s76, 1
    s_cmp_ge_u32 s76, 32768
    s_waitcnt vmcnt(0)
    v_add_f32 v2, v32, v33
    v_add_f32 v3, v36, v37
    v_add_f32 v34, v34, v35
    v_add_f32 v38, v38, v39
    v_add_f32 v2, v2, v34
    v_add_f32 v3, v3, v38
    v_cmp_u_f32 vcc, v2, v3
    s_cbranch_scc1 GPO
    s_cbranch_vccnz GP0
    s_branch GPO
OWL:
    buffer_load_dword v34, v37, s[16:19], 0 offen sc1
    buffer_load_dword v35, v38, s[16:19], 0 offen sc1
    s_branch OWB
WNOT0:
    s_cmp_lg_u32 s74, 0
    s_cbranch_scc1 STB
    s_cmp_eq_u32 s72, 1
    s_cbranch_scc1 WPREP
    s_cmp_eq_u32 s72, 3
    s_cbranch_scc1 WLC
    v_mov_b32 v52, -1
    v_mov_b32 v53, -1
    v_mov_b32 v54, -1
    v_mov_b32 v55, -1
    s_add_u32 s77, s80, 819200
    s_add_u32 s7, s77, 81920
    s_sleep 8
    s_mov_b64 exec, s[44:45]
    buffer_store_dwordx4 v[52:55], v18, s[16:19], s77 offen sc1
    s_mov_b64 exec, s[92:93]
    buffer_store_dwordx4 v[52:55], v18, s[16:19], s7 offen sc1
    s_mov_b64 exec, -1
    s_branch WPREP
WLC:
    s_mul_i32 s77, s69, 1216
    s_add_u32 s78, s3, 851968
    v_add_u32 v100, s77, v1
    v_min_u32 v100, 24048, v100
    s_add_u32 s77, s77, 1024
    v_add_u32 v101, s77, v1
    v_min_u32 v101, 24048, v101
    s_add_u32 s77, s77, 1024
    v_mov_b32 v104, -1
    v_mov_b32 v105, -1
    v_mov_b32 v106, -1
    v_mov_b32 v107, -1
    ds_read_b64_tr_b16 v[40:41], v16 offset:0
    ds_read_b64_tr_b16 v[42:43], v16 offset:1536
    ds_read_b64_tr_b16 v[44:45], v16 offset:12288
    ds_read_b64_tr_b16 v[46:47], v16 offset:13824
    ds_read_b64_tr_b16 v[48:49], v17 offset:24576
    ds_read_b64_tr_b16 v[50:51], v16 offset:32
    ds_read_b64_tr_b16 v[52:53], v16 offset:1568
    ds_read_b64_tr_b16 v[54:55], v16 offset:12320
    ds_read_b64_tr_b16 v[56:57], v16 offset:13856
    ds_read_b64_tr_b16 v[58:59], v17 offset:24608
    ds_read_b64_tr_b16 v[60:61], v16 offset:64
    ds_read_b64_tr_b16 v[62:63], v16 offset:1600
    ds_read_b64_tr_b16 v[64:65], v16 offset:12352
    ds_read_b64_tr_b16 v[66:67], v16 offset:13888
    ds_read_b64_tr_b16 v[68:69], v17 offset:24640
    v_and_b32 v25, 15, v0
    v_cmp_eq_u32 vcc, 12, v25
    v_mov_b32 v36, 0x3f803f80
    s_nop 0
    v_cndmask_b32 v70, 0, v36, vcc
    v_mov_b32 v71, v70
    v_mov_b32 v72, v70
    v_mov_b32 v73, v70
    v_mov_b32 v74, v70
    v_mov_b32 v75, v70
    v_mov_b32 v76, v70
    v_mov_b32 v77, v70
    v_mov_b32 v78, v70
    v_mov_b32 v79, v70
    s_mul_i32 s77, s72, 6656
    v_mul_u32_u24 v96, 103, v0
    v_lshrrev_b32 v96, 10, v96
    v_lshl_add_u32 v96, v96, 4, v1
    v_add_u32 v96, s77, v96
    v_mul_u32_u24 v97, 176, v25
    v_add_u32 v97, s77, v97
    v_lshrrev_b32 v28, 4, v0
    v_lshl_add_u32 v98, v28, 3, v97
    v_lshl_add_u32 v97, v28, 4, v97
    buffer_store_dwordx4 v[104:107], v100, s[8:11], s78 offen
    s_cmp_eq_u32 s10, 0
    s_cbranch_scc1 SLOW15
BACK15:
    buffer_store_dwordx4 v[104:107], v101, s[8:11], s78 offen
    s_cmp_eq_u32 s10, 0
    s_cbranch_scc1 SLOW16
BACK16:
    s_branch STB
WPREP:
    s_nop 1
    ds_read_b64_tr_b16 v[40:41], v16 offset:0
    ds_read_b64_tr_b16 v[42:43], v16 offset:1536
    ds_read_b64_tr_b16 v[44:45], v16 offset:12288
    ds_read_b64_tr_b16 v[46:47], v16 offset:13824
    ds_read_b64_tr_b16 v[48:49], v17 offset:24576
    ds_read_b64_tr_b16 v[50:51], v16 offset:32
    ds_read_b64_tr_b16 v[52:53], v16 offset:1568
    ds_read_b64_tr_b16 v[54:55], v16 offset:12320
    ds_read_b64_tr_b16 v[56:57], v16 offset:13856
    ds_read_b64_tr_b16 v[58:59], v17 offset:24608
    ds_read_b64_tr_b16 v[60:61], v16 offset:64
    ds_read_b64_tr_b16 v[62:63], v16 offset:1600
    ds_read_b64_tr_b16 v[64:65], v16 offset:12352
    ds_read_b64_tr_b16 v[66:67], v16 offset:13888
    ds_read_b64_tr_b16 v[68:69], v17 offset:24640
    v_and_b32 v25, 15, v0
    v_cmp_eq_u32 vcc, 12, v25
    v_mov_b32 v36, 0x3f803f80
    s_nop 0
    v_cndmask_b32 v70, 0, v36, vcc
    v_mov_b32 v71, v70
    v_mov_b32 v72, v70
    v_mov_b32 v73, v70
    v_mov_b32 v74, v70
    v_mov_b32 v75, v70
    v_mov_b32 v76, v70
    v_mov_b32 v77, v70
    v_mov_b32 v78, v70
    v_mov_b32 v79, v70
    s_mul_i32 s77, s72, 6656
    v_mul_u32_u24 v96, 103, v0
    v_lshrrev_b32 v96, 10, v96
    v_lshl_add_u32 v96, v96, 4, v1
    v_add_u32 v96, s77, v96
    v_mul_u32_u24 v97, 176, v25
    v_add_u32 v97, s77, v97
    v_lshrrev_b32 v28, 4, v0
    v_lshl_add_u32 v98, v28, 3, v97
    v_lshl_add_u32 v97, v28, 4, v97
    s_branch STB
WOWN:
    v_and_b32 v25, 15, v0
    v_lshrrev_b32 v26, 4, v0
    s_mul_i32 s7, s68, 10240
    s_cmp_eq_u32 s74, 0
    s_cselect_b32 s7, 0, s7
    s_add_u32 s7, s7, 655360
    v_mul_u32_u24 v37, 1280, v26
    v_add_u32 v37, s7, v37
    s_mul_i32 s7, s68, 81920
    s_add_u32 s7, s7, 45312
    v_mov_b32 v38, s7
    v_cmp_eq_u32 vcc, s68, v26
    s_nop 1
    v_cndmask_b32 v37, v37, v38, vcc
    v_add_u32 v39, 4, v26
    s_mul_i32 s7, s68, 10240
    s_cmp_eq_u32 s74, 0
    s_cselect_b32 s7, 0, s7
    s_add_u32 s7, s7, 655360
    v_mul_u32_u24 v38, 1280, v39
    v_add_u32 v38, s7, v38
    s_mul_i32 s7, s68, 81920
    s_add_u32 s7, s7, 45312
    v_mov_b32 v28, s7
    v_cmp_eq_u32 vcc, s68, v39
    s_nop 1
    v_cndmask_b32 v38, v38, v28, vcc
    s_lshl_b32 s77, s69, 6
    s_add_u32 s77, s77, s74
    v_lshl_add_u32 v25, v25, 2, s77
    v_add_u32 v37, v25, v37
    v_add_u32 v38, v25, v38
    s_cmp_eq_u32 s74, 0
    s_cbranch_scc1 GP1
    s_sleep 13
    s_mov_b32 s76, 1
POLL17:
    buffer_load_dword v28, v37, s[16:19], 0 offen sc1
    buffer_load_dword v29, v38, s[16:19], 0 offen sc1
POLLW17:
    s_waitcnt vmcnt(0)
    v_max_u32 v30, v28, v29
    v_cmp_eq_u32 vcc, -1, v30
    s_cbranch_vccnz AGAIN17
POLLX17:
    v_lshlrev_b32 v30, 16, v28
    v_and_b32 v28, 0xffff0000, v28
    v_lshlrev_b32 v31, 16, v29
    v_and_b32 v29, 0xffff0000, v29
    v_add_f32 v30, v30, v31
    v_add_f32 v28, v28, v29
    v_mov_b32 v31, v30
    v_mov_b32 v29, v28
    s_nop 0
    v_permlane32_swap_b32 v30, v31
    v_permlane32_swap_b32 v28, v29
    v_add_f32 v30, v30, v31
    v_add_f32 v28, v28, v29
    v_mov_b32 v31, v30
    v_mov_b32 v29, v28
    s_nop 0
    v_permlane16_swap_b32 v30, v31
    v_permlane16_swap_b32 v28, v29
    v_add_f32 v30, v30, v31
    v_add_f32 v28, v28, v29
    v_add_f32 v22, v22, v30
    v_add_f32 v23, v23, v28
    v_cvt_pk_bf16_f32 v28, v22, v23
    s_branch GP1
STBX:
    s_cmp_lg_u32 s72, 1
    s_cbranch_scc1 NEXT
    s_cmp_lg_u32 s74, 0
    s_cbranch_scc1 FINAL
    s_waitcnt vmcnt(0)
    v_mov_b32 v28, v34
    v_mov_b32 v29, v35
    v_max_u32 v30, v28, v29
    v_cmp_eq_u32 vcc, -1, v30
    s_cbranch_vccnz RETRY18
OK18:
    v_lshlrev_b32 v30, 16, v28
    v_and_b32 v28, 0xffff0000, v28
    v_lshlrev_b32 v31, 16, v29
    v_and_b32 v29, 0xffff0000, v29
    v_add_f32 v30, v30, v31
    v_add_f32 v28, v28, v29
    v_mov_b32 v31, v30
    v_mov_b32 v29, v28
    s_nop 0
    v_permlane32_swap_b32 v30, v31
    v_permlane32_swap_b32 v28, v29
    v_add_f32 v30, v30, v31
    v_add_f32 v28, v28, v29
    v_mov_b32 v31, v30
    v_mov_b32 v29, v28
    s_nop 0
    v_permlane16_swap_b32 v30, v31
    v_permlane16_swap_b32 v28, v29
    v_add_f32 v30, v30, v31
    v_add_f32 v28, v28, v29
    v_add_f32 v22, v22, v30
    v_add_f32 v23, v23, v28
    v_cvt_pk_bf16_f32 v28, v22, v23
    s_lshl_b32 s77, s69, 6
    s_add_u32 s77, s77, s3
    s_add_u32 s77, s77, 49152
    v_lshlrev_b32 v32, 2, v0
    v_mov_b32_dpp v29, v28 quad_perm:[1,1,1,1] row_mask:0xf bank_mask:0xf
    v_mov_b32_dpp v30, v28 quad_perm:[2,2,2,2] row_mask:0xf bank_mask:0xf
    v_mov_b32_dpp v31, v28 quad_perm:[3,3,3,3] row_mask:0xf bank_mask:0xf
    s_mov_b32 exec_lo, 0x1111
    s_mov_b32 exec_hi, 0x0
    buffer_store_dwordx4 v[28:31], v32, s[8:11], s77 offen
    s_cmp_eq_u32 s10, 0
    s_cbranch_scc1 SLOW19
BACK19:
    s_mov_b64 exec, -1
    s_branch NEXT
FINAL:
    s_cmp_lg_u32 s68, 0
    s_cbranch_scc1 DONE
    s_lshl_b32 s77, s69, 6
    v_lshlrev_b32 v37, 2, v0
    s_add_u32 s79, s77, s3
    s_add_u32 s79, s79, 46592
    s_mov_b64 exec, 15
    s_mov_b32 s76, 1
POLL20:
    buffer_load_dword v28, v1, s[16:19], s79 offen sc1
POLLW20:
    s_waitcnt vmcnt(0)
    v_cmp_eq_u32 vcc, -1, v28
    s_cbranch_vccnz AGAIN20
POLLX20:
    s_mov_b64 exec, -1
    s_mov_b32 s76, 1
POLL21:
    buffer_load_dword v28, v20, s[16:19], s74 offen sc1
    buffer_load_dword v29, v21, s[16:19], s74 offen sc1
POLLW21:
    s_waitcnt vmcnt(0)
    v_max_u32 v30, v28, v29
    v_cmp_eq_u32 vcc, -1, v30
    s_cbranch_vccnz AGAIN21
POLLX21:
    v_lshlrev_b32 v30, 16, v28
    v_and_b32 v28, 0xffff0000, v28
    v_lshlrev_b32 v31, 16, v29
    v_and_b32 v29, 0xffff0000, v29
    v_add_f32 v30, v30, v31
    v_add_f32 v28, v28, v29
    v_mov_b32 v31, v30
    v_mov_b32 v29, v28
    s_nop 0
    v_permlane32_swap_b32 v30, v31
    v_permlane32_swap_b32 v28, v29
    v_add_f32 v30, v30, v31
    v_add_f32 v28, v28, v29
    v_mov_b32 v31, v30
    v_mov_b32 v29, v28
    s_nop 0
    v_permlane16_swap_b32 v30, v31
    v_permlane16_swap_b32 v28, v29
    v_add_f32 v30, v30, v31
    v_add_f32 v28, v28, v29
    v_add_f32 v22, v22, v30
    v_add_f32 v23, v23, v28
    v_cvt_pk_bf16_f32 v28, v22, v23
    s_mov_b32 exec_lo, 0xffff
    s_mov_b32 exec_hi, 0x0
    buffer_store_dword v28, v37, s[40:43], s77 offen
    s_mov_b64 exec, -1
    s_endpgm
AGAIN17:
    s_sleep 2
    s_add_u32 s76, s76, 1
    s_cmp_lt_u32 s76, 32768
    s_cbranch_scc1 POLL17
    s_branch POLLX17
AGAIN20:
    s_add_u32 s76, s76, 1
    s_cmp_lt_u32 s76, 32768
    s_cbranch_scc1 POLL20
    s_branch POLLX20
AGAIN21:
    s_add_u32 s76, s76, 1
    s_cmp_lt_u32 s76, 32768
    s_cbranch_scc1 POLL21
    s_branch POLLX21
ROLEF:
    v_and_b32 v25, 15, v0
    v_lshrrev_b32 v26, 4, v0
    v_bfe_u32 v27, v0, 2, 2
    v_and_b32 v36, 3, v0
    s_cmp_lg_u32 s74, 0
    s_cbranch_scc1 FW
    v_lshrrev_b32 v38, 3, v0
    v_mul_u32_u24 v38, 3072, v38
    v_and_b32 v39, 7, v0
    v_lshl_add_u32 v38, v39, 4, v38
    v_bfe_u32 v39, v0, 4, 1
    v_lshlrev_b32 v39, 5, v39
    v_xor_b32 v38, v38, v39
    v_xor_b32 v39, 64, v38
    s_mov_b32 m0, s67
    s_add_u32 s67, s67, 1024
    buffer_load_dwordx4 v39, s[36:39], s66 offen nt lds
    s_add_u32 s66, s66, 24576
    s_mov_b32 m0, s67
    s_add_u32 s67, s67, 1024
    buffer_load_dwordx4 v38, s[36:39], s66 offen nt lds
    s_add_u32 s66, s66, 24576
    s_mov_b32 m0, s67
    s_add_u32 s67, s67, 1024
    buffer_load_dwordx4 v39, s[36:39], s66 offen nt lds
    s_add_u32 s66, s66, 24576
    s_mov_b32 m0, s67
    s_add_u32 s67, s67, 1024
    buffer_load_dwordx4 v38, s[36:39], s66 offen nt lds
    s_add_u32 s66, s66, 24576
    s_mov_b32 m0, s67
    s_add_u32 s67, s67, 1024
    buffer_load_dwordx4 v39, s[36:39], s66 offen nt lds
    s_add_u32 s66, s66, 24576
    s_mov_b32 m0, s67
    s_add_u32 s67, s67, 1024
    buffer_load_dwordx4 v38, s[36:39], s66 offen nt lds
    s_add_u32 s66, s66, 24576
    s_mov_b32 m0, s67
    s_add_u32 s67, s67, 1024
    buffer_load_dwordx4 v39, s[36:39], s66 offen nt lds
    s_add_u32 s66, s66, 24576
    s_sub_u32 s96, s69, 20
    s_lshl_b32 s96, s96, 2
    s_add_u32 s96, s96, s72
    s_mul_i32 s96, s96, 688
    v_add_u32 v21, s96, v1
    v_min_u32 v21, 32752, v21
    s_add_u32 s97, s3, 819200
    s_add_u32 s77, s3, 1638400
    buffer_store_dword v7, v10, s[8:11], s77 offen
    s_cmp_eq_u32 s10, 0
    s_cbranch_scc1 SLOW22
BACK22:
FW:
    s_lshl_b32 s77, s72, 5
    v_lshl_add_u32 v80, v36, 3, s77
    v_lshrrev_b32 v37, 1, v27
    v_and_b32 v38, 1, v26
    v_lshl_add_u32 v37, v38, 1, v37
    v_lshlrev_b32 v37, 5, v37
    v_xor_b32 v80, v80, v37
    v_lshl_add_u32 v37, v26, 3, v27
    v_lshl_add_u32 v80, v37, 7, v80
    v_add_u32 v80, 57344, v80
    s_sub_u32 s79, s69, 20
    s_and_b32 s7, s79, 12
    s_add_u32 s7, s7, s72
    s_lshl_b32 s78, s7, 8
    v_lshl_add_u32 v83, v25, 4, s78
    v_mul_u32_u24 v37, 3072, v26
    v_add_u32 v84, v83, v37
    v_add_u32 v83, 6400, v83
    v_lshlrev_b32 v37, 4, v26
    v_add_u32 v37, 6112, v37
    v_or_b32 v38, s7, v25
    v_mov_b32 v39, 1879048176
    v_cmp_eq_u32 vcc, 0, v38
    s_nop 1
    v_cndmask_b32 v37, v39, v37, vcc
    v_cmp_le_u32 vcc, 2, v26
    s_nop 1
    v_cndmask_b32 v84, v84, v37, vcc
    s_and_b32 s79, s79, 3
    s_lshl_b32 s78, s79, 2
    s_add_u32 s78, s78, s3
    s_add_u32 s78, s78, 50432
    s_mul_i32 s79, s79, 320
    v_cmp_eq_u32 vcc, 12, v25
    v_mov_b32 v38, 0x3f803f80
    s_nop 0
    v_cndmask_b32 v88, 0, v38, vcc
    v_mov_b32 v89, v88
    v_mov_b32 v90, v88
    v_mov_b32 v91, v88
    v_mov_b32 v92, v88
    v_mov_b32 v93, v88
    v_mov_b32 v94, v88
    v_mov_b32 v95, v88
    v_mov_b32 v96, v88
    v_mov_b32 v97, v88
    v_mov_b32 v98, v88
    v_mov_b32 v99, v88
    v_mov_b32 v100, v88
    v_mov_b32 v101, v88
    v_mov_b32 v102, v88
    v_mov_b32 v103, v88
    v_mov_b32 v104, v88
    v_mov_b32 v105, v88
    v_mov_b32 v106, v88
    v_mov_b32 v107, v88
    s_mul_i32 s77, s72, 6656
    v_mul_u32_u24 v6, 336, v25
    v_lshl_add_u32 v6, v26, 4, v6
    v_add_u32 v6, s77, v6
    v_mul_u32_u24 v37, 52, v0
    v_lshrrev_b32 v37, 10, v37
    v_lshl_add_u32 v87, v37, 4, v1
    v_add_u32 v87, s77, v87
    v_mul_u32_u24 v27, 320, v37
    v_sub_u32 v27, v1, v27
    s_mul_i32 s7, s68, 10240
    s_cmp_eq_u32 s74, 0
    s_cselect_b32 s7, 0, s7
    s_add_u32 s7, s7, 655360
    v_mul_u32_u24 v86, 1280, v37
    v_add_u32 v86, s7, v86
    s_mul_i32 s7, s68, 81920
    s_add_u32 s7, s7, 45312
    v_mov_b32 v38, s7
    v_cmp_eq_u32 vcc, s68, v37
    s_nop 1
    v_cndmask_b32 v86, v86, v38, vcc
    v_add_u32 v38, 2560, v38
    v_cmp_le_u32 vcc, 8, v37
    s_nop 1
    v_cndmask_b32 v86, v86, v38, vcc
    v_add_u32 v86, v86, v27
    v_add_u32 v37, 3, v37
    s_mul_i32 s7, s68, 10240
    s_cmp_eq_u32 s74, 0
    s_cselect_b32 s7, 0, s7
    s_add_u32 s7, s7, 655360
    v_mul_u32_u24 v18, 1280, v37
    v_add_u32 v18, s7, v18
    s_mul_i32 s7, s68, 81920
    s_add_u32 s7, s7, 45312
    v_mov_b32 v38, s7
    v_cmp_eq_u32 vcc, s68, v37
    s_nop 1
    v_cndmask_b32 v18, v18, v38, vcc
    v_add_u32 v38, 2560, v38
    v_cmp_le_u32 vcc, 8, v37
    s_nop 1
    v_cndmask_b32 v18, v18, v38, vcc
    v_add_u32 v18, v18, v27
    v_add_u32 v37, 3, v37
    s_mul_i32 s7, s68, 10240
    s_cmp_eq_u32 s74, 0
    s_cselect_b32 s7, 0, s7
    s_add_u32 s7, s7, 655360
    v_mul_u32_u24 v20, 1280, v37
    v_add_u32 v20, s7, v20
    s_mul_i32 s7, s68, 81920
    s_add_u32 s7, s7, 45312
    v_mov_b32 v38, s7
    v_cmp_eq_u32 vcc, s68, v37
    s_nop 1
    v_cndmask_b32 v20, v20, v38, vcc
    v_add_u32 v38, 2560, v38
    v_cmp_le_u32 vcc, 8, v37
    s_nop 1
    v_cndmask_b32 v20, v20, v38, vcc
    v_add_u32 v20, v20, v27
    s_add_u32 s77, s79, s74
    s_add_u32 s79, s79, s3
    s_add_u32 s79, s79, 45312
    s_cmp_lg_u32 s74, 0
    s_cbranch_scc1 FW1
    v_mov_b32 v24, -1
    v_mov_b32 v25, -1
    v_mov_b32 v26, -1
    v_mov_b32 v27, -1
    s_waitcnt vmcnt(0)
    buffer_store_dwordx4 v[24:27], v21, s[8:11], s97 offen
    s_cmp_eq_u32 s10, 0
    s_cbranch_scc1 SLOW23
BACK23:
    s_barrier
FW1:
    ds_read_b64_tr_b16 v[40:41], v80 offset:0
    ds_read_b64_tr_b16 v[42:43], v80 offset:512
    ds_read_b64_tr_b16 v[44:45], v80 offset:4096
    ds_read_b64_tr_b16 v[46:47], v80 offset:4608
    ds_read_b64_tr_b16 v[48:49], v80 offset:8192
    ds_read_b64_tr_b16 v[50:51], v80 offset:8704
    ds_read_b64_tr_b16 v[52:53], v80 offset:12288
    ds_read_b64_tr_b16 v[54:55], v80 offset:12800
    ds_read_b64_tr_b16 v[56:57], v80 offset:16384
    ds_read_b64_tr_b16 v[58:59], v80 offset:16896
    ds_read_b64_tr_b16 v[60:61], v80 offset:20480
    ds_read_b64_tr_b16 v[62:63], v80 offset:20992
    ds_read_b64_tr_b16 v[64:65], v80 offset:24576
    ds_read_b64_tr_b16 v[66:67], v80 offset:25088
    ds_read_b64_tr_b16 v[68:69], v80 offset:28672
    ds_read_b64_tr_b16 v[70:71], v80 offset:29184
    ds_read_b64_tr_b16 v[72:73], v80 offset:32768
    ds_read_b64_tr_b16 v[74:75], v80 offset:33280
    ds_read_b64_tr_b16 v[76:77], v80 offset:36864
    ds_read_b64_tr_b16 v[78:79], v80 offset:37376
    s_cmp_lg_u32 s74, 0
    s_cbranch_scc1 FW3
    s_waitcnt lgkmcnt(0)
    v_mfma_f32_16x16x32_bf16 v[108:111], v[88:91], v[40:43], 0
    v_mfma_f32_16x16x32_bf16 v[2:5], v[88:91], v[60:63], 0
    v_mfma_f32_16x16x32_bf16 v[108:111], v[92:95], v[44:47], v[108:111]
    v_mfma_f32_16x16x32_bf16 v[2:5], v[92:95], v[64:67], v[2:5]
    v_mfma_f32_16x16x32_bf16 v[108:111], v[96:99], v[48:51], v[108:111]
    v_mfma_f32_16x16x32_bf16 v[2:5], v[96:99], v[68:71], v[2:5]
    v_mfma_f32_16x16x32_bf16 v[108:111], v[100:103], v[52:55], v[108:111]
    v_mfma_f32_16x16x32_bf16 v[2:5], v[100:103], v[72:75], v[2:5]
    v_mfma_f32_16x16x32_bf16 v[108:111], v[104:107], v[56:59], v[108:111]
    v_mfma_f32_16x16x32_bf16 v[2:5], v[104:107], v[76:79], v[2:5]
FW3:
    s_mov_b32 exec_lo, 0xfffff
    s_mov_b32 exec_hi, 0x0
    s_mov_b32 s76, 1
POLL24:
    buffer_load_dword v36, v1, s[16:19], s79 offen sc1
POLLW24:
    s_waitcnt vmcnt(0)
    v_cmp_eq_u32 vcc, -1, v36
    s_cbranch_vccnz AGAIN24
POLLX24:
    s_mov_b64 exec, s[86:87]
    buffer_load_dwordx4 v[24:27], v86, s[16:19], s77 offen sc1
    buffer_load_dwordx4 v[28:31], v18, s[16:19], s77 offen sc1
    buffer_load_dwordx4 v[32:35], v20, s[16:19], s77 offen sc1
    s_cmp_eq_u32 s74, 0
    s_cbranch_scc1 CSP
    s_waitcnt vmcnt(0)
CSB:
    s_waitcnt vmcnt(2)
BW25:
    ds_write_b128 v87, v[24:27] offset:0
    ds_write_b128 v87, v[28:31] offset:1008
    ds_write_b128 v87, v[32:35] offset:2016
    v_max3_u32 v36, v24, v28, v32
    v_cmp_eq_u32 vcc, -1, v36
    s_mov_b64 exec, s[84:85]
    ds_read_b128 v[88:91], v6 offset:0
    ds_read_b128 v[92:95], v6 offset:64
    ds_read_b128 v[96:99], v6 offset:128
    ds_read_b128 v[100:103], v6 offset:192
    ds_read_b128 v[104:107], v6 offset:256
    s_mov_b64 exec, -1
    s_cbranch_vccnz BR25
BX25:
    s_waitcnt lgkmcnt(4)
    v_mfma_f32_16x16x32_bf16 v[32:35], v[88:91], v[88:91], 0
    s_waitcnt lgkmcnt(3)
    v_mfma_f32_16x16x32_bf16 v[32:35], v[92:95], v[92:95], v[32:35]
    s_waitcnt lgkmcnt(2)
    v_mfma_f32_16x16x32_bf16 v[32:35], v[96:99], v[96:99], v[32:35]
    s_waitcnt lgkmcnt(1)
    v_mfma_f32_16x16x32_bf16 v[32:35], v[100:103], v[100:103], v[32:35]
    s_waitcnt lgkmcnt(0)
    v_mfma_f32_16x16x32_bf16 v[32:35], v[104:107], v[104:107], v[32:35]
    v_mfma_f32_16x16x32_bf16 v[24:27], v[88:91], v[40:43], 0
    v_mov_b32 v36, 0
    v_mov_b32 v37, 0
    v_mfma_f32_16x16x32_bf16 v[24:27], v[92:95], v[44:47], v[24:27]
    v_mov_b32 v38, 0
    s_nop 0
    v_mfma_f32_16x16x32_bf16 v[24:27], v[96:99], v[48:51], v[24:27]
    v_mfma_f32_16x16x32_bf16 v[24:27], v[100:103], v[52:55], v[24:27]
    v_add_f32 v32, v32, v33
    v_add_f32 v34, v34, v35
    v_mfma_f32_16x16x32_bf16 v[24:27], v[104:107], v[56:59], v[24:27]
    v_mfma_f32_16x16x32_bf16 v[28:31], v[88:91], v[60:63], 0
    v_add_f32_dpp v36, v32, v34 quad_perm:[0,1,2,3] row_mask:0xf bank_mask:0x7
    v_mfma_f32_16x16x32_bf16 v[28:31], v[92:95], v[64:67], v[28:31]
    s_nop 0
    v_add_f32_dpp v36, v36, v36 row_ror:8 row_mask:0xf bank_mask:0xf
    v_mfma_f32_16x16x32_bf16 v[28:31], v[96:99], v[68:71], v[28:31]
    s_nop 0
    v_add_f32_dpp v36, v36, v36 row_ror:4 row_mask:0xf bank_mask:0xf
    v_mfma_f32_16x16x32_bf16 v[28:31], v[100:103], v[72:75], v[28:31]
    s_nop 0
    v_add_f32_dpp v36, v36, v36 row_ror:2 row_mask:0xf bank_mask:0xf
    v_mfma_f32_16x16x32_bf16 v[28:31], v[104:107], v[76:79], v[28:31]
    v_add_f32 v25, v24, v25
    v_add_f32_dpp v37, v36, v36 row_ror:1 row_mask:0x7 bank_mask:0xf
    v_add_f32_dpp v38, v36, v36 row_ror:1 row_mask:0x8 bank_mask:0xf
    v_add_f32 v26, v26, v27
    v_add_f32 v25, v25, v26
    s_nop 1
    v_permlane32_swap_b32 v25, v37
    v_add_f32 v29, v28, v29
    v_add_f32 v30, v30, v31
    v_add_f32 v29, v29, v30
    v_add_f32 v25, v25, v37
    s_nop 0
    v_permlane32_swap_b32 v29, v38
    v_add_f32 v29, v29, v38
    s_nop 1
    v_permlane16_swap_b32 v25, v29
    v_add_f32 v25, v25, v29
    buffer_store_dword v25, v84, s[8:11], s78 offen
    s_cmp_eq_u32 s10, 0
    s_cbranch_scc1 SLOW26
BACK26:
NEXT:
    s_cmp_lg_u32 s74, 0
    s_cbranch_scc1 DONE
    s_mov_b32 s74, 819200
    s_add_u32 s3, s3, 819200
    s_add_u32 s80, s80, 819200
    s_add_u32 s81, s81, 819200
    s_mov_b64 s[46:47], s[44:45]
    s_mov_b64 s[48:49], s[92:93]
    s_branch LOOP
AGAIN24:
    s_add_u32 s76, s76, 1
    s_cmp_lt_u32 s76, 32768
    s_cbranch_scc1 POLL24
    s_branch POLLX24
CSP:
    s_mov_b32 exec_lo, 0x0
    s_mov_b32 exec_hi, 0xffff0000
    buffer_store_dword v108, v83, s[8:11], s78 offen
    s_cmp_eq_u32 s10, 0
    s_cbranch_scc1 SLOW27
BACK27:
    buffer_store_dword v2, v83, s[8:11], s78 offen offset:3072
    s_cmp_eq_u32 s10, 0
    s_cbranch_scc1 SLOW28
BACK28:
    s_mov_b64 exec, s[86:87]
    s_branch CSB
BR25:
    s_cmp_ge_u32 s76, 32768
    s_cbranch_scc1 BX25
BL25:
    s_mov_b64 exec, s[86:87]
    v_cmp_eq_u32 vcc, -1, v24
    s_nop 0
    s_mov_b64 exec, vcc
    s_cbranch_execz BS25_0
    buffer_load_dwordx4 v[24:27], v86, s[16:19], s77 offen sc1
BS25_0:
    s_mov_b64 exec, s[86:87]
    v_cmp_eq_u32 vcc, -1, v28
    s_nop 0
    s_mov_b64 exec, vcc
    s_cbranch_execz BS25_1
    buffer_load_dwordx4 v[28:31], v18, s[16:19], s77 offen sc1
BS25_1:
    s_mov_b64 exec, s[86:87]
    v_cmp_eq_u32 vcc, -1, v32
    s_nop 0
    s_mov_b64 exec, vcc
    s_cbranch_execz BS25_2
    buffer_load_dwordx4 v[32:35], v20, s[16:19], s77 offen sc1
BS25_2:
    s_mov_b64 exec, s[86:87]
    s_add_u32 s76, s76, 1
    s_cmp_ge_u32 s76, 32768
    s_waitcnt vmcnt(0)
    v_max3_u32 v36, v24, v28, v32
    v_cmp_eq_u32 vcc, -1, v36
    s_cbranch_vccz BW25
    s_cbranch_scc0 BL25
    s_branch BW25
DONE:
    s_endpgm
TAGLOOP:
    s_mov_b32 s76, 0
TAGL2:
    s_sleep 8
    global_load_dword v98, v100, s[64:65] sc1
    s_waitcnt vmcnt(0)
    v_readfirstlane_b32 s96, v98
    s_nop 0
    s_cmp_lg_u32 s96, 0
    s_cbranch_scc1 TAGOK
    s_add_u32 s76, s76, 1
    s_cmp_lt_u32 s76, 32768
    s_cbranch_scc1 TAGL2
    s_branch TAGOK
DMAF:
    s_sub_u32 s78, s69, 20
    s_and_b32 s66, s78, 3
    s_lshl_b32 s66, s66, 1
    s_and_b32 s79, s72, 1
    s_add_u32 s66, s66, s79
    s_mul_i32 s66, s66, 245760
    s_lshr_b32 s78, s78, 2
    s_lshl_b32 s78, s78, 7
    s_add_u32 s66, s66, s78
    s_mul_i32 s78, s68, 384
    s_add_u32 s66, s66, s78
    s_mul_i32 s67, s72, 10240
    s_add_u32 s67, s67, 57344
    s_branch DMAX
RDYLOOP:
    s_mov_b32 s76, 0
RDYL2:
    s_sleep 8
    buffer_load_dwordx2 v[98:99], v100, s[16:19], 0 offen offset:384 sc1
    s_waitcnt vmcnt(0)
    v_cmp_ne_u32 vcc, s96, v98
    s_cbranch_vccz RDYOK
    s_add_u32 s76, s76, 1
    s_cmp_lt_u32 s76, 32768
    s_cbranch_scc1 RDYL2
    s_branch RDYOK
SLOW1:
    buffer_store_dwordx4 v[28:31], v27, s[16:19], s77 offen sc1
    s_branch BACK1
SLOW2:
    buffer_store_dwordx4 v[24:27], v106, s[16:19], 0 offen sc1
    s_branch BACK2
SLOW5:
    buffer_store_dword v24, v10, s[16:19], s3 offen sc1
    s_branch BACK5
SLOW7:
    buffer_store_dwordx4 v[28:31], v1, s[16:19], s77 offen sc1
    s_branch BACK7
RETRY8:
    s_mov_b32 s76, 1
POLL29:
    buffer_load_dword v28, v20, s[16:19], 0 offen sc1
    buffer_load_dword v29, v21, s[16:19], 0 offen sc1
POLLW29:
    s_waitcnt vmcnt(0)
    v_max_u32 v30, v28, v29
    v_cmp_eq_u32 vcc, -1, v30
    s_cbranch_vccnz AGAIN29
POLLX29:
    s_branch OK8
AGAIN29:
    s_add_u32 s76, s76, 1
    s_cmp_lt_u32 s76, 32768
    s_cbranch_scc1 POLL29
    s_branch POLLX29
SLOW9:
    buffer_store_dwordx4 v[28:31], v32, s[16:19], s77 offen sc1
    s_branch BACK9
SLOW11:
    buffer_store_dwordx4 v[28:31], v18, s[16:19], s81 offen sc1
    s_branch BACK11
SLOW12:
    buffer_store_dwordx4 v[28:31], v18, s[16:19], s97 offen sc1
    s_branch BACK12
SLOW13:
    buffer_store_dwordx2 v[34:35], v1, s[16:19], s78 offen sc1
    s_branch BACK13
SLOW14:
    buffer_store_dword v7, v10, s[16:19], s77 offen sc1
    s_branch BACK14
SLOW15:
    buffer_store_dwordx4 v[104:107], v100, s[16:19], s78 offen sc1
    s_branch BACK15
SLOW16:
    buffer_store_dwordx4 v[104:107], v101, s[16:19], s78 offen sc1
    s_branch BACK16
RETRY18:
    s_mov_b32 s76, 1
POLL30:
    buffer_load_dword v28, v37, s[16:19], 0 offen sc1
    buffer_load_dword v29, v38, s[16:19], 0 offen sc1
POLLW30:
    s_waitcnt vmcnt(0)
    v_max_u32 v30, v28, v29
    v_cmp_eq_u32 vcc, -1, v30
    s_cbranch_vccnz AGAIN30
POLLX30:
    s_branch OK18
AGAIN30:
    s_add_u32 s76, s76, 1
    s_cmp_lt_u32 s76, 32768
    s_cbranch_scc1 POLL30
    s_branch POLLX30
SLOW19:
    buffer_store_dwordx4 v[28:31], v32, s[16:19], s77 offen sc1
    s_branch BACK19
SLOW22:
    buffer_store_dword v7, v10, s[16:19], s77 offen sc1
    s_branch BACK22
SLOW23:
    buffer_store_dwordx4 v[24:27], v21, s[16:19], s97 offen sc1
    s_branch BACK23
SLOW26:
    buffer_store_dword v25, v84, s[16:19], s78 offen sc1
    s_branch BACK26
SLOW27:
    buffer_store_dword v108, v83, s[16:19], s78 offen sc1
    s_branch BACK27
SLOW28:
    buffer_store_dword v2, v83, s[16:19], s78 offen offset:3072 sc1
    s_branch BACK28
CODE_END:
    s_endpgm
.section .rodata,"a"
.p2align 6
.amdhsa_kernel interleave_layers__sliding_block_cached__glu_gated_swiglu__decode_kernel
  .amdhsa_next_free_vgpr 512
  .amdhsa_next_free_sgpr 102
  .amdhsa_accum_offset 256
  .amdhsa_group_segment_fixed_size 0
  .amdhsa_kernarg_size 96
  .amdhsa_user_sgpr_count 2
  .amdhsa_user_sgpr_kernarg_segment_ptr 1
  .amdhsa_system_sgpr_workgroup_id_x 1
.end_amdhsa_kernel
```

```asm
; @launch grid=(256,1,1) block=(256,1,1) lds=125568
.amdgcn_target "amdgcn-amd-amdhsa--gfx950"
.text
.globl interleave_layers__sliding_block_cached__glu_gated_swiglu__decode_kernel
.p2align 8
.type interleave_layers__sliding_block_cached__glu_gated_swiglu__decode_kernel,@function
interleave_layers__sliding_block_cached__glu_gated_swiglu__decode_kernel:
    s_load_dwordx16 s[44:59], s[0:1], 0
    s_load_dwordx8 s[60:67], s[0:1], 64
    s_cmp_ge_u32 s2, 256
    s_cbranch_scc1 CODE_END
    s_memrealtime s[96:97]
    v_lshrrev_b32 v2, 6, v0
    v_and_b32 v24, 63, v0
    v_readfirstlane_b32 s72, v2
    s_and_b32 s68, s2, 7
    s_lshr_b32 s69, s2, 3
    s_lshr_b32 s70, s69, 3
    s_and_b32 s71, s69, 7
    v_lshlrev_b32 v1, 4, v24
    s_lshl_b32 s77, s70, 3
    s_add_u32 s77, s77, s68
    s_mul_i32 s73, s77, 12582912
    s_lshl_b32 s78, s71, 2
    s_add_u32 s78, s78, s72
    s_mul_i32 s78, s78, 6144
    s_add_u32 s73, s73, s78
    s_add_u32 s73, s73, 11010048
    v_add_u32 v23, 4096, v1
    s_mov_b32 s10, 402653184
    s_mov_b32 s11, 0x20000
    s_getpc_b64 s[100:101]
PCREF:
    s_sub_u32 s100, s100, PCREF-interleave_layers__sliding_block_cached__glu_gated_swiglu__decode_kernel
    s_subb_u32 s101, s101, 0
    s_lshl_b32 s78, s71, 12
    v_lshl_add_u32 v25, v0, 4, s78
    v_cmp_gt_u32 vcc, CODE_END-interleave_layers__sliding_block_cached__glu_gated_swiglu__decode_kernel-16, v25
    s_nop 0
    s_and_saveexec_b64 s[98:99], vcc
    s_cbranch_execz NOCPF
    global_load_dwordx4 a[240:243], v25, s[100:101]
NOCPF:
    s_mov_b64 exec, -1
    s_mul_i32 s79, s77, 384
    s_mov_b32 s74, 0
    s_mul_i32 s3, s68, 81920
    s_getreg_b32 s75, hwreg(HW_REG_XCC_ID, 0, 4)
    s_lshl_b32 s77, s69, 9
    s_add_u32 s77, s77, s3
    s_add_u32 s77, s77, 32768
    v_add_u32 v20, s77, v1
    s_lshl_b32 s77, s68, 2
    s_add_u32 s77, s77, s69
    s_mul_i32 s77, s77, 320
    s_add_u32 s77, s77, 654848
    s_add_u32 s4, s77, 1024
    v_add_u32 v25, s77, v1
    v_cmp_le_u32 vcc, 32, v0
    s_nop 1
    v_cndmask_b32 v21, v20, v25, vcc
    v_mov_b32 v25, 2147483632
    v_cndmask_b32 v20, v20, v25, vcc
    s_cmp_lt_u32 s69, 4
    s_cselect_b32 s77, 52, 32
    v_cmp_le_u32 vcc, s77, v0
    s_nop 1
    v_cndmask_b32 v21, v21, v25, vcc
    s_mov_b32 s18, 1610612736
    s_mov_b32 s19, 0x20000
    s_waitcnt lgkmcnt(0)
    s_mov_b32 s8, s46
    s_and_b32 s9, s47, 0xffff
    s_mov_b32 s16, s66
    s_and_b32 s17, s67, 0xffff
    buffer_load_dwordx4 a[0:3], v1, s[8:11], s73 offen offset:0 nt
    buffer_load_dwordx4 a[4:7], v1, s[8:11], s73 offen offset:1024 nt
    s_or_b32 s77, s2, s72
    s_cbranch_scc1 NOTAG
    s_or_b32 s77, s96, 1
    v_mov_b32 v26, s77
    s_mov_b64 exec, 1
    global_store_dword v1, v26, s[64:65] sc1
    s_mov_b64 exec, -1
NOTAG:
    s_add_u32 s83, s73, 196608
    s_mov_b32 s12, s48
    s_and_b32 s13, s49, 0xffff
    s_mov_b32 s14, 402653184
    s_mov_b32 s15, 0x20000
    s_mov_b32 s20, s50
    s_and_b32 s21, s51, 0xffff
    s_mov_b32 s22, 7864320
    s_mov_b32 s23, 0x20000
    s_mov_b32 s36, s44
    s_and_b32 s37, s45, 0xffff
    s_mov_b32 s38, 1280
    s_mov_b32 s39, 0x20000
    s_mov_b32 s40, s62
    s_and_b32 s41, s63, 0xffff
    s_mov_b32 s42, 1280
    s_mov_b32 s43, 0x20000
    s_mov_b32 s28, s58
    s_and_b32 s29, s59, 0xffff
    s_mov_b32 s30, 1966080
    s_mov_b32 s31, 0x20000
    s_mov_b32 s32, s60
    s_and_b32 s33, s61, 0xffff
    s_mov_b32 s34, 1966080
    s_mov_b32 s35, 0x20000
    s_cmp_lt_u32 s69, 20
    s_cselect_b32 s24, s52, s56
    s_cselect_b32 s25, s53, s57
    s_cselect_b32 s26, s22, s30
    s_and_b32 s25, s25, 0xffff
    s_mov_b32 s27, 0x20000
    s_add_u32 s84, s83, 196608
    s_add_u32 s85, s84, 196608
    s_add_u32 s86, s85, 196608
    s_add_u32 s87, s86, 196608
    s_add_u32 s88, s87, 196608
    s_add_u32 s89, s88, 196608
    v_mov_b32 v0, v24
    s_mul_i32 s77, s72, 6656
    v_add_u32 v25, 0, v0
    v_mul_u32_u24 v26, 171, v25
    v_lshrrev_b32 v26, 12, v26
    v_mul_u32_u24 v27, 24, v26
    v_sub_u32 v27, v25, v27
    v_lshlrev_b32 v27, 4, v27
    v_mul_u32_u24 v25, 416, v26
    v_add3_u32 v2, v25, v27, s77
    v_mul_u32_u24 v25, 12288, v26
    v_add_u32 v40, v25, v27
    v_add_u32 v25, 64, v0
    v_mul_u32_u24 v26, 171, v25
    v_lshrrev_b32 v26, 12, v26
    v_mul_u32_u24 v27, 24, v26
    v_sub_u32 v27, v25, v27
    v_lshlrev_b32 v27, 4, v27
    v_mul_u32_u24 v25, 416, v26
    v_add3_u32 v3, v25, v27, s77
    v_mul_u32_u24 v25, 12288, v26
    v_add_u32 v41, v25, v27
    v_add_u32 v25, 128, v0
    v_mul_u32_u24 v26, 171, v25
    v_lshrrev_b32 v26, 12, v26
    v_mul_u32_u24 v27, 24, v26
    v_sub_u32 v27, v25, v27
    v_lshlrev_b32 v27, 4, v27
    v_mul_u32_u24 v25, 416, v26
    v_add3_u32 v4, v25, v27, s77
    v_mul_u32_u24 v25, 12288, v26
    v_add_u32 v42, v25, v27
    v_and_b32 v25, 15, v0
    v_lshrrev_b32 v26, 4, v0
    v_bfe_u32 v27, v0, 2, 2
    v_and_b32 v28, 3, v0
    s_mul_i32 s78, s71, 160
    v_lshlrev_b32 v36, 4, v26
    v_lshlrev_b32 v37, 3, v26
    v_lshlrev_b32 v39, 2, v0
    buffer_load_dwordx4 v[70:73], v36, s[36:39], s78 offen
    buffer_load_dwordx4 v[74:77], v36, s[36:39], s78 offen offset:64
    buffer_load_dwordx2 v[78:79], v37, s[36:39], s78 offen offset:128
    buffer_load_dwordx4 v[80:83], v1, s[36:39], 0 offen
    buffer_load_dword v84, v39, s[36:39], 0 offen offset:1024
    s_lshl_b32 s7, s69, 6
    v_lshlrev_b32 v38, 2, v25
    buffer_load_dword v22, v38, s[36:39], s7 offen
    s_mul_i32 s78, s71, 983040
    s_add_u32 s79, s79, s78
    s_mul_i32 s78, s72, 98304
    s_add_u32 s79, s79, s78
    s_mul_i32 s78, s72, 3072
    s_add_u32 s78, s78, 26624
    s_add_u32 m0, s78, 0
    s_nop 0
    buffer_load_dwordx4 v40, s[20:23], s79 offen nt lds
    s_add_u32 m0, s78, 1024
    s_nop 0
    buffer_load_dwordx4 v41, s[20:23], s79 offen nt lds
    s_add_u32 m0, s78, 2048
    s_nop 0
    buffer_load_dwordx4 v42, s[20:23], s79 offen nt lds
    s_add_u32 s79, s79, 393216
    s_add_u32 m0, s78, 12288
    s_nop 0
    buffer_load_dwordx4 v40, s[20:23], s79 offen nt lds
    s_add_u32 m0, s78, 13312
    s_nop 0
    buffer_load_dwordx4 v41, s[20:23], s79 offen nt lds
    s_add_u32 m0, s78, 14336
    s_nop 0
    buffer_load_dwordx4 v42, s[20:23], s79 offen nt lds
    s_add_u32 s79, s79, 393216
    s_cmp_ge_u32 s72, 2
    s_cbranch_scc1 NOWQ3
    s_add_u32 m0, s78, 24576
    s_nop 0
    buffer_load_dwordx4 v40, s[20:23], s79 offen nt lds
    s_add_u32 m0, s78, 25600
    s_nop 0
    buffer_load_dwordx4 v41, s[20:23], s79 offen nt lds
    s_add_u32 m0, s78, 26624
    s_nop 0
    buffer_load_dwordx4 v42, s[20:23], s79 offen nt lds
NOWQ3:
    s_mul_i32 s78, s71, 160
    s_mov_b32 s20, s52
    s_and_b32 s21, s53, 0xffff
    s_mov_b32 s22, 7864320
    s_mov_b32 s23, 0x20000
    s_cmp_lt_u32 s72, 2
    s_cselect_b32 s36, s56, s58
    s_cselect_b32 s37, s57, s59
    s_and_b32 s37, s37, 0xffff
    s_mov_b32 s38, 1966080
    buffer_load_dwordx4 a[8:11], v1, s[8:11], s73 offen offset:2048 nt
    buffer_load_dwordx4 a[12:15], v1, s[8:11], s73 offen offset:3072 nt
    buffer_load_dwordx4 a[16:19], v23, s[8:11], s73 offen offset:0 nt
    v_mul_u32_u24 v29, 416, v25
    v_lshl_add_u32 v29, v26, 4, v29
    v_add_u32 v5, s77, v29
    v_lshrrev_b32 v29, 2, v0
    v_mul_u32_u24 v29, 416, v29
    v_lshl_add_u32 v29, v28, 3, v29
    v_add_u32 v6, s77, v29
    s_mul_i32 s79, s72, 96
    s_add_u32 s79, s79, 26624
    v_lshl_add_u32 v29, v26, 3, v27
    v_mul_u32_u24 v29, 384, v29
    v_lshl_add_u32 v29, v28, 3, v29
    v_add_u32 v16, s79, v29
    v_lshl_add_u32 v29, v26, 2, v27
    v_mul_u32_u24 v29, 384, v29
    v_lshl_add_u32 v29, v28, 3, v29
    v_add_u32 v17, s79, v29
    buffer_load_dwordx4 a[20:23], v23, s[8:11], s73 offen offset:1024 nt
    s_mul_i32 s79, s72, 23
    v_min_u32 v32, 22, v0
    v_add_u32 v32, s79, v32
    v_min_u32 v32, 89, v32
    v_mul_u32_u24 v31, 103, v32
    v_lshrrev_b32 v31, 10, v31
    v_mul_u32_u24 v30, 10, v31
    v_sub_u32 v30, v32, v30
    v_lshl_add_u32 v29, v30, 4, s78
    s_mul_i32 s7, s68, 10240
    s_add_u32 s7, s7, 737280
    v_mul_u32_u24 v8, 1280, v31
    v_add_u32 v8, s7, v8
    s_mul_i32 s7, s68, 81920
    s_add_u32 s7, s7, 46592
    v_mov_b32 v30, s7
    v_cmp_eq_u32 vcc, s68, v31
    s_nop 1
    v_cndmask_b32 v8, v8, v30, vcc
    v_add_u32 v30, 2560, v30
    v_cmp_le_u32 vcc, 8, v31
    s_nop 1
    v_cndmask_b32 v8, v8, v30, vcc
    v_add_u32 v8, v8, v29
    v_add_u32 v33, v31, v32
    v_lshlrev_b32 v33, 4, v33
    v_add_u32 v33, 4096, v33
    v_add_u32 v31, 6, v31
    s_mul_i32 s7, s68, 10240
    s_add_u32 s7, s7, 737280
    v_mul_u32_u24 v9, 1280, v31
    v_add_u32 v9, s7, v9
    s_mul_i32 s7, s68, 81920
    s_add_u32 s7, s7, 46592
    v_mov_b32 v30, s7
    v_cmp_eq_u32 vcc, s68, v31
    s_nop 1
    v_cndmask_b32 v9, v9, v30, vcc
    v_add_u32 v30, 2560, v30
    v_cmp_le_u32 vcc, 8, v31
    s_nop 1
    v_cndmask_b32 v9, v9, v30, vcc
    v_add_u32 v9, v9, v29
    v_mov_b32 v30, 2147483632
    v_cmp_le_u32 vcc, 30, v0
    s_nop 1
    v_cndmask_b32 v9, v9, v30, vcc
    v_mov_b32 v9, v33
    s_lshl_b32 s78, s69, 10
    s_lshl_b32 s79, s72, 8
    s_add_u32 s78, s78, s79
    v_lshl_add_u32 v10, v0, 2, s78
    s_lshl_b32 s78, s70, 13
    s_add_u32 s78, s78, s79
    v_lshlrev_b32 v29, 10, v26
    v_lshl_add_u32 v29, v25, 4, v29
    v_add_u32 v11, s78, v29
    buffer_load_dwordx4 a[24:27], v1, s[8:11], s83 offen offset:0 nt
    s_mul_i32 s78, s72, 96
    s_add_u32 s78, s78, 118784
    v_lshl_add_u32 v29, v27, 5, s78
    v_lshl_add_u32 v29, v28, 2, v29
    v_lshrrev_b32 v30, 1, v26
    v_lshl_add_u32 v29, v30, 4, v29
    v_and_b32 v30, 1, v26
    v_lshl_add_u32 v29, v30, 1, v29
    v_mov_b32 v30, 119168
    v_cmp_le_u32 vcc, 12, v25
    s_nop 1
    v_cndmask_b32 v12, v29, v30, vcc
    v_and_b32 v30, 1, v0
    v_lshlrev_b32 v29, 5, v26
    v_lshl_add_u32 v29, v30, 4, v29
    v_add_u32 v13, 118784, v29
    v_mul_u32_u24 v30, 0xaaaa, v30
    v_and_b32 v29, 1, v27
    v_mul_u32_u24 v29, 0xaaaa, v29
    v_lshl_or_b32 v29, v29, 16, v30
    v_add_u32 v14, 0x44444444, v29
    buffer_load_dwordx4 a[28:31], v1, s[8:11], s83 offen offset:1024 nt
    s_lshl_b32 s78, s72, 8
    s_add_u32 s78, s78, 124416
    v_lshrrev_b32 v29, 5, v0
    v_lshl_add_u32 v29, v29, 6, s78
    v_bfe_u32 v30, v0, 3, 1
    v_lshl_add_u32 v29, v30, 5, v29
    v_bfe_u32 v30, v0, 1, 1
    v_lshl_add_u32 v29, v30, 4, v29
    v_bfe_u32 v30, v0, 2, 1
    v_lshl_add_u32 v29, v30, 3, v29
    v_bfe_u32 v30, v0, 4, 1
    v_lshl_add_u32 v29, v30, 2, v29
    v_bfe_u32 v30, v0, 0, 1
    v_lshl_add_u32 v29, v30, 1, v29
    v_mov_b32 v19, v29
    v_bfe_u32 v29, v0, 4, 1
    v_bfe_u32 v30, v0, 2, 1
    v_lshl_add_u32 v29, v29, 5, s78
    v_lshl_add_u32 v29, v30, 4, v29
    v_accvgpr_write_b32 a252, v29
    s_mul_i32 s78, s72, 768
    s_add_u32 s78, s78, 119296
    v_lshl_add_u32 v29, v25, 2, s78
    v_bfe_u32 v30, v0, 4, 1
    v_lshl_add_u32 v29, v30, 7, v29
    v_lshrrev_b32 v30, 5, v0
    v_lshl_add_u32 v15, v30, 6, v29
    s_waitcnt vmcnt(12)
    v_lshlrev_b32 v88, 16, v80
    v_and_b32 v89, 0xffff0000, v80
    v_lshlrev_b32 v90, 16, v81
    v_and_b32 v91, 0xffff0000, v81
    v_lshlrev_b32 v92, 16, v82
    v_and_b32 v93, 0xffff0000, v82
    v_lshlrev_b32 v94, 16, v83
    v_and_b32 v95, 0xffff0000, v83
    v_lshlrev_b32 v96, 16, v84
    v_and_b32 v97, 0xffff0000, v84
    v_add_f32 v80, v88, v89
    v_add_f32 v80, v80, v90
    v_add_f32 v80, v80, v91
    v_add_f32 v80, v80, v92
    v_add_f32 v80, v80, v93
    v_add_f32 v80, v80, v94
    v_add_f32 v80, v80, v95
    v_add_f32 v80, v80, v96
    v_add_f32 v80, v80, v97
    s_nop 1
    v_add_f32_dpp v80, v80, v80 row_ror:8 row_mask:0xf bank_mask:0xf
    s_nop 1
    v_add_f32_dpp v80, v80, v80 row_ror:4 row_mask:0xf bank_mask:0xf
    s_nop 1
    v_add_f32_dpp v80, v80, v80 row_ror:2 row_mask:0xf bank_mask:0xf
    s_nop 1
    v_add_f32_dpp v80, v80, v80 row_ror:1 row_mask:0xf bank_mask:0xf
    v_mov_b32 v81, v80
    s_nop 1
    v_permlane32_swap_b32 v80, v81
    v_add_f32 v80, v80, v81
    v_mov_b32 v81, v80
    s_nop 1
    v_permlane16_swap_b32 v80, v81
    v_add_f32 v80, v80, v81
    v_mul_f32 v80, 0x3acccccd, v80
    v_sub_f32 v88, v88, v80
    v_sub_f32 v89, v89, v80
    v_sub_f32 v90, v90, v80
    v_sub_f32 v91, v91, v80
    v_sub_f32 v92, v92, v80
    v_sub_f32 v93, v93, v80
    v_sub_f32 v94, v94, v80
    v_sub_f32 v95, v95, v80
    v_sub_f32 v96, v96, v80
    v_sub_f32 v97, v97, v80
    v_mul_f32 v82, v88, v88
    v_fmac_f32 v82, v89, v89
    v_fmac_f32 v82, v90, v90
    v_fmac_f32 v82, v91, v91
    v_fmac_f32 v82, v92, v92
    v_fmac_f32 v82, v93, v93
    v_fmac_f32 v82, v94, v94
    v_fmac_f32 v82, v95, v95
    v_fmac_f32 v82, v96, v96
    v_fmac_f32 v82, v97, v97
    buffer_load_dwordx4 a[32:35], v1, s[8:11], s83 offen offset:2048 nt
    s_nop 0
    v_add_f32_dpp v82, v82, v82 row_ror:8 row_mask:0xf bank_mask:0xf
    s_nop 1
    v_add_f32_dpp v82, v82, v82 row_ror:4 row_mask:0xf bank_mask:0xf
    s_nop 1
    v_add_f32_dpp v82, v82, v82 row_ror:2 row_mask:0xf bank_mask:0xf
    s_nop 1
    v_add_f32_dpp v82, v82, v82 row_ror:1 row_mask:0xf bank_mask:0xf
    v_mov_b32 v81, v82
    s_nop 1
    v_permlane32_swap_b32 v82, v81
    v_add_f32 v82, v82, v81
    v_mov_b32 v81, v82
    s_nop 1
    v_permlane16_swap_b32 v82, v81
    v_add_f32 v82, v82, v81
    v_mul_f32 v82, 0x3acccccd, v82
    v_add_f32 v82, 0x3727c5ac, v82
    v_rsq_f32 v82, v82
    s_mov_b32 vcc_lo, 0xaaaaaaaa
    s_mov_b32 vcc_hi, 0xaaaaaaaa
    v_mov_b32 v85, 0x3f803f80
    v_lshlrev_b32 v83, 16, v70
    v_and_b32 v84, 0xffff0000, v70
    v_sub_f32 v83, v83, v80
    v_sub_f32 v84, v84, v80
    v_mul_f32 v83, v83, v82
    v_mul_f32 v84, v84, v82
    v_cvt_pk_bf16_f32 v83, v83, v84
    v_cndmask_b32 v70, v83, v85, vcc
    v_lshlrev_b32 v83, 16, v71
    v_and_b32 v84, 0xffff0000, v71
    v_sub_f32 v83, v83, v80
    v_sub_f32 v84, v84, v80
    v_mul_f32 v83, v83, v82
    v_mul_f32 v84, v84, v82
    v_cvt_pk_bf16_f32 v83, v83, v84
    v_cndmask_b32 v71, v83, v85, vcc
    v_lshlrev_b32 v83, 16, v72
    v_and_b32 v84, 0xffff0000, v72
    v_sub_f32 v83, v83, v80
    v_sub_f32 v84, v84, v80
    v_mul_f32 v83, v83, v82
    v_mul_f32 v84, v84, v82
    v_cvt_pk_bf16_f32 v83, v83, v84
    v_cndmask_b32 v72, v83, v85, vcc
    v_lshlrev_b32 v83, 16, v73
    v_and_b32 v84, 0xffff0000, v73
    v_sub_f32 v83, v83, v80
    v_sub_f32 v84, v84, v80
    v_mul_f32 v83, v83, v82
    v_mul_f32 v84, v84, v82
    v_cvt_pk_bf16_f32 v83, v83, v84
    v_cndmask_b32 v73, v83, v85, vcc
    v_lshlrev_b32 v83, 16, v74
    v_and_b32 v84, 0xffff0000, v74
    v_sub_f32 v83, v83, v80
    v_sub_f32 v84, v84, v80
    v_mul_f32 v83, v83, v82
    v_mul_f32 v84, v84, v82
    v_cvt_pk_bf16_f32 v83, v83, v84
    v_cndmask_b32 v74, v83, v85, vcc
    v_lshlrev_b32 v83, 16, v75
    v_and_b32 v84, 0xffff0000, v75
    v_sub_f32 v83, v83, v80
    v_sub_f32 v84, v84, v80
    v_mul_f32 v83, v83, v82
    v_mul_f32 v84, v84, v82
    v_cvt_pk_bf16_f32 v83, v83, v84
    v_cndmask_b32 v75, v83, v85, vcc
    buffer_load_dwordx4 a[36:39], v1, s[8:11], s83 offen offset:3072 nt
    v_lshlrev_b32 v83, 16, v76
    v_and_b32 v84, 0xffff0000, v76
    v_sub_f32 v83, v83, v80
    v_sub_f32 v84, v84, v80
    v_mul_f32 v83, v83, v82
    v_mul_f32 v84, v84, v82
    v_cvt_pk_bf16_f32 v83, v83, v84
    v_cndmask_b32 v76, v83, v85, vcc
    v_lshlrev_b32 v83, 16, v77
    v_and_b32 v84, 0xffff0000, v77
    v_sub_f32 v83, v83, v80
    v_sub_f32 v84, v84, v80
    v_mul_f32 v83, v83, v82
    v_mul_f32 v84, v84, v82
    v_cvt_pk_bf16_f32 v83, v83, v84
    v_cndmask_b32 v77, v83, v85, vcc
    v_lshlrev_b32 v83, 16, v78
    v_and_b32 v84, 0xffff0000, v78
    v_sub_f32 v83, v83, v80
    v_sub_f32 v84, v84, v80
    v_mul_f32 v83, v83, v82
    v_mul_f32 v84, v84, v82
    v_cvt_pk_bf16_f32 v83, v83, v84
    v_cndmask_b32 v78, v83, v85, vcc
    v_lshlrev_b32 v83, 16, v79
    v_and_b32 v84, 0xffff0000, v79
    v_sub_f32 v83, v83, v80
    v_sub_f32 v84, v84, v80
    v_mul_f32 v83, v83, v82
    v_mul_f32 v84, v84, v82
    v_cvt_pk_bf16_f32 v83, v83, v84
    v_cndmask_b32 v79, v83, v85, vcc
    s_waitcnt vmcnt(8)
    s_barrier
    ds_read_b64_tr_b16 v[40:41], v16 offset:0
    ds_read_b64_tr_b16 v[42:43], v16 offset:1536
    ds_read_b64_tr_b16 v[44:45], v16 offset:12288
    ds_read_b64_tr_b16 v[46:47], v16 offset:13824
    ds_read_b64_tr_b16 v[48:49], v17 offset:24576
    ds_read_b64_tr_b16 v[50:51], v16 offset:32
    ds_read_b64_tr_b16 v[52:53], v16 offset:1568
    ds_read_b64_tr_b16 v[54:55], v16 offset:12320
    ds_read_b64_tr_b16 v[56:57], v16 offset:13856
    ds_read_b64_tr_b16 v[58:59], v17 offset:24608
    ds_read_b64_tr_b16 v[60:61], v16 offset:64
    ds_read_b64_tr_b16 v[62:63], v16 offset:1600
    ds_read_b64_tr_b16 v[64:65], v16 offset:12352
    ds_read_b64_tr_b16 v[66:67], v16 offset:13888
    ds_read_b64_tr_b16 v[68:69], v17 offset:24640
    v_mov_b32 v100, 0
    s_cmp_lg_u32 s72, 0
    s_cbranch_scc1 NOTL
    s_mov_b64 exec, 1
    global_load_dword v98, v100, s[64:65] sc1
    s_mov_b64 exec, -1
NOTL:
    buffer_load_dwordx4 a[40:43], v23, s[8:11], s83 offen offset:0 nt
    buffer_load_dwordx4 a[44:47], v23, s[8:11], s83 offen offset:1024 nt
    s_mul_i32 s79, s72, 96
    s_add_u32 s79, s79, 119296
    v_min_u32 v36, 48, v0
    v_lshl_add_u32 v36, v36, 1, s79
    v_mov_b32 v37, 119808
    v_cmp_le_u32 vcc, 48, v0
    s_nop 1
    v_cndmask_b32 v36, v36, v37, vcc
    v_add_u32 v37, 119296, v1
    s_waitcnt lgkmcnt(0)
    v_mfma_f32_16x16x32_bf16 v[24:27], v[70:73], v[40:43], 0
    v_mfma_f32_16x16x32_bf16 v[28:31], v[70:73], v[50:53], 0
    v_mfma_f32_16x16x32_bf16 v[32:35], v[70:73], v[60:63], 0
    v_mfma_f32_16x16x32_bf16 v[24:27], v[74:77], v[44:47], v[24:27]
    v_mfma_f32_16x16x32_bf16 v[28:31], v[74:77], v[54:57], v[28:31]
    v_mfma_f32_16x16x32_bf16 v[32:35], v[74:77], v[64:67], v[32:35]
    v_mfma_f32_16x16x16_bf16 v[24:27], v[78:79], v[48:49], v[24:27]
    v_mfma_f32_16x16x16_bf16 v[28:31], v[78:79], v[58:59], v[28:31]
    v_mfma_f32_16x16x16_bf16 v[32:35], v[78:79], v[68:69], v[32:35]
    buffer_load_dwordx4 a[48:51], v1, s[8:11], s84 offen offset:0 nt
    s_nop 4
    v_mov_b32 v7, v25
    v_mov_b32_dpp v24, v28 quad_perm:[0,1,2,3] row_mask:0x2 bank_mask:0xf
    s_nop 0
    v_mov_b32_dpp v7, v29 quad_perm:[0,1,2,3] row_mask:0x2 bank_mask:0xf
    v_mov_b32_dpp v24, v32 quad_perm:[0,1,2,3] row_mask:0x4 bank_mask:0xf
    s_nop 0
    v_mov_b32_dpp v7, v33 quad_perm:[0,1,2,3] row_mask:0x4 bank_mask:0xf
    v_cvt_pk_bf16_f32 v24, v24, v24
    ds_write_b16 v36, v24
    buffer_load_dwordx4 a[52:55], v1, s[8:11], s84 offen offset:1024 nt
    buffer_load_dwordx4 a[56:59], v1, s[8:11], s84 offen offset:2048 nt
    s_waitcnt lgkmcnt(0)
    s_barrier
    ds_read_b128 v[28:31], v37
    s_lshl_b32 s79, s69, 9
    s_add_u32 s79, s79, s3
    s_cmp_eq_u32 s72, 0
    s_cselect_b32 exec_lo, 0xffffff, 1
    s_mov_b32 exec_hi, 0
    s_cselect_b32 s78, 0, 1879048176
    v_add_u32 v37, s78, v1
    s_waitcnt lgkmcnt(0)
    buffer_store_dwordx4 v[28:31], v37, s[16:19], s79 offen sc1
    s_mov_b64 exec, -1
    v_mov_b32 v32, -1
    v_mov_b32 v33, -1
    v_mov_b32 v34, -1
    v_mov_b32 v35, -1
    buffer_store_dwordx4 v[32:35], v21, s[16:19], 0 offen sc1
    buffer_load_dwordx4 a[60:63], v1, s[8:11], s84 offen offset:3072 nt
    s_waitcnt vmcnt(12)
    ds_write_b128 v2, a[0:3] offset:0
    ds_write_b128 v3, a[4:7] offset:0
    ds_write_b128 v4, a[8:11] offset:0
    ds_write_b128 v2, a[12:15] offset:3328
    ds_write_b128 v3, a[16:19] offset:3328
    ds_write_b128 v4, a[20:23] offset:3328
    ds_read_b128 a[0:3], v5 offset:0
    ds_read_b128 a[4:7], v5 offset:64
    ds_read_b128 a[8:11], v5 offset:128
    ds_read_b128 a[12:15], v5 offset:192
    ds_read_b128 a[16:19], v5 offset:256
    ds_read_b128 a[20:23], v5 offset:320
    buffer_load_dwordx4 a[64:67], v23, s[8:11], s84 offen offset:0 nt
    buffer_load_dwordx4 a[68:71], v23, s[8:11], s84 offen offset:1024 nt
    s_barrier
    buffer_load_dwordx4 a[72:75], v1, s[8:11], s85 offen offset:0 nt
    buffer_load_dwordx4 a[76:79], v1, s[8:11], s85 offen offset:1024 nt
    buffer_load_dwordx4 a[80:83], v1, s[8:11], s85 offen offset:2048 nt
    buffer_load_dwordx4 a[84:87], v1, s[8:11], s85 offen offset:3072 nt
    buffer_load_dwordx4 a[88:91], v23, s[8:11], s85 offen offset:0 nt
    buffer_load_dwordx4 a[92:95], v23, s[8:11], s85 offen offset:1024 nt
    s_barrier
    s_getreg_b32 s5, hwreg(HW_REG_XCC_ID, 0, 4)
    s_cmp_lg_u32 s72, 0
    s_cbranch_scc1 NOHDR
    s_waitcnt vmcnt(9)
    v_readfirstlane_b32 s96, v98
    s_nop 0
    s_cmp_eq_u32 s96, 0
    s_cbranch_scc1 TAGLOOP
TAGOK:
    v_mov_b32 v99, s5
    s_mov_b64 exec, 1
    buffer_store_dwordx2 v[98:99], v1, s[16:19], s79 offen offset:384 sc1
    s_mov_b64 exec, -1
NOHDR:
    s_waitcnt vmcnt(14)
    ds_write_b128 v2, a[24:27] offset:0
    ds_write_b128 v3, a[28:31] offset:0
    ds_write_b128 v4, a[32:35] offset:0
    ds_write_b128 v2, a[36:39] offset:3328
    ds_write_b128 v3, a[40:43] offset:3328
    ds_write_b128 v4, a[44:47] offset:3328
    ds_read_b128 a[24:27], v5 offset:0
    ds_read_b128 a[28:31], v5 offset:64
    ds_read_b128 a[32:35], v5 offset:128
    ds_read_b128 a[36:39], v5 offset:192
    ds_read_b128 a[40:43], v5 offset:256
    ds_read_b128 a[44:47], v5 offset:320
    buffer_load_dwordx4 a[96:99], v1, s[8:11], s86 offen offset:0 nt
    buffer_load_dwordx4 a[100:103], v1, s[8:11], s86 offen offset:1024 nt
    buffer_load_dwordx4 a[104:107], v1, s[8:11], s86 offen offset:2048 nt
    buffer_load_dwordx4 a[108:111], v1, s[8:11], s86 offen offset:3072 nt
    buffer_load_dwordx4 a[112:115], v23, s[8:11], s86 offen offset:0 nt
    buffer_load_dwordx4 a[116:119], v23, s[8:11], s86 offen offset:1024 nt
    s_barrier
    s_waitcnt vmcnt(12)
    ds_write_b128 v2, a[48:51] offset:0
    ds_write_b128 v3, a[52:55] offset:0
    ds_write_b128 v4, a[56:59] offset:0
    ds_write_b128 v2, a[60:63] offset:3328
    ds_write_b128 v3, a[64:67] offset:3328
    ds_write_b128 v4, a[68:71] offset:3328
    ds_read_b128 a[48:51], v5 offset:0
    ds_read_b128 a[52:55], v5 offset:64
    ds_read_b128 a[56:59], v5 offset:128
    ds_read_b128 a[60:63], v5 offset:192
    ds_read_b128 a[64:67], v5 offset:256
    ds_read_b128 a[68:71], v5 offset:320
    v_lshlrev_b32 v100, 9, v0
    v_add_u32 v100, s3, v100
    v_bfe_u32 v96, v0, 2, 3
    v_mul_u32_u24 v96, 81920, v96
    v_and_b32 v97, 3, v0
    v_lshl_add_u32 v96, v97, 9, v96
    v_cmp_le_u32 vcc, 32, v0
    s_nop 1
    v_cndmask_b32 v100, v100, v96, vcc
    s_cmp_eq_u32 s72, 0
    s_cselect_b32 s77, 0, 1879048176
    v_add_u32 v100, s77, v100
    buffer_load_dwordx4 a[120:123], v1, s[8:11], s87 offen offset:0 nt
    buffer_load_dwordx4 a[124:127], v1, s[8:11], s87 offen offset:1024 nt
    buffer_load_dwordx4 a[128:131], v1, s[8:11], s87 offen offset:2048 nt
    buffer_load_dwordx4 a[132:135], v1, s[8:11], s87 offen offset:3072 nt
    buffer_load_dwordx4 a[136:139], v23, s[8:11], s87 offen offset:0 nt
    buffer_load_dwordx4 a[140:143], v23, s[8:11], s87 offen offset:1024 nt
    s_barrier
    s_waitcnt vmcnt(12)
    ds_write_b128 v2, a[72:75] offset:0
    ds_write_b128 v3, a[76:79] offset:0
    ds_write_b128 v4, a[80:83] offset:0
    ds_write_b128 v2, a[84:87] offset:3328
    ds_write_b128 v3, a[88:91] offset:3328
    ds_write_b128 v4, a[92:95] offset:3328
    ds_read_b128 a[72:75], v5 offset:0
    ds_read_b128 a[76:79], v5 offset:64
    ds_read_b128 a[80:83], v5 offset:128
    ds_read_b128 a[84:87], v5 offset:192
    ds_read_b128 a[88:91], v5 offset:256
    ds_read_b128 a[92:95], v5 offset:320
    buffer_load_dwordx4 a[144:147], v1, s[8:11], s88 offen offset:0 nt
    buffer_load_dwordx4 a[148:151], v1, s[8:11], s88 offen offset:1024 nt
    buffer_load_dwordx4 a[152:155], v1, s[8:11], s88 offen offset:2048 nt
    buffer_load_dwordx4 a[156:159], v1, s[8:11], s88 offen offset:3072 nt
    buffer_load_dwordx4 a[160:163], v23, s[8:11], s88 offen offset:0 nt
    buffer_load_dwordx4 a[164:167], v23, s[8:11], s88 offen offset:1024 nt
    s_barrier
    s_waitcnt vmcnt(12)
    ds_write_b128 v2, a[96:99] offset:0
    ds_write_b128 v3, a[100:103] offset:0
    ds_write_b128 v4, a[104:107] offset:0
    ds_write_b128 v2, a[108:111] offset:3328
    ds_write_b128 v3, a[112:115] offset:3328
    ds_write_b128 v4, a[116:119] offset:3328
    ds_read_b128 a[96:99], v5 offset:0
    ds_read_b128 a[100:103], v5 offset:64
    ds_read_b128 a[104:107], v5 offset:128
    ds_read_b128 a[108:111], v5 offset:192
    ds_read_b128 a[112:115], v5 offset:256
    ds_read_b128 a[116:119], v5 offset:320
    buffer_load_dwordx4 a[168:171], v1, s[8:11], s89 offen offset:0 nt
    buffer_load_dwordx4 a[172:175], v1, s[8:11], s89 offen offset:1024 nt
    buffer_load_dwordx4 a[176:179], v1, s[8:11], s89 offen offset:2048 nt
    buffer_load_dwordx4 a[180:183], v1, s[8:11], s89 offen offset:3072 nt
    buffer_load_dwordx4 a[184:187], v23, s[8:11], s89 offen offset:0 nt
    buffer_load_dwordx4 a[188:191], v23, s[8:11], s89 offen offset:1024 nt
    s_barrier
    s_cmp_ge_u32 s69, 20
    s_cbranch_scc1 DMAF
    s_lshl_b32 s66, s72, 3
    s_add_u32 s66, s66, s68
    s_mul_i32 s66, s66, 245760
    s_lshl_b32 s78, s69, 6
    s_add_u32 s66, s66, s78
    s_mul_i32 s67, s72, 12288
    s_add_u32 s67, s67, 57344
DMAX:
    v_mov_b32 v109, v20
    v_and_b32 v25, 15, v0
    v_lshrrev_b32 v26, 4, v0
    v_add_u32 v27, 4, v26
    s_mul_i32 s7, s68, 10240
    s_add_u32 s7, s7, 737280
    v_mul_u32_u24 v20, 1280, v26
    v_add_u32 v20, s7, v20
    s_mul_i32 s7, s68, 81920
    s_add_u32 s7, s7, 46592
    v_mov_b32 v28, s7
    v_cmp_eq_u32 vcc, s68, v26
    s_nop 1
    v_cndmask_b32 v20, v20, v28, vcc
    s_mul_i32 s7, s68, 10240
    s_add_u32 s7, s7, 737280
    v_mul_u32_u24 v21, 1280, v27
    v_add_u32 v21, s7, v21
    s_mul_i32 s7, s68, 81920
    s_add_u32 s7, s7, 46592
    v_mov_b32 v28, s7
    v_cmp_eq_u32 vcc, s68, v27
    s_nop 1
    v_cndmask_b32 v21, v21, v28, vcc
    s_min_u32 s7, s69, 19
    s_lshl_b32 s7, s7, 6
    v_lshl_add_u32 v25, v25, 2, s7
    v_add_u32 v20, v20, v25
    v_add_u32 v21, v21, v25
    buffer_load_dwordx4 a[216:219], v1, s[12:15], s73 offen offset:0 nt
    v_and_b32 v25, 15, v0
    v_bfe_u32 v27, v0, 2, 2
    v_and_b32 v28, 3, v0
    s_mul_i32 s7, s72, 12288
    s_add_u32 s7, s7, 57344
    v_lshl_add_u32 v29, v26, 3, v27
    v_lshlrev_b32 v29, 6, v29
    v_lshl_add_u32 v29, v28, 3, v29
    v_add_u32 v29, s7, v29
    v_accvgpr_write_b32 a246, v29
    s_mul_i32 s7, s72, 3072
    s_add_u32 s7, s7, 32768
    v_lshl_add_u32 v29, v25, 4, s7
    v_lshl_add_u32 v29, v26, 7, v29
    v_accvgpr_write_b32 a247, v29
    s_lshl_b32 s7, s72, 6
    s_add_u32 s7, s7, 45056
    v_and_b32 v29, 1, v26
    v_lshl_add_u32 v29, v29, 5, s7
    v_accvgpr_write_b32 a248, v29
    s_lshl_b32 s7, s72, 8
    s_add_u32 s7, s7, 122368
    v_lshl_add_u32 v29, v0, 2, s7
    v_accvgpr_write_b32 a249, v29
    s_lshl_b32 s81, s69, 6
    s_mul_i32 s80, s68, 1280
    s_add_u32 s80, s80, s81
    s_add_u32 s80, s80, 655360
    s_add_u32 s81, s81, s3
    s_add_u32 s81, s81, 45312
    s_waitcnt vmcnt(13)
    ds_write_b128 v2, a[120:123] offset:0
    ds_write_b128 v3, a[124:127] offset:0
    ds_write_b128 v4, a[128:131] offset:0
    ds_write_b128 v2, a[132:135] offset:3328
    ds_write_b128 v3, a[136:139] offset:3328
    ds_write_b128 v4, a[140:143] offset:3328
    ds_read_b128 a[120:123], v5 offset:0
    ds_read_b128 a[124:127], v5 offset:64
    ds_read_b128 a[128:131], v5 offset:128
    ds_read_b128 a[132:135], v5 offset:192
    ds_read_b128 a[136:139], v5 offset:256
    ds_read_b128 a[140:143], v5 offset:320
    buffer_load_dwordx4 a[220:223], v1, s[12:15], s73 offen offset:1024 nt
    buffer_load_dwordx4 a[224:227], v1, s[12:15], s73 offen offset:2048 nt
    buffer_load_dwordx4 a[228:231], v1, s[12:15], s73 offen offset:3072 nt
    buffer_load_dwordx4 a[232:235], v23, s[12:15], s73 offen offset:0 nt
    buffer_load_dwordx4 a[236:239], v23, s[12:15], s73 offen offset:1024 nt
    s_barrier
    buffer_load_dwordx2 v[98:99], v100, s[16:19], 0 offen offset:384 sc1
    s_waitcnt vmcnt(13)
    ds_write_b128 v2, a[144:147] offset:0
    ds_write_b128 v3, a[148:151] offset:0
    ds_write_b128 v4, a[152:155] offset:0
    ds_write_b128 v2, a[156:159] offset:3328
    ds_write_b128 v3, a[160:163] offset:3328
    ds_write_b128 v4, a[164:167] offset:3328
    ds_read_b128 a[144:147], v5 offset:0
    ds_read_b128 a[148:151], v5 offset:64
    ds_read_b128 a[152:155], v5 offset:128
    ds_read_b128 a[156:159], v5 offset:192
    ds_read_b128 a[160:163], v5 offset:256
    ds_read_b128 a[164:167], v5 offset:320
    buffer_load_dwordx4 v[112:115], v1, s[12:15], s83 offen offset:0 nt
    buffer_load_dwordx4 v[116:119], v1, s[12:15], s83 offen offset:1024 nt
    buffer_load_dwordx4 v[120:123], v1, s[12:15], s83 offen offset:2048 nt
    buffer_load_dwordx4 v[124:127], v1, s[12:15], s83 offen offset:3072 nt
    buffer_load_dwordx4 v[128:131], v23, s[12:15], s83 offen offset:0 nt
    buffer_load_dwordx4 v[132:135], v23, s[12:15], s83 offen offset:1024 nt
    s_barrier
    s_waitcnt vmcnt(13)
    ds_write_b128 v2, a[168:171] offset:0
    ds_write_b128 v3, a[172:175] offset:0
    ds_write_b128 v4, a[176:179] offset:0
    ds_write_b128 v2, a[180:183] offset:3328
    ds_write_b128 v3, a[184:187] offset:3328
    ds_write_b128 v4, a[188:191] offset:3328
    ds_read_b128 a[168:171], v5 offset:0
    ds_read_b128 a[172:175], v5 offset:64
    ds_read_b128 a[176:179], v5 offset:128
    ds_read_b128 a[180:183], v5 offset:192
    ds_read_b128 a[184:187], v5 offset:256
    ds_read_b128 a[188:191], v5 offset:320
    buffer_load_dwordx4 v[136:139], v1, s[12:15], s84 offen offset:0 nt
    buffer_load_dwordx4 v[140:143], v1, s[12:15], s84 offen offset:1024 nt
    buffer_load_dwordx4 v[144:147], v1, s[12:15], s84 offen offset:2048 nt
    buffer_load_dwordx4 v[148:151], v1, s[12:15], s84 offen offset:3072 nt
    buffer_load_dwordx4 v[152:155], v23, s[12:15], s84 offen offset:0 nt
    buffer_load_dwordx4 v[156:159], v23, s[12:15], s84 offen offset:1024 nt
    s_barrier
    s_waitcnt vmcnt(12)
    s_mov_b32 s76, -1
    v_mov_b32 v97, 125504
    s_cmp_lg_u32 s72, 0
    s_cbranch_scc1 RDYX
    v_cmp_ne_u32 vcc, s96, v98
    s_cbranch_vccnz RDYLOOP
RDYOK:
    v_cmp_ne_u32 vcc, s5, v99
    s_nop 1
    v_mov_b32 v96, vcc_lo
    ds_write_b32 v97, v96
RDYX:
    buffer_load_dwordx4 v[160:163], v1, s[12:15], s85 offen offset:0 nt
    buffer_load_dwordx4 v[164:167], v1, s[12:15], s85 offen offset:1024 nt
    s_waitcnt lgkmcnt(0)
    s_barrier
    ds_read_b32 v96, v97
    s_waitcnt lgkmcnt(0)
    v_readfirstlane_b32 s77, v96
    s_nop 0
    s_cmp_eq_u32 s77, 0
    s_cselect_b32 s10, s18, 0
    s_mov_b32 s8, s16
    s_mov_b32 s9, s17
    s_mov_b32 s11, 0x20000
    buffer_load_dwordx4 a[240:243], v109, s[16:19], 0 offen sc1
    s_mul_i32 s77, s69, 432
    s_add_u32 s77, s77, s3
    s_add_u32 s77, s77, 49152
    s_cmp_eq_u32 s72, 3
    s_cselect_b32 s77, s77, 1879048176
    v_add_u32 v106, s77, v1
    v_mov_b32 v107, 2147483632
    v_cmp_le_u32 vcc, 27, v0
    s_nop 1
    v_cndmask_b32 v106, v106, v107, vcc
    buffer_load_dwordx4 a[240:243], v106, s[16:19], 0 offen sc1
    s_lshl_b32 s77, s69, 2
    s_add_u32 s77, s77, s72
    s_lshl_b32 s78, s77, 8
    s_add_u32 s78, s78, 819200
    s_lshl_b32 s77, s77, 9
    s_sub_u32 s77, s77, 256
    v_lshlrev_b32 v24, 7, v0
    v_add_u32 v25, s77, v24
    v_min_u32 v25, 56704, v25
    v_add_u32 v24, s78, v24
    v_cmp_gt_u32 vcc, 2, v0
    s_nop 1
    v_cndmask_b32 v24, v25, v24, vcc
    s_add_u32 s77, s3, 819200
    s_mov_b64 exec, 63
    buffer_load_dword a243, v24, s[16:19], s77 offen sc1
    s_mov_b64 exec, -1
    s_lshl_b32 s77, s70, 12
    s_mul_i32 s78, s72, 96
    s_add_u32 s77, s77, s78
    s_add_u32 s77, s77, s3
    v_lshrrev_b32 v24, 4, v0
    v_lshlrev_b32 v24, 9, v24
    v_and_b32 v25, 15, v0
    v_min_u32 v25, 11, v25
    v_lshl_add_u32 v24, v25, 3, v24
    buffer_load_dwordx2 v[64:65], v24, s[16:19], s77 offen offset:0 sc1
    buffer_load_dwordx2 v[66:67], v24, s[16:19], s77 offen offset:2048 sc1
    s_cmp_lg_u32 s72, 1
    s_cbranch_scc1 NOBASE0
    s_cmp_ge_u32 s69, 20
    s_cbranch_scc1 NOBASE0
    v_mov_b32 v28, v22
    s_lshl_b32 s77, s69, 6
    s_add_u32 s77, s77, s3
    s_add_u32 s77, s77, 47872
    v_lshlrev_b32 v27, 2, v0
    v_mov_b32_dpp v29, v28 quad_perm:[1,1,1,1] row_mask:0xf bank_mask:0xf
    v_mov_b32_dpp v30, v28 quad_perm:[2,2,2,2] row_mask:0xf bank_mask:0xf
    v_mov_b32_dpp v31, v28 quad_perm:[3,3,3,3] row_mask:0xf bank_mask:0xf
    s_mov_b32 exec_lo, 0x1111
    s_mov_b32 exec_hi, 0x0
    buffer_store_dwordx4 v[28:31], v27, s[8:11], s77 offen
    s_cmp_eq_u32 s10, 0
    s_cbranch_scc1 SLOW1
BACK1:
    s_mov_b64 exec, -1
NOBASE0:
    ds_write_b128 v2, a[216:219] offset:0
    ds_write_b128 v3, a[220:223] offset:0
    ds_write_b128 v4, a[224:227] offset:0
    ds_write_b128 v2, a[228:231] offset:3328
    ds_write_b128 v3, a[232:235] offset:3328
    ds_write_b128 v4, a[236:239] offset:3328
    ds_read_b64_tr_b16 a[192:193], v6 offset:0
    ds_read_b64_tr_b16 a[196:197], v6 offset:32
    ds_read_b64_tr_b16 a[200:201], v6 offset:64
    ds_read_b64_tr_b16 a[204:205], v6 offset:96
    ds_read_b64_tr_b16 a[208:209], v6 offset:128
    ds_read_b64_tr_b16 a[212:213], v6 offset:160
    ds_read_b64_tr_b16 a[216:217], v6 offset:192
    ds_read_b64_tr_b16 a[220:221], v6 offset:224
    ds_read_b64_tr_b16 a[224:225], v6 offset:256
    ds_read_b64_tr_b16 a[228:229], v6 offset:288
    ds_read_b64_tr_b16 a[232:233], v6 offset:320
    ds_read_b64_tr_b16 a[236:237], v6 offset:352
    s_waitcnt vmcnt(13)
    ds_write_b128 v2, v[112:115] offset:0
    ds_write_b128 v3, v[116:119] offset:0
    ds_write_b128 v4, v[120:123] offset:0
    ds_write_b128 v2, v[124:127] offset:3328
    ds_write_b128 v3, v[128:131] offset:3328
    ds_write_b128 v4, v[132:135] offset:3328
    ds_read_b64_tr_b16 a[194:195], v6 offset:0
    ds_read_b64_tr_b16 a[198:199], v6 offset:32
    ds_read_b64_tr_b16 a[202:203], v6 offset:64
    ds_read_b64_tr_b16 a[206:207], v6 offset:96
    ds_read_b64_tr_b16 a[210:211], v6 offset:128
    ds_read_b64_tr_b16 a[214:215], v6 offset:160
    ds_read_b64_tr_b16 a[218:219], v6 offset:192
    ds_read_b64_tr_b16 a[222:223], v6 offset:224
    ds_read_b64_tr_b16 a[226:227], v6 offset:256
    ds_read_b64_tr_b16 a[230:231], v6 offset:288
    ds_read_b64_tr_b16 a[234:235], v6 offset:320
    ds_read_b64_tr_b16 a[238:239], v6 offset:352
    buffer_load_dwordx4 v[168:171], v1, s[12:15], s85 offen offset:2048 nt
    buffer_load_dwordx4 v[172:175], v1, s[12:15], s85 offen offset:3072 nt
    buffer_load_dwordx4 v[176:179], v23, s[12:15], s85 offen offset:0 nt
    buffer_load_dwordx4 v[180:183], v23, s[12:15], s85 offen offset:1024 nt
    s_barrier
    buffer_load_dwordx4 v[184:187], v1, s[12:15], s86 offen offset:0 nt
    s_waitcnt vmcnt(12)
    ds_write_b128 v2, v[136:139] offset:0
    ds_write_b128 v3, v[140:143] offset:0
    ds_write_b128 v4, v[144:147] offset:0
    ds_write_b128 v2, v[148:151] offset:3328
    ds_write_b128 v3, v[152:155] offset:3328
    ds_write_b128 v4, v[156:159] offset:3328
    ds_read_b64_tr_b16 v[112:113], v6 offset:0
    ds_read_b64_tr_b16 v[116:117], v6 offset:32
    ds_read_b64_tr_b16 v[120:121], v6 offset:64
    ds_read_b64_tr_b16 v[124:125], v6 offset:96
    ds_read_b64_tr_b16 v[128:129], v6 offset:128
    ds_read_b64_tr_b16 v[132:133], v6 offset:160
    ds_read_b64_tr_b16 v[136:137], v6 offset:192
    ds_read_b64_tr_b16 v[140:141], v6 offset:224
    ds_read_b64_tr_b16 v[144:145], v6 offset:256
    ds_read_b64_tr_b16 v[148:149], v6 offset:288
    ds_read_b64_tr_b16 v[152:153], v6 offset:320
    ds_read_b64_tr_b16 v[156:157], v6 offset:352
    buffer_load_dwordx4 v[188:191], v1, s[12:15], s86 offen offset:1024 nt
    buffer_load_dwordx4 v[192:195], v1, s[12:15], s86 offen offset:2048 nt
    buffer_load_dwordx4 v[196:199], v1, s[12:15], s86 offen offset:3072 nt
    buffer_load_dwordx4 v[200:203], v23, s[12:15], s86 offen offset:0 nt
    buffer_load_dwordx4 v[204:207], v23, s[12:15], s86 offen offset:1024 nt
    s_barrier
    buffer_load_dwordx4 v[208:211], v1, s[12:15], s87 offen offset:0 nt
    buffer_load_dwordx4 v[212:215], v1, s[12:15], s87 offen offset:1024 nt
    s_waitcnt vmcnt(12)
    v_lshlrev_b32 v24, 16, v64
    v_and_b32 v25, 0xffff0000, v64
    v_lshlrev_b32 v26, 16, v65
    v_and_b32 v27, 0xffff0000, v65
    v_lshlrev_b32 v28, 16, v66
    v_and_b32 v29, 0xffff0000, v66
    v_lshlrev_b32 v30, 16, v67
    v_and_b32 v31, 0xffff0000, v67
    v_add_f32 v24, v24, v28
    v_add_f32 v25, v25, v29
    v_add_f32 v26, v26, v30
    v_add_f32 v27, v27, v31
    s_nop 0
    v_permlane32_swap_b32 v24, v26
    v_permlane32_swap_b32 v25, v27
    v_add_f32 v24, v24, v26
    v_add_f32 v25, v25, v27
    s_nop 1
    v_permlane16_swap_b32 v24, v25
    v_add_f32 v24, v24, v25
    v_cvt_pk_bf16_f32 v24, v24, v24
    ds_write_b16 v12, v24
    buffer_load_dwordx4 v[216:219], v1, s[12:15], s87 offen offset:2048 nt
    v_mov_b32 v40, 0
    v_mov_b32 v41, 0
    v_mov_b32 v44, 0
    v_mov_b32 v45, 0
    v_mov_b32 v48, 0
    v_mov_b32 v49, 0
    v_mov_b32 v52, 0
    v_mov_b32 v53, 0
    v_mov_b32 v56, 0
    v_mov_b32 v57, 0
    v_mov_b32 v60, 0
    v_mov_b32 v61, 0
    v_mov_b32 v64, 0
    v_mov_b32 v65, 0
    v_mov_b32 v68, 0
    v_mov_b32 v69, 0
    v_mov_b32 v72, 0
    v_mov_b32 v73, 0
    v_mov_b32 v74, 0
    v_mov_b32 v75, 0
    v_mov_b32 v76, 0
    v_mov_b32 v77, 0
    v_mov_b32 v78, 0
    v_mov_b32 v79, 0
    v_mov_b32 v80, 0
    v_mov_b32 v81, 0
    v_mov_b32 v82, 0
    v_mov_b32 v83, 0
    v_mov_b32 v84, 0
    v_mov_b32 v85, 0
    v_mov_b32 v86, 0
    v_mov_b32 v87, 0
    buffer_load_dwordx4 v[220:223], v1, s[12:15], s87 offen offset:3072 nt
    buffer_load_dwordx4 v[224:227], v23, s[12:15], s87 offen offset:0 nt
    s_waitcnt lgkmcnt(0)
    s_barrier
    ds_read_b128 v[28:31], v13 offset:0
    ds_read_b128 v[32:35], v13 offset:128
    ds_read_b128 v[36:39], v13 offset:256
    v_mov_b32 v18, 0x3dd53b94
    s_waitcnt lgkmcnt(2)
    v_smfmac_f32_16x16x64_bf16 v[40:43], v[28:31], a[0:7], v14
    v_smfmac_f32_16x16x64_bf16 v[44:47], v[28:31], a[24:31], v14
    v_smfmac_f32_16x16x64_bf16 v[48:51], v[28:31], a[48:55], v14
    v_smfmac_f32_16x16x64_bf16 v[52:55], v[28:31], a[72:79], v14
    v_smfmac_f32_16x16x64_bf16 v[56:59], v[28:31], a[96:103], v14
    v_smfmac_f32_16x16x64_bf16 v[60:63], v[28:31], a[120:127], v14
    v_smfmac_f32_16x16x64_bf16 v[64:67], v[28:31], a[144:151], v14
    v_smfmac_f32_16x16x64_bf16 v[68:71], v[28:31], a[168:175], v14
    buffer_load_dwordx4 v[228:231], v23, s[12:15], s87 offen offset:1024 nt
    s_barrier
    s_waitcnt lgkmcnt(1)
    v_smfmac_f32_16x16x64_bf16 v[40:43], v[32:35], a[8:15], v14
    v_smfmac_f32_16x16x64_bf16 v[44:47], v[32:35], a[32:39], v14
    v_smfmac_f32_16x16x64_bf16 v[48:51], v[32:35], a[56:63], v14
    v_smfmac_f32_16x16x64_bf16 v[52:55], v[32:35], a[80:87], v14
    v_smfmac_f32_16x16x64_bf16 v[56:59], v[32:35], a[104:111], v14
    v_smfmac_f32_16x16x64_bf16 v[60:63], v[32:35], a[128:135], v14
    v_smfmac_f32_16x16x64_bf16 v[64:67], v[32:35], a[152:159], v14
    v_smfmac_f32_16x16x64_bf16 v[68:71], v[32:35], a[176:183], v14
    s_waitcnt lgkmcnt(0)
    v_smfmac_f32_16x16x64_bf16 v[40:43], v[36:39], a[16:23], v14
    v_smfmac_f32_16x16x64_bf16 v[44:47], v[36:39], a[40:47], v14
    v_smfmac_f32_16x16x64_bf16 v[48:51], v[36:39], a[64:71], v14
    v_smfmac_f32_16x16x64_bf16 v[52:55], v[36:39], a[88:95], v14
    v_smfmac_f32_16x16x64_bf16 v[56:59], v[36:39], a[112:119], v14
    v_smfmac_f32_16x16x64_bf16 v[60:63], v[36:39], a[136:143], v14
    v_smfmac_f32_16x16x64_bf16 v[64:67], v[36:39], a[160:167], v14
    v_smfmac_f32_16x16x64_bf16 v[68:71], v[36:39], a[184:191], v14
    buffer_load_dwordx4 v[232:235], v1, s[12:15], s88 offen offset:0 nt
    v_add_f32 v24, v40, v41
    v_add_f32 v44, v44, v45
    v_add_f32 v48, v48, v49
    v_max3_f32 v26, v24, v44, v48
    v_add_f32 v52, v52, v53
    v_add_f32 v25, v56, v57
    v_max3_f32 v26, v26, v52, v25
    v_add_f32 v60, v60, v61
    v_add_f32 v64, v64, v65
    v_max3_f32 v26, v26, v60, v64
    v_add_f32 v68, v68, v69
    v_max_f32 v26, v26, v68
    v_mov_b32_dpp v24, v44 quad_perm:[0,1,2,3] row_mask:0x2 bank_mask:0xf
    v_mov_b32_dpp v25, v60 quad_perm:[0,1,2,3] row_mask:0x2 bank_mask:0xf
    v_max_f32_dpp v26, v26, v26 row_ror:8 row_mask:0xf bank_mask:0xf
    v_mov_b32_dpp v24, v48 quad_perm:[0,1,2,3] row_mask:0x4 bank_mask:0xf
    v_mov_b32_dpp v25, v64 quad_perm:[0,1,2,3] row_mask:0x4 bank_mask:0xf
    v_max_f32_dpp v26, v26, v26 row_ror:4 row_mask:0xf bank_mask:0xf
    v_mov_b32_dpp v24, v52 quad_perm:[0,1,2,3] row_mask:0x8 bank_mask:0xf
    v_mov_b32_dpp v25, v68 quad_perm:[0,1,2,3] row_mask:0x8 bank_mask:0xf
    v_max_f32_dpp v26, v26, v26 row_ror:2 row_mask:0xf bank_mask:0xf
    v_accvgpr_read_b32 v27, a252
    s_nop 0
    v_max_f32_dpp v26, v26, v26 row_ror:1 row_mask:0xf bank_mask:0xf
    buffer_load_dwordx4 v[236:239], v1, s[12:15], s88 offen offset:1024 nt
    v_mul_f32 v26, v26, v18
    v_fma_f32 v24, v24, v18, -v26
    v_fma_f32 v25, v25, v18, -v26
    v_exp_f32 v24, v24
    v_exp_f32 v25, v25
    s_nop 0
    v_cvt_pk_bf16_f32 v28, v24, v25
    ds_write_b16 v19, v28
    ds_write_b16_d16_hi v19, v28 offset:128
    s_mov_b32 exec_lo, 0xff00ff
    s_mov_b32 exec_hi, 0xff00ff00
    ds_read_b128 v[72:75], v27 offset:0
    ds_read_b128 v[76:79], v27 offset:64
    ds_read_b128 v[80:83], v27 offset:128
    ds_read_b128 v[84:87], v27 offset:192
    s_mov_b64 exec, -1
    v_add_f32 v27, v24, v25
    v_mov_b32 v40, 0
    v_mov_b32 v44, 0
    v_add_f32_dpp v27, v27, v27 row_ror:8 row_mask:0xf bank_mask:0xf
    v_mov_b32 v48, 0
    v_mov_b32 v52, 0
    v_add_f32_dpp v27, v27, v27 row_ror:4 row_mask:0xf bank_mask:0xf
    v_mov_b32 v56, 0
    v_mov_b32 v60, 0
    v_add_f32_dpp v27, v27, v27 row_ror:2 row_mask:0xf bank_mask:0xf
    s_lshl_b32 s78, s72, 3
    s_add_u32 s78, s78, 125440
    v_add_f32_dpp v27, v27, v27 row_ror:1 row_mask:0xf bank_mask:0xf
    v_mov_b32 v28, v27
    s_nop 1
    v_permlane32_swap_b32 v27, v28
    v_add_f32 v27, v27, v28
    v_mov_b32 v28, v27
    s_nop 1
    v_permlane16_swap_b32 v27, v28
    v_add_f32 v27, v27, v28
    v_mov_b32 v28, s78
    ds_write_b64 v28, v[26:27]
    s_waitcnt vmcnt(14)
    ds_write_b128 v2, v[160:163] offset:0
    ds_write_b128 v3, v[164:167] offset:0
    ds_write_b128 v4, v[168:171] offset:0
    ds_write_b128 v2, v[172:175] offset:3328
    ds_write_b128 v3, v[176:179] offset:3328
    ds_write_b128 v4, v[180:183] offset:3328
    ds_read_b64_tr_b16 v[114:115], v6 offset:0
    ds_read_b64_tr_b16 v[118:119], v6 offset:32
    ds_read_b64_tr_b16 v[122:123], v6 offset:64
    ds_read_b64_tr_b16 v[126:127], v6 offset:96
    ds_read_b64_tr_b16 v[130:131], v6 offset:128
    ds_read_b64_tr_b16 v[134:135], v6 offset:160
    ds_read_b64_tr_b16 v[138:139], v6 offset:192
    ds_read_b64_tr_b16 v[142:143], v6 offset:224
    ds_read_b64_tr_b16 v[146:147], v6 offset:256
    ds_read_b64_tr_b16 v[150:151], v6 offset:288
    ds_read_b64_tr_b16 v[154:155], v6 offset:320
    ds_read_b64_tr_b16 v[158:159], v6 offset:352
    buffer_load_dwordx4 v[240:243], v1, s[12:15], s88 offen offset:2048 nt
    buffer_load_dwordx4 v[244:247], v1, s[12:15], s88 offen offset:3072 nt
    s_waitcnt lgkmcnt(0)
    v_smfmac_f32_16x16x64_bf16 v[40:43], v[72:75], a[192:199], v14 abid:1
    v_smfmac_f32_16x16x64_bf16 v[44:47], v[72:75], a[200:207], v14 abid:1
    v_smfmac_f32_16x16x64_bf16 v[48:51], v[72:75], a[208:215], v14 abid:1
    v_smfmac_f32_16x16x64_bf16 v[52:55], v[72:75], a[216:223], v14 abid:1
    v_smfmac_f32_16x16x64_bf16 v[56:59], v[72:75], a[224:231], v14 abid:1
    v_smfmac_f32_16x16x64_bf16 v[60:63], v[72:75], a[232:239], v14 abid:1
    buffer_load_dwordx4 v[248:251], v23, s[12:15], s88 offen offset:0 nt
    v_smfmac_f32_16x16x64_bf16 v[40:43], v[76:79], v[112:119], v14 abid:1
    v_smfmac_f32_16x16x64_bf16 v[44:47], v[76:79], v[120:127], v14 abid:1
    v_smfmac_f32_16x16x64_bf16 v[48:51], v[76:79], v[128:135], v14 abid:1
    v_smfmac_f32_16x16x64_bf16 v[52:55], v[76:79], v[136:143], v14 abid:1
    v_smfmac_f32_16x16x64_bf16 v[56:59], v[76:79], v[144:151], v14 abid:1
    v_smfmac_f32_16x16x64_bf16 v[60:63], v[76:79], v[152:159], v14 abid:1
    buffer_load_dwordx4 v[252:255], v23, s[12:15], s88 offen offset:1024 nt
    s_barrier
    s_waitcnt vmcnt(12)
    ds_write_b128 v2, v[184:187] offset:0
    ds_write_b128 v3, v[188:191] offset:0
    ds_write_b128 v4, v[192:195] offset:0
    ds_write_b128 v2, v[196:199] offset:3328
    ds_write_b128 v3, v[200:203] offset:3328
    ds_write_b128 v4, v[204:207] offset:3328
    ds_read_b64_tr_b16 v[160:161], v6 offset:0
    ds_read_b64_tr_b16 v[164:165], v6 offset:32
    ds_read_b64_tr_b16 v[168:169], v6 offset:64
    ds_read_b64_tr_b16 v[172:173], v6 offset:96
    ds_read_b64_tr_b16 v[176:177], v6 offset:128
    ds_read_b64_tr_b16 v[180:181], v6 offset:160
    ds_read_b64_tr_b16 v[184:185], v6 offset:192
    ds_read_b64_tr_b16 v[188:189], v6 offset:224
    ds_read_b64_tr_b16 v[192:193], v6 offset:256
    ds_read_b64_tr_b16 v[196:197], v6 offset:288
    ds_read_b64_tr_b16 v[200:201], v6 offset:320
    ds_read_b64_tr_b16 v[204:205], v6 offset:352
    v_mov_b32 v24, -1
    v_mov_b32 v25, -1
    v_mov_b32 v26, -1
    v_mov_b32 v27, -1
    buffer_store_dwordx4 v[24:27], v106, s[8:11], 0 offen
    s_cmp_eq_u32 s10, 0
    s_cbranch_scc1 SLOW2
BACK2:
    buffer_load_dwordx4 v[88:91], v1, s[12:15], s89 offen offset:0 nt
    buffer_load_dwordx4 v[92:95], v1, s[12:15], s89 offen offset:1024 nt
    buffer_load_dwordx4 v[96:99], v1, s[12:15], s89 offen offset:2048 nt
    buffer_load_dwordx4 v[100:103], v1, s[12:15], s89 offen offset:3072 nt
    buffer_load_dwordx4 v[104:107], v23, s[12:15], s89 offen offset:0 nt
    buffer_load_dwordx4 v[108:111], v23, s[12:15], s89 offen offset:1024 nt
    s_waitcnt vmcnt(13)
    ds_write_b128 v2, v[208:211] offset:0
    ds_write_b128 v3, v[212:215] offset:0
    ds_write_b128 v4, v[216:219] offset:0
    ds_write_b128 v2, v[220:223] offset:3328
    ds_write_b128 v3, v[224:227] offset:3328
    ds_write_b128 v4, v[228:231] offset:3328
    ds_read_b64_tr_b16 v[162:163], v6 offset:0
    ds_read_b64_tr_b16 v[166:167], v6 offset:32
    ds_read_b64_tr_b16 v[170:171], v6 offset:64
    ds_read_b64_tr_b16 v[174:175], v6 offset:96
    ds_read_b64_tr_b16 v[178:179], v6 offset:128
    ds_read_b64_tr_b16 v[182:183], v6 offset:160
    ds_read_b64_tr_b16 v[186:187], v6 offset:192
    ds_read_b64_tr_b16 v[190:191], v6 offset:224
    ds_read_b64_tr_b16 v[194:195], v6 offset:256
    ds_read_b64_tr_b16 v[198:199], v6 offset:288
    ds_read_b64_tr_b16 v[202:203], v6 offset:320
    ds_read_b64_tr_b16 v[206:207], v6 offset:352
    v_and_b32 v23, 0xffff0000, v22
    v_lshlrev_b32 v22, 16, v22
    s_mov_b32 s82, 0x1010101
    s_mov_b32 s83, 0x1010101
    s_mov_b32 s84, 0x1ff01ff
    s_mov_b32 s85, 0x1ff01ff
    s_mov_b32 s86, 0xffffffff
    s_mov_b32 s87, 0x1fff
    s_mov_b32 s50, 0x7fffff
    s_mov_b32 s51, 0x0
    s_mov_b32 s88, 0xff00ff
    s_mov_b32 s89, 0xff00ff00
    s_mov_b32 s92, 0x1010101
    s_mov_b32 s93, 0x0
    s_mov_b32 s44, 0xf0f0f0f
    s_mov_b32 s45, 0xf0f0f0f
    s_mov_b64 s[46:47], s[92:93]
    s_mov_b64 s[48:49], s[44:45]
    s_cmp_ge_u32 s69, 20
    s_cbranch_scc1 TAILF
    v_mov_b32 v24, -1
    v_mov_b32 v25, -1
    v_mov_b32 v26, -1
    v_mov_b32 v27, -1
    v_and_b32 v28, 3, v0
    v_lshrrev_b32 v29, 5, v0
    v_lshl_add_u32 v28, v29, 2, v28
    v_mul_u32_u24 v28, 10240, v28
    v_bfe_u32 v29, v0, 3, 2
    v_lshl_add_u32 v28, v29, 4, v28
    s_cmp_eq_u32 s72, 3
    s_cselect_b32 s77, 0, 1879048176
    v_add_u32 v28, s77, v28
    s_add_u32 s77, s80, 81920
    s_mov_b64 exec, s[44:45]
    buffer_store_dwordx4 v[24:27], v28, s[16:19], s77 offen sc1
    s_mov_b64 exec, -1
    v_lshrrev_b32 v38, 2, v0
    v_mul_u32_u24 v38, 1280, v38
    v_and_b32 v39, 3, v0
    v_lshl_add_u32 v39, v39, 4, v38
    s_mov_b32 m0, s67
    s_add_u32 s67, s67, 1024
    buffer_load_dwordx4 v39, s[24:27], s66 offen  lds
    s_add_u32 s66, s66, 20480
    s_mov_b32 m0, s67
    s_add_u32 s67, s67, 1024
    buffer_load_dwordx4 v39, s[24:27], s66 offen  lds
    s_add_u32 s66, s66, 20480
    s_mov_b32 m0, s67
    s_add_u32 s67, s67, 1024
    buffer_load_dwordx4 v39, s[24:27], s66 offen  lds
    s_add_u32 s66, s66, 20480
    s_waitcnt lgkmcnt(0)
    v_smfmac_f32_16x16x64_bf16 v[40:43], v[80:83], v[160:167], v14 abid:1
    v_smfmac_f32_16x16x64_bf16 v[44:47], v[80:83], v[168:175], v14 abid:1
    v_smfmac_f32_16x16x64_bf16 v[48:51], v[80:83], v[176:183], v14 abid:1
    v_smfmac_f32_16x16x64_bf16 v[52:55], v[80:83], v[184:191], v14 abid:1
    v_smfmac_f32_16x16x64_bf16 v[56:59], v[80:83], v[192:199], v14 abid:1
    v_smfmac_f32_16x16x64_bf16 v[60:63], v[80:83], v[200:207], v14 abid:1
    s_waitcnt vmcnt(11)
    ds_write_b128 v2, v[232:235] offset:0
    ds_write_b128 v3, v[236:239] offset:0
    ds_write_b128 v4, v[240:243] offset:0
    ds_write_b128 v2, v[244:247] offset:3328
    ds_write_b128 v3, v[248:251] offset:3328
    ds_write_b128 v4, v[252:255] offset:3328
    ds_read_b64_tr_b16 v[208:209], v6 offset:0
    ds_read_b64_tr_b16 v[212:213], v6 offset:32
    ds_read_b64_tr_b16 v[216:217], v6 offset:64
    ds_read_b64_tr_b16 v[220:221], v6 offset:96
    ds_read_b64_tr_b16 v[224:225], v6 offset:128
    ds_read_b64_tr_b16 v[228:229], v6 offset:160
    ds_read_b64_tr_b16 v[232:233], v6 offset:192
    ds_read_b64_tr_b16 v[236:237], v6 offset:224
    ds_read_b64_tr_b16 v[240:241], v6 offset:256
    ds_read_b64_tr_b16 v[244:245], v6 offset:288
    ds_read_b64_tr_b16 v[248:249], v6 offset:320
    ds_read_b64_tr_b16 v[252:253], v6 offset:352
    s_mov_b32 m0, s67
    s_add_u32 s67, s67, 1024
    buffer_load_dwordx4 v39, s[24:27], s66 offen  lds
    s_add_u32 s66, s66, 20480
    s_mov_b32 m0, s67
    s_add_u32 s67, s67, 1024
    buffer_load_dwordx4 v39, s[24:27], s66 offen  lds
    s_add_u32 s66, s66, 20480
    s_mov_b32 m0, s67
    s_add_u32 s67, s67, 1024
    buffer_load_dwordx4 v39, s[24:27], s66 offen  lds
    s_add_u32 s66, s66, 20480
    s_waitcnt vmcnt(12)
    ds_write_b128 v2, v[88:91] offset:0
    s_waitcnt vmcnt(11)
    ds_write_b128 v3, v[92:95] offset:0
    s_waitcnt vmcnt(10)
    ds_write_b128 v4, v[96:99] offset:0
    s_waitcnt vmcnt(9)
    ds_write_b128 v2, v[100:103] offset:3328
    s_waitcnt vmcnt(8)
    ds_write_b128 v3, v[104:107] offset:3328
    s_waitcnt vmcnt(7)
    ds_write_b128 v4, v[108:111] offset:3328
    ds_read_b64_tr_b16 v[210:211], v6 offset:0
    ds_read_b64_tr_b16 v[214:215], v6 offset:32
    ds_read_b64_tr_b16 v[218:219], v6 offset:64
    ds_read_b64_tr_b16 v[222:223], v6 offset:96
    ds_read_b64_tr_b16 v[226:227], v6 offset:128
    ds_read_b64_tr_b16 v[230:231], v6 offset:160
    ds_read_b64_tr_b16 v[234:235], v6 offset:192
    ds_read_b64_tr_b16 v[238:239], v6 offset:224
    ds_read_b64_tr_b16 v[242:243], v6 offset:256
    ds_read_b64_tr_b16 v[246:247], v6 offset:288
    ds_read_b64_tr_b16 v[250:251], v6 offset:320
    ds_read_b64_tr_b16 v[254:255], v6 offset:352
    s_branch ATT_LAST
TAILF:
    s_lshl_b32 s90, s72, 3
    s_add_u32 s90, s90, s68
    s_mul_i32 s90, s90, 24
    s_add_u32 s90, s90, s69
    s_sub_u32 s90, s90, 8
    s_mul_i32 s90, s90, 10240
    buffer_load_dwordx4 a[240:243], v1, s[20:23], s90 offen offset:0
    buffer_load_dwordx4 a[240:243], v1, s[20:23], s90 offen offset:1024
    buffer_load_dwordx4 a[240:243], v1, s[20:23], s90 offen offset:2048
    buffer_load_dwordx4 a[240:243], v1, s[20:23], s90 offen offset:3072
    s_add_u32 s90, s90, 4096
    buffer_load_dwordx4 a[240:243], v1, s[20:23], s90 offen offset:0
    buffer_load_dwordx4 a[240:243], v1, s[20:23], s90 offen offset:1024
    buffer_load_dwordx4 a[240:243], v1, s[20:23], s90 offen offset:2048
    v_lshrrev_b32 v38, 3, v0
    v_mul_u32_u24 v38, 3072, v38
    v_and_b32 v39, 7, v0
    v_lshl_add_u32 v38, v39, 4, v38
    v_bfe_u32 v39, v0, 4, 1
    v_lshlrev_b32 v39, 5, v39
    v_xor_b32 v38, v38, v39
    v_xor_b32 v39, 64, v38
    s_waitcnt lgkmcnt(0)
    v_smfmac_f32_16x16x64_bf16 v[40:43], v[80:83], v[160:167], v14 abid:1
    v_smfmac_f32_16x16x64_bf16 v[44:47], v[80:83], v[168:175], v14 abid:1
    v_smfmac_f32_16x16x64_bf16 v[48:51], v[80:83], v[176:183], v14 abid:1
    v_smfmac_f32_16x16x64_bf16 v[52:55], v[80:83], v[184:191], v14 abid:1
    v_smfmac_f32_16x16x64_bf16 v[56:59], v[80:83], v[192:199], v14 abid:1
    v_smfmac_f32_16x16x64_bf16 v[60:63], v[80:83], v[200:207], v14 abid:1
    s_waitcnt vmcnt(14)
    ds_write_b128 v2, v[232:235] offset:0
    ds_write_b128 v3, v[236:239] offset:0
    ds_write_b128 v4, v[240:243] offset:0
    ds_write_b128 v2, v[244:247] offset:3328
    ds_write_b128 v3, v[248:251] offset:3328
    ds_write_b128 v4, v[252:255] offset:3328
    ds_read_b64_tr_b16 v[208:209], v6 offset:0
    ds_read_b64_tr_b16 v[212:213], v6 offset:32
    ds_read_b64_tr_b16 v[216:217], v6 offset:64
    ds_read_b64_tr_b16 v[220:221], v6 offset:96
    ds_read_b64_tr_b16 v[224:225], v6 offset:128
    ds_read_b64_tr_b16 v[228:229], v6 offset:160
    ds_read_b64_tr_b16 v[232:233], v6 offset:192
    ds_read_b64_tr_b16 v[236:237], v6 offset:224
    ds_read_b64_tr_b16 v[240:241], v6 offset:256
    ds_read_b64_tr_b16 v[244:245], v6 offset:288
    ds_read_b64_tr_b16 v[248:249], v6 offset:320
    ds_read_b64_tr_b16 v[252:253], v6 offset:352
    buffer_load_dwordx4 a[240:243], v1, s[20:23], s90 offen offset:3072
    s_add_u32 s90, s90, 4096
    buffer_load_dwordx4 a[240:243], v1, s[20:23], s90 offen offset:0
    buffer_load_dwordx4 a[240:243], v1, s[20:23], s90 offen offset:1024
    s_waitcnt vmcnt(15)
    ds_write_b128 v2, v[88:91] offset:0
    s_waitcnt vmcnt(14)
    ds_write_b128 v3, v[92:95] offset:0
    s_waitcnt vmcnt(13)
    ds_write_b128 v4, v[96:99] offset:0
    s_waitcnt vmcnt(12)
    ds_write_b128 v2, v[100:103] offset:3328
    s_waitcnt vmcnt(11)
    ds_write_b128 v3, v[104:107] offset:3328
    s_waitcnt vmcnt(10)
    ds_write_b128 v4, v[108:111] offset:3328
    ds_read_b64_tr_b16 v[210:211], v6 offset:0
    ds_read_b64_tr_b16 v[214:215], v6 offset:32
    ds_read_b64_tr_b16 v[218:219], v6 offset:64
    ds_read_b64_tr_b16 v[222:223], v6 offset:96
    ds_read_b64_tr_b16 v[226:227], v6 offset:128
    ds_read_b64_tr_b16 v[230:231], v6 offset:160
    ds_read_b64_tr_b16 v[234:235], v6 offset:192
    ds_read_b64_tr_b16 v[238:239], v6 offset:224
    ds_read_b64_tr_b16 v[242:243], v6 offset:256
    ds_read_b64_tr_b16 v[246:247], v6 offset:288
    ds_read_b64_tr_b16 v[250:251], v6 offset:320
    ds_read_b64_tr_b16 v[254:255], v6 offset:352
    s_mov_b32 m0, s67
    s_add_u32 s67, s67, 1024
    buffer_load_dwordx4 v38, s[36:39], s66 offen nt lds
    s_add_u32 s66, s66, 24576
    s_mov_b32 m0, s67
    s_add_u32 s67, s67, 1024
    buffer_load_dwordx4 v39, s[36:39], s66 offen nt lds
    s_add_u32 s66, s66, 24576
    s_mov_b32 m0, s67
    s_add_u32 s67, s67, 1024
    buffer_load_dwordx4 v38, s[36:39], s66 offen nt lds
    s_add_u32 s66, s66, 24576
    s_branch ATT_LAST
LOOP:
    s_cmp_lt_u32 s69, 20
    s_cselect_b32 s5, s72, 4
    s_add_u32 s96, s3, 819200
    s_add_u32 s97, s96, 4096
    s_and_b32 s77, s5, 3
    s_cbranch_scc1 LOOP2
    ds_read_b64_tr_b16 v[40:41], v16 offset:0
    ds_read_b64_tr_b16 v[42:43], v16 offset:1536
    ds_read_b64_tr_b16 v[44:45], v16 offset:12288
    ds_read_b64_tr_b16 v[46:47], v16 offset:13824
    ds_read_b64_tr_b16 v[48:49], v17 offset:24576
    ds_read_b64_tr_b16 v[50:51], v16 offset:32
    ds_read_b64_tr_b16 v[52:53], v16 offset:1568
    ds_read_b64_tr_b16 v[54:55], v16 offset:12320
    ds_read_b64_tr_b16 v[56:57], v16 offset:13856
    ds_read_b64_tr_b16 v[58:59], v17 offset:24608
    ds_read_b64_tr_b16 v[60:61], v16 offset:64
    ds_read_b64_tr_b16 v[62:63], v16 offset:1600
    ds_read_b64_tr_b16 v[64:65], v16 offset:12352
    ds_read_b64_tr_b16 v[66:67], v16 offset:13888
    ds_read_b64_tr_b16 v[68:69], v17 offset:24640
    v_and_b32 v25, 15, v0
    v_cmp_eq_u32 vcc, 12, v25
    v_mov_b32 v36, 0x3f803f80
    s_nop 0
    v_cndmask_b32 v70, 0, v36, vcc
    v_mov_b32 v71, v70
    v_mov_b32 v72, v70
    v_mov_b32 v73, v70
    v_mov_b32 v74, v70
    v_mov_b32 v75, v70
    v_mov_b32 v76, v70
    v_mov_b32 v77, v70
    v_mov_b32 v78, v70
    v_mov_b32 v79, v70
    s_mov_b32 s77, 4096
    v_mul_u32_u24 v96, 103, v0
    v_lshrrev_b32 v96, 10, v96
    v_lshl_add_u32 v96, v96, 4, v1
    v_add_u32 v96, s77, v96
    v_mul_u32_u24 v97, 176, v25
    v_add_u32 v97, s77, v97
    v_lshrrev_b32 v28, 4, v0
    v_lshl_add_u32 v98, v28, 3, v97
    v_lshl_add_u32 v97, v28, 4, v97
LOOP2:
    s_add_u32 s79, s3, 4096
    s_mul_i32 s77, s71, 160
    s_add_u32 s77, s77, s3
    s_sub_u32 s77, s77, 772608
    s_mov_b32 exec_lo, 0x3ff
    s_mov_b32 exec_hi, 0x0
    s_mov_b32 s76, 1
POLL3:
    buffer_load_dword v24, v1, s[16:19], s77 offen sc1
POLLW3:
    s_waitcnt vmcnt(0)
    v_cmp_eq_u32 vcc, -1, v24
    s_cbranch_vccnz AGAIN3
POLLX3:
    s_mov_b64 exec, s[50:51]
    buffer_load_dwordx4 v[80:83], v8, s[16:19], 0 offen sc1
    s_mov_b64 exec, -1
    buffer_load_dwordx4 v[88:91], v11, s[16:19], s96 offen sc1
    buffer_load_dwordx4 v[92:95], v11, s[16:19], s97 offen sc1
    s_mov_b64 exec, s[50:51]
    s_waitcnt vmcnt(2)
BW4:
    ds_write_b128 v9, v[80:83]
    v_cmp_eq_u32 vcc, -1, v80
    s_cbranch_vccnz BR4
BX4:
    s_mov_b64 exec, s[84:85]
    s_waitcnt lgkmcnt(0)
    s_barrier
    ds_read_b128 v[70:73], v97
    ds_read_b128 v[74:77], v97 offset:64
    ds_read_b64 v[78:79], v98 offset:128
    s_mov_b64 exec, -1
    s_cmp_lg_u32 s5, 1
    s_cbranch_scc1 NOOWL
    buffer_load_dword a244, v20, s[16:19], 0 offen sc1
    buffer_load_dword a245, v21, s[16:19], 0 offen sc1
NOOWL:
    s_waitcnt lgkmcnt(2)
    v_mfma_f32_16x16x32_bf16 v[24:27], v[70:73], v[40:43], 0
    v_mfma_f32_16x16x32_bf16 v[32:35], v[70:73], v[60:63], 0
    s_waitcnt lgkmcnt(0)
    v_mfma_f32_16x16x32_bf16 v[24:27], v[74:77], v[44:47], v[24:27]
    v_mfma_f32_16x16x32_bf16 v[32:35], v[74:77], v[64:67], v[32:35]
    v_mfma_f32_16x16x16_bf16 v[24:27], v[78:79], v[48:49], v[24:27]
    v_mfma_f32_16x16x16_bf16 v[32:35], v[78:79], v[68:69], v[32:35]
    v_mfma_f32_16x16x32_bf16 v[28:31], v[70:73], v[50:53], 0
    v_mfma_f32_16x16x32_bf16 v[36:39], v[70:73], v[70:73], 0
    v_mfma_f32_16x16x32_bf16 v[28:31], v[74:77], v[54:57], v[28:31]
    v_mfma_f32_16x16x32_bf16 v[36:39], v[74:77], v[74:77], v[36:39]
    v_mfma_f32_16x16x16_bf16 v[28:31], v[78:79], v[58:59], v[28:31]
    v_mfma_f32_16x16x16_bf16 v[36:39], v[78:79], v[78:79], v[36:39]
    s_nop 0
    v_add_f32 v24, v24, v25
    v_add_f32 v26, v26, v27
    v_add_f32 v24, v24, v26
    v_add_f32 v32, v32, v33
    v_add_f32 v34, v34, v35
    v_add_f32 v32, v32, v34
    s_nop 1
    v_permlane32_swap_b32 v24, v32
    v_add_f32 v28, v28, v29
    v_add_f32 v30, v30, v31
    v_add_f32 v36, v36, v37
    v_add_f32 v38, v38, v39
    v_add_f32 v24, v24, v32
    v_add_f32 v28, v28, v30
    v_add_f32 v36, v36, v38
    s_nop 1
    v_permlane32_swap_b32 v28, v36
    v_add_f32 v28, v28, v36
    s_nop 1
    v_permlane16_swap_b32 v24, v28
    v_add_f32 v24, v24, v28
    buffer_store_dword v24, v10, s[8:11], s3 offen
    s_cmp_eq_u32 s10, 0
    s_cbranch_scc1 SLOW5
BACK5:
    v_mov_b32 v40, 0
    v_mov_b32 v41, 0
    v_mov_b32 v44, 0
    v_mov_b32 v45, 0
    v_mov_b32 v48, 0
    v_mov_b32 v49, 0
    v_mov_b32 v52, 0
    v_mov_b32 v53, 0
    v_mov_b32 v56, 0
    v_mov_b32 v57, 0
    v_mov_b32 v60, 0
    v_mov_b32 v61, 0
    v_mov_b32 v64, 0
    v_mov_b32 v65, 0
    v_mov_b32 v68, 0
    v_mov_b32 v69, 0
    v_mov_b32 v72, 0
    v_mov_b32 v73, 0
    v_mov_b32 v74, 0
    v_mov_b32 v75, 0
    v_mov_b32 v76, 0
    v_mov_b32 v77, 0
    v_mov_b32 v78, 0
    v_mov_b32 v79, 0
    v_mov_b32 v80, 0
    v_mov_b32 v81, 0
    v_mov_b32 v82, 0
    v_mov_b32 v83, 0
    v_mov_b32 v84, 0
    v_mov_b32 v85, 0
    v_mov_b32 v86, 0
    v_mov_b32 v87, 0
    s_waitcnt vmcnt(1)
    v_add_f32 v88, v88, v92
    v_add_f32 v89, v89, v93
    v_add_f32 v90, v90, v94
    v_add_f32 v91, v91, v95
    s_nop 0
    v_permlane32_swap_b32 v88, v90
    v_permlane32_swap_b32 v89, v91
    v_add_f32 v88, v88, v90
    v_add_f32 v89, v89, v91
    s_nop 1
    v_permlane16_swap_b32 v88, v89
    v_add_f32 v88, v88, v89
    v_mul_f32 v7, 0x3acccccd, v88
    s_mov_b32 s76, 1
POLL6:
    buffer_load_dwordx4 v[24:27], v11, s[16:19], s3 offen sc1
    buffer_load_dwordx4 v[28:31], v11, s[16:19], s79 offen sc1
    s_waitcnt vmcnt(0)
    v_add_f32 v24, v24, v28
    v_add_f32 v25, v25, v29
    v_add_f32 v26, v26, v30
    v_add_f32 v27, v27, v31
    s_nop 0
    v_permlane32_swap_b32 v24, v26
    v_permlane32_swap_b32 v25, v27
    v_add_f32 v24, v24, v26
    v_add_f32 v25, v25, v27
    s_nop 1
    v_permlane16_swap_b32 v24, v25
    v_add_f32 v24, v24, v25
    v_cmp_u_f32 vcc, v24, v24
    s_cbranch_vccnz AGAIN6
POLLX6:
    v_readlane_b32 s77, v24, 15
    s_mov_b32 vcc_lo, 0x70007000
    s_mov_b32 vcc_hi, 0x70007000
    v_fma_f32 v25, -s77, v7, v24
    v_cvt_pk_bf16_f32 v25, v25, v25
    ds_write_b16 v12, v25
    v_cndmask_b32 v26, 0, v24, vcc
    s_nop 1
    v_add_f32_dpp v26, v26, v26 quad_perm:[1,0,3,2] row_mask:0xf bank_mask:0xf
    s_nop 1
    v_add_f32_dpp v26, v26, v26 quad_perm:[2,3,0,1] row_mask:0xf bank_mask:0xf
    v_mov_b32 v27, v26
    s_nop 1
    v_permlane32_swap_b32 v26, v27
    v_add_f32 v26, v26, v27
    s_waitcnt lgkmcnt(0)
    s_barrier
    ds_read_b128 v[28:31], v13 offset:0
    ds_read_b128 v[32:35], v13 offset:128
    ds_read_b128 v[36:39], v13 offset:256
    v_mov_b32 v27, v26
    v_mov_b32 v25, s77
    v_subrev_f32 v25, 0x44200000, v25
    v_permlane16_swap_b32 v26, v27
    v_add_f32 v26, v26, v27
    v_mul_f32 v24, 0x3acccccd, v25
    v_readlane_b32 s77, v26, 15
    v_mul_f32 v24, v24, v24
    s_mov_b32 s78, 0x3acccccd
    v_sub_f32 v26, s77, v25
    v_fma_f32 v26, v26, s78, -v24
    v_max_f32 v26, 0, v26
    v_add_f32 v26, 0x3727c5ac, v26
    v_rsq_f32 v26, v26
    s_nop 0
    v_mul_f32 v18, 0x3dd53b94, v26
    s_waitcnt lgkmcnt(2)
    v_smfmac_f32_16x16x64_bf16 v[40:43], v[28:31], a[0:7], v14
    v_smfmac_f32_16x16x64_bf16 v[44:47], v[28:31], a[24:31], v14
    v_smfmac_f32_16x16x64_bf16 v[48:51], v[28:31], a[48:55], v14
    v_smfmac_f32_16x16x64_bf16 v[52:55], v[28:31], a[72:79], v14
    v_smfmac_f32_16x16x64_bf16 v[56:59], v[28:31], a[96:103], v14
    v_smfmac_f32_16x16x64_bf16 v[60:63], v[28:31], a[120:127], v14
    v_smfmac_f32_16x16x64_bf16 v[64:67], v[28:31], a[144:151], v14
    v_smfmac_f32_16x16x64_bf16 v[68:71], v[28:31], a[168:175], v14
    s_waitcnt lgkmcnt(1)
    v_smfmac_f32_16x16x64_bf16 v[40:43], v[32:35], a[8:15], v14
    v_smfmac_f32_16x16x64_bf16 v[44:47], v[32:35], a[32:39], v14
    v_smfmac_f32_16x16x64_bf16 v[48:51], v[32:35], a[56:63], v14
    v_smfmac_f32_16x16x64_bf16 v[52:55], v[32:35], a[80:87], v14
    v_smfmac_f32_16x16x64_bf16 v[56:59], v[32:35], a[104:111], v14
    v_smfmac_f32_16x16x64_bf16 v[60:63], v[32:35], a[128:135], v14
    v_smfmac_f32_16x16x64_bf16 v[64:67], v[32:35], a[152:159], v14
    v_smfmac_f32_16x16x64_bf16 v[68:71], v[32:35], a[176:183], v14
    s_waitcnt lgkmcnt(0)
    v_smfmac_f32_16x16x64_bf16 v[40:43], v[36:39], a[16:23], v14
    v_smfmac_f32_16x16x64_bf16 v[44:47], v[36:39], a[40:47], v14
    v_smfmac_f32_16x16x64_bf16 v[48:51], v[36:39], a[64:71], v14
    v_smfmac_f32_16x16x64_bf16 v[52:55], v[36:39], a[88:95], v14
    v_smfmac_f32_16x16x64_bf16 v[56:59], v[36:39], a[112:119], v14
    v_smfmac_f32_16x16x64_bf16 v[60:63], v[36:39], a[136:143], v14
    v_smfmac_f32_16x16x64_bf16 v[64:67], v[36:39], a[160:167], v14
    v_smfmac_f32_16x16x64_bf16 v[68:71], v[36:39], a[184:191], v14
    s_nop 0
    v_add_f32 v24, v40, v41
    v_add_f32 v44, v44, v45
    v_add_f32 v48, v48, v49
    v_max3_f32 v26, v24, v44, v48
    v_add_f32 v52, v52, v53
    v_add_f32 v25, v56, v57
    v_max3_f32 v26, v26, v52, v25
    v_add_f32 v60, v60, v61
    v_add_f32 v64, v64, v65
    v_max3_f32 v26, v26, v60, v64
    v_add_f32 v68, v68, v69
    v_max_f32 v26, v26, v68
    v_mov_b32_dpp v24, v44 quad_perm:[0,1,2,3] row_mask:0x2 bank_mask:0xf
    v_mov_b32_dpp v25, v60 quad_perm:[0,1,2,3] row_mask:0x2 bank_mask:0xf
    v_max_f32_dpp v26, v26, v26 row_ror:8 row_mask:0xf bank_mask:0xf
    v_mov_b32_dpp v24, v48 quad_perm:[0,1,2,3] row_mask:0x4 bank_mask:0xf
    v_mov_b32_dpp v25, v64 quad_perm:[0,1,2,3] row_mask:0x4 bank_mask:0xf
    v_max_f32_dpp v26, v26, v26 row_ror:4 row_mask:0xf bank_mask:0xf
    v_mov_b32_dpp v24, v52 quad_perm:[0,1,2,3] row_mask:0x8 bank_mask:0xf
    v_mov_b32_dpp v25, v68 quad_perm:[0,1,2,3] row_mask:0x8 bank_mask:0xf
    v_max_f32_dpp v26, v26, v26 row_ror:2 row_mask:0xf bank_mask:0xf
    v_accvgpr_read_b32 v27, a252
    s_nop 0
    v_max_f32_dpp v26, v26, v26 row_ror:1 row_mask:0xf bank_mask:0xf
    v_mul_f32 v26, v26, v18
    v_fma_f32 v24, v24, v18, -v26
    v_fma_f32 v25, v25, v18, -v26
    v_exp_f32 v24, v24
    v_exp_f32 v25, v25
    s_nop 0
    v_cvt_pk_bf16_f32 v28, v24, v25
    ds_write_b16 v19, v28
    ds_write_b16_d16_hi v19, v28 offset:128
    s_mov_b64 exec, s[88:89]
    ds_read_b128 v[72:75], v27 offset:0
    ds_read_b128 v[76:79], v27 offset:64
    ds_read_b128 v[80:83], v27 offset:128
    ds_read_b128 v[84:87], v27 offset:192
    s_mov_b64 exec, -1
    v_add_f32 v27, v24, v25
    v_mov_b32 v40, 0
    v_mov_b32 v44, 0
    v_add_f32_dpp v27, v27, v27 row_ror:8 row_mask:0xf bank_mask:0xf
    v_mov_b32 v48, 0
    v_mov_b32 v52, 0
    v_add_f32_dpp v27, v27, v27 row_ror:4 row_mask:0xf bank_mask:0xf
    v_mov_b32 v56, 0
    v_mov_b32 v60, 0
    v_add_f32_dpp v27, v27, v27 row_ror:2 row_mask:0xf bank_mask:0xf
    s_lshl_b32 s78, s72, 3
    s_add_u32 s78, s78, 125440
    v_add_f32_dpp v27, v27, v27 row_ror:1 row_mask:0xf bank_mask:0xf
    v_mov_b32 v28, v27
    s_nop 1
    v_permlane32_swap_b32 v27, v28
    v_add_f32 v27, v27, v28
    v_mov_b32 v28, v27
    s_nop 1
    v_permlane16_swap_b32 v27, v28
    v_add_f32 v27, v27, v28
    v_mov_b32 v28, s78
    ds_write_b64 v28, v[26:27]
    s_waitcnt lgkmcnt(4)
    v_smfmac_f32_16x16x64_bf16 v[40:43], v[72:75], a[192:199], v14 abid:1
    v_smfmac_f32_16x16x64_bf16 v[44:47], v[72:75], a[200:207], v14 abid:1
    v_smfmac_f32_16x16x64_bf16 v[48:51], v[72:75], a[208:215], v14 abid:1
    v_smfmac_f32_16x16x64_bf16 v[52:55], v[72:75], a[216:223], v14 abid:1
    v_smfmac_f32_16x16x64_bf16 v[56:59], v[72:75], a[224:231], v14 abid:1
    v_smfmac_f32_16x16x64_bf16 v[60:63], v[72:75], a[232:239], v14 abid:1
    s_waitcnt lgkmcnt(3)
    v_smfmac_f32_16x16x64_bf16 v[40:43], v[76:79], v[112:119], v14 abid:1
    v_smfmac_f32_16x16x64_bf16 v[44:47], v[76:79], v[120:127], v14 abid:1
    v_smfmac_f32_16x16x64_bf16 v[48:51], v[76:79], v[128:135], v14 abid:1
    v_smfmac_f32_16x16x64_bf16 v[52:55], v[76:79], v[136:143], v14 abid:1
    v_smfmac_f32_16x16x64_bf16 v[56:59], v[76:79], v[144:151], v14 abid:1
    v_smfmac_f32_16x16x64_bf16 v[60:63], v[76:79], v[152:159], v14 abid:1
    s_waitcnt lgkmcnt(2)
    v_smfmac_f32_16x16x64_bf16 v[40:43], v[80:83], v[160:167], v14 abid:1
    v_smfmac_f32_16x16x64_bf16 v[44:47], v[80:83], v[168:175], v14 abid:1
    v_smfmac_f32_16x16x64_bf16 v[48:51], v[80:83], v[176:183], v14 abid:1
    v_smfmac_f32_16x16x64_bf16 v[52:55], v[80:83], v[184:191], v14 abid:1
    v_smfmac_f32_16x16x64_bf16 v[56:59], v[80:83], v[192:199], v14 abid:1
    v_smfmac_f32_16x16x64_bf16 v[60:63], v[80:83], v[200:207], v14 abid:1
    s_waitcnt lgkmcnt(0)
ATT_LAST:
    s_waitcnt lgkmcnt(8)
    v_smfmac_f32_16x16x64_bf16 v[40:43], v[84:87], v[208:215], v14 abid:1
    v_smfmac_f32_16x16x64_bf16 v[44:47], v[84:87], v[216:223], v14 abid:1
    s_waitcnt lgkmcnt(4)
    v_smfmac_f32_16x16x64_bf16 v[48:51], v[84:87], v[224:231], v14 abid:1
    v_smfmac_f32_16x16x64_bf16 v[52:55], v[84:87], v[232:239], v14 abid:1
    s_waitcnt lgkmcnt(0)
    v_smfmac_f32_16x16x64_bf16 v[56:59], v[84:87], v[240:247], v14 abid:1
    v_smfmac_f32_16x16x64_bf16 v[60:63], v[84:87], v[248:255], v14 abid:1
    s_lshl_b32 s77, s72, 8
    s_add_u32 s77, s77, 119296
    v_lshl_add_u32 v24, v0, 2, s77
    v_permlane16_swap_b32 v40, v44
    v_add_f32 v40, v40, v44
    ds_write_b32 v15, v40 offset:0
    v_permlane16_swap_b32 v48, v52
    v_add_f32 v48, v48, v52
    ds_write_b32 v15, v48 offset:256
    v_permlane16_swap_b32 v56, v60
    v_add_f32 v56, v56, v60
    ds_write_b32 v15, v56 offset:512
    v_and_b32 v25, 3, v0
    v_lshlrev_b32 v25, 3, v25
    v_add_u32 v25, 125440, v25
    s_waitcnt lgkmcnt(0)
    s_barrier
    ds_read_b64 v[32:33], v25
    ds_read2st64_b32 v[40:41], v24 offset0:0 offset1:3
    ds_read2st64_b32 v[42:43], v24 offset0:6 offset1:9
    s_mul_i32 s77, s70, 3072
    s_lshl_b32 s78, s71, 4
    s_add_u32 s77, s77, s78
    s_lshl_b32 s78, s72, 10
    s_add_u32 s77, s77, s78
    s_add_u32 s77, s77, s3
    s_add_u32 s77, s77, 32768
    s_lshl_b32 s78, s69, 3
    s_add_u32 s78, s78, s3
    s_add_u32 s78, s78, 45056
    s_cmp_eq_u32 s72, 3
    s_waitcnt lgkmcnt(2)
    v_max_f32_dpp v34, v32, v32 quad_perm:[1,0,3,2] row_mask:0xf bank_mask:0xf
    s_nop 1
    v_max_f32_dpp v34, v34, v34 quad_perm:[2,3,0,1] row_mask:0xf bank_mask:0xf
    v_sub_f32 v32, v32, v34
    v_exp_f32 v32, v32
    s_cbranch_scc1 OML
    s_waitcnt lgkmcnt(0)
    v_mul_f32_dpp v28, v32, v40 quad_perm:[0,0,0,0] row_mask:0xf bank_mask:0xf
    v_mul_f32_dpp v29, v32, v41 quad_perm:[1,1,1,1] row_mask:0xf bank_mask:0xf
    v_mul_f32_dpp v30, v32, v42 quad_perm:[2,2,2,2] row_mask:0xf bank_mask:0xf
    v_fmac_f32_dpp v28, v32, v43 quad_perm:[3,3,3,3] row_mask:0xf bank_mask:0xf
    v_add_f32 v29, v29, v30
    v_add_f32 v28, v28, v29
    s_nop 1
    v_mov_b32_dpp v29, v28 row_shl:1 row_mask:0xf bank_mask:0xf
    v_cvt_pk_bf16_f32 v28, v28, v29
    s_nop 1
    v_mov_b32_dpp v29, v28 row_shl:2 row_mask:0xf bank_mask:0xf
    v_mov_b32_dpp v30, v28 row_shl:4 row_mask:0xf bank_mask:0xf
    v_mov_b32_dpp v31, v28 row_shl:6 row_mask:0xf bank_mask:0xf
    s_mov_b64 exec, s[82:83]
    buffer_store_dwordx4 v[28:31], v1, s[8:11], s77 offen
    s_cmp_eq_u32 s10, 0
    s_cbranch_scc1 SLOW7
BACK7:
    s_mov_b64 exec, -1
ODONE:
    s_cmp_ge_u32 s69, 20
    s_cbranch_scc1 ROLEF
    s_cmp_eq_u32 s74, 0
    s_cbranch_scc1 WLATE
    v_accvgpr_read_b32 v2, a246
    v_accvgpr_read_b32 v3, a247
    v_accvgpr_read_b32 v4, a248
    v_mov_b32 v88, 0
    v_mov_b32 v92, 0
    v_mov_b32 v96, 0
    v_mov_b32 v100, 0
    v_mov_b32 v104, 0
    v_mov_b32 v108, 0
    ds_read_b64_tr_b16 v[40:41], v2 offset:0
    ds_read_b64_tr_b16 v[42:43], v2 offset:256
    ds_read_b64_tr_b16 v[64:65], v2 offset:32
    ds_read_b64_tr_b16 v[66:67], v2 offset:288
    ds_read_b64_tr_b16 v[44:45], v2 offset:2048
    ds_read_b64_tr_b16 v[46:47], v2 offset:2304
    ds_read_b64_tr_b16 v[68:69], v2 offset:2080
    ds_read_b64_tr_b16 v[70:71], v2 offset:2336
    ds_read_b64_tr_b16 v[48:49], v2 offset:4096
    ds_read_b64_tr_b16 v[50:51], v2 offset:4352
    s_cmp_lg_u32 s72, 1
    s_cbranch_scc1 NOOWN0
    v_accvgpr_read_b32 v28, a244
    v_accvgpr_read_b32 v29, a245
    v_max_u32 v30, v28, v29
    v_cmp_eq_u32 vcc, -1, v30
    s_cbranch_vccnz RETRY8
OK8:
    v_lshlrev_b32 v30, 16, v28
    v_and_b32 v28, 0xffff0000, v28
    v_lshlrev_b32 v31, 16, v29
    v_and_b32 v29, 0xffff0000, v29
    v_add_f32 v30, v30, v31
    v_add_f32 v28, v28, v29
    v_mov_b32 v31, v30
    v_mov_b32 v29, v28
    s_nop 0
    v_permlane32_swap_b32 v30, v31
    v_permlane32_swap_b32 v28, v29
    v_add_f32 v30, v30, v31
    v_add_f32 v28, v28, v29
    v_mov_b32 v31, v30
    v_mov_b32 v29, v28
    s_nop 0
    v_permlane16_swap_b32 v30, v31
    v_permlane16_swap_b32 v28, v29
    v_add_f32 v30, v30, v31
    v_add_f32 v28, v28, v29
    v_add_f32 v22, v22, v30
    v_add_f32 v23, v23, v28
    v_cvt_pk_bf16_f32 v28, v22, v23
    s_lshl_b32 s77, s69, 6
    s_add_u32 s77, s77, s3
    s_add_u32 s77, s77, 47872
    v_lshlrev_b32 v32, 2, v0
    v_mov_b32_dpp v29, v28 quad_perm:[1,1,1,1] row_mask:0xf bank_mask:0xf
    v_mov_b32_dpp v30, v28 quad_perm:[2,2,2,2] row_mask:0xf bank_mask:0xf
    v_mov_b32_dpp v31, v28 quad_perm:[3,3,3,3] row_mask:0xf bank_mask:0xf
    s_mov_b32 exec_lo, 0x1111
    s_mov_b32 exec_hi, 0x0
    buffer_store_dwordx4 v[28:31], v32, s[8:11], s77 offen
    s_cmp_eq_u32 s10, 0
    s_cbranch_scc1 SLOW9
BACK9:
    s_mov_b64 exec, -1
NOOWN0:
    v_mov_b32 v25, 0
    v_mov_b32 v27, 0
    v_mov_b32 v37, 0
    v_mov_b32 v39, 0
    s_mov_b32 exec_lo, 0x00ff00ff
    s_mov_b32 exec_hi, 0x00ff00ff
    buffer_load_dwordx4 v[88:91], v3, s[16:19], s3 offen offset:0 sc1
    buffer_load_dwordx4 v[92:95], v3, s[16:19], s3 offen offset:512 sc1
    buffer_load_dwordx4 v[96:99], v3, s[16:19], s3 offen offset:1024 sc1
    buffer_load_dwordx4 v[100:103], v3, s[16:19], s3 offen offset:1536 sc1
    buffer_load_dwordx4 v[104:107], v3, s[16:19], s3 offen offset:2048 sc1
    buffer_load_dwordx4 v[108:111], v3, s[16:19], s3 offen offset:2560 sc1
    s_mov_b32 exec_lo, -1
    s_mov_b32 exec_hi, 0
    buffer_load_dwordx4 v[24:27], v4, s[16:19], s3 offen offset:0 sc1
    buffer_load_dwordx4 v[36:39], v4, s[16:19], s3 offen offset:16 sc1
    s_mov_b64 exec, -1
    ds_read_b64_tr_b16 v[72:73], v2 offset:4128
    ds_read_b64_tr_b16 v[74:75], v2 offset:4384
    ds_read_b64_tr_b16 v[52:53], v2 offset:6144
    ds_read_b64_tr_b16 v[54:55], v2 offset:6400
    ds_read_b64_tr_b16 v[76:77], v2 offset:6176
    ds_read_b64_tr_b16 v[78:79], v2 offset:6432
    ds_read_b64_tr_b16 v[56:57], v2 offset:8192
    ds_read_b64_tr_b16 v[58:59], v2 offset:8448
    ds_read_b64_tr_b16 v[80:81], v2 offset:8224
    ds_read_b64_tr_b16 v[82:83], v2 offset:8480
    ds_read_b64_tr_b16 v[60:61], v2 offset:10240
    ds_read_b64_tr_b16 v[62:63], v2 offset:10496
    ds_read_b64_tr_b16 v[84:85], v2 offset:10272
    ds_read_b64_tr_b16 v[86:87], v2 offset:10528
    v_accvgpr_read_b32 v5, a249
    v_and_b32 v18, 3, v0
    v_lshrrev_b32 v6, 5, v0
    v_lshl_add_u32 v18, v6, 2, v18
    v_mul_u32_u24 v18, 10240, v18
    v_bfe_u32 v6, v0, 3, 2
    v_lshl_add_u32 v18, v6, 4, v18
    v_and_b32 v6, 0xffffff7f, v5
WCHK:
    s_waitcnt vmcnt(0)
    v_max3_u32 v28, v88, v92, v96
    v_max3_u32 v28, v28, v100, v104
    v_max3_u32 v28, v28, v108, v25
    v_max3_u32 v28, v28, v27, v37
    v_max_u32 v28, v28, v39
    v_cmp_eq_u32 vcc, -1, v28
    s_cbranch_vccnz AGAIN10
POLLX10:
    s_waitcnt lgkmcnt(0)
    v_mfma_f32_16x16x32_bf16 v[28:31], v[88:91], v[40:43], 0
    v_mfma_f32_16x16x32_bf16 v[32:35], v[88:91], v[64:67], 0
    v_max3_f32 v88, v24, v26, v36
    v_max_f32 v88, v88, v38
    v_mfma_f32_16x16x32_bf16 v[28:31], v[92:95], v[44:47], v[28:31]
    v_mov_b32 v89, v88
    v_mfma_f32_16x16x32_bf16 v[32:35], v[92:95], v[68:71], v[32:35]
    s_nop 0
    v_permlane16_swap_b32 v88, v89
    v_max_f32 v88, v88, v89
    v_mfma_f32_16x16x32_bf16 v[28:31], v[96:99], v[48:51], v[28:31]
    v_sub_f32 v24, v24, v88
    v_sub_f32 v26, v26, v88
    v_mfma_f32_16x16x32_bf16 v[32:35], v[96:99], v[72:75], v[32:35]
    v_sub_f32 v36, v36, v88
    v_sub_f32 v38, v38, v88
    v_mfma_f32_16x16x32_bf16 v[28:31], v[100:103], v[52:55], v[28:31]
    v_exp_f32 v24, v24
    v_mfma_f32_16x16x32_bf16 v[32:35], v[100:103], v[76:79], v[32:35]
    v_exp_f32 v26, v26
    v_mfma_f32_16x16x32_bf16 v[28:31], v[104:107], v[56:59], v[28:31]
    v_exp_f32 v36, v36
    v_mfma_f32_16x16x32_bf16 v[32:35], v[104:107], v[80:83], v[32:35]
    v_exp_f32 v38, v38
    v_mfma_f32_16x16x32_bf16 v[28:31], v[108:111], v[60:63], v[28:31]
    v_mul_f32 v90, v24, v25
    v_fmac_f32 v90, v26, v27
    v_mfma_f32_16x16x32_bf16 v[32:35], v[108:111], v[84:87], v[32:35]
    v_fmac_f32 v90, v36, v37
    v_fmac_f32 v90, v38, v39
    v_mov_b32 v89, v90
    s_cmp_lg_u32 s72, 0
    s_nop 0
    v_permlane16_swap_b32 v90, v89
    v_add_f32 v90, v90, v89
    v_rcp_f32 v90, v90
    v_mul_f32 v28, v24, v28
    v_mul_f32 v32, v24, v32
    v_fmac_f32 v28, v26, v29
    v_fmac_f32 v32, v26, v33
    v_fmac_f32 v28, v36, v30
    v_fmac_f32 v32, v36, v34
    v_fmac_f32 v28, v38, v31
    v_fmac_f32 v32, v38, v35
    s_nop 1
    v_permlane16_swap_b32 v28, v32
    v_add_f32 v28, v28, v32
    v_mul_f32 v28, v28, v90
    ds_write_b32 v5, v28
    s_waitcnt lgkmcnt(0)
    s_barrier
    s_cbranch_scc1 WNOT0
    ds_read2st64_b32 v[28:29], v6 offset0:0 offset1:1
    ds_read2st64_b32 v[30:31], v6 offset0:2 offset1:3
    s_waitcnt lgkmcnt(1)
    v_add_f32 v28, v28, v29
    s_waitcnt lgkmcnt(0)
    v_add_f32 v30, v30, v31
    v_add_f32 v28, v28, v30
    s_nop 1
    v_mov_b32_dpp v29, v28 row_shl:1 row_mask:0xf bank_mask:0xf
    v_cvt_pk_bf16_f32 v32, v28, v29
    s_nop 1
    v_mov_b32_dpp v28, v32 quad_perm:[0,0,0,0] row_mask:0xf bank_mask:0xf
    v_mov_b32_dpp v29, v32 quad_perm:[2,2,2,2] row_mask:0xf bank_mask:0xf
    s_nop 0
    v_mov_b32_dpp v30, v28 row_shl:4 row_mask:0xf bank_mask:0xf
    v_mov_b32_dpp v31, v29 row_shl:4 row_mask:0xf bank_mask:0xf
    s_mov_b64 exec, s[46:47]
    buffer_store_dwordx4 v[28:31], v18, s[16:19], s80 offen sc1
    s_mov_b64 exec, s[92:93]
    buffer_store_dwordx4 v[28:31], v18, s[8:11], s81 offen
    s_cmp_eq_u32 s10, 0
    s_cbranch_scc1 SLOW11
BACK11:
    s_mov_b64 exec, -1
    v_add_u32 v111, 49152, v2
    s_cmp_lg_u32 s74, 0
    s_cbranch_scc1 W2OK
    v_lshrrev_b32 v38, 2, v0
    v_mul_u32_u24 v38, 1280, v38
    v_and_b32 v39, 3, v0
    v_lshl_add_u32 v39, v39, 4, v38
    s_mul_i32 s77, s68, 245760
    s_lshl_b32 s78, s69, 6
    s_add_u32 s77, s77, s78
    s_mov_b32 m0, 106496
    s_nop 0
    buffer_load_dwordx4 v39, s[32:35], s77 offen lds
    s_add_u32 s77, s77, 20480
    s_mov_b32 m0, 107520
    s_nop 0
    buffer_load_dwordx4 v39, s[32:35], s77 offen lds
    s_add_u32 s77, s77, 20480
    s_mov_b32 m0, 108544
    s_nop 0
    buffer_load_dwordx4 v39, s[32:35], s77 offen lds
    s_add_u32 s77, s77, 20480
    s_mov_b32 m0, 109568
    s_nop 0
    buffer_load_dwordx4 v39, s[32:35], s77 offen lds
    s_add_u32 s77, s77, 20480
    s_mov_b32 m0, 110592
    s_nop 0
    buffer_load_dwordx4 v39, s[32:35], s77 offen lds
    s_add_u32 s77, s77, 20480
    s_mov_b32 m0, 111616
    s_nop 0
    buffer_load_dwordx4 v39, s[32:35], s77 offen lds
    s_add_u32 s77, s77, 20480
    s_mov_b32 m0, 112640
    s_nop 0
    buffer_load_dwordx4 v39, s[32:35], s77 offen lds
    s_add_u32 s77, s77, 20480
    s_mov_b32 m0, 113664
    s_nop 0
    buffer_load_dwordx4 v39, s[32:35], s77 offen lds
    s_add_u32 s77, s77, 20480
    s_mov_b32 m0, 114688
    s_nop 0
    buffer_load_dwordx4 v39, s[32:35], s77 offen lds
    s_add_u32 s77, s77, 20480
    s_mov_b32 m0, 115712
    s_nop 0
    buffer_load_dwordx4 v39, s[32:35], s77 offen lds
    s_add_u32 s77, s77, 20480
    s_mov_b32 m0, 116736
    s_nop 0
    buffer_load_dwordx4 v39, s[32:35], s77 offen lds
    s_add_u32 s77, s77, 20480
    s_mov_b32 m0, 117760
    s_nop 0
    buffer_load_dwordx4 v39, s[32:35], s77 offen lds
    s_add_u32 s77, s77, 20480
    s_branch W2X
W2OK:
    ds_read_b64_tr_b16 v[40:41], v111 offset:0
    ds_read_b64_tr_b16 v[42:43], v111 offset:256
    ds_read_b64_tr_b16 v[64:65], v111 offset:32
    ds_read_b64_tr_b16 v[66:67], v111 offset:288
    ds_read_b64_tr_b16 v[44:45], v111 offset:2048
    ds_read_b64_tr_b16 v[46:47], v111 offset:2304
    ds_read_b64_tr_b16 v[68:69], v111 offset:2080
    ds_read_b64_tr_b16 v[70:71], v111 offset:2336
    ds_read_b64_tr_b16 v[48:49], v111 offset:4096
    ds_read_b64_tr_b16 v[50:51], v111 offset:4352
    ds_read_b64_tr_b16 v[72:73], v111 offset:4128
    ds_read_b64_tr_b16 v[74:75], v111 offset:4384
    ds_read_b64_tr_b16 v[52:53], v111 offset:6144
    ds_read_b64_tr_b16 v[54:55], v111 offset:6400
    ds_read_b64_tr_b16 v[76:77], v111 offset:6176
    ds_read_b64_tr_b16 v[78:79], v111 offset:6432
    ds_read_b64_tr_b16 v[56:57], v111 offset:8192
    ds_read_b64_tr_b16 v[58:59], v111 offset:8448
    ds_read_b64_tr_b16 v[80:81], v111 offset:8224
    ds_read_b64_tr_b16 v[82:83], v111 offset:8480
    ds_read_b64_tr_b16 v[60:61], v111 offset:10240
    ds_read_b64_tr_b16 v[62:63], v111 offset:10496
    ds_read_b64_tr_b16 v[84:85], v111 offset:10272
    ds_read_b64_tr_b16 v[86:87], v111 offset:10528
W2X:
    v_mov_b32 v100, 0
    v_mov_b32 v101, 0
    v_mov_b32 v104, 0
    v_mov_b32 v105, 0
    s_add_u32 s96, s80, 81920
    s_add_u32 s97, s81, 1280
STB:
    s_mul_i32 s77, s72, 48
    v_min_u32 v6, 47, v0
    v_add_u32 v6, s77, v6
    v_lshlrev_b32 v4, 4, v6
    v_add_u32 v5, 3072, v4
    v_add_u32 v108, 6400, v4
    v_cmp_le_u32 vcc, 48, v0
    v_mov_b32 v24, 6144
    v_mov_b32 v25, 6160
    v_cndmask_b32 v4, v4, v24, vcc
    v_cndmask_b32 v5, v5, v25, vcc
    v_lshrrev_b32 v24, 4, v6
    v_lshlrev_b32 v24, 5, v24
    v_bfe_u32 v25, v6, 1, 1
    v_lshl_add_u32 v24, v25, 4, v24
    v_bfe_u32 v25, v6, 2, 2
    v_lshl_add_u32 v24, v25, 2, v24
    v_and_b32 v25, 1, v6
    v_lshl_add_u32 v24, v25, 1, v24
    v_add_u32 v24, 118784, v24
    v_mov_b32 v25, 119168
    v_cndmask_b32 v6, v24, v25, vcc
    v_mov_b32 v109, 0x3727c5ac
    v_mov_b32 v110, 0x3acccccd
    s_add_u32 s79, s3, 50432
    v_accvgpr_read_b32 v2, a250
    v_accvgpr_read_b32 v3, a251
    s_add_u32 s6, s74, s72
    s_mov_b32 s76, 1
    s_cmp_eq_u32 s74, 0
    s_cbranch_scc1 GPF
GPO:
    s_cmp_eq_u32 s72, 1
    s_cbranch_scc1 WOWN
GP1:
    buffer_load_dwordx4 v[24:27], v4, s[16:19], s79 offen sc1
    buffer_load_dwordx4 v[28:31], v5, s[16:19], s79 offen sc1
    s_waitcnt vmcnt(0)
    v_add_f32 v24, v24, v25
    v_add_f32 v28, v28, v29
    v_add_f32 v26, v26, v27
    v_add_f32 v30, v30, v31
    v_add_f32 v28, v28, v30
    v_add_f32 v24, v24, v26
    v_cmp_u_f32 vcc, v24, v28
    s_cbranch_vccnz GA1
GPX:
    v_readlane_b32 s77, v28, 48
    v_readlane_b32 s78, v24, 48
    s_cmp_lg_u32 s6, 1
    s_cbranch_scc0 OWL
OWB:
    v_mul_f32 v25, s77, v110
    v_fma_f32 v26, s78, v110, v109
    v_fma_f32 v26, -v25, v25, v26
    v_add_f32 v25, 1.0, v25
    v_max_f32 v26, v26, v109
    v_fma_f32 v24, -v25, v2, v24
    v_rsq_f32 v27, v26
    v_mul_f32 v29, 0xbfb8aa3b, v24
    v_mul_f32 v29, v29, v27
    v_exp_f32 v29, v29
    v_fma_f32 v28, -v25, v3, v28
    v_fma_f32 v29, v29, v26, v26
    v_rcp_f32 v29, v29
    v_mul_f32 v28, v28, v24
    v_mul_f32 v28, v28, v29
    v_cvt_pk_bf16_f32 v28, v28, v28
    ds_write_b16 v6, v28
    v_accvgpr_write_b32 a250, v2
    v_accvgpr_write_b32 a251, v3
    s_cmp_lg_u32 s72, 0
    s_waitcnt lgkmcnt(0)
    s_barrier
    s_cbranch_scc1 STBX
    ds_read_b128 v[88:91], v13 offset:0
    ds_read_b128 v[92:95], v13 offset:128
    ds_read_b128 v[96:99], v13 offset:256
    s_waitcnt lgkmcnt(2)
    v_smfmac_f32_16x16x64_bf16 v[100:103], v[88:91], v[40:47], v14
    v_smfmac_f32_16x16x64_bf16 v[104:107], v[88:91], v[64:71], v14
    s_waitcnt lgkmcnt(1)
    v_smfmac_f32_16x16x64_bf16 v[100:103], v[92:95], v[48:55], v14
    v_smfmac_f32_16x16x64_bf16 v[104:107], v[92:95], v[72:79], v14
    s_waitcnt lgkmcnt(0)
    v_smfmac_f32_16x16x64_bf16 v[100:103], v[96:99], v[56:63], v14
    v_smfmac_f32_16x16x64_bf16 v[104:107], v[96:99], v[80:87], v14
    s_nop 6
    v_add_f32 v28, v100, v101
    s_nop 1
    v_add_f32_dpp v28, v104, v105 quad_perm:[0,1,2,3] row_mask:0xa bank_mask:0xf
    s_nop 1
    v_mov_b32_dpp v29, v28 row_shl:1 row_mask:0xf bank_mask:0xf
    v_cvt_pk_bf16_f32 v32, v28, v29
    s_nop 1
    v_mov_b32_dpp v28, v32 quad_perm:[0,0,0,0] row_mask:0xf bank_mask:0xf
    v_mov_b32_dpp v29, v32 quad_perm:[2,2,2,2] row_mask:0xf bank_mask:0xf
    s_nop 0
    v_mov_b32_dpp v30, v28 row_shl:4 row_mask:0xf bank_mask:0xf
    v_mov_b32_dpp v31, v29 row_shl:4 row_mask:0xf bank_mask:0xf
    s_mov_b64 exec, s[48:49]
    buffer_store_dwordx4 v[28:31], v18, s[16:19], s96 offen sc1
    s_mov_b64 exec, s[92:93]
    buffer_store_dwordx4 v[28:31], v18, s[8:11], s97 offen
    s_cmp_eq_u32 s10, 0
    s_cbranch_scc1 SLOW12
BACK12:
    s_mov_b64 exec, -1
    s_branch NEXT
AGAIN3:
    s_add_u32 s76, s76, 1
    s_cmp_lt_u32 s76, 32768
    s_cbranch_scc1 POLL3
    s_branch POLLX3
BR4:
    s_cmp_ge_u32 s76, 32768
    s_cbranch_scc1 BX4
    s_mov_b64 exec, vcc
    buffer_load_dwordx4 v[80:83], v8, s[16:19], 0 offen sc1
    s_add_u32 s76, s76, 1
    s_waitcnt vmcnt(0)
    s_branch BW4
AGAIN6:
    s_add_u32 s76, s76, 1
    s_cmp_lt_u32 s76, 32768
    s_cbranch_scc1 POLL6
    s_branch POLLX6
OML:
    v_mul_f32 v35, v32, v33
    s_nop 1
    v_add_f32_dpp v35, v35, v35 quad_perm:[1,0,3,2] row_mask:0xf bank_mask:0xf
    s_nop 1
    v_add_f32_dpp v35, v35, v35 quad_perm:[2,3,0,1] row_mask:0xf bank_mask:0xf
    s_mov_b64 exec, 1
    buffer_store_dwordx2 v[34:35], v1, s[8:11], s78 offen
    s_cmp_eq_u32 s10, 0
    s_cbranch_scc1 SLOW13
BACK13:
    s_mov_b64 exec, -1
    s_waitcnt lgkmcnt(0)
    s_branch ODONE
WLATE:
    v_lshrrev_b32 v38, 2, v0
    v_mul_u32_u24 v38, 1280, v38
    v_and_b32 v39, 3, v0
    v_lshl_add_u32 v39, v39, 4, v38
    s_mov_b32 m0, s67
    s_add_u32 s67, s67, 1024
    buffer_load_dwordx4 v39, s[24:27], s66 offen  lds
    s_add_u32 s66, s66, 20480
    s_mov_b32 m0, s67
    s_add_u32 s67, s67, 1024
    buffer_load_dwordx4 v39, s[24:27], s66 offen  lds
    s_add_u32 s66, s66, 20480
    s_mov_b32 m0, s67
    s_add_u32 s67, s67, 1024
    buffer_load_dwordx4 v39, s[24:27], s66 offen  lds
    s_add_u32 s66, s66, 20480
    s_mov_b32 m0, s67
    s_add_u32 s67, s67, 1024
    buffer_load_dwordx4 v39, s[24:27], s66 offen  lds
    s_add_u32 s66, s66, 20480
    s_mov_b32 m0, s67
    s_add_u32 s67, s67, 1024
    buffer_load_dwordx4 v39, s[24:27], s66 offen  lds
    s_add_u32 s66, s66, 20480
    s_mov_b32 m0, s67
    s_add_u32 s67, s67, 1024
    buffer_load_dwordx4 v39, s[24:27], s66 offen  lds
    s_add_u32 s66, s66, 20480
    s_add_u32 s77, s3, 1638400
    buffer_store_dword v7, v10, s[8:11], s77 offen
    s_cmp_eq_u32 s10, 0
    s_cbranch_scc1 SLOW14
BACK14:
    v_accvgpr_read_b32 v2, a246
    v_accvgpr_read_b32 v3, a247
    v_accvgpr_read_b32 v4, a248
    v_mov_b32 v88, 0
    v_mov_b32 v92, 0
    v_mov_b32 v96, 0
    v_mov_b32 v100, 0
    v_mov_b32 v104, 0
    v_mov_b32 v108, 0
    v_mov_b32 v25, 0
    v_mov_b32 v27, 0
    v_mov_b32 v37, 0
    v_mov_b32 v39, 0
    s_mov_b32 exec_lo, 0x00ff00ff
    s_mov_b32 exec_hi, 0x00ff00ff
    buffer_load_dwordx4 v[88:91], v3, s[16:19], s3 offen offset:0 sc1
    buffer_load_dwordx4 v[92:95], v3, s[16:19], s3 offen offset:512 sc1
    buffer_load_dwordx4 v[96:99], v3, s[16:19], s3 offen offset:1024 sc1
    buffer_load_dwordx4 v[100:103], v3, s[16:19], s3 offen offset:1536 sc1
    buffer_load_dwordx4 v[104:107], v3, s[16:19], s3 offen offset:2048 sc1
    buffer_load_dwordx4 v[108:111], v3, s[16:19], s3 offen offset:2560 sc1
    s_mov_b32 exec_lo, -1
    s_mov_b32 exec_hi, 0
    buffer_load_dwordx4 v[24:27], v4, s[16:19], s3 offen offset:0 sc1
    buffer_load_dwordx4 v[36:39], v4, s[16:19], s3 offen offset:16 sc1
    s_mov_b64 exec, -1
    s_waitcnt vmcnt(8)
    ds_read_b64_tr_b16 v[40:41], v2 offset:0
    ds_read_b64_tr_b16 v[42:43], v2 offset:256
    ds_read_b64_tr_b16 v[64:65], v2 offset:32
    ds_read_b64_tr_b16 v[66:67], v2 offset:288
    ds_read_b64_tr_b16 v[44:45], v2 offset:2048
    ds_read_b64_tr_b16 v[46:47], v2 offset:2304
    ds_read_b64_tr_b16 v[68:69], v2 offset:2080
    ds_read_b64_tr_b16 v[70:71], v2 offset:2336
    ds_read_b64_tr_b16 v[48:49], v2 offset:4096
    ds_read_b64_tr_b16 v[50:51], v2 offset:4352
    s_lshl_b32 s77, s68, 2
    s_add_u32 s77, s77, s72
    s_mul_i32 s77, s77, 61440
    s_lshl_b32 s78, s69, 6
    s_add_u32 s77, s77, s78
    v_min_u32 v35, 47, v0
    v_mul_u32_u24 v35, 1280, v35
    v_add_u32 v35, s77, v35
    ds_read_b64_tr_b16 v[72:73], v2 offset:4128
    ds_read_b64_tr_b16 v[74:75], v2 offset:4384
    ds_read_b64_tr_b16 v[52:53], v2 offset:6144
    ds_read_b64_tr_b16 v[54:55], v2 offset:6400
    ds_read_b64_tr_b16 v[76:77], v2 offset:6176
    ds_read_b64_tr_b16 v[78:79], v2 offset:6432
    ds_read_b64_tr_b16 v[56:57], v2 offset:8192
    ds_read_b64_tr_b16 v[58:59], v2 offset:8448
    ds_read_b64_tr_b16 v[80:81], v2 offset:8224
    ds_read_b64_tr_b16 v[82:83], v2 offset:8480
    ds_read_b64_tr_b16 v[60:61], v2 offset:10240
    ds_read_b64_tr_b16 v[62:63], v2 offset:10496
    ds_read_b64_tr_b16 v[84:85], v2 offset:10272
    ds_read_b64_tr_b16 v[86:87], v2 offset:10528
    v_accvgpr_read_b32 v5, a249
    v_and_b32 v18, 3, v0
    v_lshrrev_b32 v6, 5, v0
    v_lshl_add_u32 v18, v6, 2, v18
    v_mul_u32_u24 v18, 10240, v18
    v_bfe_u32 v6, v0, 3, 2
    v_lshl_add_u32 v18, v6, 4, v18
    v_and_b32 v6, 0xffffff7f, v5
    s_branch WCHK
AGAIN10:
    s_mov_b64 s[94:95], exec
    s_mov_b32 s76, 1
AG210:
    v_max3_u32 v28, v88, v92, v96
    v_max3_u32 v28, v28, v100, v104
    v_max_u32 v28, v28, v108
    v_cmp_eq_u32 vcc, -1, v28
    s_nop 0
    s_mov_b64 exec, vcc
    s_cbranch_execz AG310_0
    buffer_load_dwordx4 v[88:91], v3, s[16:19], s3 offen offset:0 sc1
    buffer_load_dwordx4 v[92:95], v3, s[16:19], s3 offen offset:512 sc1
    buffer_load_dwordx4 v[96:99], v3, s[16:19], s3 offen offset:1024 sc1
    buffer_load_dwordx4 v[100:103], v3, s[16:19], s3 offen offset:1536 sc1
    buffer_load_dwordx4 v[104:107], v3, s[16:19], s3 offen offset:2048 sc1
    buffer_load_dwordx4 v[108:111], v3, s[16:19], s3 offen offset:2560 sc1
AG310_0:
    s_mov_b64 exec, s[94:95]
    v_max3_u32 v28, v25, v27, v37
    v_max_u32 v28, v28, v39
    v_cmp_eq_u32 vcc, -1, v28
    s_nop 0
    s_mov_b64 exec, vcc
    s_cbranch_execz AG310_1
    buffer_load_dwordx4 v[24:27], v4, s[16:19], s3 offen offset:0 sc1
    buffer_load_dwordx4 v[36:39], v4, s[16:19], s3 offen offset:16 sc1
AG310_1:
    s_mov_b64 exec, s[94:95]
    s_add_u32 s76, s76, 1
    s_cmp_ge_u32 s76, 32768
    s_waitcnt vmcnt(0)
    v_max3_u32 v28, v88, v92, v96
    v_max3_u32 v28, v28, v100, v104
    v_max3_u32 v28, v28, v108, v25
    v_max3_u32 v28, v28, v27, v37
    v_max_u32 v28, v28, v39
    v_cmp_eq_u32 vcc, -1, v28
    s_cbranch_vccz POLLX10
    s_cbranch_scc0 AG210
    s_branch POLLX10
GA1:
    s_add_u32 s76, s76, 1
    s_cmp_lt_u32 s76, 32768
    s_cbranch_scc1 GP1
    s_branch GPX
GPF:
    s_cmp_lg_u32 s72, 0
    s_cbranch_scc1 GP0
    buffer_load_dwordx4 v[32:35], v108, s[16:19], s79 offen sc1
    buffer_load_dwordx4 v[36:39], v108, s[16:19], s79 offen offset:3072 sc1
    s_waitcnt vmcnt(2)
    ds_read_b64_tr_b16 v[40:41], v111 offset:0
    ds_read_b64_tr_b16 v[42:43], v111 offset:256
    ds_read_b64_tr_b16 v[64:65], v111 offset:32
    ds_read_b64_tr_b16 v[66:67], v111 offset:288
    ds_read_b64_tr_b16 v[44:45], v111 offset:2048
    ds_read_b64_tr_b16 v[46:47], v111 offset:2304
    ds_read_b64_tr_b16 v[68:69], v111 offset:2080
    ds_read_b64_tr_b16 v[70:71], v111 offset:2336
    ds_read_b64_tr_b16 v[48:49], v111 offset:4096
    ds_read_b64_tr_b16 v[50:51], v111 offset:4352
    ds_read_b64_tr_b16 v[72:73], v111 offset:4128
    ds_read_b64_tr_b16 v[74:75], v111 offset:4384
    ds_read_b64_tr_b16 v[52:53], v111 offset:6144
    ds_read_b64_tr_b16 v[54:55], v111 offset:6400
    ds_read_b64_tr_b16 v[76:77], v111 offset:6176
    ds_read_b64_tr_b16 v[78:79], v111 offset:6432
    ds_read_b64_tr_b16 v[56:57], v111 offset:8192
    ds_read_b64_tr_b16 v[58:59], v111 offset:8448
    ds_read_b64_tr_b16 v[80:81], v111 offset:8224
    ds_read_b64_tr_b16 v[82:83], v111 offset:8480
    ds_read_b64_tr_b16 v[60:61], v111 offset:10240
    ds_read_b64_tr_b16 v[62:63], v111 offset:10496
    ds_read_b64_tr_b16 v[84:85], v111 offset:10272
    ds_read_b64_tr_b16 v[86:87], v111 offset:10528
    s_branch GPW
GP0:
    buffer_load_dwordx4 v[32:35], v108, s[16:19], s79 offen sc1
    buffer_load_dwordx4 v[36:39], v108, s[16:19], s79 offen offset:3072 sc1
GPW:
    s_add_u32 s76, s76, 1
    s_cmp_ge_u32 s76, 32768
    s_waitcnt vmcnt(0)
    v_add_f32 v2, v32, v33
    v_add_f32 v3, v36, v37
    v_add_f32 v34, v34, v35
    v_add_f32 v38, v38, v39
    v_add_f32 v2, v2, v34
    v_add_f32 v3, v3, v38
    v_cmp_u_f32 vcc, v2, v3
    s_cbranch_scc1 GPO
    s_cbranch_vccnz GP0
    s_branch GPO
OWL:
    buffer_load_dword v34, v37, s[16:19], 0 offen sc1
    buffer_load_dword v35, v38, s[16:19], 0 offen sc1
    s_branch OWB
WNOT0:
    s_cmp_lg_u32 s74, 0
    s_cbranch_scc1 STB
    s_cmp_eq_u32 s72, 1
    s_cbranch_scc1 WPREP
    s_cmp_eq_u32 s72, 3
    s_cbranch_scc1 WLC
    v_mov_b32 v52, -1
    v_mov_b32 v53, -1
    v_mov_b32 v54, -1
    v_mov_b32 v55, -1
    s_add_u32 s77, s80, 819200
    s_add_u32 s7, s77, 81920
    s_sleep 8
    s_mov_b64 exec, s[44:45]
    buffer_store_dwordx4 v[52:55], v18, s[16:19], s77 offen sc1
    s_mov_b64 exec, s[92:93]
    buffer_store_dwordx4 v[52:55], v18, s[16:19], s7 offen sc1
    s_mov_b64 exec, -1
    s_branch WPREP
WLC:
    s_mul_i32 s77, s69, 1216
    s_add_u32 s78, s3, 851968
    v_add_u32 v100, s77, v1
    v_min_u32 v100, 24048, v100
    s_add_u32 s77, s77, 1024
    v_add_u32 v101, s77, v1
    v_min_u32 v101, 24048, v101
    s_add_u32 s77, s77, 1024
    v_mov_b32 v104, -1
    v_mov_b32 v105, -1
    v_mov_b32 v106, -1
    v_mov_b32 v107, -1
    ds_read_b64_tr_b16 v[40:41], v16 offset:0
    ds_read_b64_tr_b16 v[42:43], v16 offset:1536
    ds_read_b64_tr_b16 v[44:45], v16 offset:12288
    ds_read_b64_tr_b16 v[46:47], v16 offset:13824
    ds_read_b64_tr_b16 v[48:49], v17 offset:24576
    ds_read_b64_tr_b16 v[50:51], v16 offset:32
    ds_read_b64_tr_b16 v[52:53], v16 offset:1568
    ds_read_b64_tr_b16 v[54:55], v16 offset:12320
    ds_read_b64_tr_b16 v[56:57], v16 offset:13856
    ds_read_b64_tr_b16 v[58:59], v17 offset:24608
    ds_read_b64_tr_b16 v[60:61], v16 offset:64
    ds_read_b64_tr_b16 v[62:63], v16 offset:1600
    ds_read_b64_tr_b16 v[64:65], v16 offset:12352
    ds_read_b64_tr_b16 v[66:67], v16 offset:13888
    ds_read_b64_tr_b16 v[68:69], v17 offset:24640
    v_and_b32 v25, 15, v0
    v_cmp_eq_u32 vcc, 12, v25
    v_mov_b32 v36, 0x3f803f80
    s_nop 0
    v_cndmask_b32 v70, 0, v36, vcc
    v_mov_b32 v71, v70
    v_mov_b32 v72, v70
    v_mov_b32 v73, v70
    v_mov_b32 v74, v70
    v_mov_b32 v75, v70
    v_mov_b32 v76, v70
    v_mov_b32 v77, v70
    v_mov_b32 v78, v70
    v_mov_b32 v79, v70
    s_mov_b32 s77, 4096
    v_mul_u32_u24 v96, 103, v0
    v_lshrrev_b32 v96, 10, v96
    v_lshl_add_u32 v96, v96, 4, v1
    v_add_u32 v96, s77, v96
    v_mul_u32_u24 v97, 176, v25
    v_add_u32 v97, s77, v97
    v_lshrrev_b32 v28, 4, v0
    v_lshl_add_u32 v98, v28, 3, v97
    v_lshl_add_u32 v97, v28, 4, v97
    buffer_store_dwordx4 v[104:107], v100, s[8:11], s78 offen
    s_cmp_eq_u32 s10, 0
    s_cbranch_scc1 SLOW15
BACK15:
    buffer_store_dwordx4 v[104:107], v101, s[8:11], s78 offen
    s_cmp_eq_u32 s10, 0
    s_cbranch_scc1 SLOW16
BACK16:
    s_branch STB
WPREP:
    s_nop 1
    ds_read_b64_tr_b16 v[40:41], v16 offset:0
    ds_read_b64_tr_b16 v[42:43], v16 offset:1536
    ds_read_b64_tr_b16 v[44:45], v16 offset:12288
    ds_read_b64_tr_b16 v[46:47], v16 offset:13824
    ds_read_b64_tr_b16 v[48:49], v17 offset:24576
    ds_read_b64_tr_b16 v[50:51], v16 offset:32
    ds_read_b64_tr_b16 v[52:53], v16 offset:1568
    ds_read_b64_tr_b16 v[54:55], v16 offset:12320
    ds_read_b64_tr_b16 v[56:57], v16 offset:13856
    ds_read_b64_tr_b16 v[58:59], v17 offset:24608
    ds_read_b64_tr_b16 v[60:61], v16 offset:64
    ds_read_b64_tr_b16 v[62:63], v16 offset:1600
    ds_read_b64_tr_b16 v[64:65], v16 offset:12352
    ds_read_b64_tr_b16 v[66:67], v16 offset:13888
    ds_read_b64_tr_b16 v[68:69], v17 offset:24640
    v_and_b32 v25, 15, v0
    v_cmp_eq_u32 vcc, 12, v25
    v_mov_b32 v36, 0x3f803f80
    s_nop 0
    v_cndmask_b32 v70, 0, v36, vcc
    v_mov_b32 v71, v70
    v_mov_b32 v72, v70
    v_mov_b32 v73, v70
    v_mov_b32 v74, v70
    v_mov_b32 v75, v70
    v_mov_b32 v76, v70
    v_mov_b32 v77, v70
    v_mov_b32 v78, v70
    v_mov_b32 v79, v70
    s_mov_b32 s77, 4096
    v_mul_u32_u24 v96, 103, v0
    v_lshrrev_b32 v96, 10, v96
    v_lshl_add_u32 v96, v96, 4, v1
    v_add_u32 v96, s77, v96
    v_mul_u32_u24 v97, 176, v25
    v_add_u32 v97, s77, v97
    v_lshrrev_b32 v28, 4, v0
    v_lshl_add_u32 v98, v28, 3, v97
    v_lshl_add_u32 v97, v28, 4, v97
    s_branch STB
WOWN:
    v_and_b32 v25, 15, v0
    v_lshrrev_b32 v26, 4, v0
    s_mul_i32 s7, s68, 10240
    s_cmp_eq_u32 s74, 0
    s_cselect_b32 s7, 0, s7
    s_add_u32 s7, s7, 655360
    v_mul_u32_u24 v37, 1280, v26
    v_add_u32 v37, s7, v37
    s_mul_i32 s7, s68, 81920
    s_add_u32 s7, s7, 45312
    v_mov_b32 v38, s7
    v_cmp_eq_u32 vcc, s68, v26
    s_nop 1
    v_cndmask_b32 v37, v37, v38, vcc
    v_add_u32 v39, 4, v26
    s_mul_i32 s7, s68, 10240
    s_cmp_eq_u32 s74, 0
    s_cselect_b32 s7, 0, s7
    s_add_u32 s7, s7, 655360
    v_mul_u32_u24 v38, 1280, v39
    v_add_u32 v38, s7, v38
    s_mul_i32 s7, s68, 81920
    s_add_u32 s7, s7, 45312
    v_mov_b32 v28, s7
    v_cmp_eq_u32 vcc, s68, v39
    s_nop 1
    v_cndmask_b32 v38, v38, v28, vcc
    s_lshl_b32 s77, s69, 6
    s_add_u32 s77, s77, s74
    v_lshl_add_u32 v25, v25, 2, s77
    v_add_u32 v37, v25, v37
    v_add_u32 v38, v25, v38
    s_cmp_eq_u32 s74, 0
    s_cbranch_scc1 GP1
    s_sleep 13
    s_mov_b32 s76, 1
POLL17:
    buffer_load_dword v28, v37, s[16:19], 0 offen sc1
    buffer_load_dword v29, v38, s[16:19], 0 offen sc1
POLLW17:
    s_waitcnt vmcnt(0)
    v_max_u32 v30, v28, v29
    v_cmp_eq_u32 vcc, -1, v30
    s_cbranch_vccnz AGAIN17
POLLX17:
    v_lshlrev_b32 v30, 16, v28
    v_and_b32 v28, 0xffff0000, v28
    v_lshlrev_b32 v31, 16, v29
    v_and_b32 v29, 0xffff0000, v29
    v_add_f32 v30, v30, v31
    v_add_f32 v28, v28, v29
    v_mov_b32 v31, v30
    v_mov_b32 v29, v28
    s_nop 0
    v_permlane32_swap_b32 v30, v31
    v_permlane32_swap_b32 v28, v29
    v_add_f32 v30, v30, v31
    v_add_f32 v28, v28, v29
    v_mov_b32 v31, v30
    v_mov_b32 v29, v28
    s_nop 0
    v_permlane16_swap_b32 v30, v31
    v_permlane16_swap_b32 v28, v29
    v_add_f32 v30, v30, v31
    v_add_f32 v28, v28, v29
    v_add_f32 v22, v22, v30
    v_add_f32 v23, v23, v28
    v_cvt_pk_bf16_f32 v28, v22, v23
    s_branch GP1
STBX:
    s_cmp_lg_u32 s72, 1
    s_cbranch_scc1 NEXT
    s_cmp_lg_u32 s74, 0
    s_cbranch_scc1 FINAL
    s_waitcnt vmcnt(0)
    v_mov_b32 v28, v34
    v_mov_b32 v29, v35
    v_max_u32 v30, v28, v29
    v_cmp_eq_u32 vcc, -1, v30
    s_cbranch_vccnz RETRY18
OK18:
    v_lshlrev_b32 v30, 16, v28
    v_and_b32 v28, 0xffff0000, v28
    v_lshlrev_b32 v31, 16, v29
    v_and_b32 v29, 0xffff0000, v29
    v_add_f32 v30, v30, v31
    v_add_f32 v28, v28, v29
    v_mov_b32 v31, v30
    v_mov_b32 v29, v28
    s_nop 0
    v_permlane32_swap_b32 v30, v31
    v_permlane32_swap_b32 v28, v29
    v_add_f32 v30, v30, v31
    v_add_f32 v28, v28, v29
    v_mov_b32 v31, v30
    v_mov_b32 v29, v28
    s_nop 0
    v_permlane16_swap_b32 v30, v31
    v_permlane16_swap_b32 v28, v29
    v_add_f32 v30, v30, v31
    v_add_f32 v28, v28, v29
    v_add_f32 v22, v22, v30
    v_add_f32 v23, v23, v28
    v_cvt_pk_bf16_f32 v28, v22, v23
    s_lshl_b32 s77, s69, 6
    s_add_u32 s77, s77, s3
    s_add_u32 s77, s77, 49152
    v_lshlrev_b32 v32, 2, v0
    v_mov_b32_dpp v29, v28 quad_perm:[1,1,1,1] row_mask:0xf bank_mask:0xf
    v_mov_b32_dpp v30, v28 quad_perm:[2,2,2,2] row_mask:0xf bank_mask:0xf
    v_mov_b32_dpp v31, v28 quad_perm:[3,3,3,3] row_mask:0xf bank_mask:0xf
    s_mov_b32 exec_lo, 0x1111
    s_mov_b32 exec_hi, 0x0
    buffer_store_dwordx4 v[28:31], v32, s[8:11], s77 offen
    s_cmp_eq_u32 s10, 0
    s_cbranch_scc1 SLOW19
BACK19:
    s_mov_b64 exec, -1
    s_branch NEXT
FINAL:
    s_cmp_lg_u32 s68, 0
    s_cbranch_scc1 DONE
    s_lshl_b32 s77, s69, 6
    v_lshlrev_b32 v37, 2, v0
    s_add_u32 s79, s77, s3
    s_add_u32 s79, s79, 46592
    s_mov_b64 exec, 15
    s_mov_b32 s76, 1
POLL20:
    buffer_load_dword v28, v1, s[16:19], s79 offen sc1
POLLW20:
    s_waitcnt vmcnt(0)
    v_cmp_eq_u32 vcc, -1, v28
    s_cbranch_vccnz AGAIN20
POLLX20:
    s_mov_b64 exec, -1
    s_mov_b32 s76, 1
POLL21:
    buffer_load_dword v28, v20, s[16:19], s74 offen sc1
    buffer_load_dword v29, v21, s[16:19], s74 offen sc1
POLLW21:
    s_waitcnt vmcnt(0)
    v_max_u32 v30, v28, v29
    v_cmp_eq_u32 vcc, -1, v30
    s_cbranch_vccnz AGAIN21
POLLX21:
    v_lshlrev_b32 v30, 16, v28
    v_and_b32 v28, 0xffff0000, v28
    v_lshlrev_b32 v31, 16, v29
    v_and_b32 v29, 0xffff0000, v29
    v_add_f32 v30, v30, v31
    v_add_f32 v28, v28, v29
    v_mov_b32 v31, v30
    v_mov_b32 v29, v28
    s_nop 0
    v_permlane32_swap_b32 v30, v31
    v_permlane32_swap_b32 v28, v29
    v_add_f32 v30, v30, v31
    v_add_f32 v28, v28, v29
    v_mov_b32 v31, v30
    v_mov_b32 v29, v28
    s_nop 0
    v_permlane16_swap_b32 v30, v31
    v_permlane16_swap_b32 v28, v29
    v_add_f32 v30, v30, v31
    v_add_f32 v28, v28, v29
    v_add_f32 v22, v22, v30
    v_add_f32 v23, v23, v28
    v_cvt_pk_bf16_f32 v28, v22, v23
    s_mov_b32 exec_lo, 0xffff
    s_mov_b32 exec_hi, 0x0
    buffer_store_dword v28, v37, s[40:43], s77 offen
    s_mov_b64 exec, -1
    s_endpgm
AGAIN17:
    s_sleep 2
    s_add_u32 s76, s76, 1
    s_cmp_lt_u32 s76, 32768
    s_cbranch_scc1 POLL17
    s_branch POLLX17
AGAIN20:
    s_add_u32 s76, s76, 1
    s_cmp_lt_u32 s76, 32768
    s_cbranch_scc1 POLL20
    s_branch POLLX20
AGAIN21:
    s_add_u32 s76, s76, 1
    s_cmp_lt_u32 s76, 32768
    s_cbranch_scc1 POLL21
    s_branch POLLX21
ROLEF:
    v_and_b32 v25, 15, v0
    v_lshrrev_b32 v26, 4, v0
    v_bfe_u32 v27, v0, 2, 2
    v_and_b32 v36, 3, v0
    s_cmp_lg_u32 s74, 0
    s_cbranch_scc1 FW
    v_lshrrev_b32 v38, 3, v0
    v_mul_u32_u24 v38, 3072, v38
    v_and_b32 v39, 7, v0
    v_lshl_add_u32 v38, v39, 4, v38
    v_bfe_u32 v39, v0, 4, 1
    v_lshlrev_b32 v39, 5, v39
    v_xor_b32 v38, v38, v39
    v_xor_b32 v39, 64, v38
    s_mov_b32 m0, s67
    s_add_u32 s67, s67, 1024
    buffer_load_dwordx4 v39, s[36:39], s66 offen nt lds
    s_add_u32 s66, s66, 24576
    s_mov_b32 m0, s67
    s_add_u32 s67, s67, 1024
    buffer_load_dwordx4 v38, s[36:39], s66 offen nt lds
    s_add_u32 s66, s66, 24576
    s_mov_b32 m0, s67
    s_add_u32 s67, s67, 1024
    buffer_load_dwordx4 v39, s[36:39], s66 offen nt lds
    s_add_u32 s66, s66, 24576
    s_mov_b32 m0, s67
    s_add_u32 s67, s67, 1024
    buffer_load_dwordx4 v38, s[36:39], s66 offen nt lds
    s_add_u32 s66, s66, 24576
    s_mov_b32 m0, s67
    s_add_u32 s67, s67, 1024
    buffer_load_dwordx4 v39, s[36:39], s66 offen nt lds
    s_add_u32 s66, s66, 24576
    s_mov_b32 m0, s67
    s_add_u32 s67, s67, 1024
    buffer_load_dwordx4 v38, s[36:39], s66 offen nt lds
    s_add_u32 s66, s66, 24576
    s_mov_b32 m0, s67
    s_add_u32 s67, s67, 1024
    buffer_load_dwordx4 v39, s[36:39], s66 offen nt lds
    s_add_u32 s66, s66, 24576
    s_sub_u32 s96, s69, 20
    s_lshl_b32 s96, s96, 2
    s_add_u32 s96, s96, s72
    s_mul_i32 s96, s96, 688
    v_add_u32 v21, s96, v1
    v_min_u32 v21, 32752, v21
    s_add_u32 s97, s3, 819200
    s_add_u32 s77, s3, 1638400
    buffer_store_dword v7, v10, s[8:11], s77 offen
    s_cmp_eq_u32 s10, 0
    s_cbranch_scc1 SLOW22
BACK22:
FW:
    s_lshl_b32 s77, s72, 5
    v_lshl_add_u32 v80, v36, 3, s77
    v_lshrrev_b32 v37, 1, v27
    v_and_b32 v38, 1, v26
    v_lshl_add_u32 v37, v38, 1, v37
    v_lshlrev_b32 v37, 5, v37
    v_xor_b32 v80, v80, v37
    v_lshl_add_u32 v37, v26, 3, v27
    v_lshl_add_u32 v80, v37, 7, v80
    v_add_u32 v80, 57344, v80
    s_sub_u32 s79, s69, 20
    s_and_b32 s7, s79, 12
    s_add_u32 s7, s7, s72
    s_lshl_b32 s78, s7, 8
    v_lshl_add_u32 v83, v25, 4, s78
    v_mul_u32_u24 v37, 3072, v26
    v_add_u32 v84, v83, v37
    v_add_u32 v83, 6400, v83
    v_lshlrev_b32 v37, 4, v26
    v_add_u32 v37, 6112, v37
    v_or_b32 v38, s7, v25
    v_mov_b32 v39, 1879048176
    v_cmp_eq_u32 vcc, 0, v38
    s_nop 1
    v_cndmask_b32 v37, v39, v37, vcc
    v_cmp_le_u32 vcc, 2, v26
    s_nop 1
    v_cndmask_b32 v84, v84, v37, vcc
    s_and_b32 s79, s79, 3
    s_lshl_b32 s78, s79, 2
    s_add_u32 s78, s78, s3
    s_add_u32 s78, s78, 50432
    s_mul_i32 s79, s79, 320
    v_cmp_eq_u32 vcc, 12, v25
    v_mov_b32 v38, 0x3f803f80
    s_nop 0
    v_cndmask_b32 v88, 0, v38, vcc
    v_mov_b32 v89, v88
    v_mov_b32 v90, v88
    v_mov_b32 v91, v88
    v_mov_b32 v92, v88
    v_mov_b32 v93, v88
    v_mov_b32 v94, v88
    v_mov_b32 v95, v88
    v_mov_b32 v96, v88
    v_mov_b32 v97, v88
    v_mov_b32 v98, v88
    v_mov_b32 v99, v88
    v_mov_b32 v100, v88
    v_mov_b32 v101, v88
    v_mov_b32 v102, v88
    v_mov_b32 v103, v88
    v_mov_b32 v104, v88
    v_mov_b32 v105, v88
    v_mov_b32 v106, v88
    v_mov_b32 v107, v88
    v_mul_u32_u24 v6, 336, v25
    v_lshl_add_u32 v6, v26, 4, v6
    s_mul_i32 s77, s72, 45
    v_min_u32 v27, 44, v0
    v_add_u32 v27, s77, v27
    v_mul_u32_u24 v37, 205, v27
    v_lshrrev_b32 v37, 12, v37
    v_add_u32 v87, v37, v27
    v_lshlrev_b32 v87, 4, v87
    v_mul_u32_u24 v38, 20, v37
    v_sub_u32 v27, v27, v38
    v_lshlrev_b32 v27, 4, v27
    s_mul_i32 s7, s68, 10240
    s_cmp_eq_u32 s74, 0
    s_cselect_b32 s7, 0, s7
    s_add_u32 s7, s7, 655360
    v_mul_u32_u24 v86, 1280, v37
    v_add_u32 v86, s7, v86
    s_mul_i32 s7, s68, 81920
    s_add_u32 s7, s7, 45312
    v_mov_b32 v38, s7
    v_cmp_eq_u32 vcc, s68, v37
    s_nop 1
    v_cndmask_b32 v86, v86, v38, vcc
    v_add_u32 v38, 2560, v38
    v_cmp_le_u32 vcc, 8, v37
    s_nop 1
    v_cndmask_b32 v86, v86, v38, vcc
    v_add_u32 v86, v86, v27
    s_add_u32 s77, s79, s74
    s_add_u32 s79, s79, s3
    s_add_u32 s79, s79, 45312
    s_cmp_lg_u32 s74, 0
    s_cbranch_scc1 FW1
    v_mov_b32 v24, -1
    v_mov_b32 v25, -1
    v_mov_b32 v26, -1
    v_mov_b32 v27, -1
    s_waitcnt vmcnt(0)
    buffer_store_dwordx4 v[24:27], v21, s[8:11], s97 offen
    s_cmp_eq_u32 s10, 0
    s_cbranch_scc1 SLOW23
BACK23:
    s_barrier
FW1:
    ds_read_b64_tr_b16 v[40:41], v80 offset:0
    ds_read_b64_tr_b16 v[42:43], v80 offset:512
    ds_read_b64_tr_b16 v[44:45], v80 offset:4096
    ds_read_b64_tr_b16 v[46:47], v80 offset:4608
    ds_read_b64_tr_b16 v[48:49], v80 offset:8192
    ds_read_b64_tr_b16 v[50:51], v80 offset:8704
    ds_read_b64_tr_b16 v[52:53], v80 offset:12288
    ds_read_b64_tr_b16 v[54:55], v80 offset:12800
    ds_read_b64_tr_b16 v[56:57], v80 offset:16384
    ds_read_b64_tr_b16 v[58:59], v80 offset:16896
    ds_read_b64_tr_b16 v[60:61], v80 offset:20480
    ds_read_b64_tr_b16 v[62:63], v80 offset:20992
    ds_read_b64_tr_b16 v[64:65], v80 offset:24576
    ds_read_b64_tr_b16 v[66:67], v80 offset:25088
    ds_read_b64_tr_b16 v[68:69], v80 offset:28672
    ds_read_b64_tr_b16 v[70:71], v80 offset:29184
    ds_read_b64_tr_b16 v[72:73], v80 offset:32768
    ds_read_b64_tr_b16 v[74:75], v80 offset:33280
    ds_read_b64_tr_b16 v[76:77], v80 offset:36864
    ds_read_b64_tr_b16 v[78:79], v80 offset:37376
    s_cmp_lg_u32 s74, 0
    s_cbranch_scc1 FW3
    s_waitcnt lgkmcnt(0)
    v_mfma_f32_16x16x32_bf16 v[108:111], v[88:91], v[40:43], 0
    v_mfma_f32_16x16x32_bf16 v[2:5], v[88:91], v[60:63], 0
    v_mfma_f32_16x16x32_bf16 v[108:111], v[92:95], v[44:47], v[108:111]
    v_mfma_f32_16x16x32_bf16 v[2:5], v[92:95], v[64:67], v[2:5]
    v_mfma_f32_16x16x32_bf16 v[108:111], v[96:99], v[48:51], v[108:111]
    v_mfma_f32_16x16x32_bf16 v[2:5], v[96:99], v[68:71], v[2:5]
    v_mfma_f32_16x16x32_bf16 v[108:111], v[100:103], v[52:55], v[108:111]
    v_mfma_f32_16x16x32_bf16 v[2:5], v[100:103], v[72:75], v[2:5]
    v_mfma_f32_16x16x32_bf16 v[108:111], v[104:107], v[56:59], v[108:111]
    v_mfma_f32_16x16x32_bf16 v[2:5], v[104:107], v[76:79], v[2:5]
FW3:
    s_mov_b32 exec_lo, 0xfffff
    s_mov_b32 exec_hi, 0x0
    s_mov_b32 s76, 1
POLL24:
    buffer_load_dword v36, v1, s[16:19], s79 offen sc1
POLLW24:
    s_waitcnt vmcnt(0)
    v_cmp_eq_u32 vcc, -1, v36
    s_cbranch_vccnz AGAIN24
POLLX24:
    s_mov_b64 exec, s[86:87]
    buffer_load_dwordx4 v[24:27], v86, s[16:19], s77 offen sc1
    s_cmp_eq_u32 s74, 0
    s_cbranch_scc1 CSP
    s_waitcnt vmcnt(0)
CSB:
    s_waitcnt vmcnt(2)
BW25:
    ds_write_b128 v87, v[24:27]
    v_cmp_eq_u32 vcc, -1, v24
    s_cbranch_vccnz BR25
BX25:
    s_mov_b64 exec, s[84:85]
    s_waitcnt lgkmcnt(0)
    s_barrier
    ds_read_b128 v[88:91], v6 offset:0
    ds_read_b128 v[92:95], v6 offset:64
    ds_read_b128 v[96:99], v6 offset:128
    ds_read_b128 v[100:103], v6 offset:192
    ds_read_b128 v[104:107], v6 offset:256
    s_mov_b64 exec, -1
    s_waitcnt lgkmcnt(4)
    v_mfma_f32_16x16x32_bf16 v[32:35], v[88:91], v[88:91], 0
    s_waitcnt lgkmcnt(3)
    v_mfma_f32_16x16x32_bf16 v[32:35], v[92:95], v[92:95], v[32:35]
    s_waitcnt lgkmcnt(2)
    v_mfma_f32_16x16x32_bf16 v[32:35], v[96:99], v[96:99], v[32:35]
    s_waitcnt lgkmcnt(1)
    v_mfma_f32_16x16x32_bf16 v[32:35], v[100:103], v[100:103], v[32:35]
    s_waitcnt lgkmcnt(0)
    v_mfma_f32_16x16x32_bf16 v[32:35], v[104:107], v[104:107], v[32:35]
    v_mfma_f32_16x16x32_bf16 v[24:27], v[88:91], v[40:43], 0
    v_mov_b32 v36, 0
    v_mov_b32 v37, 0
    v_mfma_f32_16x16x32_bf16 v[24:27], v[92:95], v[44:47], v[24:27]
    v_mov_b32 v38, 0
    s_nop 0
    v_mfma_f32_16x16x32_bf16 v[24:27], v[96:99], v[48:51], v[24:27]
    v_mfma_f32_16x16x32_bf16 v[24:27], v[100:103], v[52:55], v[24:27]
    v_add_f32 v32, v32, v33
    v_add_f32 v34, v34, v35
    v_mfma_f32_16x16x32_bf16 v[24:27], v[104:107], v[56:59], v[24:27]
    v_mfma_f32_16x16x32_bf16 v[28:31], v[88:91], v[60:63], 0
    v_add_f32_dpp v36, v32, v34 quad_perm:[0,1,2,3] row_mask:0xf bank_mask:0x7
    v_mfma_f32_16x16x32_bf16 v[28:31], v[92:95], v[64:67], v[28:31]
    s_nop 0
    v_add_f32_dpp v36, v36, v36 row_ror:8 row_mask:0xf bank_mask:0xf
    v_mfma_f32_16x16x32_bf16 v[28:31], v[96:99], v[68:71], v[28:31]
    s_nop 0
    v_add_f32_dpp v36, v36, v36 row_ror:4 row_mask:0xf bank_mask:0xf
    v_mfma_f32_16x16x32_bf16 v[28:31], v[100:103], v[72:75], v[28:31]
    s_nop 0
    v_add_f32_dpp v36, v36, v36 row_ror:2 row_mask:0xf bank_mask:0xf
    v_mfma_f32_16x16x32_bf16 v[28:31], v[104:107], v[76:79], v[28:31]
    v_add_f32 v25, v24, v25
    v_add_f32_dpp v37, v36, v36 row_ror:1 row_mask:0x7 bank_mask:0xf
    v_add_f32_dpp v38, v36, v36 row_ror:1 row_mask:0x8 bank_mask:0xf
    v_add_f32 v26, v26, v27
    v_add_f32 v25, v25, v26
    s_nop 1
    v_permlane32_swap_b32 v25, v37
    v_add_f32 v29, v28, v29
    v_add_f32 v30, v30, v31
    v_add_f32 v29, v29, v30
    v_add_f32 v25, v25, v37
    s_nop 0
    v_permlane32_swap_b32 v29, v38
    v_add_f32 v29, v29, v38
    s_nop 1
    v_permlane16_swap_b32 v25, v29
    v_add_f32 v25, v25, v29
    buffer_store_dword v25, v84, s[8:11], s78 offen
    s_cmp_eq_u32 s10, 0
    s_cbranch_scc1 SLOW26
BACK26:
NEXT:
    s_cmp_lg_u32 s74, 0
    s_cbranch_scc1 DONE
    s_mov_b32 s74, 819200
    s_add_u32 s3, s3, 819200
    s_add_u32 s80, s80, 819200
    s_add_u32 s81, s81, 819200
    s_mov_b64 s[46:47], s[44:45]
    s_mov_b64 s[48:49], s[92:93]
    s_branch LOOP
AGAIN24:
    s_add_u32 s76, s76, 1
    s_cmp_lt_u32 s76, 32768
    s_cbranch_scc1 POLL24
    s_branch POLLX24
CSP:
    s_mov_b32 exec_lo, 0x0
    s_mov_b32 exec_hi, 0xffff0000
    buffer_store_dword v108, v83, s[8:11], s78 offen
    s_cmp_eq_u32 s10, 0
    s_cbranch_scc1 SLOW27
BACK27:
    buffer_store_dword v2, v83, s[8:11], s78 offen offset:3072
    s_cmp_eq_u32 s10, 0
    s_cbranch_scc1 SLOW28
BACK28:
    s_mov_b64 exec, s[86:87]
    s_branch CSB
BR25:
    s_cmp_ge_u32 s76, 32768
    s_cbranch_scc1 BX25
    s_mov_b64 exec, vcc
    buffer_load_dwordx4 v[24:27], v86, s[16:19], s77 offen sc1
    s_add_u32 s76, s76, 1
    s_waitcnt vmcnt(0)
    s_branch BW25
DONE:
    s_endpgm
TAGLOOP:
    s_mov_b32 s76, 0
TAGL2:
    s_sleep 8
    global_load_dword v98, v100, s[64:65] sc1
    s_waitcnt vmcnt(0)
    v_readfirstlane_b32 s96, v98
    s_nop 0
    s_cmp_lg_u32 s96, 0
    s_cbranch_scc1 TAGOK
    s_add_u32 s76, s76, 1
    s_cmp_lt_u32 s76, 32768
    s_cbranch_scc1 TAGL2
    s_branch TAGOK
DMAF:
    s_sub_u32 s78, s69, 20
    s_and_b32 s66, s78, 3
    s_lshl_b32 s66, s66, 1
    s_and_b32 s79, s72, 1
    s_add_u32 s66, s66, s79
    s_mul_i32 s66, s66, 245760
    s_lshr_b32 s78, s78, 2
    s_lshl_b32 s78, s78, 7
    s_add_u32 s66, s66, s78
    s_mul_i32 s78, s68, 384
    s_add_u32 s66, s66, s78
    s_mul_i32 s67, s72, 10240
    s_add_u32 s67, s67, 57344
    s_branch DMAX
RDYLOOP:
    s_mov_b32 s76, 0
RDYL2:
    s_sleep 8
    buffer_load_dwordx2 v[98:99], v100, s[16:19], 0 offen offset:384 sc1
    s_waitcnt vmcnt(0)
    v_cmp_ne_u32 vcc, s96, v98
    s_cbranch_vccz RDYOK
    s_add_u32 s76, s76, 1
    s_cmp_lt_u32 s76, 32768
    s_cbranch_scc1 RDYL2
    s_branch RDYOK
SLOW1:
    buffer_store_dwordx4 v[28:31], v27, s[16:19], s77 offen sc1
    s_branch BACK1
SLOW2:
    buffer_store_dwordx4 v[24:27], v106, s[16:19], 0 offen sc1
    s_branch BACK2
SLOW5:
    buffer_store_dword v24, v10, s[16:19], s3 offen sc1
    s_branch BACK5
SLOW7:
    buffer_store_dwordx4 v[28:31], v1, s[16:19], s77 offen sc1
    s_branch BACK7
RETRY8:
    s_mov_b32 s76, 1
POLL29:
    buffer_load_dword v28, v20, s[16:19], 0 offen sc1
    buffer_load_dword v29, v21, s[16:19], 0 offen sc1
POLLW29:
    s_waitcnt vmcnt(0)
    v_max_u32 v30, v28, v29
    v_cmp_eq_u32 vcc, -1, v30
    s_cbranch_vccnz AGAIN29
POLLX29:
    s_branch OK8
AGAIN29:
    s_add_u32 s76, s76, 1
    s_cmp_lt_u32 s76, 32768
    s_cbranch_scc1 POLL29
    s_branch POLLX29
SLOW9:
    buffer_store_dwordx4 v[28:31], v32, s[16:19], s77 offen sc1
    s_branch BACK9
SLOW11:
    buffer_store_dwordx4 v[28:31], v18, s[16:19], s81 offen sc1
    s_branch BACK11
SLOW12:
    buffer_store_dwordx4 v[28:31], v18, s[16:19], s97 offen sc1
    s_branch BACK12
SLOW13:
    buffer_store_dwordx2 v[34:35], v1, s[16:19], s78 offen sc1
    s_branch BACK13
SLOW14:
    buffer_store_dword v7, v10, s[16:19], s77 offen sc1
    s_branch BACK14
SLOW15:
    buffer_store_dwordx4 v[104:107], v100, s[16:19], s78 offen sc1
    s_branch BACK15
SLOW16:
    buffer_store_dwordx4 v[104:107], v101, s[16:19], s78 offen sc1
    s_branch BACK16
RETRY18:
    s_mov_b32 s76, 1
POLL30:
    buffer_load_dword v28, v37, s[16:19], 0 offen sc1
    buffer_load_dword v29, v38, s[16:19], 0 offen sc1
POLLW30:
    s_waitcnt vmcnt(0)
    v_max_u32 v30, v28, v29
    v_cmp_eq_u32 vcc, -1, v30
    s_cbranch_vccnz AGAIN30
POLLX30:
    s_branch OK18
AGAIN30:
    s_add_u32 s76, s76, 1
    s_cmp_lt_u32 s76, 32768
    s_cbranch_scc1 POLL30
    s_branch POLLX30
SLOW19:
    buffer_store_dwordx4 v[28:31], v32, s[16:19], s77 offen sc1
    s_branch BACK19
SLOW22:
    buffer_store_dword v7, v10, s[16:19], s77 offen sc1
    s_branch BACK22
SLOW23:
    buffer_store_dwordx4 v[24:27], v21, s[16:19], s97 offen sc1
    s_branch BACK23
SLOW26:
    buffer_store_dword v25, v84, s[16:19], s78 offen sc1
    s_branch BACK26
SLOW27:
    buffer_store_dword v108, v83, s[16:19], s78 offen sc1
    s_branch BACK27
SLOW28:
    buffer_store_dword v2, v83, s[16:19], s78 offen offset:3072 sc1
    s_branch BACK28
CODE_END:
    s_endpgm
.section .rodata,"a"
.p2align 6
.amdhsa_kernel interleave_layers__sliding_block_cached__glu_gated_swiglu__decode_kernel
  .amdhsa_next_free_vgpr 512
  .amdhsa_next_free_sgpr 102
  .amdhsa_accum_offset 256
  .amdhsa_group_segment_fixed_size 0
  .amdhsa_kernarg_size 96
  .amdhsa_user_sgpr_count 2
  .amdhsa_user_sgpr_kernarg_segment_ptr 1
  .amdhsa_system_sgpr_workgroup_id_x 1
.end_amdhsa_kernel
```

```asm
; @launch grid=(256,1,1) block=(256,1,1) lds=125568
.amdgcn_target "amdgcn-amd-amdhsa--gfx950"
.text
.globl interleave_layers__sliding_block_cached__glu_gated_swiglu__decode_kernel
.p2align 8
.type interleave_layers__sliding_block_cached__glu_gated_swiglu__decode_kernel,@function
interleave_layers__sliding_block_cached__glu_gated_swiglu__decode_kernel:
    s_load_dwordx16 s[44:59], s[0:1], 0
    s_load_dwordx8 s[60:67], s[0:1], 64
    s_cmp_ge_u32 s2, 256
    s_cbranch_scc1 CODE_END
    s_memrealtime s[96:97]
    v_lshrrev_b32 v2, 6, v0
    v_and_b32 v24, 63, v0
    v_readfirstlane_b32 s72, v2
    s_and_b32 s68, s2, 7
    s_lshr_b32 s69, s2, 3
    s_lshr_b32 s70, s69, 3
    s_and_b32 s71, s69, 7
    v_lshlrev_b32 v1, 4, v24
    s_lshl_b32 s77, s70, 3
    s_add_u32 s77, s77, s68
    s_mul_i32 s73, s77, 12582912
    s_lshl_b32 s78, s71, 2
    s_add_u32 s78, s78, s72
    s_mul_i32 s78, s78, 6144
    s_add_u32 s73, s73, s78
    s_add_u32 s73, s73, 11010048
    v_add_u32 v23, 4096, v1
    s_mov_b32 s10, 402653184
    s_mov_b32 s11, 0x20000
    s_getpc_b64 s[100:101]
PCREF:
    s_sub_u32 s100, s100, PCREF-interleave_layers__sliding_block_cached__glu_gated_swiglu__decode_kernel
    s_subb_u32 s101, s101, 0
    s_lshl_b32 s78, s71, 12
    v_lshl_add_u32 v25, v0, 4, s78
    v_cmp_gt_u32 vcc, CODE_END-interleave_layers__sliding_block_cached__glu_gated_swiglu__decode_kernel-16, v25
    s_nop 0
    s_and_saveexec_b64 s[98:99], vcc
    s_cbranch_execz NOCPF
    global_load_dwordx4 a[240:243], v25, s[100:101]
NOCPF:
    s_mov_b64 exec, -1
    s_mul_i32 s79, s77, 384
    s_mov_b32 s74, 0
    s_mul_i32 s3, s68, 81920
    s_getreg_b32 s75, hwreg(HW_REG_XCC_ID, 0, 4)
    s_lshl_b32 s77, s69, 9
    s_add_u32 s77, s77, s3
    s_add_u32 s77, s77, 32768
    v_add_u32 v20, s77, v1
    s_lshl_b32 s77, s68, 2
    s_add_u32 s77, s77, s69
    s_mul_i32 s77, s77, 320
    s_add_u32 s77, s77, 654848
    s_add_u32 s4, s77, 1024
    v_add_u32 v25, s77, v1
    v_cmp_le_u32 vcc, 32, v0
    s_nop 1
    v_cndmask_b32 v21, v20, v25, vcc
    v_mov_b32 v25, 2147483632
    v_cndmask_b32 v20, v20, v25, vcc
    s_cmp_lt_u32 s69, 4
    s_cselect_b32 s77, 52, 32
    v_cmp_le_u32 vcc, s77, v0
    s_nop 1
    v_cndmask_b32 v21, v21, v25, vcc
    s_mov_b32 s18, 1610612736
    s_mov_b32 s19, 0x20000
    s_waitcnt lgkmcnt(0)
    s_mov_b32 s8, s46
    s_and_b32 s9, s47, 0xffff
    s_mov_b32 s16, s66
    s_and_b32 s17, s67, 0xffff
    buffer_load_dwordx4 a[0:3], v1, s[8:11], s73 offen offset:0 nt
    buffer_load_dwordx4 a[4:7], v1, s[8:11], s73 offen offset:1024 nt
    s_or_b32 s77, s2, s72
    s_cbranch_scc1 NOTAG
    s_or_b32 s77, s96, 1
    v_mov_b32 v26, s77
    s_mov_b64 exec, 1
    global_store_dword v1, v26, s[64:65] sc1
    s_mov_b64 exec, -1
NOTAG:
    s_add_u32 s83, s73, 196608
    s_mov_b32 s12, s48
    s_and_b32 s13, s49, 0xffff
    s_mov_b32 s14, 402653184
    s_mov_b32 s15, 0x20000
    s_mov_b32 s20, s50
    s_and_b32 s21, s51, 0xffff
    s_mov_b32 s22, 7864320
    s_mov_b32 s23, 0x20000
    s_mov_b32 s36, s44
    s_and_b32 s37, s45, 0xffff
    s_mov_b32 s38, 1280
    s_mov_b32 s39, 0x20000
    s_mov_b32 s40, s62
    s_and_b32 s41, s63, 0xffff
    s_mov_b32 s42, 1280
    s_mov_b32 s43, 0x20000
    s_mov_b32 s28, s58
    s_and_b32 s29, s59, 0xffff
    s_mov_b32 s30, 1966080
    s_mov_b32 s31, 0x20000
    s_mov_b32 s32, s60
    s_and_b32 s33, s61, 0xffff
    s_mov_b32 s34, 1966080
    s_mov_b32 s35, 0x20000
    s_cmp_lt_u32 s69, 20
    s_cselect_b32 s24, s52, s56
    s_cselect_b32 s25, s53, s57
    s_cselect_b32 s26, s22, s30
    s_and_b32 s25, s25, 0xffff
    s_mov_b32 s27, 0x20000
    s_add_u32 s84, s83, 196608
    s_add_u32 s85, s84, 196608
    s_add_u32 s86, s85, 196608
    s_add_u32 s87, s86, 196608
    s_add_u32 s88, s87, 196608
    s_add_u32 s89, s88, 196608
    v_mov_b32 v0, v24
    s_mul_i32 s77, s72, 6656
    v_add_u32 v25, 0, v0
    v_mul_u32_u24 v26, 171, v25
    v_lshrrev_b32 v26, 12, v26
    v_mul_u32_u24 v27, 24, v26
    v_sub_u32 v27, v25, v27
    v_lshlrev_b32 v27, 4, v27
    v_mul_u32_u24 v25, 416, v26
    v_add3_u32 v2, v25, v27, s77
    v_mul_u32_u24 v25, 12288, v26
    v_add_u32 v40, v25, v27
    v_add_u32 v25, 64, v0
    v_mul_u32_u24 v26, 171, v25
    v_lshrrev_b32 v26, 12, v26
    v_mul_u32_u24 v27, 24, v26
    v_sub_u32 v27, v25, v27
    v_lshlrev_b32 v27, 4, v27
    v_mul_u32_u24 v25, 416, v26
    v_add3_u32 v3, v25, v27, s77
    v_mul_u32_u24 v25, 12288, v26
    v_add_u32 v41, v25, v27
    v_add_u32 v25, 128, v0
    v_mul_u32_u24 v26, 171, v25
    v_lshrrev_b32 v26, 12, v26
    v_mul_u32_u24 v27, 24, v26
    v_sub_u32 v27, v25, v27
    v_lshlrev_b32 v27, 4, v27
    v_mul_u32_u24 v25, 416, v26
    v_add3_u32 v4, v25, v27, s77
    v_mul_u32_u24 v25, 12288, v26
    v_add_u32 v42, v25, v27
    v_and_b32 v25, 15, v0
    v_lshrrev_b32 v26, 4, v0
    v_bfe_u32 v27, v0, 2, 2
    v_and_b32 v28, 3, v0
    s_mul_i32 s78, s71, 160
    v_lshlrev_b32 v36, 4, v26
    v_lshlrev_b32 v37, 3, v26
    v_lshlrev_b32 v39, 2, v0
    buffer_load_dwordx4 v[70:73], v36, s[36:39], s78 offen
    buffer_load_dwordx4 v[74:77], v36, s[36:39], s78 offen offset:64
    buffer_load_dwordx2 v[78:79], v37, s[36:39], s78 offen offset:128
    buffer_load_dwordx4 v[80:83], v1, s[36:39], 0 offen
    buffer_load_dword v84, v39, s[36:39], 0 offen offset:1024
    s_lshl_b32 s7, s69, 6
    v_lshlrev_b32 v38, 2, v25
    buffer_load_dword v22, v38, s[36:39], s7 offen
    s_mul_i32 s78, s71, 983040
    s_add_u32 s79, s79, s78
    s_mul_i32 s78, s72, 98304
    s_add_u32 s79, s79, s78
    s_mul_i32 s78, s72, 3072
    s_add_u32 s78, s78, 26624
    s_add_u32 m0, s78, 0
    s_nop 0
    buffer_load_dwordx4 v40, s[20:23], s79 offen nt lds
    s_add_u32 m0, s78, 1024
    s_nop 0
    buffer_load_dwordx4 v41, s[20:23], s79 offen nt lds
    s_add_u32 m0, s78, 2048
    s_nop 0
    buffer_load_dwordx4 v42, s[20:23], s79 offen nt lds
    s_add_u32 s79, s79, 393216
    s_add_u32 m0, s78, 12288
    s_nop 0
    buffer_load_dwordx4 v40, s[20:23], s79 offen nt lds
    s_add_u32 m0, s78, 13312
    s_nop 0
    buffer_load_dwordx4 v41, s[20:23], s79 offen nt lds
    s_add_u32 m0, s78, 14336
    s_nop 0
    buffer_load_dwordx4 v42, s[20:23], s79 offen nt lds
    s_add_u32 s79, s79, 393216
    s_cmp_ge_u32 s72, 2
    s_cbranch_scc1 NOWQ3
    s_add_u32 m0, s78, 24576
    s_nop 0
    buffer_load_dwordx4 v40, s[20:23], s79 offen nt lds
    s_add_u32 m0, s78, 25600
    s_nop 0
    buffer_load_dwordx4 v41, s[20:23], s79 offen nt lds
    s_add_u32 m0, s78, 26624
    s_nop 0
    buffer_load_dwordx4 v42, s[20:23], s79 offen nt lds
NOWQ3:
    s_mul_i32 s78, s71, 160
    s_mov_b32 s20, s52
    s_and_b32 s21, s53, 0xffff
    s_mov_b32 s22, 7864320
    s_mov_b32 s23, 0x20000
    s_cmp_lt_u32 s72, 2
    s_cselect_b32 s36, s56, s58
    s_cselect_b32 s37, s57, s59
    s_and_b32 s37, s37, 0xffff
    s_mov_b32 s38, 1966080
    buffer_load_dwordx4 a[8:11], v1, s[8:11], s73 offen offset:2048 nt
    buffer_load_dwordx4 a[12:15], v1, s[8:11], s73 offen offset:3072 nt
    buffer_load_dwordx4 a[16:19], v23, s[8:11], s73 offen offset:0 nt
    v_mul_u32_u24 v29, 416, v25
    v_lshl_add_u32 v29, v26, 4, v29
    v_add_u32 v5, s77, v29
    v_lshrrev_b32 v29, 2, v0
    v_mul_u32_u24 v29, 416, v29
    v_lshl_add_u32 v29, v28, 3, v29
    v_add_u32 v6, s77, v29
    s_mul_i32 s79, s72, 96
    s_add_u32 s79, s79, 26624
    v_lshl_add_u32 v29, v26, 3, v27
    v_mul_u32_u24 v29, 384, v29
    v_lshl_add_u32 v29, v28, 3, v29
    v_add_u32 v16, s79, v29
    v_lshl_add_u32 v29, v26, 2, v27
    v_mul_u32_u24 v29, 384, v29
    v_lshl_add_u32 v29, v28, 3, v29
    v_add_u32 v17, s79, v29
    buffer_load_dwordx4 a[20:23], v23, s[8:11], s73 offen offset:1024 nt
    s_mul_i32 s79, s72, 23
    v_min_u32 v32, 22, v0
    v_add_u32 v32, s79, v32
    v_min_u32 v32, 89, v32
    v_mul_u32_u24 v31, 103, v32
    v_lshrrev_b32 v31, 10, v31
    v_mul_u32_u24 v30, 10, v31
    v_sub_u32 v30, v32, v30
    v_lshl_add_u32 v29, v30, 4, s78
    s_mul_i32 s7, s68, 10240
    s_add_u32 s7, s7, 737280
    v_mul_u32_u24 v8, 1280, v31
    v_add_u32 v8, s7, v8
    s_mul_i32 s7, s68, 81920
    s_add_u32 s7, s7, 46592
    v_mov_b32 v30, s7
    v_cmp_eq_u32 vcc, s68, v31
    s_nop 1
    v_cndmask_b32 v8, v8, v30, vcc
    v_add_u32 v30, 2560, v30
    v_cmp_le_u32 vcc, 8, v31
    s_nop 1
    v_cndmask_b32 v8, v8, v30, vcc
    v_add_u32 v8, v8, v29
    v_add_u32 v33, v31, v32
    v_lshlrev_b32 v33, 4, v33
    v_add_u32 v33, 4096, v33
    v_add_u32 v31, 6, v31
    s_mul_i32 s7, s68, 10240
    s_add_u32 s7, s7, 737280
    v_mul_u32_u24 v9, 1280, v31
    v_add_u32 v9, s7, v9
    s_mul_i32 s7, s68, 81920
    s_add_u32 s7, s7, 46592
    v_mov_b32 v30, s7
    v_cmp_eq_u32 vcc, s68, v31
    s_nop 1
    v_cndmask_b32 v9, v9, v30, vcc
    v_add_u32 v30, 2560, v30
    v_cmp_le_u32 vcc, 8, v31
    s_nop 1
    v_cndmask_b32 v9, v9, v30, vcc
    v_add_u32 v9, v9, v29
    v_mov_b32 v30, 2147483632
    v_cmp_le_u32 vcc, 30, v0
    s_nop 1
    v_cndmask_b32 v9, v9, v30, vcc
    v_mov_b32 v9, v33
    s_lshl_b32 s78, s69, 10
    s_lshl_b32 s79, s72, 8
    s_add_u32 s78, s78, s79
    v_lshl_add_u32 v10, v0, 2, s78
    s_lshl_b32 s78, s70, 13
    s_add_u32 s78, s78, s79
    v_lshlrev_b32 v29, 10, v26
    v_lshl_add_u32 v29, v25, 4, v29
    v_add_u32 v11, s78, v29
    buffer_load_dwordx4 a[24:27], v1, s[8:11], s83 offen offset:0 nt
    s_mul_i32 s78, s72, 96
    s_add_u32 s78, s78, 118784
    v_lshl_add_u32 v29, v27, 5, s78
    v_lshl_add_u32 v29, v28, 2, v29
    v_lshrrev_b32 v30, 1, v26
    v_lshl_add_u32 v29, v30, 4, v29
    v_and_b32 v30, 1, v26
    v_lshl_add_u32 v29, v30, 1, v29
    v_mov_b32 v30, 119168
    v_cmp_le_u32 vcc, 12, v25
    s_nop 1
    v_cndmask_b32 v12, v29, v30, vcc
    v_and_b32 v30, 1, v0
    v_lshlrev_b32 v29, 5, v26
    v_lshl_add_u32 v29, v30, 4, v29
    v_add_u32 v13, 118784, v29
    v_mul_u32_u24 v30, 0xaaaa, v30
    v_and_b32 v29, 1, v27
    v_mul_u32_u24 v29, 0xaaaa, v29
    v_lshl_or_b32 v29, v29, 16, v30
    v_add_u32 v14, 0x44444444, v29
    buffer_load_dwordx4 a[28:31], v1, s[8:11], s83 offen offset:1024 nt
    s_lshl_b32 s78, s72, 8
    s_add_u32 s78, s78, 124416
    v_lshrrev_b32 v29, 5, v0
    v_lshl_add_u32 v29, v29, 6, s78
    v_bfe_u32 v30, v0, 3, 1
    v_lshl_add_u32 v29, v30, 5, v29
    v_bfe_u32 v30, v0, 1, 1
    v_lshl_add_u32 v29, v30, 4, v29
    v_bfe_u32 v30, v0, 2, 1
    v_lshl_add_u32 v29, v30, 3, v29
    v_bfe_u32 v30, v0, 4, 1
    v_lshl_add_u32 v29, v30, 2, v29
    v_bfe_u32 v30, v0, 0, 1
    v_lshl_add_u32 v29, v30, 1, v29
    v_mov_b32 v19, v29
    v_bfe_u32 v29, v0, 4, 1
    v_bfe_u32 v30, v0, 2, 1
    v_lshl_add_u32 v29, v29, 5, s78
    v_lshl_add_u32 v29, v30, 4, v29
    v_accvgpr_write_b32 a252, v29
    s_mul_i32 s78, s72, 768
    s_add_u32 s78, s78, 119296
    v_lshl_add_u32 v29, v25, 2, s78
    v_bfe_u32 v30, v0, 4, 1
    v_lshl_add_u32 v29, v30, 7, v29
    v_lshrrev_b32 v30, 5, v0
    v_lshl_add_u32 v15, v30, 6, v29
    s_waitcnt vmcnt(12)
    v_lshlrev_b32 v88, 16, v80
    v_and_b32 v89, 0xffff0000, v80
    v_lshlrev_b32 v90, 16, v81
    v_and_b32 v91, 0xffff0000, v81
    v_lshlrev_b32 v92, 16, v82
    v_and_b32 v93, 0xffff0000, v82
    v_lshlrev_b32 v94, 16, v83
    v_and_b32 v95, 0xffff0000, v83
    v_lshlrev_b32 v96, 16, v84
    v_and_b32 v97, 0xffff0000, v84
    v_add_f32 v80, v88, v89
    v_add_f32 v80, v80, v90
    v_add_f32 v80, v80, v91
    v_add_f32 v80, v80, v92
    v_add_f32 v80, v80, v93
    v_add_f32 v80, v80, v94
    v_add_f32 v80, v80, v95
    v_add_f32 v80, v80, v96
    v_add_f32 v80, v80, v97
    s_nop 1
    v_add_f32_dpp v80, v80, v80 row_ror:8 row_mask:0xf bank_mask:0xf
    s_nop 1
    v_add_f32_dpp v80, v80, v80 row_ror:4 row_mask:0xf bank_mask:0xf
    s_nop 1
    v_add_f32_dpp v80, v80, v80 row_ror:2 row_mask:0xf bank_mask:0xf
    s_nop 1
    v_add_f32_dpp v80, v80, v80 row_ror:1 row_mask:0xf bank_mask:0xf
    v_mov_b32 v81, v80
    s_nop 1
    v_permlane32_swap_b32 v80, v81
    v_add_f32 v80, v80, v81
    v_mov_b32 v81, v80
    s_nop 1
    v_permlane16_swap_b32 v80, v81
    v_add_f32 v80, v80, v81
    v_mul_f32 v80, 0x3acccccd, v80
    v_sub_f32 v88, v88, v80
    v_sub_f32 v89, v89, v80
    v_sub_f32 v90, v90, v80
    v_sub_f32 v91, v91, v80
    v_sub_f32 v92, v92, v80
    v_sub_f32 v93, v93, v80
    v_sub_f32 v94, v94, v80
    v_sub_f32 v95, v95, v80
    v_sub_f32 v96, v96, v80
    v_sub_f32 v97, v97, v80
    v_mul_f32 v82, v88, v88
    v_fmac_f32 v82, v89, v89
    v_fmac_f32 v82, v90, v90
    v_fmac_f32 v82, v91, v91
    v_fmac_f32 v82, v92, v92
    v_fmac_f32 v82, v93, v93
    v_fmac_f32 v82, v94, v94
    v_fmac_f32 v82, v95, v95
    v_fmac_f32 v82, v96, v96
    v_fmac_f32 v82, v97, v97
    buffer_load_dwordx4 a[32:35], v1, s[8:11], s83 offen offset:2048 nt
    s_nop 0
    v_add_f32_dpp v82, v82, v82 row_ror:8 row_mask:0xf bank_mask:0xf
    s_nop 1
    v_add_f32_dpp v82, v82, v82 row_ror:4 row_mask:0xf bank_mask:0xf
    s_nop 1
    v_add_f32_dpp v82, v82, v82 row_ror:2 row_mask:0xf bank_mask:0xf
    s_nop 1
    v_add_f32_dpp v82, v82, v82 row_ror:1 row_mask:0xf bank_mask:0xf
    v_mov_b32 v81, v82
    s_nop 1
    v_permlane32_swap_b32 v82, v81
    v_add_f32 v82, v82, v81
    v_mov_b32 v81, v82
    s_nop 1
    v_permlane16_swap_b32 v82, v81
    v_add_f32 v82, v82, v81
    v_mul_f32 v82, 0x3acccccd, v82
    v_add_f32 v82, 0x3727c5ac, v82
    v_rsq_f32 v82, v82
    s_mov_b32 vcc_lo, 0xaaaaaaaa
    s_mov_b32 vcc_hi, 0xaaaaaaaa
    v_mov_b32 v85, 0x3f803f80
    v_lshlrev_b32 v83, 16, v70
    v_and_b32 v84, 0xffff0000, v70
    v_sub_f32 v83, v83, v80
    v_sub_f32 v84, v84, v80
    v_mul_f32 v83, v83, v82
    v_mul_f32 v84, v84, v82
    v_cvt_pk_bf16_f32 v83, v83, v84
    v_cndmask_b32 v70, v83, v85, vcc
    v_lshlrev_b32 v83, 16, v71
    v_and_b32 v84, 0xffff0000, v71
    v_sub_f32 v83, v83, v80
    v_sub_f32 v84, v84, v80
    v_mul_f32 v83, v83, v82
    v_mul_f32 v84, v84, v82
    v_cvt_pk_bf16_f32 v83, v83, v84
    v_cndmask_b32 v71, v83, v85, vcc
    v_lshlrev_b32 v83, 16, v72
    v_and_b32 v84, 0xffff0000, v72
    v_sub_f32 v83, v83, v80
    v_sub_f32 v84, v84, v80
    v_mul_f32 v83, v83, v82
    v_mul_f32 v84, v84, v82
    v_cvt_pk_bf16_f32 v83, v83, v84
    v_cndmask_b32 v72, v83, v85, vcc
    v_lshlrev_b32 v83, 16, v73
    v_and_b32 v84, 0xffff0000, v73
    v_sub_f32 v83, v83, v80
    v_sub_f32 v84, v84, v80
    v_mul_f32 v83, v83, v82
    v_mul_f32 v84, v84, v82
    v_cvt_pk_bf16_f32 v83, v83, v84
    v_cndmask_b32 v73, v83, v85, vcc
    v_lshlrev_b32 v83, 16, v74
    v_and_b32 v84, 0xffff0000, v74
    v_sub_f32 v83, v83, v80
    v_sub_f32 v84, v84, v80
    v_mul_f32 v83, v83, v82
    v_mul_f32 v84, v84, v82
    v_cvt_pk_bf16_f32 v83, v83, v84
    v_cndmask_b32 v74, v83, v85, vcc
    v_lshlrev_b32 v83, 16, v75
    v_and_b32 v84, 0xffff0000, v75
    v_sub_f32 v83, v83, v80
    v_sub_f32 v84, v84, v80
    v_mul_f32 v83, v83, v82
    v_mul_f32 v84, v84, v82
    v_cvt_pk_bf16_f32 v83, v83, v84
    v_cndmask_b32 v75, v83, v85, vcc
    buffer_load_dwordx4 a[36:39], v1, s[8:11], s83 offen offset:3072 nt
    v_lshlrev_b32 v83, 16, v76
    v_and_b32 v84, 0xffff0000, v76
    v_sub_f32 v83, v83, v80
    v_sub_f32 v84, v84, v80
    v_mul_f32 v83, v83, v82
    v_mul_f32 v84, v84, v82
    v_cvt_pk_bf16_f32 v83, v83, v84
    v_cndmask_b32 v76, v83, v85, vcc
    v_lshlrev_b32 v83, 16, v77
    v_and_b32 v84, 0xffff0000, v77
    v_sub_f32 v83, v83, v80
    v_sub_f32 v84, v84, v80
    v_mul_f32 v83, v83, v82
    v_mul_f32 v84, v84, v82
    v_cvt_pk_bf16_f32 v83, v83, v84
    v_cndmask_b32 v77, v83, v85, vcc
    v_lshlrev_b32 v83, 16, v78
    v_and_b32 v84, 0xffff0000, v78
    v_sub_f32 v83, v83, v80
    v_sub_f32 v84, v84, v80
    v_mul_f32 v83, v83, v82
    v_mul_f32 v84, v84, v82
    v_cvt_pk_bf16_f32 v83, v83, v84
    v_cndmask_b32 v78, v83, v85, vcc
    v_lshlrev_b32 v83, 16, v79
    v_and_b32 v84, 0xffff0000, v79
    v_sub_f32 v83, v83, v80
    v_sub_f32 v84, v84, v80
    v_mul_f32 v83, v83, v82
    v_mul_f32 v84, v84, v82
    v_cvt_pk_bf16_f32 v83, v83, v84
    v_cndmask_b32 v79, v83, v85, vcc
    s_waitcnt vmcnt(8)
    s_barrier
    ds_read_b64_tr_b16 v[40:41], v16 offset:0
    ds_read_b64_tr_b16 v[42:43], v16 offset:1536
    ds_read_b64_tr_b16 v[44:45], v16 offset:12288
    ds_read_b64_tr_b16 v[46:47], v16 offset:13824
    ds_read_b64_tr_b16 v[48:49], v17 offset:24576
    ds_read_b64_tr_b16 v[50:51], v16 offset:32
    ds_read_b64_tr_b16 v[52:53], v16 offset:1568
    ds_read_b64_tr_b16 v[54:55], v16 offset:12320
    ds_read_b64_tr_b16 v[56:57], v16 offset:13856
    ds_read_b64_tr_b16 v[58:59], v17 offset:24608
    ds_read_b64_tr_b16 v[60:61], v16 offset:64
    ds_read_b64_tr_b16 v[62:63], v16 offset:1600
    ds_read_b64_tr_b16 v[64:65], v16 offset:12352
    ds_read_b64_tr_b16 v[66:67], v16 offset:13888
    ds_read_b64_tr_b16 v[68:69], v17 offset:24640
    v_mov_b32 v100, 0
    s_cmp_lg_u32 s72, 0
    s_cbranch_scc1 NOTL
    s_mov_b64 exec, 1
    global_load_dword v98, v100, s[64:65] sc1
    s_mov_b64 exec, -1
NOTL:
    buffer_load_dwordx4 a[40:43], v23, s[8:11], s83 offen offset:0 nt
    buffer_load_dwordx4 a[44:47], v23, s[8:11], s83 offen offset:1024 nt
    s_mul_i32 s79, s72, 96
    s_add_u32 s79, s79, 119296
    v_min_u32 v36, 48, v0
    v_lshl_add_u32 v36, v36, 1, s79
    v_mov_b32 v37, 119808
    v_cmp_le_u32 vcc, 48, v0
    s_nop 1
    v_cndmask_b32 v36, v36, v37, vcc
    v_add_u32 v37, 119296, v1
    s_waitcnt lgkmcnt(0)
    v_mfma_f32_16x16x32_bf16 v[24:27], v[70:73], v[40:43], 0
    v_mfma_f32_16x16x32_bf16 v[28:31], v[70:73], v[50:53], 0
    v_mfma_f32_16x16x32_bf16 v[32:35], v[70:73], v[60:63], 0
    v_mfma_f32_16x16x32_bf16 v[24:27], v[74:77], v[44:47], v[24:27]
    v_mfma_f32_16x16x32_bf16 v[28:31], v[74:77], v[54:57], v[28:31]
    v_mfma_f32_16x16x32_bf16 v[32:35], v[74:77], v[64:67], v[32:35]
    v_mfma_f32_16x16x16_bf16 v[24:27], v[78:79], v[48:49], v[24:27]
    v_mfma_f32_16x16x16_bf16 v[28:31], v[78:79], v[58:59], v[28:31]
    v_mfma_f32_16x16x16_bf16 v[32:35], v[78:79], v[68:69], v[32:35]
    buffer_load_dwordx4 a[48:51], v1, s[8:11], s84 offen offset:0 nt
    s_nop 4
    v_mov_b32 v7, v25
    v_mov_b32_dpp v24, v28 quad_perm:[0,1,2,3] row_mask:0x2 bank_mask:0xf
    s_nop 0
    v_mov_b32_dpp v7, v29 quad_perm:[0,1,2,3] row_mask:0x2 bank_mask:0xf
    v_mov_b32_dpp v24, v32 quad_perm:[0,1,2,3] row_mask:0x4 bank_mask:0xf
    s_nop 0
    v_mov_b32_dpp v7, v33 quad_perm:[0,1,2,3] row_mask:0x4 bank_mask:0xf
    v_cvt_pk_bf16_f32 v24, v24, v24
    ds_write_b16 v36, v24
    buffer_load_dwordx4 a[52:55], v1, s[8:11], s84 offen offset:1024 nt
    buffer_load_dwordx4 a[56:59], v1, s[8:11], s84 offen offset:2048 nt
    s_waitcnt lgkmcnt(0)
    s_barrier
    ds_read_b128 v[28:31], v37
    s_lshl_b32 s79, s69, 9
    s_add_u32 s79, s79, s3
    s_cmp_eq_u32 s72, 0
    s_cselect_b32 exec_lo, 0xffffff, 1
    s_mov_b32 exec_hi, 0
    s_cselect_b32 s78, 0, 1879048176
    v_add_u32 v37, s78, v1
    s_waitcnt lgkmcnt(0)
    buffer_store_dwordx4 v[28:31], v37, s[16:19], s79 offen sc1
    s_mov_b64 exec, -1
    v_mov_b32 v32, -1
    v_mov_b32 v33, -1
    v_mov_b32 v34, -1
    v_mov_b32 v35, -1
    buffer_store_dwordx4 v[32:35], v21, s[16:19], 0 offen sc1
    buffer_load_dwordx4 a[60:63], v1, s[8:11], s84 offen offset:3072 nt
    s_waitcnt vmcnt(12)
    ds_write_b128 v2, a[0:3] offset:0
    ds_write_b128 v3, a[4:7] offset:0
    ds_write_b128 v4, a[8:11] offset:0
    ds_write_b128 v2, a[12:15] offset:3328
    ds_write_b128 v3, a[16:19] offset:3328
    ds_write_b128 v4, a[20:23] offset:3328
    ds_read_b128 a[0:3], v5 offset:0
    ds_read_b128 a[4:7], v5 offset:64
    ds_read_b128 a[8:11], v5 offset:128
    ds_read_b128 a[12:15], v5 offset:192
    ds_read_b128 a[16:19], v5 offset:256
    ds_read_b128 a[20:23], v5 offset:320
    buffer_load_dwordx4 a[64:67], v23, s[8:11], s84 offen offset:0 nt
    buffer_load_dwordx4 a[68:71], v23, s[8:11], s84 offen offset:1024 nt
    s_barrier
    buffer_load_dwordx4 a[72:75], v1, s[8:11], s85 offen offset:0 nt
    buffer_load_dwordx4 a[76:79], v1, s[8:11], s85 offen offset:1024 nt
    buffer_load_dwordx4 a[80:83], v1, s[8:11], s85 offen offset:2048 nt
    buffer_load_dwordx4 a[84:87], v1, s[8:11], s85 offen offset:3072 nt
    buffer_load_dwordx4 a[88:91], v23, s[8:11], s85 offen offset:0 nt
    buffer_load_dwordx4 a[92:95], v23, s[8:11], s85 offen offset:1024 nt
    s_barrier
    s_getreg_b32 s5, hwreg(HW_REG_XCC_ID, 0, 4)
    s_cmp_lg_u32 s72, 0
    s_cbranch_scc1 NOHDR
    s_waitcnt vmcnt(9)
    v_readfirstlane_b32 s96, v98
    s_nop 0
    s_cmp_eq_u32 s96, 0
    s_cbranch_scc1 TAGLOOP
TAGOK:
    v_mov_b32 v99, s5
    s_mov_b64 exec, 1
    buffer_store_dwordx2 v[98:99], v1, s[16:19], s79 offen offset:384 sc1
    s_mov_b64 exec, -1
NOHDR:
    s_waitcnt vmcnt(14)
    ds_write_b128 v2, a[24:27] offset:0
    ds_write_b128 v3, a[28:31] offset:0
    ds_write_b128 v4, a[32:35] offset:0
    ds_write_b128 v2, a[36:39] offset:3328
    ds_write_b128 v3, a[40:43] offset:3328
    ds_write_b128 v4, a[44:47] offset:3328
    ds_read_b128 a[24:27], v5 offset:0
    ds_read_b128 a[28:31], v5 offset:64
    ds_read_b128 a[32:35], v5 offset:128
    ds_read_b128 a[36:39], v5 offset:192
    ds_read_b128 a[40:43], v5 offset:256
    ds_read_b128 a[44:47], v5 offset:320
    buffer_load_dwordx4 a[96:99], v1, s[8:11], s86 offen offset:0 nt
    buffer_load_dwordx4 a[100:103], v1, s[8:11], s86 offen offset:1024 nt
    buffer_load_dwordx4 a[104:107], v1, s[8:11], s86 offen offset:2048 nt
    buffer_load_dwordx4 a[108:111], v1, s[8:11], s86 offen offset:3072 nt
    buffer_load_dwordx4 a[112:115], v23, s[8:11], s86 offen offset:0 nt
    buffer_load_dwordx4 a[116:119], v23, s[8:11], s86 offen offset:1024 nt
    s_barrier
    s_waitcnt vmcnt(12)
    ds_write_b128 v2, a[48:51] offset:0
    ds_write_b128 v3, a[52:55] offset:0
    ds_write_b128 v4, a[56:59] offset:0
    ds_write_b128 v2, a[60:63] offset:3328
    ds_write_b128 v3, a[64:67] offset:3328
    ds_write_b128 v4, a[68:71] offset:3328
    ds_read_b128 a[48:51], v5 offset:0
    ds_read_b128 a[52:55], v5 offset:64
    ds_read_b128 a[56:59], v5 offset:128
    ds_read_b128 a[60:63], v5 offset:192
    ds_read_b128 a[64:67], v5 offset:256
    ds_read_b128 a[68:71], v5 offset:320
    v_lshlrev_b32 v100, 9, v0
    v_add_u32 v100, s3, v100
    v_bfe_u32 v96, v0, 2, 3
    v_mul_u32_u24 v96, 81920, v96
    v_and_b32 v97, 3, v0
    v_lshl_add_u32 v96, v97, 9, v96
    v_cmp_le_u32 vcc, 32, v0
    s_nop 1
    v_cndmask_b32 v100, v100, v96, vcc
    s_cmp_eq_u32 s72, 0
    s_cselect_b32 s77, 0, 1879048176
    v_add_u32 v100, s77, v100
    buffer_load_dwordx4 a[120:123], v1, s[8:11], s87 offen offset:0 nt
    buffer_load_dwordx4 a[124:127], v1, s[8:11], s87 offen offset:1024 nt
    buffer_load_dwordx4 a[128:131], v1, s[8:11], s87 offen offset:2048 nt
    buffer_load_dwordx4 a[132:135], v1, s[8:11], s87 offen offset:3072 nt
    buffer_load_dwordx4 a[136:139], v23, s[8:11], s87 offen offset:0 nt
    buffer_load_dwordx4 a[140:143], v23, s[8:11], s87 offen offset:1024 nt
    s_barrier
    s_waitcnt vmcnt(12)
    ds_write_b128 v2, a[72:75] offset:0
    ds_write_b128 v3, a[76:79] offset:0
    ds_write_b128 v4, a[80:83] offset:0
    ds_write_b128 v2, a[84:87] offset:3328
    ds_write_b128 v3, a[88:91] offset:3328
    ds_write_b128 v4, a[92:95] offset:3328
    ds_read_b128 a[72:75], v5 offset:0
    ds_read_b128 a[76:79], v5 offset:64
    ds_read_b128 a[80:83], v5 offset:128
    ds_read_b128 a[84:87], v5 offset:192
    ds_read_b128 a[88:91], v5 offset:256
    ds_read_b128 a[92:95], v5 offset:320
    buffer_load_dwordx4 a[144:147], v1, s[8:11], s88 offen offset:0 nt
    buffer_load_dwordx4 a[148:151], v1, s[8:11], s88 offen offset:1024 nt
    buffer_load_dwordx4 a[152:155], v1, s[8:11], s88 offen offset:2048 nt
    buffer_load_dwordx4 a[156:159], v1, s[8:11], s88 offen offset:3072 nt
    buffer_load_dwordx4 a[160:163], v23, s[8:11], s88 offen offset:0 nt
    buffer_load_dwordx4 a[164:167], v23, s[8:11], s88 offen offset:1024 nt
    s_barrier
    s_waitcnt vmcnt(12)
    ds_write_b128 v2, a[96:99] offset:0
    ds_write_b128 v3, a[100:103] offset:0
    ds_write_b128 v4, a[104:107] offset:0
    ds_write_b128 v2, a[108:111] offset:3328
    ds_write_b128 v3, a[112:115] offset:3328
    ds_write_b128 v4, a[116:119] offset:3328
    ds_read_b128 a[96:99], v5 offset:0
    ds_read_b128 a[100:103], v5 offset:64
    ds_read_b128 a[104:107], v5 offset:128
    ds_read_b128 a[108:111], v5 offset:192
    ds_read_b128 a[112:115], v5 offset:256
    ds_read_b128 a[116:119], v5 offset:320
    buffer_load_dwordx4 a[168:171], v1, s[8:11], s89 offen offset:0 nt
    buffer_load_dwordx4 a[172:175], v1, s[8:11], s89 offen offset:1024 nt
    buffer_load_dwordx4 a[176:179], v1, s[8:11], s89 offen offset:2048 nt
    buffer_load_dwordx4 a[180:183], v1, s[8:11], s89 offen offset:3072 nt
    buffer_load_dwordx4 a[184:187], v23, s[8:11], s89 offen offset:0 nt
    buffer_load_dwordx4 a[188:191], v23, s[8:11], s89 offen offset:1024 nt
    s_barrier
    s_cmp_ge_u32 s69, 20
    s_cbranch_scc1 DMAF
    s_lshl_b32 s66, s72, 3
    s_add_u32 s66, s66, s68
    s_mul_i32 s66, s66, 245760
    s_lshl_b32 s78, s69, 6
    s_add_u32 s66, s66, s78
    s_mul_i32 s67, s72, 12288
    s_add_u32 s67, s67, 57344
DMAX:
    v_mov_b32 v109, v20
    v_and_b32 v25, 15, v0
    v_lshrrev_b32 v26, 4, v0
    v_add_u32 v27, 4, v26
    s_mul_i32 s7, s68, 10240
    s_add_u32 s7, s7, 737280
    v_mul_u32_u24 v20, 1280, v26
    v_add_u32 v20, s7, v20
    s_mul_i32 s7, s68, 81920
    s_add_u32 s7, s7, 46592
    v_mov_b32 v28, s7
    v_cmp_eq_u32 vcc, s68, v26
    s_nop 1
    v_cndmask_b32 v20, v20, v28, vcc
    s_mul_i32 s7, s68, 10240
    s_add_u32 s7, s7, 737280
    v_mul_u32_u24 v21, 1280, v27
    v_add_u32 v21, s7, v21
    s_mul_i32 s7, s68, 81920
    s_add_u32 s7, s7, 46592
    v_mov_b32 v28, s7
    v_cmp_eq_u32 vcc, s68, v27
    s_nop 1
    v_cndmask_b32 v21, v21, v28, vcc
    s_min_u32 s7, s69, 19
    s_lshl_b32 s7, s7, 6
    v_lshl_add_u32 v25, v25, 2, s7
    v_add_u32 v20, v20, v25
    v_add_u32 v21, v21, v25
    buffer_load_dwordx4 a[216:219], v1, s[12:15], s73 offen offset:0 nt
    v_and_b32 v25, 15, v0
    v_bfe_u32 v27, v0, 2, 2
    v_and_b32 v28, 3, v0
    s_mul_i32 s7, s72, 12288
    s_add_u32 s7, s7, 57344
    v_lshl_add_u32 v29, v26, 3, v27
    v_lshlrev_b32 v29, 6, v29
    v_lshl_add_u32 v29, v28, 3, v29
    v_add_u32 v29, s7, v29
    v_accvgpr_write_b32 a246, v29
    s_mul_i32 s7, s72, 3072
    s_add_u32 s7, s7, 32768
    v_lshl_add_u32 v29, v25, 4, s7
    v_lshl_add_u32 v29, v26, 7, v29
    v_accvgpr_write_b32 a247, v29
    s_lshl_b32 s7, s72, 6
    s_add_u32 s7, s7, 45056
    v_and_b32 v29, 1, v26
    v_lshl_add_u32 v29, v29, 5, s7
    v_accvgpr_write_b32 a248, v29
    s_lshl_b32 s7, s72, 8
    s_add_u32 s7, s7, 122368
    v_lshl_add_u32 v29, v0, 2, s7
    v_accvgpr_write_b32 a249, v29
    s_lshl_b32 s81, s69, 6
    s_mul_i32 s80, s68, 1280
    s_add_u32 s80, s80, s81
    s_add_u32 s80, s80, 655360
    s_add_u32 s81, s81, s3
    s_add_u32 s81, s81, 45312
    s_waitcnt vmcnt(13)
    ds_write_b128 v2, a[120:123] offset:0
    ds_write_b128 v3, a[124:127] offset:0
    ds_write_b128 v4, a[128:131] offset:0
    ds_write_b128 v2, a[132:135] offset:3328
    ds_write_b128 v3, a[136:139] offset:3328
    ds_write_b128 v4, a[140:143] offset:3328
    ds_read_b128 a[120:123], v5 offset:0
    ds_read_b128 a[124:127], v5 offset:64
    ds_read_b128 a[128:131], v5 offset:128
    ds_read_b128 a[132:135], v5 offset:192
    ds_read_b128 a[136:139], v5 offset:256
    ds_read_b128 a[140:143], v5 offset:320
    buffer_load_dwordx4 a[220:223], v1, s[12:15], s73 offen offset:1024 nt
    buffer_load_dwordx4 a[224:227], v1, s[12:15], s73 offen offset:2048 nt
    buffer_load_dwordx4 a[228:231], v1, s[12:15], s73 offen offset:3072 nt
    buffer_load_dwordx4 a[232:235], v23, s[12:15], s73 offen offset:0 nt
    buffer_load_dwordx4 a[236:239], v23, s[12:15], s73 offen offset:1024 nt
    s_barrier
    buffer_load_dwordx2 v[98:99], v100, s[16:19], 0 offen offset:384 sc1
    s_waitcnt vmcnt(13)
    ds_write_b128 v2, a[144:147] offset:0
    ds_write_b128 v3, a[148:151] offset:0
    ds_write_b128 v4, a[152:155] offset:0
    ds_write_b128 v2, a[156:159] offset:3328
    ds_write_b128 v3, a[160:163] offset:3328
    ds_write_b128 v4, a[164:167] offset:3328
    ds_read_b128 a[144:147], v5 offset:0
    ds_read_b128 a[148:151], v5 offset:64
    ds_read_b128 a[152:155], v5 offset:128
    ds_read_b128 a[156:159], v5 offset:192
    ds_read_b128 a[160:163], v5 offset:256
    ds_read_b128 a[164:167], v5 offset:320
    buffer_load_dwordx4 v[112:115], v1, s[12:15], s83 offen offset:0 nt
    buffer_load_dwordx4 v[116:119], v1, s[12:15], s83 offen offset:1024 nt
    buffer_load_dwordx4 v[120:123], v1, s[12:15], s83 offen offset:2048 nt
    buffer_load_dwordx4 v[124:127], v1, s[12:15], s83 offen offset:3072 nt
    buffer_load_dwordx4 v[128:131], v23, s[12:15], s83 offen offset:0 nt
    buffer_load_dwordx4 v[132:135], v23, s[12:15], s83 offen offset:1024 nt
    s_barrier
    s_waitcnt vmcnt(13)
    ds_write_b128 v2, a[168:171] offset:0
    ds_write_b128 v3, a[172:175] offset:0
    ds_write_b128 v4, a[176:179] offset:0
    ds_write_b128 v2, a[180:183] offset:3328
    ds_write_b128 v3, a[184:187] offset:3328
    ds_write_b128 v4, a[188:191] offset:3328
    ds_read_b128 a[168:171], v5 offset:0
    ds_read_b128 a[172:175], v5 offset:64
    ds_read_b128 a[176:179], v5 offset:128
    ds_read_b128 a[180:183], v5 offset:192
    ds_read_b128 a[184:187], v5 offset:256
    ds_read_b128 a[188:191], v5 offset:320
    buffer_load_dwordx4 v[136:139], v1, s[12:15], s84 offen offset:0 nt
    buffer_load_dwordx4 v[140:143], v1, s[12:15], s84 offen offset:1024 nt
    buffer_load_dwordx4 v[144:147], v1, s[12:15], s84 offen offset:2048 nt
    buffer_load_dwordx4 v[148:151], v1, s[12:15], s84 offen offset:3072 nt
    buffer_load_dwordx4 v[152:155], v23, s[12:15], s84 offen offset:0 nt
    buffer_load_dwordx4 v[156:159], v23, s[12:15], s84 offen offset:1024 nt
    s_barrier
    s_waitcnt vmcnt(12)
    s_mov_b32 s76, -1
    v_mov_b32 v97, 125504
    s_cmp_lg_u32 s72, 0
    s_cbranch_scc1 RDYX
    v_cmp_ne_u32 vcc, s96, v98
    s_cbranch_vccnz RDYLOOP
RDYOK:
    v_cmp_ne_u32 vcc, s5, v99
    s_nop 1
    v_mov_b32 v96, vcc_lo
    ds_write_b32 v97, v96
RDYX:
    buffer_load_dwordx4 v[160:163], v1, s[12:15], s85 offen offset:0 nt
    buffer_load_dwordx4 v[164:167], v1, s[12:15], s85 offen offset:1024 nt
    s_waitcnt lgkmcnt(0)
    s_barrier
    ds_read_b32 v96, v97
    s_waitcnt lgkmcnt(0)
    v_readfirstlane_b32 s77, v96
    s_nop 0
    s_cmp_eq_u32 s77, 0
    s_cselect_b32 s10, s18, 0
    s_mov_b32 s8, s16
    s_mov_b32 s9, s17
    s_mov_b32 s11, 0x20000
    buffer_load_dwordx4 a[240:243], v109, s[16:19], 0 offen sc1
    s_mul_i32 s77, s69, 464
    s_add_u32 s77, s77, s3
    s_add_u32 s77, s77, 49152
    s_cmp_eq_u32 s72, 3
    s_cselect_b32 s77, s77, 1879048176
    v_add_u32 v106, s77, v1
    v_mov_b32 v107, 2147483632
    v_cmp_le_u32 vcc, 29, v0
    s_nop 1
    v_cndmask_b32 v106, v106, v107, vcc
    buffer_load_dwordx4 a[240:243], v106, s[16:19], 0 offen sc1
    s_lshl_b32 s77, s69, 2
    s_add_u32 s77, s77, s72
    s_lshl_b32 s78, s77, 8
    s_add_u32 s78, s78, 819200
    s_lshl_b32 s77, s77, 9
    s_sub_u32 s77, s77, 256
    v_lshlrev_b32 v24, 7, v0
    v_add_u32 v25, s77, v24
    v_min_u32 v25, 57472, v25
    v_add_u32 v24, s78, v24
    v_cmp_gt_u32 vcc, 2, v0
    s_nop 1
    v_cndmask_b32 v24, v25, v24, vcc
    s_add_u32 s77, s3, 819200
    s_mov_b64 exec, 63
    buffer_load_dword a243, v24, s[16:19], s77 offen sc1
    s_mov_b64 exec, -1
    s_lshl_b32 s77, s70, 12
    s_mul_i32 s78, s72, 96
    s_add_u32 s77, s77, s78
    s_add_u32 s77, s77, s3
    v_lshrrev_b32 v24, 4, v0
    v_lshlrev_b32 v24, 9, v24
    v_and_b32 v25, 15, v0
    v_min_u32 v25, 11, v25
    v_lshl_add_u32 v24, v25, 3, v24
    buffer_load_dwordx2 v[64:65], v24, s[16:19], s77 offen offset:0 sc1
    buffer_load_dwordx2 v[66:67], v24, s[16:19], s77 offen offset:2048 sc1
    s_cmp_lg_u32 s72, 1
    s_cbranch_scc1 NOBASE0
    s_cmp_ge_u32 s69, 20
    s_cbranch_scc1 NOBASE0
    v_mov_b32 v28, v22
    s_lshl_b32 s77, s69, 6
    s_add_u32 s77, s77, s3
    s_add_u32 s77, s77, 47872
    v_lshlrev_b32 v27, 2, v0
    v_mov_b32_dpp v29, v28 quad_perm:[1,1,1,1] row_mask:0xf bank_mask:0xf
    v_mov_b32_dpp v30, v28 quad_perm:[2,2,2,2] row_mask:0xf bank_mask:0xf
    v_mov_b32_dpp v31, v28 quad_perm:[3,3,3,3] row_mask:0xf bank_mask:0xf
    s_mov_b32 exec_lo, 0x1111
    s_mov_b32 exec_hi, 0x0
    buffer_store_dwordx4 v[28:31], v27, s[8:11], s77 offen
    s_cmp_eq_u32 s10, 0
    s_cbranch_scc1 SLOW1
BACK1:
    s_mov_b64 exec, -1
NOBASE0:
    ds_write_b128 v2, a[216:219] offset:0
    ds_write_b128 v3, a[220:223] offset:0
    ds_write_b128 v4, a[224:227] offset:0
    ds_write_b128 v2, a[228:231] offset:3328
    ds_write_b128 v3, a[232:235] offset:3328
    ds_write_b128 v4, a[236:239] offset:3328
    ds_read_b64_tr_b16 a[192:193], v6 offset:0
    ds_read_b64_tr_b16 a[196:197], v6 offset:32
    ds_read_b64_tr_b16 a[200:201], v6 offset:64
    ds_read_b64_tr_b16 a[204:205], v6 offset:96
    ds_read_b64_tr_b16 a[208:209], v6 offset:128
    ds_read_b64_tr_b16 a[212:213], v6 offset:160
    ds_read_b64_tr_b16 a[216:217], v6 offset:192
    ds_read_b64_tr_b16 a[220:221], v6 offset:224
    ds_read_b64_tr_b16 a[224:225], v6 offset:256
    ds_read_b64_tr_b16 a[228:229], v6 offset:288
    ds_read_b64_tr_b16 a[232:233], v6 offset:320
    ds_read_b64_tr_b16 a[236:237], v6 offset:352
    s_waitcnt vmcnt(13)
    ds_write_b128 v2, v[112:115] offset:0
    ds_write_b128 v3, v[116:119] offset:0
    ds_write_b128 v4, v[120:123] offset:0
    ds_write_b128 v2, v[124:127] offset:3328
    ds_write_b128 v3, v[128:131] offset:3328
    ds_write_b128 v4, v[132:135] offset:3328
    ds_read_b64_tr_b16 a[194:195], v6 offset:0
    ds_read_b64_tr_b16 a[198:199], v6 offset:32
    ds_read_b64_tr_b16 a[202:203], v6 offset:64
    ds_read_b64_tr_b16 a[206:207], v6 offset:96
    ds_read_b64_tr_b16 a[210:211], v6 offset:128
    ds_read_b64_tr_b16 a[214:215], v6 offset:160
    ds_read_b64_tr_b16 a[218:219], v6 offset:192
    ds_read_b64_tr_b16 a[222:223], v6 offset:224
    ds_read_b64_tr_b16 a[226:227], v6 offset:256
    ds_read_b64_tr_b16 a[230:231], v6 offset:288
    ds_read_b64_tr_b16 a[234:235], v6 offset:320
    ds_read_b64_tr_b16 a[238:239], v6 offset:352
    buffer_load_dwordx4 v[168:171], v1, s[12:15], s85 offen offset:2048 nt
    buffer_load_dwordx4 v[172:175], v1, s[12:15], s85 offen offset:3072 nt
    buffer_load_dwordx4 v[176:179], v23, s[12:15], s85 offen offset:0 nt
    buffer_load_dwordx4 v[180:183], v23, s[12:15], s85 offen offset:1024 nt
    s_barrier
    buffer_load_dwordx4 v[184:187], v1, s[12:15], s86 offen offset:0 nt
    s_waitcnt vmcnt(12)
    ds_write_b128 v2, v[136:139] offset:0
    ds_write_b128 v3, v[140:143] offset:0
    ds_write_b128 v4, v[144:147] offset:0
    ds_write_b128 v2, v[148:151] offset:3328
    ds_write_b128 v3, v[152:155] offset:3328
    ds_write_b128 v4, v[156:159] offset:3328
    ds_read_b64_tr_b16 v[112:113], v6 offset:0
    ds_read_b64_tr_b16 v[116:117], v6 offset:32
    ds_read_b64_tr_b16 v[120:121], v6 offset:64
    ds_read_b64_tr_b16 v[124:125], v6 offset:96
    ds_read_b64_tr_b16 v[128:129], v6 offset:128
    ds_read_b64_tr_b16 v[132:133], v6 offset:160
    ds_read_b64_tr_b16 v[136:137], v6 offset:192
    ds_read_b64_tr_b16 v[140:141], v6 offset:224
    ds_read_b64_tr_b16 v[144:145], v6 offset:256
    ds_read_b64_tr_b16 v[148:149], v6 offset:288
    ds_read_b64_tr_b16 v[152:153], v6 offset:320
    ds_read_b64_tr_b16 v[156:157], v6 offset:352
    buffer_load_dwordx4 v[188:191], v1, s[12:15], s86 offen offset:1024 nt
    buffer_load_dwordx4 v[192:195], v1, s[12:15], s86 offen offset:2048 nt
    buffer_load_dwordx4 v[196:199], v1, s[12:15], s86 offen offset:3072 nt
    buffer_load_dwordx4 v[200:203], v23, s[12:15], s86 offen offset:0 nt
    buffer_load_dwordx4 v[204:207], v23, s[12:15], s86 offen offset:1024 nt
    s_barrier
    buffer_load_dwordx4 v[208:211], v1, s[12:15], s87 offen offset:0 nt
    buffer_load_dwordx4 v[212:215], v1, s[12:15], s87 offen offset:1024 nt
    s_waitcnt vmcnt(12)
    v_lshlrev_b32 v24, 16, v64
    v_and_b32 v25, 0xffff0000, v64
    v_lshlrev_b32 v26, 16, v65
    v_and_b32 v27, 0xffff0000, v65
    v_lshlrev_b32 v28, 16, v66
    v_and_b32 v29, 0xffff0000, v66
    v_lshlrev_b32 v30, 16, v67
    v_and_b32 v31, 0xffff0000, v67
    v_add_f32 v24, v24, v28
    v_add_f32 v25, v25, v29
    v_add_f32 v26, v26, v30
    v_add_f32 v27, v27, v31
    s_nop 0
    v_permlane32_swap_b32 v24, v26
    v_permlane32_swap_b32 v25, v27
    v_add_f32 v24, v24, v26
    v_add_f32 v25, v25, v27
    s_nop 1
    v_permlane16_swap_b32 v24, v25
    v_add_f32 v24, v24, v25
    v_cvt_pk_bf16_f32 v24, v24, v24
    ds_write_b16 v12, v24
    buffer_load_dwordx4 v[216:219], v1, s[12:15], s87 offen offset:2048 nt
    v_mov_b32 v40, 0
    v_mov_b32 v41, 0
    v_mov_b32 v44, 0
    v_mov_b32 v45, 0
    v_mov_b32 v48, 0
    v_mov_b32 v49, 0
    v_mov_b32 v52, 0
    v_mov_b32 v53, 0
    v_mov_b32 v56, 0
    v_mov_b32 v57, 0
    v_mov_b32 v60, 0
    v_mov_b32 v61, 0
    v_mov_b32 v64, 0
    v_mov_b32 v65, 0
    v_mov_b32 v68, 0
    v_mov_b32 v69, 0
    v_mov_b32 v72, 0
    v_mov_b32 v73, 0
    v_mov_b32 v74, 0
    v_mov_b32 v75, 0
    v_mov_b32 v76, 0
    v_mov_b32 v77, 0
    v_mov_b32 v78, 0
    v_mov_b32 v79, 0
    v_mov_b32 v80, 0
    v_mov_b32 v81, 0
    v_mov_b32 v82, 0
    v_mov_b32 v83, 0
    v_mov_b32 v84, 0
    v_mov_b32 v85, 0
    v_mov_b32 v86, 0
    v_mov_b32 v87, 0
    buffer_load_dwordx4 v[220:223], v1, s[12:15], s87 offen offset:3072 nt
    buffer_load_dwordx4 v[224:227], v23, s[12:15], s87 offen offset:0 nt
    s_waitcnt lgkmcnt(0)
    s_barrier
    ds_read_b128 v[28:31], v13 offset:0
    ds_read_b128 v[32:35], v13 offset:128
    ds_read_b128 v[36:39], v13 offset:256
    v_mov_b32 v18, 0x3dd53b94
    s_waitcnt lgkmcnt(2)
    v_smfmac_f32_16x16x64_bf16 v[40:43], v[28:31], a[0:7], v14
    v_smfmac_f32_16x16x64_bf16 v[44:47], v[28:31], a[24:31], v14
    v_smfmac_f32_16x16x64_bf16 v[48:51], v[28:31], a[48:55], v14
    v_smfmac_f32_16x16x64_bf16 v[52:55], v[28:31], a[72:79], v14
    v_smfmac_f32_16x16x64_bf16 v[56:59], v[28:31], a[96:103], v14
    v_smfmac_f32_16x16x64_bf16 v[60:63], v[28:31], a[120:127], v14
    v_smfmac_f32_16x16x64_bf16 v[64:67], v[28:31], a[144:151], v14
    v_smfmac_f32_16x16x64_bf16 v[68:71], v[28:31], a[168:175], v14
    buffer_load_dwordx4 v[228:231], v23, s[12:15], s87 offen offset:1024 nt
    s_barrier
    s_waitcnt lgkmcnt(1)
    v_smfmac_f32_16x16x64_bf16 v[40:43], v[32:35], a[8:15], v14
    v_smfmac_f32_16x16x64_bf16 v[44:47], v[32:35], a[32:39], v14
    v_smfmac_f32_16x16x64_bf16 v[48:51], v[32:35], a[56:63], v14
    v_smfmac_f32_16x16x64_bf16 v[52:55], v[32:35], a[80:87], v14
    v_smfmac_f32_16x16x64_bf16 v[56:59], v[32:35], a[104:111], v14
    v_smfmac_f32_16x16x64_bf16 v[60:63], v[32:35], a[128:135], v14
    v_smfmac_f32_16x16x64_bf16 v[64:67], v[32:35], a[152:159], v14
    v_smfmac_f32_16x16x64_bf16 v[68:71], v[32:35], a[176:183], v14
    s_waitcnt lgkmcnt(0)
    v_smfmac_f32_16x16x64_bf16 v[40:43], v[36:39], a[16:23], v14
    v_smfmac_f32_16x16x64_bf16 v[44:47], v[36:39], a[40:47], v14
    v_smfmac_f32_16x16x64_bf16 v[48:51], v[36:39], a[64:71], v14
    v_smfmac_f32_16x16x64_bf16 v[52:55], v[36:39], a[88:95], v14
    v_smfmac_f32_16x16x64_bf16 v[56:59], v[36:39], a[112:119], v14
    v_smfmac_f32_16x16x64_bf16 v[60:63], v[36:39], a[136:143], v14
    v_smfmac_f32_16x16x64_bf16 v[64:67], v[36:39], a[160:167], v14
    v_smfmac_f32_16x16x64_bf16 v[68:71], v[36:39], a[184:191], v14
    buffer_load_dwordx4 v[232:235], v1, s[12:15], s88 offen offset:0 nt
    v_add_f32 v24, v40, v41
    v_add_f32 v44, v44, v45
    v_add_f32 v48, v48, v49
    v_max3_f32 v26, v24, v44, v48
    v_add_f32 v52, v52, v53
    v_add_f32 v25, v56, v57
    v_max3_f32 v26, v26, v52, v25
    v_add_f32 v60, v60, v61
    v_add_f32 v64, v64, v65
    v_max3_f32 v26, v26, v60, v64
    v_add_f32 v68, v68, v69
    v_max_f32 v26, v26, v68
    v_mov_b32_dpp v24, v44 quad_perm:[0,1,2,3] row_mask:0x2 bank_mask:0xf
    v_mov_b32_dpp v25, v60 quad_perm:[0,1,2,3] row_mask:0x2 bank_mask:0xf
    v_max_f32_dpp v26, v26, v26 row_ror:8 row_mask:0xf bank_mask:0xf
    v_mov_b32_dpp v24, v48 quad_perm:[0,1,2,3] row_mask:0x4 bank_mask:0xf
    v_mov_b32_dpp v25, v64 quad_perm:[0,1,2,3] row_mask:0x4 bank_mask:0xf
    v_max_f32_dpp v26, v26, v26 row_ror:4 row_mask:0xf bank_mask:0xf
    v_mov_b32_dpp v24, v52 quad_perm:[0,1,2,3] row_mask:0x8 bank_mask:0xf
    v_mov_b32_dpp v25, v68 quad_perm:[0,1,2,3] row_mask:0x8 bank_mask:0xf
    v_max_f32_dpp v26, v26, v26 row_ror:2 row_mask:0xf bank_mask:0xf
    v_accvgpr_read_b32 v27, a252
    s_nop 0
    v_max_f32_dpp v26, v26, v26 row_ror:1 row_mask:0xf bank_mask:0xf
    buffer_load_dwordx4 v[236:239], v1, s[12:15], s88 offen offset:1024 nt
    v_mul_f32 v26, v26, v18
    v_fma_f32 v24, v24, v18, -v26
    v_fma_f32 v25, v25, v18, -v26
    v_exp_f32 v24, v24
    v_exp_f32 v25, v25
    s_nop 0
    v_cvt_pk_bf16_f32 v28, v24, v25
    ds_write_b16 v19, v28
    ds_write_b16_d16_hi v19, v28 offset:128
    s_mov_b32 exec_lo, 0xff00ff
    s_mov_b32 exec_hi, 0xff00ff00
    ds_read_b128 v[72:75], v27 offset:0
    ds_read_b128 v[76:79], v27 offset:64
    ds_read_b128 v[80:83], v27 offset:128
    ds_read_b128 v[84:87], v27 offset:192
    s_mov_b64 exec, -1
    v_add_f32 v27, v24, v25
    v_mov_b32 v40, 0
    v_mov_b32 v44, 0
    v_add_f32_dpp v27, v27, v27 row_ror:8 row_mask:0xf bank_mask:0xf
    v_mov_b32 v48, 0
    v_mov_b32 v52, 0
    v_add_f32_dpp v27, v27, v27 row_ror:4 row_mask:0xf bank_mask:0xf
    v_mov_b32 v56, 0
    v_mov_b32 v60, 0
    v_add_f32_dpp v27, v27, v27 row_ror:2 row_mask:0xf bank_mask:0xf
    s_lshl_b32 s78, s72, 3
    s_add_u32 s78, s78, 125440
    v_add_f32_dpp v27, v27, v27 row_ror:1 row_mask:0xf bank_mask:0xf
    v_mov_b32 v28, v27
    s_nop 1
    v_permlane32_swap_b32 v27, v28
    v_add_f32 v27, v27, v28
    v_mov_b32 v28, v27
    s_nop 1
    v_permlane16_swap_b32 v27, v28
    v_add_f32 v27, v27, v28
    v_mov_b32 v28, s78
    ds_write_b64 v28, v[26:27]
    s_waitcnt vmcnt(14)
    ds_write_b128 v2, v[160:163] offset:0
    ds_write_b128 v3, v[164:167] offset:0
    ds_write_b128 v4, v[168:171] offset:0
    ds_write_b128 v2, v[172:175] offset:3328
    ds_write_b128 v3, v[176:179] offset:3328
    ds_write_b128 v4, v[180:183] offset:3328
    ds_read_b64_tr_b16 v[114:115], v6 offset:0
    ds_read_b64_tr_b16 v[118:119], v6 offset:32
    ds_read_b64_tr_b16 v[122:123], v6 offset:64
    ds_read_b64_tr_b16 v[126:127], v6 offset:96
    ds_read_b64_tr_b16 v[130:131], v6 offset:128
    ds_read_b64_tr_b16 v[134:135], v6 offset:160
    ds_read_b64_tr_b16 v[138:139], v6 offset:192
    ds_read_b64_tr_b16 v[142:143], v6 offset:224
    ds_read_b64_tr_b16 v[146:147], v6 offset:256
    ds_read_b64_tr_b16 v[150:151], v6 offset:288
    ds_read_b64_tr_b16 v[154:155], v6 offset:320
    ds_read_b64_tr_b16 v[158:159], v6 offset:352
    buffer_load_dwordx4 v[240:243], v1, s[12:15], s88 offen offset:2048 nt
    buffer_load_dwordx4 v[244:247], v1, s[12:15], s88 offen offset:3072 nt
    s_waitcnt lgkmcnt(0)
    v_smfmac_f32_16x16x64_bf16 v[40:43], v[72:75], a[192:199], v14 abid:1
    v_smfmac_f32_16x16x64_bf16 v[44:47], v[72:75], a[200:207], v14 abid:1
    v_smfmac_f32_16x16x64_bf16 v[48:51], v[72:75], a[208:215], v14 abid:1
    v_smfmac_f32_16x16x64_bf16 v[52:55], v[72:75], a[216:223], v14 abid:1
    v_smfmac_f32_16x16x64_bf16 v[56:59], v[72:75], a[224:231], v14 abid:1
    v_smfmac_f32_16x16x64_bf16 v[60:63], v[72:75], a[232:239], v14 abid:1
    buffer_load_dwordx4 v[248:251], v23, s[12:15], s88 offen offset:0 nt
    v_smfmac_f32_16x16x64_bf16 v[40:43], v[76:79], v[112:119], v14 abid:1
    v_smfmac_f32_16x16x64_bf16 v[44:47], v[76:79], v[120:127], v14 abid:1
    v_smfmac_f32_16x16x64_bf16 v[48:51], v[76:79], v[128:135], v14 abid:1
    v_smfmac_f32_16x16x64_bf16 v[52:55], v[76:79], v[136:143], v14 abid:1
    v_smfmac_f32_16x16x64_bf16 v[56:59], v[76:79], v[144:151], v14 abid:1
    v_smfmac_f32_16x16x64_bf16 v[60:63], v[76:79], v[152:159], v14 abid:1
    buffer_load_dwordx4 v[252:255], v23, s[12:15], s88 offen offset:1024 nt
    s_barrier
    s_waitcnt vmcnt(12)
    ds_write_b128 v2, v[184:187] offset:0
    ds_write_b128 v3, v[188:191] offset:0
    ds_write_b128 v4, v[192:195] offset:0
    ds_write_b128 v2, v[196:199] offset:3328
    ds_write_b128 v3, v[200:203] offset:3328
    ds_write_b128 v4, v[204:207] offset:3328
    ds_read_b64_tr_b16 v[160:161], v6 offset:0
    ds_read_b64_tr_b16 v[164:165], v6 offset:32
    ds_read_b64_tr_b16 v[168:169], v6 offset:64
    ds_read_b64_tr_b16 v[172:173], v6 offset:96
    ds_read_b64_tr_b16 v[176:177], v6 offset:128
    ds_read_b64_tr_b16 v[180:181], v6 offset:160
    ds_read_b64_tr_b16 v[184:185], v6 offset:192
    ds_read_b64_tr_b16 v[188:189], v6 offset:224
    ds_read_b64_tr_b16 v[192:193], v6 offset:256
    ds_read_b64_tr_b16 v[196:197], v6 offset:288
    ds_read_b64_tr_b16 v[200:201], v6 offset:320
    ds_read_b64_tr_b16 v[204:205], v6 offset:352
    v_mov_b32 v24, -1
    v_mov_b32 v25, -1
    v_mov_b32 v26, -1
    v_mov_b32 v27, -1
    buffer_store_dwordx4 v[24:27], v106, s[8:11], 0 offen
    s_cmp_eq_u32 s10, 0
    s_cbranch_scc1 SLOW2
BACK2:
    buffer_load_dwordx4 v[88:91], v1, s[12:15], s89 offen offset:0 nt
    buffer_load_dwordx4 v[92:95], v1, s[12:15], s89 offen offset:1024 nt
    buffer_load_dwordx4 v[96:99], v1, s[12:15], s89 offen offset:2048 nt
    buffer_load_dwordx4 v[100:103], v1, s[12:15], s89 offen offset:3072 nt
    buffer_load_dwordx4 v[104:107], v23, s[12:15], s89 offen offset:0 nt
    buffer_load_dwordx4 v[108:111], v23, s[12:15], s89 offen offset:1024 nt
    s_waitcnt vmcnt(13)
    ds_write_b128 v2, v[208:211] offset:0
    ds_write_b128 v3, v[212:215] offset:0
    ds_write_b128 v4, v[216:219] offset:0
    ds_write_b128 v2, v[220:223] offset:3328
    ds_write_b128 v3, v[224:227] offset:3328
    ds_write_b128 v4, v[228:231] offset:3328
    ds_read_b64_tr_b16 v[162:163], v6 offset:0
    ds_read_b64_tr_b16 v[166:167], v6 offset:32
    ds_read_b64_tr_b16 v[170:171], v6 offset:64
    ds_read_b64_tr_b16 v[174:175], v6 offset:96
    ds_read_b64_tr_b16 v[178:179], v6 offset:128
    ds_read_b64_tr_b16 v[182:183], v6 offset:160
    ds_read_b64_tr_b16 v[186:187], v6 offset:192
    ds_read_b64_tr_b16 v[190:191], v6 offset:224
    ds_read_b64_tr_b16 v[194:195], v6 offset:256
    ds_read_b64_tr_b16 v[198:199], v6 offset:288
    ds_read_b64_tr_b16 v[202:203], v6 offset:320
    ds_read_b64_tr_b16 v[206:207], v6 offset:352
    v_and_b32 v23, 0xffff0000, v22
    v_lshlrev_b32 v22, 16, v22
    s_mov_b32 s82, 0x1010101
    s_mov_b32 s83, 0x1010101
    s_mov_b32 s84, 0x1ff01ff
    s_mov_b32 s85, 0x1ff01ff
    s_mov_b32 s86, 0xffffffff
    s_mov_b32 s87, 0x1fff
    s_mov_b32 s50, 0x7fffff
    s_mov_b32 s51, 0x0
    s_mov_b32 s88, 0xff00ff
    s_mov_b32 s89, 0xff00ff00
    s_mov_b32 s92, 0x1010101
    s_mov_b32 s93, 0x0
    s_mov_b32 s44, 0xf0f0f0f
    s_mov_b32 s45, 0xf0f0f0f
    s_mov_b64 s[46:47], s[92:93]
    s_mov_b64 s[48:49], s[44:45]
    s_cmp_ge_u32 s69, 20
    s_cbranch_scc1 TAILF
    v_mov_b32 v24, -1
    v_mov_b32 v25, -1
    v_mov_b32 v26, -1
    v_mov_b32 v27, -1
    v_and_b32 v28, 3, v0
    v_lshrrev_b32 v29, 5, v0
    v_lshl_add_u32 v28, v29, 2, v28
    v_mul_u32_u24 v28, 10240, v28
    v_bfe_u32 v29, v0, 3, 2
    v_lshl_add_u32 v28, v29, 4, v28
    s_cmp_eq_u32 s72, 3
    s_cselect_b32 s77, 0, 1879048176
    v_add_u32 v28, s77, v28
    s_add_u32 s77, s80, 81920
    s_mov_b64 exec, s[44:45]
    buffer_store_dwordx4 v[24:27], v28, s[16:19], s77 offen sc1
    s_mov_b64 exec, -1
    v_lshrrev_b32 v38, 2, v0
    v_mul_u32_u24 v38, 1280, v38
    v_and_b32 v39, 3, v0
    v_lshl_add_u32 v39, v39, 4, v38
    s_mov_b32 m0, s67
    s_add_u32 s67, s67, 1024
    buffer_load_dwordx4 v39, s[24:27], s66 offen  lds
    s_add_u32 s66, s66, 20480
    s_mov_b32 m0, s67
    s_add_u32 s67, s67, 1024
    buffer_load_dwordx4 v39, s[24:27], s66 offen  lds
    s_add_u32 s66, s66, 20480
    s_mov_b32 m0, s67
    s_add_u32 s67, s67, 1024
    buffer_load_dwordx4 v39, s[24:27], s66 offen  lds
    s_add_u32 s66, s66, 20480
    s_waitcnt lgkmcnt(0)
    v_smfmac_f32_16x16x64_bf16 v[40:43], v[80:83], v[160:167], v14 abid:1
    v_smfmac_f32_16x16x64_bf16 v[44:47], v[80:83], v[168:175], v14 abid:1
    v_smfmac_f32_16x16x64_bf16 v[48:51], v[80:83], v[176:183], v14 abid:1
    v_smfmac_f32_16x16x64_bf16 v[52:55], v[80:83], v[184:191], v14 abid:1
    v_smfmac_f32_16x16x64_bf16 v[56:59], v[80:83], v[192:199], v14 abid:1
    v_smfmac_f32_16x16x64_bf16 v[60:63], v[80:83], v[200:207], v14 abid:1
    s_waitcnt vmcnt(11)
    ds_write_b128 v2, v[232:235] offset:0
    ds_write_b128 v3, v[236:239] offset:0
    ds_write_b128 v4, v[240:243] offset:0
    ds_write_b128 v2, v[244:247] offset:3328
    ds_write_b128 v3, v[248:251] offset:3328
    ds_write_b128 v4, v[252:255] offset:3328
    ds_read_b64_tr_b16 v[208:209], v6 offset:0
    ds_read_b64_tr_b16 v[212:213], v6 offset:32
    ds_read_b64_tr_b16 v[216:217], v6 offset:64
    ds_read_b64_tr_b16 v[220:221], v6 offset:96
    ds_read_b64_tr_b16 v[224:225], v6 offset:128
    ds_read_b64_tr_b16 v[228:229], v6 offset:160
    ds_read_b64_tr_b16 v[232:233], v6 offset:192
    ds_read_b64_tr_b16 v[236:237], v6 offset:224
    ds_read_b64_tr_b16 v[240:241], v6 offset:256
    ds_read_b64_tr_b16 v[244:245], v6 offset:288
    ds_read_b64_tr_b16 v[248:249], v6 offset:320
    ds_read_b64_tr_b16 v[252:253], v6 offset:352
    s_mov_b32 m0, s67
    s_add_u32 s67, s67, 1024
    buffer_load_dwordx4 v39, s[24:27], s66 offen  lds
    s_add_u32 s66, s66, 20480
    s_mov_b32 m0, s67
    s_add_u32 s67, s67, 1024
    buffer_load_dwordx4 v39, s[24:27], s66 offen  lds
    s_add_u32 s66, s66, 20480
    s_mov_b32 m0, s67
    s_add_u32 s67, s67, 1024
    buffer_load_dwordx4 v39, s[24:27], s66 offen  lds
    s_add_u32 s66, s66, 20480
    s_waitcnt vmcnt(12)
    ds_write_b128 v2, v[88:91] offset:0
    s_waitcnt vmcnt(11)
    ds_write_b128 v3, v[92:95] offset:0
    s_waitcnt vmcnt(10)
    ds_write_b128 v4, v[96:99] offset:0
    s_waitcnt vmcnt(9)
    ds_write_b128 v2, v[100:103] offset:3328
    s_waitcnt vmcnt(8)
    ds_write_b128 v3, v[104:107] offset:3328
    s_waitcnt vmcnt(7)
    ds_write_b128 v4, v[108:111] offset:3328
    ds_read_b64_tr_b16 v[210:211], v6 offset:0
    ds_read_b64_tr_b16 v[214:215], v6 offset:32
    ds_read_b64_tr_b16 v[218:219], v6 offset:64
    ds_read_b64_tr_b16 v[222:223], v6 offset:96
    ds_read_b64_tr_b16 v[226:227], v6 offset:128
    ds_read_b64_tr_b16 v[230:231], v6 offset:160
    ds_read_b64_tr_b16 v[234:235], v6 offset:192
    ds_read_b64_tr_b16 v[238:239], v6 offset:224
    ds_read_b64_tr_b16 v[242:243], v6 offset:256
    ds_read_b64_tr_b16 v[246:247], v6 offset:288
    ds_read_b64_tr_b16 v[250:251], v6 offset:320
    ds_read_b64_tr_b16 v[254:255], v6 offset:352
    s_branch ATT_LAST
TAILF:
    s_lshl_b32 s90, s72, 3
    s_add_u32 s90, s90, s68
    s_mul_i32 s90, s90, 24
    s_add_u32 s90, s90, s69
    s_sub_u32 s90, s90, 8
    s_mul_i32 s90, s90, 10240
    buffer_load_dwordx4 a[240:243], v1, s[20:23], s90 offen offset:0
    buffer_load_dwordx4 a[240:243], v1, s[20:23], s90 offen offset:1024
    buffer_load_dwordx4 a[240:243], v1, s[20:23], s90 offen offset:2048
    buffer_load_dwordx4 a[240:243], v1, s[20:23], s90 offen offset:3072
    s_add_u32 s90, s90, 4096
    buffer_load_dwordx4 a[240:243], v1, s[20:23], s90 offen offset:0
    buffer_load_dwordx4 a[240:243], v1, s[20:23], s90 offen offset:1024
    buffer_load_dwordx4 a[240:243], v1, s[20:23], s90 offen offset:2048
    v_lshrrev_b32 v38, 3, v0
    v_mul_u32_u24 v38, 3072, v38
    v_and_b32 v39, 7, v0
    v_lshl_add_u32 v38, v39, 4, v38
    v_bfe_u32 v39, v0, 4, 1
    v_lshlrev_b32 v39, 5, v39
    v_xor_b32 v38, v38, v39
    v_xor_b32 v39, 64, v38
    s_waitcnt lgkmcnt(0)
    v_smfmac_f32_16x16x64_bf16 v[40:43], v[80:83], v[160:167], v14 abid:1
    v_smfmac_f32_16x16x64_bf16 v[44:47], v[80:83], v[168:175], v14 abid:1
    v_smfmac_f32_16x16x64_bf16 v[48:51], v[80:83], v[176:183], v14 abid:1
    v_smfmac_f32_16x16x64_bf16 v[52:55], v[80:83], v[184:191], v14 abid:1
    v_smfmac_f32_16x16x64_bf16 v[56:59], v[80:83], v[192:199], v14 abid:1
    v_smfmac_f32_16x16x64_bf16 v[60:63], v[80:83], v[200:207], v14 abid:1
    s_waitcnt vmcnt(14)
    ds_write_b128 v2, v[232:235] offset:0
    ds_write_b128 v3, v[236:239] offset:0
    ds_write_b128 v4, v[240:243] offset:0
    ds_write_b128 v2, v[244:247] offset:3328
    ds_write_b128 v3, v[248:251] offset:3328
    ds_write_b128 v4, v[252:255] offset:3328
    ds_read_b64_tr_b16 v[208:209], v6 offset:0
    ds_read_b64_tr_b16 v[212:213], v6 offset:32
    ds_read_b64_tr_b16 v[216:217], v6 offset:64
    ds_read_b64_tr_b16 v[220:221], v6 offset:96
    ds_read_b64_tr_b16 v[224:225], v6 offset:128
    ds_read_b64_tr_b16 v[228:229], v6 offset:160
    ds_read_b64_tr_b16 v[232:233], v6 offset:192
    ds_read_b64_tr_b16 v[236:237], v6 offset:224
    ds_read_b64_tr_b16 v[240:241], v6 offset:256
    ds_read_b64_tr_b16 v[244:245], v6 offset:288
    ds_read_b64_tr_b16 v[248:249], v6 offset:320
    ds_read_b64_tr_b16 v[252:253], v6 offset:352
    buffer_load_dwordx4 a[240:243], v1, s[20:23], s90 offen offset:3072
    s_add_u32 s90, s90, 4096
    buffer_load_dwordx4 a[240:243], v1, s[20:23], s90 offen offset:0
    buffer_load_dwordx4 a[240:243], v1, s[20:23], s90 offen offset:1024
    s_waitcnt vmcnt(15)
    ds_write_b128 v2, v[88:91] offset:0
    s_waitcnt vmcnt(14)
    ds_write_b128 v3, v[92:95] offset:0
    s_waitcnt vmcnt(13)
    ds_write_b128 v4, v[96:99] offset:0
    s_waitcnt vmcnt(12)
    ds_write_b128 v2, v[100:103] offset:3328
    s_waitcnt vmcnt(11)
    ds_write_b128 v3, v[104:107] offset:3328
    s_waitcnt vmcnt(10)
    ds_write_b128 v4, v[108:111] offset:3328
    ds_read_b64_tr_b16 v[210:211], v6 offset:0
    ds_read_b64_tr_b16 v[214:215], v6 offset:32
    ds_read_b64_tr_b16 v[218:219], v6 offset:64
    ds_read_b64_tr_b16 v[222:223], v6 offset:96
    ds_read_b64_tr_b16 v[226:227], v6 offset:128
    ds_read_b64_tr_b16 v[230:231], v6 offset:160
    ds_read_b64_tr_b16 v[234:235], v6 offset:192
    ds_read_b64_tr_b16 v[238:239], v6 offset:224
    ds_read_b64_tr_b16 v[242:243], v6 offset:256
    ds_read_b64_tr_b16 v[246:247], v6 offset:288
    ds_read_b64_tr_b16 v[250:251], v6 offset:320
    ds_read_b64_tr_b16 v[254:255], v6 offset:352
    s_mov_b32 m0, s67
    s_add_u32 s67, s67, 1024
    buffer_load_dwordx4 v38, s[36:39], s66 offen nt lds
    s_add_u32 s66, s66, 24576
    s_mov_b32 m0, s67
    s_add_u32 s67, s67, 1024
    buffer_load_dwordx4 v39, s[36:39], s66 offen nt lds
    s_add_u32 s66, s66, 24576
    s_mov_b32 m0, s67
    s_add_u32 s67, s67, 1024
    buffer_load_dwordx4 v38, s[36:39], s66 offen nt lds
    s_add_u32 s66, s66, 24576
    s_branch ATT_LAST
LOOP:
    s_cmp_lt_u32 s69, 20
    s_cselect_b32 s5, s72, 4
    s_add_u32 s96, s3, 819200
    s_add_u32 s97, s96, 4096
    s_and_b32 s77, s5, 3
    s_cbranch_scc1 LOOP2
    ds_read_b64_tr_b16 v[40:41], v16 offset:0
    ds_read_b64_tr_b16 v[42:43], v16 offset:1536
    ds_read_b64_tr_b16 v[44:45], v16 offset:12288
    ds_read_b64_tr_b16 v[46:47], v16 offset:13824
    ds_read_b64_tr_b16 v[48:49], v17 offset:24576
    ds_read_b64_tr_b16 v[50:51], v16 offset:32
    ds_read_b64_tr_b16 v[52:53], v16 offset:1568
    ds_read_b64_tr_b16 v[54:55], v16 offset:12320
    ds_read_b64_tr_b16 v[56:57], v16 offset:13856
    ds_read_b64_tr_b16 v[58:59], v17 offset:24608
    ds_read_b64_tr_b16 v[60:61], v16 offset:64
    ds_read_b64_tr_b16 v[62:63], v16 offset:1600
    ds_read_b64_tr_b16 v[64:65], v16 offset:12352
    ds_read_b64_tr_b16 v[66:67], v16 offset:13888
    ds_read_b64_tr_b16 v[68:69], v17 offset:24640
    v_and_b32 v25, 15, v0
    v_cmp_eq_u32 vcc, 12, v25
    v_mov_b32 v36, 0x3f803f80
    s_nop 0
    v_cndmask_b32 v70, 0, v36, vcc
    v_mov_b32 v71, v70
    v_mov_b32 v72, v70
    v_mov_b32 v73, v70
    v_mov_b32 v74, v70
    v_mov_b32 v75, v70
    v_mov_b32 v76, v70
    v_mov_b32 v77, v70
    v_mov_b32 v78, v70
    v_mov_b32 v79, v70
    s_mov_b32 s77, 4096
    v_mul_u32_u24 v96, 103, v0
    v_lshrrev_b32 v96, 10, v96
    v_lshl_add_u32 v96, v96, 4, v1
    v_add_u32 v96, s77, v96
    v_mul_u32_u24 v97, 176, v25
    v_add_u32 v97, s77, v97
    v_lshrrev_b32 v28, 4, v0
    v_lshl_add_u32 v98, v28, 3, v97
    v_lshl_add_u32 v97, v28, 4, v97
LOOP2:
    s_add_u32 s79, s3, 4096
    s_mul_i32 s77, s71, 160
    s_add_u32 s77, s77, s3
    s_sub_u32 s77, s77, 772608
    s_mov_b32 exec_lo, 0x3ff
    s_mov_b32 exec_hi, 0x0
    s_mov_b32 s76, 1
POLL3:
    buffer_load_dword v24, v1, s[16:19], s77 offen sc1
POLLW3:
    s_waitcnt vmcnt(0)
    v_cmp_eq_u32 vcc, -1, v24
    s_cbranch_vccnz AGAIN3
POLLX3:
    s_mov_b64 exec, s[50:51]
    buffer_load_dwordx4 v[80:83], v8, s[16:19], 0 offen sc1
    s_mov_b64 exec, -1
    buffer_load_dwordx4 v[88:91], v11, s[16:19], s96 offen sc1
    buffer_load_dwordx4 v[92:95], v11, s[16:19], s97 offen sc1
    s_mov_b64 exec, s[50:51]
    s_waitcnt vmcnt(2)
BW4:
    ds_write_b128 v9, v[80:83]
    v_cmp_eq_u32 vcc, -1, v80
    s_cbranch_vccnz BR4
BX4:
    s_mov_b64 exec, s[84:85]
    s_waitcnt lgkmcnt(0)
    s_barrier
    ds_read_b128 v[70:73], v97
    ds_read_b128 v[74:77], v97 offset:64
    ds_read_b64 v[78:79], v98 offset:128
    s_mov_b64 exec, -1
    s_cmp_lg_u32 s5, 1
    s_cbranch_scc1 NOOWL
    buffer_load_dword a244, v20, s[16:19], 0 offen sc1
    buffer_load_dword a245, v21, s[16:19], 0 offen sc1
NOOWL:
    s_waitcnt lgkmcnt(2)
    v_mfma_f32_16x16x32_bf16 v[24:27], v[70:73], v[40:43], 0
    v_mfma_f32_16x16x32_bf16 v[32:35], v[70:73], v[60:63], 0
    s_waitcnt lgkmcnt(0)
    v_mfma_f32_16x16x32_bf16 v[24:27], v[74:77], v[44:47], v[24:27]
    v_mfma_f32_16x16x32_bf16 v[32:35], v[74:77], v[64:67], v[32:35]
    v_mfma_f32_16x16x16_bf16 v[24:27], v[78:79], v[48:49], v[24:27]
    v_mfma_f32_16x16x16_bf16 v[32:35], v[78:79], v[68:69], v[32:35]
    v_mfma_f32_16x16x32_bf16 v[28:31], v[70:73], v[50:53], 0
    v_mfma_f32_16x16x32_bf16 v[36:39], v[70:73], v[70:73], 0
    v_mfma_f32_16x16x32_bf16 v[28:31], v[74:77], v[54:57], v[28:31]
    v_mfma_f32_16x16x32_bf16 v[36:39], v[74:77], v[74:77], v[36:39]
    v_mfma_f32_16x16x16_bf16 v[28:31], v[78:79], v[58:59], v[28:31]
    v_mfma_f32_16x16x16_bf16 v[36:39], v[78:79], v[78:79], v[36:39]
    s_nop 0
    v_add_f32 v24, v24, v25
    v_add_f32 v26, v26, v27
    v_add_f32 v24, v24, v26
    v_add_f32 v32, v32, v33
    v_add_f32 v34, v34, v35
    v_add_f32 v32, v32, v34
    s_nop 1
    v_permlane32_swap_b32 v24, v32
    v_add_f32 v28, v28, v29
    v_add_f32 v30, v30, v31
    v_add_f32 v36, v36, v37
    v_add_f32 v38, v38, v39
    v_add_f32 v24, v24, v32
    v_add_f32 v28, v28, v30
    v_add_f32 v36, v36, v38
    s_nop 1
    v_permlane32_swap_b32 v28, v36
    v_add_f32 v28, v28, v36
    s_nop 1
    v_permlane16_swap_b32 v24, v28
    v_add_f32 v24, v24, v28
    buffer_store_dword v24, v10, s[8:11], s3 offen
    s_cmp_eq_u32 s10, 0
    s_cbranch_scc1 SLOW5
BACK5:
    v_mov_b32 v40, 0
    v_mov_b32 v41, 0
    v_mov_b32 v44, 0
    v_mov_b32 v45, 0
    v_mov_b32 v48, 0
    v_mov_b32 v49, 0
    v_mov_b32 v52, 0
    v_mov_b32 v53, 0
    v_mov_b32 v56, 0
    v_mov_b32 v57, 0
    v_mov_b32 v60, 0
    v_mov_b32 v61, 0
    v_mov_b32 v64, 0
    v_mov_b32 v65, 0
    v_mov_b32 v68, 0
    v_mov_b32 v69, 0
    v_mov_b32 v72, 0
    v_mov_b32 v73, 0
    v_mov_b32 v74, 0
    v_mov_b32 v75, 0
    v_mov_b32 v76, 0
    v_mov_b32 v77, 0
    v_mov_b32 v78, 0
    v_mov_b32 v79, 0
    v_mov_b32 v80, 0
    v_mov_b32 v81, 0
    v_mov_b32 v82, 0
    v_mov_b32 v83, 0
    v_mov_b32 v84, 0
    v_mov_b32 v85, 0
    v_mov_b32 v86, 0
    v_mov_b32 v87, 0
    s_waitcnt vmcnt(1)
    v_add_f32 v88, v88, v92
    v_add_f32 v89, v89, v93
    v_add_f32 v90, v90, v94
    v_add_f32 v91, v91, v95
    s_nop 0
    v_permlane32_swap_b32 v88, v90
    v_permlane32_swap_b32 v89, v91
    v_add_f32 v88, v88, v90
    v_add_f32 v89, v89, v91
    s_nop 1
    v_permlane16_swap_b32 v88, v89
    v_add_f32 v88, v88, v89
    v_mul_f32 v7, 0x3acccccd, v88
    s_mov_b32 s76, 1
POLL6:
    buffer_load_dwordx4 v[24:27], v11, s[16:19], s3 offen sc1
    buffer_load_dwordx4 v[28:31], v11, s[16:19], s79 offen sc1
    s_waitcnt vmcnt(0)
    v_add_f32 v24, v24, v28
    v_add_f32 v25, v25, v29
    v_add_f32 v26, v26, v30
    v_add_f32 v27, v27, v31
    s_nop 0
    v_permlane32_swap_b32 v24, v26
    v_permlane32_swap_b32 v25, v27
    v_add_f32 v24, v24, v26
    v_add_f32 v25, v25, v27
    s_nop 1
    v_permlane16_swap_b32 v24, v25
    v_add_f32 v24, v24, v25
    v_cmp_u_f32 vcc, v24, v24
    s_cbranch_vccnz AGAIN6
POLLX6:
    v_readlane_b32 s77, v24, 15
    s_mov_b32 vcc_lo, 0x70007000
    s_mov_b32 vcc_hi, 0x70007000
    v_fma_f32 v25, -s77, v7, v24
    v_cvt_pk_bf16_f32 v25, v25, v25
    ds_write_b16 v12, v25
    v_cndmask_b32 v26, 0, v24, vcc
    s_nop 1
    v_add_f32_dpp v26, v26, v26 quad_perm:[1,0,3,2] row_mask:0xf bank_mask:0xf
    s_nop 1
    v_add_f32_dpp v26, v26, v26 quad_perm:[2,3,0,1] row_mask:0xf bank_mask:0xf
    v_mov_b32 v27, v26
    s_nop 1
    v_permlane32_swap_b32 v26, v27
    v_add_f32 v26, v26, v27
    s_waitcnt lgkmcnt(0)
    s_barrier
    ds_read_b128 v[28:31], v13 offset:0
    ds_read_b128 v[32:35], v13 offset:128
    ds_read_b128 v[36:39], v13 offset:256
    v_mov_b32 v27, v26
    v_mov_b32 v25, s77
    v_subrev_f32 v25, 0x44200000, v25
    v_permlane16_swap_b32 v26, v27
    v_add_f32 v26, v26, v27
    v_mul_f32 v24, 0x3acccccd, v25
    v_readlane_b32 s77, v26, 15
    v_mul_f32 v24, v24, v24
    s_mov_b32 s78, 0x3acccccd
    v_sub_f32 v26, s77, v25
    v_fma_f32 v26, v26, s78, -v24
    v_max_f32 v26, 0, v26
    v_add_f32 v26, 0x3727c5ac, v26
    v_rsq_f32 v26, v26
    s_nop 0
    v_mul_f32 v18, 0x3dd53b94, v26
    s_waitcnt lgkmcnt(2)
    v_smfmac_f32_16x16x64_bf16 v[40:43], v[28:31], a[0:7], v14
    v_smfmac_f32_16x16x64_bf16 v[44:47], v[28:31], a[24:31], v14
    v_smfmac_f32_16x16x64_bf16 v[48:51], v[28:31], a[48:55], v14
    v_smfmac_f32_16x16x64_bf16 v[52:55], v[28:31], a[72:79], v14
    v_smfmac_f32_16x16x64_bf16 v[56:59], v[28:31], a[96:103], v14
    v_smfmac_f32_16x16x64_bf16 v[60:63], v[28:31], a[120:127], v14
    v_smfmac_f32_16x16x64_bf16 v[64:67], v[28:31], a[144:151], v14
    v_smfmac_f32_16x16x64_bf16 v[68:71], v[28:31], a[168:175], v14
    s_waitcnt lgkmcnt(1)
    v_smfmac_f32_16x16x64_bf16 v[40:43], v[32:35], a[8:15], v14
    v_smfmac_f32_16x16x64_bf16 v[44:47], v[32:35], a[32:39], v14
    v_smfmac_f32_16x16x64_bf16 v[48:51], v[32:35], a[56:63], v14
    v_smfmac_f32_16x16x64_bf16 v[52:55], v[32:35], a[80:87], v14
    v_smfmac_f32_16x16x64_bf16 v[56:59], v[32:35], a[104:111], v14
    v_smfmac_f32_16x16x64_bf16 v[60:63], v[32:35], a[128:135], v14
    v_smfmac_f32_16x16x64_bf16 v[64:67], v[32:35], a[152:159], v14
    v_smfmac_f32_16x16x64_bf16 v[68:71], v[32:35], a[176:183], v14
    s_waitcnt lgkmcnt(0)
    v_smfmac_f32_16x16x64_bf16 v[40:43], v[36:39], a[16:23], v14
    v_smfmac_f32_16x16x64_bf16 v[44:47], v[36:39], a[40:47], v14
    v_smfmac_f32_16x16x64_bf16 v[48:51], v[36:39], a[64:71], v14
    v_smfmac_f32_16x16x64_bf16 v[52:55], v[36:39], a[88:95], v14
    v_smfmac_f32_16x16x64_bf16 v[56:59], v[36:39], a[112:119], v14
    v_smfmac_f32_16x16x64_bf16 v[60:63], v[36:39], a[136:143], v14
    v_smfmac_f32_16x16x64_bf16 v[64:67], v[36:39], a[160:167], v14
    v_smfmac_f32_16x16x64_bf16 v[68:71], v[36:39], a[184:191], v14
    s_nop 0
    v_add_f32 v24, v40, v41
    v_add_f32 v44, v44, v45
    v_add_f32 v48, v48, v49
    v_max3_f32 v26, v24, v44, v48
    v_add_f32 v52, v52, v53
    v_add_f32 v25, v56, v57
    v_max3_f32 v26, v26, v52, v25
    v_add_f32 v60, v60, v61
    v_add_f32 v64, v64, v65
    v_max3_f32 v26, v26, v60, v64
    v_add_f32 v68, v68, v69
    v_max_f32 v26, v26, v68
    v_mov_b32_dpp v24, v44 quad_perm:[0,1,2,3] row_mask:0x2 bank_mask:0xf
    v_mov_b32_dpp v25, v60 quad_perm:[0,1,2,3] row_mask:0x2 bank_mask:0xf
    v_max_f32_dpp v26, v26, v26 row_ror:8 row_mask:0xf bank_mask:0xf
    v_mov_b32_dpp v24, v48 quad_perm:[0,1,2,3] row_mask:0x4 bank_mask:0xf
    v_mov_b32_dpp v25, v64 quad_perm:[0,1,2,3] row_mask:0x4 bank_mask:0xf
    v_max_f32_dpp v26, v26, v26 row_ror:4 row_mask:0xf bank_mask:0xf
    v_mov_b32_dpp v24, v52 quad_perm:[0,1,2,3] row_mask:0x8 bank_mask:0xf
    v_mov_b32_dpp v25, v68 quad_perm:[0,1,2,3] row_mask:0x8 bank_mask:0xf
    v_max_f32_dpp v26, v26, v26 row_ror:2 row_mask:0xf bank_mask:0xf
    v_accvgpr_read_b32 v27, a252
    s_nop 0
    v_max_f32_dpp v26, v26, v26 row_ror:1 row_mask:0xf bank_mask:0xf
    v_mul_f32 v26, v26, v18
    v_fma_f32 v24, v24, v18, -v26
    v_fma_f32 v25, v25, v18, -v26
    v_exp_f32 v24, v24
    v_exp_f32 v25, v25
    s_nop 0
    v_cvt_pk_bf16_f32 v28, v24, v25
    ds_write_b16 v19, v28
    ds_write_b16_d16_hi v19, v28 offset:128
    s_mov_b64 exec, s[88:89]
    ds_read_b128 v[72:75], v27 offset:0
    ds_read_b128 v[76:79], v27 offset:64
    ds_read_b128 v[80:83], v27 offset:128
    ds_read_b128 v[84:87], v27 offset:192
    s_mov_b64 exec, -1
    v_add_f32 v27, v24, v25
    v_mov_b32 v40, 0
    v_mov_b32 v44, 0
    v_add_f32_dpp v27, v27, v27 row_ror:8 row_mask:0xf bank_mask:0xf
    v_mov_b32 v48, 0
    v_mov_b32 v52, 0
    v_add_f32_dpp v27, v27, v27 row_ror:4 row_mask:0xf bank_mask:0xf
    v_mov_b32 v56, 0
    v_mov_b32 v60, 0
    v_add_f32_dpp v27, v27, v27 row_ror:2 row_mask:0xf bank_mask:0xf
    s_lshl_b32 s78, s72, 3
    s_add_u32 s78, s78, 125440
    v_add_f32_dpp v27, v27, v27 row_ror:1 row_mask:0xf bank_mask:0xf
    v_mov_b32 v28, v27
    s_nop 1
    v_permlane32_swap_b32 v27, v28
    v_add_f32 v27, v27, v28
    v_mov_b32 v28, v27
    s_nop 1
    v_permlane16_swap_b32 v27, v28
    v_add_f32 v27, v27, v28
    v_mov_b32 v28, s78
    ds_write_b64 v28, v[26:27]
    s_waitcnt lgkmcnt(4)
    v_smfmac_f32_16x16x64_bf16 v[40:43], v[72:75], a[192:199], v14 abid:1
    v_smfmac_f32_16x16x64_bf16 v[44:47], v[72:75], a[200:207], v14 abid:1
    v_smfmac_f32_16x16x64_bf16 v[48:51], v[72:75], a[208:215], v14 abid:1
    v_smfmac_f32_16x16x64_bf16 v[52:55], v[72:75], a[216:223], v14 abid:1
    v_smfmac_f32_16x16x64_bf16 v[56:59], v[72:75], a[224:231], v14 abid:1
    v_smfmac_f32_16x16x64_bf16 v[60:63], v[72:75], a[232:239], v14 abid:1
    s_waitcnt lgkmcnt(3)
    v_smfmac_f32_16x16x64_bf16 v[40:43], v[76:79], v[112:119], v14 abid:1
    v_smfmac_f32_16x16x64_bf16 v[44:47], v[76:79], v[120:127], v14 abid:1
    v_smfmac_f32_16x16x64_bf16 v[48:51], v[76:79], v[128:135], v14 abid:1
    v_smfmac_f32_16x16x64_bf16 v[52:55], v[76:79], v[136:143], v14 abid:1
    v_smfmac_f32_16x16x64_bf16 v[56:59], v[76:79], v[144:151], v14 abid:1
    v_smfmac_f32_16x16x64_bf16 v[60:63], v[76:79], v[152:159], v14 abid:1
    s_waitcnt lgkmcnt(2)
    v_smfmac_f32_16x16x64_bf16 v[40:43], v[80:83], v[160:167], v14 abid:1
    v_smfmac_f32_16x16x64_bf16 v[44:47], v[80:83], v[168:175], v14 abid:1
    v_smfmac_f32_16x16x64_bf16 v[48:51], v[80:83], v[176:183], v14 abid:1
    v_smfmac_f32_16x16x64_bf16 v[52:55], v[80:83], v[184:191], v14 abid:1
    v_smfmac_f32_16x16x64_bf16 v[56:59], v[80:83], v[192:199], v14 abid:1
    v_smfmac_f32_16x16x64_bf16 v[60:63], v[80:83], v[200:207], v14 abid:1
    s_waitcnt lgkmcnt(0)
ATT_LAST:
    s_waitcnt lgkmcnt(8)
    v_smfmac_f32_16x16x64_bf16 v[40:43], v[84:87], v[208:215], v14 abid:1
    v_smfmac_f32_16x16x64_bf16 v[44:47], v[84:87], v[216:223], v14 abid:1
    s_waitcnt lgkmcnt(4)
    v_smfmac_f32_16x16x64_bf16 v[48:51], v[84:87], v[224:231], v14 abid:1
    v_smfmac_f32_16x16x64_bf16 v[52:55], v[84:87], v[232:239], v14 abid:1
    s_waitcnt lgkmcnt(0)
    v_smfmac_f32_16x16x64_bf16 v[56:59], v[84:87], v[240:247], v14 abid:1
    v_smfmac_f32_16x16x64_bf16 v[60:63], v[84:87], v[248:255], v14 abid:1
    s_lshl_b32 s77, s72, 8
    s_add_u32 s77, s77, 119296
    v_lshl_add_u32 v24, v0, 2, s77
    v_permlane16_swap_b32 v40, v44
    v_add_f32 v40, v40, v44
    ds_write_b32 v15, v40 offset:0
    v_permlane16_swap_b32 v48, v52
    v_add_f32 v48, v48, v52
    ds_write_b32 v15, v48 offset:256
    v_permlane16_swap_b32 v56, v60
    v_add_f32 v56, v56, v60
    ds_write_b32 v15, v56 offset:512
    v_and_b32 v25, 3, v0
    v_lshlrev_b32 v25, 3, v25
    v_add_u32 v25, 125440, v25
    s_waitcnt lgkmcnt(0)
    s_barrier
    ds_read_b64 v[32:33], v25
    ds_read2st64_b32 v[40:41], v24 offset0:0 offset1:3
    ds_read2st64_b32 v[42:43], v24 offset0:6 offset1:9
    s_mul_i32 s77, s70, 3072
    s_lshl_b32 s78, s71, 4
    s_add_u32 s77, s77, s78
    s_lshl_b32 s78, s72, 10
    s_add_u32 s77, s77, s78
    s_add_u32 s77, s77, s3
    s_add_u32 s77, s77, 32768
    s_lshl_b32 s78, s69, 3
    s_add_u32 s78, s78, s3
    s_add_u32 s78, s78, 45056
    s_cmp_eq_u32 s72, 3
    s_waitcnt lgkmcnt(2)
    v_max_f32_dpp v34, v32, v32 quad_perm:[1,0,3,2] row_mask:0xf bank_mask:0xf
    s_nop 1
    v_max_f32_dpp v34, v34, v34 quad_perm:[2,3,0,1] row_mask:0xf bank_mask:0xf
    v_sub_f32 v32, v32, v34
    v_exp_f32 v32, v32
    s_cbranch_scc1 OML
    s_waitcnt lgkmcnt(0)
    v_mul_f32_dpp v28, v32, v40 quad_perm:[0,0,0,0] row_mask:0xf bank_mask:0xf
    v_mul_f32_dpp v29, v32, v41 quad_perm:[1,1,1,1] row_mask:0xf bank_mask:0xf
    v_mul_f32_dpp v30, v32, v42 quad_perm:[2,2,2,2] row_mask:0xf bank_mask:0xf
    v_fmac_f32_dpp v28, v32, v43 quad_perm:[3,3,3,3] row_mask:0xf bank_mask:0xf
    v_add_f32 v29, v29, v30
    v_add_f32 v28, v28, v29
    s_nop 1
    v_mov_b32_dpp v29, v28 row_shl:1 row_mask:0xf bank_mask:0xf
    v_cvt_pk_bf16_f32 v28, v28, v29
    s_nop 1
    v_mov_b32_dpp v29, v28 row_shl:2 row_mask:0xf bank_mask:0xf
    v_mov_b32_dpp v30, v28 row_shl:4 row_mask:0xf bank_mask:0xf
    v_mov_b32_dpp v31, v28 row_shl:6 row_mask:0xf bank_mask:0xf
    s_mov_b64 exec, s[82:83]
    buffer_store_dwordx4 v[28:31], v1, s[8:11], s77 offen
    s_cmp_eq_u32 s10, 0
    s_cbranch_scc1 SLOW7
BACK7:
    s_mov_b64 exec, -1
ODONE:
    s_cmp_ge_u32 s69, 20
    s_cbranch_scc1 ROLEF
    s_cmp_eq_u32 s74, 0
    s_cbranch_scc1 WLATE
    v_accvgpr_read_b32 v2, a246
    v_accvgpr_read_b32 v3, a247
    v_accvgpr_read_b32 v4, a248
    v_mov_b32 v88, 0
    v_mov_b32 v92, 0
    v_mov_b32 v96, 0
    v_mov_b32 v100, 0
    v_mov_b32 v104, 0
    v_mov_b32 v108, 0
    ds_read_b64_tr_b16 v[40:41], v2 offset:0
    ds_read_b64_tr_b16 v[42:43], v2 offset:256
    ds_read_b64_tr_b16 v[64:65], v2 offset:32
    ds_read_b64_tr_b16 v[66:67], v2 offset:288
    ds_read_b64_tr_b16 v[44:45], v2 offset:2048
    ds_read_b64_tr_b16 v[46:47], v2 offset:2304
    ds_read_b64_tr_b16 v[68:69], v2 offset:2080
    ds_read_b64_tr_b16 v[70:71], v2 offset:2336
    ds_read_b64_tr_b16 v[48:49], v2 offset:4096
    ds_read_b64_tr_b16 v[50:51], v2 offset:4352
    s_cmp_lg_u32 s72, 1
    s_cbranch_scc1 NOOWN0
    v_accvgpr_read_b32 v28, a244
    v_accvgpr_read_b32 v29, a245
    v_max_u32 v30, v28, v29
    v_cmp_eq_u32 vcc, -1, v30
    s_cbranch_vccnz RETRY8
OK8:
    v_lshlrev_b32 v30, 16, v28
    v_and_b32 v28, 0xffff0000, v28
    v_lshlrev_b32 v31, 16, v29
    v_and_b32 v29, 0xffff0000, v29
    v_add_f32 v30, v30, v31
    v_add_f32 v28, v28, v29
    v_mov_b32 v31, v30
    v_mov_b32 v29, v28
    s_nop 0
    v_permlane32_swap_b32 v30, v31
    v_permlane32_swap_b32 v28, v29
    v_add_f32 v30, v30, v31
    v_add_f32 v28, v28, v29
    v_mov_b32 v31, v30
    v_mov_b32 v29, v28
    s_nop 0
    v_permlane16_swap_b32 v30, v31
    v_permlane16_swap_b32 v28, v29
    v_add_f32 v30, v30, v31
    v_add_f32 v28, v28, v29
    v_add_f32 v22, v22, v30
    v_add_f32 v23, v23, v28
    v_cvt_pk_bf16_f32 v28, v22, v23
    s_lshl_b32 s77, s69, 6
    s_add_u32 s77, s77, s3
    s_add_u32 s77, s77, 47872
    v_lshlrev_b32 v32, 2, v0
    v_mov_b32_dpp v29, v28 quad_perm:[1,1,1,1] row_mask:0xf bank_mask:0xf
    v_mov_b32_dpp v30, v28 quad_perm:[2,2,2,2] row_mask:0xf bank_mask:0xf
    v_mov_b32_dpp v31, v28 quad_perm:[3,3,3,3] row_mask:0xf bank_mask:0xf
    s_mov_b32 exec_lo, 0x1111
    s_mov_b32 exec_hi, 0x0
    buffer_store_dwordx4 v[28:31], v32, s[8:11], s77 offen
    s_cmp_eq_u32 s10, 0
    s_cbranch_scc1 SLOW9
BACK9:
    s_mov_b64 exec, -1
NOOWN0:
    v_mov_b32 v25, 0
    v_mov_b32 v27, 0
    v_mov_b32 v37, 0
    v_mov_b32 v39, 0
    s_mov_b32 exec_lo, 0x00ff00ff
    s_mov_b32 exec_hi, 0x00ff00ff
    buffer_load_dwordx4 v[88:91], v3, s[16:19], s3 offen offset:0 sc1
    buffer_load_dwordx4 v[92:95], v3, s[16:19], s3 offen offset:512 sc1
    buffer_load_dwordx4 v[96:99], v3, s[16:19], s3 offen offset:1024 sc1
    buffer_load_dwordx4 v[100:103], v3, s[16:19], s3 offen offset:1536 sc1
    buffer_load_dwordx4 v[104:107], v3, s[16:19], s3 offen offset:2048 sc1
    buffer_load_dwordx4 v[108:111], v3, s[16:19], s3 offen offset:2560 sc1
    s_mov_b32 exec_lo, -1
    s_mov_b32 exec_hi, 0
    buffer_load_dwordx4 v[24:27], v4, s[16:19], s3 offen offset:0 sc1
    buffer_load_dwordx4 v[36:39], v4, s[16:19], s3 offen offset:16 sc1
    s_mov_b64 exec, -1
    ds_read_b64_tr_b16 v[72:73], v2 offset:4128
    ds_read_b64_tr_b16 v[74:75], v2 offset:4384
    ds_read_b64_tr_b16 v[52:53], v2 offset:6144
    ds_read_b64_tr_b16 v[54:55], v2 offset:6400
    ds_read_b64_tr_b16 v[76:77], v2 offset:6176
    ds_read_b64_tr_b16 v[78:79], v2 offset:6432
    ds_read_b64_tr_b16 v[56:57], v2 offset:8192
    ds_read_b64_tr_b16 v[58:59], v2 offset:8448
    ds_read_b64_tr_b16 v[80:81], v2 offset:8224
    ds_read_b64_tr_b16 v[82:83], v2 offset:8480
    ds_read_b64_tr_b16 v[60:61], v2 offset:10240
    ds_read_b64_tr_b16 v[62:63], v2 offset:10496
    ds_read_b64_tr_b16 v[84:85], v2 offset:10272
    ds_read_b64_tr_b16 v[86:87], v2 offset:10528
    v_accvgpr_read_b32 v5, a249
    v_and_b32 v18, 3, v0
    v_lshrrev_b32 v6, 5, v0
    v_lshl_add_u32 v18, v6, 2, v18
    v_mul_u32_u24 v18, 10240, v18
    v_bfe_u32 v6, v0, 3, 2
    v_lshl_add_u32 v18, v6, 4, v18
    v_and_b32 v6, 0xffffff7f, v5
WCHK:
    s_waitcnt vmcnt(0)
    v_max3_u32 v28, v88, v92, v96
    v_max3_u32 v28, v28, v100, v104
    v_max3_u32 v28, v28, v108, v25
    v_max3_u32 v28, v28, v27, v37
    v_max_u32 v28, v28, v39
    v_cmp_eq_u32 vcc, -1, v28
    s_cbranch_vccnz AGAIN10
POLLX10:
    s_waitcnt lgkmcnt(0)
    v_mfma_f32_16x16x32_bf16 v[28:31], v[88:91], v[40:43], 0
    v_mfma_f32_16x16x32_bf16 v[32:35], v[88:91], v[64:67], 0
    v_max3_f32 v88, v24, v26, v36
    v_max_f32 v88, v88, v38
    v_mfma_f32_16x16x32_bf16 v[28:31], v[92:95], v[44:47], v[28:31]
    v_mov_b32 v89, v88
    v_mfma_f32_16x16x32_bf16 v[32:35], v[92:95], v[68:71], v[32:35]
    s_nop 0
    v_permlane16_swap_b32 v88, v89
    v_max_f32 v88, v88, v89
    v_mfma_f32_16x16x32_bf16 v[28:31], v[96:99], v[48:51], v[28:31]
    v_sub_f32 v24, v24, v88
    v_sub_f32 v26, v26, v88
    v_mfma_f32_16x16x32_bf16 v[32:35], v[96:99], v[72:75], v[32:35]
    v_sub_f32 v36, v36, v88
    v_sub_f32 v38, v38, v88
    v_mfma_f32_16x16x32_bf16 v[28:31], v[100:103], v[52:55], v[28:31]
    v_exp_f32 v24, v24
    v_mfma_f32_16x16x32_bf16 v[32:35], v[100:103], v[76:79], v[32:35]
    v_exp_f32 v26, v26
    v_mfma_f32_16x16x32_bf16 v[28:31], v[104:107], v[56:59], v[28:31]
    v_exp_f32 v36, v36
    v_mfma_f32_16x16x32_bf16 v[32:35], v[104:107], v[80:83], v[32:35]
    v_exp_f32 v38, v38
    v_mfma_f32_16x16x32_bf16 v[28:31], v[108:111], v[60:63], v[28:31]
    v_mul_f32 v90, v24, v25
    v_fmac_f32 v90, v26, v27
    v_mfma_f32_16x16x32_bf16 v[32:35], v[108:111], v[84:87], v[32:35]
    v_fmac_f32 v90, v36, v37
    v_fmac_f32 v90, v38, v39
    v_mov_b32 v89, v90
    s_cmp_lg_u32 s72, 0
    s_nop 0
    v_permlane16_swap_b32 v90, v89
    v_add_f32 v90, v90, v89
    v_rcp_f32 v90, v90
    v_mul_f32 v28, v24, v28
    v_mul_f32 v32, v24, v32
    v_fmac_f32 v28, v26, v29
    v_fmac_f32 v32, v26, v33
    v_fmac_f32 v28, v36, v30
    v_fmac_f32 v32, v36, v34
    v_fmac_f32 v28, v38, v31
    v_fmac_f32 v32, v38, v35
    s_nop 1
    v_permlane16_swap_b32 v28, v32
    v_add_f32 v28, v28, v32
    v_mul_f32 v28, v28, v90
    ds_write_b32 v5, v28
    s_waitcnt lgkmcnt(0)
    s_barrier
    s_cbranch_scc1 WNOT0
    ds_read2st64_b32 v[28:29], v6 offset0:0 offset1:1
    ds_read2st64_b32 v[30:31], v6 offset0:2 offset1:3
    s_waitcnt lgkmcnt(1)
    v_add_f32 v28, v28, v29
    s_waitcnt lgkmcnt(0)
    v_add_f32 v30, v30, v31
    v_add_f32 v28, v28, v30
    s_nop 1
    v_mov_b32_dpp v29, v28 row_shl:1 row_mask:0xf bank_mask:0xf
    v_cvt_pk_bf16_f32 v32, v28, v29
    s_nop 1
    v_mov_b32_dpp v28, v32 quad_perm:[0,0,0,0] row_mask:0xf bank_mask:0xf
    v_mov_b32_dpp v29, v32 quad_perm:[2,2,2,2] row_mask:0xf bank_mask:0xf
    s_nop 0
    v_mov_b32_dpp v30, v28 row_shl:4 row_mask:0xf bank_mask:0xf
    v_mov_b32_dpp v31, v29 row_shl:4 row_mask:0xf bank_mask:0xf
    s_mov_b64 exec, s[46:47]
    buffer_store_dwordx4 v[28:31], v18, s[16:19], s80 offen sc1
    s_mov_b64 exec, s[92:93]
    buffer_store_dwordx4 v[28:31], v18, s[8:11], s81 offen
    s_cmp_eq_u32 s10, 0
    s_cbranch_scc1 SLOW11
BACK11:
    s_mov_b64 exec, -1
    v_add_u32 v111, 49152, v2
    s_cmp_lg_u32 s74, 0
    s_cbranch_scc1 W2OK
    v_lshrrev_b32 v38, 2, v0
    v_mul_u32_u24 v38, 1280, v38
    v_and_b32 v39, 3, v0
    v_lshl_add_u32 v39, v39, 4, v38
    s_mul_i32 s77, s68, 245760
    s_lshl_b32 s78, s69, 6
    s_add_u32 s77, s77, s78
    s_mov_b32 m0, 106496
    s_nop 0
    buffer_load_dwordx4 v39, s[32:35], s77 offen lds
    s_add_u32 s77, s77, 20480
    s_mov_b32 m0, 107520
    s_nop 0
    buffer_load_dwordx4 v39, s[32:35], s77 offen lds
    s_add_u32 s77, s77, 20480
    s_mov_b32 m0, 108544
    s_nop 0
    buffer_load_dwordx4 v39, s[32:35], s77 offen lds
    s_add_u32 s77, s77, 20480
    s_mov_b32 m0, 109568
    s_nop 0
    buffer_load_dwordx4 v39, s[32:35], s77 offen lds
    s_add_u32 s77, s77, 20480
    s_mov_b32 m0, 110592
    s_nop 0
    buffer_load_dwordx4 v39, s[32:35], s77 offen lds
    s_add_u32 s77, s77, 20480
    s_mov_b32 m0, 111616
    s_nop 0
    buffer_load_dwordx4 v39, s[32:35], s77 offen lds
    s_add_u32 s77, s77, 20480
    s_mov_b32 m0, 112640
    s_nop 0
    buffer_load_dwordx4 v39, s[32:35], s77 offen lds
    s_add_u32 s77, s77, 20480
    s_mov_b32 m0, 113664
    s_nop 0
    buffer_load_dwordx4 v39, s[32:35], s77 offen lds
    s_add_u32 s77, s77, 20480
    s_mov_b32 m0, 114688
    s_nop 0
    buffer_load_dwordx4 v39, s[32:35], s77 offen lds
    s_add_u32 s77, s77, 20480
    s_mov_b32 m0, 115712
    s_nop 0
    buffer_load_dwordx4 v39, s[32:35], s77 offen lds
    s_add_u32 s77, s77, 20480
    s_mov_b32 m0, 116736
    s_nop 0
    buffer_load_dwordx4 v39, s[32:35], s77 offen lds
    s_add_u32 s77, s77, 20480
    s_mov_b32 m0, 117760
    s_nop 0
    buffer_load_dwordx4 v39, s[32:35], s77 offen lds
    s_add_u32 s77, s77, 20480
    s_branch W2X
W2OK:
    ds_read_b64_tr_b16 v[40:41], v111 offset:0
    ds_read_b64_tr_b16 v[42:43], v111 offset:256
    ds_read_b64_tr_b16 v[64:65], v111 offset:32
    ds_read_b64_tr_b16 v[66:67], v111 offset:288
    ds_read_b64_tr_b16 v[44:45], v111 offset:2048
    ds_read_b64_tr_b16 v[46:47], v111 offset:2304
    ds_read_b64_tr_b16 v[68:69], v111 offset:2080
    ds_read_b64_tr_b16 v[70:71], v111 offset:2336
    ds_read_b64_tr_b16 v[48:49], v111 offset:4096
    ds_read_b64_tr_b16 v[50:51], v111 offset:4352
    ds_read_b64_tr_b16 v[72:73], v111 offset:4128
    ds_read_b64_tr_b16 v[74:75], v111 offset:4384
    ds_read_b64_tr_b16 v[52:53], v111 offset:6144
    ds_read_b64_tr_b16 v[54:55], v111 offset:6400
    ds_read_b64_tr_b16 v[76:77], v111 offset:6176
    ds_read_b64_tr_b16 v[78:79], v111 offset:6432
    ds_read_b64_tr_b16 v[56:57], v111 offset:8192
    ds_read_b64_tr_b16 v[58:59], v111 offset:8448
    ds_read_b64_tr_b16 v[80:81], v111 offset:8224
    ds_read_b64_tr_b16 v[82:83], v111 offset:8480
    ds_read_b64_tr_b16 v[60:61], v111 offset:10240
    ds_read_b64_tr_b16 v[62:63], v111 offset:10496
    ds_read_b64_tr_b16 v[84:85], v111 offset:10272
    ds_read_b64_tr_b16 v[86:87], v111 offset:10528
W2X:
    v_mov_b32 v100, 0
    v_mov_b32 v101, 0
    v_mov_b32 v104, 0
    v_mov_b32 v105, 0
    s_add_u32 s96, s80, 81920
    s_add_u32 s97, s81, 1280
STB:
    s_mul_i32 s77, s72, 48
    v_min_u32 v6, 47, v0
    v_add_u32 v6, s77, v6
    v_lshlrev_b32 v4, 4, v6
    v_add_u32 v108, 7168, v4
    v_lshlrev_b32 v4, 2, v6
    v_cmp_le_u32 vcc, 48, v0
    v_mov_b32 v24, 768
    s_nop 0
    v_cndmask_b32 v4, v4, v24, vcc
    v_add_u32 v5, 3584, v4
    v_lshrrev_b32 v24, 4, v6
    v_lshlrev_b32 v24, 5, v24
    v_bfe_u32 v25, v6, 1, 1
    v_lshl_add_u32 v24, v25, 4, v24
    v_bfe_u32 v25, v6, 2, 2
    v_lshl_add_u32 v24, v25, 2, v24
    v_and_b32 v25, 1, v6
    v_lshl_add_u32 v24, v25, 1, v24
    v_add_u32 v24, 118784, v24
    v_mov_b32 v25, 119168
    v_cndmask_b32 v6, v24, v25, vcc
    v_mov_b32 v109, 0x3727c5ac
    v_mov_b32 v110, 0x3acccccd
    s_add_u32 s79, s3, 50432
    v_accvgpr_read_b32 v2, a250
    v_accvgpr_read_b32 v3, a251
    s_add_u32 s6, s74, s72
    s_mov_b32 s76, 1
    s_cmp_eq_u32 s74, 0
    s_cbranch_scc1 GPF
GPO:
    s_cmp_eq_u32 s72, 1
    s_cbranch_scc1 WOWN
GP1:
    buffer_load_dword v24, v4, s[16:19], s79 offen offset:0 sc1
    buffer_load_dword v28, v5, s[16:19], s79 offen offset:0 sc1
    buffer_load_dword v25, v4, s[16:19], s79 offen offset:896 sc1
    buffer_load_dword v29, v5, s[16:19], s79 offen offset:896 sc1
    buffer_load_dword v26, v4, s[16:19], s79 offen offset:1792 sc1
    buffer_load_dword v30, v5, s[16:19], s79 offen offset:1792 sc1
    buffer_load_dword v27, v4, s[16:19], s79 offen offset:2688 sc1
    buffer_load_dword v31, v5, s[16:19], s79 offen offset:2688 sc1
    s_waitcnt vmcnt(0)
    v_add_f32 v24, v24, v25
    v_add_f32 v28, v28, v29
    v_add_f32 v26, v26, v27
    v_add_f32 v30, v30, v31
    v_add_f32 v28, v28, v30
    v_add_f32 v24, v24, v26
    v_cmp_u_f32 vcc, v24, v28
    s_cbranch_vccnz GA1
GPX:
    v_readlane_b32 s77, v28, 48
    v_readlane_b32 s78, v24, 48
    s_cmp_lg_u32 s6, 1
    s_cbranch_scc0 OWL
OWB:
    v_mul_f32 v25, s77, v110
    v_fma_f32 v26, s78, v110, v109
    v_fma_f32 v26, -v25, v25, v26
    v_add_f32 v25, 1.0, v25
    v_max_f32 v26, v26, v109
    v_fma_f32 v24, -v25, v2, v24
    v_rsq_f32 v27, v26
    v_mul_f32 v29, 0xbfb8aa3b, v24
    v_mul_f32 v29, v29, v27
    v_exp_f32 v29, v29
    v_fma_f32 v28, -v25, v3, v28
    v_fma_f32 v29, v29, v26, v26
    v_rcp_f32 v29, v29
    v_mul_f32 v28, v28, v24
    v_mul_f32 v28, v28, v29
    v_cvt_pk_bf16_f32 v28, v28, v28
    ds_write_b16 v6, v28
    v_accvgpr_write_b32 a250, v2
    v_accvgpr_write_b32 a251, v3
    s_cmp_lg_u32 s72, 0
    s_waitcnt lgkmcnt(0)
    s_barrier
    s_cbranch_scc1 STBX
    ds_read_b128 v[88:91], v13 offset:0
    ds_read_b128 v[92:95], v13 offset:128
    ds_read_b128 v[96:99], v13 offset:256
    s_waitcnt lgkmcnt(2)
    v_smfmac_f32_16x16x64_bf16 v[100:103], v[88:91], v[40:47], v14
    v_smfmac_f32_16x16x64_bf16 v[104:107], v[88:91], v[64:71], v14
    s_waitcnt lgkmcnt(1)
    v_smfmac_f32_16x16x64_bf16 v[100:103], v[92:95], v[48:55], v14
    v_smfmac_f32_16x16x64_bf16 v[104:107], v[92:95], v[72:79], v14
    s_waitcnt lgkmcnt(0)
    v_smfmac_f32_16x16x64_bf16 v[100:103], v[96:99], v[56:63], v14
    v_smfmac_f32_16x16x64_bf16 v[104:107], v[96:99], v[80:87], v14
    s_nop 6
    v_add_f32 v28, v100, v101
    s_nop 1
    v_add_f32_dpp v28, v104, v105 quad_perm:[0,1,2,3] row_mask:0xa bank_mask:0xf
    s_nop 1
    v_mov_b32_dpp v29, v28 row_shl:1 row_mask:0xf bank_mask:0xf
    v_cvt_pk_bf16_f32 v32, v28, v29
    s_nop 1
    v_mov_b32_dpp v28, v32 quad_perm:[0,0,0,0] row_mask:0xf bank_mask:0xf
    v_mov_b32_dpp v29, v32 quad_perm:[2,2,2,2] row_mask:0xf bank_mask:0xf
    s_nop 0
    v_mov_b32_dpp v30, v28 row_shl:4 row_mask:0xf bank_mask:0xf
    v_mov_b32_dpp v31, v29 row_shl:4 row_mask:0xf bank_mask:0xf
    s_mov_b64 exec, s[48:49]
    buffer_store_dwordx4 v[28:31], v18, s[16:19], s96 offen sc1
    s_mov_b64 exec, s[92:93]
    buffer_store_dwordx4 v[28:31], v18, s[8:11], s97 offen
    s_cmp_eq_u32 s10, 0
    s_cbranch_scc1 SLOW12
BACK12:
    s_mov_b64 exec, -1
    s_branch NEXT
AGAIN3:
    s_add_u32 s76, s76, 1
    s_cmp_lt_u32 s76, 32768
    s_cbranch_scc1 POLL3
    s_branch POLLX3
BR4:
    s_cmp_ge_u32 s76, 32768
    s_cbranch_scc1 BX4
    s_mov_b64 exec, vcc
    buffer_load_dwordx4 v[80:83], v8, s[16:19], 0 offen sc1
    s_add_u32 s76, s76, 1
    s_waitcnt vmcnt(0)
    s_branch BW4
AGAIN6:
    s_add_u32 s76, s76, 1
    s_cmp_lt_u32 s76, 32768
    s_cbranch_scc1 POLL6
    s_branch POLLX6
OML:
    v_mul_f32 v35, v32, v33
    s_nop 1
    v_add_f32_dpp v35, v35, v35 quad_perm:[1,0,3,2] row_mask:0xf bank_mask:0xf
    s_nop 1
    v_add_f32_dpp v35, v35, v35 quad_perm:[2,3,0,1] row_mask:0xf bank_mask:0xf
    s_mov_b64 exec, 1
    buffer_store_dwordx2 v[34:35], v1, s[8:11], s78 offen
    s_cmp_eq_u32 s10, 0
    s_cbranch_scc1 SLOW13
BACK13:
    s_mov_b64 exec, -1
    s_waitcnt lgkmcnt(0)
    s_branch ODONE
WLATE:
    v_lshrrev_b32 v38, 2, v0
    v_mul_u32_u24 v38, 1280, v38
    v_and_b32 v39, 3, v0
    v_lshl_add_u32 v39, v39, 4, v38
    s_mov_b32 m0, s67
    s_add_u32 s67, s67, 1024
    buffer_load_dwordx4 v39, s[24:27], s66 offen  lds
    s_add_u32 s66, s66, 20480
    s_mov_b32 m0, s67
    s_add_u32 s67, s67, 1024
    buffer_load_dwordx4 v39, s[24:27], s66 offen  lds
    s_add_u32 s66, s66, 20480
    s_mov_b32 m0, s67
    s_add_u32 s67, s67, 1024
    buffer_load_dwordx4 v39, s[24:27], s66 offen  lds
    s_add_u32 s66, s66, 20480
    s_mov_b32 m0, s67
    s_add_u32 s67, s67, 1024
    buffer_load_dwordx4 v39, s[24:27], s66 offen  lds
    s_add_u32 s66, s66, 20480
    s_mov_b32 m0, s67
    s_add_u32 s67, s67, 1024
    buffer_load_dwordx4 v39, s[24:27], s66 offen  lds
    s_add_u32 s66, s66, 20480
    s_mov_b32 m0, s67
    s_add_u32 s67, s67, 1024
    buffer_load_dwordx4 v39, s[24:27], s66 offen  lds
    s_add_u32 s66, s66, 20480
    s_add_u32 s77, s3, 1638400
    buffer_store_dword v7, v10, s[8:11], s77 offen
    s_cmp_eq_u32 s10, 0
    s_cbranch_scc1 SLOW14
BACK14:
    v_accvgpr_read_b32 v2, a246
    v_accvgpr_read_b32 v3, a247
    v_accvgpr_read_b32 v4, a248
    v_mov_b32 v88, 0
    v_mov_b32 v92, 0
    v_mov_b32 v96, 0
    v_mov_b32 v100, 0
    v_mov_b32 v104, 0
    v_mov_b32 v108, 0
    v_mov_b32 v25, 0
    v_mov_b32 v27, 0
    v_mov_b32 v37, 0
    v_mov_b32 v39, 0
    s_mov_b32 exec_lo, 0x00ff00ff
    s_mov_b32 exec_hi, 0x00ff00ff
    buffer_load_dwordx4 v[88:91], v3, s[16:19], s3 offen offset:0 sc1
    buffer_load_dwordx4 v[92:95], v3, s[16:19], s3 offen offset:512 sc1
    buffer_load_dwordx4 v[96:99], v3, s[16:19], s3 offen offset:1024 sc1
    buffer_load_dwordx4 v[100:103], v3, s[16:19], s3 offen offset:1536 sc1
    buffer_load_dwordx4 v[104:107], v3, s[16:19], s3 offen offset:2048 sc1
    buffer_load_dwordx4 v[108:111], v3, s[16:19], s3 offen offset:2560 sc1
    s_mov_b32 exec_lo, -1
    s_mov_b32 exec_hi, 0
    buffer_load_dwordx4 v[24:27], v4, s[16:19], s3 offen offset:0 sc1
    buffer_load_dwordx4 v[36:39], v4, s[16:19], s3 offen offset:16 sc1
    s_mov_b64 exec, -1
    s_waitcnt vmcnt(8)
    ds_read_b64_tr_b16 v[40:41], v2 offset:0
    ds_read_b64_tr_b16 v[42:43], v2 offset:256
    ds_read_b64_tr_b16 v[64:65], v2 offset:32
    ds_read_b64_tr_b16 v[66:67], v2 offset:288
    ds_read_b64_tr_b16 v[44:45], v2 offset:2048
    ds_read_b64_tr_b16 v[46:47], v2 offset:2304
    ds_read_b64_tr_b16 v[68:69], v2 offset:2080
    ds_read_b64_tr_b16 v[70:71], v2 offset:2336
    ds_read_b64_tr_b16 v[48:49], v2 offset:4096
    ds_read_b64_tr_b16 v[50:51], v2 offset:4352
    s_lshl_b32 s77, s68, 2
    s_add_u32 s77, s77, s72
    s_mul_i32 s77, s77, 61440
    s_lshl_b32 s78, s69, 6
    s_add_u32 s77, s77, s78
    v_min_u32 v35, 47, v0
    v_mul_u32_u24 v35, 1280, v35
    v_add_u32 v35, s77, v35
    ds_read_b64_tr_b16 v[72:73], v2 offset:4128
    ds_read_b64_tr_b16 v[74:75], v2 offset:4384
    ds_read_b64_tr_b16 v[52:53], v2 offset:6144
    ds_read_b64_tr_b16 v[54:55], v2 offset:6400
    ds_read_b64_tr_b16 v[76:77], v2 offset:6176
    ds_read_b64_tr_b16 v[78:79], v2 offset:6432
    ds_read_b64_tr_b16 v[56:57], v2 offset:8192
    ds_read_b64_tr_b16 v[58:59], v2 offset:8448
    ds_read_b64_tr_b16 v[80:81], v2 offset:8224
    ds_read_b64_tr_b16 v[82:83], v2 offset:8480
    ds_read_b64_tr_b16 v[60:61], v2 offset:10240
    ds_read_b64_tr_b16 v[62:63], v2 offset:10496
    ds_read_b64_tr_b16 v[84:85], v2 offset:10272
    ds_read_b64_tr_b16 v[86:87], v2 offset:10528
    v_accvgpr_read_b32 v5, a249
    v_and_b32 v18, 3, v0
    v_lshrrev_b32 v6, 5, v0
    v_lshl_add_u32 v18, v6, 2, v18
    v_mul_u32_u24 v18, 10240, v18
    v_bfe_u32 v6, v0, 3, 2
    v_lshl_add_u32 v18, v6, 4, v18
    v_and_b32 v6, 0xffffff7f, v5
    s_branch WCHK
AGAIN10:
    s_mov_b64 s[94:95], exec
    s_mov_b32 s76, 1
AG210:
    v_max3_u32 v28, v88, v92, v96
    v_max3_u32 v28, v28, v100, v104
    v_max_u32 v28, v28, v108
    v_cmp_eq_u32 vcc, -1, v28
    s_nop 0
    s_mov_b64 exec, vcc
    s_cbranch_execz AG310_0
    buffer_load_dwordx4 v[88:91], v3, s[16:19], s3 offen offset:0 sc1
    buffer_load_dwordx4 v[92:95], v3, s[16:19], s3 offen offset:512 sc1
    buffer_load_dwordx4 v[96:99], v3, s[16:19], s3 offen offset:1024 sc1
    buffer_load_dwordx4 v[100:103], v3, s[16:19], s3 offen offset:1536 sc1
    buffer_load_dwordx4 v[104:107], v3, s[16:19], s3 offen offset:2048 sc1
    buffer_load_dwordx4 v[108:111], v3, s[16:19], s3 offen offset:2560 sc1
AG310_0:
    s_mov_b64 exec, s[94:95]
    v_max3_u32 v28, v25, v27, v37
    v_max_u32 v28, v28, v39
    v_cmp_eq_u32 vcc, -1, v28
    s_nop 0
    s_mov_b64 exec, vcc
    s_cbranch_execz AG310_1
    buffer_load_dwordx4 v[24:27], v4, s[16:19], s3 offen offset:0 sc1
    buffer_load_dwordx4 v[36:39], v4, s[16:19], s3 offen offset:16 sc1
AG310_1:
    s_mov_b64 exec, s[94:95]
    s_add_u32 s76, s76, 1
    s_cmp_ge_u32 s76, 32768
    s_waitcnt vmcnt(0)
    v_max3_u32 v28, v88, v92, v96
    v_max3_u32 v28, v28, v100, v104
    v_max3_u32 v28, v28, v108, v25
    v_max3_u32 v28, v28, v27, v37
    v_max_u32 v28, v28, v39
    v_cmp_eq_u32 vcc, -1, v28
    s_cbranch_vccz POLLX10
    s_cbranch_scc0 AG210
    s_branch POLLX10
GA1:
    s_add_u32 s76, s76, 1
    s_cmp_lt_u32 s76, 32768
    s_cbranch_scc1 GP1
    s_branch GPX
GPF:
    s_cmp_lg_u32 s72, 0
    s_cbranch_scc1 GP0
    buffer_load_dwordx4 v[32:35], v108, s[16:19], s79 offen sc1
    buffer_load_dwordx4 v[36:39], v108, s[16:19], s79 offen offset:3072 sc1
    s_waitcnt vmcnt(2)
    ds_read_b64_tr_b16 v[40:41], v111 offset:0
    ds_read_b64_tr_b16 v[42:43], v111 offset:256
    ds_read_b64_tr_b16 v[64:65], v111 offset:32
    ds_read_b64_tr_b16 v[66:67], v111 offset:288
    ds_read_b64_tr_b16 v[44:45], v111 offset:2048
    ds_read_b64_tr_b16 v[46:47], v111 offset:2304
    ds_read_b64_tr_b16 v[68:69], v111 offset:2080
    ds_read_b64_tr_b16 v[70:71], v111 offset:2336
    ds_read_b64_tr_b16 v[48:49], v111 offset:4096
    ds_read_b64_tr_b16 v[50:51], v111 offset:4352
    ds_read_b64_tr_b16 v[72:73], v111 offset:4128
    ds_read_b64_tr_b16 v[74:75], v111 offset:4384
    ds_read_b64_tr_b16 v[52:53], v111 offset:6144
    ds_read_b64_tr_b16 v[54:55], v111 offset:6400
    ds_read_b64_tr_b16 v[76:77], v111 offset:6176
    ds_read_b64_tr_b16 v[78:79], v111 offset:6432
    ds_read_b64_tr_b16 v[56:57], v111 offset:8192
    ds_read_b64_tr_b16 v[58:59], v111 offset:8448
    ds_read_b64_tr_b16 v[80:81], v111 offset:8224
    ds_read_b64_tr_b16 v[82:83], v111 offset:8480
    ds_read_b64_tr_b16 v[60:61], v111 offset:10240
    ds_read_b64_tr_b16 v[62:63], v111 offset:10496
    ds_read_b64_tr_b16 v[84:85], v111 offset:10272
    ds_read_b64_tr_b16 v[86:87], v111 offset:10528
    s_branch GPW
GP0:
    buffer_load_dwordx4 v[32:35], v108, s[16:19], s79 offen sc1
    buffer_load_dwordx4 v[36:39], v108, s[16:19], s79 offen offset:3072 sc1
GPW:
    s_add_u32 s76, s76, 1
    s_cmp_ge_u32 s76, 32768
    s_waitcnt vmcnt(0)
    v_add_f32 v2, v32, v33
    v_add_f32 v3, v36, v37
    v_add_f32 v34, v34, v35
    v_add_f32 v38, v38, v39
    v_add_f32 v2, v2, v34
    v_add_f32 v3, v3, v38
    v_cmp_u_f32 vcc, v2, v3
    s_cbranch_scc1 GPO
    s_cbranch_vccnz GP0
    s_branch GPO
OWL:
    buffer_load_dword v34, v37, s[16:19], 0 offen sc1
    buffer_load_dword v35, v38, s[16:19], 0 offen sc1
    s_branch OWB
WNOT0:
    s_cmp_lg_u32 s74, 0
    s_cbranch_scc1 STB
    s_cmp_eq_u32 s72, 1
    s_cbranch_scc1 WPREP
    s_cmp_eq_u32 s72, 3
    s_cbranch_scc1 WLC
    v_mov_b32 v52, -1
    v_mov_b32 v53, -1
    v_mov_b32 v54, -1
    v_mov_b32 v55, -1
    s_add_u32 s77, s80, 819200
    s_add_u32 s7, s77, 81920
    s_sleep 8
    s_mov_b64 exec, s[44:45]
    buffer_store_dwordx4 v[52:55], v18, s[16:19], s77 offen sc1
    s_mov_b64 exec, s[92:93]
    buffer_store_dwordx4 v[52:55], v18, s[16:19], s7 offen sc1
    s_mov_b64 exec, -1
    s_branch WPREP
WLC:
    s_mul_i32 s77, s69, 1248
    s_add_u32 s78, s3, 851968
    v_add_u32 v100, s77, v1
    v_min_u32 v100, 24816, v100
    s_add_u32 s77, s77, 1024
    v_add_u32 v101, s77, v1
    v_min_u32 v101, 24816, v101
    s_add_u32 s77, s77, 1024
    v_mov_b32 v104, -1
    v_mov_b32 v105, -1
    v_mov_b32 v106, -1
    v_mov_b32 v107, -1
    ds_read_b64_tr_b16 v[40:41], v16 offset:0
    ds_read_b64_tr_b16 v[42:43], v16 offset:1536
    ds_read_b64_tr_b16 v[44:45], v16 offset:12288
    ds_read_b64_tr_b16 v[46:47], v16 offset:13824
    ds_read_b64_tr_b16 v[48:49], v17 offset:24576
    ds_read_b64_tr_b16 v[50:51], v16 offset:32
    ds_read_b64_tr_b16 v[52:53], v16 offset:1568
    ds_read_b64_tr_b16 v[54:55], v16 offset:12320
    ds_read_b64_tr_b16 v[56:57], v16 offset:13856
    ds_read_b64_tr_b16 v[58:59], v17 offset:24608
    ds_read_b64_tr_b16 v[60:61], v16 offset:64
    ds_read_b64_tr_b16 v[62:63], v16 offset:1600
    ds_read_b64_tr_b16 v[64:65], v16 offset:12352
    ds_read_b64_tr_b16 v[66:67], v16 offset:13888
    ds_read_b64_tr_b16 v[68:69], v17 offset:24640
    v_and_b32 v25, 15, v0
    v_cmp_eq_u32 vcc, 12, v25
    v_mov_b32 v36, 0x3f803f80
    s_nop 0
    v_cndmask_b32 v70, 0, v36, vcc
    v_mov_b32 v71, v70
    v_mov_b32 v72, v70
    v_mov_b32 v73, v70
    v_mov_b32 v74, v70
    v_mov_b32 v75, v70
    v_mov_b32 v76, v70
    v_mov_b32 v77, v70
    v_mov_b32 v78, v70
    v_mov_b32 v79, v70
    s_mov_b32 s77, 4096
    v_mul_u32_u24 v96, 103, v0
    v_lshrrev_b32 v96, 10, v96
    v_lshl_add_u32 v96, v96, 4, v1
    v_add_u32 v96, s77, v96
    v_mul_u32_u24 v97, 176, v25
    v_add_u32 v97, s77, v97
    v_lshrrev_b32 v28, 4, v0
    v_lshl_add_u32 v98, v28, 3, v97
    v_lshl_add_u32 v97, v28, 4, v97
    buffer_store_dwordx4 v[104:107], v100, s[8:11], s78 offen
    s_cmp_eq_u32 s10, 0
    s_cbranch_scc1 SLOW15
BACK15:
    buffer_store_dwordx4 v[104:107], v101, s[8:11], s78 offen
    s_cmp_eq_u32 s10, 0
    s_cbranch_scc1 SLOW16
BACK16:
    s_branch STB
WPREP:
    s_nop 1
    ds_read_b64_tr_b16 v[40:41], v16 offset:0
    ds_read_b64_tr_b16 v[42:43], v16 offset:1536
    ds_read_b64_tr_b16 v[44:45], v16 offset:12288
    ds_read_b64_tr_b16 v[46:47], v16 offset:13824
    ds_read_b64_tr_b16 v[48:49], v17 offset:24576
    ds_read_b64_tr_b16 v[50:51], v16 offset:32
    ds_read_b64_tr_b16 v[52:53], v16 offset:1568
    ds_read_b64_tr_b16 v[54:55], v16 offset:12320
    ds_read_b64_tr_b16 v[56:57], v16 offset:13856
    ds_read_b64_tr_b16 v[58:59], v17 offset:24608
    ds_read_b64_tr_b16 v[60:61], v16 offset:64
    ds_read_b64_tr_b16 v[62:63], v16 offset:1600
    ds_read_b64_tr_b16 v[64:65], v16 offset:12352
    ds_read_b64_tr_b16 v[66:67], v16 offset:13888
    ds_read_b64_tr_b16 v[68:69], v17 offset:24640
    v_and_b32 v25, 15, v0
    v_cmp_eq_u32 vcc, 12, v25
    v_mov_b32 v36, 0x3f803f80
    s_nop 0
    v_cndmask_b32 v70, 0, v36, vcc
    v_mov_b32 v71, v70
    v_mov_b32 v72, v70
    v_mov_b32 v73, v70
    v_mov_b32 v74, v70
    v_mov_b32 v75, v70
    v_mov_b32 v76, v70
    v_mov_b32 v77, v70
    v_mov_b32 v78, v70
    v_mov_b32 v79, v70
    s_mov_b32 s77, 4096
    v_mul_u32_u24 v96, 103, v0
    v_lshrrev_b32 v96, 10, v96
    v_lshl_add_u32 v96, v96, 4, v1
    v_add_u32 v96, s77, v96
    v_mul_u32_u24 v97, 176, v25
    v_add_u32 v97, s77, v97
    v_lshrrev_b32 v28, 4, v0
    v_lshl_add_u32 v98, v28, 3, v97
    v_lshl_add_u32 v97, v28, 4, v97
    s_branch STB
WOWN:
    v_and_b32 v25, 15, v0
    v_lshrrev_b32 v26, 4, v0
    s_mul_i32 s7, s68, 10240
    s_cmp_eq_u32 s74, 0
    s_cselect_b32 s7, 0, s7
    s_add_u32 s7, s7, 655360
    v_mul_u32_u24 v37, 1280, v26
    v_add_u32 v37, s7, v37
    s_mul_i32 s7, s68, 81920
    s_add_u32 s7, s7, 45312
    v_mov_b32 v38, s7
    v_cmp_eq_u32 vcc, s68, v26
    s_nop 1
    v_cndmask_b32 v37, v37, v38, vcc
    v_add_u32 v39, 4, v26
    s_mul_i32 s7, s68, 10240
    s_cmp_eq_u32 s74, 0
    s_cselect_b32 s7, 0, s7
    s_add_u32 s7, s7, 655360
    v_mul_u32_u24 v38, 1280, v39
    v_add_u32 v38, s7, v38
    s_mul_i32 s7, s68, 81920
    s_add_u32 s7, s7, 45312
    v_mov_b32 v28, s7
    v_cmp_eq_u32 vcc, s68, v39
    s_nop 1
    v_cndmask_b32 v38, v38, v28, vcc
    s_lshl_b32 s77, s69, 6
    s_add_u32 s77, s77, s74
    v_lshl_add_u32 v25, v25, 2, s77
    v_add_u32 v37, v25, v37
    v_add_u32 v38, v25, v38
    s_cmp_eq_u32 s74, 0
    s_cbranch_scc1 GP1
    s_sleep 9
    s_mov_b32 s76, 1
POLL17:
    buffer_load_dword v28, v37, s[16:19], 0 offen sc1
    buffer_load_dword v29, v38, s[16:19], 0 offen sc1
POLLW17:
    s_waitcnt vmcnt(0)
    v_max_u32 v30, v28, v29
    v_cmp_eq_u32 vcc, -1, v30
    s_cbranch_vccnz AGAIN17
POLLX17:
    v_lshlrev_b32 v30, 16, v28
    v_and_b32 v28, 0xffff0000, v28
    v_lshlrev_b32 v31, 16, v29
    v_and_b32 v29, 0xffff0000, v29
    v_add_f32 v30, v30, v31
    v_add_f32 v28, v28, v29
    v_mov_b32 v31, v30
    v_mov_b32 v29, v28
    s_nop 0
    v_permlane32_swap_b32 v30, v31
    v_permlane32_swap_b32 v28, v29
    v_add_f32 v30, v30, v31
    v_add_f32 v28, v28, v29
    v_mov_b32 v31, v30
    v_mov_b32 v29, v28
    s_nop 0
    v_permlane16_swap_b32 v30, v31
    v_permlane16_swap_b32 v28, v29
    v_add_f32 v30, v30, v31
    v_add_f32 v28, v28, v29
    v_add_f32 v22, v22, v30
    v_add_f32 v23, v23, v28
    v_cvt_pk_bf16_f32 v28, v22, v23
    s_branch GP1
STBX:
    s_cmp_lg_u32 s72, 1
    s_cbranch_scc1 NEXT
    s_cmp_lg_u32 s74, 0
    s_cbranch_scc1 FINAL
    s_waitcnt vmcnt(0)
    v_mov_b32 v28, v34
    v_mov_b32 v29, v35
    v_max_u32 v30, v28, v29
    v_cmp_eq_u32 vcc, -1, v30
    s_cbranch_vccnz RETRY18
OK18:
    v_lshlrev_b32 v30, 16, v28
    v_and_b32 v28, 0xffff0000, v28
    v_lshlrev_b32 v31, 16, v29
    v_and_b32 v29, 0xffff0000, v29
    v_add_f32 v30, v30, v31
    v_add_f32 v28, v28, v29
    v_mov_b32 v31, v30
    v_mov_b32 v29, v28
    s_nop 0
    v_permlane32_swap_b32 v30, v31
    v_permlane32_swap_b32 v28, v29
    v_add_f32 v30, v30, v31
    v_add_f32 v28, v28, v29
    v_mov_b32 v31, v30
    v_mov_b32 v29, v28
    s_nop 0
    v_permlane16_swap_b32 v30, v31
    v_permlane16_swap_b32 v28, v29
    v_add_f32 v30, v30, v31
    v_add_f32 v28, v28, v29
    v_add_f32 v22, v22, v30
    v_add_f32 v23, v23, v28
    v_cvt_pk_bf16_f32 v28, v22, v23
    s_lshl_b32 s77, s69, 6
    s_add_u32 s77, s77, s3
    s_add_u32 s77, s77, 49152
    v_lshlrev_b32 v32, 2, v0
    v_mov_b32_dpp v29, v28 quad_perm:[1,1,1,1] row_mask:0xf bank_mask:0xf
    v_mov_b32_dpp v30, v28 quad_perm:[2,2,2,2] row_mask:0xf bank_mask:0xf
    v_mov_b32_dpp v31, v28 quad_perm:[3,3,3,3] row_mask:0xf bank_mask:0xf
    s_mov_b32 exec_lo, 0x1111
    s_mov_b32 exec_hi, 0x0
    buffer_store_dwordx4 v[28:31], v32, s[8:11], s77 offen
    s_cmp_eq_u32 s10, 0
    s_cbranch_scc1 SLOW19
BACK19:
    s_mov_b64 exec, -1
    s_branch NEXT
FINAL:
    s_cmp_lg_u32 s68, 0
    s_cbranch_scc1 DONE
    s_lshl_b32 s77, s69, 6
    v_lshlrev_b32 v37, 2, v0
    s_add_u32 s79, s77, s3
    s_add_u32 s79, s79, 46592
    s_mov_b64 exec, 15
    s_mov_b32 s76, 1
POLL20:
    buffer_load_dword v28, v1, s[16:19], s79 offen sc1
POLLW20:
    s_waitcnt vmcnt(0)
    v_cmp_eq_u32 vcc, -1, v28
    s_cbranch_vccnz AGAIN20
POLLX20:
    s_mov_b64 exec, -1
    s_mov_b32 s76, 1
POLL21:
    buffer_load_dword v28, v20, s[16:19], s74 offen sc1
    buffer_load_dword v29, v21, s[16:19], s74 offen sc1
POLLW21:
    s_waitcnt vmcnt(0)
    v_max_u32 v30, v28, v29
    v_cmp_eq_u32 vcc, -1, v30
    s_cbranch_vccnz AGAIN21
POLLX21:
    v_lshlrev_b32 v30, 16, v28
    v_and_b32 v28, 0xffff0000, v28
    v_lshlrev_b32 v31, 16, v29
    v_and_b32 v29, 0xffff0000, v29
    v_add_f32 v30, v30, v31
    v_add_f32 v28, v28, v29
    v_mov_b32 v31, v30
    v_mov_b32 v29, v28
    s_nop 0
    v_permlane32_swap_b32 v30, v31
    v_permlane32_swap_b32 v28, v29
    v_add_f32 v30, v30, v31
    v_add_f32 v28, v28, v29
    v_mov_b32 v31, v30
    v_mov_b32 v29, v28
    s_nop 0
    v_permlane16_swap_b32 v30, v31
    v_permlane16_swap_b32 v28, v29
    v_add_f32 v30, v30, v31
    v_add_f32 v28, v28, v29
    v_add_f32 v22, v22, v30
    v_add_f32 v23, v23, v28
    v_cvt_pk_bf16_f32 v28, v22, v23
    s_mov_b32 exec_lo, 0xffff
    s_mov_b32 exec_hi, 0x0
    buffer_store_dword v28, v37, s[40:43], s77 offen
    s_mov_b64 exec, -1
    s_endpgm
AGAIN17:
    s_sleep 2
    s_add_u32 s76, s76, 1
    s_cmp_lt_u32 s76, 32768
    s_cbranch_scc1 POLL17
    s_branch POLLX17
AGAIN20:
    s_add_u32 s76, s76, 1
    s_cmp_lt_u32 s76, 32768
    s_cbranch_scc1 POLL20
    s_branch POLLX20
AGAIN21:
    s_add_u32 s76, s76, 1
    s_cmp_lt_u32 s76, 32768
    s_cbranch_scc1 POLL21
    s_branch POLLX21
ROLEF:
    v_and_b32 v25, 15, v0
    v_lshrrev_b32 v26, 4, v0
    v_bfe_u32 v27, v0, 2, 2
    v_and_b32 v36, 3, v0
    s_cmp_lg_u32 s74, 0
    s_cbranch_scc1 FW
    v_lshrrev_b32 v38, 3, v0
    v_mul_u32_u24 v38, 3072, v38
    v_and_b32 v39, 7, v0
    v_lshl_add_u32 v38, v39, 4, v38
    v_bfe_u32 v39, v0, 4, 1
    v_lshlrev_b32 v39, 5, v39
    v_xor_b32 v38, v38, v39
    v_xor_b32 v39, 64, v38
    s_mov_b32 m0, s67
    s_add_u32 s67, s67, 1024
    buffer_load_dwordx4 v39, s[36:39], s66 offen nt lds
    s_add_u32 s66, s66, 24576
    s_mov_b32 m0, s67
    s_add_u32 s67, s67, 1024
    buffer_load_dwordx4 v38, s[36:39], s66 offen nt lds
    s_add_u32 s66, s66, 24576
    s_mov_b32 m0, s67
    s_add_u32 s67, s67, 1024
    buffer_load_dwordx4 v39, s[36:39], s66 offen nt lds
    s_add_u32 s66, s66, 24576
    s_mov_b32 m0, s67
    s_add_u32 s67, s67, 1024
    buffer_load_dwordx4 v38, s[36:39], s66 offen nt lds
    s_add_u32 s66, s66, 24576
    s_mov_b32 m0, s67
    s_add_u32 s67, s67, 1024
    buffer_load_dwordx4 v39, s[36:39], s66 offen nt lds
    s_add_u32 s66, s66, 24576
    s_mov_b32 m0, s67
    s_add_u32 s67, s67, 1024
    buffer_load_dwordx4 v38, s[36:39], s66 offen nt lds
    s_add_u32 s66, s66, 24576
    s_mov_b32 m0, s67
    s_add_u32 s67, s67, 1024
    buffer_load_dwordx4 v39, s[36:39], s66 offen nt lds
    s_add_u32 s66, s66, 24576
    s_sub_u32 s96, s69, 20
    s_lshl_b32 s96, s96, 2
    s_add_u32 s96, s96, s72
    s_mul_i32 s96, s96, 688
    v_add_u32 v21, s96, v1
    v_min_u32 v21, 32752, v21
    s_add_u32 s97, s3, 819200
    s_add_u32 s77, s3, 1638400
    buffer_store_dword v7, v10, s[8:11], s77 offen
    s_cmp_eq_u32 s10, 0
    s_cbranch_scc1 SLOW22
BACK22:
FW:
    s_lshl_b32 s77, s72, 5
    v_lshl_add_u32 v80, v36, 3, s77
    v_lshrrev_b32 v37, 1, v27
    v_and_b32 v38, 1, v26
    v_lshl_add_u32 v37, v38, 1, v37
    v_lshlrev_b32 v37, 5, v37
    v_xor_b32 v80, v80, v37
    v_lshl_add_u32 v37, v26, 3, v27
    v_lshl_add_u32 v80, v37, 7, v80
    v_add_u32 v80, 57344, v80
    s_sub_u32 s79, s69, 20
    s_and_b32 s7, s79, 12
    s_add_u32 s7, s7, s72
    s_lshl_b32 s78, s7, 8
    v_lshl_add_u32 v83, v25, 4, s78
    v_lshrrev_b32 v84, 2, v83
    v_mov_b32 v37, 768
    v_cmp_le_u32 vcc, 2, v26
    s_nop 1
    v_cndmask_b32 v84, v84, v37, vcc
    v_and_b32 v37, 1, v26
    v_mul_u32_u24 v37, 3584, v37
    v_add_u32 v84, v84, v37
    s_cmp_eq_u32 s7, 0
    s_mov_b32 s52, -1
    s_cselect_b32 s53, 0x10001, 0
    s_and_b32 s79, s79, 3
    s_mul_i32 s78, s79, 892
    s_sub_u32 s78, 7168, s78
    v_add_u32 v83, s78, v83
    s_mul_i32 s78, s79, 896
    s_add_u32 s78, s78, s3
    s_add_u32 s78, s78, 50432
    s_mul_i32 s79, s79, 320
    v_cmp_eq_u32 vcc, 12, v25
    v_mov_b32 v38, 0x3f803f80
    s_nop 0
    v_cndmask_b32 v88, 0, v38, vcc
    v_mov_b32 v89, v88
    v_mov_b32 v90, v88
    v_mov_b32 v91, v88
    v_mov_b32 v92, v88
    v_mov_b32 v93, v88
    v_mov_b32 v94, v88
    v_mov_b32 v95, v88
    v_mov_b32 v96, v88
    v_mov_b32 v97, v88
    v_mov_b32 v98, v88
    v_mov_b32 v99, v88
    v_mov_b32 v100, v88
    v_mov_b32 v101, v88
    v_mov_b32 v102, v88
    v_mov_b32 v103, v88
    v_mov_b32 v104, v88
    v_mov_b32 v105, v88
    v_mov_b32 v106, v88
    v_mov_b32 v107, v88
    v_mul_u32_u24 v6, 336, v25
    v_lshl_add_u32 v6, v26, 4, v6
    s_mul_i32 s77, s72, 45
    v_min_u32 v27, 44, v0
    v_add_u32 v27, s77, v27
    v_mul_u32_u24 v37, 205, v27
    v_lshrrev_b32 v37, 12, v37
    v_add_u32 v87, v37, v27
    v_lshlrev_b32 v87, 4, v87
    v_mul_u32_u24 v38, 20, v37
    v_sub_u32 v27, v27, v38
    v_lshlrev_b32 v27, 4, v27
    s_mul_i32 s7, s68, 10240
    s_cmp_eq_u32 s74, 0
    s_cselect_b32 s7, 0, s7
    s_add_u32 s7, s7, 655360
    v_mul_u32_u24 v86, 1280, v37
    v_add_u32 v86, s7, v86
    s_mul_i32 s7, s68, 81920
    s_add_u32 s7, s7, 45312
    v_mov_b32 v38, s7
    v_cmp_eq_u32 vcc, s68, v37
    s_nop 1
    v_cndmask_b32 v86, v86, v38, vcc
    v_add_u32 v38, 2560, v38
    v_cmp_le_u32 vcc, 8, v37
    s_nop 1
    v_cndmask_b32 v86, v86, v38, vcc
    v_add_u32 v86, v86, v27
    s_add_u32 s77, s79, s74
    s_add_u32 s79, s79, s3
    s_add_u32 s79, s79, 45312
    s_cmp_lg_u32 s74, 0
    s_cbranch_scc1 FW1
    v_mov_b32 v24, -1
    v_mov_b32 v25, -1
    v_mov_b32 v26, -1
    v_mov_b32 v27, -1
    s_waitcnt vmcnt(0)
    buffer_store_dwordx4 v[24:27], v21, s[8:11], s97 offen
    s_cmp_eq_u32 s10, 0
    s_cbranch_scc1 SLOW23
BACK23:
    s_barrier
FW1:
    ds_read_b64_tr_b16 v[40:41], v80 offset:0
    ds_read_b64_tr_b16 v[42:43], v80 offset:512
    ds_read_b64_tr_b16 v[44:45], v80 offset:4096
    ds_read_b64_tr_b16 v[46:47], v80 offset:4608
    ds_read_b64_tr_b16 v[48:49], v80 offset:8192
    ds_read_b64_tr_b16 v[50:51], v80 offset:8704
    ds_read_b64_tr_b16 v[52:53], v80 offset:12288
    ds_read_b64_tr_b16 v[54:55], v80 offset:12800
    ds_read_b64_tr_b16 v[56:57], v80 offset:16384
    ds_read_b64_tr_b16 v[58:59], v80 offset:16896
    ds_read_b64_tr_b16 v[60:61], v80 offset:20480
    ds_read_b64_tr_b16 v[62:63], v80 offset:20992
    ds_read_b64_tr_b16 v[64:65], v80 offset:24576
    ds_read_b64_tr_b16 v[66:67], v80 offset:25088
    ds_read_b64_tr_b16 v[68:69], v80 offset:28672
    ds_read_b64_tr_b16 v[70:71], v80 offset:29184
    ds_read_b64_tr_b16 v[72:73], v80 offset:32768
    ds_read_b64_tr_b16 v[74:75], v80 offset:33280
    ds_read_b64_tr_b16 v[76:77], v80 offset:36864
    ds_read_b64_tr_b16 v[78:79], v80 offset:37376
    s_cmp_lg_u32 s74, 0
    s_cbranch_scc1 FW3
    s_waitcnt lgkmcnt(0)
    v_mfma_f32_16x16x32_bf16 v[108:111], v[88:91], v[40:43], 0
    v_mfma_f32_16x16x32_bf16 v[2:5], v[88:91], v[60:63], 0
    v_mfma_f32_16x16x32_bf16 v[108:111], v[92:95], v[44:47], v[108:111]
    v_mfma_f32_16x16x32_bf16 v[2:5], v[92:95], v[64:67], v[2:5]
    v_mfma_f32_16x16x32_bf16 v[108:111], v[96:99], v[48:51], v[108:111]
    v_mfma_f32_16x16x32_bf16 v[2:5], v[96:99], v[68:71], v[2:5]
    v_mfma_f32_16x16x32_bf16 v[108:111], v[100:103], v[52:55], v[108:111]
    v_mfma_f32_16x16x32_bf16 v[2:5], v[100:103], v[72:75], v[2:5]
    v_mfma_f32_16x16x32_bf16 v[108:111], v[104:107], v[56:59], v[108:111]
    v_mfma_f32_16x16x32_bf16 v[2:5], v[104:107], v[76:79], v[2:5]
FW3:
    s_mov_b32 exec_lo, 0xfffff
    s_mov_b32 exec_hi, 0x0
    s_mov_b32 s76, 1
POLL24:
    buffer_load_dword v36, v1, s[16:19], s79 offen sc1
POLLW24:
    s_waitcnt vmcnt(0)
    v_cmp_eq_u32 vcc, -1, v36
    s_cbranch_vccnz AGAIN24
POLLX24:
    s_mov_b64 exec, s[86:87]
    buffer_load_dwordx4 v[24:27], v86, s[16:19], s77 offen sc1
    s_cmp_eq_u32 s74, 0
    s_cbranch_scc1 CSP
    s_waitcnt vmcnt(0)
CSB:
    s_waitcnt vmcnt(2)
BW25:
    ds_write_b128 v87, v[24:27]
    v_cmp_eq_u32 vcc, -1, v24
    s_cbranch_vccnz BR25
BX25:
    s_mov_b64 exec, s[84:85]
    s_waitcnt lgkmcnt(0)
    s_barrier
    ds_read_b128 v[88:91], v6 offset:0
    ds_read_b128 v[92:95], v6 offset:64
    ds_read_b128 v[96:99], v6 offset:128
    ds_read_b128 v[100:103], v6 offset:192
    ds_read_b128 v[104:107], v6 offset:256
    s_mov_b64 exec, -1
    s_waitcnt lgkmcnt(4)
    v_mfma_f32_16x16x32_bf16 v[32:35], v[88:91], v[88:91], 0
    s_waitcnt lgkmcnt(3)
    v_mfma_f32_16x16x32_bf16 v[32:35], v[92:95], v[92:95], v[32:35]
    s_waitcnt lgkmcnt(2)
    v_mfma_f32_16x16x32_bf16 v[32:35], v[96:99], v[96:99], v[32:35]
    s_waitcnt lgkmcnt(1)
    v_mfma_f32_16x16x32_bf16 v[32:35], v[100:103], v[100:103], v[32:35]
    s_waitcnt lgkmcnt(0)
    v_mfma_f32_16x16x32_bf16 v[32:35], v[104:107], v[104:107], v[32:35]
    v_mfma_f32_16x16x32_bf16 v[24:27], v[88:91], v[40:43], 0
    v_mov_b32 v36, 0
    v_mov_b32 v37, 0
    v_mfma_f32_16x16x32_bf16 v[24:27], v[92:95], v[44:47], v[24:27]
    v_mov_b32 v38, 0
    s_nop 0
    v_mfma_f32_16x16x32_bf16 v[24:27], v[96:99], v[48:51], v[24:27]
    v_mfma_f32_16x16x32_bf16 v[24:27], v[100:103], v[52:55], v[24:27]
    v_add_f32 v32, v32, v33
    v_add_f32 v34, v34, v35
    v_mfma_f32_16x16x32_bf16 v[24:27], v[104:107], v[56:59], v[24:27]
    v_mfma_f32_16x16x32_bf16 v[28:31], v[88:91], v[60:63], 0
    v_add_f32_dpp v36, v32, v34 quad_perm:[0,1,2,3] row_mask:0xf bank_mask:0x7
    v_mfma_f32_16x16x32_bf16 v[28:31], v[92:95], v[64:67], v[28:31]
    s_nop 0
    v_add_f32_dpp v36, v36, v36 row_ror:8 row_mask:0xf bank_mask:0xf
    v_mfma_f32_16x16x32_bf16 v[28:31], v[96:99], v[68:71], v[28:31]
    s_nop 0
    v_add_f32_dpp v36, v36, v36 row_ror:4 row_mask:0xf bank_mask:0xf
    v_mfma_f32_16x16x32_bf16 v[28:31], v[100:103], v[72:75], v[28:31]
    s_nop 0
    v_add_f32_dpp v36, v36, v36 row_ror:2 row_mask:0xf bank_mask:0xf
    v_mfma_f32_16x16x32_bf16 v[28:31], v[104:107], v[76:79], v[28:31]
    v_add_f32 v25, v24, v25
    v_add_f32_dpp v37, v36, v36 row_ror:1 row_mask:0x7 bank_mask:0xf
    v_add_f32_dpp v38, v36, v36 row_ror:1 row_mask:0x8 bank_mask:0xf
    v_add_f32 v26, v26, v27
    v_add_f32 v25, v25, v26
    s_nop 1
    v_permlane32_swap_b32 v25, v37
    v_add_f32 v29, v28, v29
    v_add_f32 v30, v30, v31
    v_add_f32 v29, v29, v30
    v_add_f32 v25, v25, v37
    s_nop 0
    v_permlane32_swap_b32 v29, v38
    v_add_f32 v29, v29, v38
    s_nop 1
    v_permlane16_swap_b32 v25, v29
    s_mov_b64 exec, s[52:53]
    v_add_f32 v25, v25, v29
    buffer_store_dword v25, v84, s[8:11], s78 offen
    s_cmp_eq_u32 s10, 0
    s_cbranch_scc1 SLOW26
BACK26:
    s_mov_b64 exec, -1
NEXT:
    s_cmp_lg_u32 s74, 0
    s_cbranch_scc1 DONE
    s_mov_b32 s74, 819200
    s_add_u32 s3, s3, 819200
    s_add_u32 s80, s80, 819200
    s_add_u32 s81, s81, 819200
    s_mov_b64 s[46:47], s[44:45]
    s_mov_b64 s[48:49], s[92:93]
    s_branch LOOP
AGAIN24:
    s_add_u32 s76, s76, 1
    s_cmp_lt_u32 s76, 32768
    s_cbranch_scc1 POLL24
    s_branch POLLX24
CSP:
    s_mov_b32 exec_lo, 0x0
    s_mov_b32 exec_hi, 0xffff0000
    buffer_store_dword v108, v83, s[8:11], s78 offen
    s_cmp_eq_u32 s10, 0
    s_cbranch_scc1 SLOW27
BACK27:
    buffer_store_dword v2, v83, s[8:11], s78 offen offset:3072
    s_cmp_eq_u32 s10, 0
    s_cbranch_scc1 SLOW28
BACK28:
    s_mov_b64 exec, s[86:87]
    s_branch CSB
BR25:
    s_cmp_ge_u32 s76, 32768
    s_cbranch_scc1 BX25
    s_mov_b64 exec, vcc
    buffer_load_dwordx4 v[24:27], v86, s[16:19], s77 offen sc1
    s_add_u32 s76, s76, 1
    s_waitcnt vmcnt(0)
    s_branch BW25
DONE:
    s_endpgm
TAGLOOP:
    s_mov_b32 s76, 0
TAGL2:
    s_sleep 8
    global_load_dword v98, v100, s[64:65] sc1
    s_waitcnt vmcnt(0)
    v_readfirstlane_b32 s96, v98
    s_nop 0
    s_cmp_lg_u32 s96, 0
    s_cbranch_scc1 TAGOK
    s_add_u32 s76, s76, 1
    s_cmp_lt_u32 s76, 32768
    s_cbranch_scc1 TAGL2
    s_branch TAGOK
DMAF:
    s_sub_u32 s78, s69, 20
    s_and_b32 s66, s78, 3
    s_lshl_b32 s66, s66, 1
    s_and_b32 s79, s72, 1
    s_add_u32 s66, s66, s79
    s_mul_i32 s66, s66, 245760
    s_lshr_b32 s78, s78, 2
    s_lshl_b32 s78, s78, 7
    s_add_u32 s66, s66, s78
    s_mul_i32 s78, s68, 384
    s_add_u32 s66, s66, s78
    s_mul_i32 s67, s72, 10240
    s_add_u32 s67, s67, 57344
    s_branch DMAX
RDYLOOP:
    s_mov_b32 s76, 0
RDYL2:
    s_sleep 8
    buffer_load_dwordx2 v[98:99], v100, s[16:19], 0 offen offset:384 sc1
    s_waitcnt vmcnt(0)
    v_cmp_ne_u32 vcc, s96, v98
    s_cbranch_vccz RDYOK
    s_add_u32 s76, s76, 1
    s_cmp_lt_u32 s76, 32768
    s_cbranch_scc1 RDYL2
    s_branch RDYOK
SLOW1:
    buffer_store_dwordx4 v[28:31], v27, s[16:19], s77 offen sc1
    s_branch BACK1
SLOW2:
    buffer_store_dwordx4 v[24:27], v106, s[16:19], 0 offen sc1
    s_branch BACK2
SLOW5:
    buffer_store_dword v24, v10, s[16:19], s3 offen sc1
    s_branch BACK5
SLOW7:
    buffer_store_dwordx4 v[28:31], v1, s[16:19], s77 offen sc1
    s_branch BACK7
RETRY8:
    s_mov_b32 s76, 1
POLL29:
    buffer_load_dword v28, v20, s[16:19], 0 offen sc1
    buffer_load_dword v29, v21, s[16:19], 0 offen sc1
POLLW29:
    s_waitcnt vmcnt(0)
    v_max_u32 v30, v28, v29
    v_cmp_eq_u32 vcc, -1, v30
    s_cbranch_vccnz AGAIN29
POLLX29:
    s_branch OK8
AGAIN29:
    s_add_u32 s76, s76, 1
    s_cmp_lt_u32 s76, 32768
    s_cbranch_scc1 POLL29
    s_branch POLLX29
SLOW9:
    buffer_store_dwordx4 v[28:31], v32, s[16:19], s77 offen sc1
    s_branch BACK9
SLOW11:
    buffer_store_dwordx4 v[28:31], v18, s[16:19], s81 offen sc1
    s_branch BACK11
SLOW12:
    buffer_store_dwordx4 v[28:31], v18, s[16:19], s97 offen sc1
    s_branch BACK12
SLOW13:
    buffer_store_dwordx2 v[34:35], v1, s[16:19], s78 offen sc1
    s_branch BACK13
SLOW14:
    buffer_store_dword v7, v10, s[16:19], s77 offen sc1
    s_branch BACK14
SLOW15:
    buffer_store_dwordx4 v[104:107], v100, s[16:19], s78 offen sc1
    s_branch BACK15
SLOW16:
    buffer_store_dwordx4 v[104:107], v101, s[16:19], s78 offen sc1
    s_branch BACK16
RETRY18:
    s_mov_b32 s76, 1
POLL30:
    buffer_load_dword v28, v37, s[16:19], 0 offen sc1
    buffer_load_dword v29, v38, s[16:19], 0 offen sc1
POLLW30:
    s_waitcnt vmcnt(0)
    v_max_u32 v30, v28, v29
    v_cmp_eq_u32 vcc, -1, v30
    s_cbranch_vccnz AGAIN30
POLLX30:
    s_branch OK18
AGAIN30:
    s_add_u32 s76, s76, 1
    s_cmp_lt_u32 s76, 32768
    s_cbranch_scc1 POLL30
    s_branch POLLX30
SLOW19:
    buffer_store_dwordx4 v[28:31], v32, s[16:19], s77 offen sc1
    s_branch BACK19
SLOW22:
    buffer_store_dword v7, v10, s[16:19], s77 offen sc1
    s_branch BACK22
SLOW23:
    buffer_store_dwordx4 v[24:27], v21, s[16:19], s97 offen sc1
    s_branch BACK23
SLOW26:
    buffer_store_dword v25, v84, s[16:19], s78 offen sc1
    s_branch BACK26
SLOW27:
    buffer_store_dword v108, v83, s[16:19], s78 offen sc1
    s_branch BACK27
SLOW28:
    buffer_store_dword v2, v83, s[16:19], s78 offen offset:3072 sc1
    s_branch BACK28
CODE_END:
    s_endpgm
.section .rodata,"a"
.p2align 6
.amdhsa_kernel interleave_layers__sliding_block_cached__glu_gated_swiglu__decode_kernel
  .amdhsa_next_free_vgpr 512
  .amdhsa_next_free_sgpr 102
  .amdhsa_accum_offset 256
  .amdhsa_group_segment_fixed_size 0
  .amdhsa_kernarg_size 96
  .amdhsa_user_sgpr_count 2
  .amdhsa_user_sgpr_kernarg_segment_ptr 1
  .amdhsa_system_sgpr_workgroup_id_x 1
.end_amdhsa_kernel
```

```asm
; @launch grid=(256,1,1) block=(256,1,1) lds=125568
.amdgcn_target "amdgcn-amd-amdhsa--gfx950"
.text
.globl interleave_layers__sliding_block_cached__glu_gated_swiglu__decode_kernel
.p2align 8
.type interleave_layers__sliding_block_cached__glu_gated_swiglu__decode_kernel,@function
interleave_layers__sliding_block_cached__glu_gated_swiglu__decode_kernel:
    s_load_dwordx16 s[44:59], s[0:1], 0
    s_load_dwordx8 s[60:67], s[0:1], 64
    s_cmp_ge_u32 s2, 256
    s_cbranch_scc1 CODE_END
    s_memrealtime s[96:97]
    v_lshrrev_b32 v2, 6, v0
    v_and_b32 v24, 63, v0
    v_readfirstlane_b32 s72, v2
    s_and_b32 s68, s2, 7
    s_lshr_b32 s69, s2, 3
    s_lshr_b32 s70, s69, 3
    s_and_b32 s71, s69, 7
    v_lshlrev_b32 v1, 4, v24
    s_lshl_b32 s77, s70, 3
    s_add_u32 s77, s77, s68
    s_mul_i32 s73, s77, 12582912
    s_lshl_b32 s78, s71, 2
    s_add_u32 s78, s78, s72
    s_mul_i32 s78, s78, 6144
    s_add_u32 s73, s73, s78
    s_add_u32 s73, s73, 11010048
    v_add_u32 v23, 4096, v1
    s_mov_b32 s10, 402653184
    s_mov_b32 s11, 0x20000
    s_getpc_b64 s[100:101]
PCREF:
    s_sub_u32 s100, s100, PCREF-interleave_layers__sliding_block_cached__glu_gated_swiglu__decode_kernel
    s_subb_u32 s101, s101, 0
    s_lshl_b32 s78, s71, 12
    v_lshl_add_u32 v25, v0, 4, s78
    v_cmp_gt_u32 vcc, CODE_END-interleave_layers__sliding_block_cached__glu_gated_swiglu__decode_kernel-16, v25
    s_nop 0
    s_and_saveexec_b64 s[98:99], vcc
    s_cbranch_execz NOCPF
    global_load_dwordx4 a[240:243], v25, s[100:101]
NOCPF:
    s_mov_b64 exec, -1
    s_mul_i32 s79, s77, 384
    s_mov_b32 s74, 0
    s_mul_i32 s3, s68, 81920
    s_getreg_b32 s75, hwreg(HW_REG_XCC_ID, 0, 4)
    s_lshl_b32 s77, s69, 9
    s_add_u32 s77, s77, s3
    s_add_u32 s77, s77, 32768
    v_add_u32 v20, s77, v1
    s_lshl_b32 s77, s68, 2
    s_add_u32 s77, s77, s69
    s_mul_i32 s77, s77, 320
    s_add_u32 s77, s77, 654848
    s_add_u32 s4, s77, 1024
    v_add_u32 v25, s77, v1
    v_cmp_le_u32 vcc, 32, v0
    s_nop 1
    v_cndmask_b32 v21, v20, v25, vcc
    v_mov_b32 v25, 2147483632
    v_cndmask_b32 v20, v20, v25, vcc
    s_cmp_lt_u32 s69, 4
    s_cselect_b32 s77, 52, 32
    v_cmp_le_u32 vcc, s77, v0
    s_nop 1
    v_cndmask_b32 v21, v21, v25, vcc
    s_mov_b32 s18, 1610612736
    s_mov_b32 s19, 0x20000
    s_waitcnt lgkmcnt(0)
    s_mov_b32 s8, s46
    s_and_b32 s9, s47, 0xffff
    s_mov_b32 s16, s66
    s_and_b32 s17, s67, 0xffff
    buffer_load_dwordx4 a[0:3], v1, s[8:11], s73 offen offset:0 nt
    buffer_load_dwordx4 a[4:7], v1, s[8:11], s73 offen offset:1024 nt
    s_or_b32 s77, s2, s72
    s_cbranch_scc1 NOTAG
    s_or_b32 s77, s96, 1
    v_mov_b32 v26, s77
    s_mov_b64 exec, 1
    global_store_dword v1, v26, s[64:65] sc1
    s_mov_b64 exec, -1
NOTAG:
    s_add_u32 s83, s73, 196608
    s_mov_b32 s12, s48
    s_and_b32 s13, s49, 0xffff
    s_mov_b32 s14, 402653184
    s_mov_b32 s15, 0x20000
    s_mov_b32 s20, s50
    s_and_b32 s21, s51, 0xffff
    s_mov_b32 s22, 7864320
    s_mov_b32 s23, 0x20000
    s_mov_b32 s36, s44
    s_and_b32 s37, s45, 0xffff
    s_mov_b32 s38, 1280
    s_mov_b32 s39, 0x20000
    s_mov_b32 s40, s62
    s_and_b32 s41, s63, 0xffff
    s_mov_b32 s42, 1280
    s_mov_b32 s43, 0x20000
    s_mov_b32 s28, s58
    s_and_b32 s29, s59, 0xffff
    s_mov_b32 s30, 1966080
    s_mov_b32 s31, 0x20000
    s_mov_b32 s32, s60
    s_and_b32 s33, s61, 0xffff
    s_mov_b32 s34, 1966080
    s_mov_b32 s35, 0x20000
    s_cmp_lt_u32 s69, 20
    s_cselect_b32 s24, s52, s56
    s_cselect_b32 s25, s53, s57
    s_cselect_b32 s26, s22, s30
    s_and_b32 s25, s25, 0xffff
    s_mov_b32 s27, 0x20000
    s_add_u32 s84, s83, 196608
    s_add_u32 s85, s84, 196608
    s_add_u32 s86, s85, 196608
    s_add_u32 s87, s86, 196608
    s_add_u32 s88, s87, 196608
    s_add_u32 s89, s88, 196608
    v_mov_b32 v0, v24
    s_mul_i32 s77, s72, 6656
    v_add_u32 v25, 0, v0
    v_mul_u32_u24 v26, 171, v25
    v_lshrrev_b32 v26, 12, v26
    v_mul_u32_u24 v27, 24, v26
    v_sub_u32 v27, v25, v27
    v_lshlrev_b32 v27, 4, v27
    v_mul_u32_u24 v25, 416, v26
    v_add3_u32 v2, v25, v27, s77
    v_mul_u32_u24 v25, 12288, v26
    v_add_u32 v40, v25, v27
    v_add_u32 v25, 64, v0
    v_mul_u32_u24 v26, 171, v25
    v_lshrrev_b32 v26, 12, v26
    v_mul_u32_u24 v27, 24, v26
    v_sub_u32 v27, v25, v27
    v_lshlrev_b32 v27, 4, v27
    v_mul_u32_u24 v25, 416, v26
    v_add3_u32 v3, v25, v27, s77
    v_mul_u32_u24 v25, 12288, v26
    v_add_u32 v41, v25, v27
    v_add_u32 v25, 128, v0
    v_mul_u32_u24 v26, 171, v25
    v_lshrrev_b32 v26, 12, v26
    v_mul_u32_u24 v27, 24, v26
    v_sub_u32 v27, v25, v27
    v_lshlrev_b32 v27, 4, v27
    v_mul_u32_u24 v25, 416, v26
    v_add3_u32 v4, v25, v27, s77
    v_mul_u32_u24 v25, 12288, v26
    v_add_u32 v42, v25, v27
    v_and_b32 v25, 15, v0
    v_lshrrev_b32 v26, 4, v0
    v_bfe_u32 v27, v0, 2, 2
    v_and_b32 v28, 3, v0
    s_mul_i32 s78, s71, 160
    v_lshlrev_b32 v36, 4, v26
    v_lshlrev_b32 v37, 3, v26
    v_lshlrev_b32 v39, 2, v0
    buffer_load_dwordx4 v[70:73], v36, s[36:39], s78 offen
    buffer_load_dwordx4 v[74:77], v36, s[36:39], s78 offen offset:64
    buffer_load_dwordx2 v[78:79], v37, s[36:39], s78 offen offset:128
    buffer_load_dwordx4 v[80:83], v1, s[36:39], 0 offen
    buffer_load_dword v84, v39, s[36:39], 0 offen offset:1024
    s_lshl_b32 s7, s69, 6
    v_lshlrev_b32 v38, 2, v25
    buffer_load_dword v22, v38, s[36:39], s7 offen
    s_mul_i32 s78, s71, 983040
    s_add_u32 s79, s79, s78
    s_mul_i32 s78, s72, 98304
    s_add_u32 s79, s79, s78
    s_mul_i32 s78, s72, 3072
    s_add_u32 s78, s78, 26624
    s_add_u32 m0, s78, 0
    s_nop 0
    buffer_load_dwordx4 v40, s[20:23], s79 offen nt lds
    s_add_u32 m0, s78, 1024
    s_nop 0
    buffer_load_dwordx4 v41, s[20:23], s79 offen nt lds
    s_add_u32 m0, s78, 2048
    s_nop 0
    buffer_load_dwordx4 v42, s[20:23], s79 offen nt lds
    s_add_u32 s79, s79, 393216
    s_add_u32 m0, s78, 12288
    s_nop 0
    buffer_load_dwordx4 v40, s[20:23], s79 offen nt lds
    s_add_u32 m0, s78, 13312
    s_nop 0
    buffer_load_dwordx4 v41, s[20:23], s79 offen nt lds
    s_add_u32 m0, s78, 14336
    s_nop 0
    buffer_load_dwordx4 v42, s[20:23], s79 offen nt lds
    s_add_u32 s79, s79, 393216
    s_cmp_ge_u32 s72, 2
    s_cbranch_scc1 NOWQ3
    s_add_u32 m0, s78, 24576
    s_nop 0
    buffer_load_dwordx4 v40, s[20:23], s79 offen nt lds
    s_add_u32 m0, s78, 25600
    s_nop 0
    buffer_load_dwordx4 v41, s[20:23], s79 offen nt lds
    s_add_u32 m0, s78, 26624
    s_nop 0
    buffer_load_dwordx4 v42, s[20:23], s79 offen nt lds
NOWQ3:
    s_mul_i32 s78, s71, 160
    s_mov_b32 s20, s52
    s_and_b32 s21, s53, 0xffff
    s_mov_b32 s22, 7864320
    s_mov_b32 s23, 0x20000
    s_cmp_lt_u32 s72, 2
    s_cselect_b32 s36, s56, s58
    s_cselect_b32 s37, s57, s59
    s_and_b32 s37, s37, 0xffff
    s_mov_b32 s38, 1966080
    buffer_load_dwordx4 a[8:11], v1, s[8:11], s73 offen offset:2048 nt
    buffer_load_dwordx4 a[12:15], v1, s[8:11], s73 offen offset:3072 nt
    buffer_load_dwordx4 a[16:19], v23, s[8:11], s73 offen offset:0 nt
    v_mul_u32_u24 v29, 416, v25
    v_lshl_add_u32 v29, v26, 4, v29
    v_add_u32 v5, s77, v29
    v_lshrrev_b32 v29, 2, v0
    v_mul_u32_u24 v29, 416, v29
    v_lshl_add_u32 v29, v28, 3, v29
    v_add_u32 v6, s77, v29
    s_mul_i32 s79, s72, 96
    s_add_u32 s79, s79, 26624
    v_lshl_add_u32 v29, v26, 3, v27
    v_mul_u32_u24 v29, 384, v29
    v_lshl_add_u32 v29, v28, 3, v29
    v_add_u32 v16, s79, v29
    v_lshl_add_u32 v29, v26, 2, v27
    v_mul_u32_u24 v29, 384, v29
    v_lshl_add_u32 v29, v28, 3, v29
    v_add_u32 v17, s79, v29
    buffer_load_dwordx4 a[20:23], v23, s[8:11], s73 offen offset:1024 nt
    s_mul_i32 s79, s72, 23
    v_min_u32 v32, 22, v0
    v_add_u32 v32, s79, v32
    v_min_u32 v32, 89, v32
    v_mul_u32_u24 v31, 103, v32
    v_lshrrev_b32 v31, 10, v31
    v_mul_u32_u24 v30, 10, v31
    v_sub_u32 v30, v32, v30
    v_lshl_add_u32 v29, v30, 4, s78
    s_mul_i32 s7, s68, 10240
    s_add_u32 s7, s7, 737280
    v_mul_u32_u24 v8, 1280, v31
    v_add_u32 v8, s7, v8
    s_mul_i32 s7, s68, 81920
    s_add_u32 s7, s7, 46592
    v_mov_b32 v30, s7
    v_cmp_eq_u32 vcc, s68, v31
    s_nop 1
    v_cndmask_b32 v8, v8, v30, vcc
    v_add_u32 v30, 2560, v30
    v_cmp_le_u32 vcc, 8, v31
    s_nop 1
    v_cndmask_b32 v8, v8, v30, vcc
    v_add_u32 v8, v8, v29
    v_add_u32 v33, v31, v32
    v_lshlrev_b32 v33, 4, v33
    v_add_u32 v33, 4096, v33
    v_add_u32 v31, 6, v31
    s_mul_i32 s7, s68, 10240
    s_add_u32 s7, s7, 737280
    v_mul_u32_u24 v9, 1280, v31
    v_add_u32 v9, s7, v9
    s_mul_i32 s7, s68, 81920
    s_add_u32 s7, s7, 46592
    v_mov_b32 v30, s7
    v_cmp_eq_u32 vcc, s68, v31
    s_nop 1
    v_cndmask_b32 v9, v9, v30, vcc
    v_add_u32 v30, 2560, v30
    v_cmp_le_u32 vcc, 8, v31
    s_nop 1
    v_cndmask_b32 v9, v9, v30, vcc
    v_add_u32 v9, v9, v29
    v_mov_b32 v30, 2147483632
    v_cmp_le_u32 vcc, 30, v0
    s_nop 1
    v_cndmask_b32 v9, v9, v30, vcc
    v_mov_b32 v9, v33
    s_lshl_b32 s78, s69, 10
    s_lshl_b32 s79, s72, 8
    s_add_u32 s78, s78, s79
    v_lshl_add_u32 v10, v0, 2, s78
    s_lshl_b32 s78, s70, 13
    s_add_u32 s78, s78, s79
    v_lshlrev_b32 v29, 10, v26
    v_lshl_add_u32 v29, v25, 4, v29
    v_add_u32 v11, s78, v29
    buffer_load_dwordx4 a[24:27], v1, s[8:11], s83 offen offset:0 nt
    s_mul_i32 s78, s72, 96
    s_add_u32 s78, s78, 118784
    v_lshl_add_u32 v29, v27, 5, s78
    v_lshl_add_u32 v29, v28, 2, v29
    v_lshrrev_b32 v30, 1, v26
    v_lshl_add_u32 v29, v30, 4, v29
    v_and_b32 v30, 1, v26
    v_lshl_add_u32 v29, v30, 1, v29
    v_mov_b32 v30, 119168
    v_cmp_le_u32 vcc, 12, v25
    s_nop 1
    v_cndmask_b32 v12, v29, v30, vcc
    v_and_b32 v30, 1, v0
    v_lshlrev_b32 v29, 5, v26
    v_lshl_add_u32 v29, v30, 4, v29
    v_add_u32 v13, 118784, v29
    v_mul_u32_u24 v30, 0xaaaa, v30
    v_and_b32 v29, 1, v27
    v_mul_u32_u24 v29, 0xaaaa, v29
    v_lshl_or_b32 v29, v29, 16, v30
    v_add_u32 v14, 0x44444444, v29
    buffer_load_dwordx4 a[28:31], v1, s[8:11], s83 offen offset:1024 nt
    s_lshl_b32 s78, s72, 8
    s_add_u32 s78, s78, 124416
    v_lshrrev_b32 v29, 5, v0
    v_lshl_add_u32 v29, v29, 6, s78
    v_bfe_u32 v30, v0, 3, 1
    v_lshl_add_u32 v29, v30, 5, v29
    v_bfe_u32 v30, v0, 1, 1
    v_lshl_add_u32 v29, v30, 4, v29
    v_bfe_u32 v30, v0, 2, 1
    v_lshl_add_u32 v29, v30, 3, v29
    v_bfe_u32 v30, v0, 4, 1
    v_lshl_add_u32 v29, v30, 2, v29
    v_bfe_u32 v30, v0, 0, 1
    v_lshl_add_u32 v29, v30, 1, v29
    v_mov_b32 v19, v29
    v_bfe_u32 v29, v0, 4, 1
    v_bfe_u32 v30, v0, 2, 1
    v_lshl_add_u32 v29, v29, 5, s78
    v_lshl_add_u32 v29, v30, 4, v29
    v_accvgpr_write_b32 a252, v29
    s_mul_i32 s78, s72, 768
    s_add_u32 s78, s78, 119296
    v_lshl_add_u32 v29, v25, 2, s78
    v_bfe_u32 v30, v0, 4, 1
    v_lshl_add_u32 v29, v30, 7, v29
    v_lshrrev_b32 v30, 5, v0
    v_lshl_add_u32 v15, v30, 6, v29
    s_waitcnt vmcnt(12)
    v_lshlrev_b32 v88, 16, v80
    v_and_b32 v89, 0xffff0000, v80
    v_lshlrev_b32 v90, 16, v81
    v_and_b32 v91, 0xffff0000, v81
    v_lshlrev_b32 v92, 16, v82
    v_and_b32 v93, 0xffff0000, v82
    v_lshlrev_b32 v94, 16, v83
    v_and_b32 v95, 0xffff0000, v83
    v_lshlrev_b32 v96, 16, v84
    v_and_b32 v97, 0xffff0000, v84
    v_add_f32 v80, v88, v89
    v_add_f32 v80, v80, v90
    v_add_f32 v80, v80, v91
    v_add_f32 v80, v80, v92
    v_add_f32 v80, v80, v93
    v_add_f32 v80, v80, v94
    v_add_f32 v80, v80, v95
    v_add_f32 v80, v80, v96
    v_add_f32 v80, v80, v97
    s_nop 1
    v_add_f32_dpp v80, v80, v80 row_ror:8 row_mask:0xf bank_mask:0xf
    s_nop 1
    v_add_f32_dpp v80, v80, v80 row_ror:4 row_mask:0xf bank_mask:0xf
    s_nop 1
    v_add_f32_dpp v80, v80, v80 row_ror:2 row_mask:0xf bank_mask:0xf
    s_nop 1
    v_add_f32_dpp v80, v80, v80 row_ror:1 row_mask:0xf bank_mask:0xf
    v_mov_b32 v81, v80
    s_nop 1
    v_permlane32_swap_b32 v80, v81
    v_add_f32 v80, v80, v81
    v_mov_b32 v81, v80
    s_nop 1
    v_permlane16_swap_b32 v80, v81
    v_add_f32 v80, v80, v81
    v_mul_f32 v80, 0x3acccccd, v80
    v_sub_f32 v88, v88, v80
    v_sub_f32 v89, v89, v80
    v_sub_f32 v90, v90, v80
    v_sub_f32 v91, v91, v80
    v_sub_f32 v92, v92, v80
    v_sub_f32 v93, v93, v80
    v_sub_f32 v94, v94, v80
    v_sub_f32 v95, v95, v80
    v_sub_f32 v96, v96, v80
    v_sub_f32 v97, v97, v80
    v_mul_f32 v82, v88, v88
    v_fmac_f32 v82, v89, v89
    v_fmac_f32 v82, v90, v90
    v_fmac_f32 v82, v91, v91
    v_fmac_f32 v82, v92, v92
    v_fmac_f32 v82, v93, v93
    v_fmac_f32 v82, v94, v94
    v_fmac_f32 v82, v95, v95
    v_fmac_f32 v82, v96, v96
    v_fmac_f32 v82, v97, v97
    buffer_load_dwordx4 a[32:35], v1, s[8:11], s83 offen offset:2048 nt
    s_nop 0
    v_add_f32_dpp v82, v82, v82 row_ror:8 row_mask:0xf bank_mask:0xf
    s_nop 1
    v_add_f32_dpp v82, v82, v82 row_ror:4 row_mask:0xf bank_mask:0xf
    s_nop 1
    v_add_f32_dpp v82, v82, v82 row_ror:2 row_mask:0xf bank_mask:0xf
    s_nop 1
    v_add_f32_dpp v82, v82, v82 row_ror:1 row_mask:0xf bank_mask:0xf
    v_mov_b32 v81, v82
    s_nop 1
    v_permlane32_swap_b32 v82, v81
    v_add_f32 v82, v82, v81
    v_mov_b32 v81, v82
    s_nop 1
    v_permlane16_swap_b32 v82, v81
    v_add_f32 v82, v82, v81
    v_mul_f32 v82, 0x3acccccd, v82
    v_add_f32 v82, 0x3727c5ac, v82
    v_rsq_f32 v82, v82
    s_mov_b32 vcc_lo, 0xaaaaaaaa
    s_mov_b32 vcc_hi, 0xaaaaaaaa
    v_mov_b32 v85, 0x3f803f80
    v_lshlrev_b32 v83, 16, v70
    v_and_b32 v84, 0xffff0000, v70
    v_sub_f32 v83, v83, v80
    v_sub_f32 v84, v84, v80
    v_mul_f32 v83, v83, v82
    v_mul_f32 v84, v84, v82
    v_cvt_pk_bf16_f32 v83, v83, v84
    v_cndmask_b32 v70, v83, v85, vcc
    v_lshlrev_b32 v83, 16, v71
    v_and_b32 v84, 0xffff0000, v71
    v_sub_f32 v83, v83, v80
    v_sub_f32 v84, v84, v80
    v_mul_f32 v83, v83, v82
    v_mul_f32 v84, v84, v82
    v_cvt_pk_bf16_f32 v83, v83, v84
    v_cndmask_b32 v71, v83, v85, vcc
    v_lshlrev_b32 v83, 16, v72
    v_and_b32 v84, 0xffff0000, v72
    v_sub_f32 v83, v83, v80
    v_sub_f32 v84, v84, v80
    v_mul_f32 v83, v83, v82
    v_mul_f32 v84, v84, v82
    v_cvt_pk_bf16_f32 v83, v83, v84
    v_cndmask_b32 v72, v83, v85, vcc
    v_lshlrev_b32 v83, 16, v73
    v_and_b32 v84, 0xffff0000, v73
    v_sub_f32 v83, v83, v80
    v_sub_f32 v84, v84, v80
    v_mul_f32 v83, v83, v82
    v_mul_f32 v84, v84, v82
    v_cvt_pk_bf16_f32 v83, v83, v84
    v_cndmask_b32 v73, v83, v85, vcc
    v_lshlrev_b32 v83, 16, v74
    v_and_b32 v84, 0xffff0000, v74
    v_sub_f32 v83, v83, v80
    v_sub_f32 v84, v84, v80
    v_mul_f32 v83, v83, v82
    v_mul_f32 v84, v84, v82
    v_cvt_pk_bf16_f32 v83, v83, v84
    v_cndmask_b32 v74, v83, v85, vcc
    v_lshlrev_b32 v83, 16, v75
    v_and_b32 v84, 0xffff0000, v75
    v_sub_f32 v83, v83, v80
    v_sub_f32 v84, v84, v80
    v_mul_f32 v83, v83, v82
    v_mul_f32 v84, v84, v82
    v_cvt_pk_bf16_f32 v83, v83, v84
    v_cndmask_b32 v75, v83, v85, vcc
    buffer_load_dwordx4 a[36:39], v1, s[8:11], s83 offen offset:3072 nt
    v_lshlrev_b32 v83, 16, v76
    v_and_b32 v84, 0xffff0000, v76
    v_sub_f32 v83, v83, v80
    v_sub_f32 v84, v84, v80
    v_mul_f32 v83, v83, v82
    v_mul_f32 v84, v84, v82
    v_cvt_pk_bf16_f32 v83, v83, v84
    v_cndmask_b32 v76, v83, v85, vcc
    v_lshlrev_b32 v83, 16, v77
    v_and_b32 v84, 0xffff0000, v77
    v_sub_f32 v83, v83, v80
    v_sub_f32 v84, v84, v80
    v_mul_f32 v83, v83, v82
    v_mul_f32 v84, v84, v82
    v_cvt_pk_bf16_f32 v83, v83, v84
    v_cndmask_b32 v77, v83, v85, vcc
    v_lshlrev_b32 v83, 16, v78
    v_and_b32 v84, 0xffff0000, v78
    v_sub_f32 v83, v83, v80
    v_sub_f32 v84, v84, v80
    v_mul_f32 v83, v83, v82
    v_mul_f32 v84, v84, v82
    v_cvt_pk_bf16_f32 v83, v83, v84
    v_cndmask_b32 v78, v83, v85, vcc
    v_lshlrev_b32 v83, 16, v79
    v_and_b32 v84, 0xffff0000, v79
    v_sub_f32 v83, v83, v80
    v_sub_f32 v84, v84, v80
    v_mul_f32 v83, v83, v82
    v_mul_f32 v84, v84, v82
    v_cvt_pk_bf16_f32 v83, v83, v84
    v_cndmask_b32 v79, v83, v85, vcc
    s_waitcnt vmcnt(8)
    s_barrier
    ds_read_b64_tr_b16 v[40:41], v16 offset:0
    ds_read_b64_tr_b16 v[42:43], v16 offset:1536
    ds_read_b64_tr_b16 v[44:45], v16 offset:12288
    ds_read_b64_tr_b16 v[46:47], v16 offset:13824
    ds_read_b64_tr_b16 v[48:49], v17 offset:24576
    ds_read_b64_tr_b16 v[50:51], v16 offset:32
    ds_read_b64_tr_b16 v[52:53], v16 offset:1568
    ds_read_b64_tr_b16 v[54:55], v16 offset:12320
    ds_read_b64_tr_b16 v[56:57], v16 offset:13856
    ds_read_b64_tr_b16 v[58:59], v17 offset:24608
    ds_read_b64_tr_b16 v[60:61], v16 offset:64
    ds_read_b64_tr_b16 v[62:63], v16 offset:1600
    ds_read_b64_tr_b16 v[64:65], v16 offset:12352
    ds_read_b64_tr_b16 v[66:67], v16 offset:13888
    ds_read_b64_tr_b16 v[68:69], v17 offset:24640
    v_mov_b32 v100, 0
    s_cmp_lg_u32 s72, 0
    s_cbranch_scc1 NOTL
    s_mov_b64 exec, 1
    global_load_dword v98, v100, s[64:65] sc1
    s_mov_b64 exec, -1
NOTL:
    buffer_load_dwordx4 a[40:43], v23, s[8:11], s83 offen offset:0 nt
    buffer_load_dwordx4 a[44:47], v23, s[8:11], s83 offen offset:1024 nt
    s_mul_i32 s79, s72, 96
    s_add_u32 s79, s79, 119296
    v_min_u32 v36, 48, v0
    v_lshl_add_u32 v36, v36, 1, s79
    v_mov_b32 v37, 119808
    v_cmp_le_u32 vcc, 48, v0
    s_nop 1
    v_cndmask_b32 v36, v36, v37, vcc
    v_add_u32 v37, 119296, v1
    s_waitcnt lgkmcnt(0)
    v_mfma_f32_16x16x32_bf16 v[24:27], v[70:73], v[40:43], 0
    v_mfma_f32_16x16x32_bf16 v[28:31], v[70:73], v[50:53], 0
    v_mfma_f32_16x16x32_bf16 v[32:35], v[70:73], v[60:63], 0
    v_mfma_f32_16x16x32_bf16 v[24:27], v[74:77], v[44:47], v[24:27]
    v_mfma_f32_16x16x32_bf16 v[28:31], v[74:77], v[54:57], v[28:31]
    v_mfma_f32_16x16x32_bf16 v[32:35], v[74:77], v[64:67], v[32:35]
    v_mfma_f32_16x16x16_bf16 v[24:27], v[78:79], v[48:49], v[24:27]
    v_mfma_f32_16x16x16_bf16 v[28:31], v[78:79], v[58:59], v[28:31]
    v_mfma_f32_16x16x16_bf16 v[32:35], v[78:79], v[68:69], v[32:35]
    buffer_load_dwordx4 a[48:51], v1, s[8:11], s84 offen offset:0 nt
    s_nop 4
    v_mov_b32 v7, v25
    v_mov_b32_dpp v24, v28 quad_perm:[0,1,2,3] row_mask:0x2 bank_mask:0xf
    s_nop 0
    v_mov_b32_dpp v7, v29 quad_perm:[0,1,2,3] row_mask:0x2 bank_mask:0xf
    v_mov_b32_dpp v24, v32 quad_perm:[0,1,2,3] row_mask:0x4 bank_mask:0xf
    s_nop 0
    v_mov_b32_dpp v7, v33 quad_perm:[0,1,2,3] row_mask:0x4 bank_mask:0xf
    v_cvt_pk_bf16_f32 v24, v24, v24
    ds_write_b16 v36, v24
    buffer_load_dwordx4 a[52:55], v1, s[8:11], s84 offen offset:1024 nt
    buffer_load_dwordx4 a[56:59], v1, s[8:11], s84 offen offset:2048 nt
    s_waitcnt lgkmcnt(0)
    s_barrier
    ds_read_b128 v[28:31], v37
    s_lshl_b32 s79, s69, 9
    s_add_u32 s79, s79, s3
    s_cmp_eq_u32 s72, 0
    s_cselect_b32 exec_lo, 0xffffff, 1
    s_mov_b32 exec_hi, 0
    s_cselect_b32 s78, 0, 1879048176
    v_add_u32 v37, s78, v1
    s_waitcnt lgkmcnt(0)
    buffer_store_dwordx4 v[28:31], v37, s[16:19], s79 offen sc1
    s_mov_b64 exec, -1
    v_mov_b32 v32, -1
    v_mov_b32 v33, -1
    v_mov_b32 v34, -1
    v_mov_b32 v35, -1
    buffer_store_dwordx4 v[32:35], v21, s[16:19], 0 offen sc1
    buffer_load_dwordx4 a[60:63], v1, s[8:11], s84 offen offset:3072 nt
    s_waitcnt vmcnt(12)
    ds_write_b128 v2, a[0:3] offset:0
    ds_write_b128 v3, a[4:7] offset:0
    ds_write_b128 v4, a[8:11] offset:0
    ds_write_b128 v2, a[12:15] offset:3328
    ds_write_b128 v3, a[16:19] offset:3328
    ds_write_b128 v4, a[20:23] offset:3328
    ds_read_b128 a[0:3], v5 offset:0
    ds_read_b128 a[4:7], v5 offset:64
    ds_read_b128 a[8:11], v5 offset:128
    ds_read_b128 a[12:15], v5 offset:192
    ds_read_b128 a[16:19], v5 offset:256
    ds_read_b128 a[20:23], v5 offset:320
    buffer_load_dwordx4 a[64:67], v23, s[8:11], s84 offen offset:0 nt
    buffer_load_dwordx4 a[68:71], v23, s[8:11], s84 offen offset:1024 nt
    s_barrier
    buffer_load_dwordx4 a[72:75], v1, s[8:11], s85 offen offset:0 nt
    buffer_load_dwordx4 a[76:79], v1, s[8:11], s85 offen offset:1024 nt
    buffer_load_dwordx4 a[80:83], v1, s[8:11], s85 offen offset:2048 nt
    buffer_load_dwordx4 a[84:87], v1, s[8:11], s85 offen offset:3072 nt
    buffer_load_dwordx4 a[88:91], v23, s[8:11], s85 offen offset:0 nt
    buffer_load_dwordx4 a[92:95], v23, s[8:11], s85 offen offset:1024 nt
    s_barrier
    s_getreg_b32 s5, hwreg(HW_REG_XCC_ID, 0, 4)
    s_cmp_lg_u32 s72, 0
    s_cbranch_scc1 NOHDR
    s_waitcnt vmcnt(9)
    v_readfirstlane_b32 s96, v98
    s_nop 0
    s_cmp_eq_u32 s96, 0
    s_cbranch_scc1 TAGLOOP
TAGOK:
    v_mov_b32 v99, s5
    s_mov_b64 exec, 1
    buffer_store_dwordx2 v[98:99], v1, s[16:19], s79 offen offset:384 sc1
    s_mov_b64 exec, -1
NOHDR:
    s_waitcnt vmcnt(14)
    ds_write_b128 v2, a[24:27] offset:0
    ds_write_b128 v3, a[28:31] offset:0
    ds_write_b128 v4, a[32:35] offset:0
    ds_write_b128 v2, a[36:39] offset:3328
    ds_write_b128 v3, a[40:43] offset:3328
    ds_write_b128 v4, a[44:47] offset:3328
    ds_read_b128 a[24:27], v5 offset:0
    ds_read_b128 a[28:31], v5 offset:64
    ds_read_b128 a[32:35], v5 offset:128
    ds_read_b128 a[36:39], v5 offset:192
    ds_read_b128 a[40:43], v5 offset:256
    ds_read_b128 a[44:47], v5 offset:320
    buffer_load_dwordx4 a[96:99], v1, s[8:11], s86 offen offset:0 nt
    buffer_load_dwordx4 a[100:103], v1, s[8:11], s86 offen offset:1024 nt
    buffer_load_dwordx4 a[104:107], v1, s[8:11], s86 offen offset:2048 nt
    buffer_load_dwordx4 a[108:111], v1, s[8:11], s86 offen offset:3072 nt
    buffer_load_dwordx4 a[112:115], v23, s[8:11], s86 offen offset:0 nt
    buffer_load_dwordx4 a[116:119], v23, s[8:11], s86 offen offset:1024 nt
    s_barrier
    s_waitcnt vmcnt(12)
    ds_write_b128 v2, a[48:51] offset:0
    ds_write_b128 v3, a[52:55] offset:0
    ds_write_b128 v4, a[56:59] offset:0
    ds_write_b128 v2, a[60:63] offset:3328
    ds_write_b128 v3, a[64:67] offset:3328
    ds_write_b128 v4, a[68:71] offset:3328
    ds_read_b128 a[48:51], v5 offset:0
    ds_read_b128 a[52:55], v5 offset:64
    ds_read_b128 a[56:59], v5 offset:128
    ds_read_b128 a[60:63], v5 offset:192
    ds_read_b128 a[64:67], v5 offset:256
    ds_read_b128 a[68:71], v5 offset:320
    v_lshlrev_b32 v100, 9, v0
    v_add_u32 v100, s3, v100
    v_bfe_u32 v96, v0, 2, 3
    v_mul_u32_u24 v96, 81920, v96
    v_and_b32 v97, 3, v0
    v_lshl_add_u32 v96, v97, 9, v96
    v_cmp_le_u32 vcc, 32, v0
    s_nop 1
    v_cndmask_b32 v100, v100, v96, vcc
    s_cmp_eq_u32 s72, 0
    s_cselect_b32 s77, 0, 1879048176
    v_add_u32 v100, s77, v100
    buffer_load_dwordx4 a[120:123], v1, s[8:11], s87 offen offset:0 nt
    buffer_load_dwordx4 a[124:127], v1, s[8:11], s87 offen offset:1024 nt
    buffer_load_dwordx4 a[128:131], v1, s[8:11], s87 offen offset:2048 nt
    buffer_load_dwordx4 a[132:135], v1, s[8:11], s87 offen offset:3072 nt
    buffer_load_dwordx4 a[136:139], v23, s[8:11], s87 offen offset:0 nt
    buffer_load_dwordx4 a[140:143], v23, s[8:11], s87 offen offset:1024 nt
    s_barrier
    s_waitcnt vmcnt(12)
    ds_write_b128 v2, a[72:75] offset:0
    ds_write_b128 v3, a[76:79] offset:0
    ds_write_b128 v4, a[80:83] offset:0
    ds_write_b128 v2, a[84:87] offset:3328
    ds_write_b128 v3, a[88:91] offset:3328
    ds_write_b128 v4, a[92:95] offset:3328
    ds_read_b128 a[72:75], v5 offset:0
    ds_read_b128 a[76:79], v5 offset:64
    ds_read_b128 a[80:83], v5 offset:128
    ds_read_b128 a[84:87], v5 offset:192
    ds_read_b128 a[88:91], v5 offset:256
    ds_read_b128 a[92:95], v5 offset:320
    buffer_load_dwordx4 a[144:147], v1, s[8:11], s88 offen offset:0 nt
    buffer_load_dwordx4 a[148:151], v1, s[8:11], s88 offen offset:1024 nt
    buffer_load_dwordx4 a[152:155], v1, s[8:11], s88 offen offset:2048 nt
    buffer_load_dwordx4 a[156:159], v1, s[8:11], s88 offen offset:3072 nt
    buffer_load_dwordx4 a[160:163], v23, s[8:11], s88 offen offset:0 nt
    buffer_load_dwordx4 a[164:167], v23, s[8:11], s88 offen offset:1024 nt
    s_barrier
    s_waitcnt vmcnt(12)
    ds_write_b128 v2, a[96:99] offset:0
    ds_write_b128 v3, a[100:103] offset:0
    ds_write_b128 v4, a[104:107] offset:0
    ds_write_b128 v2, a[108:111] offset:3328
    ds_write_b128 v3, a[112:115] offset:3328
    ds_write_b128 v4, a[116:119] offset:3328
    ds_read_b128 a[96:99], v5 offset:0
    ds_read_b128 a[100:103], v5 offset:64
    ds_read_b128 a[104:107], v5 offset:128
    ds_read_b128 a[108:111], v5 offset:192
    ds_read_b128 a[112:115], v5 offset:256
    ds_read_b128 a[116:119], v5 offset:320
    buffer_load_dwordx4 a[168:171], v1, s[8:11], s89 offen offset:0 nt
    buffer_load_dwordx4 a[172:175], v1, s[8:11], s89 offen offset:1024 nt
    buffer_load_dwordx4 a[176:179], v1, s[8:11], s89 offen offset:2048 nt
    buffer_load_dwordx4 a[180:183], v1, s[8:11], s89 offen offset:3072 nt
    buffer_load_dwordx4 a[184:187], v23, s[8:11], s89 offen offset:0 nt
    buffer_load_dwordx4 a[188:191], v23, s[8:11], s89 offen offset:1024 nt
    s_barrier
    s_cmp_ge_u32 s69, 20
    s_cbranch_scc1 DMAF
    s_lshl_b32 s66, s72, 3
    s_add_u32 s66, s66, s68
    s_mul_i32 s66, s66, 245760
    s_lshl_b32 s78, s69, 6
    s_add_u32 s66, s66, s78
    s_mul_i32 s67, s72, 12288
    s_add_u32 s67, s67, 57344
DMAX:
    v_mov_b32 v109, v20
    v_and_b32 v25, 15, v0
    v_lshrrev_b32 v26, 4, v0
    v_add_u32 v27, 4, v26
    s_mul_i32 s7, s68, 10240
    s_add_u32 s7, s7, 737280
    v_mul_u32_u24 v20, 1280, v26
    v_add_u32 v20, s7, v20
    s_mul_i32 s7, s68, 81920
    s_add_u32 s7, s7, 46592
    v_mov_b32 v28, s7
    v_cmp_eq_u32 vcc, s68, v26
    s_nop 1
    v_cndmask_b32 v20, v20, v28, vcc
    s_mul_i32 s7, s68, 10240
    s_add_u32 s7, s7, 737280
    v_mul_u32_u24 v21, 1280, v27
    v_add_u32 v21, s7, v21
    s_mul_i32 s7, s68, 81920
    s_add_u32 s7, s7, 46592
    v_mov_b32 v28, s7
    v_cmp_eq_u32 vcc, s68, v27
    s_nop 1
    v_cndmask_b32 v21, v21, v28, vcc
    s_min_u32 s7, s69, 19
    s_lshl_b32 s7, s7, 6
    v_lshl_add_u32 v25, v25, 2, s7
    v_add_u32 v20, v20, v25
    v_add_u32 v21, v21, v25
    buffer_load_dwordx4 a[216:219], v1, s[12:15], s73 offen offset:0 nt
    v_and_b32 v25, 15, v0
    v_bfe_u32 v27, v0, 2, 2
    v_and_b32 v28, 3, v0
    s_mul_i32 s7, s72, 12288
    s_add_u32 s7, s7, 57344
    v_lshl_add_u32 v29, v26, 3, v27
    v_lshlrev_b32 v29, 6, v29
    v_lshl_add_u32 v29, v28, 3, v29
    v_add_u32 v29, s7, v29
    v_accvgpr_write_b32 a246, v29
    s_mul_i32 s7, s72, 3072
    s_add_u32 s7, s7, 32768
    v_lshl_add_u32 v29, v25, 4, s7
    v_lshl_add_u32 v29, v26, 7, v29
    v_accvgpr_write_b32 a247, v29
    s_lshl_b32 s7, s72, 6
    s_add_u32 s7, s7, 45056
    v_and_b32 v29, 1, v26
    v_lshl_add_u32 v29, v29, 5, s7
    v_accvgpr_write_b32 a248, v29
    s_lshl_b32 s7, s72, 8
    s_add_u32 s7, s7, 122368
    v_lshl_add_u32 v29, v0, 2, s7
    v_accvgpr_write_b32 a249, v29
    s_lshl_b32 s81, s69, 6
    s_mul_i32 s80, s68, 1280
    s_add_u32 s80, s80, s81
    s_add_u32 s80, s80, 655360
    s_add_u32 s81, s81, s3
    s_add_u32 s81, s81, 45312
    s_waitcnt vmcnt(13)
    ds_write_b128 v2, a[120:123] offset:0
    ds_write_b128 v3, a[124:127] offset:0
    ds_write_b128 v4, a[128:131] offset:0
    ds_write_b128 v2, a[132:135] offset:3328
    ds_write_b128 v3, a[136:139] offset:3328
    ds_write_b128 v4, a[140:143] offset:3328
    ds_read_b128 a[120:123], v5 offset:0
    ds_read_b128 a[124:127], v5 offset:64
    ds_read_b128 a[128:131], v5 offset:128
    ds_read_b128 a[132:135], v5 offset:192
    ds_read_b128 a[136:139], v5 offset:256
    ds_read_b128 a[140:143], v5 offset:320
    buffer_load_dwordx4 a[220:223], v1, s[12:15], s73 offen offset:1024 nt
    buffer_load_dwordx4 a[224:227], v1, s[12:15], s73 offen offset:2048 nt
    buffer_load_dwordx4 a[228:231], v1, s[12:15], s73 offen offset:3072 nt
    buffer_load_dwordx4 a[232:235], v23, s[12:15], s73 offen offset:0 nt
    buffer_load_dwordx4 a[236:239], v23, s[12:15], s73 offen offset:1024 nt
    s_barrier
    s_waitcnt vmcnt(12)
    ds_write_b128 v2, a[144:147] offset:0
    ds_write_b128 v3, a[148:151] offset:0
    ds_write_b128 v4, a[152:155] offset:0
    ds_write_b128 v2, a[156:159] offset:3328
    ds_write_b128 v3, a[160:163] offset:3328
    ds_write_b128 v4, a[164:167] offset:3328
    ds_read_b128 a[144:147], v5 offset:0
    ds_read_b128 a[148:151], v5 offset:64
    ds_read_b128 a[152:155], v5 offset:128
    ds_read_b128 a[156:159], v5 offset:192
    ds_read_b128 a[160:163], v5 offset:256
    ds_read_b128 a[164:167], v5 offset:320
    buffer_load_dwordx4 v[112:115], v1, s[12:15], s83 offen offset:0 nt
    buffer_load_dwordx4 v[116:119], v1, s[12:15], s83 offen offset:1024 nt
    buffer_load_dwordx4 v[120:123], v1, s[12:15], s83 offen offset:2048 nt
    buffer_load_dwordx4 v[124:127], v1, s[12:15], s83 offen offset:3072 nt
    buffer_load_dwordx4 v[128:131], v23, s[12:15], s83 offen offset:0 nt
    buffer_load_dwordx4 v[132:135], v23, s[12:15], s83 offen offset:1024 nt
    s_barrier
    buffer_load_dwordx2 v[98:99], v100, s[16:19], 0 offen offset:384 sc1
    s_waitcnt vmcnt(13)
    ds_write_b128 v2, a[168:171] offset:0
    ds_write_b128 v3, a[172:175] offset:0
    ds_write_b128 v4, a[176:179] offset:0
    ds_write_b128 v2, a[180:183] offset:3328
    ds_write_b128 v3, a[184:187] offset:3328
    ds_write_b128 v4, a[188:191] offset:3328
    ds_read_b128 a[168:171], v5 offset:0
    ds_read_b128 a[172:175], v5 offset:64
    ds_read_b128 a[176:179], v5 offset:128
    ds_read_b128 a[180:183], v5 offset:192
    ds_read_b128 a[184:187], v5 offset:256
    ds_read_b128 a[188:191], v5 offset:320
    buffer_load_dwordx4 v[136:139], v1, s[12:15], s84 offen offset:0 nt
    buffer_load_dwordx4 v[140:143], v1, s[12:15], s84 offen offset:1024 nt
    buffer_load_dwordx4 v[144:147], v1, s[12:15], s84 offen offset:2048 nt
    buffer_load_dwordx4 v[148:151], v1, s[12:15], s84 offen offset:3072 nt
    buffer_load_dwordx4 v[152:155], v23, s[12:15], s84 offen offset:0 nt
    buffer_load_dwordx4 v[156:159], v23, s[12:15], s84 offen offset:1024 nt
    s_barrier
    s_waitcnt vmcnt(13)
    ds_write_b128 v2, a[216:219] offset:0
    ds_write_b128 v3, a[220:223] offset:0
    ds_write_b128 v4, a[224:227] offset:0
    ds_write_b128 v2, a[228:231] offset:3328
    ds_write_b128 v3, a[232:235] offset:3328
    ds_write_b128 v4, a[236:239] offset:3328
    ds_read_b64_tr_b16 a[192:193], v6 offset:0
    ds_read_b64_tr_b16 a[196:197], v6 offset:32
    ds_read_b64_tr_b16 a[200:201], v6 offset:64
    ds_read_b64_tr_b16 a[204:205], v6 offset:96
    ds_read_b64_tr_b16 a[208:209], v6 offset:128
    ds_read_b64_tr_b16 a[212:213], v6 offset:160
    ds_read_b64_tr_b16 a[216:217], v6 offset:192
    ds_read_b64_tr_b16 a[220:221], v6 offset:224
    ds_read_b64_tr_b16 a[224:225], v6 offset:256
    ds_read_b64_tr_b16 a[228:229], v6 offset:288
    ds_read_b64_tr_b16 a[232:233], v6 offset:320
    ds_read_b64_tr_b16 a[236:237], v6 offset:352
    buffer_load_dwordx4 v[160:163], v1, s[12:15], s85 offen offset:0 nt
    buffer_load_dwordx4 v[164:167], v1, s[12:15], s85 offen offset:1024 nt
    buffer_load_dwordx4 v[168:171], v1, s[12:15], s85 offen offset:2048 nt
    buffer_load_dwordx4 v[172:175], v1, s[12:15], s85 offen offset:3072 nt
    buffer_load_dwordx4 v[176:179], v23, s[12:15], s85 offen offset:0 nt
    buffer_load_dwordx4 v[180:183], v23, s[12:15], s85 offen offset:1024 nt
    s_barrier
    s_waitcnt vmcnt(12)
    s_mov_b32 s76, -1
    v_mov_b32 v97, 125504
    s_cmp_lg_u32 s72, 0
    s_cbranch_scc1 RDYX
    v_cmp_ne_u32 vcc, s96, v98
    s_cbranch_vccnz RDYLOOP
RDYOK:
    v_cmp_ne_u32 vcc, s5, v99
    s_nop 1
    v_mov_b32 v96, vcc_lo
    ds_write_b32 v97, v96
RDYX:
    buffer_load_dwordx4 v[184:187], v1, s[12:15], s86 offen offset:0 nt
    buffer_load_dwordx4 v[188:191], v1, s[12:15], s86 offen offset:1024 nt
    s_waitcnt lgkmcnt(0)
    s_barrier
    ds_read_b32 v96, v97
    s_waitcnt lgkmcnt(0)
    v_readfirstlane_b32 s77, v96
    s_nop 0
    s_cmp_eq_u32 s77, 0
    s_cselect_b32 s10, s18, 0
    s_mov_b32 s8, s16
    s_mov_b32 s9, s17
    s_mov_b32 s11, 0x20000
    buffer_load_dwordx4 a[240:243], v109, s[16:19], 0 offen sc1
    s_mul_i32 s77, s69, 464
    s_add_u32 s77, s77, s3
    s_add_u32 s77, s77, 49152
    s_cmp_eq_u32 s72, 3
    s_cselect_b32 s77, s77, 1879048176
    v_add_u32 v106, s77, v1
    v_mov_b32 v107, 2147483632
    v_cmp_le_u32 vcc, 29, v0
    s_nop 1
    v_cndmask_b32 v106, v106, v107, vcc
    buffer_load_dwordx4 a[240:243], v106, s[16:19], 0 offen sc1
    s_lshl_b32 s77, s69, 2
    s_add_u32 s77, s77, s72
    s_lshl_b32 s78, s77, 8
    s_add_u32 s78, s78, 819200
    s_lshl_b32 s77, s77, 9
    s_sub_u32 s77, s77, 256
    v_lshlrev_b32 v24, 7, v0
    v_add_u32 v25, s77, v24
    v_min_u32 v25, 57472, v25
    v_add_u32 v24, s78, v24
    v_cmp_gt_u32 vcc, 2, v0
    s_nop 1
    v_cndmask_b32 v24, v25, v24, vcc
    s_add_u32 s77, s3, 819200
    s_mov_b64 exec, 63
    buffer_load_dword a243, v24, s[16:19], s77 offen sc1
    s_mov_b64 exec, -1
    s_lshl_b32 s77, s70, 12
    s_mul_i32 s78, s72, 96
    s_add_u32 s77, s77, s78
    s_add_u32 s77, s77, s3
    v_lshrrev_b32 v24, 4, v0
    v_lshlrev_b32 v24, 9, v24
    v_and_b32 v25, 15, v0
    v_min_u32 v25, 11, v25
    v_lshl_add_u32 v24, v25, 3, v24
    buffer_load_dwordx2 v[64:65], v24, s[16:19], s77 offen offset:0 sc1
    buffer_load_dwordx2 v[66:67], v24, s[16:19], s77 offen offset:2048 sc1
    s_cmp_lg_u32 s72, 1
    s_cbranch_scc1 NOBASE0
    s_cmp_ge_u32 s69, 20
    s_cbranch_scc1 NOBASE0
    v_mov_b32 v28, v22
    s_lshl_b32 s77, s69, 6
    s_add_u32 s77, s77, s3
    s_add_u32 s77, s77, 47872
    v_lshlrev_b32 v27, 2, v0
    v_mov_b32_dpp v29, v28 quad_perm:[1,1,1,1] row_mask:0xf bank_mask:0xf
    v_mov_b32_dpp v30, v28 quad_perm:[2,2,2,2] row_mask:0xf bank_mask:0xf
    v_mov_b32_dpp v31, v28 quad_perm:[3,3,3,3] row_mask:0xf bank_mask:0xf
    s_mov_b32 exec_lo, 0x1111
    s_mov_b32 exec_hi, 0x0
    buffer_store_dwordx4 v[28:31], v27, s[8:11], s77 offen
    s_cmp_eq_u32 s10, 0
    s_cbranch_scc1 SLOW1
BACK1:
    s_mov_b64 exec, -1
NOBASE0:
    ds_write_b128 v2, v[112:115] offset:0
    ds_write_b128 v3, v[116:119] offset:0
    ds_write_b128 v4, v[120:123] offset:0
    ds_write_b128 v2, v[124:127] offset:3328
    ds_write_b128 v3, v[128:131] offset:3328
    ds_write_b128 v4, v[132:135] offset:3328
    ds_read_b64_tr_b16 a[194:195], v6 offset:0
    ds_read_b64_tr_b16 a[198:199], v6 offset:32
    ds_read_b64_tr_b16 a[202:203], v6 offset:64
    ds_read_b64_tr_b16 a[206:207], v6 offset:96
    ds_read_b64_tr_b16 a[210:211], v6 offset:128
    ds_read_b64_tr_b16 a[214:215], v6 offset:160
    ds_read_b64_tr_b16 a[218:219], v6 offset:192
    ds_read_b64_tr_b16 a[222:223], v6 offset:224
    ds_read_b64_tr_b16 a[226:227], v6 offset:256
    ds_read_b64_tr_b16 a[230:231], v6 offset:288
    ds_read_b64_tr_b16 a[234:235], v6 offset:320
    ds_read_b64_tr_b16 a[238:239], v6 offset:352
    s_waitcnt vmcnt(13)
    ds_write_b128 v2, v[136:139] offset:0
    ds_write_b128 v3, v[140:143] offset:0
    ds_write_b128 v4, v[144:147] offset:0
    ds_write_b128 v2, v[148:151] offset:3328
    ds_write_b128 v3, v[152:155] offset:3328
    ds_write_b128 v4, v[156:159] offset:3328
    ds_read_b64_tr_b16 v[112:113], v6 offset:0
    ds_read_b64_tr_b16 v[116:117], v6 offset:32
    ds_read_b64_tr_b16 v[120:121], v6 offset:64
    ds_read_b64_tr_b16 v[124:125], v6 offset:96
    ds_read_b64_tr_b16 v[128:129], v6 offset:128
    ds_read_b64_tr_b16 v[132:133], v6 offset:160
    ds_read_b64_tr_b16 v[136:137], v6 offset:192
    ds_read_b64_tr_b16 v[140:141], v6 offset:224
    ds_read_b64_tr_b16 v[144:145], v6 offset:256
    ds_read_b64_tr_b16 v[148:149], v6 offset:288
    ds_read_b64_tr_b16 v[152:153], v6 offset:320
    ds_read_b64_tr_b16 v[156:157], v6 offset:352
    buffer_load_dwordx4 v[192:195], v1, s[12:15], s86 offen offset:2048 nt
    buffer_load_dwordx4 v[196:199], v1, s[12:15], s86 offen offset:3072 nt
    buffer_load_dwordx4 v[200:203], v23, s[12:15], s86 offen offset:0 nt
    buffer_load_dwordx4 v[204:207], v23, s[12:15], s86 offen offset:1024 nt
    s_barrier
    buffer_load_dwordx4 v[208:211], v1, s[12:15], s87 offen offset:0 nt
    s_waitcnt vmcnt(12)
    ds_write_b128 v2, v[160:163] offset:0
    ds_write_b128 v3, v[164:167] offset:0
    ds_write_b128 v4, v[168:171] offset:0
    ds_write_b128 v2, v[172:175] offset:3328
    ds_write_b128 v3, v[176:179] offset:3328
    ds_write_b128 v4, v[180:183] offset:3328
    ds_read_b64_tr_b16 v[114:115], v6 offset:0
    ds_read_b64_tr_b16 v[118:119], v6 offset:32
    ds_read_b64_tr_b16 v[122:123], v6 offset:64
    ds_read_b64_tr_b16 v[126:127], v6 offset:96
    ds_read_b64_tr_b16 v[130:131], v6 offset:128
    ds_read_b64_tr_b16 v[134:135], v6 offset:160
    ds_read_b64_tr_b16 v[138:139], v6 offset:192
    ds_read_b64_tr_b16 v[142:143], v6 offset:224
    ds_read_b64_tr_b16 v[146:147], v6 offset:256
    ds_read_b64_tr_b16 v[150:151], v6 offset:288
    ds_read_b64_tr_b16 v[154:155], v6 offset:320
    ds_read_b64_tr_b16 v[158:159], v6 offset:352
    buffer_load_dwordx4 v[212:215], v1, s[12:15], s87 offen offset:1024 nt
    buffer_load_dwordx4 v[216:219], v1, s[12:15], s87 offen offset:2048 nt
    buffer_load_dwordx4 v[220:223], v1, s[12:15], s87 offen offset:3072 nt
    buffer_load_dwordx4 v[224:227], v23, s[12:15], s87 offen offset:0 nt
    buffer_load_dwordx4 v[228:231], v23, s[12:15], s87 offen offset:1024 nt
    s_barrier
    buffer_load_dwordx4 v[232:235], v1, s[12:15], s88 offen offset:0 nt
    buffer_load_dwordx4 v[236:239], v1, s[12:15], s88 offen offset:1024 nt
    s_waitcnt vmcnt(12)
    v_lshlrev_b32 v24, 16, v64
    v_and_b32 v25, 0xffff0000, v64
    v_lshlrev_b32 v26, 16, v65
    v_and_b32 v27, 0xffff0000, v65
    v_lshlrev_b32 v28, 16, v66
    v_and_b32 v29, 0xffff0000, v66
    v_lshlrev_b32 v30, 16, v67
    v_and_b32 v31, 0xffff0000, v67
    v_add_f32 v24, v24, v28
    v_add_f32 v25, v25, v29
    v_add_f32 v26, v26, v30
    v_add_f32 v27, v27, v31
    s_nop 0
    v_permlane32_swap_b32 v24, v26
    v_permlane32_swap_b32 v25, v27
    v_add_f32 v24, v24, v26
    v_add_f32 v25, v25, v27
    s_nop 1
    v_permlane16_swap_b32 v24, v25
    v_add_f32 v24, v24, v25
    v_cvt_pk_bf16_f32 v24, v24, v24
    ds_write_b16 v12, v24
    buffer_load_dwordx4 v[240:243], v1, s[12:15], s88 offen offset:2048 nt
    v_mov_b32 v40, 0
    v_mov_b32 v41, 0
    v_mov_b32 v44, 0
    v_mov_b32 v45, 0
    v_mov_b32 v48, 0
    v_mov_b32 v49, 0
    v_mov_b32 v52, 0
    v_mov_b32 v53, 0
    v_mov_b32 v56, 0
    v_mov_b32 v57, 0
    v_mov_b32 v60, 0
    v_mov_b32 v61, 0
    v_mov_b32 v64, 0
    v_mov_b32 v65, 0
    v_mov_b32 v68, 0
    v_mov_b32 v69, 0
    v_mov_b32 v72, 0
    v_mov_b32 v73, 0
    v_mov_b32 v74, 0
    v_mov_b32 v75, 0
    v_mov_b32 v76, 0
    v_mov_b32 v77, 0
    v_mov_b32 v78, 0
    v_mov_b32 v79, 0
    v_mov_b32 v80, 0
    v_mov_b32 v81, 0
    v_mov_b32 v82, 0
    v_mov_b32 v83, 0
    v_mov_b32 v84, 0
    v_mov_b32 v85, 0
    v_mov_b32 v86, 0
    v_mov_b32 v87, 0
    buffer_load_dwordx4 v[244:247], v1, s[12:15], s88 offen offset:3072 nt
    buffer_load_dwordx4 v[248:251], v23, s[12:15], s88 offen offset:0 nt
    s_waitcnt lgkmcnt(0)
    s_barrier
    ds_read_b128 v[28:31], v13 offset:0
    ds_read_b128 v[32:35], v13 offset:128
    ds_read_b128 v[36:39], v13 offset:256
    v_mov_b32 v18, 0x3dd53b94
    s_waitcnt lgkmcnt(2)
    v_smfmac_f32_16x16x64_bf16 v[40:43], v[28:31], a[0:7], v14
    v_smfmac_f32_16x16x64_bf16 v[44:47], v[28:31], a[24:31], v14
    v_smfmac_f32_16x16x64_bf16 v[48:51], v[28:31], a[48:55], v14
    v_smfmac_f32_16x16x64_bf16 v[52:55], v[28:31], a[72:79], v14
    v_smfmac_f32_16x16x64_bf16 v[56:59], v[28:31], a[96:103], v14
    v_smfmac_f32_16x16x64_bf16 v[60:63], v[28:31], a[120:127], v14
    v_smfmac_f32_16x16x64_bf16 v[64:67], v[28:31], a[144:151], v14
    v_smfmac_f32_16x16x64_bf16 v[68:71], v[28:31], a[168:175], v14
    buffer_load_dwordx4 v[252:255], v23, s[12:15], s88 offen offset:1024 nt
    s_barrier
    s_waitcnt lgkmcnt(1)
    v_smfmac_f32_16x16x64_bf16 v[40:43], v[32:35], a[8:15], v14
    v_smfmac_f32_16x16x64_bf16 v[44:47], v[32:35], a[32:39], v14
    v_smfmac_f32_16x16x64_bf16 v[48:51], v[32:35], a[56:63], v14
    v_smfmac_f32_16x16x64_bf16 v[52:55], v[32:35], a[80:87], v14
    v_smfmac_f32_16x16x64_bf16 v[56:59], v[32:35], a[104:111], v14
    v_smfmac_f32_16x16x64_bf16 v[60:63], v[32:35], a[128:135], v14
    v_smfmac_f32_16x16x64_bf16 v[64:67], v[32:35], a[152:159], v14
    v_smfmac_f32_16x16x64_bf16 v[68:71], v[32:35], a[176:183], v14
    s_waitcnt lgkmcnt(0)
    v_smfmac_f32_16x16x64_bf16 v[40:43], v[36:39], a[16:23], v14
    v_smfmac_f32_16x16x64_bf16 v[44:47], v[36:39], a[40:47], v14
    v_smfmac_f32_16x16x64_bf16 v[48:51], v[36:39], a[64:71], v14
    v_smfmac_f32_16x16x64_bf16 v[52:55], v[36:39], a[88:95], v14
    v_smfmac_f32_16x16x64_bf16 v[56:59], v[36:39], a[112:119], v14
    v_smfmac_f32_16x16x64_bf16 v[60:63], v[36:39], a[136:143], v14
    v_smfmac_f32_16x16x64_bf16 v[64:67], v[36:39], a[160:167], v14
    v_smfmac_f32_16x16x64_bf16 v[68:71], v[36:39], a[184:191], v14
    s_nop 0
    v_add_f32 v24, v40, v41
    v_add_f32 v44, v44, v45
    v_add_f32 v48, v48, v49
    v_max3_f32 v26, v24, v44, v48
    v_add_f32 v52, v52, v53
    v_add_f32 v25, v56, v57
    v_max3_f32 v26, v26, v52, v25
    v_add_f32 v60, v60, v61
    v_add_f32 v64, v64, v65
    v_max3_f32 v26, v26, v60, v64
    v_add_f32 v68, v68, v69
    v_max_f32 v26, v26, v68
    v_mov_b32_dpp v24, v44 quad_perm:[0,1,2,3] row_mask:0x2 bank_mask:0xf
    v_mov_b32_dpp v25, v60 quad_perm:[0,1,2,3] row_mask:0x2 bank_mask:0xf
    v_max_f32_dpp v26, v26, v26 row_ror:8 row_mask:0xf bank_mask:0xf
    v_mov_b32_dpp v24, v48 quad_perm:[0,1,2,3] row_mask:0x4 bank_mask:0xf
    v_mov_b32_dpp v25, v64 quad_perm:[0,1,2,3] row_mask:0x4 bank_mask:0xf
    v_max_f32_dpp v26, v26, v26 row_ror:4 row_mask:0xf bank_mask:0xf
    v_mov_b32_dpp v24, v52 quad_perm:[0,1,2,3] row_mask:0x8 bank_mask:0xf
    v_mov_b32_dpp v25, v68 quad_perm:[0,1,2,3] row_mask:0x8 bank_mask:0xf
    v_max_f32_dpp v26, v26, v26 row_ror:2 row_mask:0xf bank_mask:0xf
    v_accvgpr_read_b32 v27, a252
    s_nop 0
    v_max_f32_dpp v26, v26, v26 row_ror:1 row_mask:0xf bank_mask:0xf
    v_mul_f32 v26, v26, v18
    v_fma_f32 v24, v24, v18, -v26
    v_fma_f32 v25, v25, v18, -v26
    v_exp_f32 v24, v24
    v_exp_f32 v25, v25
    s_nop 0
    v_cvt_pk_bf16_f32 v28, v24, v25
    ds_write_b16 v19, v28
    ds_write_b16_d16_hi v19, v28 offset:128
    s_mov_b32 exec_lo, 0xff00ff
    s_mov_b32 exec_hi, 0xff00ff00
    ds_read_b128 v[72:75], v27 offset:0
    ds_read_b128 v[76:79], v27 offset:64
    ds_read_b128 v[80:83], v27 offset:128
    ds_read_b128 v[84:87], v27 offset:192
    s_mov_b64 exec, -1
    v_add_f32 v27, v24, v25
    v_mov_b32 v40, 0
    v_mov_b32 v44, 0
    v_add_f32_dpp v27, v27, v27 row_ror:8 row_mask:0xf bank_mask:0xf
    v_mov_b32 v48, 0
    v_mov_b32 v52, 0
    v_add_f32_dpp v27, v27, v27 row_ror:4 row_mask:0xf bank_mask:0xf
    v_mov_b32 v56, 0
    v_mov_b32 v60, 0
    v_add_f32_dpp v27, v27, v27 row_ror:2 row_mask:0xf bank_mask:0xf
    s_lshl_b32 s78, s72, 3
    s_add_u32 s78, s78, 125440
    v_add_f32_dpp v27, v27, v27 row_ror:1 row_mask:0xf bank_mask:0xf
    v_mov_b32 v28, v27
    s_nop 1
    v_permlane32_swap_b32 v27, v28
    v_add_f32 v27, v27, v28
    v_mov_b32 v28, v27
    s_nop 1
    v_permlane16_swap_b32 v27, v28
    v_add_f32 v27, v27, v28
    v_mov_b32 v28, s78
    ds_write_b64 v28, v[26:27]
    s_waitcnt lgkmcnt(0)
    v_smfmac_f32_16x16x64_bf16 v[40:43], v[72:75], a[192:199], v14 abid:1
    v_smfmac_f32_16x16x64_bf16 v[44:47], v[72:75], a[200:207], v14 abid:1
    v_smfmac_f32_16x16x64_bf16 v[48:51], v[72:75], a[208:215], v14 abid:1
    v_smfmac_f32_16x16x64_bf16 v[52:55], v[72:75], a[216:223], v14 abid:1
    v_smfmac_f32_16x16x64_bf16 v[56:59], v[72:75], a[224:231], v14 abid:1
    v_smfmac_f32_16x16x64_bf16 v[60:63], v[72:75], a[232:239], v14 abid:1
    v_smfmac_f32_16x16x64_bf16 v[40:43], v[76:79], v[112:119], v14 abid:1
    v_smfmac_f32_16x16x64_bf16 v[44:47], v[76:79], v[120:127], v14 abid:1
    v_smfmac_f32_16x16x64_bf16 v[48:51], v[76:79], v[128:135], v14 abid:1
    v_smfmac_f32_16x16x64_bf16 v[52:55], v[76:79], v[136:143], v14 abid:1
    v_smfmac_f32_16x16x64_bf16 v[56:59], v[76:79], v[144:151], v14 abid:1
    v_smfmac_f32_16x16x64_bf16 v[60:63], v[76:79], v[152:159], v14 abid:1
    s_waitcnt vmcnt(12)
    ds_write_b128 v2, v[184:187] offset:0
    ds_write_b128 v3, v[188:191] offset:0
    ds_write_b128 v4, v[192:195] offset:0
    ds_write_b128 v2, v[196:199] offset:3328
    ds_write_b128 v3, v[200:203] offset:3328
    ds_write_b128 v4, v[204:207] offset:3328
    ds_read_b64_tr_b16 v[160:161], v6 offset:0
    ds_read_b64_tr_b16 v[164:165], v6 offset:32
    ds_read_b64_tr_b16 v[168:169], v6 offset:64
    ds_read_b64_tr_b16 v[172:173], v6 offset:96
    ds_read_b64_tr_b16 v[176:177], v6 offset:128
    ds_read_b64_tr_b16 v[180:181], v6 offset:160
    ds_read_b64_tr_b16 v[184:185], v6 offset:192
    ds_read_b64_tr_b16 v[188:189], v6 offset:224
    ds_read_b64_tr_b16 v[192:193], v6 offset:256
    ds_read_b64_tr_b16 v[196:197], v6 offset:288
    ds_read_b64_tr_b16 v[200:201], v6 offset:320
    ds_read_b64_tr_b16 v[204:205], v6 offset:352
    v_mov_b32 v24, -1
    v_mov_b32 v25, -1
    v_mov_b32 v26, -1
    v_mov_b32 v27, -1
    buffer_store_dwordx4 v[24:27], v106, s[8:11], 0 offen
    s_cmp_eq_u32 s10, 0
    s_cbranch_scc1 SLOW2
BACK2:
    buffer_load_dwordx4 v[88:91], v1, s[12:15], s89 offen offset:0 nt
    buffer_load_dwordx4 v[92:95], v1, s[12:15], s89 offen offset:1024 nt
    buffer_load_dwordx4 v[96:99], v1, s[12:15], s89 offen offset:2048 nt
    buffer_load_dwordx4 v[100:103], v1, s[12:15], s89 offen offset:3072 nt
    buffer_load_dwordx4 v[104:107], v23, s[12:15], s89 offen offset:0 nt
    buffer_load_dwordx4 v[108:111], v23, s[12:15], s89 offen offset:1024 nt
    s_waitcnt vmcnt(13)
    ds_write_b128 v2, v[208:211] offset:0
    ds_write_b128 v3, v[212:215] offset:0
    ds_write_b128 v4, v[216:219] offset:0
    ds_write_b128 v2, v[220:223] offset:3328
    ds_write_b128 v3, v[224:227] offset:3328
    ds_write_b128 v4, v[228:231] offset:3328
    ds_read_b64_tr_b16 v[162:163], v6 offset:0
    ds_read_b64_tr_b16 v[166:167], v6 offset:32
    ds_read_b64_tr_b16 v[170:171], v6 offset:64
    ds_read_b64_tr_b16 v[174:175], v6 offset:96
    ds_read_b64_tr_b16 v[178:179], v6 offset:128
    ds_read_b64_tr_b16 v[182:183], v6 offset:160
    ds_read_b64_tr_b16 v[186:187], v6 offset:192
    ds_read_b64_tr_b16 v[190:191], v6 offset:224
    ds_read_b64_tr_b16 v[194:195], v6 offset:256
    ds_read_b64_tr_b16 v[198:199], v6 offset:288
    ds_read_b64_tr_b16 v[202:203], v6 offset:320
    ds_read_b64_tr_b16 v[206:207], v6 offset:352
    v_and_b32 v23, 0xffff0000, v22
    v_lshlrev_b32 v22, 16, v22
    s_mov_b32 s82, 0x1010101
    s_mov_b32 s83, 0x1010101
    s_mov_b32 s84, 0x1ff01ff
    s_mov_b32 s85, 0x1ff01ff
    s_mov_b32 s86, 0xffffffff
    s_mov_b32 s87, 0x1fff
    s_mov_b32 s50, 0x7fffff
    s_mov_b32 s51, 0x0
    s_mov_b32 s88, 0xff00ff
    s_mov_b32 s89, 0xff00ff00
    s_mov_b32 s92, 0x1010101
    s_mov_b32 s93, 0x0
    s_mov_b32 s44, 0xf0f0f0f
    s_mov_b32 s45, 0xf0f0f0f
    s_mov_b64 s[46:47], s[92:93]
    s_mov_b64 s[48:49], s[44:45]
    s_cmp_ge_u32 s69, 20
    s_cbranch_scc1 TAILF
    v_mov_b32 v24, -1
    v_mov_b32 v25, -1
    v_mov_b32 v26, -1
    v_mov_b32 v27, -1
    v_and_b32 v28, 3, v0
    v_lshrrev_b32 v29, 5, v0
    v_lshl_add_u32 v28, v29, 2, v28
    v_mul_u32_u24 v28, 10240, v28
    v_bfe_u32 v29, v0, 3, 2
    v_lshl_add_u32 v28, v29, 4, v28
    s_cmp_eq_u32 s72, 3
    s_cselect_b32 s77, 0, 1879048176
    v_add_u32 v28, s77, v28
    s_add_u32 s77, s80, 81920
    s_mov_b64 exec, s[44:45]
    buffer_store_dwordx4 v[24:27], v28, s[16:19], s77 offen sc1
    s_mov_b64 exec, -1
    v_lshrrev_b32 v38, 2, v0
    v_mul_u32_u24 v38, 1280, v38
    v_and_b32 v39, 3, v0
    v_lshl_add_u32 v39, v39, 4, v38
    s_mov_b32 m0, s67
    s_add_u32 s67, s67, 1024
    buffer_load_dwordx4 v39, s[24:27], s66 offen  lds
    s_add_u32 s66, s66, 20480
    s_mov_b32 m0, s67
    s_add_u32 s67, s67, 1024
    buffer_load_dwordx4 v39, s[24:27], s66 offen  lds
    s_add_u32 s66, s66, 20480
    s_mov_b32 m0, s67
    s_add_u32 s67, s67, 1024
    buffer_load_dwordx4 v39, s[24:27], s66 offen  lds
    s_add_u32 s66, s66, 20480
    s_waitcnt lgkmcnt(0)
    v_smfmac_f32_16x16x64_bf16 v[40:43], v[80:83], v[160:167], v14 abid:1
    v_smfmac_f32_16x16x64_bf16 v[44:47], v[80:83], v[168:175], v14 abid:1
    v_smfmac_f32_16x16x64_bf16 v[48:51], v[80:83], v[176:183], v14 abid:1
    v_smfmac_f32_16x16x64_bf16 v[52:55], v[80:83], v[184:191], v14 abid:1
    v_smfmac_f32_16x16x64_bf16 v[56:59], v[80:83], v[192:199], v14 abid:1
    v_smfmac_f32_16x16x64_bf16 v[60:63], v[80:83], v[200:207], v14 abid:1
    s_waitcnt vmcnt(11)
    ds_write_b128 v2, v[232:235] offset:0
    ds_write_b128 v3, v[236:239] offset:0
    ds_write_b128 v4, v[240:243] offset:0
    ds_write_b128 v2, v[244:247] offset:3328
    ds_write_b128 v3, v[248:251] offset:3328
    ds_write_b128 v4, v[252:255] offset:3328
    ds_read_b64_tr_b16 v[208:209], v6 offset:0
    ds_read_b64_tr_b16 v[212:213], v6 offset:32
    ds_read_b64_tr_b16 v[216:217], v6 offset:64
    ds_read_b64_tr_b16 v[220:221], v6 offset:96
    ds_read_b64_tr_b16 v[224:225], v6 offset:128
    ds_read_b64_tr_b16 v[228:229], v6 offset:160
    ds_read_b64_tr_b16 v[232:233], v6 offset:192
    ds_read_b64_tr_b16 v[236:237], v6 offset:224
    ds_read_b64_tr_b16 v[240:241], v6 offset:256
    ds_read_b64_tr_b16 v[244:245], v6 offset:288
    ds_read_b64_tr_b16 v[248:249], v6 offset:320
    ds_read_b64_tr_b16 v[252:253], v6 offset:352
    s_mov_b32 m0, s67
    s_add_u32 s67, s67, 1024
    buffer_load_dwordx4 v39, s[24:27], s66 offen  lds
    s_add_u32 s66, s66, 20480
    s_mov_b32 m0, s67
    s_add_u32 s67, s67, 1024
    buffer_load_dwordx4 v39, s[24:27], s66 offen  lds
    s_add_u32 s66, s66, 20480
    s_mov_b32 m0, s67
    s_add_u32 s67, s67, 1024
    buffer_load_dwordx4 v39, s[24:27], s66 offen  lds
    s_add_u32 s66, s66, 20480
    s_waitcnt vmcnt(12)
    ds_write_b128 v2, v[88:91] offset:0
    s_waitcnt vmcnt(11)
    ds_write_b128 v3, v[92:95] offset:0
    s_waitcnt vmcnt(10)
    ds_write_b128 v4, v[96:99] offset:0
    s_waitcnt vmcnt(9)
    ds_write_b128 v2, v[100:103] offset:3328
    s_waitcnt vmcnt(8)
    ds_write_b128 v3, v[104:107] offset:3328
    s_waitcnt vmcnt(7)
    ds_write_b128 v4, v[108:111] offset:3328
    ds_read_b64_tr_b16 v[210:211], v6 offset:0
    ds_read_b64_tr_b16 v[214:215], v6 offset:32
    ds_read_b64_tr_b16 v[218:219], v6 offset:64
    ds_read_b64_tr_b16 v[222:223], v6 offset:96
    ds_read_b64_tr_b16 v[226:227], v6 offset:128
    ds_read_b64_tr_b16 v[230:231], v6 offset:160
    ds_read_b64_tr_b16 v[234:235], v6 offset:192
    ds_read_b64_tr_b16 v[238:239], v6 offset:224
    ds_read_b64_tr_b16 v[242:243], v6 offset:256
    ds_read_b64_tr_b16 v[246:247], v6 offset:288
    ds_read_b64_tr_b16 v[250:251], v6 offset:320
    ds_read_b64_tr_b16 v[254:255], v6 offset:352
    s_branch ATT_LAST
TAILF:
    s_lshl_b32 s90, s72, 3
    s_add_u32 s90, s90, s68
    s_add_u32 s90, s90, 1
    s_mul_i32 s90, s90, 245760
    s_sub_u32 s78, 32, s69
    s_mul_i32 s78, s78, 10240
    s_sub_u32 s90, s90, s78
    buffer_load_dwordx4 a[240:243], v1, s[20:23], s90 offen offset:0
    buffer_load_dwordx4 a[240:243], v1, s[20:23], s90 offen offset:1024
    buffer_load_dwordx4 a[240:243], v1, s[20:23], s90 offen offset:2048
    buffer_load_dwordx4 a[240:243], v1, s[20:23], s90 offen offset:3072
    s_add_u32 s90, s90, 4096
    buffer_load_dwordx4 a[240:243], v1, s[20:23], s90 offen offset:0
    buffer_load_dwordx4 a[240:243], v1, s[20:23], s90 offen offset:1024
    buffer_load_dwordx4 a[240:243], v1, s[20:23], s90 offen offset:2048
    v_lshrrev_b32 v38, 3, v0
    v_mul_u32_u24 v38, 3072, v38
    v_and_b32 v39, 7, v0
    v_lshl_add_u32 v38, v39, 4, v38
    v_bfe_u32 v39, v0, 4, 1
    v_lshlrev_b32 v39, 5, v39
    v_xor_b32 v38, v38, v39
    v_xor_b32 v39, 64, v38
    s_waitcnt lgkmcnt(0)
    v_smfmac_f32_16x16x64_bf16 v[40:43], v[80:83], v[160:167], v14 abid:1
    v_smfmac_f32_16x16x64_bf16 v[44:47], v[80:83], v[168:175], v14 abid:1
    v_smfmac_f32_16x16x64_bf16 v[48:51], v[80:83], v[176:183], v14 abid:1
    v_smfmac_f32_16x16x64_bf16 v[52:55], v[80:83], v[184:191], v14 abid:1
    v_smfmac_f32_16x16x64_bf16 v[56:59], v[80:83], v[192:199], v14 abid:1
    v_smfmac_f32_16x16x64_bf16 v[60:63], v[80:83], v[200:207], v14 abid:1
    s_waitcnt vmcnt(14)
    ds_write_b128 v2, v[232:235] offset:0
    ds_write_b128 v3, v[236:239] offset:0
    ds_write_b128 v4, v[240:243] offset:0
    ds_write_b128 v2, v[244:247] offset:3328
    ds_write_b128 v3, v[248:251] offset:3328
    ds_write_b128 v4, v[252:255] offset:3328
    ds_read_b64_tr_b16 v[208:209], v6 offset:0
    ds_read_b64_tr_b16 v[212:213], v6 offset:32
    ds_read_b64_tr_b16 v[216:217], v6 offset:64
    ds_read_b64_tr_b16 v[220:221], v6 offset:96
    ds_read_b64_tr_b16 v[224:225], v6 offset:128
    ds_read_b64_tr_b16 v[228:229], v6 offset:160
    ds_read_b64_tr_b16 v[232:233], v6 offset:192
    ds_read_b64_tr_b16 v[236:237], v6 offset:224
    ds_read_b64_tr_b16 v[240:241], v6 offset:256
    ds_read_b64_tr_b16 v[244:245], v6 offset:288
    ds_read_b64_tr_b16 v[248:249], v6 offset:320
    ds_read_b64_tr_b16 v[252:253], v6 offset:352
    buffer_load_dwordx4 a[240:243], v1, s[20:23], s90 offen offset:3072
    s_add_u32 s90, s90, 4096
    buffer_load_dwordx4 a[240:243], v1, s[20:23], s90 offen offset:0
    buffer_load_dwordx4 a[240:243], v1, s[20:23], s90 offen offset:1024
    s_waitcnt vmcnt(15)
    ds_write_b128 v2, v[88:91] offset:0
    s_waitcnt vmcnt(14)
    ds_write_b128 v3, v[92:95] offset:0
    s_waitcnt vmcnt(13)
    ds_write_b128 v4, v[96:99] offset:0
    s_waitcnt vmcnt(12)
    ds_write_b128 v2, v[100:103] offset:3328
    s_waitcnt vmcnt(11)
    ds_write_b128 v3, v[104:107] offset:3328
    s_waitcnt vmcnt(10)
    ds_write_b128 v4, v[108:111] offset:3328
    ds_read_b64_tr_b16 v[210:211], v6 offset:0
    ds_read_b64_tr_b16 v[214:215], v6 offset:32
    ds_read_b64_tr_b16 v[218:219], v6 offset:64
    ds_read_b64_tr_b16 v[222:223], v6 offset:96
    ds_read_b64_tr_b16 v[226:227], v6 offset:128
    ds_read_b64_tr_b16 v[230:231], v6 offset:160
    ds_read_b64_tr_b16 v[234:235], v6 offset:192
    ds_read_b64_tr_b16 v[238:239], v6 offset:224
    ds_read_b64_tr_b16 v[242:243], v6 offset:256
    ds_read_b64_tr_b16 v[246:247], v6 offset:288
    ds_read_b64_tr_b16 v[250:251], v6 offset:320
    ds_read_b64_tr_b16 v[254:255], v6 offset:352
    s_branch ATT_LAST
LOOP:
    s_cmp_lt_u32 s69, 20
    s_cselect_b32 s5, s72, 4
    s_add_u32 s96, s3, 819200
    s_add_u32 s97, s96, 4096
    s_and_b32 s77, s5, 3
    s_cbranch_scc1 LOOP2
    ds_read_b64_tr_b16 v[40:41], v16 offset:0
    ds_read_b64_tr_b16 v[42:43], v16 offset:1536
    ds_read_b64_tr_b16 v[44:45], v16 offset:12288
    ds_read_b64_tr_b16 v[46:47], v16 offset:13824
    ds_read_b64_tr_b16 v[48:49], v17 offset:24576
    ds_read_b64_tr_b16 v[50:51], v16 offset:32
    ds_read_b64_tr_b16 v[52:53], v16 offset:1568
    ds_read_b64_tr_b16 v[54:55], v16 offset:12320
    ds_read_b64_tr_b16 v[56:57], v16 offset:13856
    ds_read_b64_tr_b16 v[58:59], v17 offset:24608
    ds_read_b64_tr_b16 v[60:61], v16 offset:64
    ds_read_b64_tr_b16 v[62:63], v16 offset:1600
    ds_read_b64_tr_b16 v[64:65], v16 offset:12352
    ds_read_b64_tr_b16 v[66:67], v16 offset:13888
    ds_read_b64_tr_b16 v[68:69], v17 offset:24640
    v_and_b32 v25, 15, v0
    v_cmp_eq_u32 vcc, 12, v25
    v_mov_b32 v36, 0x3f803f80
    s_nop 0
    v_cndmask_b32 v70, 0, v36, vcc
    v_mov_b32 v71, v70
    v_mov_b32 v72, v70
    v_mov_b32 v73, v70
    v_mov_b32 v74, v70
    v_mov_b32 v75, v70
    v_mov_b32 v76, v70
    v_mov_b32 v77, v70
    v_mov_b32 v78, v70
    v_mov_b32 v79, v70
    s_mov_b32 s77, 4096
    v_mul_u32_u24 v96, 103, v0
    v_lshrrev_b32 v96, 10, v96
    v_lshl_add_u32 v96, v96, 4, v1
    v_add_u32 v96, s77, v96
    v_mul_u32_u24 v97, 176, v25
    v_add_u32 v97, s77, v97
    v_lshrrev_b32 v28, 4, v0
    v_lshl_add_u32 v98, v28, 3, v97
    v_lshl_add_u32 v97, v28, 4, v97
LOOP2:
    s_add_u32 s79, s3, 4096
    s_mul_i32 s77, s71, 160
    s_add_u32 s77, s77, s3
    s_sub_u32 s77, s77, 772608
    s_mov_b32 exec_lo, 0x3ff
    s_mov_b32 exec_hi, 0x0
    s_mov_b32 s76, 1
POLL3:
    buffer_load_dword v24, v1, s[16:19], s77 offen sc1
POLLW3:
    s_waitcnt vmcnt(0)
    v_cmp_eq_u32 vcc, -1, v24
    s_cbranch_vccnz AGAIN3
POLLX3:
    s_mov_b64 exec, s[50:51]
    buffer_load_dwordx4 v[80:83], v8, s[16:19], 0 offen sc1
    s_mov_b64 exec, -1
    buffer_load_dwordx4 v[88:91], v11, s[16:19], s96 offen sc1
    buffer_load_dwordx4 v[92:95], v11, s[16:19], s97 offen sc1
    s_mov_b64 exec, s[50:51]
    s_waitcnt vmcnt(2)
BW4:
    ds_write_b128 v9, v[80:83]
    v_cmp_eq_u32 vcc, -1, v80
    s_cbranch_vccnz BR4
BX4:
    s_mov_b64 exec, s[84:85]
    s_waitcnt lgkmcnt(0)
    s_barrier
    ds_read_b128 v[70:73], v97
    ds_read_b128 v[74:77], v97 offset:64
    ds_read_b64 v[78:79], v98 offset:128
    s_mov_b64 exec, -1
    s_cmp_lg_u32 s5, 1
    s_cbranch_scc1 NOOWL
    buffer_load_dword a244, v20, s[16:19], 0 offen sc1
    buffer_load_dword a245, v21, s[16:19], 0 offen sc1
NOOWL:
    s_waitcnt lgkmcnt(2)
    v_mfma_f32_16x16x32_bf16 v[24:27], v[70:73], v[40:43], 0
    v_mfma_f32_16x16x32_bf16 v[32:35], v[70:73], v[60:63], 0
    s_waitcnt lgkmcnt(0)
    v_mfma_f32_16x16x32_bf16 v[24:27], v[74:77], v[44:47], v[24:27]
    v_mfma_f32_16x16x32_bf16 v[32:35], v[74:77], v[64:67], v[32:35]
    v_mfma_f32_16x16x16_bf16 v[24:27], v[78:79], v[48:49], v[24:27]
    v_mfma_f32_16x16x16_bf16 v[32:35], v[78:79], v[68:69], v[32:35]
    v_mfma_f32_16x16x32_bf16 v[28:31], v[70:73], v[50:53], 0
    v_mfma_f32_16x16x32_bf16 v[36:39], v[70:73], v[70:73], 0
    v_mfma_f32_16x16x32_bf16 v[28:31], v[74:77], v[54:57], v[28:31]
    v_mfma_f32_16x16x32_bf16 v[36:39], v[74:77], v[74:77], v[36:39]
    v_mfma_f32_16x16x16_bf16 v[28:31], v[78:79], v[58:59], v[28:31]
    v_mfma_f32_16x16x16_bf16 v[36:39], v[78:79], v[78:79], v[36:39]
    s_nop 0
    v_add_f32 v24, v24, v25
    v_add_f32 v26, v26, v27
    v_add_f32 v24, v24, v26
    v_add_f32 v32, v32, v33
    v_add_f32 v34, v34, v35
    v_add_f32 v32, v32, v34
    s_nop 1
    v_permlane32_swap_b32 v24, v32
    v_add_f32 v28, v28, v29
    v_add_f32 v30, v30, v31
    v_add_f32 v36, v36, v37
    v_add_f32 v38, v38, v39
    v_add_f32 v24, v24, v32
    v_add_f32 v28, v28, v30
    v_add_f32 v36, v36, v38
    s_nop 1
    v_permlane32_swap_b32 v28, v36
    v_add_f32 v28, v28, v36
    s_nop 1
    v_permlane16_swap_b32 v24, v28
    v_add_f32 v24, v24, v28
    buffer_store_dword v24, v10, s[8:11], s3 offen
    s_cmp_eq_u32 s10, 0
    s_cbranch_scc1 SLOW5
BACK5:
    v_mov_b32 v40, 0
    v_mov_b32 v41, 0
    v_mov_b32 v44, 0
    v_mov_b32 v45, 0
    v_mov_b32 v48, 0
    v_mov_b32 v49, 0
    v_mov_b32 v52, 0
    v_mov_b32 v53, 0
    v_mov_b32 v56, 0
    v_mov_b32 v57, 0
    v_mov_b32 v60, 0
    v_mov_b32 v61, 0
    v_mov_b32 v64, 0
    v_mov_b32 v65, 0
    v_mov_b32 v68, 0
    v_mov_b32 v69, 0
    v_mov_b32 v72, 0
    v_mov_b32 v73, 0
    v_mov_b32 v74, 0
    v_mov_b32 v75, 0
    v_mov_b32 v76, 0
    v_mov_b32 v77, 0
    v_mov_b32 v78, 0
    v_mov_b32 v79, 0
    v_mov_b32 v80, 0
    v_mov_b32 v81, 0
    v_mov_b32 v82, 0
    v_mov_b32 v83, 0
    v_mov_b32 v84, 0
    v_mov_b32 v85, 0
    v_mov_b32 v86, 0
    v_mov_b32 v87, 0
    s_waitcnt vmcnt(1)
    v_add_f32 v88, v88, v92
    v_add_f32 v89, v89, v93
    v_add_f32 v90, v90, v94
    v_add_f32 v91, v91, v95
    s_nop 0
    v_permlane32_swap_b32 v88, v90
    v_permlane32_swap_b32 v89, v91
    v_add_f32 v88, v88, v90
    v_add_f32 v89, v89, v91
    s_nop 1
    v_permlane16_swap_b32 v88, v89
    v_add_f32 v88, v88, v89
    v_mul_f32 v7, 0x3acccccd, v88
    s_mov_b32 s76, 1
POLL6:
    buffer_load_dwordx4 v[24:27], v11, s[16:19], s3 offen sc1
    buffer_load_dwordx4 v[28:31], v11, s[16:19], s79 offen sc1
    s_waitcnt vmcnt(0)
    v_add_f32 v24, v24, v28
    v_add_f32 v25, v25, v29
    v_add_f32 v26, v26, v30
    v_add_f32 v27, v27, v31
    s_nop 0
    v_permlane32_swap_b32 v24, v26
    v_permlane32_swap_b32 v25, v27
    v_add_f32 v24, v24, v26
    v_add_f32 v25, v25, v27
    s_nop 1
    v_permlane16_swap_b32 v24, v25
    v_add_f32 v24, v24, v25
    v_cmp_u_f32 vcc, v24, v24
    s_cbranch_vccnz AGAIN6
POLLX6:
    v_readlane_b32 s77, v24, 15
    s_mov_b32 vcc_lo, 0x70007000
    s_mov_b32 vcc_hi, 0x70007000
    v_fma_f32 v25, -s77, v7, v24
    v_cvt_pk_bf16_f32 v25, v25, v25
    ds_write_b16 v12, v25
    v_cndmask_b32 v26, 0, v24, vcc
    s_nop 1
    v_add_f32_dpp v26, v26, v26 quad_perm:[1,0,3,2] row_mask:0xf bank_mask:0xf
    s_nop 1
    v_add_f32_dpp v26, v26, v26 quad_perm:[2,3,0,1] row_mask:0xf bank_mask:0xf
    v_mov_b32 v27, v26
    s_nop 1
    v_permlane32_swap_b32 v26, v27
    v_add_f32 v26, v26, v27
    s_waitcnt lgkmcnt(0)
    s_barrier
    ds_read_b128 v[28:31], v13 offset:0
    ds_read_b128 v[32:35], v13 offset:128
    ds_read_b128 v[36:39], v13 offset:256
    v_mov_b32 v27, v26
    v_mov_b32 v25, s77
    v_subrev_f32 v25, 0x44200000, v25
    v_permlane16_swap_b32 v26, v27
    v_add_f32 v26, v26, v27
    v_mul_f32 v24, 0x3acccccd, v25
    v_readlane_b32 s77, v26, 15
    v_mul_f32 v24, v24, v24
    s_mov_b32 s78, 0x3acccccd
    v_sub_f32 v26, s77, v25
    v_fma_f32 v26, v26, s78, -v24
    v_max_f32 v26, 0, v26
    v_add_f32 v26, 0x3727c5ac, v26
    v_rsq_f32 v26, v26
    s_nop 0
    v_mul_f32 v18, 0x3dd53b94, v26
    s_waitcnt lgkmcnt(2)
    v_smfmac_f32_16x16x64_bf16 v[40:43], v[28:31], a[0:7], v14
    v_smfmac_f32_16x16x64_bf16 v[44:47], v[28:31], a[24:31], v14
    v_smfmac_f32_16x16x64_bf16 v[48:51], v[28:31], a[48:55], v14
    v_smfmac_f32_16x16x64_bf16 v[52:55], v[28:31], a[72:79], v14
    v_smfmac_f32_16x16x64_bf16 v[56:59], v[28:31], a[96:103], v14
    v_smfmac_f32_16x16x64_bf16 v[60:63], v[28:31], a[120:127], v14
    v_smfmac_f32_16x16x64_bf16 v[64:67], v[28:31], a[144:151], v14
    v_smfmac_f32_16x16x64_bf16 v[68:71], v[28:31], a[168:175], v14
    s_waitcnt lgkmcnt(1)
    v_smfmac_f32_16x16x64_bf16 v[40:43], v[32:35], a[8:15], v14
    v_smfmac_f32_16x16x64_bf16 v[44:47], v[32:35], a[32:39], v14
    v_smfmac_f32_16x16x64_bf16 v[48:51], v[32:35], a[56:63], v14
    v_smfmac_f32_16x16x64_bf16 v[52:55], v[32:35], a[80:87], v14
    v_smfmac_f32_16x16x64_bf16 v[56:59], v[32:35], a[104:111], v14
    v_smfmac_f32_16x16x64_bf16 v[60:63], v[32:35], a[128:135], v14
    v_smfmac_f32_16x16x64_bf16 v[64:67], v[32:35], a[152:159], v14
    v_smfmac_f32_16x16x64_bf16 v[68:71], v[32:35], a[176:183], v14
    s_waitcnt lgkmcnt(0)
    v_smfmac_f32_16x16x64_bf16 v[40:43], v[36:39], a[16:23], v14
    v_smfmac_f32_16x16x64_bf16 v[44:47], v[36:39], a[40:47], v14
    v_smfmac_f32_16x16x64_bf16 v[48:51], v[36:39], a[64:71], v14
    v_smfmac_f32_16x16x64_bf16 v[52:55], v[36:39], a[88:95], v14
    v_smfmac_f32_16x16x64_bf16 v[56:59], v[36:39], a[112:119], v14
    v_smfmac_f32_16x16x64_bf16 v[60:63], v[36:39], a[136:143], v14
    v_smfmac_f32_16x16x64_bf16 v[64:67], v[36:39], a[160:167], v14
    v_smfmac_f32_16x16x64_bf16 v[68:71], v[36:39], a[184:191], v14
    s_nop 0
    v_add_f32 v24, v40, v41
    v_add_f32 v44, v44, v45
    v_add_f32 v48, v48, v49
    v_max3_f32 v26, v24, v44, v48
    v_add_f32 v52, v52, v53
    v_add_f32 v25, v56, v57
    v_max3_f32 v26, v26, v52, v25
    v_add_f32 v60, v60, v61
    v_add_f32 v64, v64, v65
    v_max3_f32 v26, v26, v60, v64
    v_add_f32 v68, v68, v69
    v_max_f32 v26, v26, v68
    v_mov_b32_dpp v24, v44 quad_perm:[0,1,2,3] row_mask:0x2 bank_mask:0xf
    v_mov_b32_dpp v25, v60 quad_perm:[0,1,2,3] row_mask:0x2 bank_mask:0xf
    v_max_f32_dpp v26, v26, v26 row_ror:8 row_mask:0xf bank_mask:0xf
    v_mov_b32_dpp v24, v48 quad_perm:[0,1,2,3] row_mask:0x4 bank_mask:0xf
    v_mov_b32_dpp v25, v64 quad_perm:[0,1,2,3] row_mask:0x4 bank_mask:0xf
    v_max_f32_dpp v26, v26, v26 row_ror:4 row_mask:0xf bank_mask:0xf
    v_mov_b32_dpp v24, v52 quad_perm:[0,1,2,3] row_mask:0x8 bank_mask:0xf
    v_mov_b32_dpp v25, v68 quad_perm:[0,1,2,3] row_mask:0x8 bank_mask:0xf
    v_max_f32_dpp v26, v26, v26 row_ror:2 row_mask:0xf bank_mask:0xf
    v_accvgpr_read_b32 v27, a252
    s_nop 0
    v_max_f32_dpp v26, v26, v26 row_ror:1 row_mask:0xf bank_mask:0xf
    v_mul_f32 v26, v26, v18
    v_fma_f32 v24, v24, v18, -v26
    v_fma_f32 v25, v25, v18, -v26
    v_exp_f32 v24, v24
    v_exp_f32 v25, v25
    s_nop 0
    v_cvt_pk_bf16_f32 v28, v24, v25
    ds_write_b16 v19, v28
    ds_write_b16_d16_hi v19, v28 offset:128
    s_mov_b64 exec, s[88:89]
    ds_read_b128 v[72:75], v27 offset:0
    ds_read_b128 v[76:79], v27 offset:64
    ds_read_b128 v[80:83], v27 offset:128
    ds_read_b128 v[84:87], v27 offset:192
    s_mov_b64 exec, -1
    v_add_f32 v27, v24, v25
    v_mov_b32 v40, 0
    v_mov_b32 v44, 0
    v_add_f32_dpp v27, v27, v27 row_ror:8 row_mask:0xf bank_mask:0xf
    v_mov_b32 v48, 0
    v_mov_b32 v52, 0
    v_add_f32_dpp v27, v27, v27 row_ror:4 row_mask:0xf bank_mask:0xf
    v_mov_b32 v56, 0
    v_mov_b32 v60, 0
    v_add_f32_dpp v27, v27, v27 row_ror:2 row_mask:0xf bank_mask:0xf
    s_lshl_b32 s78, s72, 3
    s_add_u32 s78, s78, 125440
    v_add_f32_dpp v27, v27, v27 row_ror:1 row_mask:0xf bank_mask:0xf
    v_mov_b32 v28, v27
    s_nop 1
    v_permlane32_swap_b32 v27, v28
    v_add_f32 v27, v27, v28
    v_mov_b32 v28, v27
    s_nop 1
    v_permlane16_swap_b32 v27, v28
    v_add_f32 v27, v27, v28
    v_mov_b32 v28, s78
    ds_write_b64 v28, v[26:27]
    s_waitcnt lgkmcnt(4)
    v_smfmac_f32_16x16x64_bf16 v[40:43], v[72:75], a[192:199], v14 abid:1
    v_smfmac_f32_16x16x64_bf16 v[44:47], v[72:75], a[200:207], v14 abid:1
    v_smfmac_f32_16x16x64_bf16 v[48:51], v[72:75], a[208:215], v14 abid:1
    v_smfmac_f32_16x16x64_bf16 v[52:55], v[72:75], a[216:223], v14 abid:1
    v_smfmac_f32_16x16x64_bf16 v[56:59], v[72:75], a[224:231], v14 abid:1
    v_smfmac_f32_16x16x64_bf16 v[60:63], v[72:75], a[232:239], v14 abid:1
    s_waitcnt lgkmcnt(3)
    v_smfmac_f32_16x16x64_bf16 v[40:43], v[76:79], v[112:119], v14 abid:1
    v_smfmac_f32_16x16x64_bf16 v[44:47], v[76:79], v[120:127], v14 abid:1
    v_smfmac_f32_16x16x64_bf16 v[48:51], v[76:79], v[128:135], v14 abid:1
    v_smfmac_f32_16x16x64_bf16 v[52:55], v[76:79], v[136:143], v14 abid:1
    v_smfmac_f32_16x16x64_bf16 v[56:59], v[76:79], v[144:151], v14 abid:1
    v_smfmac_f32_16x16x64_bf16 v[60:63], v[76:79], v[152:159], v14 abid:1
    s_waitcnt lgkmcnt(2)
    v_smfmac_f32_16x16x64_bf16 v[40:43], v[80:83], v[160:167], v14 abid:1
    v_smfmac_f32_16x16x64_bf16 v[44:47], v[80:83], v[168:175], v14 abid:1
    v_smfmac_f32_16x16x64_bf16 v[48:51], v[80:83], v[176:183], v14 abid:1
    v_smfmac_f32_16x16x64_bf16 v[52:55], v[80:83], v[184:191], v14 abid:1
    v_smfmac_f32_16x16x64_bf16 v[56:59], v[80:83], v[192:199], v14 abid:1
    v_smfmac_f32_16x16x64_bf16 v[60:63], v[80:83], v[200:207], v14 abid:1
    s_waitcnt lgkmcnt(0)
ATT_LAST:
    s_waitcnt lgkmcnt(8)
    v_smfmac_f32_16x16x64_bf16 v[40:43], v[84:87], v[208:215], v14 abid:1
    v_smfmac_f32_16x16x64_bf16 v[44:47], v[84:87], v[216:223], v14 abid:1
    s_waitcnt lgkmcnt(4)
    v_smfmac_f32_16x16x64_bf16 v[48:51], v[84:87], v[224:231], v14 abid:1
    v_smfmac_f32_16x16x64_bf16 v[52:55], v[84:87], v[232:239], v14 abid:1
    s_waitcnt lgkmcnt(0)
    v_smfmac_f32_16x16x64_bf16 v[56:59], v[84:87], v[240:247], v14 abid:1
    v_smfmac_f32_16x16x64_bf16 v[60:63], v[84:87], v[248:255], v14 abid:1
    s_lshl_b32 s77, s72, 8
    s_add_u32 s77, s77, 119296
    v_lshl_add_u32 v24, v0, 2, s77
    v_permlane16_swap_b32 v40, v44
    v_add_f32 v40, v40, v44
    ds_write_b32 v15, v40 offset:0
    v_permlane16_swap_b32 v48, v52
    v_add_f32 v48, v48, v52
    ds_write_b32 v15, v48 offset:256
    v_permlane16_swap_b32 v56, v60
    v_add_f32 v56, v56, v60
    ds_write_b32 v15, v56 offset:512
    v_and_b32 v25, 3, v0
    v_lshlrev_b32 v25, 3, v25
    v_add_u32 v25, 125440, v25
    s_waitcnt lgkmcnt(0)
    s_barrier
    ds_read_b64 v[32:33], v25
    ds_read2st64_b32 v[40:41], v24 offset0:0 offset1:3
    ds_read2st64_b32 v[42:43], v24 offset0:6 offset1:9
    s_mul_i32 s77, s70, 3072
    s_lshl_b32 s78, s71, 4
    s_add_u32 s77, s77, s78
    s_lshl_b32 s78, s72, 10
    s_add_u32 s77, s77, s78
    s_add_u32 s77, s77, s3
    s_add_u32 s77, s77, 32768
    s_lshl_b32 s78, s69, 3
    s_add_u32 s78, s78, s3
    s_add_u32 s78, s78, 45056
    s_cmp_eq_u32 s72, 3
    s_waitcnt lgkmcnt(2)
    v_max_f32_dpp v34, v32, v32 quad_perm:[1,0,3,2] row_mask:0xf bank_mask:0xf
    s_nop 1
    v_max_f32_dpp v34, v34, v34 quad_perm:[2,3,0,1] row_mask:0xf bank_mask:0xf
    v_sub_f32 v32, v32, v34
    v_exp_f32 v32, v32
    s_cbranch_scc1 OML
    s_waitcnt lgkmcnt(0)
    v_mul_f32_dpp v28, v32, v40 quad_perm:[0,0,0,0] row_mask:0xf bank_mask:0xf
    v_mul_f32_dpp v29, v32, v41 quad_perm:[1,1,1,1] row_mask:0xf bank_mask:0xf
    v_mul_f32_dpp v30, v32, v42 quad_perm:[2,2,2,2] row_mask:0xf bank_mask:0xf
    v_fmac_f32_dpp v28, v32, v43 quad_perm:[3,3,3,3] row_mask:0xf bank_mask:0xf
    v_add_f32 v29, v29, v30
    v_add_f32 v28, v28, v29
    s_nop 1
    v_mov_b32_dpp v29, v28 row_shl:1 row_mask:0xf bank_mask:0xf
    v_cvt_pk_bf16_f32 v28, v28, v29
    s_nop 1
    v_mov_b32_dpp v29, v28 row_shl:2 row_mask:0xf bank_mask:0xf
    v_mov_b32_dpp v30, v28 row_shl:4 row_mask:0xf bank_mask:0xf
    v_mov_b32_dpp v31, v28 row_shl:6 row_mask:0xf bank_mask:0xf
    s_mov_b64 exec, s[82:83]
    buffer_store_dwordx4 v[28:31], v1, s[8:11], s77 offen
    s_cmp_eq_u32 s10, 0
    s_cbranch_scc1 SLOW7
BACK7:
    s_mov_b64 exec, -1
ODONE:
    s_cmp_ge_u32 s69, 20
    s_cbranch_scc1 ROLEF
    s_cmp_eq_u32 s74, 0
    s_cbranch_scc1 WLATE
    v_accvgpr_read_b32 v2, a246
    v_accvgpr_read_b32 v3, a247
    v_accvgpr_read_b32 v4, a248
    v_mov_b32 v88, 0
    v_mov_b32 v92, 0
    v_mov_b32 v96, 0
    v_mov_b32 v100, 0
    v_mov_b32 v104, 0
    v_mov_b32 v108, 0
    ds_read_b64_tr_b16 v[40:41], v2 offset:0
    ds_read_b64_tr_b16 v[42:43], v2 offset:256
    ds_read_b64_tr_b16 v[64:65], v2 offset:32
    ds_read_b64_tr_b16 v[66:67], v2 offset:288
    ds_read_b64_tr_b16 v[44:45], v2 offset:2048
    ds_read_b64_tr_b16 v[46:47], v2 offset:2304
    ds_read_b64_tr_b16 v[68:69], v2 offset:2080
    ds_read_b64_tr_b16 v[70:71], v2 offset:2336
    ds_read_b64_tr_b16 v[48:49], v2 offset:4096
    ds_read_b64_tr_b16 v[50:51], v2 offset:4352
    s_cmp_lg_u32 s72, 1
    s_cbranch_scc1 NOOWN0
    v_accvgpr_read_b32 v28, a244
    v_accvgpr_read_b32 v29, a245
    v_max_u32 v30, v28, v29
    v_cmp_eq_u32 vcc, -1, v30
    s_cbranch_vccnz RETRY8
OK8:
    v_lshlrev_b32 v30, 16, v28
    v_and_b32 v28, 0xffff0000, v28
    v_lshlrev_b32 v31, 16, v29
    v_and_b32 v29, 0xffff0000, v29
    v_add_f32 v30, v30, v31
    v_add_f32 v28, v28, v29
    v_mov_b32 v31, v30
    v_mov_b32 v29, v28
    s_nop 0
    v_permlane32_swap_b32 v30, v31
    v_permlane32_swap_b32 v28, v29
    v_add_f32 v30, v30, v31
    v_add_f32 v28, v28, v29
    v_mov_b32 v31, v30
    v_mov_b32 v29, v28
    s_nop 0
    v_permlane16_swap_b32 v30, v31
    v_permlane16_swap_b32 v28, v29
    v_add_f32 v30, v30, v31
    v_add_f32 v28, v28, v29
    v_add_f32 v22, v22, v30
    v_add_f32 v23, v23, v28
    v_cvt_pk_bf16_f32 v28, v22, v23
    s_lshl_b32 s77, s69, 6
    s_add_u32 s77, s77, s3
    s_add_u32 s77, s77, 47872
    v_lshlrev_b32 v32, 2, v0
    v_mov_b32_dpp v29, v28 quad_perm:[1,1,1,1] row_mask:0xf bank_mask:0xf
    v_mov_b32_dpp v30, v28 quad_perm:[2,2,2,2] row_mask:0xf bank_mask:0xf
    v_mov_b32_dpp v31, v28 quad_perm:[3,3,3,3] row_mask:0xf bank_mask:0xf
    s_mov_b32 exec_lo, 0x1111
    s_mov_b32 exec_hi, 0x0
    buffer_store_dwordx4 v[28:31], v32, s[8:11], s77 offen
    s_cmp_eq_u32 s10, 0
    s_cbranch_scc1 SLOW9
BACK9:
    s_mov_b64 exec, -1
NOOWN0:
    v_mov_b32 v25, 0
    v_mov_b32 v27, 0
    v_mov_b32 v37, 0
    v_mov_b32 v39, 0
    s_mov_b32 exec_lo, 0x00ff00ff
    s_mov_b32 exec_hi, 0x00ff00ff
    buffer_load_dwordx4 v[88:91], v3, s[16:19], s3 offen offset:0 sc1
    buffer_load_dwordx4 v[92:95], v3, s[16:19], s3 offen offset:512 sc1
    buffer_load_dwordx4 v[96:99], v3, s[16:19], s3 offen offset:1024 sc1
    buffer_load_dwordx4 v[100:103], v3, s[16:19], s3 offen offset:1536 sc1
    buffer_load_dwordx4 v[104:107], v3, s[16:19], s3 offen offset:2048 sc1
    buffer_load_dwordx4 v[108:111], v3, s[16:19], s3 offen offset:2560 sc1
    s_mov_b32 exec_lo, -1
    s_mov_b32 exec_hi, 0
    buffer_load_dwordx4 v[24:27], v4, s[16:19], s3 offen offset:0 sc1
    buffer_load_dwordx4 v[36:39], v4, s[16:19], s3 offen offset:16 sc1
    s_mov_b64 exec, -1
    ds_read_b64_tr_b16 v[72:73], v2 offset:4128
    ds_read_b64_tr_b16 v[74:75], v2 offset:4384
    ds_read_b64_tr_b16 v[52:53], v2 offset:6144
    ds_read_b64_tr_b16 v[54:55], v2 offset:6400
    ds_read_b64_tr_b16 v[76:77], v2 offset:6176
    ds_read_b64_tr_b16 v[78:79], v2 offset:6432
    ds_read_b64_tr_b16 v[56:57], v2 offset:8192
    ds_read_b64_tr_b16 v[58:59], v2 offset:8448
    ds_read_b64_tr_b16 v[80:81], v2 offset:8224
    ds_read_b64_tr_b16 v[82:83], v2 offset:8480
    ds_read_b64_tr_b16 v[60:61], v2 offset:10240
    ds_read_b64_tr_b16 v[62:63], v2 offset:10496
    ds_read_b64_tr_b16 v[84:85], v2 offset:10272
    ds_read_b64_tr_b16 v[86:87], v2 offset:10528
    v_accvgpr_read_b32 v5, a249
    v_and_b32 v18, 3, v0
    v_lshrrev_b32 v6, 5, v0
    v_lshl_add_u32 v18, v6, 2, v18
    v_mul_u32_u24 v18, 10240, v18
    v_bfe_u32 v6, v0, 3, 2
    v_lshl_add_u32 v18, v6, 4, v18
    v_and_b32 v6, 0xffffff7f, v5
WCHK:
    s_waitcnt vmcnt(0)
    v_max3_u32 v28, v88, v92, v96
    v_max3_u32 v28, v28, v100, v104
    v_max3_u32 v28, v28, v108, v25
    v_max3_u32 v28, v28, v27, v37
    v_max_u32 v28, v28, v39
    v_cmp_eq_u32 vcc, -1, v28
    s_cbranch_vccnz AGAIN10
POLLX10:
    s_waitcnt lgkmcnt(0)
    v_mfma_f32_16x16x32_bf16 v[28:31], v[88:91], v[40:43], 0
    v_mfma_f32_16x16x32_bf16 v[32:35], v[88:91], v[64:67], 0
    v_max3_f32 v88, v24, v26, v36
    v_max_f32 v88, v88, v38
    v_mfma_f32_16x16x32_bf16 v[28:31], v[92:95], v[44:47], v[28:31]
    v_mov_b32 v89, v88
    v_mfma_f32_16x16x32_bf16 v[32:35], v[92:95], v[68:71], v[32:35]
    s_nop 0
    v_permlane16_swap_b32 v88, v89
    v_max_f32 v88, v88, v89
    v_mfma_f32_16x16x32_bf16 v[28:31], v[96:99], v[48:51], v[28:31]
    v_sub_f32 v24, v24, v88
    v_sub_f32 v26, v26, v88
    v_mfma_f32_16x16x32_bf16 v[32:35], v[96:99], v[72:75], v[32:35]
    v_sub_f32 v36, v36, v88
    v_sub_f32 v38, v38, v88
    v_mfma_f32_16x16x32_bf16 v[28:31], v[100:103], v[52:55], v[28:31]
    v_exp_f32 v24, v24
    v_mfma_f32_16x16x32_bf16 v[32:35], v[100:103], v[76:79], v[32:35]
    v_exp_f32 v26, v26
    v_mfma_f32_16x16x32_bf16 v[28:31], v[104:107], v[56:59], v[28:31]
    v_exp_f32 v36, v36
    v_mfma_f32_16x16x32_bf16 v[32:35], v[104:107], v[80:83], v[32:35]
    v_exp_f32 v38, v38
    v_mfma_f32_16x16x32_bf16 v[28:31], v[108:111], v[60:63], v[28:31]
    v_mul_f32 v90, v24, v25
    v_fmac_f32 v90, v26, v27
    v_mfma_f32_16x16x32_bf16 v[32:35], v[108:111], v[84:87], v[32:35]
    v_fmac_f32 v90, v36, v37
    v_fmac_f32 v90, v38, v39
    v_mov_b32 v89, v90
    s_cmp_lg_u32 s72, 0
    s_nop 0
    v_permlane16_swap_b32 v90, v89
    v_add_f32 v90, v90, v89
    v_rcp_f32 v90, v90
    v_mul_f32 v28, v24, v28
    v_mul_f32 v32, v24, v32
    v_fmac_f32 v28, v26, v29
    v_fmac_f32 v32, v26, v33
    v_fmac_f32 v28, v36, v30
    v_fmac_f32 v32, v36, v34
    v_fmac_f32 v28, v38, v31
    v_fmac_f32 v32, v38, v35
    s_nop 1
    v_permlane16_swap_b32 v28, v32
    v_add_f32 v28, v28, v32
    v_mul_f32 v28, v28, v90
    ds_write_b32 v5, v28
    s_waitcnt lgkmcnt(0)
    s_barrier
    s_cbranch_scc1 WNOT0
    ds_read2st64_b32 v[28:29], v6 offset0:0 offset1:1
    ds_read2st64_b32 v[30:31], v6 offset0:2 offset1:3
    s_waitcnt lgkmcnt(1)
    v_add_f32 v28, v28, v29
    s_waitcnt lgkmcnt(0)
    v_add_f32 v30, v30, v31
    v_add_f32 v28, v28, v30
    s_nop 1
    v_mov_b32_dpp v29, v28 row_shl:1 row_mask:0xf bank_mask:0xf
    v_cvt_pk_bf16_f32 v32, v28, v29
    s_nop 1
    v_mov_b32_dpp v28, v32 quad_perm:[0,0,0,0] row_mask:0xf bank_mask:0xf
    v_mov_b32_dpp v29, v32 quad_perm:[2,2,2,2] row_mask:0xf bank_mask:0xf
    s_nop 0
    v_mov_b32_dpp v30, v28 row_shl:4 row_mask:0xf bank_mask:0xf
    v_mov_b32_dpp v31, v29 row_shl:4 row_mask:0xf bank_mask:0xf
    s_mov_b64 exec, s[46:47]
    buffer_store_dwordx4 v[28:31], v18, s[16:19], s80 offen sc1
    s_mov_b64 exec, s[92:93]
    buffer_store_dwordx4 v[28:31], v18, s[8:11], s81 offen
    s_cmp_eq_u32 s10, 0
    s_cbranch_scc1 SLOW11
BACK11:
    s_mov_b64 exec, -1
    v_add_u32 v111, 49152, v2
    s_cmp_lg_u32 s74, 0
    s_cbranch_scc1 W2OK
    v_lshrrev_b32 v38, 2, v0
    v_mul_u32_u24 v38, 1280, v38
    v_and_b32 v39, 3, v0
    v_lshl_add_u32 v39, v39, 4, v38
    s_mul_i32 s77, s68, 245760
    s_lshl_b32 s78, s69, 6
    s_add_u32 s77, s77, s78
    s_mov_b32 m0, 106496
    s_nop 0
    buffer_load_dwordx4 v39, s[32:35], s77 offen lds
    s_add_u32 s77, s77, 20480
    s_mov_b32 m0, 107520
    s_nop 0
    buffer_load_dwordx4 v39, s[32:35], s77 offen lds
    s_add_u32 s77, s77, 20480
    s_mov_b32 m0, 108544
    s_nop 0
    buffer_load_dwordx4 v39, s[32:35], s77 offen lds
    s_add_u32 s77, s77, 20480
    s_mov_b32 m0, 109568
    s_nop 0
    buffer_load_dwordx4 v39, s[32:35], s77 offen lds
    s_add_u32 s77, s77, 20480
    s_mov_b32 m0, 110592
    s_nop 0
    buffer_load_dwordx4 v39, s[32:35], s77 offen lds
    s_add_u32 s77, s77, 20480
    s_mov_b32 m0, 111616
    s_nop 0
    buffer_load_dwordx4 v39, s[32:35], s77 offen lds
    s_add_u32 s77, s77, 20480
    s_mov_b32 m0, 112640
    s_nop 0
    buffer_load_dwordx4 v39, s[32:35], s77 offen lds
    s_add_u32 s77, s77, 20480
    s_mov_b32 m0, 113664
    s_nop 0
    buffer_load_dwordx4 v39, s[32:35], s77 offen lds
    s_add_u32 s77, s77, 20480
    s_mov_b32 m0, 114688
    s_nop 0
    buffer_load_dwordx4 v39, s[32:35], s77 offen lds
    s_add_u32 s77, s77, 20480
    s_mov_b32 m0, 115712
    s_nop 0
    buffer_load_dwordx4 v39, s[32:35], s77 offen lds
    s_add_u32 s77, s77, 20480
    s_mov_b32 m0, 116736
    s_nop 0
    buffer_load_dwordx4 v39, s[32:35], s77 offen lds
    s_add_u32 s77, s77, 20480
    s_mov_b32 m0, 117760
    s_nop 0
    buffer_load_dwordx4 v39, s[32:35], s77 offen lds
    s_add_u32 s77, s77, 20480
    s_branch W2X
W2OK:
    ds_read_b64_tr_b16 v[40:41], v111 offset:0
    ds_read_b64_tr_b16 v[42:43], v111 offset:256
    ds_read_b64_tr_b16 v[64:65], v111 offset:32
    ds_read_b64_tr_b16 v[66:67], v111 offset:288
    ds_read_b64_tr_b16 v[44:45], v111 offset:2048
    ds_read_b64_tr_b16 v[46:47], v111 offset:2304
    ds_read_b64_tr_b16 v[68:69], v111 offset:2080
    ds_read_b64_tr_b16 v[70:71], v111 offset:2336
    ds_read_b64_tr_b16 v[48:49], v111 offset:4096
    ds_read_b64_tr_b16 v[50:51], v111 offset:4352
    ds_read_b64_tr_b16 v[72:73], v111 offset:4128
    ds_read_b64_tr_b16 v[74:75], v111 offset:4384
    ds_read_b64_tr_b16 v[52:53], v111 offset:6144
    ds_read_b64_tr_b16 v[54:55], v111 offset:6400
    ds_read_b64_tr_b16 v[76:77], v111 offset:6176
    ds_read_b64_tr_b16 v[78:79], v111 offset:6432
    ds_read_b64_tr_b16 v[56:57], v111 offset:8192
    ds_read_b64_tr_b16 v[58:59], v111 offset:8448
    ds_read_b64_tr_b16 v[80:81], v111 offset:8224
    ds_read_b64_tr_b16 v[82:83], v111 offset:8480
    ds_read_b64_tr_b16 v[60:61], v111 offset:10240
    ds_read_b64_tr_b16 v[62:63], v111 offset:10496
    ds_read_b64_tr_b16 v[84:85], v111 offset:10272
    ds_read_b64_tr_b16 v[86:87], v111 offset:10528
W2X:
    v_mov_b32 v100, 0
    v_mov_b32 v101, 0
    v_mov_b32 v104, 0
    v_mov_b32 v105, 0
    s_add_u32 s96, s80, 81920
    s_add_u32 s97, s81, 1280
STB:
    s_mul_i32 s77, s72, 48
    v_min_u32 v6, 47, v0
    v_add_u32 v6, s77, v6
    v_lshlrev_b32 v4, 4, v6
    v_add_u32 v108, 7168, v4
    v_lshlrev_b32 v4, 2, v6
    v_cmp_le_u32 vcc, 48, v0
    v_mov_b32 v24, 768
    s_nop 0
    v_cndmask_b32 v4, v4, v24, vcc
    v_add_u32 v5, 3584, v4
    v_lshrrev_b32 v24, 4, v6
    v_lshlrev_b32 v24, 5, v24
    v_bfe_u32 v25, v6, 1, 1
    v_lshl_add_u32 v24, v25, 4, v24
    v_bfe_u32 v25, v6, 2, 2
    v_lshl_add_u32 v24, v25, 2, v24
    v_and_b32 v25, 1, v6
    v_lshl_add_u32 v24, v25, 1, v24
    v_add_u32 v24, 118784, v24
    v_mov_b32 v25, 119168
    v_cndmask_b32 v6, v24, v25, vcc
    v_mov_b32 v109, 0x3727c5ac
    v_mov_b32 v110, 0x3acccccd
    s_add_u32 s79, s3, 50432
    v_accvgpr_read_b32 v2, a250
    v_accvgpr_read_b32 v3, a251
    s_add_u32 s6, s74, s72
    s_mov_b32 s76, 1
    s_cmp_eq_u32 s74, 0
    s_cbranch_scc1 GPF
GPO:
    s_cmp_eq_u32 s72, 1
    s_cbranch_scc1 WOWN
GP1:
    buffer_load_dword v24, v4, s[16:19], s79 offen offset:0 sc1
    buffer_load_dword v28, v5, s[16:19], s79 offen offset:0 sc1
    buffer_load_dword v25, v4, s[16:19], s79 offen offset:896 sc1
    buffer_load_dword v29, v5, s[16:19], s79 offen offset:896 sc1
    buffer_load_dword v26, v4, s[16:19], s79 offen offset:1792 sc1
    buffer_load_dword v30, v5, s[16:19], s79 offen offset:1792 sc1
    buffer_load_dword v27, v4, s[16:19], s79 offen offset:2688 sc1
    buffer_load_dword v31, v5, s[16:19], s79 offen offset:2688 sc1
    s_waitcnt vmcnt(0)
    v_add_f32 v24, v24, v25
    v_add_f32 v28, v28, v29
    v_add_f32 v26, v26, v27
    v_add_f32 v30, v30, v31
    v_add_f32 v28, v28, v30
    v_add_f32 v24, v24, v26
    v_cmp_u_f32 vcc, v24, v28
    s_cbranch_vccnz GA1
GPX:
    v_readlane_b32 s77, v28, 48
    v_readlane_b32 s78, v24, 48
    s_cmp_lg_u32 s6, 1
    s_cbranch_scc0 OWL
OWB:
    v_mul_f32 v25, s77, v110
    v_fma_f32 v26, s78, v110, v109
    v_fma_f32 v26, -v25, v25, v26
    v_add_f32 v25, 1.0, v25
    v_max_f32 v26, v26, v109
    v_fma_f32 v24, -v25, v2, v24
    v_rsq_f32 v27, v26
    v_mul_f32 v29, 0xbfb8aa3b, v24
    v_mul_f32 v29, v29, v27
    v_exp_f32 v29, v29
    v_fma_f32 v28, -v25, v3, v28
    v_fma_f32 v29, v29, v26, v26
    v_rcp_f32 v29, v29
    v_mul_f32 v28, v28, v24
    v_mul_f32 v28, v28, v29
    v_cvt_pk_bf16_f32 v28, v28, v28
    ds_write_b16 v6, v28
    v_accvgpr_write_b32 a250, v2
    v_accvgpr_write_b32 a251, v3
    s_cmp_lg_u32 s72, 0
    s_waitcnt lgkmcnt(0)
    s_barrier
    s_cbranch_scc1 STBX
    ds_read_b128 v[88:91], v13 offset:0
    ds_read_b128 v[92:95], v13 offset:128
    ds_read_b128 v[96:99], v13 offset:256
    s_waitcnt lgkmcnt(2)
    v_smfmac_f32_16x16x64_bf16 v[100:103], v[88:91], v[40:47], v14
    v_smfmac_f32_16x16x64_bf16 v[104:107], v[88:91], v[64:71], v14
    s_waitcnt lgkmcnt(1)
    v_smfmac_f32_16x16x64_bf16 v[100:103], v[92:95], v[48:55], v14
    v_smfmac_f32_16x16x64_bf16 v[104:107], v[92:95], v[72:79], v14
    s_waitcnt lgkmcnt(0)
    v_smfmac_f32_16x16x64_bf16 v[100:103], v[96:99], v[56:63], v14
    v_smfmac_f32_16x16x64_bf16 v[104:107], v[96:99], v[80:87], v14
    s_nop 6
    v_add_f32 v28, v100, v101
    s_nop 1
    v_add_f32_dpp v28, v104, v105 quad_perm:[0,1,2,3] row_mask:0xa bank_mask:0xf
    s_nop 1
    v_mov_b32_dpp v29, v28 row_shl:1 row_mask:0xf bank_mask:0xf
    v_cvt_pk_bf16_f32 v32, v28, v29
    s_nop 1
    v_mov_b32_dpp v28, v32 quad_perm:[0,0,0,0] row_mask:0xf bank_mask:0xf
    v_mov_b32_dpp v29, v32 quad_perm:[2,2,2,2] row_mask:0xf bank_mask:0xf
    s_nop 0
    v_mov_b32_dpp v30, v28 row_shl:4 row_mask:0xf bank_mask:0xf
    v_mov_b32_dpp v31, v29 row_shl:4 row_mask:0xf bank_mask:0xf
    s_mov_b64 exec, s[48:49]
    buffer_store_dwordx4 v[28:31], v18, s[16:19], s96 offen sc1
    s_mov_b64 exec, s[92:93]
    buffer_store_dwordx4 v[28:31], v18, s[8:11], s97 offen
    s_cmp_eq_u32 s10, 0
    s_cbranch_scc1 SLOW12
BACK12:
    s_mov_b64 exec, -1
    s_branch NEXT
AGAIN3:
    s_add_u32 s76, s76, 1
    s_cmp_lt_u32 s76, 32768
    s_cbranch_scc1 POLL3
    s_branch POLLX3
BR4:
    s_cmp_ge_u32 s76, 32768
    s_cbranch_scc1 BX4
    s_mov_b64 exec, vcc
    buffer_load_dwordx4 v[80:83], v8, s[16:19], 0 offen sc1
    s_add_u32 s76, s76, 1
    s_waitcnt vmcnt(0)
    s_branch BW4
AGAIN6:
    s_add_u32 s76, s76, 1
    s_cmp_lt_u32 s76, 32768
    s_cbranch_scc1 POLL6
    s_branch POLLX6
OML:
    v_mul_f32 v35, v32, v33
    s_nop 1
    v_add_f32_dpp v35, v35, v35 quad_perm:[1,0,3,2] row_mask:0xf bank_mask:0xf
    s_nop 1
    v_add_f32_dpp v35, v35, v35 quad_perm:[2,3,0,1] row_mask:0xf bank_mask:0xf
    s_mov_b64 exec, 1
    buffer_store_dwordx2 v[34:35], v1, s[8:11], s78 offen
    s_cmp_eq_u32 s10, 0
    s_cbranch_scc1 SLOW13
BACK13:
    s_mov_b64 exec, -1
    s_waitcnt lgkmcnt(0)
    s_branch ODONE
WLATE:
    v_lshrrev_b32 v38, 2, v0
    v_mul_u32_u24 v38, 1280, v38
    v_and_b32 v39, 3, v0
    v_lshl_add_u32 v39, v39, 4, v38
    s_mov_b32 m0, s67
    s_add_u32 s67, s67, 1024
    buffer_load_dwordx4 v39, s[24:27], s66 offen  lds
    s_add_u32 s66, s66, 20480
    s_mov_b32 m0, s67
    s_add_u32 s67, s67, 1024
    buffer_load_dwordx4 v39, s[24:27], s66 offen  lds
    s_add_u32 s66, s66, 20480
    s_mov_b32 m0, s67
    s_add_u32 s67, s67, 1024
    buffer_load_dwordx4 v39, s[24:27], s66 offen  lds
    s_add_u32 s66, s66, 20480
    s_mov_b32 m0, s67
    s_add_u32 s67, s67, 1024
    buffer_load_dwordx4 v39, s[24:27], s66 offen  lds
    s_add_u32 s66, s66, 20480
    s_mov_b32 m0, s67
    s_add_u32 s67, s67, 1024
    buffer_load_dwordx4 v39, s[24:27], s66 offen  lds
    s_add_u32 s66, s66, 20480
    s_mov_b32 m0, s67
    s_add_u32 s67, s67, 1024
    buffer_load_dwordx4 v39, s[24:27], s66 offen  lds
    s_add_u32 s66, s66, 20480
    s_add_u32 s77, s3, 1638400
    buffer_store_dword v7, v10, s[8:11], s77 offen
    s_cmp_eq_u32 s10, 0
    s_cbranch_scc1 SLOW14
BACK14:
    v_accvgpr_read_b32 v2, a246
    v_accvgpr_read_b32 v3, a247
    v_accvgpr_read_b32 v4, a248
    v_mov_b32 v88, 0
    v_mov_b32 v92, 0
    v_mov_b32 v96, 0
    v_mov_b32 v100, 0
    v_mov_b32 v104, 0
    v_mov_b32 v108, 0
    v_mov_b32 v25, 0
    v_mov_b32 v27, 0
    v_mov_b32 v37, 0
    v_mov_b32 v39, 0
    s_mov_b32 exec_lo, 0x00ff00ff
    s_mov_b32 exec_hi, 0x00ff00ff
    buffer_load_dwordx4 v[88:91], v3, s[16:19], s3 offen offset:0 sc1
    buffer_load_dwordx4 v[92:95], v3, s[16:19], s3 offen offset:512 sc1
    buffer_load_dwordx4 v[96:99], v3, s[16:19], s3 offen offset:1024 sc1
    buffer_load_dwordx4 v[100:103], v3, s[16:19], s3 offen offset:1536 sc1
    buffer_load_dwordx4 v[104:107], v3, s[16:19], s3 offen offset:2048 sc1
    buffer_load_dwordx4 v[108:111], v3, s[16:19], s3 offen offset:2560 sc1
    s_mov_b32 exec_lo, -1
    s_mov_b32 exec_hi, 0
    buffer_load_dwordx4 v[24:27], v4, s[16:19], s3 offen offset:0 sc1
    buffer_load_dwordx4 v[36:39], v4, s[16:19], s3 offen offset:16 sc1
    s_mov_b64 exec, -1
    s_waitcnt vmcnt(8)
    ds_read_b64_tr_b16 v[40:41], v2 offset:0
    ds_read_b64_tr_b16 v[42:43], v2 offset:256
    ds_read_b64_tr_b16 v[64:65], v2 offset:32
    ds_read_b64_tr_b16 v[66:67], v2 offset:288
    ds_read_b64_tr_b16 v[44:45], v2 offset:2048
    ds_read_b64_tr_b16 v[46:47], v2 offset:2304
    ds_read_b64_tr_b16 v[68:69], v2 offset:2080
    ds_read_b64_tr_b16 v[70:71], v2 offset:2336
    ds_read_b64_tr_b16 v[48:49], v2 offset:4096
    ds_read_b64_tr_b16 v[50:51], v2 offset:4352
    s_lshl_b32 s77, s68, 2
    s_add_u32 s77, s77, s72
    s_mul_i32 s77, s77, 61440
    s_lshl_b32 s78, s69, 6
    s_add_u32 s77, s77, s78
    v_min_u32 v35, 47, v0
    v_mul_u32_u24 v35, 1280, v35
    v_add_u32 v35, s77, v35
    ds_read_b64_tr_b16 v[72:73], v2 offset:4128
    ds_read_b64_tr_b16 v[74:75], v2 offset:4384
    ds_read_b64_tr_b16 v[52:53], v2 offset:6144
    ds_read_b64_tr_b16 v[54:55], v2 offset:6400
    ds_read_b64_tr_b16 v[76:77], v2 offset:6176
    ds_read_b64_tr_b16 v[78:79], v2 offset:6432
    ds_read_b64_tr_b16 v[56:57], v2 offset:8192
    ds_read_b64_tr_b16 v[58:59], v2 offset:8448
    ds_read_b64_tr_b16 v[80:81], v2 offset:8224
    ds_read_b64_tr_b16 v[82:83], v2 offset:8480
    ds_read_b64_tr_b16 v[60:61], v2 offset:10240
    ds_read_b64_tr_b16 v[62:63], v2 offset:10496
    ds_read_b64_tr_b16 v[84:85], v2 offset:10272
    ds_read_b64_tr_b16 v[86:87], v2 offset:10528
    v_accvgpr_read_b32 v5, a249
    v_and_b32 v18, 3, v0
    v_lshrrev_b32 v6, 5, v0
    v_lshl_add_u32 v18, v6, 2, v18
    v_mul_u32_u24 v18, 10240, v18
    v_bfe_u32 v6, v0, 3, 2
    v_lshl_add_u32 v18, v6, 4, v18
    v_and_b32 v6, 0xffffff7f, v5
    s_branch WCHK
AGAIN10:
    s_mov_b64 s[94:95], exec
    s_mov_b32 s76, 1
AG210:
    v_max3_u32 v28, v88, v92, v96
    v_max3_u32 v28, v28, v100, v104
    v_max_u32 v28, v28, v108
    v_cmp_eq_u32 vcc, -1, v28
    s_nop 0
    s_mov_b64 exec, vcc
    s_cbranch_execz AG310_0
    buffer_load_dwordx4 v[88:91], v3, s[16:19], s3 offen offset:0 sc1
    buffer_load_dwordx4 v[92:95], v3, s[16:19], s3 offen offset:512 sc1
    buffer_load_dwordx4 v[96:99], v3, s[16:19], s3 offen offset:1024 sc1
    buffer_load_dwordx4 v[100:103], v3, s[16:19], s3 offen offset:1536 sc1
    buffer_load_dwordx4 v[104:107], v3, s[16:19], s3 offen offset:2048 sc1
    buffer_load_dwordx4 v[108:111], v3, s[16:19], s3 offen offset:2560 sc1
AG310_0:
    s_mov_b64 exec, s[94:95]
    v_max3_u32 v28, v25, v27, v37
    v_max_u32 v28, v28, v39
    v_cmp_eq_u32 vcc, -1, v28
    s_nop 0
    s_mov_b64 exec, vcc
    s_cbranch_execz AG310_1
    buffer_load_dwordx4 v[24:27], v4, s[16:19], s3 offen offset:0 sc1
    buffer_load_dwordx4 v[36:39], v4, s[16:19], s3 offen offset:16 sc1
AG310_1:
    s_mov_b64 exec, s[94:95]
    s_add_u32 s76, s76, 1
    s_cmp_ge_u32 s76, 32768
    s_waitcnt vmcnt(0)
    v_max3_u32 v28, v88, v92, v96
    v_max3_u32 v28, v28, v100, v104
    v_max3_u32 v28, v28, v108, v25
    v_max3_u32 v28, v28, v27, v37
    v_max_u32 v28, v28, v39
    v_cmp_eq_u32 vcc, -1, v28
    s_cbranch_vccz POLLX10
    s_cbranch_scc0 AG210
    s_branch POLLX10
GA1:
    s_add_u32 s76, s76, 1
    s_cmp_lt_u32 s76, 32768
    s_cbranch_scc1 GP1
    s_branch GPX
GPF:
    s_cmp_lg_u32 s72, 0
    s_cbranch_scc1 GP0
    buffer_load_dwordx4 v[32:35], v108, s[16:19], s79 offen sc1
    buffer_load_dwordx4 v[36:39], v108, s[16:19], s79 offen offset:3072 sc1
    s_waitcnt vmcnt(2)
    ds_read_b64_tr_b16 v[40:41], v111 offset:0
    ds_read_b64_tr_b16 v[42:43], v111 offset:256
    ds_read_b64_tr_b16 v[64:65], v111 offset:32
    ds_read_b64_tr_b16 v[66:67], v111 offset:288
    ds_read_b64_tr_b16 v[44:45], v111 offset:2048
    ds_read_b64_tr_b16 v[46:47], v111 offset:2304
    ds_read_b64_tr_b16 v[68:69], v111 offset:2080
    ds_read_b64_tr_b16 v[70:71], v111 offset:2336
    ds_read_b64_tr_b16 v[48:49], v111 offset:4096
    ds_read_b64_tr_b16 v[50:51], v111 offset:4352
    ds_read_b64_tr_b16 v[72:73], v111 offset:4128
    ds_read_b64_tr_b16 v[74:75], v111 offset:4384
    ds_read_b64_tr_b16 v[52:53], v111 offset:6144
    ds_read_b64_tr_b16 v[54:55], v111 offset:6400
    ds_read_b64_tr_b16 v[76:77], v111 offset:6176
    ds_read_b64_tr_b16 v[78:79], v111 offset:6432
    ds_read_b64_tr_b16 v[56:57], v111 offset:8192
    ds_read_b64_tr_b16 v[58:59], v111 offset:8448
    ds_read_b64_tr_b16 v[80:81], v111 offset:8224
    ds_read_b64_tr_b16 v[82:83], v111 offset:8480
    ds_read_b64_tr_b16 v[60:61], v111 offset:10240
    ds_read_b64_tr_b16 v[62:63], v111 offset:10496
    ds_read_b64_tr_b16 v[84:85], v111 offset:10272
    ds_read_b64_tr_b16 v[86:87], v111 offset:10528
    s_branch GPW
GP0:
    buffer_load_dwordx4 v[32:35], v108, s[16:19], s79 offen sc1
    buffer_load_dwordx4 v[36:39], v108, s[16:19], s79 offen offset:3072 sc1
GPW:
    s_add_u32 s76, s76, 1
    s_cmp_ge_u32 s76, 32768
    s_waitcnt vmcnt(0)
    v_add_f32 v2, v32, v33
    v_add_f32 v3, v36, v37
    v_add_f32 v34, v34, v35
    v_add_f32 v38, v38, v39
    v_add_f32 v2, v2, v34
    v_add_f32 v3, v3, v38
    v_cmp_u_f32 vcc, v2, v3
    s_cbranch_scc1 GPO
    s_cbranch_vccnz GP0
    s_branch GPO
OWL:
    buffer_load_dword v34, v37, s[16:19], 0 offen sc1
    buffer_load_dword v35, v38, s[16:19], 0 offen sc1
    s_branch OWB
WNOT0:
    s_cmp_lg_u32 s74, 0
    s_cbranch_scc1 STB
    s_cmp_eq_u32 s72, 1
    s_cbranch_scc1 WPREP
    s_cmp_eq_u32 s72, 3
    s_cbranch_scc1 WLC
    v_mov_b32 v52, -1
    v_mov_b32 v53, -1
    v_mov_b32 v54, -1
    v_mov_b32 v55, -1
    s_add_u32 s77, s80, 819200
    s_add_u32 s7, s77, 81920
    s_sleep 8
    s_mov_b64 exec, s[44:45]
    buffer_store_dwordx4 v[52:55], v18, s[16:19], s77 offen sc1
    s_mov_b64 exec, s[92:93]
    buffer_store_dwordx4 v[52:55], v18, s[16:19], s7 offen sc1
    s_mov_b64 exec, -1
    s_branch WPREP
WLC:
    s_mul_i32 s77, s69, 1248
    s_add_u32 s78, s3, 851968
    v_add_u32 v100, s77, v1
    v_min_u32 v100, 24816, v100
    s_add_u32 s77, s77, 1024
    v_add_u32 v101, s77, v1
    v_min_u32 v101, 24816, v101
    s_add_u32 s77, s77, 1024
    v_mov_b32 v104, -1
    v_mov_b32 v105, -1
    v_mov_b32 v106, -1
    v_mov_b32 v107, -1
    ds_read_b64_tr_b16 v[40:41], v16 offset:0
    ds_read_b64_tr_b16 v[42:43], v16 offset:1536
    ds_read_b64_tr_b16 v[44:45], v16 offset:12288
    ds_read_b64_tr_b16 v[46:47], v16 offset:13824
    ds_read_b64_tr_b16 v[48:49], v17 offset:24576
    ds_read_b64_tr_b16 v[50:51], v16 offset:32
    ds_read_b64_tr_b16 v[52:53], v16 offset:1568
    ds_read_b64_tr_b16 v[54:55], v16 offset:12320
    ds_read_b64_tr_b16 v[56:57], v16 offset:13856
    ds_read_b64_tr_b16 v[58:59], v17 offset:24608
    ds_read_b64_tr_b16 v[60:61], v16 offset:64
    ds_read_b64_tr_b16 v[62:63], v16 offset:1600
    ds_read_b64_tr_b16 v[64:65], v16 offset:12352
    ds_read_b64_tr_b16 v[66:67], v16 offset:13888
    ds_read_b64_tr_b16 v[68:69], v17 offset:24640
    v_and_b32 v25, 15, v0
    v_cmp_eq_u32 vcc, 12, v25
    v_mov_b32 v36, 0x3f803f80
    s_nop 0
    v_cndmask_b32 v70, 0, v36, vcc
    v_mov_b32 v71, v70
    v_mov_b32 v72, v70
    v_mov_b32 v73, v70
    v_mov_b32 v74, v70
    v_mov_b32 v75, v70
    v_mov_b32 v76, v70
    v_mov_b32 v77, v70
    v_mov_b32 v78, v70
    v_mov_b32 v79, v70
    s_mov_b32 s77, 4096
    v_mul_u32_u24 v96, 103, v0
    v_lshrrev_b32 v96, 10, v96
    v_lshl_add_u32 v96, v96, 4, v1
    v_add_u32 v96, s77, v96
    v_mul_u32_u24 v97, 176, v25
    v_add_u32 v97, s77, v97
    v_lshrrev_b32 v28, 4, v0
    v_lshl_add_u32 v98, v28, 3, v97
    v_lshl_add_u32 v97, v28, 4, v97
    buffer_store_dwordx4 v[104:107], v100, s[8:11], s78 offen
    s_cmp_eq_u32 s10, 0
    s_cbranch_scc1 SLOW15
BACK15:
    buffer_store_dwordx4 v[104:107], v101, s[8:11], s78 offen
    s_cmp_eq_u32 s10, 0
    s_cbranch_scc1 SLOW16
BACK16:
    s_branch STB
WPREP:
    s_nop 1
    ds_read_b64_tr_b16 v[40:41], v16 offset:0
    ds_read_b64_tr_b16 v[42:43], v16 offset:1536
    ds_read_b64_tr_b16 v[44:45], v16 offset:12288
    ds_read_b64_tr_b16 v[46:47], v16 offset:13824
    ds_read_b64_tr_b16 v[48:49], v17 offset:24576
    ds_read_b64_tr_b16 v[50:51], v16 offset:32
    ds_read_b64_tr_b16 v[52:53], v16 offset:1568
    ds_read_b64_tr_b16 v[54:55], v16 offset:12320
    ds_read_b64_tr_b16 v[56:57], v16 offset:13856
    ds_read_b64_tr_b16 v[58:59], v17 offset:24608
    ds_read_b64_tr_b16 v[60:61], v16 offset:64
    ds_read_b64_tr_b16 v[62:63], v16 offset:1600
    ds_read_b64_tr_b16 v[64:65], v16 offset:12352
    ds_read_b64_tr_b16 v[66:67], v16 offset:13888
    ds_read_b64_tr_b16 v[68:69], v17 offset:24640
    v_and_b32 v25, 15, v0
    v_cmp_eq_u32 vcc, 12, v25
    v_mov_b32 v36, 0x3f803f80
    s_nop 0
    v_cndmask_b32 v70, 0, v36, vcc
    v_mov_b32 v71, v70
    v_mov_b32 v72, v70
    v_mov_b32 v73, v70
    v_mov_b32 v74, v70
    v_mov_b32 v75, v70
    v_mov_b32 v76, v70
    v_mov_b32 v77, v70
    v_mov_b32 v78, v70
    v_mov_b32 v79, v70
    s_mov_b32 s77, 4096
    v_mul_u32_u24 v96, 103, v0
    v_lshrrev_b32 v96, 10, v96
    v_lshl_add_u32 v96, v96, 4, v1
    v_add_u32 v96, s77, v96
    v_mul_u32_u24 v97, 176, v25
    v_add_u32 v97, s77, v97
    v_lshrrev_b32 v28, 4, v0
    v_lshl_add_u32 v98, v28, 3, v97
    v_lshl_add_u32 v97, v28, 4, v97
    s_branch STB
WOWN:
    v_and_b32 v25, 15, v0
    v_lshrrev_b32 v26, 4, v0
    s_mul_i32 s7, s68, 10240
    s_cmp_eq_u32 s74, 0
    s_cselect_b32 s7, 0, s7
    s_add_u32 s7, s7, 655360
    v_mul_u32_u24 v37, 1280, v26
    v_add_u32 v37, s7, v37
    s_mul_i32 s7, s68, 81920
    s_add_u32 s7, s7, 45312
    v_mov_b32 v38, s7
    v_cmp_eq_u32 vcc, s68, v26
    s_nop 1
    v_cndmask_b32 v37, v37, v38, vcc
    v_add_u32 v39, 4, v26
    s_mul_i32 s7, s68, 10240
    s_cmp_eq_u32 s74, 0
    s_cselect_b32 s7, 0, s7
    s_add_u32 s7, s7, 655360
    v_mul_u32_u24 v38, 1280, v39
    v_add_u32 v38, s7, v38
    s_mul_i32 s7, s68, 81920
    s_add_u32 s7, s7, 45312
    v_mov_b32 v28, s7
    v_cmp_eq_u32 vcc, s68, v39
    s_nop 1
    v_cndmask_b32 v38, v38, v28, vcc
    s_lshl_b32 s77, s69, 6
    s_add_u32 s77, s77, s74
    v_lshl_add_u32 v25, v25, 2, s77
    v_add_u32 v37, v25, v37
    v_add_u32 v38, v25, v38
    s_cmp_eq_u32 s74, 0
    s_cbranch_scc1 GP1
    s_sleep 9
    s_mov_b32 s76, 1
POLL17:
    buffer_load_dword v28, v37, s[16:19], 0 offen sc1
    buffer_load_dword v29, v38, s[16:19], 0 offen sc1
POLLW17:
    s_waitcnt vmcnt(0)
    v_max_u32 v30, v28, v29
    v_cmp_eq_u32 vcc, -1, v30
    s_cbranch_vccnz AGAIN17
POLLX17:
    v_lshlrev_b32 v30, 16, v28
    v_and_b32 v28, 0xffff0000, v28
    v_lshlrev_b32 v31, 16, v29
    v_and_b32 v29, 0xffff0000, v29
    v_add_f32 v30, v30, v31
    v_add_f32 v28, v28, v29
    v_mov_b32 v31, v30
    v_mov_b32 v29, v28
    s_nop 0
    v_permlane32_swap_b32 v30, v31
    v_permlane32_swap_b32 v28, v29
    v_add_f32 v30, v30, v31
    v_add_f32 v28, v28, v29
    v_mov_b32 v31, v30
    v_mov_b32 v29, v28
    s_nop 0
    v_permlane16_swap_b32 v30, v31
    v_permlane16_swap_b32 v28, v29
    v_add_f32 v30, v30, v31
    v_add_f32 v28, v28, v29
    v_add_f32 v22, v22, v30
    v_add_f32 v23, v23, v28
    v_cvt_pk_bf16_f32 v28, v22, v23
    s_branch GP1
STBX:
    s_cmp_lg_u32 s72, 1
    s_cbranch_scc1 NEXT
    s_cmp_lg_u32 s74, 0
    s_cbranch_scc1 FINAL
    s_waitcnt vmcnt(0)
    v_mov_b32 v28, v34
    v_mov_b32 v29, v35
    v_max_u32 v30, v28, v29
    v_cmp_eq_u32 vcc, -1, v30
    s_cbranch_vccnz RETRY18
OK18:
    v_lshlrev_b32 v30, 16, v28
    v_and_b32 v28, 0xffff0000, v28
    v_lshlrev_b32 v31, 16, v29
    v_and_b32 v29, 0xffff0000, v29
    v_add_f32 v30, v30, v31
    v_add_f32 v28, v28, v29
    v_mov_b32 v31, v30
    v_mov_b32 v29, v28
    s_nop 0
    v_permlane32_swap_b32 v30, v31
    v_permlane32_swap_b32 v28, v29
    v_add_f32 v30, v30, v31
    v_add_f32 v28, v28, v29
    v_mov_b32 v31, v30
    v_mov_b32 v29, v28
    s_nop 0
    v_permlane16_swap_b32 v30, v31
    v_permlane16_swap_b32 v28, v29
    v_add_f32 v30, v30, v31
    v_add_f32 v28, v28, v29
    v_add_f32 v22, v22, v30
    v_add_f32 v23, v23, v28
    v_cvt_pk_bf16_f32 v28, v22, v23
    s_lshl_b32 s77, s69, 6
    s_add_u32 s77, s77, s3
    s_add_u32 s77, s77, 49152
    v_lshlrev_b32 v32, 2, v0
    v_mov_b32_dpp v29, v28 quad_perm:[1,1,1,1] row_mask:0xf bank_mask:0xf
    v_mov_b32_dpp v30, v28 quad_perm:[2,2,2,2] row_mask:0xf bank_mask:0xf
    v_mov_b32_dpp v31, v28 quad_perm:[3,3,3,3] row_mask:0xf bank_mask:0xf
    s_mov_b32 exec_lo, 0x1111
    s_mov_b32 exec_hi, 0x0
    buffer_store_dwordx4 v[28:31], v32, s[8:11], s77 offen
    s_cmp_eq_u32 s10, 0
    s_cbranch_scc1 SLOW19
BACK19:
    s_mov_b64 exec, -1
    s_branch NEXT
FINAL:
    s_cmp_lg_u32 s68, 0
    s_cbranch_scc1 DONE
    s_lshl_b32 s77, s69, 6
    v_lshlrev_b32 v37, 2, v0
    s_add_u32 s79, s77, s3
    s_add_u32 s79, s79, 46592
    s_mov_b64 exec, 15
    s_mov_b32 s76, 1
POLL20:
    buffer_load_dword v28, v1, s[16:19], s79 offen sc1
POLLW20:
    s_waitcnt vmcnt(0)
    v_cmp_eq_u32 vcc, -1, v28
    s_cbranch_vccnz AGAIN20
POLLX20:
    s_mov_b64 exec, -1
    s_mov_b32 s76, 1
POLL21:
    buffer_load_dword v28, v20, s[16:19], s74 offen sc1
    buffer_load_dword v29, v21, s[16:19], s74 offen sc1
POLLW21:
    s_waitcnt vmcnt(0)
    v_max_u32 v30, v28, v29
    v_cmp_eq_u32 vcc, -1, v30
    s_cbranch_vccnz AGAIN21
POLLX21:
    v_lshlrev_b32 v30, 16, v28
    v_and_b32 v28, 0xffff0000, v28
    v_lshlrev_b32 v31, 16, v29
    v_and_b32 v29, 0xffff0000, v29
    v_add_f32 v30, v30, v31
    v_add_f32 v28, v28, v29
    v_mov_b32 v31, v30
    v_mov_b32 v29, v28
    s_nop 0
    v_permlane32_swap_b32 v30, v31
    v_permlane32_swap_b32 v28, v29
    v_add_f32 v30, v30, v31
    v_add_f32 v28, v28, v29
    v_mov_b32 v31, v30
    v_mov_b32 v29, v28
    s_nop 0
    v_permlane16_swap_b32 v30, v31
    v_permlane16_swap_b32 v28, v29
    v_add_f32 v30, v30, v31
    v_add_f32 v28, v28, v29
    v_add_f32 v22, v22, v30
    v_add_f32 v23, v23, v28
    v_cvt_pk_bf16_f32 v28, v22, v23
    s_mov_b32 exec_lo, 0xffff
    s_mov_b32 exec_hi, 0x0
    buffer_store_dword v28, v37, s[40:43], s77 offen
    s_mov_b64 exec, -1
    s_endpgm
AGAIN17:
    s_sleep 2
    s_add_u32 s76, s76, 1
    s_cmp_lt_u32 s76, 32768
    s_cbranch_scc1 POLL17
    s_branch POLLX17
AGAIN20:
    s_add_u32 s76, s76, 1
    s_cmp_lt_u32 s76, 32768
    s_cbranch_scc1 POLL20
    s_branch POLLX20
AGAIN21:
    s_add_u32 s76, s76, 1
    s_cmp_lt_u32 s76, 32768
    s_cbranch_scc1 POLL21
    s_branch POLLX21
ROLEF:
    v_and_b32 v25, 15, v0
    v_lshrrev_b32 v26, 4, v0
    v_bfe_u32 v27, v0, 2, 2
    v_and_b32 v36, 3, v0
    s_cmp_lg_u32 s74, 0
    s_cbranch_scc1 FW
    v_lshrrev_b32 v38, 3, v0
    v_mul_u32_u24 v38, 3072, v38
    v_and_b32 v39, 7, v0
    v_lshl_add_u32 v38, v39, 4, v38
    v_bfe_u32 v39, v0, 4, 1
    v_lshlrev_b32 v39, 5, v39
    v_xor_b32 v38, v38, v39
    v_xor_b32 v39, 64, v38
    s_mov_b32 m0, s67
    s_add_u32 s67, s67, 1024
    buffer_load_dwordx4 v38, s[36:39], s66 offen nt lds
    s_add_u32 s66, s66, 24576
    s_mov_b32 m0, s67
    s_add_u32 s67, s67, 1024
    buffer_load_dwordx4 v39, s[36:39], s66 offen nt lds
    s_add_u32 s66, s66, 24576
    s_mov_b32 m0, s67
    s_add_u32 s67, s67, 1024
    buffer_load_dwordx4 v38, s[36:39], s66 offen nt lds
    s_add_u32 s66, s66, 24576
    s_mov_b32 m0, s67
    s_add_u32 s67, s67, 1024
    buffer_load_dwordx4 v39, s[36:39], s66 offen nt lds
    s_add_u32 s66, s66, 24576
    s_mov_b32 m0, s67
    s_add_u32 s67, s67, 1024
    buffer_load_dwordx4 v38, s[36:39], s66 offen nt lds
    s_add_u32 s66, s66, 24576
    s_mov_b32 m0, s67
    s_add_u32 s67, s67, 1024
    buffer_load_dwordx4 v39, s[36:39], s66 offen nt lds
    s_add_u32 s66, s66, 24576
    s_mov_b32 m0, s67
    s_add_u32 s67, s67, 1024
    buffer_load_dwordx4 v38, s[36:39], s66 offen nt lds
    s_add_u32 s66, s66, 24576
    s_mov_b32 m0, s67
    s_add_u32 s67, s67, 1024
    buffer_load_dwordx4 v39, s[36:39], s66 offen nt lds
    s_add_u32 s66, s66, 24576
    s_mov_b32 m0, s67
    s_add_u32 s67, s67, 1024
    buffer_load_dwordx4 v38, s[36:39], s66 offen nt lds
    s_add_u32 s66, s66, 24576
    s_mov_b32 m0, s67
    s_add_u32 s67, s67, 1024
    buffer_load_dwordx4 v39, s[36:39], s66 offen nt lds
    s_add_u32 s66, s66, 24576
    s_sub_u32 s96, s69, 20
    s_lshl_b32 s96, s96, 2
    s_add_u32 s96, s96, s72
    s_mul_i32 s96, s96, 688
    v_add_u32 v21, s96, v1
    v_min_u32 v21, 32752, v21
    s_add_u32 s97, s3, 819200
    s_add_u32 s77, s3, 1638400
    buffer_store_dword v7, v10, s[8:11], s77 offen
    s_cmp_eq_u32 s10, 0
    s_cbranch_scc1 SLOW22
BACK22:
FW:
    s_lshl_b32 s77, s72, 5
    v_lshl_add_u32 v80, v36, 3, s77
    v_lshrrev_b32 v37, 1, v27
    v_and_b32 v38, 1, v26
    v_lshl_add_u32 v37, v38, 1, v37
    v_lshlrev_b32 v37, 5, v37
    v_xor_b32 v80, v80, v37
    v_lshl_add_u32 v37, v26, 3, v27
    v_lshl_add_u32 v80, v37, 7, v80
    v_add_u32 v80, 57344, v80
    s_sub_u32 s79, s69, 20
    s_and_b32 s7, s79, 12
    s_add_u32 s7, s7, s72
    s_lshl_b32 s78, s7, 8
    v_lshl_add_u32 v83, v25, 4, s78
    v_lshrrev_b32 v84, 2, v83
    v_mov_b32 v37, 768
    v_cmp_le_u32 vcc, 2, v26
    s_nop 1
    v_cndmask_b32 v84, v84, v37, vcc
    v_and_b32 v37, 1, v26
    v_mul_u32_u24 v37, 3584, v37
    v_add_u32 v84, v84, v37
    s_cmp_eq_u32 s7, 0
    s_mov_b32 s52, -1
    s_cselect_b32 s53, 0x10001, 0
    s_and_b32 s79, s79, 3
    s_mul_i32 s78, s79, 892
    s_sub_u32 s78, 7168, s78
    v_add_u32 v83, s78, v83
    s_mul_i32 s78, s79, 896
    s_add_u32 s78, s78, s3
    s_add_u32 s78, s78, 50432
    s_mul_i32 s79, s79, 320
    v_cmp_eq_u32 vcc, 12, v25
    v_mov_b32 v38, 0x3f803f80
    s_nop 0
    v_cndmask_b32 v88, 0, v38, vcc
    v_mov_b32 v89, v88
    v_mov_b32 v90, v88
    v_mov_b32 v91, v88
    v_mov_b32 v92, v88
    v_mov_b32 v93, v88
    v_mov_b32 v94, v88
    v_mov_b32 v95, v88
    v_mov_b32 v96, v88
    v_mov_b32 v97, v88
    v_mov_b32 v98, v88
    v_mov_b32 v99, v88
    v_mov_b32 v100, v88
    v_mov_b32 v101, v88
    v_mov_b32 v102, v88
    v_mov_b32 v103, v88
    v_mov_b32 v104, v88
    v_mov_b32 v105, v88
    v_mov_b32 v106, v88
    v_mov_b32 v107, v88
    v_mul_u32_u24 v6, 336, v25
    v_lshl_add_u32 v6, v26, 4, v6
    s_mul_i32 s77, s72, 45
    v_min_u32 v27, 44, v0
    v_add_u32 v27, s77, v27
    v_mul_u32_u24 v37, 205, v27
    v_lshrrev_b32 v37, 12, v37
    v_add_u32 v87, v37, v27
    v_lshlrev_b32 v87, 4, v87
    v_mul_u32_u24 v38, 20, v37
    v_sub_u32 v27, v27, v38
    v_lshlrev_b32 v27, 4, v27
    s_mul_i32 s7, s68, 10240
    s_cmp_eq_u32 s74, 0
    s_cselect_b32 s7, 0, s7
    s_add_u32 s7, s7, 655360
    v_mul_u32_u24 v86, 1280, v37
    v_add_u32 v86, s7, v86
    s_mul_i32 s7, s68, 81920
    s_add_u32 s7, s7, 45312
    v_mov_b32 v38, s7
    v_cmp_eq_u32 vcc, s68, v37
    s_nop 1
    v_cndmask_b32 v86, v86, v38, vcc
    v_add_u32 v38, 2560, v38
    v_cmp_le_u32 vcc, 8, v37
    s_nop 1
    v_cndmask_b32 v86, v86, v38, vcc
    v_add_u32 v86, v86, v27
    s_add_u32 s77, s79, s74
    s_add_u32 s79, s79, s3
    s_add_u32 s79, s79, 45312
    s_cmp_lg_u32 s74, 0
    s_cbranch_scc1 FW1
    v_mov_b32 v24, -1
    v_mov_b32 v25, -1
    v_mov_b32 v26, -1
    v_mov_b32 v27, -1
    s_waitcnt vmcnt(0)
    buffer_store_dwordx4 v[24:27], v21, s[8:11], s97 offen
    s_cmp_eq_u32 s10, 0
    s_cbranch_scc1 SLOW23
BACK23:
    s_barrier
FW1:
    ds_read_b64_tr_b16 v[40:41], v80 offset:0
    ds_read_b64_tr_b16 v[42:43], v80 offset:512
    ds_read_b64_tr_b16 v[44:45], v80 offset:4096
    ds_read_b64_tr_b16 v[46:47], v80 offset:4608
    ds_read_b64_tr_b16 v[48:49], v80 offset:8192
    ds_read_b64_tr_b16 v[50:51], v80 offset:8704
    ds_read_b64_tr_b16 v[52:53], v80 offset:12288
    ds_read_b64_tr_b16 v[54:55], v80 offset:12800
    ds_read_b64_tr_b16 v[56:57], v80 offset:16384
    ds_read_b64_tr_b16 v[58:59], v80 offset:16896
    ds_read_b64_tr_b16 v[60:61], v80 offset:20480
    ds_read_b64_tr_b16 v[62:63], v80 offset:20992
    ds_read_b64_tr_b16 v[64:65], v80 offset:24576
    ds_read_b64_tr_b16 v[66:67], v80 offset:25088
    ds_read_b64_tr_b16 v[68:69], v80 offset:28672
    ds_read_b64_tr_b16 v[70:71], v80 offset:29184
    ds_read_b64_tr_b16 v[72:73], v80 offset:32768
    ds_read_b64_tr_b16 v[74:75], v80 offset:33280
    ds_read_b64_tr_b16 v[76:77], v80 offset:36864
    ds_read_b64_tr_b16 v[78:79], v80 offset:37376
    s_cmp_lg_u32 s74, 0
    s_cbranch_scc1 FW3
    s_waitcnt lgkmcnt(0)
    v_mfma_f32_16x16x32_bf16 v[108:111], v[88:91], v[40:43], 0
    v_mfma_f32_16x16x32_bf16 v[2:5], v[88:91], v[60:63], 0
    v_mfma_f32_16x16x32_bf16 v[108:111], v[92:95], v[44:47], v[108:111]
    v_mfma_f32_16x16x32_bf16 v[2:5], v[92:95], v[64:67], v[2:5]
    v_mfma_f32_16x16x32_bf16 v[108:111], v[96:99], v[48:51], v[108:111]
    v_mfma_f32_16x16x32_bf16 v[2:5], v[96:99], v[68:71], v[2:5]
    v_mfma_f32_16x16x32_bf16 v[108:111], v[100:103], v[52:55], v[108:111]
    v_mfma_f32_16x16x32_bf16 v[2:5], v[100:103], v[72:75], v[2:5]
    v_mfma_f32_16x16x32_bf16 v[108:111], v[104:107], v[56:59], v[108:111]
    v_mfma_f32_16x16x32_bf16 v[2:5], v[104:107], v[76:79], v[2:5]
FW3:
    s_mov_b32 exec_lo, 0xfffff
    s_mov_b32 exec_hi, 0x0
    s_mov_b32 s76, 1
POLL24:
    buffer_load_dword v36, v1, s[16:19], s79 offen sc1
POLLW24:
    s_waitcnt vmcnt(0)
    v_cmp_eq_u32 vcc, -1, v36
    s_cbranch_vccnz AGAIN24
POLLX24:
    s_mov_b64 exec, s[86:87]
    buffer_load_dwordx4 v[24:27], v86, s[16:19], s77 offen sc1
    s_cmp_eq_u32 s74, 0
    s_cbranch_scc1 CSP
    s_waitcnt vmcnt(0)
CSB:
    s_waitcnt vmcnt(2)
BW25:
    ds_write_b128 v87, v[24:27]
    v_cmp_eq_u32 vcc, -1, v24
    s_cbranch_vccnz BR25
BX25:
    s_mov_b64 exec, s[84:85]
    s_waitcnt lgkmcnt(0)
    s_barrier
    ds_read_b128 v[88:91], v6 offset:0
    ds_read_b128 v[92:95], v6 offset:64
    ds_read_b128 v[96:99], v6 offset:128
    ds_read_b128 v[100:103], v6 offset:192
    ds_read_b128 v[104:107], v6 offset:256
    s_mov_b64 exec, -1
    s_waitcnt lgkmcnt(4)
    v_mfma_f32_16x16x32_bf16 v[32:35], v[88:91], v[88:91], 0
    s_waitcnt lgkmcnt(3)
    v_mfma_f32_16x16x32_bf16 v[32:35], v[92:95], v[92:95], v[32:35]
    s_waitcnt lgkmcnt(2)
    v_mfma_f32_16x16x32_bf16 v[32:35], v[96:99], v[96:99], v[32:35]
    s_waitcnt lgkmcnt(1)
    v_mfma_f32_16x16x32_bf16 v[32:35], v[100:103], v[100:103], v[32:35]
    s_waitcnt lgkmcnt(0)
    v_mfma_f32_16x16x32_bf16 v[32:35], v[104:107], v[104:107], v[32:35]
    v_mfma_f32_16x16x32_bf16 v[24:27], v[88:91], v[40:43], 0
    v_mov_b32 v36, 0
    v_mov_b32 v37, 0
    v_mfma_f32_16x16x32_bf16 v[24:27], v[92:95], v[44:47], v[24:27]
    v_mov_b32 v38, 0
    s_nop 0
    v_mfma_f32_16x16x32_bf16 v[24:27], v[96:99], v[48:51], v[24:27]
    v_mfma_f32_16x16x32_bf16 v[24:27], v[100:103], v[52:55], v[24:27]
    v_add_f32 v32, v32, v33
    v_add_f32 v34, v34, v35
    v_mfma_f32_16x16x32_bf16 v[24:27], v[104:107], v[56:59], v[24:27]
    v_mfma_f32_16x16x32_bf16 v[28:31], v[88:91], v[60:63], 0
    v_add_f32_dpp v36, v32, v34 quad_perm:[0,1,2,3] row_mask:0xf bank_mask:0x7
    v_mfma_f32_16x16x32_bf16 v[28:31], v[92:95], v[64:67], v[28:31]
    s_nop 0
    v_add_f32_dpp v36, v36, v36 row_ror:8 row_mask:0xf bank_mask:0xf
    v_mfma_f32_16x16x32_bf16 v[28:31], v[96:99], v[68:71], v[28:31]
    s_nop 0
    v_add_f32_dpp v36, v36, v36 row_ror:4 row_mask:0xf bank_mask:0xf
    v_mfma_f32_16x16x32_bf16 v[28:31], v[100:103], v[72:75], v[28:31]
    s_nop 0
    v_add_f32_dpp v36, v36, v36 row_ror:2 row_mask:0xf bank_mask:0xf
    v_mfma_f32_16x16x32_bf16 v[28:31], v[104:107], v[76:79], v[28:31]
    v_add_f32 v25, v24, v25
    v_add_f32_dpp v37, v36, v36 row_ror:1 row_mask:0x7 bank_mask:0xf
    v_add_f32_dpp v38, v36, v36 row_ror:1 row_mask:0x8 bank_mask:0xf
    v_add_f32 v26, v26, v27
    v_add_f32 v25, v25, v26
    s_nop 1
    v_permlane32_swap_b32 v25, v37
    v_add_f32 v29, v28, v29
    v_add_f32 v30, v30, v31
    v_add_f32 v29, v29, v30
    v_add_f32 v25, v25, v37
    s_nop 0
    v_permlane32_swap_b32 v29, v38
    v_add_f32 v29, v29, v38
    s_nop 1
    v_permlane16_swap_b32 v25, v29
    s_mov_b64 exec, s[52:53]
    v_add_f32 v25, v25, v29
    buffer_store_dword v25, v84, s[8:11], s78 offen
    s_cmp_eq_u32 s10, 0
    s_cbranch_scc1 SLOW26
BACK26:
    s_mov_b64 exec, -1
NEXT:
    s_cmp_lg_u32 s74, 0
    s_cbranch_scc1 DONE
    s_mov_b32 s74, 819200
    s_add_u32 s3, s3, 819200
    s_add_u32 s80, s80, 819200
    s_add_u32 s81, s81, 819200
    s_mov_b64 s[46:47], s[44:45]
    s_mov_b64 s[48:49], s[92:93]
    s_branch LOOP
AGAIN24:
    s_add_u32 s76, s76, 1
    s_cmp_lt_u32 s76, 32768
    s_cbranch_scc1 POLL24
    s_branch POLLX24
CSP:
    s_mov_b32 exec_lo, 0x0
    s_mov_b32 exec_hi, 0xffff0000
    buffer_store_dword v108, v83, s[8:11], s78 offen
    s_cmp_eq_u32 s10, 0
    s_cbranch_scc1 SLOW27
BACK27:
    buffer_store_dword v2, v83, s[8:11], s78 offen offset:3072
    s_cmp_eq_u32 s10, 0
    s_cbranch_scc1 SLOW28
BACK28:
    s_mov_b64 exec, s[86:87]
    s_branch CSB
BR25:
    s_cmp_ge_u32 s76, 32768
    s_cbranch_scc1 BX25
    s_mov_b64 exec, vcc
    buffer_load_dwordx4 v[24:27], v86, s[16:19], s77 offen sc1
    s_add_u32 s76, s76, 1
    s_waitcnt vmcnt(0)
    s_branch BW25
DONE:
    s_endpgm
TAGLOOP:
    s_mov_b32 s76, 0
TAGL2:
    s_sleep 8
    global_load_dword v98, v100, s[64:65] sc1
    s_waitcnt vmcnt(0)
    v_readfirstlane_b32 s96, v98
    s_nop 0
    s_cmp_lg_u32 s96, 0
    s_cbranch_scc1 TAGOK
    s_add_u32 s76, s76, 1
    s_cmp_lt_u32 s76, 32768
    s_cbranch_scc1 TAGL2
    s_branch TAGOK
DMAF:
    s_sub_u32 s78, s69, 20
    s_and_b32 s66, s78, 3
    s_lshl_b32 s66, s66, 1
    s_and_b32 s79, s72, 1
    s_add_u32 s66, s66, s79
    s_mul_i32 s66, s66, 245760
    s_lshr_b32 s78, s78, 2
    s_lshl_b32 s78, s78, 7
    s_add_u32 s66, s66, s78
    s_mul_i32 s78, s68, 384
    s_add_u32 s66, s66, s78
    s_mul_i32 s67, s72, 10240
    s_add_u32 s67, s67, 57344
    s_branch DMAX
RDYLOOP:
    s_mov_b32 s76, 0
RDYL2:
    s_sleep 8
    buffer_load_dwordx2 v[98:99], v100, s[16:19], 0 offen offset:384 sc1
    s_waitcnt vmcnt(0)
    v_cmp_ne_u32 vcc, s96, v98
    s_cbranch_vccz RDYOK
    s_add_u32 s76, s76, 1
    s_cmp_lt_u32 s76, 32768
    s_cbranch_scc1 RDYL2
    s_branch RDYOK
SLOW1:
    buffer_store_dwordx4 v[28:31], v27, s[16:19], s77 offen sc1
    s_branch BACK1
SLOW2:
    buffer_store_dwordx4 v[24:27], v106, s[16:19], 0 offen sc1
    s_branch BACK2
SLOW5:
    buffer_store_dword v24, v10, s[16:19], s3 offen sc1
    s_branch BACK5
SLOW7:
    buffer_store_dwordx4 v[28:31], v1, s[16:19], s77 offen sc1
    s_branch BACK7
RETRY8:
    s_mov_b32 s76, 1
POLL29:
    buffer_load_dword v28, v20, s[16:19], 0 offen sc1
    buffer_load_dword v29, v21, s[16:19], 0 offen sc1
POLLW29:
    s_waitcnt vmcnt(0)
    v_max_u32 v30, v28, v29
    v_cmp_eq_u32 vcc, -1, v30
    s_cbranch_vccnz AGAIN29
POLLX29:
    s_branch OK8
AGAIN29:
    s_add_u32 s76, s76, 1
    s_cmp_lt_u32 s76, 32768
    s_cbranch_scc1 POLL29
    s_branch POLLX29
SLOW9:
    buffer_store_dwordx4 v[28:31], v32, s[16:19], s77 offen sc1
    s_branch BACK9
SLOW11:
    buffer_store_dwordx4 v[28:31], v18, s[16:19], s81 offen sc1
    s_branch BACK11
SLOW12:
    buffer_store_dwordx4 v[28:31], v18, s[16:19], s97 offen sc1
    s_branch BACK12
SLOW13:
    buffer_store_dwordx2 v[34:35], v1, s[16:19], s78 offen sc1
    s_branch BACK13
SLOW14:
    buffer_store_dword v7, v10, s[16:19], s77 offen sc1
    s_branch BACK14
SLOW15:
    buffer_store_dwordx4 v[104:107], v100, s[16:19], s78 offen sc1
    s_branch BACK15
SLOW16:
    buffer_store_dwordx4 v[104:107], v101, s[16:19], s78 offen sc1
    s_branch BACK16
RETRY18:
    s_mov_b32 s76, 1
POLL30:
    buffer_load_dword v28, v37, s[16:19], 0 offen sc1
    buffer_load_dword v29, v38, s[16:19], 0 offen sc1
POLLW30:
    s_waitcnt vmcnt(0)
    v_max_u32 v30, v28, v29
    v_cmp_eq_u32 vcc, -1, v30
    s_cbranch_vccnz AGAIN30
POLLX30:
    s_branch OK18
AGAIN30:
    s_add_u32 s76, s76, 1
    s_cmp_lt_u32 s76, 32768
    s_cbranch_scc1 POLL30
    s_branch POLLX30
SLOW19:
    buffer_store_dwordx4 v[28:31], v32, s[16:19], s77 offen sc1
    s_branch BACK19
SLOW22:
    buffer_store_dword v7, v10, s[16:19], s77 offen sc1
    s_branch BACK22
SLOW23:
    buffer_store_dwordx4 v[24:27], v21, s[16:19], s97 offen sc1
    s_branch BACK23
SLOW26:
    buffer_store_dword v25, v84, s[16:19], s78 offen sc1
    s_branch BACK26
SLOW27:
    buffer_store_dword v108, v83, s[16:19], s78 offen sc1
    s_branch BACK27
SLOW28:
    buffer_store_dword v2, v83, s[16:19], s78 offen offset:3072 sc1
    s_branch BACK28
CODE_END:
    s_endpgm
.section .rodata,"a"
.p2align 6
.amdhsa_kernel interleave_layers__sliding_block_cached__glu_gated_swiglu__decode_kernel
  .amdhsa_next_free_vgpr 512
  .amdhsa_next_free_sgpr 102
  .amdhsa_accum_offset 256
  .amdhsa_group_segment_fixed_size 0
  .amdhsa_kernarg_size 96
  .amdhsa_user_sgpr_count 2
  .amdhsa_user_sgpr_kernarg_segment_ptr 1
  .amdhsa_system_sgpr_workgroup_id_x 1
.end_amdhsa_kernel
```

```asm
; @launch grid=(256,1,1) block=(256,1,1) lds=125568
.amdgcn_target "amdgcn-amd-amdhsa--gfx950"
.text
.globl interleave_layers__sliding_block_cached__glu_gated_swiglu__decode_kernel
.p2align 8
.type interleave_layers__sliding_block_cached__glu_gated_swiglu__decode_kernel,@function
interleave_layers__sliding_block_cached__glu_gated_swiglu__decode_kernel:
    s_load_dwordx16 s[44:59], s[0:1], 0
    s_load_dwordx8 s[60:67], s[0:1], 64
    s_cmp_ge_u32 s2, 256
    s_cbranch_scc1 CODE_END
    s_memrealtime s[96:97]
    v_lshrrev_b32 v2, 6, v0
    v_and_b32 v24, 63, v0
    v_readfirstlane_b32 s72, v2
    s_and_b32 s68, s2, 7
    s_lshr_b32 s69, s2, 3
    s_lshr_b32 s70, s69, 3
    s_and_b32 s71, s69, 7
    v_lshlrev_b32 v1, 4, v24
    s_lshl_b32 s77, s70, 3
    s_add_u32 s77, s77, s68
    s_mul_i32 s73, s77, 12582912
    s_lshl_b32 s78, s71, 2
    s_add_u32 s78, s78, s72
    s_mul_i32 s78, s78, 6144
    s_add_u32 s73, s73, s78
    s_add_u32 s73, s73, 11010048
    v_add_u32 v23, 4096, v1
    s_mov_b32 s10, 402653184
    s_mov_b32 s11, 0x20000
    s_getpc_b64 s[100:101]
PCREF:
    s_sub_u32 s100, s100, PCREF-interleave_layers__sliding_block_cached__glu_gated_swiglu__decode_kernel
    s_subb_u32 s101, s101, 0
    s_lshl_b32 s78, s71, 12
    v_lshl_add_u32 v25, v0, 4, s78
    v_cmp_gt_u32 vcc, CODE_END-interleave_layers__sliding_block_cached__glu_gated_swiglu__decode_kernel-16, v25
    s_nop 0
    s_and_saveexec_b64 s[98:99], vcc
    s_cbranch_execz NOCPF
    global_load_dwordx4 a[240:243], v25, s[100:101]
NOCPF:
    s_mov_b64 exec, -1
    s_mul_i32 s79, s77, 384
    s_mov_b32 s74, 0
    s_mul_i32 s3, s68, 81920
    s_getreg_b32 s75, hwreg(HW_REG_XCC_ID, 0, 4)
    s_lshl_b32 s77, s69, 9
    s_add_u32 s77, s77, s3
    s_add_u32 s77, s77, 32768
    v_add_u32 v20, s77, v1
    s_lshl_b32 s77, s68, 2
    s_add_u32 s77, s77, s69
    s_mul_i32 s77, s77, 320
    s_add_u32 s77, s77, 654848
    s_add_u32 s4, s77, 1024
    v_add_u32 v25, s77, v1
    v_cmp_le_u32 vcc, 32, v0
    s_nop 1
    v_cndmask_b32 v21, v20, v25, vcc
    v_mov_b32 v25, 2147483632
    v_cndmask_b32 v20, v20, v25, vcc
    s_cmp_lt_u32 s69, 4
    s_cselect_b32 s77, 52, 32
    v_cmp_le_u32 vcc, s77, v0
    s_nop 1
    v_cndmask_b32 v21, v21, v25, vcc
    s_mov_b32 s18, 1610612736
    s_mov_b32 s19, 0x20000
    s_waitcnt lgkmcnt(0)
    s_mov_b32 s8, s46
    s_and_b32 s9, s47, 0xffff
    s_mov_b32 s16, s66
    s_and_b32 s17, s67, 0xffff
    buffer_load_dwordx4 a[0:3], v1, s[8:11], s73 offen offset:0 nt
    buffer_load_dwordx4 a[4:7], v1, s[8:11], s73 offen offset:1024 nt
    s_or_b32 s77, s2, s72
    s_cbranch_scc1 NOTAG
    s_or_b32 s77, s96, 1
    v_mov_b32 v26, s77
    s_mov_b64 exec, 1
    global_store_dword v1, v26, s[64:65] sc1
    s_mov_b64 exec, -1
NOTAG:
    s_add_u32 s83, s73, 196608
    s_mov_b32 s12, s48
    s_and_b32 s13, s49, 0xffff
    s_mov_b32 s14, 402653184
    s_mov_b32 s15, 0x20000
    s_mov_b32 s20, s50
    s_and_b32 s21, s51, 0xffff
    s_mov_b32 s22, 7864320
    s_mov_b32 s23, 0x20000
    s_mov_b32 s36, s44
    s_and_b32 s37, s45, 0xffff
    s_mov_b32 s38, 1280
    s_mov_b32 s39, 0x20000
    s_mov_b32 s40, s62
    s_and_b32 s41, s63, 0xffff
    s_mov_b32 s42, 1280
    s_mov_b32 s43, 0x20000
    s_mov_b32 s28, s58
    s_and_b32 s29, s59, 0xffff
    s_mov_b32 s30, 1966080
    s_mov_b32 s31, 0x20000
    s_mov_b32 s32, s60
    s_and_b32 s33, s61, 0xffff
    s_mov_b32 s34, 1966080
    s_mov_b32 s35, 0x20000
    s_cmp_lt_u32 s69, 20
    s_cselect_b32 s24, s52, s56
    s_cselect_b32 s25, s53, s57
    s_cselect_b32 s26, s22, s30
    s_and_b32 s25, s25, 0xffff
    s_mov_b32 s27, 0x20000
    s_add_u32 s84, s83, 196608
    s_add_u32 s85, s84, 196608
    s_add_u32 s86, s85, 196608
    s_add_u32 s87, s86, 196608
    s_add_u32 s88, s87, 196608
    s_add_u32 s89, s88, 196608
    v_mov_b32 v0, v24
    s_mul_i32 s77, s72, 6656
    v_add_u32 v25, 0, v0
    v_mul_u32_u24 v26, 171, v25
    v_lshrrev_b32 v26, 12, v26
    v_mul_u32_u24 v27, 24, v26
    v_sub_u32 v27, v25, v27
    v_lshlrev_b32 v27, 4, v27
    v_mul_u32_u24 v25, 416, v26
    v_add3_u32 v2, v25, v27, s77
    v_mul_u32_u24 v25, 12288, v26
    v_add_u32 v40, v25, v27
    v_add_u32 v25, 64, v0
    v_mul_u32_u24 v26, 171, v25
    v_lshrrev_b32 v26, 12, v26
    v_mul_u32_u24 v27, 24, v26
    v_sub_u32 v27, v25, v27
    v_lshlrev_b32 v27, 4, v27
    v_mul_u32_u24 v25, 416, v26
    v_add3_u32 v3, v25, v27, s77
    v_mul_u32_u24 v25, 12288, v26
    v_add_u32 v41, v25, v27
    v_add_u32 v25, 128, v0
    v_mul_u32_u24 v26, 171, v25
    v_lshrrev_b32 v26, 12, v26
    v_mul_u32_u24 v27, 24, v26
    v_sub_u32 v27, v25, v27
    v_lshlrev_b32 v27, 4, v27
    v_mul_u32_u24 v25, 416, v26
    v_add3_u32 v4, v25, v27, s77
    v_mul_u32_u24 v25, 12288, v26
    v_add_u32 v42, v25, v27
    v_and_b32 v25, 15, v0
    v_lshrrev_b32 v26, 4, v0
    v_bfe_u32 v27, v0, 2, 2
    v_and_b32 v28, 3, v0
    s_mul_i32 s78, s71, 160
    v_lshlrev_b32 v36, 4, v26
    v_lshlrev_b32 v37, 3, v26
    v_lshlrev_b32 v39, 2, v0
    buffer_load_dwordx4 v[70:73], v36, s[36:39], s78 offen
    buffer_load_dwordx4 v[74:77], v36, s[36:39], s78 offen offset:64
    buffer_load_dwordx2 v[78:79], v37, s[36:39], s78 offen offset:128
    buffer_load_dwordx4 v[80:83], v1, s[36:39], 0 offen
    buffer_load_dword v84, v39, s[36:39], 0 offen offset:1024
    s_lshl_b32 s7, s69, 6
    v_lshlrev_b32 v38, 2, v25
    buffer_load_dword v22, v38, s[36:39], s7 offen
    s_mul_i32 s78, s71, 983040
    s_add_u32 s79, s79, s78
    s_mul_i32 s78, s72, 98304
    s_add_u32 s79, s79, s78
    s_mul_i32 s78, s72, 3072
    s_add_u32 s78, s78, 26624
    s_add_u32 m0, s78, 0
    s_nop 0
    buffer_load_dwordx4 v40, s[20:23], s79 offen nt lds
    s_add_u32 m0, s78, 1024
    s_nop 0
    buffer_load_dwordx4 v41, s[20:23], s79 offen nt lds
    s_add_u32 m0, s78, 2048
    s_nop 0
    buffer_load_dwordx4 v42, s[20:23], s79 offen nt lds
    s_add_u32 s79, s79, 393216
    s_add_u32 m0, s78, 12288
    s_nop 0
    buffer_load_dwordx4 v40, s[20:23], s79 offen nt lds
    s_add_u32 m0, s78, 13312
    s_nop 0
    buffer_load_dwordx4 v41, s[20:23], s79 offen nt lds
    s_add_u32 m0, s78, 14336
    s_nop 0
    buffer_load_dwordx4 v42, s[20:23], s79 offen nt lds
    s_add_u32 s79, s79, 393216
    s_cmp_ge_u32 s72, 2
    s_cbranch_scc1 NOWQ3
    s_add_u32 m0, s78, 24576
    s_nop 0
    buffer_load_dwordx4 v40, s[20:23], s79 offen nt lds
    s_add_u32 m0, s78, 25600
    s_nop 0
    buffer_load_dwordx4 v41, s[20:23], s79 offen nt lds
    s_add_u32 m0, s78, 26624
    s_nop 0
    buffer_load_dwordx4 v42, s[20:23], s79 offen nt lds
NOWQ3:
    s_mul_i32 s78, s71, 160
    s_mov_b32 s20, s52
    s_and_b32 s21, s53, 0xffff
    s_mov_b32 s22, 7864320
    s_mov_b32 s23, 0x20000
    s_cmp_lt_u32 s72, 2
    s_cselect_b32 s36, s56, s58
    s_cselect_b32 s37, s57, s59
    s_and_b32 s37, s37, 0xffff
    s_mov_b32 s38, 1966080
    buffer_load_dwordx4 a[8:11], v1, s[8:11], s73 offen offset:2048 nt
    buffer_load_dwordx4 a[12:15], v1, s[8:11], s73 offen offset:3072 nt
    buffer_load_dwordx4 a[16:19], v23, s[8:11], s73 offen offset:0 nt
    v_mul_u32_u24 v29, 416, v25
    v_lshl_add_u32 v29, v26, 4, v29
    v_add_u32 v5, s77, v29
    v_lshrrev_b32 v29, 2, v0
    v_mul_u32_u24 v29, 416, v29
    v_lshl_add_u32 v29, v28, 3, v29
    v_add_u32 v6, s77, v29
    s_mul_i32 s79, s72, 96
    s_add_u32 s79, s79, 26624
    v_lshl_add_u32 v29, v26, 3, v27
    v_mul_u32_u24 v29, 384, v29
    v_lshl_add_u32 v29, v28, 3, v29
    v_add_u32 v16, s79, v29
    v_lshl_add_u32 v29, v26, 2, v27
    v_mul_u32_u24 v29, 384, v29
    v_lshl_add_u32 v29, v28, 3, v29
    v_add_u32 v17, s79, v29
    buffer_load_dwordx4 a[20:23], v23, s[8:11], s73 offen offset:1024 nt
    s_mul_i32 s79, s72, 23
    v_min_u32 v32, 22, v0
    v_add_u32 v32, s79, v32
    v_min_u32 v32, 89, v32
    v_mul_u32_u24 v31, 103, v32
    v_lshrrev_b32 v31, 10, v31
    v_mul_u32_u24 v30, 10, v31
    v_sub_u32 v30, v32, v30
    v_lshl_add_u32 v29, v30, 4, s78
    s_mul_i32 s7, s68, 10240
    s_add_u32 s7, s7, 737280
    v_mul_u32_u24 v8, 1280, v31
    v_add_u32 v8, s7, v8
    s_mul_i32 s7, s68, 81920
    s_add_u32 s7, s7, 46592
    v_mov_b32 v30, s7
    v_cmp_eq_u32 vcc, s68, v31
    s_nop 1
    v_cndmask_b32 v8, v8, v30, vcc
    v_add_u32 v30, 2560, v30
    v_cmp_le_u32 vcc, 8, v31
    s_nop 1
    v_cndmask_b32 v8, v8, v30, vcc
    v_add_u32 v8, v8, v29
    v_add_u32 v33, v31, v32
    v_lshlrev_b32 v33, 4, v33
    v_add_u32 v33, 4096, v33
    v_add_u32 v31, 6, v31
    s_mul_i32 s7, s68, 10240
    s_add_u32 s7, s7, 737280
    v_mul_u32_u24 v9, 1280, v31
    v_add_u32 v9, s7, v9
    s_mul_i32 s7, s68, 81920
    s_add_u32 s7, s7, 46592
    v_mov_b32 v30, s7
    v_cmp_eq_u32 vcc, s68, v31
    s_nop 1
    v_cndmask_b32 v9, v9, v30, vcc
    v_add_u32 v30, 2560, v30
    v_cmp_le_u32 vcc, 8, v31
    s_nop 1
    v_cndmask_b32 v9, v9, v30, vcc
    v_add_u32 v9, v9, v29
    v_mov_b32 v30, 2147483632
    v_cmp_le_u32 vcc, 30, v0
    s_nop 1
    v_cndmask_b32 v9, v9, v30, vcc
    v_mov_b32 v9, v33
    s_lshl_b32 s78, s69, 10
    s_lshl_b32 s79, s72, 8
    s_add_u32 s78, s78, s79
    v_lshl_add_u32 v10, v0, 2, s78
    s_lshl_b32 s78, s70, 13
    s_add_u32 s78, s78, s79
    v_lshlrev_b32 v29, 10, v26
    v_lshl_add_u32 v29, v25, 4, v29
    v_add_u32 v11, s78, v29
    buffer_load_dwordx4 a[24:27], v1, s[8:11], s83 offen offset:0 nt
    s_mul_i32 s78, s72, 96
    s_add_u32 s78, s78, 118784
    v_lshl_add_u32 v29, v27, 5, s78
    v_lshl_add_u32 v29, v28, 2, v29
    v_lshrrev_b32 v30, 1, v26
    v_lshl_add_u32 v29, v30, 4, v29
    v_and_b32 v30, 1, v26
    v_lshl_add_u32 v29, v30, 1, v29
    v_mov_b32 v30, 119168
    v_cmp_le_u32 vcc, 12, v25
    s_nop 1
    v_cndmask_b32 v12, v29, v30, vcc
    v_and_b32 v30, 1, v0
    v_lshlrev_b32 v29, 5, v26
    v_lshl_add_u32 v29, v30, 4, v29
    v_add_u32 v13, 118784, v29
    v_mul_u32_u24 v30, 0xaaaa, v30
    v_and_b32 v29, 1, v27
    v_mul_u32_u24 v29, 0xaaaa, v29
    v_lshl_or_b32 v29, v29, 16, v30
    v_add_u32 v14, 0x44444444, v29
    buffer_load_dwordx4 a[28:31], v1, s[8:11], s83 offen offset:1024 nt
    s_lshl_b32 s78, s72, 8
    s_add_u32 s78, s78, 124416
    v_lshrrev_b32 v29, 5, v0
    v_lshl_add_u32 v29, v29, 6, s78
    v_bfe_u32 v30, v0, 3, 1
    v_lshl_add_u32 v29, v30, 5, v29
    v_bfe_u32 v30, v0, 1, 1
    v_lshl_add_u32 v29, v30, 4, v29
    v_bfe_u32 v30, v0, 2, 1
    v_lshl_add_u32 v29, v30, 3, v29
    v_bfe_u32 v30, v0, 4, 1
    v_lshl_add_u32 v29, v30, 2, v29
    v_bfe_u32 v30, v0, 0, 1
    v_lshl_add_u32 v29, v30, 1, v29
    v_mov_b32 v19, v29
    v_bfe_u32 v29, v0, 4, 1
    v_bfe_u32 v30, v0, 2, 1
    v_lshl_add_u32 v29, v29, 5, s78
    v_lshl_add_u32 v29, v30, 4, v29
    v_accvgpr_write_b32 a252, v29
    s_mul_i32 s78, s72, 768
    s_add_u32 s78, s78, 119296
    v_lshl_add_u32 v29, v25, 2, s78
    v_bfe_u32 v30, v0, 4, 1
    v_lshl_add_u32 v29, v30, 7, v29
    v_lshrrev_b32 v30, 5, v0
    v_lshl_add_u32 v15, v30, 6, v29
    s_waitcnt vmcnt(12)
    v_lshlrev_b32 v88, 16, v80
    v_and_b32 v89, 0xffff0000, v80
    v_lshlrev_b32 v90, 16, v81
    v_and_b32 v91, 0xffff0000, v81
    v_lshlrev_b32 v92, 16, v82
    v_and_b32 v93, 0xffff0000, v82
    v_lshlrev_b32 v94, 16, v83
    v_and_b32 v95, 0xffff0000, v83
    v_lshlrev_b32 v96, 16, v84
    v_and_b32 v97, 0xffff0000, v84
    v_add_f32 v80, v88, v89
    v_add_f32 v80, v80, v90
    v_add_f32 v80, v80, v91
    v_add_f32 v80, v80, v92
    v_add_f32 v80, v80, v93
    v_add_f32 v80, v80, v94
    v_add_f32 v80, v80, v95
    v_add_f32 v80, v80, v96
    v_add_f32 v80, v80, v97
    s_nop 1
    v_add_f32_dpp v80, v80, v80 row_ror:8 row_mask:0xf bank_mask:0xf
    s_nop 1
    v_add_f32_dpp v80, v80, v80 row_ror:4 row_mask:0xf bank_mask:0xf
    s_nop 1
    v_add_f32_dpp v80, v80, v80 row_ror:2 row_mask:0xf bank_mask:0xf
    s_nop 1
    v_add_f32_dpp v80, v80, v80 row_ror:1 row_mask:0xf bank_mask:0xf
    v_mov_b32 v81, v80
    s_nop 1
    v_permlane32_swap_b32 v80, v81
    v_add_f32 v80, v80, v81
    v_mov_b32 v81, v80
    s_nop 1
    v_permlane16_swap_b32 v80, v81
    v_add_f32 v80, v80, v81
    v_mul_f32 v80, 0x3acccccd, v80
    v_sub_f32 v88, v88, v80
    v_sub_f32 v89, v89, v80
    v_sub_f32 v90, v90, v80
    v_sub_f32 v91, v91, v80
    v_sub_f32 v92, v92, v80
    v_sub_f32 v93, v93, v80
    v_sub_f32 v94, v94, v80
    v_sub_f32 v95, v95, v80
    v_sub_f32 v96, v96, v80
    v_sub_f32 v97, v97, v80
    v_mul_f32 v82, v88, v88
    v_fmac_f32 v82, v89, v89
    v_fmac_f32 v82, v90, v90
    v_fmac_f32 v82, v91, v91
    v_fmac_f32 v82, v92, v92
    v_fmac_f32 v82, v93, v93
    v_fmac_f32 v82, v94, v94
    v_fmac_f32 v82, v95, v95
    v_fmac_f32 v82, v96, v96
    v_fmac_f32 v82, v97, v97
    buffer_load_dwordx4 a[32:35], v1, s[8:11], s83 offen offset:2048 nt
    s_nop 0
    v_add_f32_dpp v82, v82, v82 row_ror:8 row_mask:0xf bank_mask:0xf
    s_nop 1
    v_add_f32_dpp v82, v82, v82 row_ror:4 row_mask:0xf bank_mask:0xf
    s_nop 1
    v_add_f32_dpp v82, v82, v82 row_ror:2 row_mask:0xf bank_mask:0xf
    s_nop 1
    v_add_f32_dpp v82, v82, v82 row_ror:1 row_mask:0xf bank_mask:0xf
    v_mov_b32 v81, v82
    s_nop 1
    v_permlane32_swap_b32 v82, v81
    v_add_f32 v82, v82, v81
    v_mov_b32 v81, v82
    s_nop 1
    v_permlane16_swap_b32 v82, v81
    v_add_f32 v82, v82, v81
    v_mul_f32 v82, 0x3acccccd, v82
    v_add_f32 v82, 0x3727c5ac, v82
    v_rsq_f32 v82, v82
    s_mov_b32 vcc_lo, 0xaaaaaaaa
    s_mov_b32 vcc_hi, 0xaaaaaaaa
    v_mov_b32 v85, 0x3f803f80
    v_lshlrev_b32 v83, 16, v70
    v_and_b32 v84, 0xffff0000, v70
    v_sub_f32 v83, v83, v80
    v_sub_f32 v84, v84, v80
    v_mul_f32 v83, v83, v82
    v_mul_f32 v84, v84, v82
    v_cvt_pk_bf16_f32 v83, v83, v84
    v_cndmask_b32 v70, v83, v85, vcc
    v_lshlrev_b32 v83, 16, v71
    v_and_b32 v84, 0xffff0000, v71
    v_sub_f32 v83, v83, v80
    v_sub_f32 v84, v84, v80
    v_mul_f32 v83, v83, v82
    v_mul_f32 v84, v84, v82
    v_cvt_pk_bf16_f32 v83, v83, v84
    v_cndmask_b32 v71, v83, v85, vcc
    v_lshlrev_b32 v83, 16, v72
    v_and_b32 v84, 0xffff0000, v72
    v_sub_f32 v83, v83, v80
    v_sub_f32 v84, v84, v80
    v_mul_f32 v83, v83, v82
    v_mul_f32 v84, v84, v82
    v_cvt_pk_bf16_f32 v83, v83, v84
    v_cndmask_b32 v72, v83, v85, vcc
    v_lshlrev_b32 v83, 16, v73
    v_and_b32 v84, 0xffff0000, v73
    v_sub_f32 v83, v83, v80
    v_sub_f32 v84, v84, v80
    v_mul_f32 v83, v83, v82
    v_mul_f32 v84, v84, v82
    v_cvt_pk_bf16_f32 v83, v83, v84
    v_cndmask_b32 v73, v83, v85, vcc
    v_lshlrev_b32 v83, 16, v74
    v_and_b32 v84, 0xffff0000, v74
    v_sub_f32 v83, v83, v80
    v_sub_f32 v84, v84, v80
    v_mul_f32 v83, v83, v82
    v_mul_f32 v84, v84, v82
    v_cvt_pk_bf16_f32 v83, v83, v84
    v_cndmask_b32 v74, v83, v85, vcc
    v_lshlrev_b32 v83, 16, v75
    v_and_b32 v84, 0xffff0000, v75
    v_sub_f32 v83, v83, v80
    v_sub_f32 v84, v84, v80
    v_mul_f32 v83, v83, v82
    v_mul_f32 v84, v84, v82
    v_cvt_pk_bf16_f32 v83, v83, v84
    v_cndmask_b32 v75, v83, v85, vcc
    buffer_load_dwordx4 a[36:39], v1, s[8:11], s83 offen offset:3072 nt
    v_lshlrev_b32 v83, 16, v76
    v_and_b32 v84, 0xffff0000, v76
    v_sub_f32 v83, v83, v80
    v_sub_f32 v84, v84, v80
    v_mul_f32 v83, v83, v82
    v_mul_f32 v84, v84, v82
    v_cvt_pk_bf16_f32 v83, v83, v84
    v_cndmask_b32 v76, v83, v85, vcc
    v_lshlrev_b32 v83, 16, v77
    v_and_b32 v84, 0xffff0000, v77
    v_sub_f32 v83, v83, v80
    v_sub_f32 v84, v84, v80
    v_mul_f32 v83, v83, v82
    v_mul_f32 v84, v84, v82
    v_cvt_pk_bf16_f32 v83, v83, v84
    v_cndmask_b32 v77, v83, v85, vcc
    v_lshlrev_b32 v83, 16, v78
    v_and_b32 v84, 0xffff0000, v78
    v_sub_f32 v83, v83, v80
    v_sub_f32 v84, v84, v80
    v_mul_f32 v83, v83, v82
    v_mul_f32 v84, v84, v82
    v_cvt_pk_bf16_f32 v83, v83, v84
    v_cndmask_b32 v78, v83, v85, vcc
    v_lshlrev_b32 v83, 16, v79
    v_and_b32 v84, 0xffff0000, v79
    v_sub_f32 v83, v83, v80
    v_sub_f32 v84, v84, v80
    v_mul_f32 v83, v83, v82
    v_mul_f32 v84, v84, v82
    v_cvt_pk_bf16_f32 v83, v83, v84
    v_cndmask_b32 v79, v83, v85, vcc
    s_waitcnt vmcnt(8)
    s_barrier
    ds_read_b64_tr_b16 v[40:41], v16 offset:0
    ds_read_b64_tr_b16 v[42:43], v16 offset:1536
    ds_read_b64_tr_b16 v[44:45], v16 offset:12288
    ds_read_b64_tr_b16 v[46:47], v16 offset:13824
    ds_read_b64_tr_b16 v[48:49], v17 offset:24576
    ds_read_b64_tr_b16 v[50:51], v16 offset:32
    ds_read_b64_tr_b16 v[52:53], v16 offset:1568
    ds_read_b64_tr_b16 v[54:55], v16 offset:12320
    ds_read_b64_tr_b16 v[56:57], v16 offset:13856
    ds_read_b64_tr_b16 v[58:59], v17 offset:24608
    ds_read_b64_tr_b16 v[60:61], v16 offset:64
    ds_read_b64_tr_b16 v[62:63], v16 offset:1600
    ds_read_b64_tr_b16 v[64:65], v16 offset:12352
    ds_read_b64_tr_b16 v[66:67], v16 offset:13888
    ds_read_b64_tr_b16 v[68:69], v17 offset:24640
    v_mov_b32 v100, 0
    s_cmp_lg_u32 s72, 0
    s_cbranch_scc1 NOTL
    s_mov_b64 exec, 1
    global_load_dword v98, v100, s[64:65] sc1
    s_mov_b64 exec, -1
NOTL:
    buffer_load_dwordx4 a[40:43], v23, s[8:11], s83 offen offset:0 nt
    buffer_load_dwordx4 a[44:47], v23, s[8:11], s83 offen offset:1024 nt
    s_mul_i32 s79, s72, 96
    s_add_u32 s79, s79, 119296
    v_min_u32 v36, 48, v0
    v_lshl_add_u32 v36, v36, 1, s79
    v_mov_b32 v37, 119808
    v_cmp_le_u32 vcc, 48, v0
    s_nop 1
    v_cndmask_b32 v36, v36, v37, vcc
    v_add_u32 v37, 119296, v1
    s_waitcnt lgkmcnt(0)
    v_mfma_f32_16x16x32_bf16 v[24:27], v[70:73], v[40:43], 0
    v_mfma_f32_16x16x32_bf16 v[28:31], v[70:73], v[50:53], 0
    v_mfma_f32_16x16x32_bf16 v[32:35], v[70:73], v[60:63], 0
    v_mfma_f32_16x16x32_bf16 v[24:27], v[74:77], v[44:47], v[24:27]
    v_mfma_f32_16x16x32_bf16 v[28:31], v[74:77], v[54:57], v[28:31]
    v_mfma_f32_16x16x32_bf16 v[32:35], v[74:77], v[64:67], v[32:35]
    v_mfma_f32_16x16x16_bf16 v[24:27], v[78:79], v[48:49], v[24:27]
    v_mfma_f32_16x16x16_bf16 v[28:31], v[78:79], v[58:59], v[28:31]
    v_mfma_f32_16x16x16_bf16 v[32:35], v[78:79], v[68:69], v[32:35]
    buffer_load_dwordx4 a[48:51], v1, s[8:11], s84 offen offset:0 nt
    s_nop 4
    v_mov_b32 v7, v25
    v_mov_b32_dpp v24, v28 quad_perm:[0,1,2,3] row_mask:0x2 bank_mask:0xf
    s_nop 0
    v_mov_b32_dpp v7, v29 quad_perm:[0,1,2,3] row_mask:0x2 bank_mask:0xf
    v_mov_b32_dpp v24, v32 quad_perm:[0,1,2,3] row_mask:0x4 bank_mask:0xf
    s_nop 0
    v_mov_b32_dpp v7, v33 quad_perm:[0,1,2,3] row_mask:0x4 bank_mask:0xf
    v_cvt_pk_bf16_f32 v24, v24, v24
    ds_write_b16 v36, v24
    buffer_load_dwordx4 a[52:55], v1, s[8:11], s84 offen offset:1024 nt
    buffer_load_dwordx4 a[56:59], v1, s[8:11], s84 offen offset:2048 nt
    s_waitcnt lgkmcnt(0)
    s_barrier
    ds_read_b128 v[28:31], v37
    s_lshl_b32 s79, s69, 9
    s_add_u32 s79, s79, s3
    s_cmp_eq_u32 s72, 0
    s_cselect_b32 exec_lo, 0xffffff, 1
    s_mov_b32 exec_hi, 0
    s_cselect_b32 s78, 0, 1879048176
    v_add_u32 v37, s78, v1
    s_waitcnt lgkmcnt(0)
    buffer_store_dwordx4 v[28:31], v37, s[16:19], s79 offen sc1
    s_mov_b64 exec, -1
    v_mov_b32 v32, -1
    v_mov_b32 v33, -1
    v_mov_b32 v34, -1
    v_mov_b32 v35, -1
    buffer_store_dwordx4 v[32:35], v21, s[16:19], 0 offen sc1
    buffer_load_dwordx4 a[60:63], v1, s[8:11], s84 offen offset:3072 nt
    s_waitcnt vmcnt(12)
    ds_write_b128 v2, a[0:3] offset:0
    ds_write_b128 v3, a[4:7] offset:0
    ds_write_b128 v4, a[8:11] offset:0
    ds_write_b128 v2, a[12:15] offset:3328
    ds_write_b128 v3, a[16:19] offset:3328
    ds_write_b128 v4, a[20:23] offset:3328
    ds_read_b128 a[0:3], v5 offset:0
    ds_read_b128 a[4:7], v5 offset:64
    ds_read_b128 a[8:11], v5 offset:128
    ds_read_b128 a[12:15], v5 offset:192
    ds_read_b128 a[16:19], v5 offset:256
    ds_read_b128 a[20:23], v5 offset:320
    buffer_load_dwordx4 a[64:67], v23, s[8:11], s84 offen offset:0 nt
    buffer_load_dwordx4 a[68:71], v23, s[8:11], s84 offen offset:1024 nt
    s_barrier
    buffer_load_dwordx4 a[72:75], v1, s[8:11], s85 offen offset:0 nt
    buffer_load_dwordx4 a[76:79], v1, s[8:11], s85 offen offset:1024 nt
    buffer_load_dwordx4 a[80:83], v1, s[8:11], s85 offen offset:2048 nt
    buffer_load_dwordx4 a[84:87], v1, s[8:11], s85 offen offset:3072 nt
    buffer_load_dwordx4 a[88:91], v23, s[8:11], s85 offen offset:0 nt
    buffer_load_dwordx4 a[92:95], v23, s[8:11], s85 offen offset:1024 nt
    s_barrier
    s_getreg_b32 s5, hwreg(HW_REG_XCC_ID, 0, 4)
    s_cmp_lg_u32 s72, 0
    s_cbranch_scc1 NOHDR
    s_waitcnt vmcnt(9)
    v_readfirstlane_b32 s96, v98
    s_nop 0
    s_cmp_eq_u32 s96, 0
    s_cbranch_scc1 TAGLOOP
TAGOK:
    v_mov_b32 v99, s5
    s_mov_b64 exec, 1
    buffer_store_dwordx2 v[98:99], v1, s[16:19], s79 offen offset:384 sc1
    s_mov_b64 exec, -1
NOHDR:
    s_waitcnt vmcnt(14)
    ds_write_b128 v2, a[24:27] offset:0
    ds_write_b128 v3, a[28:31] offset:0
    ds_write_b128 v4, a[32:35] offset:0
    ds_write_b128 v2, a[36:39] offset:3328
    ds_write_b128 v3, a[40:43] offset:3328
    ds_write_b128 v4, a[44:47] offset:3328
    ds_read_b128 a[24:27], v5 offset:0
    ds_read_b128 a[28:31], v5 offset:64
    ds_read_b128 a[32:35], v5 offset:128
    ds_read_b128 a[36:39], v5 offset:192
    ds_read_b128 a[40:43], v5 offset:256
    ds_read_b128 a[44:47], v5 offset:320
    buffer_load_dwordx4 a[96:99], v1, s[8:11], s86 offen offset:0 nt
    buffer_load_dwordx4 a[100:103], v1, s[8:11], s86 offen offset:1024 nt
    buffer_load_dwordx4 a[104:107], v1, s[8:11], s86 offen offset:2048 nt
    buffer_load_dwordx4 a[108:111], v1, s[8:11], s86 offen offset:3072 nt
    buffer_load_dwordx4 a[112:115], v23, s[8:11], s86 offen offset:0 nt
    buffer_load_dwordx4 a[116:119], v23, s[8:11], s86 offen offset:1024 nt
    s_barrier
    s_waitcnt vmcnt(12)
    ds_write_b128 v2, a[48:51] offset:0
    ds_write_b128 v3, a[52:55] offset:0
    ds_write_b128 v4, a[56:59] offset:0
    ds_write_b128 v2, a[60:63] offset:3328
    ds_write_b128 v3, a[64:67] offset:3328
    ds_write_b128 v4, a[68:71] offset:3328
    ds_read_b128 a[48:51], v5 offset:0
    ds_read_b128 a[52:55], v5 offset:64
    ds_read_b128 a[56:59], v5 offset:128
    ds_read_b128 a[60:63], v5 offset:192
    ds_read_b128 a[64:67], v5 offset:256
    ds_read_b128 a[68:71], v5 offset:320
    v_lshlrev_b32 v100, 9, v0
    v_add_u32 v100, s3, v100
    v_bfe_u32 v96, v0, 2, 3
    v_mul_u32_u24 v96, 81920, v96
    v_and_b32 v97, 3, v0
    v_lshl_add_u32 v96, v97, 9, v96
    v_cmp_le_u32 vcc, 32, v0
    s_nop 1
    v_cndmask_b32 v100, v100, v96, vcc
    s_cmp_eq_u32 s72, 0
    s_cselect_b32 s77, 0, 1879048176
    v_add_u32 v100, s77, v100
    buffer_load_dwordx4 a[120:123], v1, s[8:11], s87 offen offset:0 nt
    buffer_load_dwordx4 a[124:127], v1, s[8:11], s87 offen offset:1024 nt
    buffer_load_dwordx4 a[128:131], v1, s[8:11], s87 offen offset:2048 nt
    buffer_load_dwordx4 a[132:135], v1, s[8:11], s87 offen offset:3072 nt
    buffer_load_dwordx4 a[136:139], v23, s[8:11], s87 offen offset:0 nt
    buffer_load_dwordx4 a[140:143], v23, s[8:11], s87 offen offset:1024 nt
    s_barrier
    s_waitcnt vmcnt(12)
    ds_write_b128 v2, a[72:75] offset:0
    ds_write_b128 v3, a[76:79] offset:0
    ds_write_b128 v4, a[80:83] offset:0
    ds_write_b128 v2, a[84:87] offset:3328
    ds_write_b128 v3, a[88:91] offset:3328
    ds_write_b128 v4, a[92:95] offset:3328
    ds_read_b128 a[72:75], v5 offset:0
    ds_read_b128 a[76:79], v5 offset:64
    ds_read_b128 a[80:83], v5 offset:128
    ds_read_b128 a[84:87], v5 offset:192
    ds_read_b128 a[88:91], v5 offset:256
    ds_read_b128 a[92:95], v5 offset:320
    buffer_load_dwordx4 a[144:147], v1, s[8:11], s88 offen offset:0 nt
    buffer_load_dwordx4 a[148:151], v1, s[8:11], s88 offen offset:1024 nt
    buffer_load_dwordx4 a[152:155], v1, s[8:11], s88 offen offset:2048 nt
    buffer_load_dwordx4 a[156:159], v1, s[8:11], s88 offen offset:3072 nt
    buffer_load_dwordx4 a[160:163], v23, s[8:11], s88 offen offset:0 nt
    buffer_load_dwordx4 a[164:167], v23, s[8:11], s88 offen offset:1024 nt
    s_barrier
    s_waitcnt vmcnt(12)
    ds_write_b128 v2, a[96:99] offset:0
    ds_write_b128 v3, a[100:103] offset:0
    ds_write_b128 v4, a[104:107] offset:0
    ds_write_b128 v2, a[108:111] offset:3328
    ds_write_b128 v3, a[112:115] offset:3328
    ds_write_b128 v4, a[116:119] offset:3328
    ds_read_b128 a[96:99], v5 offset:0
    ds_read_b128 a[100:103], v5 offset:64
    ds_read_b128 a[104:107], v5 offset:128
    ds_read_b128 a[108:111], v5 offset:192
    ds_read_b128 a[112:115], v5 offset:256
    ds_read_b128 a[116:119], v5 offset:320
    buffer_load_dwordx4 a[168:171], v1, s[8:11], s89 offen offset:0 nt
    buffer_load_dwordx4 a[172:175], v1, s[8:11], s89 offen offset:1024 nt
    buffer_load_dwordx4 a[176:179], v1, s[8:11], s89 offen offset:2048 nt
    buffer_load_dwordx4 a[180:183], v1, s[8:11], s89 offen offset:3072 nt
    buffer_load_dwordx4 a[184:187], v23, s[8:11], s89 offen offset:0 nt
    buffer_load_dwordx4 a[188:191], v23, s[8:11], s89 offen offset:1024 nt
    s_barrier
    s_cmp_ge_u32 s69, 20
    s_cbranch_scc1 DMAF
    s_lshl_b32 s66, s72, 3
    s_add_u32 s66, s66, s68
    s_mul_i32 s66, s66, 245760
    s_lshl_b32 s78, s69, 6
    s_add_u32 s66, s66, s78
    s_mul_i32 s67, s72, 12288
    s_add_u32 s67, s67, 57344
DMAX:
    v_mov_b32 v109, v20
    v_and_b32 v25, 15, v0
    v_lshrrev_b32 v26, 4, v0
    v_add_u32 v27, 4, v26
    s_mul_i32 s7, s68, 10240
    s_add_u32 s7, s7, 737280
    v_mul_u32_u24 v20, 1280, v26
    v_add_u32 v20, s7, v20
    s_mul_i32 s7, s68, 81920
    s_add_u32 s7, s7, 46592
    v_mov_b32 v28, s7
    v_cmp_eq_u32 vcc, s68, v26
    s_nop 1
    v_cndmask_b32 v20, v20, v28, vcc
    s_mul_i32 s7, s68, 10240
    s_add_u32 s7, s7, 737280
    v_mul_u32_u24 v21, 1280, v27
    v_add_u32 v21, s7, v21
    s_mul_i32 s7, s68, 81920
    s_add_u32 s7, s7, 46592
    v_mov_b32 v28, s7
    v_cmp_eq_u32 vcc, s68, v27
    s_nop 1
    v_cndmask_b32 v21, v21, v28, vcc
    s_min_u32 s7, s69, 19
    s_lshl_b32 s7, s7, 6
    v_lshl_add_u32 v25, v25, 2, s7
    v_add_u32 v20, v20, v25
    v_add_u32 v21, v21, v25
    buffer_load_dwordx4 a[216:219], v1, s[12:15], s73 offen offset:0 nt
    v_and_b32 v25, 15, v0
    v_bfe_u32 v27, v0, 2, 2
    v_and_b32 v28, 3, v0
    s_mul_i32 s7, s72, 12288
    s_add_u32 s7, s7, 57344
    v_lshl_add_u32 v29, v26, 3, v27
    v_lshlrev_b32 v29, 6, v29
    v_lshl_add_u32 v29, v28, 3, v29
    v_add_u32 v29, s7, v29
    v_accvgpr_write_b32 a246, v29
    s_mul_i32 s7, s72, 3072
    s_add_u32 s7, s7, 32768
    v_add_u32 v29, s7, v1
    v_accvgpr_write_b32 a247, v29
    s_lshl_b32 s7, s72, 6
    s_add_u32 s7, s7, 45056
    v_xor_b32 v29, v26, v27
    v_and_b32 v29, 1, v29
    v_lshl_add_u32 v29, v29, 2, v28
    v_lshl_add_u32 v29, v29, 3, s7
    v_accvgpr_write_b32 a248, v29
    s_lshl_b32 s7, s72, 8
    s_add_u32 s7, s7, 122368
    v_lshl_add_u32 v29, v0, 2, s7
    v_accvgpr_write_b32 a249, v29
    s_lshl_b32 s81, s69, 6
    s_mul_i32 s80, s68, 1280
    s_add_u32 s80, s80, s81
    s_add_u32 s80, s80, 655360
    s_add_u32 s81, s81, s3
    s_add_u32 s81, s81, 45312
    s_waitcnt vmcnt(13)
    ds_write_b128 v2, a[120:123] offset:0
    ds_write_b128 v3, a[124:127] offset:0
    ds_write_b128 v4, a[128:131] offset:0
    ds_write_b128 v2, a[132:135] offset:3328
    ds_write_b128 v3, a[136:139] offset:3328
    ds_write_b128 v4, a[140:143] offset:3328
    ds_read_b128 a[120:123], v5 offset:0
    ds_read_b128 a[124:127], v5 offset:64
    ds_read_b128 a[128:131], v5 offset:128
    ds_read_b128 a[132:135], v5 offset:192
    ds_read_b128 a[136:139], v5 offset:256
    ds_read_b128 a[140:143], v5 offset:320
    buffer_load_dwordx4 a[220:223], v1, s[12:15], s73 offen offset:1024 nt
    buffer_load_dwordx4 a[224:227], v1, s[12:15], s73 offen offset:2048 nt
    buffer_load_dwordx4 a[228:231], v1, s[12:15], s73 offen offset:3072 nt
    buffer_load_dwordx4 a[232:235], v23, s[12:15], s73 offen offset:0 nt
    buffer_load_dwordx4 a[236:239], v23, s[12:15], s73 offen offset:1024 nt
    s_barrier
    s_waitcnt vmcnt(12)
    ds_write_b128 v2, a[144:147] offset:0
    ds_write_b128 v3, a[148:151] offset:0
    ds_write_b128 v4, a[152:155] offset:0
    ds_write_b128 v2, a[156:159] offset:3328
    ds_write_b128 v3, a[160:163] offset:3328
    ds_write_b128 v4, a[164:167] offset:3328
    ds_read_b128 a[144:147], v5 offset:0
    ds_read_b128 a[148:151], v5 offset:64
    ds_read_b128 a[152:155], v5 offset:128
    ds_read_b128 a[156:159], v5 offset:192
    ds_read_b128 a[160:163], v5 offset:256
    ds_read_b128 a[164:167], v5 offset:320
    buffer_load_dwordx4 v[112:115], v1, s[12:15], s83 offen offset:0 nt
    buffer_load_dwordx4 v[116:119], v1, s[12:15], s83 offen offset:1024 nt
    buffer_load_dwordx4 v[120:123], v1, s[12:15], s83 offen offset:2048 nt
    buffer_load_dwordx4 v[124:127], v1, s[12:15], s83 offen offset:3072 nt
    buffer_load_dwordx4 v[128:131], v23, s[12:15], s83 offen offset:0 nt
    buffer_load_dwordx4 v[132:135], v23, s[12:15], s83 offen offset:1024 nt
    s_barrier
    buffer_load_dwordx2 v[98:99], v100, s[16:19], 0 offen offset:384 sc1
    s_waitcnt vmcnt(13)
    ds_write_b128 v2, a[168:171] offset:0
    ds_write_b128 v3, a[172:175] offset:0
    ds_write_b128 v4, a[176:179] offset:0
    ds_write_b128 v2, a[180:183] offset:3328
    ds_write_b128 v3, a[184:187] offset:3328
    ds_write_b128 v4, a[188:191] offset:3328
    ds_read_b128 a[168:171], v5 offset:0
    ds_read_b128 a[172:175], v5 offset:64
    ds_read_b128 a[176:179], v5 offset:128
    ds_read_b128 a[180:183], v5 offset:192
    ds_read_b128 a[184:187], v5 offset:256
    ds_read_b128 a[188:191], v5 offset:320
    buffer_load_dwordx4 v[136:139], v1, s[12:15], s84 offen offset:0 nt
    buffer_load_dwordx4 v[140:143], v1, s[12:15], s84 offen offset:1024 nt
    buffer_load_dwordx4 v[144:147], v1, s[12:15], s84 offen offset:2048 nt
    buffer_load_dwordx4 v[148:151], v1, s[12:15], s84 offen offset:3072 nt
    buffer_load_dwordx4 v[152:155], v23, s[12:15], s84 offen offset:0 nt
    buffer_load_dwordx4 v[156:159], v23, s[12:15], s84 offen offset:1024 nt
    s_barrier
    s_waitcnt vmcnt(13)
    ds_write_b128 v2, a[216:219] offset:0
    ds_write_b128 v3, a[220:223] offset:0
    ds_write_b128 v4, a[224:227] offset:0
    ds_write_b128 v2, a[228:231] offset:3328
    ds_write_b128 v3, a[232:235] offset:3328
    ds_write_b128 v4, a[236:239] offset:3328
    ds_read_b64_tr_b16 a[192:193], v6 offset:0
    ds_read_b64_tr_b16 a[196:197], v6 offset:32
    ds_read_b64_tr_b16 a[200:201], v6 offset:64
    ds_read_b64_tr_b16 a[204:205], v6 offset:96
    ds_read_b64_tr_b16 a[208:209], v6 offset:128
    ds_read_b64_tr_b16 a[212:213], v6 offset:160
    ds_read_b64_tr_b16 a[216:217], v6 offset:192
    ds_read_b64_tr_b16 a[220:221], v6 offset:224
    ds_read_b64_tr_b16 a[224:225], v6 offset:256
    ds_read_b64_tr_b16 a[228:229], v6 offset:288
    ds_read_b64_tr_b16 a[232:233], v6 offset:320
    ds_read_b64_tr_b16 a[236:237], v6 offset:352
    buffer_load_dwordx4 v[160:163], v1, s[12:15], s85 offen offset:0 nt
    buffer_load_dwordx4 v[164:167], v1, s[12:15], s85 offen offset:1024 nt
    buffer_load_dwordx4 v[168:171], v1, s[12:15], s85 offen offset:2048 nt
    buffer_load_dwordx4 v[172:175], v1, s[12:15], s85 offen offset:3072 nt
    buffer_load_dwordx4 v[176:179], v23, s[12:15], s85 offen offset:0 nt
    buffer_load_dwordx4 v[180:183], v23, s[12:15], s85 offen offset:1024 nt
    s_barrier
    s_waitcnt vmcnt(12)
    s_mov_b32 s76, -1
    v_mov_b32 v97, 125504
    s_cmp_lg_u32 s72, 0
    s_cbranch_scc1 RDYX
    v_cmp_ne_u32 vcc, s96, v98
    s_cbranch_vccnz RDYLOOP
RDYOK:
    v_cmp_ne_u32 vcc, s5, v99
    s_nop 1
    v_mov_b32 v96, vcc_lo
    ds_write_b32 v97, v96
RDYX:
    buffer_load_dwordx4 v[184:187], v1, s[12:15], s86 offen offset:0 nt
    buffer_load_dwordx4 v[188:191], v1, s[12:15], s86 offen offset:1024 nt
    s_waitcnt lgkmcnt(0)
    s_barrier
    ds_read_b32 v96, v97
    s_waitcnt lgkmcnt(0)
    v_readfirstlane_b32 s77, v96
    s_nop 0
    s_cmp_eq_u32 s77, 0
    s_cselect_b32 s10, s18, 0
    s_mov_b32 s8, s16
    s_mov_b32 s9, s17
    s_mov_b32 s11, 0x20000
    buffer_load_dwordx4 a[240:243], v109, s[16:19], 0 offen sc1
    s_mul_i32 s77, s69, 464
    s_add_u32 s77, s77, s3
    s_add_u32 s77, s77, 49152
    s_cmp_eq_u32 s72, 3
    s_cselect_b32 s77, s77, 1879048176
    v_add_u32 v106, s77, v1
    v_mov_b32 v107, 2147483632
    v_cmp_le_u32 vcc, 29, v0
    s_nop 1
    v_cndmask_b32 v106, v106, v107, vcc
    buffer_load_dwordx4 a[240:243], v106, s[16:19], 0 offen sc1
    s_lshl_b32 s77, s69, 2
    s_add_u32 s77, s77, s72
    s_lshl_b32 s78, s77, 8
    s_add_u32 s78, s78, 819200
    s_lshl_b32 s77, s77, 9
    s_sub_u32 s77, s77, 256
    v_lshlrev_b32 v24, 7, v0
    v_add_u32 v25, s77, v24
    v_min_u32 v25, 57472, v25
    v_add_u32 v24, s78, v24
    v_cmp_gt_u32 vcc, 2, v0
    s_nop 1
    v_cndmask_b32 v24, v25, v24, vcc
    s_add_u32 s77, s3, 819200
    s_mov_b64 exec, 63
    buffer_load_dword a243, v24, s[16:19], s77 offen sc1
    s_mov_b64 exec, -1
    s_lshl_b32 s77, s70, 12
    s_mul_i32 s78, s72, 96
    s_add_u32 s77, s77, s78
    s_add_u32 s77, s77, s3
    v_lshrrev_b32 v24, 4, v0
    v_lshlrev_b32 v24, 9, v24
    v_and_b32 v25, 15, v0
    v_min_u32 v25, 11, v25
    v_lshl_add_u32 v24, v25, 3, v24
    buffer_load_dwordx2 v[64:65], v24, s[16:19], s77 offen offset:0 sc1
    buffer_load_dwordx2 v[66:67], v24, s[16:19], s77 offen offset:2048 sc1
    s_cmp_lg_u32 s72, 1
    s_cbranch_scc1 NOBASE0
    s_cmp_ge_u32 s69, 20
    s_cbranch_scc1 NOBASE0
    v_mov_b32 v28, v22
    s_lshl_b32 s77, s69, 6
    s_add_u32 s77, s77, s3
    s_add_u32 s77, s77, 47872
    v_lshlrev_b32 v27, 2, v0
    v_mov_b32_dpp v29, v28 quad_perm:[1,1,1,1] row_mask:0xf bank_mask:0xf
    v_mov_b32_dpp v30, v28 quad_perm:[2,2,2,2] row_mask:0xf bank_mask:0xf
    v_mov_b32_dpp v31, v28 quad_perm:[3,3,3,3] row_mask:0xf bank_mask:0xf
    s_mov_b32 exec_lo, 0x1111
    s_mov_b32 exec_hi, 0x0
    buffer_store_dwordx4 v[28:31], v27, s[8:11], s77 offen
    s_cmp_eq_u32 s10, 0
    s_cbranch_scc1 SLOW1
BACK1:
    s_mov_b64 exec, -1
NOBASE0:
    ds_write_b128 v2, v[112:115] offset:0
    ds_write_b128 v3, v[116:119] offset:0
    ds_write_b128 v4, v[120:123] offset:0
    ds_write_b128 v2, v[124:127] offset:3328
    ds_write_b128 v3, v[128:131] offset:3328
    ds_write_b128 v4, v[132:135] offset:3328
    ds_read_b64_tr_b16 a[194:195], v6 offset:0
    ds_read_b64_tr_b16 a[198:199], v6 offset:32
    ds_read_b64_tr_b16 a[202:203], v6 offset:64
    ds_read_b64_tr_b16 a[206:207], v6 offset:96
    ds_read_b64_tr_b16 a[210:211], v6 offset:128
    ds_read_b64_tr_b16 a[214:215], v6 offset:160
    ds_read_b64_tr_b16 a[218:219], v6 offset:192
    ds_read_b64_tr_b16 a[222:223], v6 offset:224
    ds_read_b64_tr_b16 a[226:227], v6 offset:256
    ds_read_b64_tr_b16 a[230:231], v6 offset:288
    ds_read_b64_tr_b16 a[234:235], v6 offset:320
    ds_read_b64_tr_b16 a[238:239], v6 offset:352
    s_waitcnt vmcnt(13)
    ds_write_b128 v2, v[136:139] offset:0
    ds_write_b128 v3, v[140:143] offset:0
    ds_write_b128 v4, v[144:147] offset:0
    ds_write_b128 v2, v[148:151] offset:3328
    ds_write_b128 v3, v[152:155] offset:3328
    ds_write_b128 v4, v[156:159] offset:3328
    ds_read_b64_tr_b16 v[112:113], v6 offset:0
    ds_read_b64_tr_b16 v[116:117], v6 offset:32
    ds_read_b64_tr_b16 v[120:121], v6 offset:64
    ds_read_b64_tr_b16 v[124:125], v6 offset:96
    ds_read_b64_tr_b16 v[128:129], v6 offset:128
    ds_read_b64_tr_b16 v[132:133], v6 offset:160
    ds_read_b64_tr_b16 v[136:137], v6 offset:192
    ds_read_b64_tr_b16 v[140:141], v6 offset:224
    ds_read_b64_tr_b16 v[144:145], v6 offset:256
    ds_read_b64_tr_b16 v[148:149], v6 offset:288
    ds_read_b64_tr_b16 v[152:153], v6 offset:320
    ds_read_b64_tr_b16 v[156:157], v6 offset:352
    buffer_load_dwordx4 v[192:195], v1, s[12:15], s86 offen offset:2048 nt
    buffer_load_dwordx4 v[196:199], v1, s[12:15], s86 offen offset:3072 nt
    buffer_load_dwordx4 v[200:203], v23, s[12:15], s86 offen offset:0 nt
    buffer_load_dwordx4 v[204:207], v23, s[12:15], s86 offen offset:1024 nt
    s_barrier
    buffer_load_dwordx4 v[208:211], v1, s[12:15], s87 offen offset:0 nt
    s_waitcnt vmcnt(12)
    ds_write_b128 v2, v[160:163] offset:0
    ds_write_b128 v3, v[164:167] offset:0
    ds_write_b128 v4, v[168:171] offset:0
    ds_write_b128 v2, v[172:175] offset:3328
    ds_write_b128 v3, v[176:179] offset:3328
    ds_write_b128 v4, v[180:183] offset:3328
    ds_read_b64_tr_b16 v[114:115], v6 offset:0
    ds_read_b64_tr_b16 v[118:119], v6 offset:32
    ds_read_b64_tr_b16 v[122:123], v6 offset:64
    ds_read_b64_tr_b16 v[126:127], v6 offset:96
    ds_read_b64_tr_b16 v[130:131], v6 offset:128
    ds_read_b64_tr_b16 v[134:135], v6 offset:160
    ds_read_b64_tr_b16 v[138:139], v6 offset:192
    ds_read_b64_tr_b16 v[142:143], v6 offset:224
    ds_read_b64_tr_b16 v[146:147], v6 offset:256
    ds_read_b64_tr_b16 v[150:151], v6 offset:288
    ds_read_b64_tr_b16 v[154:155], v6 offset:320
    ds_read_b64_tr_b16 v[158:159], v6 offset:352
    buffer_load_dwordx4 v[212:215], v1, s[12:15], s87 offen offset:1024 nt
    buffer_load_dwordx4 v[216:219], v1, s[12:15], s87 offen offset:2048 nt
    buffer_load_dwordx4 v[220:223], v1, s[12:15], s87 offen offset:3072 nt
    buffer_load_dwordx4 v[224:227], v23, s[12:15], s87 offen offset:0 nt
    buffer_load_dwordx4 v[228:231], v23, s[12:15], s87 offen offset:1024 nt
    s_barrier
    buffer_load_dwordx4 v[232:235], v1, s[12:15], s88 offen offset:0 nt
    buffer_load_dwordx4 v[236:239], v1, s[12:15], s88 offen offset:1024 nt
    s_waitcnt vmcnt(12)
    v_lshlrev_b32 v24, 16, v64
    v_and_b32 v25, 0xffff0000, v64
    v_lshlrev_b32 v26, 16, v65
    v_and_b32 v27, 0xffff0000, v65
    v_lshlrev_b32 v28, 16, v66
    v_and_b32 v29, 0xffff0000, v66
    v_lshlrev_b32 v30, 16, v67
    v_and_b32 v31, 0xffff0000, v67
    v_add_f32 v24, v24, v28
    v_add_f32 v25, v25, v29
    v_add_f32 v26, v26, v30
    v_add_f32 v27, v27, v31
    s_nop 0
    v_permlane32_swap_b32 v24, v26
    v_permlane32_swap_b32 v25, v27
    v_add_f32 v24, v24, v26
    v_add_f32 v25, v25, v27
    s_nop 1
    v_permlane16_swap_b32 v24, v25
    v_add_f32 v24, v24, v25
    v_cvt_pk_bf16_f32 v24, v24, v24
    ds_write_b16 v12, v24
    buffer_load_dwordx4 v[240:243], v1, s[12:15], s88 offen offset:2048 nt
    v_mov_b32 v40, 0
    v_mov_b32 v41, 0
    v_mov_b32 v44, 0
    v_mov_b32 v45, 0
    v_mov_b32 v48, 0
    v_mov_b32 v49, 0
    v_mov_b32 v52, 0
    v_mov_b32 v53, 0
    v_mov_b32 v56, 0
    v_mov_b32 v57, 0
    v_mov_b32 v60, 0
    v_mov_b32 v61, 0
    v_mov_b32 v64, 0
    v_mov_b32 v65, 0
    v_mov_b32 v68, 0
    v_mov_b32 v69, 0
    v_mov_b32 v72, 0
    v_mov_b32 v73, 0
    v_mov_b32 v74, 0
    v_mov_b32 v75, 0
    v_mov_b32 v76, 0
    v_mov_b32 v77, 0
    v_mov_b32 v78, 0
    v_mov_b32 v79, 0
    v_mov_b32 v80, 0
    v_mov_b32 v81, 0
    v_mov_b32 v82, 0
    v_mov_b32 v83, 0
    v_mov_b32 v84, 0
    v_mov_b32 v85, 0
    v_mov_b32 v86, 0
    v_mov_b32 v87, 0
    buffer_load_dwordx4 v[244:247], v1, s[12:15], s88 offen offset:3072 nt
    buffer_load_dwordx4 v[248:251], v23, s[12:15], s88 offen offset:0 nt
    s_waitcnt lgkmcnt(0)
    s_barrier
    ds_read_b128 v[28:31], v13 offset:0
    ds_read_b128 v[32:35], v13 offset:128
    ds_read_b128 v[36:39], v13 offset:256
    v_mov_b32 v18, 0x3dd53b94
    s_waitcnt lgkmcnt(2)
    v_smfmac_f32_16x16x64_bf16 v[40:43], v[28:31], a[0:7], v14
    v_smfmac_f32_16x16x64_bf16 v[44:47], v[28:31], a[24:31], v14
    v_smfmac_f32_16x16x64_bf16 v[48:51], v[28:31], a[48:55], v14
    v_smfmac_f32_16x16x64_bf16 v[52:55], v[28:31], a[72:79], v14
    v_smfmac_f32_16x16x64_bf16 v[56:59], v[28:31], a[96:103], v14
    v_smfmac_f32_16x16x64_bf16 v[60:63], v[28:31], a[120:127], v14
    v_smfmac_f32_16x16x64_bf16 v[64:67], v[28:31], a[144:151], v14
    v_smfmac_f32_16x16x64_bf16 v[68:71], v[28:31], a[168:175], v14
    buffer_load_dwordx4 v[252:255], v23, s[12:15], s88 offen offset:1024 nt
    s_barrier
    s_waitcnt lgkmcnt(1)
    v_smfmac_f32_16x16x64_bf16 v[40:43], v[32:35], a[8:15], v14
    v_smfmac_f32_16x16x64_bf16 v[44:47], v[32:35], a[32:39], v14
    v_smfmac_f32_16x16x64_bf16 v[48:51], v[32:35], a[56:63], v14
    v_smfmac_f32_16x16x64_bf16 v[52:55], v[32:35], a[80:87], v14
    v_smfmac_f32_16x16x64_bf16 v[56:59], v[32:35], a[104:111], v14
    v_smfmac_f32_16x16x64_bf16 v[60:63], v[32:35], a[128:135], v14
    v_smfmac_f32_16x16x64_bf16 v[64:67], v[32:35], a[152:159], v14
    v_smfmac_f32_16x16x64_bf16 v[68:71], v[32:35], a[176:183], v14
    s_waitcnt lgkmcnt(0)
    v_smfmac_f32_16x16x64_bf16 v[40:43], v[36:39], a[16:23], v14
    v_smfmac_f32_16x16x64_bf16 v[44:47], v[36:39], a[40:47], v14
    v_smfmac_f32_16x16x64_bf16 v[48:51], v[36:39], a[64:71], v14
    v_smfmac_f32_16x16x64_bf16 v[52:55], v[36:39], a[88:95], v14
    v_smfmac_f32_16x16x64_bf16 v[56:59], v[36:39], a[112:119], v14
    v_smfmac_f32_16x16x64_bf16 v[60:63], v[36:39], a[136:143], v14
    v_smfmac_f32_16x16x64_bf16 v[64:67], v[36:39], a[160:167], v14
    v_smfmac_f32_16x16x64_bf16 v[68:71], v[36:39], a[184:191], v14
    s_nop 0
    v_add_f32 v24, v40, v41
    v_add_f32 v44, v44, v45
    v_add_f32 v48, v48, v49
    v_max3_f32 v26, v24, v44, v48
    v_add_f32 v52, v52, v53
    v_add_f32 v25, v56, v57
    v_max3_f32 v26, v26, v52, v25
    v_add_f32 v60, v60, v61
    v_add_f32 v64, v64, v65
    v_max3_f32 v26, v26, v60, v64
    v_add_f32 v68, v68, v69
    v_max_f32 v26, v26, v68
    v_mov_b32_dpp v24, v44 quad_perm:[0,1,2,3] row_mask:0x2 bank_mask:0xf
    v_mov_b32_dpp v25, v60 quad_perm:[0,1,2,3] row_mask:0x2 bank_mask:0xf
    v_max_f32_dpp v26, v26, v26 row_ror:8 row_mask:0xf bank_mask:0xf
    v_mov_b32_dpp v24, v48 quad_perm:[0,1,2,3] row_mask:0x4 bank_mask:0xf
    v_mov_b32_dpp v25, v64 quad_perm:[0,1,2,3] row_mask:0x4 bank_mask:0xf
    v_max_f32_dpp v26, v26, v26 row_ror:4 row_mask:0xf bank_mask:0xf
    v_mov_b32_dpp v24, v52 quad_perm:[0,1,2,3] row_mask:0x8 bank_mask:0xf
    v_mov_b32_dpp v25, v68 quad_perm:[0,1,2,3] row_mask:0x8 bank_mask:0xf
    v_max_f32_dpp v26, v26, v26 row_ror:2 row_mask:0xf bank_mask:0xf
    v_accvgpr_read_b32 v27, a252
    s_nop 0
    v_max_f32_dpp v26, v26, v26 row_ror:1 row_mask:0xf bank_mask:0xf
    v_mul_f32 v26, v26, v18
    v_fma_f32 v24, v24, v18, -v26
    v_fma_f32 v25, v25, v18, -v26
    v_exp_f32 v24, v24
    v_exp_f32 v25, v25
    s_nop 0
    v_cvt_pk_bf16_f32 v28, v24, v25
    ds_write_b16 v19, v28
    ds_write_b16_d16_hi v19, v28 offset:128
    s_mov_b32 exec_lo, 0xff00ff
    s_mov_b32 exec_hi, 0xff00ff00
    ds_read_b128 v[72:75], v27 offset:0
    ds_read_b128 v[76:79], v27 offset:64
    ds_read_b128 v[80:83], v27 offset:128
    ds_read_b128 v[84:87], v27 offset:192
    s_mov_b64 exec, -1
    v_add_f32 v27, v24, v25
    v_mov_b32 v40, 0
    v_mov_b32 v44, 0
    v_add_f32_dpp v27, v27, v27 row_ror:8 row_mask:0xf bank_mask:0xf
    v_mov_b32 v48, 0
    v_mov_b32 v52, 0
    v_add_f32_dpp v27, v27, v27 row_ror:4 row_mask:0xf bank_mask:0xf
    v_mov_b32 v56, 0
    v_mov_b32 v60, 0
    v_add_f32_dpp v27, v27, v27 row_ror:2 row_mask:0xf bank_mask:0xf
    s_lshl_b32 s78, s72, 3
    s_add_u32 s78, s78, 125440
    v_add_f32_dpp v27, v27, v27 row_ror:1 row_mask:0xf bank_mask:0xf
    v_mov_b32 v28, v27
    s_nop 1
    v_permlane32_swap_b32 v27, v28
    v_add_f32 v27, v27, v28
    v_mov_b32 v28, v27
    s_nop 1
    v_permlane16_swap_b32 v27, v28
    v_add_f32 v27, v27, v28
    v_mov_b32 v28, s78
    ds_write_b64 v28, v[26:27]
    s_waitcnt lgkmcnt(0)
    v_smfmac_f32_16x16x64_bf16 v[40:43], v[72:75], a[192:199], v14 abid:1
    v_smfmac_f32_16x16x64_bf16 v[44:47], v[72:75], a[200:207], v14 abid:1
    v_smfmac_f32_16x16x64_bf16 v[48:51], v[72:75], a[208:215], v14 abid:1
    v_smfmac_f32_16x16x64_bf16 v[52:55], v[72:75], a[216:223], v14 abid:1
    v_smfmac_f32_16x16x64_bf16 v[56:59], v[72:75], a[224:231], v14 abid:1
    v_smfmac_f32_16x16x64_bf16 v[60:63], v[72:75], a[232:239], v14 abid:1
    v_smfmac_f32_16x16x64_bf16 v[40:43], v[76:79], v[112:119], v14 abid:1
    v_smfmac_f32_16x16x64_bf16 v[44:47], v[76:79], v[120:127], v14 abid:1
    v_smfmac_f32_16x16x64_bf16 v[48:51], v[76:79], v[128:135], v14 abid:1
    v_smfmac_f32_16x16x64_bf16 v[52:55], v[76:79], v[136:143], v14 abid:1
    v_smfmac_f32_16x16x64_bf16 v[56:59], v[76:79], v[144:151], v14 abid:1
    v_smfmac_f32_16x16x64_bf16 v[60:63], v[76:79], v[152:159], v14 abid:1
    s_waitcnt vmcnt(12)
    ds_write_b128 v2, v[184:187] offset:0
    ds_write_b128 v3, v[188:191] offset:0
    ds_write_b128 v4, v[192:195] offset:0
    ds_write_b128 v2, v[196:199] offset:3328
    ds_write_b128 v3, v[200:203] offset:3328
    ds_write_b128 v4, v[204:207] offset:3328
    ds_read_b64_tr_b16 v[160:161], v6 offset:0
    ds_read_b64_tr_b16 v[164:165], v6 offset:32
    ds_read_b64_tr_b16 v[168:169], v6 offset:64
    ds_read_b64_tr_b16 v[172:173], v6 offset:96
    ds_read_b64_tr_b16 v[176:177], v6 offset:128
    ds_read_b64_tr_b16 v[180:181], v6 offset:160
    ds_read_b64_tr_b16 v[184:185], v6 offset:192
    ds_read_b64_tr_b16 v[188:189], v6 offset:224
    ds_read_b64_tr_b16 v[192:193], v6 offset:256
    ds_read_b64_tr_b16 v[196:197], v6 offset:288
    ds_read_b64_tr_b16 v[200:201], v6 offset:320
    ds_read_b64_tr_b16 v[204:205], v6 offset:352
    v_mov_b32 v24, -1
    v_mov_b32 v25, -1
    v_mov_b32 v26, -1
    v_mov_b32 v27, -1
    buffer_store_dwordx4 v[24:27], v106, s[8:11], 0 offen
    s_cmp_eq_u32 s10, 0
    s_cbranch_scc1 SLOW2
BACK2:
    buffer_load_dwordx4 v[88:91], v1, s[12:15], s89 offen offset:0 nt
    buffer_load_dwordx4 v[92:95], v1, s[12:15], s89 offen offset:1024 nt
    buffer_load_dwordx4 v[96:99], v1, s[12:15], s89 offen offset:2048 nt
    buffer_load_dwordx4 v[100:103], v1, s[12:15], s89 offen offset:3072 nt
    buffer_load_dwordx4 v[104:107], v23, s[12:15], s89 offen offset:0 nt
    buffer_load_dwordx4 v[108:111], v23, s[12:15], s89 offen offset:1024 nt
    s_waitcnt vmcnt(13)
    ds_write_b128 v2, v[208:211] offset:0
    ds_write_b128 v3, v[212:215] offset:0
    ds_write_b128 v4, v[216:219] offset:0
    ds_write_b128 v2, v[220:223] offset:3328
    ds_write_b128 v3, v[224:227] offset:3328
    ds_write_b128 v4, v[228:231] offset:3328
    ds_read_b64_tr_b16 v[162:163], v6 offset:0
    ds_read_b64_tr_b16 v[166:167], v6 offset:32
    ds_read_b64_tr_b16 v[170:171], v6 offset:64
    ds_read_b64_tr_b16 v[174:175], v6 offset:96
    ds_read_b64_tr_b16 v[178:179], v6 offset:128
    ds_read_b64_tr_b16 v[182:183], v6 offset:160
    ds_read_b64_tr_b16 v[186:187], v6 offset:192
    ds_read_b64_tr_b16 v[190:191], v6 offset:224
    ds_read_b64_tr_b16 v[194:195], v6 offset:256
    ds_read_b64_tr_b16 v[198:199], v6 offset:288
    ds_read_b64_tr_b16 v[202:203], v6 offset:320
    ds_read_b64_tr_b16 v[206:207], v6 offset:352
    v_and_b32 v23, 0xffff0000, v22
    v_lshlrev_b32 v22, 16, v22
    s_mov_b32 s82, 0x50005
    s_mov_b32 s83, 0x50005
    s_mov_b32 s84, 0x1ff01ff
    s_mov_b32 s85, 0x1ff01ff
    s_mov_b32 s86, 0xffffffff
    s_mov_b32 s87, 0x1fff
    s_mov_b32 s50, 0x7fffff
    s_mov_b32 s51, 0x0
    s_mov_b32 s88, 0xff00ff
    s_mov_b32 s89, 0xff00ff00
    s_mov_b32 s92, 0x1010101
    s_mov_b32 s93, 0x0
    s_mov_b32 s44, 0xf0f0f0f
    s_mov_b32 s45, 0xf0f0f0f
    s_mov_b64 s[46:47], s[92:93]
    s_mov_b64 s[48:49], s[44:45]
    s_cmp_ge_u32 s69, 20
    s_cbranch_scc1 TAILF
    v_mov_b32 v24, -1
    v_mov_b32 v25, -1
    v_mov_b32 v26, -1
    v_mov_b32 v27, -1
    v_and_b32 v28, 3, v0
    v_lshrrev_b32 v29, 5, v0
    v_lshl_add_u32 v28, v29, 2, v28
    v_mul_u32_u24 v28, 10240, v28
    v_bfe_u32 v29, v0, 3, 2
    v_lshl_add_u32 v28, v29, 4, v28
    s_cmp_eq_u32 s72, 3
    s_cselect_b32 s77, 0, 1879048176
    v_add_u32 v28, s77, v28
    s_add_u32 s77, s80, 81920
    s_mov_b64 exec, s[44:45]
    buffer_store_dwordx4 v[24:27], v28, s[16:19], s77 offen sc1
    s_mov_b64 exec, -1
    v_lshrrev_b32 v38, 2, v0
    v_mul_u32_u24 v38, 1280, v38
    v_and_b32 v39, 3, v0
    v_lshl_add_u32 v39, v39, 4, v38
    s_mov_b32 m0, s67
    s_add_u32 s67, s67, 1024
    buffer_load_dwordx4 v39, s[24:27], s66 offen  lds
    s_add_u32 s66, s66, 20480
    s_mov_b32 m0, s67
    s_add_u32 s67, s67, 1024
    buffer_load_dwordx4 v39, s[24:27], s66 offen  lds
    s_add_u32 s66, s66, 20480
    s_mov_b32 m0, s67
    s_add_u32 s67, s67, 1024
    buffer_load_dwordx4 v39, s[24:27], s66 offen  lds
    s_add_u32 s66, s66, 20480
    s_waitcnt lgkmcnt(0)
    v_smfmac_f32_16x16x64_bf16 v[40:43], v[80:83], v[160:167], v14 abid:1
    v_smfmac_f32_16x16x64_bf16 v[44:47], v[80:83], v[168:175], v14 abid:1
    v_smfmac_f32_16x16x64_bf16 v[48:51], v[80:83], v[176:183], v14 abid:1
    v_smfmac_f32_16x16x64_bf16 v[52:55], v[80:83], v[184:191], v14 abid:1
    v_smfmac_f32_16x16x64_bf16 v[56:59], v[80:83], v[192:199], v14 abid:1
    v_smfmac_f32_16x16x64_bf16 v[60:63], v[80:83], v[200:207], v14 abid:1
    s_waitcnt vmcnt(11)
    ds_write_b128 v2, v[232:235] offset:0
    ds_write_b128 v3, v[236:239] offset:0
    ds_write_b128 v4, v[240:243] offset:0
    ds_write_b128 v2, v[244:247] offset:3328
    ds_write_b128 v3, v[248:251] offset:3328
    ds_write_b128 v4, v[252:255] offset:3328
    ds_read_b64_tr_b16 v[208:209], v6 offset:0
    ds_read_b64_tr_b16 v[212:213], v6 offset:32
    ds_read_b64_tr_b16 v[216:217], v6 offset:64
    ds_read_b64_tr_b16 v[220:221], v6 offset:96
    ds_read_b64_tr_b16 v[224:225], v6 offset:128
    ds_read_b64_tr_b16 v[228:229], v6 offset:160
    ds_read_b64_tr_b16 v[232:233], v6 offset:192
    ds_read_b64_tr_b16 v[236:237], v6 offset:224
    ds_read_b64_tr_b16 v[240:241], v6 offset:256
    ds_read_b64_tr_b16 v[244:245], v6 offset:288
    ds_read_b64_tr_b16 v[248:249], v6 offset:320
    ds_read_b64_tr_b16 v[252:253], v6 offset:352
    s_mov_b32 m0, s67
    s_add_u32 s67, s67, 1024
    buffer_load_dwordx4 v39, s[24:27], s66 offen  lds
    s_add_u32 s66, s66, 20480
    s_mov_b32 m0, s67
    s_add_u32 s67, s67, 1024
    buffer_load_dwordx4 v39, s[24:27], s66 offen  lds
    s_add_u32 s66, s66, 20480
    s_mov_b32 m0, s67
    s_add_u32 s67, s67, 1024
    buffer_load_dwordx4 v39, s[24:27], s66 offen  lds
    s_add_u32 s66, s66, 20480
    s_waitcnt vmcnt(12)
    ds_write_b128 v2, v[88:91] offset:0
    s_waitcnt vmcnt(11)
    ds_write_b128 v3, v[92:95] offset:0
    s_waitcnt vmcnt(10)
    ds_write_b128 v4, v[96:99] offset:0
    s_waitcnt vmcnt(9)
    ds_write_b128 v2, v[100:103] offset:3328
    s_waitcnt vmcnt(8)
    ds_write_b128 v3, v[104:107] offset:3328
    s_waitcnt vmcnt(7)
    ds_write_b128 v4, v[108:111] offset:3328
    ds_read_b64_tr_b16 v[210:211], v6 offset:0
    ds_read_b64_tr_b16 v[214:215], v6 offset:32
    ds_read_b64_tr_b16 v[218:219], v6 offset:64
    ds_read_b64_tr_b16 v[222:223], v6 offset:96
    ds_read_b64_tr_b16 v[226:227], v6 offset:128
    ds_read_b64_tr_b16 v[230:231], v6 offset:160
    ds_read_b64_tr_b16 v[234:235], v6 offset:192
    ds_read_b64_tr_b16 v[238:239], v6 offset:224
    ds_read_b64_tr_b16 v[242:243], v6 offset:256
    ds_read_b64_tr_b16 v[246:247], v6 offset:288
    ds_read_b64_tr_b16 v[250:251], v6 offset:320
    ds_read_b64_tr_b16 v[254:255], v6 offset:352
    s_branch ATT_LAST
TAILF:
    s_lshl_b32 s90, s72, 3
    s_add_u32 s90, s90, s68
    s_add_u32 s90, s90, 1
    s_mul_i32 s90, s90, 245760
    s_sub_u32 s78, 32, s69
    s_mul_i32 s78, s78, 10240
    s_sub_u32 s90, s90, s78
    buffer_load_dwordx4 a[240:243], v1, s[20:23], s90 offen offset:0
    buffer_load_dwordx4 a[240:243], v1, s[20:23], s90 offen offset:1024
    buffer_load_dwordx4 a[240:243], v1, s[20:23], s90 offen offset:2048
    buffer_load_dwordx4 a[240:243], v1, s[20:23], s90 offen offset:3072
    s_add_u32 s90, s90, 4096
    buffer_load_dwordx4 a[240:243], v1, s[20:23], s90 offen offset:0
    buffer_load_dwordx4 a[240:243], v1, s[20:23], s90 offen offset:1024
    buffer_load_dwordx4 a[240:243], v1, s[20:23], s90 offen offset:2048
    v_lshrrev_b32 v38, 3, v0
    v_mul_u32_u24 v38, 3072, v38
    v_and_b32 v39, 7, v0
    v_lshl_add_u32 v38, v39, 4, v38
    v_bfe_u32 v39, v0, 4, 1
    v_lshlrev_b32 v39, 5, v39
    v_xor_b32 v38, v38, v39
    v_xor_b32 v39, 64, v38
    s_waitcnt lgkmcnt(0)
    v_smfmac_f32_16x16x64_bf16 v[40:43], v[80:83], v[160:167], v14 abid:1
    v_smfmac_f32_16x16x64_bf16 v[44:47], v[80:83], v[168:175], v14 abid:1
    v_smfmac_f32_16x16x64_bf16 v[48:51], v[80:83], v[176:183], v14 abid:1
    v_smfmac_f32_16x16x64_bf16 v[52:55], v[80:83], v[184:191], v14 abid:1
    v_smfmac_f32_16x16x64_bf16 v[56:59], v[80:83], v[192:199], v14 abid:1
    v_smfmac_f32_16x16x64_bf16 v[60:63], v[80:83], v[200:207], v14 abid:1
    s_waitcnt vmcnt(14)
    ds_write_b128 v2, v[232:235] offset:0
    ds_write_b128 v3, v[236:239] offset:0
    ds_write_b128 v4, v[240:243] offset:0
    ds_write_b128 v2, v[244:247] offset:3328
    ds_write_b128 v3, v[248:251] offset:3328
    ds_write_b128 v4, v[252:255] offset:3328
    ds_read_b64_tr_b16 v[208:209], v6 offset:0
    ds_read_b64_tr_b16 v[212:213], v6 offset:32
    ds_read_b64_tr_b16 v[216:217], v6 offset:64
    ds_read_b64_tr_b16 v[220:221], v6 offset:96
    ds_read_b64_tr_b16 v[224:225], v6 offset:128
    ds_read_b64_tr_b16 v[228:229], v6 offset:160
    ds_read_b64_tr_b16 v[232:233], v6 offset:192
    ds_read_b64_tr_b16 v[236:237], v6 offset:224
    ds_read_b64_tr_b16 v[240:241], v6 offset:256
    ds_read_b64_tr_b16 v[244:245], v6 offset:288
    ds_read_b64_tr_b16 v[248:249], v6 offset:320
    ds_read_b64_tr_b16 v[252:253], v6 offset:352
    buffer_load_dwordx4 a[240:243], v1, s[20:23], s90 offen offset:3072
    s_add_u32 s90, s90, 4096
    buffer_load_dwordx4 a[240:243], v1, s[20:23], s90 offen offset:0
    buffer_load_dwordx4 a[240:243], v1, s[20:23], s90 offen offset:1024
    s_waitcnt vmcnt(15)
    ds_write_b128 v2, v[88:91] offset:0
    s_waitcnt vmcnt(14)
    ds_write_b128 v3, v[92:95] offset:0
    s_waitcnt vmcnt(13)
    ds_write_b128 v4, v[96:99] offset:0
    s_waitcnt vmcnt(12)
    ds_write_b128 v2, v[100:103] offset:3328
    s_waitcnt vmcnt(11)
    ds_write_b128 v3, v[104:107] offset:3328
    s_waitcnt vmcnt(10)
    ds_write_b128 v4, v[108:111] offset:3328
    ds_read_b64_tr_b16 v[210:211], v6 offset:0
    ds_read_b64_tr_b16 v[214:215], v6 offset:32
    ds_read_b64_tr_b16 v[218:219], v6 offset:64
    ds_read_b64_tr_b16 v[222:223], v6 offset:96
    ds_read_b64_tr_b16 v[226:227], v6 offset:128
    ds_read_b64_tr_b16 v[230:231], v6 offset:160
    ds_read_b64_tr_b16 v[234:235], v6 offset:192
    ds_read_b64_tr_b16 v[238:239], v6 offset:224
    ds_read_b64_tr_b16 v[242:243], v6 offset:256
    ds_read_b64_tr_b16 v[246:247], v6 offset:288
    ds_read_b64_tr_b16 v[250:251], v6 offset:320
    ds_read_b64_tr_b16 v[254:255], v6 offset:352
    s_branch ATT_LAST
LOOP:
    s_cmp_lt_u32 s69, 20
    s_cselect_b32 s5, s72, 4
    s_add_u32 s96, s3, 819200
    s_add_u32 s97, s96, 4096
    s_and_b32 s77, s5, 3
    s_cbranch_scc1 LOOP2
    ds_read_b64_tr_b16 v[40:41], v16 offset:0
    ds_read_b64_tr_b16 v[42:43], v16 offset:1536
    ds_read_b64_tr_b16 v[44:45], v16 offset:12288
    ds_read_b64_tr_b16 v[46:47], v16 offset:13824
    ds_read_b64_tr_b16 v[48:49], v17 offset:24576
    ds_read_b64_tr_b16 v[50:51], v16 offset:32
    ds_read_b64_tr_b16 v[52:53], v16 offset:1568
    ds_read_b64_tr_b16 v[54:55], v16 offset:12320
    ds_read_b64_tr_b16 v[56:57], v16 offset:13856
    ds_read_b64_tr_b16 v[58:59], v17 offset:24608
    ds_read_b64_tr_b16 v[60:61], v16 offset:64
    ds_read_b64_tr_b16 v[62:63], v16 offset:1600
    ds_read_b64_tr_b16 v[64:65], v16 offset:12352
    ds_read_b64_tr_b16 v[66:67], v16 offset:13888
    ds_read_b64_tr_b16 v[68:69], v17 offset:24640
    v_and_b32 v25, 15, v0
    v_cmp_eq_u32 vcc, 12, v25
    v_mov_b32 v36, 0x3f803f80
    s_nop 0
    v_cndmask_b32 v70, 0, v36, vcc
    v_mov_b32 v71, v70
    v_mov_b32 v72, v70
    v_mov_b32 v73, v70
    v_mov_b32 v74, v70
    v_mov_b32 v75, v70
    v_mov_b32 v76, v70
    v_mov_b32 v77, v70
    v_mov_b32 v78, v70
    v_mov_b32 v79, v70
    s_mov_b32 s77, 4096
    v_mul_u32_u24 v96, 103, v0
    v_lshrrev_b32 v96, 10, v96
    v_lshl_add_u32 v96, v96, 4, v1
    v_add_u32 v96, s77, v96
    v_mul_u32_u24 v97, 176, v25
    v_add_u32 v97, s77, v97
    v_lshrrev_b32 v28, 4, v0
    v_lshl_add_u32 v98, v28, 3, v97
    v_lshl_add_u32 v97, v28, 4, v97
LOOP2:
    s_add_u32 s79, s3, 4096
    s_mul_i32 s77, s71, 160
    s_add_u32 s77, s77, s3
    s_sub_u32 s77, s77, 772608
    s_mov_b32 exec_lo, 0x3ff
    s_mov_b32 exec_hi, 0x0
    s_mov_b32 s76, 1
POLL3:
    buffer_load_dword v24, v1, s[16:19], s77 offen sc1
POLLW3:
    s_waitcnt vmcnt(0)
    v_cmp_eq_u32 vcc, -1, v24
    s_cbranch_vccnz AGAIN3
POLLX3:
    s_mov_b64 exec, s[50:51]
    buffer_load_dwordx4 v[80:83], v8, s[16:19], 0 offen sc1
    s_mov_b64 exec, -1
    buffer_load_dwordx4 v[88:91], v11, s[16:19], s96 offen sc1
    buffer_load_dwordx4 v[92:95], v11, s[16:19], s97 offen sc1
    s_mov_b64 exec, s[50:51]
    s_waitcnt vmcnt(2)
BW4:
    ds_write_b128 v9, v[80:83]
    v_cmp_eq_u32 vcc, -1, v80
    s_cbranch_vccnz BR4
BX4:
    s_mov_b64 exec, s[84:85]
    s_waitcnt lgkmcnt(0)
    s_barrier
    ds_read_b128 v[70:73], v97
    ds_read_b128 v[74:77], v97 offset:64
    ds_read_b64 v[78:79], v98 offset:128
    s_mov_b64 exec, -1
    s_cmp_lg_u32 s5, 1
    s_cbranch_scc1 NOOWL
    buffer_load_dword a244, v20, s[16:19], 0 offen sc1
    buffer_load_dword a245, v21, s[16:19], 0 offen sc1
NOOWL:
    s_waitcnt lgkmcnt(2)
    v_mfma_f32_16x16x32_bf16 v[24:27], v[70:73], v[40:43], 0
    v_mfma_f32_16x16x32_bf16 v[32:35], v[70:73], v[60:63], 0
    s_waitcnt lgkmcnt(0)
    v_mfma_f32_16x16x32_bf16 v[24:27], v[74:77], v[44:47], v[24:27]
    v_mfma_f32_16x16x32_bf16 v[32:35], v[74:77], v[64:67], v[32:35]
    v_mfma_f32_16x16x16_bf16 v[24:27], v[78:79], v[48:49], v[24:27]
    v_mfma_f32_16x16x16_bf16 v[32:35], v[78:79], v[68:69], v[32:35]
    v_mfma_f32_16x16x32_bf16 v[28:31], v[70:73], v[50:53], 0
    v_mfma_f32_16x16x32_bf16 v[36:39], v[70:73], v[70:73], 0
    v_mfma_f32_16x16x32_bf16 v[28:31], v[74:77], v[54:57], v[28:31]
    v_mfma_f32_16x16x32_bf16 v[36:39], v[74:77], v[74:77], v[36:39]
    v_mfma_f32_16x16x16_bf16 v[28:31], v[78:79], v[58:59], v[28:31]
    v_mfma_f32_16x16x16_bf16 v[36:39], v[78:79], v[78:79], v[36:39]
    s_nop 0
    v_add_f32 v24, v24, v25
    v_add_f32 v26, v26, v27
    v_add_f32 v24, v24, v26
    v_add_f32 v32, v32, v33
    v_add_f32 v34, v34, v35
    v_add_f32 v32, v32, v34
    s_nop 1
    v_permlane32_swap_b32 v24, v32
    v_add_f32 v28, v28, v29
    v_add_f32 v30, v30, v31
    v_add_f32 v36, v36, v37
    v_add_f32 v38, v38, v39
    v_add_f32 v24, v24, v32
    v_add_f32 v28, v28, v30
    v_add_f32 v36, v36, v38
    s_nop 1
    v_permlane32_swap_b32 v28, v36
    v_add_f32 v28, v28, v36
    s_nop 1
    v_permlane16_swap_b32 v24, v28
    v_add_f32 v24, v24, v28
    buffer_store_dword v24, v10, s[8:11], s3 offen
    s_cmp_eq_u32 s10, 0
    s_cbranch_scc1 SLOW5
BACK5:
    v_mov_b32 v40, 0
    v_mov_b32 v41, 0
    v_mov_b32 v44, 0
    v_mov_b32 v45, 0
    v_mov_b32 v48, 0
    v_mov_b32 v49, 0
    v_mov_b32 v52, 0
    v_mov_b32 v53, 0
    v_mov_b32 v56, 0
    v_mov_b32 v57, 0
    v_mov_b32 v60, 0
    v_mov_b32 v61, 0
    v_mov_b32 v64, 0
    v_mov_b32 v65, 0
    v_mov_b32 v68, 0
    v_mov_b32 v69, 0
    v_mov_b32 v72, 0
    v_mov_b32 v73, 0
    v_mov_b32 v74, 0
    v_mov_b32 v75, 0
    v_mov_b32 v76, 0
    v_mov_b32 v77, 0
    v_mov_b32 v78, 0
    v_mov_b32 v79, 0
    v_mov_b32 v80, 0
    v_mov_b32 v81, 0
    v_mov_b32 v82, 0
    v_mov_b32 v83, 0
    v_mov_b32 v84, 0
    v_mov_b32 v85, 0
    v_mov_b32 v86, 0
    v_mov_b32 v87, 0
    s_waitcnt vmcnt(1)
    v_add_f32 v88, v88, v92
    v_add_f32 v89, v89, v93
    v_add_f32 v90, v90, v94
    v_add_f32 v91, v91, v95
    s_nop 0
    v_permlane32_swap_b32 v88, v90
    v_permlane32_swap_b32 v89, v91
    v_add_f32 v88, v88, v90
    v_add_f32 v89, v89, v91
    s_nop 1
    v_permlane16_swap_b32 v88, v89
    v_add_f32 v88, v88, v89
    v_mul_f32 v7, 0x3acccccd, v88
    s_mov_b32 s76, 1
POLL6:
    buffer_load_dwordx4 v[24:27], v11, s[16:19], s3 offen sc1
    buffer_load_dwordx4 v[28:31], v11, s[16:19], s79 offen sc1
    s_waitcnt vmcnt(0)
    v_add_f32 v24, v24, v28
    v_add_f32 v25, v25, v29
    v_add_f32 v26, v26, v30
    v_add_f32 v27, v27, v31
    s_nop 0
    v_permlane32_swap_b32 v24, v26
    v_permlane32_swap_b32 v25, v27
    v_add_f32 v24, v24, v26
    v_add_f32 v25, v25, v27
    s_nop 1
    v_permlane16_swap_b32 v24, v25
    v_add_f32 v24, v24, v25
    v_cmp_u_f32 vcc, v24, v24
    s_cbranch_vccnz AGAIN6
POLLX6:
    v_readlane_b32 s77, v24, 15
    s_mov_b32 vcc_lo, 0x70007000
    s_mov_b32 vcc_hi, 0x70007000
    v_fma_f32 v25, -s77, v7, v24
    v_cvt_pk_bf16_f32 v25, v25, v25
    ds_write_b16 v12, v25
    v_cndmask_b32 v26, 0, v24, vcc
    s_nop 1
    v_add_f32_dpp v26, v26, v26 quad_perm:[1,0,3,2] row_mask:0xf bank_mask:0xf
    s_nop 1
    v_add_f32_dpp v26, v26, v26 quad_perm:[2,3,0,1] row_mask:0xf bank_mask:0xf
    v_mov_b32 v27, v26
    s_nop 1
    v_permlane32_swap_b32 v26, v27
    v_add_f32 v26, v26, v27
    s_waitcnt lgkmcnt(0)
    s_barrier
    ds_read_b128 v[28:31], v13 offset:0
    ds_read_b128 v[32:35], v13 offset:128
    ds_read_b128 v[36:39], v13 offset:256
    v_mov_b32 v27, v26
    v_mov_b32 v25, s77
    v_subrev_f32 v25, 0x44200000, v25
    v_permlane16_swap_b32 v26, v27
    v_add_f32 v26, v26, v27
    v_mul_f32 v24, 0x3acccccd, v25
    v_readlane_b32 s77, v26, 15
    v_mul_f32 v24, v24, v24
    s_mov_b32 s78, 0x3acccccd
    v_sub_f32 v26, s77, v25
    v_fma_f32 v26, v26, s78, -v24
    v_max_f32 v26, 0, v26
    v_add_f32 v26, 0x3727c5ac, v26
    v_rsq_f32 v26, v26
    s_nop 0
    v_mul_f32 v18, 0x3dd53b94, v26
    s_waitcnt lgkmcnt(2)
    v_smfmac_f32_16x16x64_bf16 v[40:43], v[28:31], a[0:7], v14
    v_smfmac_f32_16x16x64_bf16 v[44:47], v[28:31], a[24:31], v14
    v_smfmac_f32_16x16x64_bf16 v[48:51], v[28:31], a[48:55], v14
    v_smfmac_f32_16x16x64_bf16 v[52:55], v[28:31], a[72:79], v14
    v_smfmac_f32_16x16x64_bf16 v[56:59], v[28:31], a[96:103], v14
    v_smfmac_f32_16x16x64_bf16 v[60:63], v[28:31], a[120:127], v14
    v_smfmac_f32_16x16x64_bf16 v[64:67], v[28:31], a[144:151], v14
    v_smfmac_f32_16x16x64_bf16 v[68:71], v[28:31], a[168:175], v14
    s_waitcnt lgkmcnt(1)
    v_smfmac_f32_16x16x64_bf16 v[40:43], v[32:35], a[8:15], v14
    v_smfmac_f32_16x16x64_bf16 v[44:47], v[32:35], a[32:39], v14
    v_smfmac_f32_16x16x64_bf16 v[48:51], v[32:35], a[56:63], v14
    v_smfmac_f32_16x16x64_bf16 v[52:55], v[32:35], a[80:87], v14
    v_smfmac_f32_16x16x64_bf16 v[56:59], v[32:35], a[104:111], v14
    v_smfmac_f32_16x16x64_bf16 v[60:63], v[32:35], a[128:135], v14
    v_smfmac_f32_16x16x64_bf16 v[64:67], v[32:35], a[152:159], v14
    v_smfmac_f32_16x16x64_bf16 v[68:71], v[32:35], a[176:183], v14
    s_waitcnt lgkmcnt(0)
    v_smfmac_f32_16x16x64_bf16 v[40:43], v[36:39], a[16:23], v14
    v_smfmac_f32_16x16x64_bf16 v[44:47], v[36:39], a[40:47], v14
    v_smfmac_f32_16x16x64_bf16 v[48:51], v[36:39], a[64:71], v14
    v_smfmac_f32_16x16x64_bf16 v[52:55], v[36:39], a[88:95], v14
    v_smfmac_f32_16x16x64_bf16 v[56:59], v[36:39], a[112:119], v14
    v_smfmac_f32_16x16x64_bf16 v[60:63], v[36:39], a[136:143], v14
    v_smfmac_f32_16x16x64_bf16 v[64:67], v[36:39], a[160:167], v14
    v_smfmac_f32_16x16x64_bf16 v[68:71], v[36:39], a[184:191], v14
    s_nop 0
    v_add_f32 v24, v40, v41
    v_add_f32 v44, v44, v45
    v_add_f32 v48, v48, v49
    v_max3_f32 v26, v24, v44, v48
    v_add_f32 v52, v52, v53
    v_add_f32 v25, v56, v57
    v_max3_f32 v26, v26, v52, v25
    v_add_f32 v60, v60, v61
    v_add_f32 v64, v64, v65
    v_max3_f32 v26, v26, v60, v64
    v_add_f32 v68, v68, v69
    v_max_f32 v26, v26, v68
    v_mov_b32_dpp v24, v44 quad_perm:[0,1,2,3] row_mask:0x2 bank_mask:0xf
    v_mov_b32_dpp v25, v60 quad_perm:[0,1,2,3] row_mask:0x2 bank_mask:0xf
    v_max_f32_dpp v26, v26, v26 row_ror:8 row_mask:0xf bank_mask:0xf
    v_mov_b32_dpp v24, v48 quad_perm:[0,1,2,3] row_mask:0x4 bank_mask:0xf
    v_mov_b32_dpp v25, v64 quad_perm:[0,1,2,3] row_mask:0x4 bank_mask:0xf
    v_max_f32_dpp v26, v26, v26 row_ror:4 row_mask:0xf bank_mask:0xf
    v_mov_b32_dpp v24, v52 quad_perm:[0,1,2,3] row_mask:0x8 bank_mask:0xf
    v_mov_b32_dpp v25, v68 quad_perm:[0,1,2,3] row_mask:0x8 bank_mask:0xf
    v_max_f32_dpp v26, v26, v26 row_ror:2 row_mask:0xf bank_mask:0xf
    v_accvgpr_read_b32 v27, a252
    s_nop 0
    v_max_f32_dpp v26, v26, v26 row_ror:1 row_mask:0xf bank_mask:0xf
    v_mul_f32 v26, v26, v18
    v_fma_f32 v24, v24, v18, -v26
    v_fma_f32 v25, v25, v18, -v26
    v_exp_f32 v24, v24
    v_exp_f32 v25, v25
    s_nop 0
    v_cvt_pk_bf16_f32 v28, v24, v25
    ds_write_b16 v19, v28
    ds_write_b16_d16_hi v19, v28 offset:128
    s_mov_b64 exec, s[88:89]
    ds_read_b128 v[72:75], v27 offset:0
    ds_read_b128 v[76:79], v27 offset:64
    ds_read_b128 v[80:83], v27 offset:128
    ds_read_b128 v[84:87], v27 offset:192
    s_mov_b64 exec, -1
    v_add_f32 v27, v24, v25
    v_mov_b32 v40, 0
    v_mov_b32 v44, 0
    v_add_f32_dpp v27, v27, v27 row_ror:8 row_mask:0xf bank_mask:0xf
    v_mov_b32 v48, 0
    v_mov_b32 v52, 0
    v_add_f32_dpp v27, v27, v27 row_ror:4 row_mask:0xf bank_mask:0xf
    v_mov_b32 v56, 0
    v_mov_b32 v60, 0
    v_add_f32_dpp v27, v27, v27 row_ror:2 row_mask:0xf bank_mask:0xf
    s_lshl_b32 s78, s72, 3
    s_add_u32 s78, s78, 125440
    v_add_f32_dpp v27, v27, v27 row_ror:1 row_mask:0xf bank_mask:0xf
    v_mov_b32 v28, v27
    s_nop 1
    v_permlane32_swap_b32 v27, v28
    v_add_f32 v27, v27, v28
    v_mov_b32 v28, v27
    s_nop 1
    v_permlane16_swap_b32 v27, v28
    v_add_f32 v27, v27, v28
    v_mov_b32 v28, s78
    ds_write_b64 v28, v[26:27]
    s_waitcnt lgkmcnt(4)
    v_smfmac_f32_16x16x64_bf16 v[40:43], v[72:75], a[192:199], v14 abid:1
    v_smfmac_f32_16x16x64_bf16 v[44:47], v[72:75], a[200:207], v14 abid:1
    v_smfmac_f32_16x16x64_bf16 v[48:51], v[72:75], a[208:215], v14 abid:1
    v_smfmac_f32_16x16x64_bf16 v[52:55], v[72:75], a[216:223], v14 abid:1
    v_smfmac_f32_16x16x64_bf16 v[56:59], v[72:75], a[224:231], v14 abid:1
    v_smfmac_f32_16x16x64_bf16 v[60:63], v[72:75], a[232:239], v14 abid:1
    s_waitcnt lgkmcnt(3)
    v_smfmac_f32_16x16x64_bf16 v[40:43], v[76:79], v[112:119], v14 abid:1
    v_smfmac_f32_16x16x64_bf16 v[44:47], v[76:79], v[120:127], v14 abid:1
    v_smfmac_f32_16x16x64_bf16 v[48:51], v[76:79], v[128:135], v14 abid:1
    v_smfmac_f32_16x16x64_bf16 v[52:55], v[76:79], v[136:143], v14 abid:1
    v_smfmac_f32_16x16x64_bf16 v[56:59], v[76:79], v[144:151], v14 abid:1
    v_smfmac_f32_16x16x64_bf16 v[60:63], v[76:79], v[152:159], v14 abid:1
    s_waitcnt lgkmcnt(2)
    v_smfmac_f32_16x16x64_bf16 v[40:43], v[80:83], v[160:167], v14 abid:1
    v_smfmac_f32_16x16x64_bf16 v[44:47], v[80:83], v[168:175], v14 abid:1
    v_smfmac_f32_16x16x64_bf16 v[48:51], v[80:83], v[176:183], v14 abid:1
    v_smfmac_f32_16x16x64_bf16 v[52:55], v[80:83], v[184:191], v14 abid:1
    v_smfmac_f32_16x16x64_bf16 v[56:59], v[80:83], v[192:199], v14 abid:1
    v_smfmac_f32_16x16x64_bf16 v[60:63], v[80:83], v[200:207], v14 abid:1
    s_waitcnt lgkmcnt(0)
ATT_LAST:
    s_waitcnt lgkmcnt(8)
    v_smfmac_f32_16x16x64_bf16 v[40:43], v[84:87], v[208:215], v14 abid:1
    v_smfmac_f32_16x16x64_bf16 v[44:47], v[84:87], v[216:223], v14 abid:1
    s_waitcnt lgkmcnt(4)
    v_smfmac_f32_16x16x64_bf16 v[48:51], v[84:87], v[224:231], v14 abid:1
    v_smfmac_f32_16x16x64_bf16 v[52:55], v[84:87], v[232:239], v14 abid:1
    s_waitcnt lgkmcnt(0)
    v_smfmac_f32_16x16x64_bf16 v[56:59], v[84:87], v[240:247], v14 abid:1
    v_smfmac_f32_16x16x64_bf16 v[60:63], v[84:87], v[248:255], v14 abid:1
    s_lshl_b32 s77, s72, 8
    s_add_u32 s77, s77, 119296
    v_lshl_add_u32 v24, v0, 2, s77
    v_permlane16_swap_b32 v40, v44
    v_add_f32 v40, v40, v44
    ds_write_b32 v15, v40 offset:0
    v_permlane16_swap_b32 v48, v52
    v_add_f32 v48, v48, v52
    ds_write_b32 v15, v48 offset:256
    v_permlane16_swap_b32 v56, v60
    v_add_f32 v56, v56, v60
    ds_write_b32 v15, v56 offset:512
    v_and_b32 v25, 3, v0
    v_mad_u32_u24 v26, v25, 48, v1
    v_lshlrev_b32 v25, 3, v25
    v_add_u32 v25, 125440, v25
    s_waitcnt lgkmcnt(0)
    s_barrier
    ds_read_b64 v[32:33], v25
    ds_read2st64_b32 v[40:41], v24 offset0:0 offset1:3
    ds_read2st64_b32 v[42:43], v24 offset0:6 offset1:9
    s_mul_i32 s77, s70, 3072
    s_lshl_b32 s78, s71, 4
    s_add_u32 s77, s77, s78
    s_lshl_b32 s78, s72, 10
    s_add_u32 s77, s77, s78
    s_add_u32 s77, s77, s3
    s_add_u32 s77, s77, 32768
    s_lshl_b32 s78, s69, 3
    s_add_u32 s78, s78, s3
    s_add_u32 s78, s78, 45056
    s_cmp_eq_u32 s72, 3
    s_waitcnt lgkmcnt(2)
    v_max_f32_dpp v34, v32, v32 quad_perm:[1,0,3,2] row_mask:0xf bank_mask:0xf
    s_nop 1
    v_max_f32_dpp v34, v34, v34 quad_perm:[2,3,0,1] row_mask:0xf bank_mask:0xf
    v_sub_f32 v32, v32, v34
    v_exp_f32 v32, v32
    s_cbranch_scc1 OML
    s_waitcnt lgkmcnt(0)
    v_mul_f32_dpp v28, v32, v40 quad_perm:[0,0,0,0] row_mask:0xf bank_mask:0xf
    v_mul_f32_dpp v29, v32, v41 quad_perm:[1,1,1,1] row_mask:0xf bank_mask:0xf
    v_mul_f32_dpp v30, v32, v42 quad_perm:[2,2,2,2] row_mask:0xf bank_mask:0xf
    v_fmac_f32_dpp v28, v32, v43 quad_perm:[3,3,3,3] row_mask:0xf bank_mask:0xf
    v_add_f32 v29, v29, v30
    v_add_f32 v28, v28, v29
    s_nop 1
    v_mov_b32_dpp v29, v28 row_shl:1 row_mask:0xf bank_mask:0xf
    v_cvt_pk_bf16_f32 v28, v28, v29
    s_nop 1
    v_mov_b32_dpp v29, v28 row_shl:4 row_mask:0xf bank_mask:0xf
    v_mov_b32_dpp v30, v28 row_shl:8 row_mask:0xf bank_mask:0xf
    v_mov_b32_dpp v31, v28 row_shl:12 row_mask:0xf bank_mask:0xf
    s_mov_b64 exec, s[82:83]
    buffer_store_dwordx4 v[28:31], v26, s[8:11], s77 offen
    s_cmp_eq_u32 s10, 0
    s_cbranch_scc1 SLOW7
BACK7:
    s_mov_b64 exec, -1
ODONE:
    s_cmp_ge_u32 s69, 20
    s_cbranch_scc1 ROLEF
    s_cmp_eq_u32 s74, 0
    s_cbranch_scc1 WLATE
    v_accvgpr_read_b32 v2, a246
    v_accvgpr_read_b32 v3, a247
    v_accvgpr_read_b32 v4, a248
    ds_read_b64_tr_b16 v[40:41], v2 offset:0
    ds_read_b64_tr_b16 v[42:43], v2 offset:256
    ds_read_b64_tr_b16 v[64:65], v2 offset:32
    ds_read_b64_tr_b16 v[66:67], v2 offset:288
    ds_read_b64_tr_b16 v[44:45], v2 offset:2048
    ds_read_b64_tr_b16 v[46:47], v2 offset:2304
    ds_read_b64_tr_b16 v[68:69], v2 offset:2080
    ds_read_b64_tr_b16 v[70:71], v2 offset:2336
    ds_read_b64_tr_b16 v[48:49], v2 offset:4096
    ds_read_b64_tr_b16 v[50:51], v2 offset:4352
    s_cmp_lg_u32 s72, 1
    s_cbranch_scc1 NOOWN0
    v_accvgpr_read_b32 v28, a244
    v_accvgpr_read_b32 v29, a245
    v_max_u32 v30, v28, v29
    v_cmp_eq_u32 vcc, -1, v30
    s_cbranch_vccnz RETRY8
OK8:
    v_lshlrev_b32 v30, 16, v28
    v_and_b32 v28, 0xffff0000, v28
    v_lshlrev_b32 v31, 16, v29
    v_and_b32 v29, 0xffff0000, v29
    v_add_f32 v30, v30, v31
    v_add_f32 v28, v28, v29
    v_mov_b32 v31, v30
    v_mov_b32 v29, v28
    s_nop 0
    v_permlane32_swap_b32 v30, v31
    v_permlane32_swap_b32 v28, v29
    v_add_f32 v30, v30, v31
    v_add_f32 v28, v28, v29
    v_mov_b32 v31, v30
    v_mov_b32 v29, v28
    s_nop 0
    v_permlane16_swap_b32 v30, v31
    v_permlane16_swap_b32 v28, v29
    v_add_f32 v30, v30, v31
    v_add_f32 v28, v28, v29
    v_add_f32 v22, v22, v30
    v_add_f32 v23, v23, v28
    v_cvt_pk_bf16_f32 v28, v22, v23
    s_lshl_b32 s77, s69, 6
    s_add_u32 s77, s77, s3
    s_add_u32 s77, s77, 47872
    v_lshlrev_b32 v32, 2, v0
    v_mov_b32_dpp v29, v28 quad_perm:[1,1,1,1] row_mask:0xf bank_mask:0xf
    v_mov_b32_dpp v30, v28 quad_perm:[2,2,2,2] row_mask:0xf bank_mask:0xf
    v_mov_b32_dpp v31, v28 quad_perm:[3,3,3,3] row_mask:0xf bank_mask:0xf
    s_mov_b32 exec_lo, 0x1111
    s_mov_b32 exec_hi, 0x0
    buffer_store_dwordx4 v[28:31], v32, s[8:11], s77 offen
    s_cmp_eq_u32 s10, 0
    s_cbranch_scc1 SLOW9
BACK9:
    s_mov_b64 exec, -1
NOOWN0:
    buffer_load_dwordx2 v[24:25], v4, s[16:19], s3 offen sc1
    buffer_load_dwordx4 v[88:91], v3, s[16:19], s3 offen offset:0 sc1
    buffer_load_dwordx4 v[92:95], v3, s[16:19], s3 offen offset:1024 sc1
    buffer_load_dwordx4 v[96:99], v3, s[16:19], s3 offen offset:2048 sc1
    ds_read_b64_tr_b16 v[72:73], v2 offset:4128
    ds_read_b64_tr_b16 v[74:75], v2 offset:4384
    ds_read_b64_tr_b16 v[52:53], v2 offset:6144
    ds_read_b64_tr_b16 v[54:55], v2 offset:6400
    ds_read_b64_tr_b16 v[76:77], v2 offset:6176
    ds_read_b64_tr_b16 v[78:79], v2 offset:6432
    ds_read_b64_tr_b16 v[56:57], v2 offset:8192
    ds_read_b64_tr_b16 v[58:59], v2 offset:8448
    ds_read_b64_tr_b16 v[80:81], v2 offset:8224
    ds_read_b64_tr_b16 v[82:83], v2 offset:8480
    ds_read_b64_tr_b16 v[60:61], v2 offset:10240
    ds_read_b64_tr_b16 v[62:63], v2 offset:10496
    ds_read_b64_tr_b16 v[84:85], v2 offset:10272
    ds_read_b64_tr_b16 v[86:87], v2 offset:10528
    v_accvgpr_read_b32 v5, a249
    v_and_b32 v18, 3, v0
    v_lshrrev_b32 v6, 5, v0
    v_lshl_add_u32 v18, v6, 2, v18
    v_mul_u32_u24 v18, 10240, v18
    v_bfe_u32 v6, v0, 3, 2
    v_lshl_add_u32 v18, v6, 4, v18
    v_and_b32 v6, 0xffffff7f, v5
    v_bfe_u32 v26, v0, 3, 1
    v_mul_u32_u24 v26, 0xaaaa, v26
    v_add_u32 v26, 0x4444, v26
    v_mov_b32 v28, 0
    v_mov_b32 v29, 0
    v_mov_b32 v30, 0
    v_mov_b32 v31, 0
    v_mov_b32 v32, 0
    v_mov_b32 v33, 0
    v_mov_b32 v34, 0
    v_mov_b32 v35, 0
WCHK:
    s_waitcnt vmcnt(0)
    v_max3_u32 v38, v88, v92, v96
    v_max_u32 v38, v38, v25
    v_cmp_eq_u32 vcc, -1, v38
    s_cbranch_vccnz AGAIN10
POLLX10:
    s_waitcnt lgkmcnt(0)
    v_max_f32_dpp v27, v24, v24 quad_perm:[1,0,3,2] row_mask:0xf bank_mask:0xf
    v_smfmac_f32_16x16x64_bf16 v[28:31], v[88:91], v[40:47], v26
    v_smfmac_f32_16x16x64_bf16 v[32:35], v[88:91], v[64:71], v26
    v_max_f32_dpp v27, v27, v27 quad_perm:[2,3,0,1] row_mask:0xf bank_mask:0xf
    v_smfmac_f32_16x16x64_bf16 v[28:31], v[92:95], v[48:55], v26
    v_smfmac_f32_16x16x64_bf16 v[32:35], v[92:95], v[72:79], v26
    v_max_f32_dpp v27, v27, v27 row_ror:4 row_mask:0xf bank_mask:0xf
    v_sub_f32 v24, v24, v27
    v_exp_f32 v24, v24
    v_smfmac_f32_16x16x64_bf16 v[28:31], v[96:99], v[56:63], v26
    v_smfmac_f32_16x16x64_bf16 v[32:35], v[96:99], v[80:87], v26
    v_mul_f32 v36, v24, v25
    s_cmp_lg_u32 s72, 0
    s_nop 0
    v_add_f32_dpp v36, v36, v36 quad_perm:[1,0,3,2] row_mask:0xf bank_mask:0xf
    s_nop 1
    v_add_f32_dpp v36, v36, v36 quad_perm:[2,3,0,1] row_mask:0xf bank_mask:0xf
    v_mul_f32_dpp v28, v24, v28 row_newbcast:0 row_mask:0xf bank_mask:0xf
    v_mul_f32_dpp v30, v24, v30 row_newbcast:2 row_mask:0xf bank_mask:0xf
    v_add_f32_dpp v36, v36, v36 row_ror:4 row_mask:0xf bank_mask:0xf
    v_mul_f32_dpp v32, v24, v32 row_newbcast:0 row_mask:0xf bank_mask:0xf
    v_mul_f32_dpp v34, v24, v34 row_newbcast:2 row_mask:0xf bank_mask:0xf
    v_rcp_f32 v36, v36
    v_fmac_f32_dpp v28, v24, v29 row_newbcast:1 row_mask:0xf bank_mask:0xf
    v_fmac_f32_dpp v30, v24, v31 row_newbcast:3 row_mask:0xf bank_mask:0xf
    v_fmac_f32_dpp v32, v24, v33 row_newbcast:1 row_mask:0xf bank_mask:0xf
    v_fmac_f32_dpp v34, v24, v35 row_newbcast:3 row_mask:0xf bank_mask:0xf
    v_add_f32 v28, v28, v30
    v_add_f32 v32, v32, v34
    s_nop 1
    v_permlane16_swap_b32 v28, v32
    v_add_f32 v37, v28, v32
    v_add_f32 v28, v28, v32
    s_nop 1
    v_permlane32_swap_b32 v28, v37
    v_add_f32 v28, v28, v37
    v_mul_f32 v28, v28, v36
    ds_write_b32 v5, v28
    s_waitcnt lgkmcnt(0)
    s_barrier
    s_cbranch_scc1 WNOT0
    ds_read2st64_b32 v[28:29], v6 offset0:0 offset1:1
    ds_read2st64_b32 v[30:31], v6 offset0:2 offset1:3
    s_waitcnt lgkmcnt(1)
    v_add_f32 v28, v28, v29
    s_waitcnt lgkmcnt(0)
    v_add_f32 v30, v30, v31
    v_add_f32 v28, v28, v30
    s_nop 1
    v_mov_b32_dpp v29, v28 row_shl:1 row_mask:0xf bank_mask:0xf
    v_cvt_pk_bf16_f32 v32, v28, v29
    s_nop 1
    v_mov_b32_dpp v28, v32 quad_perm:[0,0,0,0] row_mask:0xf bank_mask:0xf
    v_mov_b32_dpp v29, v32 quad_perm:[2,2,2,2] row_mask:0xf bank_mask:0xf
    s_nop 0
    v_mov_b32_dpp v30, v28 row_shl:4 row_mask:0xf bank_mask:0xf
    v_mov_b32_dpp v31, v29 row_shl:4 row_mask:0xf bank_mask:0xf
    s_mov_b64 exec, s[46:47]
    buffer_store_dwordx4 v[28:31], v18, s[16:19], s80 offen sc1
    s_mov_b64 exec, s[92:93]
    buffer_store_dwordx4 v[28:31], v18, s[8:11], s81 offen
    s_cmp_eq_u32 s10, 0
    s_cbranch_scc1 SLOW11
BACK11:
    s_mov_b64 exec, -1
    v_add_u32 v111, 49152, v2
    s_cmp_lg_u32 s74, 0
    s_cbranch_scc1 W2OK
    v_lshrrev_b32 v38, 2, v0
    v_mul_u32_u24 v38, 1280, v38
    v_and_b32 v39, 3, v0
    v_lshl_add_u32 v39, v39, 4, v38
    s_mul_i32 s77, s68, 245760
    s_lshl_b32 s78, s69, 6
    s_add_u32 s77, s77, s78
    s_mov_b32 m0, 106496
    s_nop 0
    buffer_load_dwordx4 v39, s[32:35], s77 offen lds
    s_add_u32 s77, s77, 20480
    s_mov_b32 m0, 107520
    s_nop 0
    buffer_load_dwordx4 v39, s[32:35], s77 offen lds
    s_add_u32 s77, s77, 20480
    s_mov_b32 m0, 108544
    s_nop 0
    buffer_load_dwordx4 v39, s[32:35], s77 offen lds
    s_add_u32 s77, s77, 20480
    s_mov_b32 m0, 109568
    s_nop 0
    buffer_load_dwordx4 v39, s[32:35], s77 offen lds
    s_add_u32 s77, s77, 20480
    s_mov_b32 m0, 110592
    s_nop 0
    buffer_load_dwordx4 v39, s[32:35], s77 offen lds
    s_add_u32 s77, s77, 20480
    s_mov_b32 m0, 111616
    s_nop 0
    buffer_load_dwordx4 v39, s[32:35], s77 offen lds
    s_add_u32 s77, s77, 20480
    s_mov_b32 m0, 112640
    s_nop 0
    buffer_load_dwordx4 v39, s[32:35], s77 offen lds
    s_add_u32 s77, s77, 20480
    s_mov_b32 m0, 113664
    s_nop 0
    buffer_load_dwordx4 v39, s[32:35], s77 offen lds
    s_add_u32 s77, s77, 20480
    s_mov_b32 m0, 114688
    s_nop 0
    buffer_load_dwordx4 v39, s[32:35], s77 offen lds
    s_add_u32 s77, s77, 20480
    s_mov_b32 m0, 115712
    s_nop 0
    buffer_load_dwordx4 v39, s[32:35], s77 offen lds
    s_add_u32 s77, s77, 20480
    s_mov_b32 m0, 116736
    s_nop 0
    buffer_load_dwordx4 v39, s[32:35], s77 offen lds
    s_add_u32 s77, s77, 20480
    s_mov_b32 m0, 117760
    s_nop 0
    buffer_load_dwordx4 v39, s[32:35], s77 offen lds
    s_add_u32 s77, s77, 20480
    s_branch W2X
W2OK:
    ds_read_b64_tr_b16 v[40:41], v111 offset:0
    ds_read_b64_tr_b16 v[42:43], v111 offset:256
    ds_read_b64_tr_b16 v[64:65], v111 offset:32
    ds_read_b64_tr_b16 v[66:67], v111 offset:288
    ds_read_b64_tr_b16 v[44:45], v111 offset:2048
    ds_read_b64_tr_b16 v[46:47], v111 offset:2304
    ds_read_b64_tr_b16 v[68:69], v111 offset:2080
    ds_read_b64_tr_b16 v[70:71], v111 offset:2336
    ds_read_b64_tr_b16 v[48:49], v111 offset:4096
    ds_read_b64_tr_b16 v[50:51], v111 offset:4352
    ds_read_b64_tr_b16 v[72:73], v111 offset:4128
    ds_read_b64_tr_b16 v[74:75], v111 offset:4384
    ds_read_b64_tr_b16 v[52:53], v111 offset:6144
    ds_read_b64_tr_b16 v[54:55], v111 offset:6400
    ds_read_b64_tr_b16 v[76:77], v111 offset:6176
    ds_read_b64_tr_b16 v[78:79], v111 offset:6432
    ds_read_b64_tr_b16 v[56:57], v111 offset:8192
    ds_read_b64_tr_b16 v[58:59], v111 offset:8448
    ds_read_b64_tr_b16 v[80:81], v111 offset:8224
    ds_read_b64_tr_b16 v[82:83], v111 offset:8480
    ds_read_b64_tr_b16 v[60:61], v111 offset:10240
    ds_read_b64_tr_b16 v[62:63], v111 offset:10496
    ds_read_b64_tr_b16 v[84:85], v111 offset:10272
    ds_read_b64_tr_b16 v[86:87], v111 offset:10528
W2X:
    v_mov_b32 v100, 0
    v_mov_b32 v101, 0
    v_mov_b32 v104, 0
    v_mov_b32 v105, 0
    s_add_u32 s96, s80, 81920
    s_add_u32 s97, s81, 1280
STB:
    s_mul_i32 s77, s72, 48
    v_min_u32 v6, 47, v0
    v_add_u32 v6, s77, v6
    v_lshlrev_b32 v4, 4, v6
    v_add_u32 v108, 7168, v4
    v_lshlrev_b32 v4, 2, v6
    v_cmp_le_u32 vcc, 48, v0
    v_mov_b32 v24, 768
    s_nop 0
    v_cndmask_b32 v4, v4, v24, vcc
    v_add_u32 v5, 3584, v4
    v_lshrrev_b32 v24, 4, v6
    v_lshlrev_b32 v24, 5, v24
    v_bfe_u32 v25, v6, 1, 1
    v_lshl_add_u32 v24, v25, 4, v24
    v_bfe_u32 v25, v6, 2, 2
    v_lshl_add_u32 v24, v25, 2, v24
    v_and_b32 v25, 1, v6
    v_lshl_add_u32 v24, v25, 1, v24
    v_add_u32 v24, 118784, v24
    v_mov_b32 v25, 119168
    v_cndmask_b32 v6, v24, v25, vcc
    v_mov_b32 v109, 0x3727c5ac
    v_mov_b32 v110, 0x3acccccd
    s_add_u32 s79, s3, 50432
    v_accvgpr_read_b32 v2, a250
    v_accvgpr_read_b32 v3, a251
    s_add_u32 s6, s74, s72
    s_mov_b32 s76, 1
    s_cmp_eq_u32 s74, 0
    s_cbranch_scc1 GPF
GPO:
    s_cmp_eq_u32 s72, 1
    s_cbranch_scc1 WOWN
GP1:
    buffer_load_dword v24, v4, s[16:19], s79 offen offset:0 sc1
    buffer_load_dword v28, v5, s[16:19], s79 offen offset:0 sc1
    buffer_load_dword v25, v4, s[16:19], s79 offen offset:896 sc1
    buffer_load_dword v29, v5, s[16:19], s79 offen offset:896 sc1
    buffer_load_dword v26, v4, s[16:19], s79 offen offset:1792 sc1
    buffer_load_dword v30, v5, s[16:19], s79 offen offset:1792 sc1
    buffer_load_dword v27, v4, s[16:19], s79 offen offset:2688 sc1
    buffer_load_dword v31, v5, s[16:19], s79 offen offset:2688 sc1
    s_waitcnt vmcnt(0)
    v_add_f32 v24, v24, v25
    v_add_f32 v28, v28, v29
    v_add_f32 v26, v26, v27
    v_add_f32 v30, v30, v31
    v_add_f32 v28, v28, v30
    v_add_f32 v24, v24, v26
    v_cmp_u_f32 vcc, v24, v28
    s_cbranch_vccnz GA1
GPX:
    v_readlane_b32 s77, v28, 48
    v_readlane_b32 s78, v24, 48
    s_cmp_lg_u32 s6, 1
    s_cbranch_scc0 OWL
OWB:
    v_mul_f32 v25, s77, v110
    v_fma_f32 v26, s78, v110, v109
    v_fma_f32 v26, -v25, v25, v26
    v_add_f32 v25, 1.0, v25
    v_max_f32 v26, v26, v109
    v_fma_f32 v24, -v25, v2, v24
    v_rsq_f32 v27, v26
    v_mul_f32 v29, 0xbfb8aa3b, v24
    v_mul_f32 v29, v29, v27
    v_exp_f32 v29, v29
    v_fma_f32 v28, -v25, v3, v28
    v_fma_f32 v29, v29, v26, v26
    v_rcp_f32 v29, v29
    v_mul_f32 v28, v28, v24
    v_mul_f32 v28, v28, v29
    v_cvt_pk_bf16_f32 v28, v28, v28
    ds_write_b16 v6, v28
    v_accvgpr_write_b32 a250, v2
    v_accvgpr_write_b32 a251, v3
    s_cmp_lg_u32 s72, 0
    s_waitcnt lgkmcnt(0)
    s_barrier
    s_cbranch_scc1 STBX
    ds_read_b128 v[88:91], v13 offset:0
    ds_read_b128 v[92:95], v13 offset:128
    ds_read_b128 v[96:99], v13 offset:256
    s_waitcnt lgkmcnt(2)
    v_smfmac_f32_16x16x64_bf16 v[100:103], v[88:91], v[40:47], v14
    v_smfmac_f32_16x16x64_bf16 v[104:107], v[88:91], v[64:71], v14
    s_waitcnt lgkmcnt(1)
    v_smfmac_f32_16x16x64_bf16 v[100:103], v[92:95], v[48:55], v14
    v_smfmac_f32_16x16x64_bf16 v[104:107], v[92:95], v[72:79], v14
    s_waitcnt lgkmcnt(0)
    v_smfmac_f32_16x16x64_bf16 v[100:103], v[96:99], v[56:63], v14
    v_smfmac_f32_16x16x64_bf16 v[104:107], v[96:99], v[80:87], v14
    s_nop 6
    v_add_f32 v28, v100, v101
    s_nop 1
    v_add_f32_dpp v28, v104, v105 quad_perm:[0,1,2,3] row_mask:0xa bank_mask:0xf
    s_nop 1
    v_mov_b32_dpp v29, v28 row_shl:1 row_mask:0xf bank_mask:0xf
    v_cvt_pk_bf16_f32 v32, v28, v29
    s_nop 1
    v_mov_b32_dpp v28, v32 quad_perm:[0,0,0,0] row_mask:0xf bank_mask:0xf
    v_mov_b32_dpp v29, v32 quad_perm:[2,2,2,2] row_mask:0xf bank_mask:0xf
    s_nop 0
    v_mov_b32_dpp v30, v28 row_shl:4 row_mask:0xf bank_mask:0xf
    v_mov_b32_dpp v31, v29 row_shl:4 row_mask:0xf bank_mask:0xf
    s_mov_b64 exec, s[48:49]
    buffer_store_dwordx4 v[28:31], v18, s[16:19], s96 offen sc1
    s_mov_b64 exec, s[92:93]
    buffer_store_dwordx4 v[28:31], v18, s[8:11], s97 offen
    s_cmp_eq_u32 s10, 0
    s_cbranch_scc1 SLOW12
BACK12:
    s_mov_b64 exec, -1
    s_branch NEXT
AGAIN3:
    s_add_u32 s76, s76, 1
    s_cmp_lt_u32 s76, 32768
    s_cbranch_scc1 POLL3
    s_branch POLLX3
BR4:
    s_cmp_ge_u32 s76, 32768
    s_cbranch_scc1 BX4
    s_mov_b64 exec, vcc
    buffer_load_dwordx4 v[80:83], v8, s[16:19], 0 offen sc1
    s_add_u32 s76, s76, 1
    s_waitcnt vmcnt(0)
    s_branch BW4
AGAIN6:
    s_add_u32 s76, s76, 1
    s_cmp_lt_u32 s76, 32768
    s_cbranch_scc1 POLL6
    s_branch POLLX6
OML:
    v_mul_f32 v35, v32, v33
    s_nop 1
    v_add_f32_dpp v35, v35, v35 quad_perm:[1,0,3,2] row_mask:0xf bank_mask:0xf
    s_nop 1
    v_add_f32_dpp v35, v35, v35 quad_perm:[2,3,0,1] row_mask:0xf bank_mask:0xf
    s_mov_b64 exec, 1
    buffer_store_dwordx2 v[34:35], v1, s[8:11], s78 offen
    s_cmp_eq_u32 s10, 0
    s_cbranch_scc1 SLOW13
BACK13:
    s_mov_b64 exec, -1
    s_waitcnt lgkmcnt(0)
    s_branch ODONE
WLATE:
    v_lshrrev_b32 v38, 2, v0
    v_mul_u32_u24 v38, 1280, v38
    v_and_b32 v39, 3, v0
    v_lshl_add_u32 v39, v39, 4, v38
    s_mov_b32 m0, s67
    s_add_u32 s67, s67, 1024
    buffer_load_dwordx4 v39, s[24:27], s66 offen  lds
    s_add_u32 s66, s66, 20480
    s_mov_b32 m0, s67
    s_add_u32 s67, s67, 1024
    buffer_load_dwordx4 v39, s[24:27], s66 offen  lds
    s_add_u32 s66, s66, 20480
    s_mov_b32 m0, s67
    s_add_u32 s67, s67, 1024
    buffer_load_dwordx4 v39, s[24:27], s66 offen  lds
    s_add_u32 s66, s66, 20480
    s_mov_b32 m0, s67
    s_add_u32 s67, s67, 1024
    buffer_load_dwordx4 v39, s[24:27], s66 offen  lds
    s_add_u32 s66, s66, 20480
    s_mov_b32 m0, s67
    s_add_u32 s67, s67, 1024
    buffer_load_dwordx4 v39, s[24:27], s66 offen  lds
    s_add_u32 s66, s66, 20480
    s_mov_b32 m0, s67
    s_add_u32 s67, s67, 1024
    buffer_load_dwordx4 v39, s[24:27], s66 offen  lds
    s_add_u32 s66, s66, 20480
    v_accvgpr_read_b32 v2, a246
    v_accvgpr_read_b32 v3, a247
    v_accvgpr_read_b32 v4, a248
    buffer_load_dwordx2 v[24:25], v4, s[16:19], s3 offen sc1
    buffer_load_dwordx4 v[88:91], v3, s[16:19], s3 offen offset:0 sc1
    buffer_load_dwordx4 v[92:95], v3, s[16:19], s3 offen offset:1024 sc1
    buffer_load_dwordx4 v[96:99], v3, s[16:19], s3 offen offset:2048 sc1
    s_add_u32 s77, s3, 1638400
    buffer_store_dword v7, v10, s[8:11], s77 offen
    s_cmp_eq_u32 s10, 0
    s_cbranch_scc1 SLOW14
BACK14:
    v_accvgpr_read_b32 v5, a249
    v_and_b32 v18, 3, v0
    v_lshrrev_b32 v6, 5, v0
    v_lshl_add_u32 v18, v6, 2, v18
    v_mul_u32_u24 v18, 10240, v18
    v_bfe_u32 v6, v0, 3, 2
    v_lshl_add_u32 v18, v6, 4, v18
    v_and_b32 v6, 0xffffff7f, v5
    v_bfe_u32 v26, v0, 3, 1
    v_mul_u32_u24 v26, 0xaaaa, v26
    v_add_u32 v26, 0x4444, v26
    v_mov_b32 v28, 0
    v_mov_b32 v29, 0
    v_mov_b32 v30, 0
    v_mov_b32 v31, 0
    v_mov_b32 v32, 0
    v_mov_b32 v33, 0
    v_mov_b32 v34, 0
    v_mov_b32 v35, 0
    s_waitcnt vmcnt(11)
    ds_read_b64_tr_b16 v[40:41], v2 offset:0
    ds_read_b64_tr_b16 v[42:43], v2 offset:256
    ds_read_b64_tr_b16 v[64:65], v2 offset:32
    ds_read_b64_tr_b16 v[66:67], v2 offset:288
    ds_read_b64_tr_b16 v[44:45], v2 offset:2048
    ds_read_b64_tr_b16 v[46:47], v2 offset:2304
    ds_read_b64_tr_b16 v[68:69], v2 offset:2080
    ds_read_b64_tr_b16 v[70:71], v2 offset:2336
    ds_read_b64_tr_b16 v[48:49], v2 offset:4096
    ds_read_b64_tr_b16 v[50:51], v2 offset:4352
    ds_read_b64_tr_b16 v[72:73], v2 offset:4128
    ds_read_b64_tr_b16 v[74:75], v2 offset:4384
    s_waitcnt vmcnt(5)
    ds_read_b64_tr_b16 v[52:53], v2 offset:6144
    ds_read_b64_tr_b16 v[54:55], v2 offset:6400
    ds_read_b64_tr_b16 v[76:77], v2 offset:6176
    ds_read_b64_tr_b16 v[78:79], v2 offset:6432
    ds_read_b64_tr_b16 v[56:57], v2 offset:8192
    ds_read_b64_tr_b16 v[58:59], v2 offset:8448
    ds_read_b64_tr_b16 v[80:81], v2 offset:8224
    ds_read_b64_tr_b16 v[82:83], v2 offset:8480
    ds_read_b64_tr_b16 v[60:61], v2 offset:10240
    ds_read_b64_tr_b16 v[62:63], v2 offset:10496
    ds_read_b64_tr_b16 v[84:85], v2 offset:10272
    ds_read_b64_tr_b16 v[86:87], v2 offset:10528
    s_branch WCHK
AGAIN10:
    s_mov_b64 s[94:95], exec
    s_mov_b32 s76, 1
AG210:
    s_mov_b64 exec, vcc
    buffer_load_dwordx2 v[24:25], v4, s[16:19], s3 offen sc1
    buffer_load_dwordx4 v[88:91], v3, s[16:19], s3 offen offset:0 sc1
    buffer_load_dwordx4 v[92:95], v3, s[16:19], s3 offen offset:1024 sc1
    buffer_load_dwordx4 v[96:99], v3, s[16:19], s3 offen offset:2048 sc1
AG310_0:
    s_mov_b64 exec, s[94:95]
    s_add_u32 s76, s76, 1
    s_cmp_ge_u32 s76, 32768
    s_waitcnt vmcnt(0)
    v_max3_u32 v38, v88, v92, v96
    v_max_u32 v38, v38, v25
    v_cmp_eq_u32 vcc, -1, v38
    s_cbranch_vccz POLLX10
    s_cbranch_scc0 AG210
    s_branch POLLX10
GA1:
    s_add_u32 s76, s76, 1
    s_cmp_lt_u32 s76, 32768
    s_cbranch_scc1 GP1
    s_branch GPX
GPF:
    s_cmp_lg_u32 s72, 0
    s_cbranch_scc1 GP0
    buffer_load_dwordx4 v[32:35], v108, s[16:19], s79 offen sc1
    buffer_load_dwordx4 v[36:39], v108, s[16:19], s79 offen offset:3072 sc1
    s_waitcnt vmcnt(2)
    ds_read_b64_tr_b16 v[40:41], v111 offset:0
    ds_read_b64_tr_b16 v[42:43], v111 offset:256
    ds_read_b64_tr_b16 v[64:65], v111 offset:32
    ds_read_b64_tr_b16 v[66:67], v111 offset:288
    ds_read_b64_tr_b16 v[44:45], v111 offset:2048
    ds_read_b64_tr_b16 v[46:47], v111 offset:2304
    ds_read_b64_tr_b16 v[68:69], v111 offset:2080
    ds_read_b64_tr_b16 v[70:71], v111 offset:2336
    ds_read_b64_tr_b16 v[48:49], v111 offset:4096
    ds_read_b64_tr_b16 v[50:51], v111 offset:4352
    ds_read_b64_tr_b16 v[72:73], v111 offset:4128
    ds_read_b64_tr_b16 v[74:75], v111 offset:4384
    ds_read_b64_tr_b16 v[52:53], v111 offset:6144
    ds_read_b64_tr_b16 v[54:55], v111 offset:6400
    ds_read_b64_tr_b16 v[76:77], v111 offset:6176
    ds_read_b64_tr_b16 v[78:79], v111 offset:6432
    ds_read_b64_tr_b16 v[56:57], v111 offset:8192
    ds_read_b64_tr_b16 v[58:59], v111 offset:8448
    ds_read_b64_tr_b16 v[80:81], v111 offset:8224
    ds_read_b64_tr_b16 v[82:83], v111 offset:8480
    ds_read_b64_tr_b16 v[60:61], v111 offset:10240
    ds_read_b64_tr_b16 v[62:63], v111 offset:10496
    ds_read_b64_tr_b16 v[84:85], v111 offset:10272
    ds_read_b64_tr_b16 v[86:87], v111 offset:10528
    s_branch GPW
GP0:
    buffer_load_dwordx4 v[32:35], v108, s[16:19], s79 offen sc1
    buffer_load_dwordx4 v[36:39], v108, s[16:19], s79 offen offset:3072 sc1
GPW:
    s_add_u32 s76, s76, 1
    s_cmp_ge_u32 s76, 32768
    s_waitcnt vmcnt(0)
    v_add_f32 v2, v32, v33
    v_add_f32 v3, v36, v37
    v_add_f32 v34, v34, v35
    v_add_f32 v38, v38, v39
    v_add_f32 v2, v2, v34
    v_add_f32 v3, v3, v38
    v_cmp_u_f32 vcc, v2, v3
    s_cbranch_scc1 GPO
    s_cbranch_vccnz GP0
    s_branch GPO
OWL:
    buffer_load_dword v34, v37, s[16:19], 0 offen sc1
    buffer_load_dword v35, v38, s[16:19], 0 offen sc1
    s_branch OWB
WNOT0:
    s_cmp_lg_u32 s74, 0
    s_cbranch_scc1 STB
    s_cmp_eq_u32 s72, 1
    s_cbranch_scc1 WPREP
    s_cmp_eq_u32 s72, 3
    s_cbranch_scc1 WLC
    v_mov_b32 v52, -1
    v_mov_b32 v53, -1
    v_mov_b32 v54, -1
    v_mov_b32 v55, -1
    s_add_u32 s77, s80, 819200
    s_add_u32 s7, s77, 81920
    s_sleep 8
    s_mov_b64 exec, s[44:45]
    buffer_store_dwordx4 v[52:55], v18, s[16:19], s77 offen sc1
    s_mov_b64 exec, s[92:93]
    buffer_store_dwordx4 v[52:55], v18, s[16:19], s7 offen sc1
    s_mov_b64 exec, -1
    s_branch WPREP
WLC:
    s_mul_i32 s77, s69, 1248
    s_add_u32 s78, s3, 851968
    v_add_u32 v100, s77, v1
    v_min_u32 v100, 24816, v100
    s_add_u32 s77, s77, 1024
    v_add_u32 v101, s77, v1
    v_min_u32 v101, 24816, v101
    s_add_u32 s77, s77, 1024
    v_mov_b32 v104, -1
    v_mov_b32 v105, -1
    v_mov_b32 v106, -1
    v_mov_b32 v107, -1
    ds_read_b64_tr_b16 v[40:41], v16 offset:0
    ds_read_b64_tr_b16 v[42:43], v16 offset:1536
    ds_read_b64_tr_b16 v[44:45], v16 offset:12288
    ds_read_b64_tr_b16 v[46:47], v16 offset:13824
    ds_read_b64_tr_b16 v[48:49], v17 offset:24576
    ds_read_b64_tr_b16 v[50:51], v16 offset:32
    ds_read_b64_tr_b16 v[52:53], v16 offset:1568
    ds_read_b64_tr_b16 v[54:55], v16 offset:12320
    ds_read_b64_tr_b16 v[56:57], v16 offset:13856
    ds_read_b64_tr_b16 v[58:59], v17 offset:24608
    ds_read_b64_tr_b16 v[60:61], v16 offset:64
    ds_read_b64_tr_b16 v[62:63], v16 offset:1600
    ds_read_b64_tr_b16 v[64:65], v16 offset:12352
    ds_read_b64_tr_b16 v[66:67], v16 offset:13888
    ds_read_b64_tr_b16 v[68:69], v17 offset:24640
    v_and_b32 v25, 15, v0
    v_cmp_eq_u32 vcc, 12, v25
    v_mov_b32 v36, 0x3f803f80
    s_nop 0
    v_cndmask_b32 v70, 0, v36, vcc
    v_mov_b32 v71, v70
    v_mov_b32 v72, v70
    v_mov_b32 v73, v70
    v_mov_b32 v74, v70
    v_mov_b32 v75, v70
    v_mov_b32 v76, v70
    v_mov_b32 v77, v70
    v_mov_b32 v78, v70
    v_mov_b32 v79, v70
    s_mov_b32 s77, 4096
    v_mul_u32_u24 v96, 103, v0
    v_lshrrev_b32 v96, 10, v96
    v_lshl_add_u32 v96, v96, 4, v1
    v_add_u32 v96, s77, v96
    v_mul_u32_u24 v97, 176, v25
    v_add_u32 v97, s77, v97
    v_lshrrev_b32 v28, 4, v0
    v_lshl_add_u32 v98, v28, 3, v97
    v_lshl_add_u32 v97, v28, 4, v97
    buffer_store_dwordx4 v[104:107], v100, s[8:11], s78 offen
    s_cmp_eq_u32 s10, 0
    s_cbranch_scc1 SLOW15
BACK15:
    buffer_store_dwordx4 v[104:107], v101, s[8:11], s78 offen
    s_cmp_eq_u32 s10, 0
    s_cbranch_scc1 SLOW16
BACK16:
    s_branch STB
WPREP:
    s_nop 1
    ds_read_b64_tr_b16 v[40:41], v16 offset:0
    ds_read_b64_tr_b16 v[42:43], v16 offset:1536
    ds_read_b64_tr_b16 v[44:45], v16 offset:12288
    ds_read_b64_tr_b16 v[46:47], v16 offset:13824
    ds_read_b64_tr_b16 v[48:49], v17 offset:24576
    ds_read_b64_tr_b16 v[50:51], v16 offset:32
    ds_read_b64_tr_b16 v[52:53], v16 offset:1568
    ds_read_b64_tr_b16 v[54:55], v16 offset:12320
    ds_read_b64_tr_b16 v[56:57], v16 offset:13856
    ds_read_b64_tr_b16 v[58:59], v17 offset:24608
    ds_read_b64_tr_b16 v[60:61], v16 offset:64
    ds_read_b64_tr_b16 v[62:63], v16 offset:1600
    ds_read_b64_tr_b16 v[64:65], v16 offset:12352
    ds_read_b64_tr_b16 v[66:67], v16 offset:13888
    ds_read_b64_tr_b16 v[68:69], v17 offset:24640
    v_and_b32 v25, 15, v0
    v_cmp_eq_u32 vcc, 12, v25
    v_mov_b32 v36, 0x3f803f80
    s_nop 0
    v_cndmask_b32 v70, 0, v36, vcc
    v_mov_b32 v71, v70
    v_mov_b32 v72, v70
    v_mov_b32 v73, v70
    v_mov_b32 v74, v70
    v_mov_b32 v75, v70
    v_mov_b32 v76, v70
    v_mov_b32 v77, v70
    v_mov_b32 v78, v70
    v_mov_b32 v79, v70
    s_mov_b32 s77, 4096
    v_mul_u32_u24 v96, 103, v0
    v_lshrrev_b32 v96, 10, v96
    v_lshl_add_u32 v96, v96, 4, v1
    v_add_u32 v96, s77, v96
    v_mul_u32_u24 v97, 176, v25
    v_add_u32 v97, s77, v97
    v_lshrrev_b32 v28, 4, v0
    v_lshl_add_u32 v98, v28, 3, v97
    v_lshl_add_u32 v97, v28, 4, v97
    s_branch STB
WOWN:
    v_and_b32 v25, 15, v0
    v_lshrrev_b32 v26, 4, v0
    s_mul_i32 s7, s68, 10240
    s_cmp_eq_u32 s74, 0
    s_cselect_b32 s7, 0, s7
    s_add_u32 s7, s7, 655360
    v_mul_u32_u24 v37, 1280, v26
    v_add_u32 v37, s7, v37
    s_mul_i32 s7, s68, 81920
    s_add_u32 s7, s7, 45312
    v_mov_b32 v38, s7
    v_cmp_eq_u32 vcc, s68, v26
    s_nop 1
    v_cndmask_b32 v37, v37, v38, vcc
    v_add_u32 v39, 4, v26
    s_mul_i32 s7, s68, 10240
    s_cmp_eq_u32 s74, 0
    s_cselect_b32 s7, 0, s7
    s_add_u32 s7, s7, 655360
    v_mul_u32_u24 v38, 1280, v39
    v_add_u32 v38, s7, v38
    s_mul_i32 s7, s68, 81920
    s_add_u32 s7, s7, 45312
    v_mov_b32 v28, s7
    v_cmp_eq_u32 vcc, s68, v39
    s_nop 1
    v_cndmask_b32 v38, v38, v28, vcc
    s_lshl_b32 s77, s69, 6
    s_add_u32 s77, s77, s74
    v_lshl_add_u32 v25, v25, 2, s77
    v_add_u32 v37, v25, v37
    v_add_u32 v38, v25, v38
    s_cmp_eq_u32 s74, 0
    s_cbranch_scc1 GP1
    s_sleep 9
    s_mov_b32 s76, 1
POLL17:
    buffer_load_dword v28, v37, s[16:19], 0 offen sc1
    buffer_load_dword v29, v38, s[16:19], 0 offen sc1
POLLW17:
    s_waitcnt vmcnt(0)
    v_max_u32 v30, v28, v29
    v_cmp_eq_u32 vcc, -1, v30
    s_cbranch_vccnz AGAIN17
POLLX17:
    v_lshlrev_b32 v30, 16, v28
    v_and_b32 v28, 0xffff0000, v28
    v_lshlrev_b32 v31, 16, v29
    v_and_b32 v29, 0xffff0000, v29
    v_add_f32 v30, v30, v31
    v_add_f32 v28, v28, v29
    v_mov_b32 v31, v30
    v_mov_b32 v29, v28
    s_nop 0
    v_permlane32_swap_b32 v30, v31
    v_permlane32_swap_b32 v28, v29
    v_add_f32 v30, v30, v31
    v_add_f32 v28, v28, v29
    v_mov_b32 v31, v30
    v_mov_b32 v29, v28
    s_nop 0
    v_permlane16_swap_b32 v30, v31
    v_permlane16_swap_b32 v28, v29
    v_add_f32 v30, v30, v31
    v_add_f32 v28, v28, v29
    v_add_f32 v22, v22, v30
    v_add_f32 v23, v23, v28
    v_cvt_pk_bf16_f32 v28, v22, v23
    s_branch GP1
STBX:
    s_cmp_lg_u32 s72, 1
    s_cbranch_scc1 NEXT
    s_cmp_lg_u32 s74, 0
    s_cbranch_scc1 FINAL
    s_waitcnt vmcnt(0)
    v_mov_b32 v28, v34
    v_mov_b32 v29, v35
    v_max_u32 v30, v28, v29
    v_cmp_eq_u32 vcc, -1, v30
    s_cbranch_vccnz RETRY18
OK18:
    v_lshlrev_b32 v30, 16, v28
    v_and_b32 v28, 0xffff0000, v28
    v_lshlrev_b32 v31, 16, v29
    v_and_b32 v29, 0xffff0000, v29
    v_add_f32 v30, v30, v31
    v_add_f32 v28, v28, v29
    v_mov_b32 v31, v30
    v_mov_b32 v29, v28
    s_nop 0
    v_permlane32_swap_b32 v30, v31
    v_permlane32_swap_b32 v28, v29
    v_add_f32 v30, v30, v31
    v_add_f32 v28, v28, v29
    v_mov_b32 v31, v30
    v_mov_b32 v29, v28
    s_nop 0
    v_permlane16_swap_b32 v30, v31
    v_permlane16_swap_b32 v28, v29
    v_add_f32 v30, v30, v31
    v_add_f32 v28, v28, v29
    v_add_f32 v22, v22, v30
    v_add_f32 v23, v23, v28
    v_cvt_pk_bf16_f32 v28, v22, v23
    s_lshl_b32 s77, s69, 6
    s_add_u32 s77, s77, s3
    s_add_u32 s77, s77, 49152
    v_lshlrev_b32 v32, 2, v0
    v_mov_b32_dpp v29, v28 quad_perm:[1,1,1,1] row_mask:0xf bank_mask:0xf
    v_mov_b32_dpp v30, v28 quad_perm:[2,2,2,2] row_mask:0xf bank_mask:0xf
    v_mov_b32_dpp v31, v28 quad_perm:[3,3,3,3] row_mask:0xf bank_mask:0xf
    s_mov_b32 exec_lo, 0x1111
    s_mov_b32 exec_hi, 0x0
    buffer_store_dwordx4 v[28:31], v32, s[8:11], s77 offen
    s_cmp_eq_u32 s10, 0
    s_cbranch_scc1 SLOW19
BACK19:
    s_mov_b64 exec, -1
    s_branch NEXT
FINAL:
    s_cmp_lg_u32 s68, 0
    s_cbranch_scc1 DONE
    s_lshl_b32 s77, s69, 6
    v_lshlrev_b32 v37, 2, v0
    s_add_u32 s79, s77, s3
    s_add_u32 s79, s79, 46592
    s_mov_b64 exec, 15
    s_mov_b32 s76, 1
POLL20:
    buffer_load_dword v28, v1, s[16:19], s79 offen sc1
POLLW20:
    s_waitcnt vmcnt(0)
    v_cmp_eq_u32 vcc, -1, v28
    s_cbranch_vccnz AGAIN20
POLLX20:
    s_mov_b64 exec, -1
    s_mov_b32 s76, 1
POLL21:
    buffer_load_dword v28, v20, s[16:19], s74 offen sc1
    buffer_load_dword v29, v21, s[16:19], s74 offen sc1
POLLW21:
    s_waitcnt vmcnt(0)
    v_max_u32 v30, v28, v29
    v_cmp_eq_u32 vcc, -1, v30
    s_cbranch_vccnz AGAIN21
POLLX21:
    v_lshlrev_b32 v30, 16, v28
    v_and_b32 v28, 0xffff0000, v28
    v_lshlrev_b32 v31, 16, v29
    v_and_b32 v29, 0xffff0000, v29
    v_add_f32 v30, v30, v31
    v_add_f32 v28, v28, v29
    v_mov_b32 v31, v30
    v_mov_b32 v29, v28
    s_nop 0
    v_permlane32_swap_b32 v30, v31
    v_permlane32_swap_b32 v28, v29
    v_add_f32 v30, v30, v31
    v_add_f32 v28, v28, v29
    v_mov_b32 v31, v30
    v_mov_b32 v29, v28
    s_nop 0
    v_permlane16_swap_b32 v30, v31
    v_permlane16_swap_b32 v28, v29
    v_add_f32 v30, v30, v31
    v_add_f32 v28, v28, v29
    v_add_f32 v22, v22, v30
    v_add_f32 v23, v23, v28
    v_cvt_pk_bf16_f32 v28, v22, v23
    s_mov_b32 exec_lo, 0xffff
    s_mov_b32 exec_hi, 0x0
    buffer_store_dword v28, v37, s[40:43], s77 offen
    s_mov_b64 exec, -1
    s_endpgm
AGAIN17:
    s_sleep 2
    s_add_u32 s76, s76, 1
    s_cmp_lt_u32 s76, 32768
    s_cbranch_scc1 POLL17
    s_branch POLLX17
AGAIN20:
    s_add_u32 s76, s76, 1
    s_cmp_lt_u32 s76, 32768
    s_cbranch_scc1 POLL20
    s_branch POLLX20
AGAIN21:
    s_add_u32 s76, s76, 1
    s_cmp_lt_u32 s76, 32768
    s_cbranch_scc1 POLL21
    s_branch POLLX21
ROLEF:
    v_and_b32 v25, 15, v0
    v_lshrrev_b32 v26, 4, v0
    v_bfe_u32 v27, v0, 2, 2
    v_and_b32 v36, 3, v0
    s_cmp_lg_u32 s74, 0
    s_cbranch_scc1 FW
    v_lshrrev_b32 v38, 3, v0
    v_mul_u32_u24 v38, 3072, v38
    v_and_b32 v39, 7, v0
    v_lshl_add_u32 v38, v39, 4, v38
    v_bfe_u32 v39, v0, 4, 1
    v_lshlrev_b32 v39, 5, v39
    v_xor_b32 v38, v38, v39
    v_xor_b32 v39, 64, v38
    s_mov_b32 m0, s67
    s_add_u32 s67, s67, 1024
    buffer_load_dwordx4 v38, s[36:39], s66 offen nt lds
    s_add_u32 s66, s66, 24576
    s_mov_b32 m0, s67
    s_add_u32 s67, s67, 1024
    buffer_load_dwordx4 v39, s[36:39], s66 offen nt lds
    s_add_u32 s66, s66, 24576
    s_mov_b32 m0, s67
    s_add_u32 s67, s67, 1024
    buffer_load_dwordx4 v38, s[36:39], s66 offen nt lds
    s_add_u32 s66, s66, 24576
    s_mov_b32 m0, s67
    s_add_u32 s67, s67, 1024
    buffer_load_dwordx4 v39, s[36:39], s66 offen nt lds
    s_add_u32 s66, s66, 24576
    s_mov_b32 m0, s67
    s_add_u32 s67, s67, 1024
    buffer_load_dwordx4 v38, s[36:39], s66 offen nt lds
    s_add_u32 s66, s66, 24576
    s_mov_b32 m0, s67
    s_add_u32 s67, s67, 1024
    buffer_load_dwordx4 v39, s[36:39], s66 offen nt lds
    s_add_u32 s66, s66, 24576
    s_mov_b32 m0, s67
    s_add_u32 s67, s67, 1024
    buffer_load_dwordx4 v38, s[36:39], s66 offen nt lds
    s_add_u32 s66, s66, 24576
    s_mov_b32 m0, s67
    s_add_u32 s67, s67, 1024
    buffer_load_dwordx4 v39, s[36:39], s66 offen nt lds
    s_add_u32 s66, s66, 24576
    s_mov_b32 m0, s67
    s_add_u32 s67, s67, 1024
    buffer_load_dwordx4 v38, s[36:39], s66 offen nt lds
    s_add_u32 s66, s66, 24576
    s_mov_b32 m0, s67
    s_add_u32 s67, s67, 1024
    buffer_load_dwordx4 v39, s[36:39], s66 offen nt lds
    s_add_u32 s66, s66, 24576
    s_sub_u32 s96, s69, 20
    s_lshl_b32 s96, s96, 2
    s_add_u32 s96, s96, s72
    s_mul_i32 s96, s96, 688
    v_add_u32 v21, s96, v1
    v_min_u32 v21, 32752, v21
    s_add_u32 s97, s3, 819200
    s_add_u32 s77, s3, 1638400
    buffer_store_dword v7, v10, s[8:11], s77 offen
    s_cmp_eq_u32 s10, 0
    s_cbranch_scc1 SLOW22
BACK22:
FW:
    s_lshl_b32 s77, s72, 5
    v_lshl_add_u32 v80, v36, 3, s77
    v_lshrrev_b32 v37, 1, v27
    v_and_b32 v38, 1, v26
    v_lshl_add_u32 v37, v38, 1, v37
    v_lshlrev_b32 v37, 5, v37
    v_xor_b32 v80, v80, v37
    v_lshl_add_u32 v37, v26, 3, v27
    v_lshl_add_u32 v80, v37, 7, v80
    v_add_u32 v80, 57344, v80
    s_sub_u32 s79, s69, 20
    s_and_b32 s7, s79, 12
    s_add_u32 s7, s7, s72
    s_lshl_b32 s78, s7, 8
    v_lshl_add_u32 v83, v25, 4, s78
    v_lshrrev_b32 v84, 2, v83
    v_mov_b32 v37, 768
    v_cmp_le_u32 vcc, 2, v26
    s_nop 1
    v_cndmask_b32 v84, v84, v37, vcc
    v_and_b32 v37, 1, v26
    v_mul_u32_u24 v37, 3584, v37
    v_add_u32 v84, v84, v37
    s_cmp_eq_u32 s7, 0
    s_mov_b32 s52, -1
    s_cselect_b32 s53, 0x10001, 0
    s_and_b32 s79, s79, 3
    s_mul_i32 s78, s79, 892
    s_sub_u32 s78, 7168, s78
    v_add_u32 v83, s78, v83
    s_mul_i32 s78, s79, 896
    s_add_u32 s78, s78, s3
    s_add_u32 s78, s78, 50432
    s_mul_i32 s79, s79, 320
    v_cmp_eq_u32 vcc, 12, v25
    v_mov_b32 v38, 0x3f803f80
    s_nop 0
    v_cndmask_b32 v88, 0, v38, vcc
    v_mov_b32 v89, v88
    v_mov_b32 v90, v88
    v_mov_b32 v91, v88
    v_mov_b32 v92, v88
    v_mov_b32 v93, v88
    v_mov_b32 v94, v88
    v_mov_b32 v95, v88
    v_mov_b32 v96, v88
    v_mov_b32 v97, v88
    v_mov_b32 v98, v88
    v_mov_b32 v99, v88
    v_mov_b32 v100, v88
    v_mov_b32 v101, v88
    v_mov_b32 v102, v88
    v_mov_b32 v103, v88
    v_mov_b32 v104, v88
    v_mov_b32 v105, v88
    v_mov_b32 v106, v88
    v_mov_b32 v107, v88
    v_mul_u32_u24 v6, 336, v25
    v_lshl_add_u32 v6, v26, 4, v6
    s_mul_i32 s77, s72, 45
    v_min_u32 v27, 44, v0
    v_add_u32 v27, s77, v27
    v_mul_u32_u24 v37, 205, v27
    v_lshrrev_b32 v37, 12, v37
    v_add_u32 v87, v37, v27
    v_lshlrev_b32 v87, 4, v87
    v_mul_u32_u24 v38, 20, v37
    v_sub_u32 v27, v27, v38
    v_lshlrev_b32 v27, 4, v27
    s_mul_i32 s7, s68, 10240
    s_cmp_eq_u32 s74, 0
    s_cselect_b32 s7, 0, s7
    s_add_u32 s7, s7, 655360
    v_mul_u32_u24 v86, 1280, v37
    v_add_u32 v86, s7, v86
    s_mul_i32 s7, s68, 81920
    s_add_u32 s7, s7, 45312
    v_mov_b32 v38, s7
    v_cmp_eq_u32 vcc, s68, v37
    s_nop 1
    v_cndmask_b32 v86, v86, v38, vcc
    v_add_u32 v38, 2560, v38
    v_cmp_le_u32 vcc, 8, v37
    s_nop 1
    v_cndmask_b32 v86, v86, v38, vcc
    v_add_u32 v86, v86, v27
    s_add_u32 s77, s79, s74
    s_add_u32 s79, s79, s3
    s_add_u32 s79, s79, 45312
    s_cmp_lg_u32 s74, 0
    s_cbranch_scc1 FW1
    v_mov_b32 v24, -1
    v_mov_b32 v25, -1
    v_mov_b32 v26, -1
    v_mov_b32 v27, -1
    s_waitcnt vmcnt(0)
    buffer_store_dwordx4 v[24:27], v21, s[8:11], s97 offen
    s_cmp_eq_u32 s10, 0
    s_cbranch_scc1 SLOW23
BACK23:
    s_barrier
FW1:
    ds_read_b64_tr_b16 v[40:41], v80 offset:0
    ds_read_b64_tr_b16 v[42:43], v80 offset:512
    ds_read_b64_tr_b16 v[44:45], v80 offset:4096
    ds_read_b64_tr_b16 v[46:47], v80 offset:4608
    ds_read_b64_tr_b16 v[48:49], v80 offset:8192
    ds_read_b64_tr_b16 v[50:51], v80 offset:8704
    ds_read_b64_tr_b16 v[52:53], v80 offset:12288
    ds_read_b64_tr_b16 v[54:55], v80 offset:12800
    ds_read_b64_tr_b16 v[56:57], v80 offset:16384
    ds_read_b64_tr_b16 v[58:59], v80 offset:16896
    ds_read_b64_tr_b16 v[60:61], v80 offset:20480
    ds_read_b64_tr_b16 v[62:63], v80 offset:20992
    ds_read_b64_tr_b16 v[64:65], v80 offset:24576
    ds_read_b64_tr_b16 v[66:67], v80 offset:25088
    ds_read_b64_tr_b16 v[68:69], v80 offset:28672
    ds_read_b64_tr_b16 v[70:71], v80 offset:29184
    ds_read_b64_tr_b16 v[72:73], v80 offset:32768
    ds_read_b64_tr_b16 v[74:75], v80 offset:33280
    ds_read_b64_tr_b16 v[76:77], v80 offset:36864
    ds_read_b64_tr_b16 v[78:79], v80 offset:37376
    s_cmp_lg_u32 s74, 0
    s_cbranch_scc1 FW3
    s_waitcnt lgkmcnt(0)
    v_mfma_f32_16x16x32_bf16 v[108:111], v[88:91], v[40:43], 0
    v_mfma_f32_16x16x32_bf16 v[2:5], v[88:91], v[60:63], 0
    v_mfma_f32_16x16x32_bf16 v[108:111], v[92:95], v[44:47], v[108:111]
    v_mfma_f32_16x16x32_bf16 v[2:5], v[92:95], v[64:67], v[2:5]
    v_mfma_f32_16x16x32_bf16 v[108:111], v[96:99], v[48:51], v[108:111]
    v_mfma_f32_16x16x32_bf16 v[2:5], v[96:99], v[68:71], v[2:5]
    v_mfma_f32_16x16x32_bf16 v[108:111], v[100:103], v[52:55], v[108:111]
    v_mfma_f32_16x16x32_bf16 v[2:5], v[100:103], v[72:75], v[2:5]
    v_mfma_f32_16x16x32_bf16 v[108:111], v[104:107], v[56:59], v[108:111]
    v_mfma_f32_16x16x32_bf16 v[2:5], v[104:107], v[76:79], v[2:5]
FW3:
    s_mov_b32 exec_lo, 0xfffff
    s_mov_b32 exec_hi, 0x0
    s_mov_b32 s76, 1
POLL24:
    buffer_load_dword v36, v1, s[16:19], s79 offen sc1
POLLW24:
    s_waitcnt vmcnt(0)
    v_cmp_eq_u32 vcc, -1, v36
    s_cbranch_vccnz AGAIN24
POLLX24:
    s_mov_b64 exec, s[86:87]
    buffer_load_dwordx4 v[24:27], v86, s[16:19], s77 offen sc1
    s_cmp_eq_u32 s74, 0
    s_cbranch_scc1 CSP
    s_waitcnt vmcnt(0)
CSB:
    s_waitcnt vmcnt(2)
BW25:
    ds_write_b128 v87, v[24:27]
    v_cmp_eq_u32 vcc, -1, v24
    s_cbranch_vccnz BR25
BX25:
    s_mov_b64 exec, s[84:85]
    s_waitcnt lgkmcnt(0)
    s_barrier
    ds_read_b128 v[88:91], v6 offset:0
    ds_read_b128 v[92:95], v6 offset:64
    ds_read_b128 v[96:99], v6 offset:128
    ds_read_b128 v[100:103], v6 offset:192
    ds_read_b128 v[104:107], v6 offset:256
    s_mov_b64 exec, -1
    s_waitcnt lgkmcnt(4)
    v_mfma_f32_16x16x32_bf16 v[32:35], v[88:91], v[88:91], 0
    s_waitcnt lgkmcnt(3)
    v_mfma_f32_16x16x32_bf16 v[32:35], v[92:95], v[92:95], v[32:35]
    s_waitcnt lgkmcnt(2)
    v_mfma_f32_16x16x32_bf16 v[32:35], v[96:99], v[96:99], v[32:35]
    s_waitcnt lgkmcnt(1)
    v_mfma_f32_16x16x32_bf16 v[32:35], v[100:103], v[100:103], v[32:35]
    s_waitcnt lgkmcnt(0)
    v_mfma_f32_16x16x32_bf16 v[32:35], v[104:107], v[104:107], v[32:35]
    v_mfma_f32_16x16x32_bf16 v[24:27], v[88:91], v[40:43], 0
    v_mov_b32 v36, 0
    v_mov_b32 v37, 0
    v_mfma_f32_16x16x32_bf16 v[24:27], v[92:95], v[44:47], v[24:27]
    v_mov_b32 v38, 0
    s_nop 0
    v_mfma_f32_16x16x32_bf16 v[24:27], v[96:99], v[48:51], v[24:27]
    v_mfma_f32_16x16x32_bf16 v[24:27], v[100:103], v[52:55], v[24:27]
    v_add_f32 v32, v32, v33
    v_add_f32 v34, v34, v35
    v_mfma_f32_16x16x32_bf16 v[24:27], v[104:107], v[56:59], v[24:27]
    v_mfma_f32_16x16x32_bf16 v[28:31], v[88:91], v[60:63], 0
    v_add_f32_dpp v36, v32, v34 quad_perm:[0,1,2,3] row_mask:0xf bank_mask:0x7
    v_mfma_f32_16x16x32_bf16 v[28:31], v[92:95], v[64:67], v[28:31]
    s_nop 0
    v_add_f32_dpp v36, v36, v36 row_ror:8 row_mask:0xf bank_mask:0xf
    v_mfma_f32_16x16x32_bf16 v[28:31], v[96:99], v[68:71], v[28:31]
    s_nop 0
    v_add_f32_dpp v36, v36, v36 row_ror:4 row_mask:0xf bank_mask:0xf
    v_mfma_f32_16x16x32_bf16 v[28:31], v[100:103], v[72:75], v[28:31]
    s_nop 0
    v_add_f32_dpp v36, v36, v36 row_ror:2 row_mask:0xf bank_mask:0xf
    v_mfma_f32_16x16x32_bf16 v[28:31], v[104:107], v[76:79], v[28:31]
    v_add_f32 v25, v24, v25
    v_add_f32_dpp v37, v36, v36 row_ror:1 row_mask:0x7 bank_mask:0xf
    v_add_f32_dpp v38, v36, v36 row_ror:1 row_mask:0x8 bank_mask:0xf
    v_add_f32 v26, v26, v27
    v_add_f32 v25, v25, v26
    s_nop 1
    v_permlane32_swap_b32 v25, v37
    v_add_f32 v29, v28, v29
    v_add_f32 v30, v30, v31
    v_add_f32 v29, v29, v30
    v_add_f32 v25, v25, v37
    s_nop 0
    v_permlane32_swap_b32 v29, v38
    v_add_f32 v29, v29, v38
    s_nop 1
    v_permlane16_swap_b32 v25, v29
    s_mov_b64 exec, s[52:53]
    v_add_f32 v25, v25, v29
    buffer_store_dword v25, v84, s[8:11], s78 offen
    s_cmp_eq_u32 s10, 0
    s_cbranch_scc1 SLOW26
BACK26:
    s_mov_b64 exec, -1
NEXT:
    s_cmp_lg_u32 s74, 0
    s_cbranch_scc1 DONE
    s_mov_b32 s74, 819200
    s_add_u32 s3, s3, 819200
    s_add_u32 s80, s80, 819200
    s_add_u32 s81, s81, 819200
    s_mov_b64 s[46:47], s[44:45]
    s_mov_b64 s[48:49], s[92:93]
    s_branch LOOP
AGAIN24:
    s_add_u32 s76, s76, 1
    s_cmp_lt_u32 s76, 32768
    s_cbranch_scc1 POLL24
    s_branch POLLX24
CSP:
    s_mov_b32 exec_lo, 0x0
    s_mov_b32 exec_hi, 0xffff0000
    buffer_store_dword v108, v83, s[8:11], s78 offen
    s_cmp_eq_u32 s10, 0
    s_cbranch_scc1 SLOW27
BACK27:
    buffer_store_dword v2, v83, s[8:11], s78 offen offset:3072
    s_cmp_eq_u32 s10, 0
    s_cbranch_scc1 SLOW28
BACK28:
    s_mov_b64 exec, s[86:87]
    s_branch CSB
BR25:
    s_cmp_ge_u32 s76, 32768
    s_cbranch_scc1 BX25
    s_mov_b64 exec, vcc
    buffer_load_dwordx4 v[24:27], v86, s[16:19], s77 offen sc1
    s_add_u32 s76, s76, 1
    s_waitcnt vmcnt(0)
    s_branch BW25
DONE:
    s_endpgm
TAGLOOP:
    s_mov_b32 s76, 0
TAGL2:
    s_sleep 8
    global_load_dword v98, v100, s[64:65] sc1
    s_waitcnt vmcnt(0)
    v_readfirstlane_b32 s96, v98
    s_nop 0
    s_cmp_lg_u32 s96, 0
    s_cbranch_scc1 TAGOK
    s_add_u32 s76, s76, 1
    s_cmp_lt_u32 s76, 32768
    s_cbranch_scc1 TAGL2
    s_branch TAGOK
DMAF:
    s_sub_u32 s78, s69, 20
    s_and_b32 s66, s78, 3
    s_lshl_b32 s66, s66, 1
    s_and_b32 s79, s72, 1
    s_add_u32 s66, s66, s79
    s_mul_i32 s66, s66, 245760
    s_lshr_b32 s78, s78, 2
    s_lshl_b32 s78, s78, 7
    s_add_u32 s66, s66, s78
    s_mul_i32 s78, s68, 384
    s_add_u32 s66, s66, s78
    s_mul_i32 s67, s72, 10240
    s_add_u32 s67, s67, 57344
    s_branch DMAX
RDYLOOP:
    s_mov_b32 s76, 0
RDYL2:
    s_sleep 8
    buffer_load_dwordx2 v[98:99], v100, s[16:19], 0 offen offset:384 sc1
    s_waitcnt vmcnt(0)
    v_cmp_ne_u32 vcc, s96, v98
    s_cbranch_vccz RDYOK
    s_add_u32 s76, s76, 1
    s_cmp_lt_u32 s76, 32768
    s_cbranch_scc1 RDYL2
    s_branch RDYOK
SLOW1:
    buffer_store_dwordx4 v[28:31], v27, s[16:19], s77 offen sc1
    s_branch BACK1
SLOW2:
    buffer_store_dwordx4 v[24:27], v106, s[16:19], 0 offen sc1
    s_branch BACK2
SLOW5:
    buffer_store_dword v24, v10, s[16:19], s3 offen sc1
    s_branch BACK5
SLOW7:
    buffer_store_dwordx4 v[28:31], v26, s[16:19], s77 offen sc1
    s_branch BACK7
RETRY8:
    s_mov_b32 s76, 1
POLL29:
    buffer_load_dword v28, v20, s[16:19], 0 offen sc1
    buffer_load_dword v29, v21, s[16:19], 0 offen sc1
POLLW29:
    s_waitcnt vmcnt(0)
    v_max_u32 v30, v28, v29
    v_cmp_eq_u32 vcc, -1, v30
    s_cbranch_vccnz AGAIN29
POLLX29:
    s_branch OK8
AGAIN29:
    s_add_u32 s76, s76, 1
    s_cmp_lt_u32 s76, 32768
    s_cbranch_scc1 POLL29
    s_branch POLLX29
SLOW9:
    buffer_store_dwordx4 v[28:31], v32, s[16:19], s77 offen sc1
    s_branch BACK9
SLOW11:
    buffer_store_dwordx4 v[28:31], v18, s[16:19], s81 offen sc1
    s_branch BACK11
SLOW12:
    buffer_store_dwordx4 v[28:31], v18, s[16:19], s97 offen sc1
    s_branch BACK12
SLOW13:
    buffer_store_dwordx2 v[34:35], v1, s[16:19], s78 offen sc1
    s_branch BACK13
SLOW14:
    buffer_store_dword v7, v10, s[16:19], s77 offen sc1
    s_branch BACK14
SLOW15:
    buffer_store_dwordx4 v[104:107], v100, s[16:19], s78 offen sc1
    s_branch BACK15
SLOW16:
    buffer_store_dwordx4 v[104:107], v101, s[16:19], s78 offen sc1
    s_branch BACK16
RETRY18:
    s_mov_b32 s76, 1
POLL30:
    buffer_load_dword v28, v37, s[16:19], 0 offen sc1
    buffer_load_dword v29, v38, s[16:19], 0 offen sc1
POLLW30:
    s_waitcnt vmcnt(0)
    v_max_u32 v30, v28, v29
    v_cmp_eq_u32 vcc, -1, v30
    s_cbranch_vccnz AGAIN30
POLLX30:
    s_branch OK18
AGAIN30:
    s_add_u32 s76, s76, 1
    s_cmp_lt_u32 s76, 32768
    s_cbranch_scc1 POLL30
    s_branch POLLX30
SLOW19:
    buffer_store_dwordx4 v[28:31], v32, s[16:19], s77 offen sc1
    s_branch BACK19
SLOW22:
    buffer_store_dword v7, v10, s[16:19], s77 offen sc1
    s_branch BACK22
SLOW23:
    buffer_store_dwordx4 v[24:27], v21, s[16:19], s97 offen sc1
    s_branch BACK23
SLOW26:
    buffer_store_dword v25, v84, s[16:19], s78 offen sc1
    s_branch BACK26
SLOW27:
    buffer_store_dword v108, v83, s[16:19], s78 offen sc1
    s_branch BACK27
SLOW28:
    buffer_store_dword v2, v83, s[16:19], s78 offen offset:3072 sc1
    s_branch BACK28
CODE_END:
    s_endpgm
.section .rodata,"a"
.p2align 6
.amdhsa_kernel interleave_layers__sliding_block_cached__glu_gated_swiglu__decode_kernel
  .amdhsa_next_free_vgpr 512
  .amdhsa_next_free_sgpr 102
  .amdhsa_accum_offset 256
  .amdhsa_group_segment_fixed_size 0
  .amdhsa_kernarg_size 96
  .amdhsa_user_sgpr_count 2
  .amdhsa_user_sgpr_kernarg_segment_ptr 1
  .amdhsa_system_sgpr_workgroup_id_x 1
.end_amdhsa_kernel
```

```asm
; @launch grid=(256,1,1) block=(256,1,1) lds=125568
.amdgcn_target "amdgcn-amd-amdhsa--gfx950"
.text
.globl interleave_layers__sliding_block_cached__glu_gated_swiglu__decode_kernel
.p2align 8
.type interleave_layers__sliding_block_cached__glu_gated_swiglu__decode_kernel,@function
interleave_layers__sliding_block_cached__glu_gated_swiglu__decode_kernel:
    s_load_dwordx16 s[44:59], s[0:1], 0
    s_load_dwordx8 s[60:67], s[0:1], 64
    s_cmp_ge_u32 s2, 256
    s_cbranch_scc1 CODE_END
    s_memrealtime s[96:97]
    v_lshrrev_b32 v2, 6, v0
    v_and_b32 v24, 63, v0
    v_readfirstlane_b32 s72, v2
    s_and_b32 s68, s2, 7
    s_lshr_b32 s69, s2, 3
    s_lshr_b32 s70, s69, 3
    s_and_b32 s71, s69, 7
    v_lshlrev_b32 v1, 4, v24
    s_lshl_b32 s77, s70, 3
    s_add_u32 s77, s77, s68
    s_mul_i32 s73, s77, 12582912
    s_lshl_b32 s78, s71, 2
    s_add_u32 s78, s78, s72
    s_mul_i32 s78, s78, 6144
    s_add_u32 s73, s73, s78
    s_add_u32 s73, s73, 11010048
    v_add_u32 v23, 4096, v1
    s_mov_b32 s10, 402653184
    s_mov_b32 s11, 0x20000
    s_getpc_b64 s[100:101]
PCREF:
    s_sub_u32 s100, s100, PCREF-interleave_layers__sliding_block_cached__glu_gated_swiglu__decode_kernel
    s_subb_u32 s101, s101, 0
    s_lshl_b32 s78, s71, 12
    v_lshl_add_u32 v25, v0, 4, s78
    v_cmp_gt_u32 vcc, CODE_END-interleave_layers__sliding_block_cached__glu_gated_swiglu__decode_kernel-16, v25
    s_nop 0
    s_and_saveexec_b64 s[98:99], vcc
    s_cbranch_execz NOCPF
    global_load_dwordx4 a[240:243], v25, s[100:101]
NOCPF:
    s_mov_b64 exec, -1
    s_mul_i32 s79, s77, 384
    s_mov_b32 s74, 0
    s_mul_i32 s3, s68, 81920
    s_getreg_b32 s75, hwreg(HW_REG_XCC_ID, 0, 4)
    s_lshl_b32 s77, s69, 9
    s_add_u32 s77, s77, s3
    s_add_u32 s77, s77, 32768
    v_add_u32 v20, s77, v1
    s_lshl_b32 s77, s68, 2
    s_add_u32 s77, s77, s69
    s_mul_i32 s77, s77, 320
    s_add_u32 s77, s77, 654848
    s_add_u32 s4, s77, 1024
    v_add_u32 v25, s77, v1
    v_cmp_le_u32 vcc, 32, v0
    s_nop 1
    v_cndmask_b32 v21, v20, v25, vcc
    v_mov_b32 v25, 2147483632
    v_cndmask_b32 v20, v20, v25, vcc
    s_cmp_lt_u32 s69, 4
    s_cselect_b32 s77, 52, 32
    v_cmp_le_u32 vcc, s77, v0
    s_nop 1
    v_cndmask_b32 v21, v21, v25, vcc
    s_mov_b32 s18, 1610612736
    s_mov_b32 s19, 0x20000
    s_waitcnt lgkmcnt(0)
    s_mov_b32 s8, s46
    s_and_b32 s9, s47, 0xffff
    s_mov_b32 s16, s66
    s_and_b32 s17, s67, 0xffff
    buffer_load_dwordx4 a[0:3], v1, s[8:11], s73 offen offset:0 nt
    buffer_load_dwordx4 a[4:7], v1, s[8:11], s73 offen offset:1024 nt
    s_or_b32 s77, s2, s72
    s_cbranch_scc1 NOTAG
    s_or_b32 s77, s96, 1
    v_mov_b32 v26, s77
    s_mov_b64 exec, 1
    global_store_dword v1, v26, s[64:65] sc1
    s_mov_b64 exec, -1
NOTAG:
    s_add_u32 s83, s73, 196608
    s_mov_b32 s12, s48
    s_and_b32 s13, s49, 0xffff
    s_mov_b32 s14, 402653184
    s_mov_b32 s15, 0x20000
    s_mov_b32 s20, s50
    s_and_b32 s21, s51, 0xffff
    s_mov_b32 s22, 7864320
    s_mov_b32 s23, 0x20000
    s_mov_b32 s36, s44
    s_and_b32 s37, s45, 0xffff
    s_mov_b32 s38, 1280
    s_mov_b32 s39, 0x20000
    s_mov_b32 s40, s62
    s_and_b32 s41, s63, 0xffff
    s_mov_b32 s42, 1280
    s_mov_b32 s43, 0x20000
    s_mov_b32 s28, s58
    s_and_b32 s29, s59, 0xffff
    s_mov_b32 s30, 1966080
    s_mov_b32 s31, 0x20000
    s_mov_b32 s32, s60
    s_and_b32 s33, s61, 0xffff
    s_mov_b32 s34, 1966080
    s_mov_b32 s35, 0x20000
    s_cmp_lt_u32 s69, 20
    s_cselect_b32 s24, s52, s56
    s_cselect_b32 s25, s53, s57
    s_cselect_b32 s26, s22, s30
    s_and_b32 s25, s25, 0xffff
    s_mov_b32 s27, 0x20000
    s_add_u32 s84, s83, 196608
    s_add_u32 s85, s84, 196608
    s_add_u32 s86, s85, 196608
    s_add_u32 s87, s86, 196608
    s_add_u32 s88, s87, 196608
    s_add_u32 s89, s88, 196608
    v_mov_b32 v0, v24
    s_mul_i32 s77, s72, 6656
    v_add_u32 v25, 0, v0
    v_mul_u32_u24 v26, 171, v25
    v_lshrrev_b32 v26, 12, v26
    v_mul_u32_u24 v27, 24, v26
    v_sub_u32 v27, v25, v27
    v_lshlrev_b32 v27, 4, v27
    v_mul_u32_u24 v25, 416, v26
    v_add3_u32 v2, v25, v27, s77
    v_mul_u32_u24 v25, 12288, v26
    v_add_u32 v40, v25, v27
    v_add_u32 v25, 64, v0
    v_mul_u32_u24 v26, 171, v25
    v_lshrrev_b32 v26, 12, v26
    v_mul_u32_u24 v27, 24, v26
    v_sub_u32 v27, v25, v27
    v_lshlrev_b32 v27, 4, v27
    v_mul_u32_u24 v25, 416, v26
    v_add3_u32 v3, v25, v27, s77
    v_mul_u32_u24 v25, 12288, v26
    v_add_u32 v41, v25, v27
    v_add_u32 v25, 128, v0
    v_mul_u32_u24 v26, 171, v25
    v_lshrrev_b32 v26, 12, v26
    v_mul_u32_u24 v27, 24, v26
    v_sub_u32 v27, v25, v27
    v_lshlrev_b32 v27, 4, v27
    v_mul_u32_u24 v25, 416, v26
    v_add3_u32 v4, v25, v27, s77
    v_mul_u32_u24 v25, 12288, v26
    v_add_u32 v42, v25, v27
    v_and_b32 v25, 15, v0
    v_lshrrev_b32 v26, 4, v0
    v_bfe_u32 v27, v0, 2, 2
    v_and_b32 v28, 3, v0
    s_mul_i32 s78, s71, 160
    v_lshlrev_b32 v36, 4, v26
    v_lshlrev_b32 v37, 3, v26
    v_lshlrev_b32 v39, 2, v0
    buffer_load_dwordx4 v[70:73], v36, s[36:39], s78 offen
    buffer_load_dwordx4 v[74:77], v36, s[36:39], s78 offen offset:64
    buffer_load_dwordx2 v[78:79], v37, s[36:39], s78 offen offset:128
    buffer_load_dwordx4 v[80:83], v1, s[36:39], 0 offen
    buffer_load_dword v84, v39, s[36:39], 0 offen offset:1024
    s_lshl_b32 s7, s69, 6
    v_lshlrev_b32 v38, 2, v25
    buffer_load_dword v22, v38, s[36:39], s7 offen
    s_mul_i32 s78, s71, 983040
    s_add_u32 s79, s79, s78
    s_mul_i32 s78, s72, 98304
    s_add_u32 s79, s79, s78
    s_mul_i32 s78, s72, 3072
    s_add_u32 s78, s78, 26624
    s_add_u32 m0, s78, 0
    s_nop 0
    buffer_load_dwordx4 v40, s[20:23], s79 offen nt lds
    s_add_u32 m0, s78, 1024
    s_nop 0
    buffer_load_dwordx4 v41, s[20:23], s79 offen nt lds
    s_add_u32 m0, s78, 2048
    s_nop 0
    buffer_load_dwordx4 v42, s[20:23], s79 offen nt lds
    s_add_u32 s79, s79, 393216
    s_add_u32 m0, s78, 12288
    s_nop 0
    buffer_load_dwordx4 v40, s[20:23], s79 offen nt lds
    s_add_u32 m0, s78, 13312
    s_nop 0
    buffer_load_dwordx4 v41, s[20:23], s79 offen nt lds
    s_add_u32 m0, s78, 14336
    s_nop 0
    buffer_load_dwordx4 v42, s[20:23], s79 offen nt lds
    s_add_u32 s79, s79, 393216
    s_cmp_ge_u32 s72, 2
    s_cbranch_scc1 NOWQ3
    s_add_u32 m0, s78, 24576
    s_nop 0
    buffer_load_dwordx4 v40, s[20:23], s79 offen nt lds
    s_add_u32 m0, s78, 25600
    s_nop 0
    buffer_load_dwordx4 v41, s[20:23], s79 offen nt lds
    s_add_u32 m0, s78, 26624
    s_nop 0
    buffer_load_dwordx4 v42, s[20:23], s79 offen nt lds
NOWQ3:
    s_mul_i32 s78, s71, 160
    s_mov_b32 s20, s52
    s_and_b32 s21, s53, 0xffff
    s_mov_b32 s22, 7864320
    s_mov_b32 s23, 0x20000
    s_cmp_lt_u32 s72, 2
    s_cselect_b32 s36, s56, s58
    s_cselect_b32 s37, s57, s59
    s_and_b32 s37, s37, 0xffff
    s_mov_b32 s38, 1966080
    buffer_load_dwordx4 a[8:11], v1, s[8:11], s73 offen offset:2048 nt
    buffer_load_dwordx4 a[12:15], v1, s[8:11], s73 offen offset:3072 nt
    buffer_load_dwordx4 a[16:19], v23, s[8:11], s73 offen offset:0 nt
    v_mul_u32_u24 v29, 416, v25
    v_lshl_add_u32 v29, v26, 4, v29
    v_add_u32 v5, s77, v29
    v_lshrrev_b32 v29, 2, v0
    v_mul_u32_u24 v29, 416, v29
    v_lshl_add_u32 v29, v28, 3, v29
    v_add_u32 v6, s77, v29
    s_mul_i32 s79, s72, 96
    s_add_u32 s79, s79, 26624
    v_lshl_add_u32 v29, v26, 3, v27
    v_mul_u32_u24 v29, 384, v29
    v_lshl_add_u32 v29, v28, 3, v29
    v_add_u32 v16, s79, v29
    v_lshl_add_u32 v29, v26, 2, v27
    v_mul_u32_u24 v29, 384, v29
    v_lshl_add_u32 v29, v28, 3, v29
    v_add_u32 v17, s79, v29
    buffer_load_dwordx4 a[20:23], v23, s[8:11], s73 offen offset:1024 nt
    s_mul_i32 s79, s72, 23
    v_min_u32 v32, 22, v0
    v_add_u32 v32, s79, v32
    v_min_u32 v32, 89, v32
    v_mul_u32_u24 v31, 103, v32
    v_lshrrev_b32 v31, 10, v31
    v_mul_u32_u24 v30, 10, v31
    v_sub_u32 v30, v32, v30
    v_lshl_add_u32 v29, v30, 4, s78
    s_mul_i32 s7, s68, 10240
    s_add_u32 s7, s7, 737280
    v_mul_u32_u24 v8, 1280, v31
    v_add_u32 v8, s7, v8
    s_mul_i32 s7, s68, 81920
    s_add_u32 s7, s7, 46592
    v_mov_b32 v30, s7
    v_cmp_eq_u32 vcc, s68, v31
    s_nop 1
    v_cndmask_b32 v8, v8, v30, vcc
    v_add_u32 v30, 2560, v30
    v_cmp_le_u32 vcc, 8, v31
    s_nop 1
    v_cndmask_b32 v8, v8, v30, vcc
    v_add_u32 v8, v8, v29
    v_add_u32 v33, v31, v32
    v_lshlrev_b32 v33, 4, v33
    v_add_u32 v33, 4096, v33
    v_add_u32 v31, 6, v31
    s_mul_i32 s7, s68, 10240
    s_add_u32 s7, s7, 737280
    v_mul_u32_u24 v9, 1280, v31
    v_add_u32 v9, s7, v9
    s_mul_i32 s7, s68, 81920
    s_add_u32 s7, s7, 46592
    v_mov_b32 v30, s7
    v_cmp_eq_u32 vcc, s68, v31
    s_nop 1
    v_cndmask_b32 v9, v9, v30, vcc
    v_add_u32 v30, 2560, v30
    v_cmp_le_u32 vcc, 8, v31
    s_nop 1
    v_cndmask_b32 v9, v9, v30, vcc
    v_add_u32 v9, v9, v29
    v_mov_b32 v30, 2147483632
    v_cmp_le_u32 vcc, 30, v0
    s_nop 1
    v_cndmask_b32 v9, v9, v30, vcc
    v_mov_b32 v9, v33
    s_lshl_b32 s78, s69, 10
    s_lshl_b32 s79, s72, 8
    s_add_u32 s78, s78, s79
    v_lshl_add_u32 v10, v0, 2, s78
    s_lshl_b32 s78, s70, 13
    s_add_u32 s78, s78, s79
    v_lshlrev_b32 v29, 10, v26
    v_lshl_add_u32 v29, v25, 4, v29
    v_add_u32 v11, s78, v29
    buffer_load_dwordx4 a[24:27], v1, s[8:11], s83 offen offset:0 nt
    s_mul_i32 s78, s72, 96
    s_add_u32 s78, s78, 118784
    v_lshl_add_u32 v29, v27, 5, s78
    v_lshl_add_u32 v29, v28, 2, v29
    v_lshrrev_b32 v30, 1, v26
    v_lshl_add_u32 v29, v30, 4, v29
    v_and_b32 v30, 1, v26
    v_lshl_add_u32 v29, v30, 1, v29
    v_mov_b32 v30, 119168
    v_cmp_le_u32 vcc, 12, v25
    s_nop 1
    v_cndmask_b32 v12, v29, v30, vcc
    v_and_b32 v30, 1, v0
    v_lshlrev_b32 v29, 5, v26
    v_lshl_add_u32 v29, v30, 4, v29
    v_add_u32 v13, 118784, v29
    v_mul_u32_u24 v30, 0xaaaa, v30
    v_and_b32 v29, 1, v27
    v_mul_u32_u24 v29, 0xaaaa, v29
    v_lshl_or_b32 v29, v29, 16, v30
    v_add_u32 v14, 0x44444444, v29
    buffer_load_dwordx4 a[28:31], v1, s[8:11], s83 offen offset:1024 nt
    s_lshl_b32 s78, s72, 8
    s_add_u32 s78, s78, 124416
    v_lshrrev_b32 v29, 5, v0
    v_lshl_add_u32 v29, v29, 6, s78
    v_bfe_u32 v30, v0, 3, 1
    v_lshl_add_u32 v29, v30, 5, v29
    v_bfe_u32 v30, v0, 1, 1
    v_lshl_add_u32 v29, v30, 4, v29
    v_bfe_u32 v30, v0, 2, 1
    v_lshl_add_u32 v29, v30, 3, v29
    v_bfe_u32 v30, v0, 4, 1
    v_lshl_add_u32 v29, v30, 2, v29
    v_bfe_u32 v30, v0, 0, 1
    v_lshl_add_u32 v29, v30, 1, v29
    v_mov_b32 v19, v29
    v_bfe_u32 v29, v0, 4, 1
    v_bfe_u32 v30, v0, 2, 1
    v_lshl_add_u32 v29, v29, 5, s78
    v_lshl_add_u32 v29, v30, 4, v29
    v_accvgpr_write_b32 a252, v29
    s_mul_i32 s78, s72, 768
    s_add_u32 s78, s78, 119296
    v_lshl_add_u32 v29, v25, 2, s78
    v_bfe_u32 v30, v0, 4, 1
    v_lshl_add_u32 v29, v30, 7, v29
    v_lshrrev_b32 v30, 5, v0
    v_lshl_add_u32 v15, v30, 6, v29
    s_waitcnt vmcnt(12)
    v_lshlrev_b32 v88, 16, v80
    v_and_b32 v89, 0xffff0000, v80
    v_lshlrev_b32 v90, 16, v81
    v_and_b32 v91, 0xffff0000, v81
    v_lshlrev_b32 v92, 16, v82
    v_and_b32 v93, 0xffff0000, v82
    v_lshlrev_b32 v94, 16, v83
    v_and_b32 v95, 0xffff0000, v83
    v_lshlrev_b32 v96, 16, v84
    v_and_b32 v97, 0xffff0000, v84
    v_add_f32 v80, v88, v89
    v_add_f32 v80, v80, v90
    v_add_f32 v80, v80, v91
    v_add_f32 v80, v80, v92
    v_add_f32 v80, v80, v93
    v_add_f32 v80, v80, v94
    v_add_f32 v80, v80, v95
    v_add_f32 v80, v80, v96
    v_add_f32 v80, v80, v97
    s_nop 1
    v_add_f32_dpp v80, v80, v80 row_ror:8 row_mask:0xf bank_mask:0xf
    s_nop 1
    v_add_f32_dpp v80, v80, v80 row_ror:4 row_mask:0xf bank_mask:0xf
    s_nop 1
    v_add_f32_dpp v80, v80, v80 row_ror:2 row_mask:0xf bank_mask:0xf
    s_nop 1
    v_add_f32_dpp v80, v80, v80 row_ror:1 row_mask:0xf bank_mask:0xf
    v_mov_b32 v81, v80
    s_nop 1
    v_permlane32_swap_b32 v80, v81
    v_add_f32 v80, v80, v81
    v_mov_b32 v81, v80
    s_nop 1
    v_permlane16_swap_b32 v80, v81
    v_add_f32 v80, v80, v81
    v_mul_f32 v80, 0x3acccccd, v80
    v_sub_f32 v88, v88, v80
    v_sub_f32 v89, v89, v80
    v_sub_f32 v90, v90, v80
    v_sub_f32 v91, v91, v80
    v_sub_f32 v92, v92, v80
    v_sub_f32 v93, v93, v80
    v_sub_f32 v94, v94, v80
    v_sub_f32 v95, v95, v80
    v_sub_f32 v96, v96, v80
    v_sub_f32 v97, v97, v80
    v_mul_f32 v82, v88, v88
    v_fmac_f32 v82, v89, v89
    v_fmac_f32 v82, v90, v90
    v_fmac_f32 v82, v91, v91
    v_fmac_f32 v82, v92, v92
    v_fmac_f32 v82, v93, v93
    v_fmac_f32 v82, v94, v94
    v_fmac_f32 v82, v95, v95
    v_fmac_f32 v82, v96, v96
    v_fmac_f32 v82, v97, v97
    buffer_load_dwordx4 a[32:35], v1, s[8:11], s83 offen offset:2048 nt
    s_nop 0
    v_add_f32_dpp v82, v82, v82 row_ror:8 row_mask:0xf bank_mask:0xf
    s_nop 1
    v_add_f32_dpp v82, v82, v82 row_ror:4 row_mask:0xf bank_mask:0xf
    s_nop 1
    v_add_f32_dpp v82, v82, v82 row_ror:2 row_mask:0xf bank_mask:0xf
    s_nop 1
    v_add_f32_dpp v82, v82, v82 row_ror:1 row_mask:0xf bank_mask:0xf
    v_mov_b32 v81, v82
    s_nop 1
    v_permlane32_swap_b32 v82, v81
    v_add_f32 v82, v82, v81
    v_mov_b32 v81, v82
    s_nop 1
    v_permlane16_swap_b32 v82, v81
    v_add_f32 v82, v82, v81
    v_mul_f32 v82, 0x3acccccd, v82
    v_add_f32 v82, 0x3727c5ac, v82
    v_rsq_f32 v82, v82
    s_mov_b32 vcc_lo, 0xaaaaaaaa
    s_mov_b32 vcc_hi, 0xaaaaaaaa
    v_mov_b32 v85, 0x3f803f80
    v_lshlrev_b32 v83, 16, v70
    v_and_b32 v84, 0xffff0000, v70
    v_sub_f32 v83, v83, v80
    v_sub_f32 v84, v84, v80
    v_mul_f32 v83, v83, v82
    v_mul_f32 v84, v84, v82
    v_cvt_pk_bf16_f32 v83, v83, v84
    v_cndmask_b32 v70, v83, v85, vcc
    v_lshlrev_b32 v83, 16, v71
    v_and_b32 v84, 0xffff0000, v71
    v_sub_f32 v83, v83, v80
    v_sub_f32 v84, v84, v80
    v_mul_f32 v83, v83, v82
    v_mul_f32 v84, v84, v82
    v_cvt_pk_bf16_f32 v83, v83, v84
    v_cndmask_b32 v71, v83, v85, vcc
    v_lshlrev_b32 v83, 16, v72
    v_and_b32 v84, 0xffff0000, v72
    v_sub_f32 v83, v83, v80
    v_sub_f32 v84, v84, v80
    v_mul_f32 v83, v83, v82
    v_mul_f32 v84, v84, v82
    v_cvt_pk_bf16_f32 v83, v83, v84
    v_cndmask_b32 v72, v83, v85, vcc
    v_lshlrev_b32 v83, 16, v73
    v_and_b32 v84, 0xffff0000, v73
    v_sub_f32 v83, v83, v80
    v_sub_f32 v84, v84, v80
    v_mul_f32 v83, v83, v82
    v_mul_f32 v84, v84, v82
    v_cvt_pk_bf16_f32 v83, v83, v84
    v_cndmask_b32 v73, v83, v85, vcc
    v_lshlrev_b32 v83, 16, v74
    v_and_b32 v84, 0xffff0000, v74
    v_sub_f32 v83, v83, v80
    v_sub_f32 v84, v84, v80
    v_mul_f32 v83, v83, v82
    v_mul_f32 v84, v84, v82
    v_cvt_pk_bf16_f32 v83, v83, v84
    v_cndmask_b32 v74, v83, v85, vcc
    v_lshlrev_b32 v83, 16, v75
    v_and_b32 v84, 0xffff0000, v75
    v_sub_f32 v83, v83, v80
    v_sub_f32 v84, v84, v80
    v_mul_f32 v83, v83, v82
    v_mul_f32 v84, v84, v82
    v_cvt_pk_bf16_f32 v83, v83, v84
    v_cndmask_b32 v75, v83, v85, vcc
    buffer_load_dwordx4 a[36:39], v1, s[8:11], s83 offen offset:3072 nt
    v_lshlrev_b32 v83, 16, v76
    v_and_b32 v84, 0xffff0000, v76
    v_sub_f32 v83, v83, v80
    v_sub_f32 v84, v84, v80
    v_mul_f32 v83, v83, v82
    v_mul_f32 v84, v84, v82
    v_cvt_pk_bf16_f32 v83, v83, v84
    v_cndmask_b32 v76, v83, v85, vcc
    v_lshlrev_b32 v83, 16, v77
    v_and_b32 v84, 0xffff0000, v77
    v_sub_f32 v83, v83, v80
    v_sub_f32 v84, v84, v80
    v_mul_f32 v83, v83, v82
    v_mul_f32 v84, v84, v82
    v_cvt_pk_bf16_f32 v83, v83, v84
    v_cndmask_b32 v77, v83, v85, vcc
    v_lshlrev_b32 v83, 16, v78
    v_and_b32 v84, 0xffff0000, v78
    v_sub_f32 v83, v83, v80
    v_sub_f32 v84, v84, v80
    v_mul_f32 v83, v83, v82
    v_mul_f32 v84, v84, v82
    v_cvt_pk_bf16_f32 v83, v83, v84
    v_cndmask_b32 v78, v83, v85, vcc
    v_lshlrev_b32 v83, 16, v79
    v_and_b32 v84, 0xffff0000, v79
    v_sub_f32 v83, v83, v80
    v_sub_f32 v84, v84, v80
    v_mul_f32 v83, v83, v82
    v_mul_f32 v84, v84, v82
    v_cvt_pk_bf16_f32 v83, v83, v84
    v_cndmask_b32 v79, v83, v85, vcc
    s_waitcnt vmcnt(8)
    s_barrier
    ds_read_b64_tr_b16 v[40:41], v16 offset:0
    ds_read_b64_tr_b16 v[42:43], v16 offset:1536
    ds_read_b64_tr_b16 v[44:45], v16 offset:12288
    ds_read_b64_tr_b16 v[46:47], v16 offset:13824
    ds_read_b64_tr_b16 v[48:49], v17 offset:24576
    ds_read_b64_tr_b16 v[50:51], v16 offset:32
    ds_read_b64_tr_b16 v[52:53], v16 offset:1568
    ds_read_b64_tr_b16 v[54:55], v16 offset:12320
    ds_read_b64_tr_b16 v[56:57], v16 offset:13856
    ds_read_b64_tr_b16 v[58:59], v17 offset:24608
    ds_read_b64_tr_b16 v[60:61], v16 offset:64
    ds_read_b64_tr_b16 v[62:63], v16 offset:1600
    ds_read_b64_tr_b16 v[64:65], v16 offset:12352
    ds_read_b64_tr_b16 v[66:67], v16 offset:13888
    ds_read_b64_tr_b16 v[68:69], v17 offset:24640
    v_mov_b32 v100, 0
    s_cmp_lg_u32 s72, 0
    s_cbranch_scc1 NOTL
    s_mov_b64 exec, 1
    global_load_dword v98, v100, s[64:65] sc1
    s_mov_b64 exec, -1
NOTL:
    buffer_load_dwordx4 a[40:43], v23, s[8:11], s83 offen offset:0 nt
    buffer_load_dwordx4 a[44:47], v23, s[8:11], s83 offen offset:1024 nt
    s_mul_i32 s79, s72, 96
    s_add_u32 s79, s79, 119296
    v_min_u32 v36, 48, v0
    v_lshl_add_u32 v36, v36, 1, s79
    v_mov_b32 v37, 119808
    v_cmp_le_u32 vcc, 48, v0
    s_nop 1
    v_cndmask_b32 v36, v36, v37, vcc
    v_add_u32 v37, 119296, v1
    s_waitcnt lgkmcnt(0)
    v_mfma_f32_16x16x32_bf16 v[24:27], v[70:73], v[40:43], 0
    v_mfma_f32_16x16x32_bf16 v[28:31], v[70:73], v[50:53], 0
    v_mfma_f32_16x16x32_bf16 v[32:35], v[70:73], v[60:63], 0
    v_mfma_f32_16x16x32_bf16 v[24:27], v[74:77], v[44:47], v[24:27]
    v_mfma_f32_16x16x32_bf16 v[28:31], v[74:77], v[54:57], v[28:31]
    v_mfma_f32_16x16x32_bf16 v[32:35], v[74:77], v[64:67], v[32:35]
    v_mfma_f32_16x16x16_bf16 v[24:27], v[78:79], v[48:49], v[24:27]
    v_mfma_f32_16x16x16_bf16 v[28:31], v[78:79], v[58:59], v[28:31]
    v_mfma_f32_16x16x16_bf16 v[32:35], v[78:79], v[68:69], v[32:35]
    buffer_load_dwordx4 a[48:51], v1, s[8:11], s84 offen offset:0 nt
    s_nop 4
    v_mov_b32 v7, v25
    v_mov_b32_dpp v24, v28 quad_perm:[0,1,2,3] row_mask:0x2 bank_mask:0xf
    s_nop 0
    v_mov_b32_dpp v7, v29 quad_perm:[0,1,2,3] row_mask:0x2 bank_mask:0xf
    v_mov_b32_dpp v24, v32 quad_perm:[0,1,2,3] row_mask:0x4 bank_mask:0xf
    s_nop 0
    v_mov_b32_dpp v7, v33 quad_perm:[0,1,2,3] row_mask:0x4 bank_mask:0xf
    v_cvt_pk_bf16_f32 v24, v24, v24
    ds_write_b16 v36, v24
    buffer_load_dwordx4 a[52:55], v1, s[8:11], s84 offen offset:1024 nt
    buffer_load_dwordx4 a[56:59], v1, s[8:11], s84 offen offset:2048 nt
    s_waitcnt lgkmcnt(0)
    s_barrier
    ds_read_b128 v[28:31], v37
    s_lshl_b32 s79, s69, 9
    s_add_u32 s79, s79, s3
    s_cmp_eq_u32 s72, 0
    s_cselect_b32 exec_lo, 0xffffff, 1
    s_mov_b32 exec_hi, 0
    s_cselect_b32 s78, 0, 1879048176
    v_add_u32 v37, s78, v1
    s_waitcnt lgkmcnt(0)
    buffer_store_dwordx4 v[28:31], v37, s[16:19], s79 offen sc1
    s_mov_b64 exec, -1
    v_mov_b32 v32, -1
    v_mov_b32 v33, -1
    v_mov_b32 v34, -1
    v_mov_b32 v35, -1
    buffer_store_dwordx4 v[32:35], v21, s[16:19], 0 offen sc1
    buffer_load_dwordx4 a[60:63], v1, s[8:11], s84 offen offset:3072 nt
    s_waitcnt vmcnt(12)
    ds_write_b128 v2, a[0:3] offset:0
    ds_write_b128 v3, a[4:7] offset:0
    ds_write_b128 v4, a[8:11] offset:0
    ds_write_b128 v2, a[12:15] offset:3328
    ds_write_b128 v3, a[16:19] offset:3328
    ds_write_b128 v4, a[20:23] offset:3328
    ds_read_b128 a[0:3], v5 offset:0
    ds_read_b128 a[4:7], v5 offset:64
    ds_read_b128 a[8:11], v5 offset:128
    ds_read_b128 a[12:15], v5 offset:192
    ds_read_b128 a[16:19], v5 offset:256
    ds_read_b128 a[20:23], v5 offset:320
    buffer_load_dwordx4 a[64:67], v23, s[8:11], s84 offen offset:0 nt
    buffer_load_dwordx4 a[68:71], v23, s[8:11], s84 offen offset:1024 nt
    s_barrier
    buffer_load_dwordx4 a[72:75], v1, s[8:11], s85 offen offset:0 nt
    buffer_load_dwordx4 a[76:79], v1, s[8:11], s85 offen offset:1024 nt
    buffer_load_dwordx4 a[80:83], v1, s[8:11], s85 offen offset:2048 nt
    buffer_load_dwordx4 a[84:87], v1, s[8:11], s85 offen offset:3072 nt
    buffer_load_dwordx4 a[88:91], v23, s[8:11], s85 offen offset:0 nt
    buffer_load_dwordx4 a[92:95], v23, s[8:11], s85 offen offset:1024 nt
    s_barrier
    s_getreg_b32 s5, hwreg(HW_REG_XCC_ID, 0, 4)
    s_cmp_lg_u32 s72, 0
    s_cbranch_scc1 NOHDR
    s_waitcnt vmcnt(9)
    v_readfirstlane_b32 s96, v98
    s_nop 0
    s_cmp_eq_u32 s96, 0
    s_cbranch_scc1 TAGLOOP
TAGOK:
    v_mov_b32 v99, s5
    s_mov_b64 exec, 1
    buffer_store_dwordx2 v[98:99], v1, s[16:19], s79 offen offset:384 sc1
    s_mov_b64 exec, -1
NOHDR:
    s_waitcnt vmcnt(14)
    ds_write_b128 v2, a[24:27] offset:0
    ds_write_b128 v3, a[28:31] offset:0
    ds_write_b128 v4, a[32:35] offset:0
    ds_write_b128 v2, a[36:39] offset:3328
    ds_write_b128 v3, a[40:43] offset:3328
    ds_write_b128 v4, a[44:47] offset:3328
    ds_read_b128 a[24:27], v5 offset:0
    ds_read_b128 a[28:31], v5 offset:64
    ds_read_b128 a[32:35], v5 offset:128
    ds_read_b128 a[36:39], v5 offset:192
    ds_read_b128 a[40:43], v5 offset:256
    ds_read_b128 a[44:47], v5 offset:320
    buffer_load_dwordx4 a[96:99], v1, s[8:11], s86 offen offset:0 nt
    buffer_load_dwordx4 a[100:103], v1, s[8:11], s86 offen offset:1024 nt
    buffer_load_dwordx4 a[104:107], v1, s[8:11], s86 offen offset:2048 nt
    buffer_load_dwordx4 a[108:111], v1, s[8:11], s86 offen offset:3072 nt
    buffer_load_dwordx4 a[112:115], v23, s[8:11], s86 offen offset:0 nt
    buffer_load_dwordx4 a[116:119], v23, s[8:11], s86 offen offset:1024 nt
    s_barrier
    s_waitcnt vmcnt(12)
    ds_write_b128 v2, a[48:51] offset:0
    ds_write_b128 v3, a[52:55] offset:0
    ds_write_b128 v4, a[56:59] offset:0
    ds_write_b128 v2, a[60:63] offset:3328
    ds_write_b128 v3, a[64:67] offset:3328
    ds_write_b128 v4, a[68:71] offset:3328
    ds_read_b128 a[48:51], v5 offset:0
    ds_read_b128 a[52:55], v5 offset:64
    ds_read_b128 a[56:59], v5 offset:128
    ds_read_b128 a[60:63], v5 offset:192
    ds_read_b128 a[64:67], v5 offset:256
    ds_read_b128 a[68:71], v5 offset:320
    v_lshlrev_b32 v100, 9, v0
    v_add_u32 v100, s3, v100
    v_bfe_u32 v96, v0, 2, 3
    v_mul_u32_u24 v96, 81920, v96
    v_and_b32 v97, 3, v0
    v_lshl_add_u32 v96, v97, 9, v96
    v_cmp_le_u32 vcc, 32, v0
    s_nop 1
    v_cndmask_b32 v100, v100, v96, vcc
    s_cmp_eq_u32 s72, 0
    s_cselect_b32 s77, 0, 1879048176
    v_add_u32 v100, s77, v100
    buffer_load_dwordx4 a[120:123], v1, s[8:11], s87 offen offset:0 nt
    buffer_load_dwordx4 a[124:127], v1, s[8:11], s87 offen offset:1024 nt
    buffer_load_dwordx4 a[128:131], v1, s[8:11], s87 offen offset:2048 nt
    buffer_load_dwordx4 a[132:135], v1, s[8:11], s87 offen offset:3072 nt
    buffer_load_dwordx4 a[136:139], v23, s[8:11], s87 offen offset:0 nt
    buffer_load_dwordx4 a[140:143], v23, s[8:11], s87 offen offset:1024 nt
    s_barrier
    s_waitcnt vmcnt(12)
    ds_write_b128 v2, a[72:75] offset:0
    ds_write_b128 v3, a[76:79] offset:0
    ds_write_b128 v4, a[80:83] offset:0
    ds_write_b128 v2, a[84:87] offset:3328
    ds_write_b128 v3, a[88:91] offset:3328
    ds_write_b128 v4, a[92:95] offset:3328
    ds_read_b128 a[72:75], v5 offset:0
    ds_read_b128 a[76:79], v5 offset:64
    ds_read_b128 a[80:83], v5 offset:128
    ds_read_b128 a[84:87], v5 offset:192
    ds_read_b128 a[88:91], v5 offset:256
    ds_read_b128 a[92:95], v5 offset:320
    buffer_load_dwordx4 a[144:147], v1, s[8:11], s88 offen offset:0 nt
    buffer_load_dwordx4 a[148:151], v1, s[8:11], s88 offen offset:1024 nt
    buffer_load_dwordx4 a[152:155], v1, s[8:11], s88 offen offset:2048 nt
    buffer_load_dwordx4 a[156:159], v1, s[8:11], s88 offen offset:3072 nt
    buffer_load_dwordx4 a[160:163], v23, s[8:11], s88 offen offset:0 nt
    buffer_load_dwordx4 a[164:167], v23, s[8:11], s88 offen offset:1024 nt
    s_barrier
    s_waitcnt vmcnt(12)
    ds_write_b128 v2, a[96:99] offset:0
    ds_write_b128 v3, a[100:103] offset:0
    ds_write_b128 v4, a[104:107] offset:0
    ds_write_b128 v2, a[108:111] offset:3328
    ds_write_b128 v3, a[112:115] offset:3328
    ds_write_b128 v4, a[116:119] offset:3328
    ds_read_b128 a[96:99], v5 offset:0
    ds_read_b128 a[100:103], v5 offset:64
    ds_read_b128 a[104:107], v5 offset:128
    ds_read_b128 a[108:111], v5 offset:192
    ds_read_b128 a[112:115], v5 offset:256
    ds_read_b128 a[116:119], v5 offset:320
    buffer_load_dwordx4 a[168:171], v1, s[8:11], s89 offen offset:0 nt
    buffer_load_dwordx4 a[172:175], v1, s[8:11], s89 offen offset:1024 nt
    buffer_load_dwordx4 a[176:179], v1, s[8:11], s89 offen offset:2048 nt
    buffer_load_dwordx4 a[180:183], v1, s[8:11], s89 offen offset:3072 nt
    buffer_load_dwordx4 a[184:187], v23, s[8:11], s89 offen offset:0 nt
    buffer_load_dwordx4 a[188:191], v23, s[8:11], s89 offen offset:1024 nt
    s_barrier
    s_cmp_ge_u32 s69, 20
    s_cbranch_scc1 DMAF
    s_lshl_b32 s66, s72, 3
    s_add_u32 s66, s66, s68
    s_mul_i32 s66, s66, 245760
    s_lshl_b32 s78, s69, 6
    s_add_u32 s66, s66, s78
    s_mul_i32 s67, s72, 12288
    s_add_u32 s67, s67, 57344
DMAX:
    v_mov_b32 v109, v20
    v_and_b32 v25, 15, v0
    v_lshrrev_b32 v26, 4, v0
    v_add_u32 v27, 4, v26
    s_mul_i32 s7, s68, 10240
    s_add_u32 s7, s7, 737280
    v_mul_u32_u24 v20, 1280, v26
    v_add_u32 v20, s7, v20
    s_mul_i32 s7, s68, 81920
    s_add_u32 s7, s7, 46592
    v_mov_b32 v28, s7
    v_cmp_eq_u32 vcc, s68, v26
    s_nop 1
    v_cndmask_b32 v20, v20, v28, vcc
    s_mul_i32 s7, s68, 10240
    s_add_u32 s7, s7, 737280
    v_mul_u32_u24 v21, 1280, v27
    v_add_u32 v21, s7, v21
    s_mul_i32 s7, s68, 81920
    s_add_u32 s7, s7, 46592
    v_mov_b32 v28, s7
    v_cmp_eq_u32 vcc, s68, v27
    s_nop 1
    v_cndmask_b32 v21, v21, v28, vcc
    s_min_u32 s7, s69, 19
    s_lshl_b32 s7, s7, 6
    v_lshl_add_u32 v25, v25, 2, s7
    v_add_u32 v20, v20, v25
    v_add_u32 v21, v21, v25
    buffer_load_dwordx4 a[216:219], v1, s[12:15], s73 offen offset:0 nt
    v_and_b32 v25, 15, v0
    v_bfe_u32 v27, v0, 2, 2
    v_and_b32 v28, 3, v0
    s_mul_i32 s7, s72, 12288
    s_add_u32 s7, s7, 57344
    v_lshl_add_u32 v29, v26, 3, v27
    v_lshlrev_b32 v29, 6, v29
    v_lshl_add_u32 v29, v28, 3, v29
    v_add_u32 v29, s7, v29
    v_accvgpr_write_b32 a246, v29
    s_mul_i32 s7, s72, 3072
    s_add_u32 s7, s7, 32768
    v_add_u32 v29, s7, v1
    v_accvgpr_write_b32 a247, v29
    s_lshl_b32 s7, s72, 6
    s_add_u32 s7, s7, 45056
    v_xor_b32 v29, v26, v27
    v_and_b32 v29, 1, v29
    v_lshl_add_u32 v29, v29, 2, v28
    v_lshl_add_u32 v29, v29, 3, s7
    v_accvgpr_write_b32 a248, v29
    s_lshl_b32 s7, s72, 8
    s_add_u32 s7, s7, 122368
    v_lshl_add_u32 v29, v0, 2, s7
    v_accvgpr_write_b32 a249, v29
    s_lshl_b32 s81, s69, 6
    s_mul_i32 s80, s68, 1280
    s_add_u32 s80, s80, s81
    s_add_u32 s80, s80, 655360
    s_add_u32 s81, s81, s3
    s_add_u32 s81, s81, 45312
    s_waitcnt vmcnt(13)
    ds_write_b128 v2, a[120:123] offset:0
    ds_write_b128 v3, a[124:127] offset:0
    ds_write_b128 v4, a[128:131] offset:0
    ds_write_b128 v2, a[132:135] offset:3328
    ds_write_b128 v3, a[136:139] offset:3328
    ds_write_b128 v4, a[140:143] offset:3328
    ds_read_b128 a[120:123], v5 offset:0
    ds_read_b128 a[124:127], v5 offset:64
    ds_read_b128 a[128:131], v5 offset:128
    ds_read_b128 a[132:135], v5 offset:192
    ds_read_b128 a[136:139], v5 offset:256
    ds_read_b128 a[140:143], v5 offset:320
    buffer_load_dwordx4 a[220:223], v1, s[12:15], s73 offen offset:1024 nt
    buffer_load_dwordx4 a[224:227], v1, s[12:15], s73 offen offset:2048 nt
    buffer_load_dwordx4 a[228:231], v1, s[12:15], s73 offen offset:3072 nt
    buffer_load_dwordx4 a[232:235], v23, s[12:15], s73 offen offset:0 nt
    buffer_load_dwordx4 a[236:239], v23, s[12:15], s73 offen offset:1024 nt
    s_barrier
    s_waitcnt vmcnt(12)
    ds_write_b128 v2, a[144:147] offset:0
    ds_write_b128 v3, a[148:151] offset:0
    ds_write_b128 v4, a[152:155] offset:0
    ds_write_b128 v2, a[156:159] offset:3328
    ds_write_b128 v3, a[160:163] offset:3328
    ds_write_b128 v4, a[164:167] offset:3328
    ds_read_b128 a[144:147], v5 offset:0
    ds_read_b128 a[148:151], v5 offset:64
    ds_read_b128 a[152:155], v5 offset:128
    ds_read_b128 a[156:159], v5 offset:192
    ds_read_b128 a[160:163], v5 offset:256
    ds_read_b128 a[164:167], v5 offset:320
    buffer_load_dwordx4 v[112:115], v1, s[12:15], s83 offen offset:0 nt
    buffer_load_dwordx4 v[116:119], v1, s[12:15], s83 offen offset:1024 nt
    buffer_load_dwordx4 v[120:123], v1, s[12:15], s83 offen offset:2048 nt
    buffer_load_dwordx4 v[124:127], v1, s[12:15], s83 offen offset:3072 nt
    buffer_load_dwordx4 v[128:131], v23, s[12:15], s83 offen offset:0 nt
    buffer_load_dwordx4 v[132:135], v23, s[12:15], s83 offen offset:1024 nt
    s_barrier
    buffer_load_dwordx2 v[98:99], v100, s[16:19], 0 offen offset:384 sc1
    s_waitcnt vmcnt(13)
    ds_write_b128 v2, a[168:171] offset:0
    ds_write_b128 v3, a[172:175] offset:0
    ds_write_b128 v4, a[176:179] offset:0
    ds_write_b128 v2, a[180:183] offset:3328
    ds_write_b128 v3, a[184:187] offset:3328
    ds_write_b128 v4, a[188:191] offset:3328
    ds_read_b128 a[168:171], v5 offset:0
    ds_read_b128 a[172:175], v5 offset:64
    ds_read_b128 a[176:179], v5 offset:128
    ds_read_b128 a[180:183], v5 offset:192
    ds_read_b128 a[184:187], v5 offset:256
    ds_read_b128 a[188:191], v5 offset:320
    buffer_load_dwordx4 v[136:139], v1, s[12:15], s84 offen offset:0 nt
    buffer_load_dwordx4 v[140:143], v1, s[12:15], s84 offen offset:1024 nt
    buffer_load_dwordx4 v[144:147], v1, s[12:15], s84 offen offset:2048 nt
    buffer_load_dwordx4 v[148:151], v1, s[12:15], s84 offen offset:3072 nt
    buffer_load_dwordx4 v[152:155], v23, s[12:15], s84 offen offset:0 nt
    buffer_load_dwordx4 v[156:159], v23, s[12:15], s84 offen offset:1024 nt
    s_barrier
    s_waitcnt vmcnt(13)
    ds_write_b128 v2, a[216:219] offset:0
    ds_write_b128 v3, a[220:223] offset:0
    ds_write_b128 v4, a[224:227] offset:0
    ds_write_b128 v2, a[228:231] offset:3328
    ds_write_b128 v3, a[232:235] offset:3328
    ds_write_b128 v4, a[236:239] offset:3328
    ds_read_b64_tr_b16 a[192:193], v6 offset:0
    ds_read_b64_tr_b16 a[196:197], v6 offset:32
    ds_read_b64_tr_b16 a[200:201], v6 offset:64
    ds_read_b64_tr_b16 a[204:205], v6 offset:96
    ds_read_b64_tr_b16 a[208:209], v6 offset:128
    ds_read_b64_tr_b16 a[212:213], v6 offset:160
    ds_read_b64_tr_b16 a[216:217], v6 offset:192
    ds_read_b64_tr_b16 a[220:221], v6 offset:224
    ds_read_b64_tr_b16 a[224:225], v6 offset:256
    ds_read_b64_tr_b16 a[228:229], v6 offset:288
    ds_read_b64_tr_b16 a[232:233], v6 offset:320
    ds_read_b64_tr_b16 a[236:237], v6 offset:352
    buffer_load_dwordx4 v[160:163], v1, s[12:15], s85 offen offset:0 nt
    buffer_load_dwordx4 v[164:167], v1, s[12:15], s85 offen offset:1024 nt
    buffer_load_dwordx4 v[168:171], v1, s[12:15], s85 offen offset:2048 nt
    buffer_load_dwordx4 v[172:175], v1, s[12:15], s85 offen offset:3072 nt
    buffer_load_dwordx4 v[176:179], v23, s[12:15], s85 offen offset:0 nt
    buffer_load_dwordx4 v[180:183], v23, s[12:15], s85 offen offset:1024 nt
    s_barrier
    s_waitcnt vmcnt(12)
    s_mov_b32 s76, -1
    v_mov_b32 v97, 125504
    s_cmp_lg_u32 s72, 0
    s_cbranch_scc1 RDYX
    v_cmp_ne_u32 vcc, s96, v98
    s_cbranch_vccnz RDYLOOP
RDYOK:
    v_cmp_ne_u32 vcc, s5, v99
    s_nop 1
    v_mov_b32 v96, vcc_lo
    ds_write_b32 v97, v96
RDYX:
    buffer_load_dwordx4 v[184:187], v1, s[12:15], s86 offen offset:0 nt
    buffer_load_dwordx4 v[188:191], v1, s[12:15], s86 offen offset:1024 nt
    s_waitcnt lgkmcnt(0)
    s_barrier
    ds_read_b32 v96, v97
    s_waitcnt lgkmcnt(0)
    v_readfirstlane_b32 s77, v96
    s_nop 0
    s_cmp_eq_u32 s77, 0
    s_cselect_b32 s10, s18, 0
    s_mov_b32 s8, s16
    s_mov_b32 s9, s17
    s_mov_b32 s11, 0x20000
    buffer_load_dwordx4 a[240:243], v109, s[16:19], 0 offen sc1
    s_mul_i32 s77, s69, 464
    s_add_u32 s77, s77, s3
    s_add_u32 s77, s77, 49152
    s_cmp_eq_u32 s72, 3
    s_cselect_b32 s77, s77, 1879048176
    v_add_u32 v106, s77, v1
    v_mov_b32 v107, 2147483632
    v_cmp_le_u32 vcc, 29, v0
    s_nop 1
    v_cndmask_b32 v106, v106, v107, vcc
    buffer_load_dwordx4 a[240:243], v106, s[16:19], 0 offen sc1
    s_lshl_b32 s77, s69, 2
    s_add_u32 s77, s77, s72
    s_lshl_b32 s78, s77, 8
    s_add_u32 s78, s78, 819200
    s_lshl_b32 s77, s77, 9
    s_sub_u32 s77, s77, 256
    v_lshlrev_b32 v24, 7, v0
    v_add_u32 v25, s77, v24
    v_min_u32 v25, 57472, v25
    v_add_u32 v24, s78, v24
    v_cmp_gt_u32 vcc, 2, v0
    s_nop 1
    v_cndmask_b32 v24, v25, v24, vcc
    s_add_u32 s77, s3, 819200
    s_mov_b64 exec, 63
    buffer_load_dword a243, v24, s[16:19], s77 offen sc1
    s_mov_b64 exec, -1
    s_lshl_b32 s77, s70, 12
    s_mul_i32 s78, s72, 96
    s_add_u32 s77, s77, s78
    s_add_u32 s77, s77, s3
    v_lshrrev_b32 v24, 4, v0
    v_lshlrev_b32 v24, 9, v24
    v_and_b32 v25, 15, v0
    v_min_u32 v25, 11, v25
    v_lshl_add_u32 v24, v25, 3, v24
    buffer_load_dwordx2 v[64:65], v24, s[16:19], s77 offen offset:0 sc1
    buffer_load_dwordx2 v[66:67], v24, s[16:19], s77 offen offset:2048 sc1
    s_cmp_lg_u32 s72, 1
    s_cbranch_scc1 NOBASE0
    s_cmp_ge_u32 s69, 20
    s_cbranch_scc1 NOBASE0
    v_mov_b32 v28, v22
    s_lshl_b32 s77, s69, 6
    s_add_u32 s77, s77, s3
    s_add_u32 s77, s77, 47872
    v_lshlrev_b32 v27, 2, v0
    v_mov_b32_dpp v29, v28 quad_perm:[1,1,1,1] row_mask:0xf bank_mask:0xf
    v_mov_b32_dpp v30, v28 quad_perm:[2,2,2,2] row_mask:0xf bank_mask:0xf
    v_mov_b32_dpp v31, v28 quad_perm:[3,3,3,3] row_mask:0xf bank_mask:0xf
    s_mov_b32 exec_lo, 0x1111
    s_mov_b32 exec_hi, 0x0
    buffer_store_dwordx4 v[28:31], v27, s[8:11], s77 offen
    s_cmp_eq_u32 s10, 0
    s_cbranch_scc1 SLOW1
BACK1:
    s_mov_b64 exec, -1
NOBASE0:
    ds_write_b128 v2, v[112:115] offset:0
    ds_write_b128 v3, v[116:119] offset:0
    ds_write_b128 v4, v[120:123] offset:0
    ds_write_b128 v2, v[124:127] offset:3328
    ds_write_b128 v3, v[128:131] offset:3328
    ds_write_b128 v4, v[132:135] offset:3328
    ds_read_b64_tr_b16 a[194:195], v6 offset:0
    ds_read_b64_tr_b16 a[198:199], v6 offset:32
    ds_read_b64_tr_b16 a[202:203], v6 offset:64
    ds_read_b64_tr_b16 a[206:207], v6 offset:96
    ds_read_b64_tr_b16 a[210:211], v6 offset:128
    ds_read_b64_tr_b16 a[214:215], v6 offset:160
    ds_read_b64_tr_b16 a[218:219], v6 offset:192
    ds_read_b64_tr_b16 a[222:223], v6 offset:224
    ds_read_b64_tr_b16 a[226:227], v6 offset:256
    ds_read_b64_tr_b16 a[230:231], v6 offset:288
    ds_read_b64_tr_b16 a[234:235], v6 offset:320
    ds_read_b64_tr_b16 a[238:239], v6 offset:352
    s_waitcnt vmcnt(13)
    ds_write_b128 v2, v[136:139] offset:0
    ds_write_b128 v3, v[140:143] offset:0
    ds_write_b128 v4, v[144:147] offset:0
    ds_write_b128 v2, v[148:151] offset:3328
    ds_write_b128 v3, v[152:155] offset:3328
    ds_write_b128 v4, v[156:159] offset:3328
    ds_read_b64_tr_b16 v[112:113], v6 offset:0
    ds_read_b64_tr_b16 v[116:117], v6 offset:32
    ds_read_b64_tr_b16 v[120:121], v6 offset:64
    ds_read_b64_tr_b16 v[124:125], v6 offset:96
    ds_read_b64_tr_b16 v[128:129], v6 offset:128
    ds_read_b64_tr_b16 v[132:133], v6 offset:160
    ds_read_b64_tr_b16 v[136:137], v6 offset:192
    ds_read_b64_tr_b16 v[140:141], v6 offset:224
    ds_read_b64_tr_b16 v[144:145], v6 offset:256
    ds_read_b64_tr_b16 v[148:149], v6 offset:288
    ds_read_b64_tr_b16 v[152:153], v6 offset:320
    ds_read_b64_tr_b16 v[156:157], v6 offset:352
    buffer_load_dwordx4 v[192:195], v1, s[12:15], s86 offen offset:2048 nt
    buffer_load_dwordx4 v[196:199], v1, s[12:15], s86 offen offset:3072 nt
    buffer_load_dwordx4 v[200:203], v23, s[12:15], s86 offen offset:0 nt
    buffer_load_dwordx4 v[204:207], v23, s[12:15], s86 offen offset:1024 nt
    s_barrier
    buffer_load_dwordx4 v[208:211], v1, s[12:15], s87 offen offset:0 nt
    s_waitcnt vmcnt(12)
    ds_write_b128 v2, v[160:163] offset:0
    ds_write_b128 v3, v[164:167] offset:0
    ds_write_b128 v4, v[168:171] offset:0
    ds_write_b128 v2, v[172:175] offset:3328
    ds_write_b128 v3, v[176:179] offset:3328
    ds_write_b128 v4, v[180:183] offset:3328
    ds_read_b64_tr_b16 v[114:115], v6 offset:0
    ds_read_b64_tr_b16 v[118:119], v6 offset:32
    ds_read_b64_tr_b16 v[122:123], v6 offset:64
    ds_read_b64_tr_b16 v[126:127], v6 offset:96
    ds_read_b64_tr_b16 v[130:131], v6 offset:128
    ds_read_b64_tr_b16 v[134:135], v6 offset:160
    ds_read_b64_tr_b16 v[138:139], v6 offset:192
    ds_read_b64_tr_b16 v[142:143], v6 offset:224
    ds_read_b64_tr_b16 v[146:147], v6 offset:256
    ds_read_b64_tr_b16 v[150:151], v6 offset:288
    ds_read_b64_tr_b16 v[154:155], v6 offset:320
    ds_read_b64_tr_b16 v[158:159], v6 offset:352
    buffer_load_dwordx4 v[212:215], v1, s[12:15], s87 offen offset:1024 nt
    buffer_load_dwordx4 v[216:219], v1, s[12:15], s87 offen offset:2048 nt
    buffer_load_dwordx4 v[220:223], v1, s[12:15], s87 offen offset:3072 nt
    buffer_load_dwordx4 v[224:227], v23, s[12:15], s87 offen offset:0 nt
    buffer_load_dwordx4 v[228:231], v23, s[12:15], s87 offen offset:1024 nt
    s_barrier
    buffer_load_dwordx4 v[232:235], v1, s[12:15], s88 offen offset:0 nt
    buffer_load_dwordx4 v[236:239], v1, s[12:15], s88 offen offset:1024 nt
    s_waitcnt vmcnt(12)
    v_lshlrev_b32 v24, 16, v64
    v_and_b32 v25, 0xffff0000, v64
    v_lshlrev_b32 v26, 16, v65
    v_and_b32 v27, 0xffff0000, v65
    v_lshlrev_b32 v28, 16, v66
    v_and_b32 v29, 0xffff0000, v66
    v_lshlrev_b32 v30, 16, v67
    v_and_b32 v31, 0xffff0000, v67
    v_add_f32 v24, v24, v28
    v_add_f32 v25, v25, v29
    v_add_f32 v26, v26, v30
    v_add_f32 v27, v27, v31
    s_nop 0
    v_permlane32_swap_b32 v24, v26
    v_permlane32_swap_b32 v25, v27
    v_add_f32 v24, v24, v26
    v_add_f32 v25, v25, v27
    s_nop 1
    v_permlane16_swap_b32 v24, v25
    v_add_f32 v24, v24, v25
    v_cvt_pk_bf16_f32 v24, v24, v24
    ds_write_b16 v12, v24
    buffer_load_dwordx4 v[240:243], v1, s[12:15], s88 offen offset:2048 nt
    v_mov_b32 v40, 0
    v_mov_b32 v41, 0
    v_mov_b32 v44, 0
    v_mov_b32 v45, 0
    v_mov_b32 v48, 0
    v_mov_b32 v49, 0
    v_mov_b32 v52, 0
    v_mov_b32 v53, 0
    v_mov_b32 v56, 0
    v_mov_b32 v57, 0
    v_mov_b32 v60, 0
    v_mov_b32 v61, 0
    v_mov_b32 v64, 0
    v_mov_b32 v65, 0
    v_mov_b32 v68, 0
    v_mov_b32 v69, 0
    v_mov_b32 v72, 0
    v_mov_b32 v73, 0
    v_mov_b32 v74, 0
    v_mov_b32 v75, 0
    v_mov_b32 v76, 0
    v_mov_b32 v77, 0
    v_mov_b32 v78, 0
    v_mov_b32 v79, 0
    v_mov_b32 v80, 0
    v_mov_b32 v81, 0
    v_mov_b32 v82, 0
    v_mov_b32 v83, 0
    v_mov_b32 v84, 0
    v_mov_b32 v85, 0
    v_mov_b32 v86, 0
    v_mov_b32 v87, 0
    buffer_load_dwordx4 v[244:247], v1, s[12:15], s88 offen offset:3072 nt
    buffer_load_dwordx4 v[248:251], v23, s[12:15], s88 offen offset:0 nt
    s_waitcnt lgkmcnt(0)
    s_barrier
    ds_read_b128 v[28:31], v13 offset:0
    ds_read_b128 v[32:35], v13 offset:128
    ds_read_b128 v[36:39], v13 offset:256
    v_mov_b32 v18, 0x3dd53b94
    s_waitcnt lgkmcnt(2)
    v_smfmac_f32_16x16x64_bf16 v[40:43], v[28:31], a[0:7], v14
    v_smfmac_f32_16x16x64_bf16 v[44:47], v[28:31], a[24:31], v14
    v_smfmac_f32_16x16x64_bf16 v[48:51], v[28:31], a[48:55], v14
    v_smfmac_f32_16x16x64_bf16 v[52:55], v[28:31], a[72:79], v14
    v_smfmac_f32_16x16x64_bf16 v[56:59], v[28:31], a[96:103], v14
    v_smfmac_f32_16x16x64_bf16 v[60:63], v[28:31], a[120:127], v14
    v_smfmac_f32_16x16x64_bf16 v[64:67], v[28:31], a[144:151], v14
    v_smfmac_f32_16x16x64_bf16 v[68:71], v[28:31], a[168:175], v14
    buffer_load_dwordx4 v[252:255], v23, s[12:15], s88 offen offset:1024 nt
    s_barrier
    s_waitcnt lgkmcnt(1)
    v_smfmac_f32_16x16x64_bf16 v[40:43], v[32:35], a[8:15], v14
    v_smfmac_f32_16x16x64_bf16 v[44:47], v[32:35], a[32:39], v14
    v_smfmac_f32_16x16x64_bf16 v[48:51], v[32:35], a[56:63], v14
    v_smfmac_f32_16x16x64_bf16 v[52:55], v[32:35], a[80:87], v14
    v_smfmac_f32_16x16x64_bf16 v[56:59], v[32:35], a[104:111], v14
    v_smfmac_f32_16x16x64_bf16 v[60:63], v[32:35], a[128:135], v14
    v_smfmac_f32_16x16x64_bf16 v[64:67], v[32:35], a[152:159], v14
    v_smfmac_f32_16x16x64_bf16 v[68:71], v[32:35], a[176:183], v14
    s_waitcnt lgkmcnt(0)
    v_smfmac_f32_16x16x64_bf16 v[40:43], v[36:39], a[16:23], v14
    v_smfmac_f32_16x16x64_bf16 v[44:47], v[36:39], a[40:47], v14
    v_smfmac_f32_16x16x64_bf16 v[48:51], v[36:39], a[64:71], v14
    v_smfmac_f32_16x16x64_bf16 v[52:55], v[36:39], a[88:95], v14
    v_smfmac_f32_16x16x64_bf16 v[56:59], v[36:39], a[112:119], v14
    v_smfmac_f32_16x16x64_bf16 v[60:63], v[36:39], a[136:143], v14
    v_smfmac_f32_16x16x64_bf16 v[64:67], v[36:39], a[160:167], v14
    v_smfmac_f32_16x16x64_bf16 v[68:71], v[36:39], a[184:191], v14
    s_nop 0
    v_add_f32 v24, v40, v41
    v_add_f32 v44, v44, v45
    v_add_f32 v48, v48, v49
    v_max3_f32 v26, v24, v44, v48
    v_add_f32 v52, v52, v53
    v_add_f32 v25, v56, v57
    v_max3_f32 v26, v26, v52, v25
    v_add_f32 v60, v60, v61
    v_add_f32 v64, v64, v65
    v_max3_f32 v26, v26, v60, v64
    v_add_f32 v68, v68, v69
    v_max_f32 v26, v26, v68
    v_mov_b32_dpp v24, v44 quad_perm:[0,1,2,3] row_mask:0x2 bank_mask:0xf
    v_mov_b32_dpp v25, v60 quad_perm:[0,1,2,3] row_mask:0x2 bank_mask:0xf
    v_max_f32_dpp v26, v26, v26 row_ror:8 row_mask:0xf bank_mask:0xf
    v_mov_b32_dpp v24, v48 quad_perm:[0,1,2,3] row_mask:0x4 bank_mask:0xf
    v_mov_b32_dpp v25, v64 quad_perm:[0,1,2,3] row_mask:0x4 bank_mask:0xf
    v_max_f32_dpp v26, v26, v26 row_ror:4 row_mask:0xf bank_mask:0xf
    v_mov_b32_dpp v24, v52 quad_perm:[0,1,2,3] row_mask:0x8 bank_mask:0xf
    v_mov_b32_dpp v25, v68 quad_perm:[0,1,2,3] row_mask:0x8 bank_mask:0xf
    v_max_f32_dpp v26, v26, v26 row_ror:2 row_mask:0xf bank_mask:0xf
    v_accvgpr_read_b32 v27, a252
    s_nop 0
    v_max_f32_dpp v26, v26, v26 row_ror:1 row_mask:0xf bank_mask:0xf
    v_mul_f32 v26, v26, v18
    v_fma_f32 v24, v24, v18, -v26
    v_fma_f32 v25, v25, v18, -v26
    v_exp_f32 v24, v24
    v_exp_f32 v25, v25
    s_nop 0
    v_cvt_pk_bf16_f32 v28, v24, v25
    ds_write_b16 v19, v28
    ds_write_b16_d16_hi v19, v28 offset:128
    s_mov_b32 exec_lo, 0xff00ff
    s_mov_b32 exec_hi, 0xff00ff00
    ds_read_b128 v[72:75], v27 offset:0
    ds_read_b128 v[76:79], v27 offset:64
    ds_read_b128 v[80:83], v27 offset:128
    ds_read_b128 v[84:87], v27 offset:192
    s_mov_b64 exec, -1
    v_add_f32 v27, v24, v25
    v_mov_b32 v40, 0
    v_mov_b32 v44, 0
    v_add_f32_dpp v27, v27, v27 row_ror:8 row_mask:0xf bank_mask:0xf
    v_mov_b32 v48, 0
    v_mov_b32 v52, 0
    v_add_f32_dpp v27, v27, v27 row_ror:4 row_mask:0xf bank_mask:0xf
    v_mov_b32 v56, 0
    v_mov_b32 v60, 0
    v_add_f32_dpp v27, v27, v27 row_ror:2 row_mask:0xf bank_mask:0xf
    s_lshl_b32 s78, s72, 3
    s_add_u32 s78, s78, 125440
    v_add_f32_dpp v27, v27, v27 row_ror:1 row_mask:0xf bank_mask:0xf
    v_mov_b32 v28, v27
    s_nop 1
    v_permlane32_swap_b32 v27, v28
    v_add_f32 v27, v27, v28
    v_mov_b32 v28, v27
    s_nop 1
    v_permlane16_swap_b32 v27, v28
    v_add_f32 v27, v27, v28
    v_mov_b32 v28, s78
    ds_write_b64 v28, v[26:27]
    s_waitcnt lgkmcnt(0)
    v_smfmac_f32_16x16x64_bf16 v[40:43], v[72:75], a[192:199], v14 abid:1
    v_smfmac_f32_16x16x64_bf16 v[44:47], v[72:75], a[200:207], v14 abid:1
    v_smfmac_f32_16x16x64_bf16 v[48:51], v[72:75], a[208:215], v14 abid:1
    v_smfmac_f32_16x16x64_bf16 v[52:55], v[72:75], a[216:223], v14 abid:1
    v_smfmac_f32_16x16x64_bf16 v[56:59], v[72:75], a[224:231], v14 abid:1
    v_smfmac_f32_16x16x64_bf16 v[60:63], v[72:75], a[232:239], v14 abid:1
    v_smfmac_f32_16x16x64_bf16 v[40:43], v[76:79], v[112:119], v14 abid:1
    v_smfmac_f32_16x16x64_bf16 v[44:47], v[76:79], v[120:127], v14 abid:1
    v_smfmac_f32_16x16x64_bf16 v[48:51], v[76:79], v[128:135], v14 abid:1
    v_smfmac_f32_16x16x64_bf16 v[52:55], v[76:79], v[136:143], v14 abid:1
    v_smfmac_f32_16x16x64_bf16 v[56:59], v[76:79], v[144:151], v14 abid:1
    v_smfmac_f32_16x16x64_bf16 v[60:63], v[76:79], v[152:159], v14 abid:1
    s_waitcnt vmcnt(12)
    ds_write_b128 v2, v[184:187] offset:0
    ds_write_b128 v3, v[188:191] offset:0
    ds_write_b128 v4, v[192:195] offset:0
    ds_write_b128 v2, v[196:199] offset:3328
    ds_write_b128 v3, v[200:203] offset:3328
    ds_write_b128 v4, v[204:207] offset:3328
    ds_read_b64_tr_b16 v[160:161], v6 offset:0
    ds_read_b64_tr_b16 v[164:165], v6 offset:32
    ds_read_b64_tr_b16 v[168:169], v6 offset:64
    ds_read_b64_tr_b16 v[172:173], v6 offset:96
    ds_read_b64_tr_b16 v[176:177], v6 offset:128
    ds_read_b64_tr_b16 v[180:181], v6 offset:160
    ds_read_b64_tr_b16 v[184:185], v6 offset:192
    ds_read_b64_tr_b16 v[188:189], v6 offset:224
    ds_read_b64_tr_b16 v[192:193], v6 offset:256
    ds_read_b64_tr_b16 v[196:197], v6 offset:288
    ds_read_b64_tr_b16 v[200:201], v6 offset:320
    ds_read_b64_tr_b16 v[204:205], v6 offset:352
    v_mov_b32 v24, -1
    v_mov_b32 v25, -1
    v_mov_b32 v26, -1
    v_mov_b32 v27, -1
    buffer_store_dwordx4 v[24:27], v106, s[8:11], 0 offen
    s_cmp_eq_u32 s10, 0
    s_cbranch_scc1 SLOW2
BACK2:
    buffer_load_dwordx4 v[88:91], v1, s[12:15], s89 offen offset:0 nt
    buffer_load_dwordx4 v[92:95], v1, s[12:15], s89 offen offset:1024 nt
    buffer_load_dwordx4 v[96:99], v1, s[12:15], s89 offen offset:2048 nt
    buffer_load_dwordx4 v[100:103], v1, s[12:15], s89 offen offset:3072 nt
    buffer_load_dwordx4 v[104:107], v23, s[12:15], s89 offen offset:0 nt
    buffer_load_dwordx4 v[108:111], v23, s[12:15], s89 offen offset:1024 nt
    s_waitcnt vmcnt(13)
    ds_write_b128 v2, v[208:211] offset:0
    ds_write_b128 v3, v[212:215] offset:0
    ds_write_b128 v4, v[216:219] offset:0
    ds_write_b128 v2, v[220:223] offset:3328
    ds_write_b128 v3, v[224:227] offset:3328
    ds_write_b128 v4, v[228:231] offset:3328
    ds_read_b64_tr_b16 v[162:163], v6 offset:0
    ds_read_b64_tr_b16 v[166:167], v6 offset:32
    ds_read_b64_tr_b16 v[170:171], v6 offset:64
    ds_read_b64_tr_b16 v[174:175], v6 offset:96
    ds_read_b64_tr_b16 v[178:179], v6 offset:128
    ds_read_b64_tr_b16 v[182:183], v6 offset:160
    ds_read_b64_tr_b16 v[186:187], v6 offset:192
    ds_read_b64_tr_b16 v[190:191], v6 offset:224
    ds_read_b64_tr_b16 v[194:195], v6 offset:256
    ds_read_b64_tr_b16 v[198:199], v6 offset:288
    ds_read_b64_tr_b16 v[202:203], v6 offset:320
    ds_read_b64_tr_b16 v[206:207], v6 offset:352
    v_and_b32 v23, 0xffff0000, v22
    v_lshlrev_b32 v22, 16, v22
    s_mov_b32 s82, 0x50005
    s_mov_b32 s83, 0x50005
    s_mov_b32 s84, 0x1ff01ff
    s_mov_b32 s85, 0x1ff01ff
    s_mov_b32 s86, 0xffffffff
    s_mov_b32 s87, 0x1fff
    s_mov_b32 s50, 0x7fffff
    s_mov_b32 s51, 0x0
    s_mov_b32 s88, 0xff00ff
    s_mov_b32 s89, 0xff00ff00
    s_mov_b32 s92, 0x1010101
    s_mov_b32 s93, 0x0
    s_mov_b32 s44, 0xf0f0f0f
    s_mov_b32 s45, 0xf0f0f0f
    s_mov_b64 s[46:47], s[92:93]
    s_mov_b64 s[48:49], s[44:45]
    s_cmp_ge_u32 s69, 20
    s_cbranch_scc1 TAILF
    v_mov_b32 v24, -1
    v_mov_b32 v25, -1
    v_mov_b32 v26, -1
    v_mov_b32 v27, -1
    v_and_b32 v28, 3, v0
    v_lshrrev_b32 v29, 5, v0
    v_lshl_add_u32 v28, v29, 2, v28
    v_mul_u32_u24 v28, 10240, v28
    v_bfe_u32 v29, v0, 3, 2
    v_lshl_add_u32 v28, v29, 4, v28
    s_cmp_eq_u32 s72, 3
    s_cselect_b32 s77, 0, 1879048176
    v_add_u32 v28, s77, v28
    s_add_u32 s77, s80, 81920
    s_mov_b64 exec, s[44:45]
    buffer_store_dwordx4 v[24:27], v28, s[16:19], s77 offen sc1
    s_mov_b64 exec, -1
    v_lshrrev_b32 v38, 2, v0
    v_mul_u32_u24 v38, 1280, v38
    v_and_b32 v39, 3, v0
    v_lshl_add_u32 v39, v39, 4, v38
    s_mov_b32 m0, s67
    s_add_u32 s67, s67, 1024
    buffer_load_dwordx4 v39, s[24:27], s66 offen  lds
    s_add_u32 s66, s66, 20480
    s_mov_b32 m0, s67
    s_add_u32 s67, s67, 1024
    buffer_load_dwordx4 v39, s[24:27], s66 offen  lds
    s_add_u32 s66, s66, 20480
    s_mov_b32 m0, s67
    s_add_u32 s67, s67, 1024
    buffer_load_dwordx4 v39, s[24:27], s66 offen  lds
    s_add_u32 s66, s66, 20480
    s_waitcnt lgkmcnt(0)
    v_smfmac_f32_16x16x64_bf16 v[40:43], v[80:83], v[160:167], v14 abid:1
    v_smfmac_f32_16x16x64_bf16 v[44:47], v[80:83], v[168:175], v14 abid:1
    v_smfmac_f32_16x16x64_bf16 v[48:51], v[80:83], v[176:183], v14 abid:1
    v_smfmac_f32_16x16x64_bf16 v[52:55], v[80:83], v[184:191], v14 abid:1
    v_smfmac_f32_16x16x64_bf16 v[56:59], v[80:83], v[192:199], v14 abid:1
    v_smfmac_f32_16x16x64_bf16 v[60:63], v[80:83], v[200:207], v14 abid:1
    s_waitcnt vmcnt(11)
    ds_write_b128 v2, v[232:235] offset:0
    ds_write_b128 v3, v[236:239] offset:0
    ds_write_b128 v4, v[240:243] offset:0
    ds_write_b128 v2, v[244:247] offset:3328
    ds_write_b128 v3, v[248:251] offset:3328
    ds_write_b128 v4, v[252:255] offset:3328
    ds_read_b64_tr_b16 v[208:209], v6 offset:0
    ds_read_b64_tr_b16 v[212:213], v6 offset:32
    ds_read_b64_tr_b16 v[216:217], v6 offset:64
    ds_read_b64_tr_b16 v[220:221], v6 offset:96
    ds_read_b64_tr_b16 v[224:225], v6 offset:128
    ds_read_b64_tr_b16 v[228:229], v6 offset:160
    ds_read_b64_tr_b16 v[232:233], v6 offset:192
    ds_read_b64_tr_b16 v[236:237], v6 offset:224
    ds_read_b64_tr_b16 v[240:241], v6 offset:256
    ds_read_b64_tr_b16 v[244:245], v6 offset:288
    ds_read_b64_tr_b16 v[248:249], v6 offset:320
    ds_read_b64_tr_b16 v[252:253], v6 offset:352
    s_mov_b32 m0, s67
    s_add_u32 s67, s67, 1024
    buffer_load_dwordx4 v39, s[24:27], s66 offen  lds
    s_add_u32 s66, s66, 20480
    s_mov_b32 m0, s67
    s_add_u32 s67, s67, 1024
    buffer_load_dwordx4 v39, s[24:27], s66 offen  lds
    s_add_u32 s66, s66, 20480
    s_mov_b32 m0, s67
    s_add_u32 s67, s67, 1024
    buffer_load_dwordx4 v39, s[24:27], s66 offen  lds
    s_add_u32 s66, s66, 20480
    s_waitcnt vmcnt(12)
    ds_write_b128 v2, v[88:91] offset:0
    s_waitcnt vmcnt(11)
    ds_write_b128 v3, v[92:95] offset:0
    s_waitcnt vmcnt(10)
    ds_write_b128 v4, v[96:99] offset:0
    s_waitcnt vmcnt(9)
    ds_write_b128 v2, v[100:103] offset:3328
    s_waitcnt vmcnt(8)
    ds_write_b128 v3, v[104:107] offset:3328
    s_waitcnt vmcnt(7)
    ds_write_b128 v4, v[108:111] offset:3328
    ds_read_b64_tr_b16 v[210:211], v6 offset:0
    ds_read_b64_tr_b16 v[214:215], v6 offset:32
    ds_read_b64_tr_b16 v[218:219], v6 offset:64
    ds_read_b64_tr_b16 v[222:223], v6 offset:96
    ds_read_b64_tr_b16 v[226:227], v6 offset:128
    ds_read_b64_tr_b16 v[230:231], v6 offset:160
    ds_read_b64_tr_b16 v[234:235], v6 offset:192
    ds_read_b64_tr_b16 v[238:239], v6 offset:224
    ds_read_b64_tr_b16 v[242:243], v6 offset:256
    ds_read_b64_tr_b16 v[246:247], v6 offset:288
    ds_read_b64_tr_b16 v[250:251], v6 offset:320
    ds_read_b64_tr_b16 v[254:255], v6 offset:352
    s_branch ATT_LAST
TAILF:
    s_lshl_b32 s90, s72, 3
    s_add_u32 s90, s90, s68
    s_add_u32 s90, s90, 1
    s_mul_i32 s90, s90, 245760
    s_sub_u32 s78, 32, s69
    s_mul_i32 s78, s78, 10240
    s_sub_u32 s90, s90, s78
    buffer_load_dwordx4 a[240:243], v1, s[20:23], s90 offen offset:0
    buffer_load_dwordx4 a[240:243], v1, s[20:23], s90 offen offset:1024
    buffer_load_dwordx4 a[240:243], v1, s[20:23], s90 offen offset:2048
    buffer_load_dwordx4 a[240:243], v1, s[20:23], s90 offen offset:3072
    s_add_u32 s90, s90, 4096
    buffer_load_dwordx4 a[240:243], v1, s[20:23], s90 offen offset:0
    buffer_load_dwordx4 a[240:243], v1, s[20:23], s90 offen offset:1024
    buffer_load_dwordx4 a[240:243], v1, s[20:23], s90 offen offset:2048
    v_lshrrev_b32 v38, 3, v0
    v_mul_u32_u24 v38, 3072, v38
    v_and_b32 v39, 7, v0
    v_lshl_add_u32 v38, v39, 4, v38
    v_bfe_u32 v39, v0, 4, 1
    v_lshlrev_b32 v39, 5, v39
    v_xor_b32 v38, v38, v39
    v_xor_b32 v39, 64, v38
    s_waitcnt lgkmcnt(0)
    v_smfmac_f32_16x16x64_bf16 v[40:43], v[80:83], v[160:167], v14 abid:1
    v_smfmac_f32_16x16x64_bf16 v[44:47], v[80:83], v[168:175], v14 abid:1
    v_smfmac_f32_16x16x64_bf16 v[48:51], v[80:83], v[176:183], v14 abid:1
    v_smfmac_f32_16x16x64_bf16 v[52:55], v[80:83], v[184:191], v14 abid:1
    v_smfmac_f32_16x16x64_bf16 v[56:59], v[80:83], v[192:199], v14 abid:1
    v_smfmac_f32_16x16x64_bf16 v[60:63], v[80:83], v[200:207], v14 abid:1
    s_waitcnt vmcnt(14)
    ds_write_b128 v2, v[232:235] offset:0
    ds_write_b128 v3, v[236:239] offset:0
    ds_write_b128 v4, v[240:243] offset:0
    ds_write_b128 v2, v[244:247] offset:3328
    ds_write_b128 v3, v[248:251] offset:3328
    ds_write_b128 v4, v[252:255] offset:3328
    ds_read_b64_tr_b16 v[208:209], v6 offset:0
    ds_read_b64_tr_b16 v[212:213], v6 offset:32
    ds_read_b64_tr_b16 v[216:217], v6 offset:64
    ds_read_b64_tr_b16 v[220:221], v6 offset:96
    ds_read_b64_tr_b16 v[224:225], v6 offset:128
    ds_read_b64_tr_b16 v[228:229], v6 offset:160
    ds_read_b64_tr_b16 v[232:233], v6 offset:192
    ds_read_b64_tr_b16 v[236:237], v6 offset:224
    ds_read_b64_tr_b16 v[240:241], v6 offset:256
    ds_read_b64_tr_b16 v[244:245], v6 offset:288
    ds_read_b64_tr_b16 v[248:249], v6 offset:320
    ds_read_b64_tr_b16 v[252:253], v6 offset:352
    buffer_load_dwordx4 a[240:243], v1, s[20:23], s90 offen offset:3072
    s_add_u32 s90, s90, 4096
    buffer_load_dwordx4 a[240:243], v1, s[20:23], s90 offen offset:0
    buffer_load_dwordx4 a[240:243], v1, s[20:23], s90 offen offset:1024
    s_waitcnt vmcnt(15)
    ds_write_b128 v2, v[88:91] offset:0
    s_waitcnt vmcnt(14)
    ds_write_b128 v3, v[92:95] offset:0
    s_waitcnt vmcnt(13)
    ds_write_b128 v4, v[96:99] offset:0
    s_waitcnt vmcnt(12)
    ds_write_b128 v2, v[100:103] offset:3328
    s_waitcnt vmcnt(11)
    ds_write_b128 v3, v[104:107] offset:3328
    s_waitcnt vmcnt(10)
    ds_write_b128 v4, v[108:111] offset:3328
    ds_read_b64_tr_b16 v[210:211], v6 offset:0
    ds_read_b64_tr_b16 v[214:215], v6 offset:32
    ds_read_b64_tr_b16 v[218:219], v6 offset:64
    ds_read_b64_tr_b16 v[222:223], v6 offset:96
    ds_read_b64_tr_b16 v[226:227], v6 offset:128
    ds_read_b64_tr_b16 v[230:231], v6 offset:160
    ds_read_b64_tr_b16 v[234:235], v6 offset:192
    ds_read_b64_tr_b16 v[238:239], v6 offset:224
    ds_read_b64_tr_b16 v[242:243], v6 offset:256
    ds_read_b64_tr_b16 v[246:247], v6 offset:288
    ds_read_b64_tr_b16 v[250:251], v6 offset:320
    ds_read_b64_tr_b16 v[254:255], v6 offset:352
    s_branch ATT_LAST
LOOP:
    s_cmp_lt_u32 s69, 20
    s_cselect_b32 s5, s72, 4
    s_add_u32 s96, s3, 819200
    s_add_u32 s97, s96, 4096
    s_and_b32 s77, s5, 3
    s_cbranch_scc1 LOOP2
    ds_read_b64_tr_b16 v[40:41], v16 offset:0
    ds_read_b64_tr_b16 v[42:43], v16 offset:1536
    ds_read_b64_tr_b16 v[44:45], v16 offset:12288
    ds_read_b64_tr_b16 v[46:47], v16 offset:13824
    ds_read_b64_tr_b16 v[48:49], v17 offset:24576
    ds_read_b64_tr_b16 v[50:51], v16 offset:32
    ds_read_b64_tr_b16 v[52:53], v16 offset:1568
    ds_read_b64_tr_b16 v[54:55], v16 offset:12320
    ds_read_b64_tr_b16 v[56:57], v16 offset:13856
    ds_read_b64_tr_b16 v[58:59], v17 offset:24608
    ds_read_b64_tr_b16 v[60:61], v16 offset:64
    ds_read_b64_tr_b16 v[62:63], v16 offset:1600
    ds_read_b64_tr_b16 v[64:65], v16 offset:12352
    ds_read_b64_tr_b16 v[66:67], v16 offset:13888
    ds_read_b64_tr_b16 v[68:69], v17 offset:24640
    v_and_b32 v25, 15, v0
    v_cmp_eq_u32 vcc, 12, v25
    v_mov_b32 v36, 0x3f803f80
    s_nop 0
    v_cndmask_b32 v70, 0, v36, vcc
    v_mov_b32 v71, v70
    v_mov_b32 v72, v70
    v_mov_b32 v73, v70
    v_mov_b32 v74, v70
    v_mov_b32 v75, v70
    v_mov_b32 v76, v70
    v_mov_b32 v77, v70
    v_mov_b32 v78, v70
    v_mov_b32 v79, v70
    s_mov_b32 s77, 4096
    v_mul_u32_u24 v96, 103, v0
    v_lshrrev_b32 v96, 10, v96
    v_lshl_add_u32 v96, v96, 4, v1
    v_add_u32 v96, s77, v96
    v_mul_u32_u24 v97, 176, v25
    v_add_u32 v97, s77, v97
    v_lshrrev_b32 v28, 4, v0
    v_lshl_add_u32 v98, v28, 3, v97
    v_lshl_add_u32 v97, v28, 4, v97
LOOP2:
    s_add_u32 s79, s3, 4096
    s_mul_i32 s77, s71, 160
    s_add_u32 s77, s77, s3
    s_sub_u32 s77, s77, 772608
    s_mov_b32 exec_lo, 0x3ff
    s_mov_b32 exec_hi, 0x0
    s_mov_b32 s76, 1
POLL3:
    buffer_load_dword v24, v1, s[16:19], s77 offen sc1
POLLW3:
    s_waitcnt vmcnt(0)
    v_cmp_eq_u32 vcc, -1, v24
    s_cbranch_vccnz AGAIN3
POLLX3:
    s_mov_b64 exec, s[50:51]
    buffer_load_dwordx4 v[80:83], v8, s[16:19], 0 offen sc1
    s_waitcnt vmcnt(0)
BW4:
    ds_write_b128 v9, v[80:83]
    v_cmp_eq_u32 vcc, -1, v80
    s_cbranch_vccnz BR4
BX4:
    s_mov_b64 exec, s[84:85]
    s_waitcnt lgkmcnt(0)
    s_barrier
    ds_read_b128 v[70:73], v97
    ds_read_b128 v[74:77], v97 offset:64
    ds_read_b64 v[78:79], v98 offset:128
    s_mov_b64 exec, -1
    s_cmp_lg_u32 s5, 1
    s_cbranch_scc1 NOOWL
    buffer_load_dword a244, v20, s[16:19], 0 offen sc1
    buffer_load_dword a245, v21, s[16:19], 0 offen sc1
NOOWL:
    buffer_load_dwordx4 v[88:91], v11, s[16:19], s96 offen sc1
    buffer_load_dwordx4 v[92:95], v11, s[16:19], s97 offen sc1
    s_waitcnt lgkmcnt(2)
    v_mfma_f32_16x16x32_bf16 v[24:27], v[70:73], v[40:43], 0
    v_mfma_f32_16x16x32_bf16 v[32:35], v[70:73], v[60:63], 0
    s_waitcnt lgkmcnt(0)
    v_mfma_f32_16x16x32_bf16 v[24:27], v[74:77], v[44:47], v[24:27]
    v_mfma_f32_16x16x32_bf16 v[32:35], v[74:77], v[64:67], v[32:35]
    v_mfma_f32_16x16x16_bf16 v[24:27], v[78:79], v[48:49], v[24:27]
    v_mfma_f32_16x16x16_bf16 v[32:35], v[78:79], v[68:69], v[32:35]
    v_mfma_f32_16x16x32_bf16 v[28:31], v[70:73], v[50:53], 0
    v_mfma_f32_16x16x32_bf16 v[36:39], v[70:73], v[70:73], 0
    v_mfma_f32_16x16x32_bf16 v[28:31], v[74:77], v[54:57], v[28:31]
    v_mfma_f32_16x16x32_bf16 v[36:39], v[74:77], v[74:77], v[36:39]
    v_mfma_f32_16x16x16_bf16 v[28:31], v[78:79], v[58:59], v[28:31]
    v_mfma_f32_16x16x16_bf16 v[36:39], v[78:79], v[78:79], v[36:39]
    s_nop 0
    v_add_f32 v24, v24, v25
    v_add_f32 v26, v26, v27
    v_add_f32 v24, v24, v26
    v_add_f32 v32, v32, v33
    v_add_f32 v34, v34, v35
    v_add_f32 v32, v32, v34
    s_nop 1
    v_permlane32_swap_b32 v24, v32
    v_add_f32 v28, v28, v29
    v_add_f32 v30, v30, v31
    v_add_f32 v36, v36, v37
    v_add_f32 v38, v38, v39
    v_add_f32 v24, v24, v32
    v_add_f32 v28, v28, v30
    v_add_f32 v36, v36, v38
    s_nop 1
    v_permlane32_swap_b32 v28, v36
    v_add_f32 v28, v28, v36
    s_nop 1
    v_permlane16_swap_b32 v24, v28
    v_add_f32 v24, v24, v28
    buffer_store_dword v24, v10, s[8:11], s3 offen
    s_cmp_eq_u32 s10, 0
    s_cbranch_scc1 SLOW5
BACK5:
    v_mov_b32 v40, 0
    v_mov_b32 v41, 0
    v_mov_b32 v44, 0
    v_mov_b32 v45, 0
    v_mov_b32 v48, 0
    v_mov_b32 v49, 0
    v_mov_b32 v52, 0
    v_mov_b32 v53, 0
    v_mov_b32 v56, 0
    v_mov_b32 v57, 0
    v_mov_b32 v60, 0
    v_mov_b32 v61, 0
    v_mov_b32 v64, 0
    v_mov_b32 v65, 0
    v_mov_b32 v68, 0
    v_mov_b32 v69, 0
    v_mov_b32 v72, 0
    v_mov_b32 v73, 0
    v_mov_b32 v74, 0
    v_mov_b32 v75, 0
    v_mov_b32 v76, 0
    v_mov_b32 v77, 0
    v_mov_b32 v78, 0
    v_mov_b32 v79, 0
    v_mov_b32 v80, 0
    v_mov_b32 v81, 0
    v_mov_b32 v82, 0
    v_mov_b32 v83, 0
    v_mov_b32 v84, 0
    v_mov_b32 v85, 0
    v_mov_b32 v86, 0
    v_mov_b32 v87, 0
    s_waitcnt vmcnt(1)
    v_add_f32 v88, v88, v92
    v_add_f32 v89, v89, v93
    v_add_f32 v90, v90, v94
    v_add_f32 v91, v91, v95
    s_nop 0
    v_permlane32_swap_b32 v88, v90
    v_permlane32_swap_b32 v89, v91
    v_add_f32 v88, v88, v90
    v_add_f32 v89, v89, v91
    s_nop 1
    v_permlane16_swap_b32 v88, v89
    v_add_f32 v88, v88, v89
    v_mul_f32 v7, 0x3acccccd, v88
    s_mov_b32 s76, 1
POLL6:
    buffer_load_dwordx4 v[24:27], v11, s[16:19], s3 offen sc1
    buffer_load_dwordx4 v[28:31], v11, s[16:19], s79 offen sc1
    s_waitcnt vmcnt(0)
    v_add_f32 v24, v24, v28
    v_add_f32 v25, v25, v29
    v_add_f32 v26, v26, v30
    v_add_f32 v27, v27, v31
    s_nop 0
    v_permlane32_swap_b32 v24, v26
    v_permlane32_swap_b32 v25, v27
    v_add_f32 v24, v24, v26
    v_add_f32 v25, v25, v27
    s_nop 1
    v_permlane16_swap_b32 v24, v25
    v_add_f32 v24, v24, v25
    v_cmp_u_f32 vcc, v24, v24
    s_cbranch_vccnz AGAIN6
POLLX6:
    v_readlane_b32 s77, v24, 15
    s_mov_b32 vcc_lo, 0x70007000
    s_mov_b32 vcc_hi, 0x70007000
    v_fma_f32 v25, -s77, v7, v24
    v_cvt_pk_bf16_f32 v25, v25, v25
    ds_write_b16 v12, v25
    v_cndmask_b32 v26, 0, v24, vcc
    s_nop 1
    v_add_f32_dpp v26, v26, v26 quad_perm:[1,0,3,2] row_mask:0xf bank_mask:0xf
    s_nop 1
    v_add_f32_dpp v26, v26, v26 quad_perm:[2,3,0,1] row_mask:0xf bank_mask:0xf
    v_mov_b32 v27, v26
    s_nop 1
    v_permlane32_swap_b32 v26, v27
    v_add_f32 v26, v26, v27
    s_waitcnt lgkmcnt(0)
    s_barrier
    ds_read_b128 v[28:31], v13 offset:0
    ds_read_b128 v[32:35], v13 offset:128
    ds_read_b128 v[36:39], v13 offset:256
    v_mov_b32 v27, v26
    v_mov_b32 v25, s77
    v_subrev_f32 v25, 0x44200000, v25
    v_permlane16_swap_b32 v26, v27
    v_add_f32 v26, v26, v27
    v_mul_f32 v24, 0x3acccccd, v25
    v_readlane_b32 s77, v26, 15
    v_mul_f32 v24, v24, v24
    s_mov_b32 s78, 0x3acccccd
    v_sub_f32 v26, s77, v25
    v_fma_f32 v26, v26, s78, -v24
    v_max_f32 v26, 0, v26
    v_add_f32 v26, 0x3727c5ac, v26
    v_rsq_f32 v26, v26
    s_nop 0
    v_mul_f32 v18, 0x3dd53b94, v26
    s_waitcnt lgkmcnt(2)
    v_smfmac_f32_16x16x64_bf16 v[40:43], v[28:31], a[0:7], v14
    v_smfmac_f32_16x16x64_bf16 v[44:47], v[28:31], a[24:31], v14
    v_smfmac_f32_16x16x64_bf16 v[48:51], v[28:31], a[48:55], v14
    v_smfmac_f32_16x16x64_bf16 v[52:55], v[28:31], a[72:79], v14
    v_smfmac_f32_16x16x64_bf16 v[56:59], v[28:31], a[96:103], v14
    v_smfmac_f32_16x16x64_bf16 v[60:63], v[28:31], a[120:127], v14
    v_smfmac_f32_16x16x64_bf16 v[64:67], v[28:31], a[144:151], v14
    v_smfmac_f32_16x16x64_bf16 v[68:71], v[28:31], a[168:175], v14
    s_waitcnt lgkmcnt(1)
    v_smfmac_f32_16x16x64_bf16 v[40:43], v[32:35], a[8:15], v14
    v_smfmac_f32_16x16x64_bf16 v[44:47], v[32:35], a[32:39], v14
    v_smfmac_f32_16x16x64_bf16 v[48:51], v[32:35], a[56:63], v14
    v_smfmac_f32_16x16x64_bf16 v[52:55], v[32:35], a[80:87], v14
    v_smfmac_f32_16x16x64_bf16 v[56:59], v[32:35], a[104:111], v14
    v_smfmac_f32_16x16x64_bf16 v[60:63], v[32:35], a[128:135], v14
    v_smfmac_f32_16x16x64_bf16 v[64:67], v[32:35], a[152:159], v14
    v_smfmac_f32_16x16x64_bf16 v[68:71], v[32:35], a[176:183], v14
    s_waitcnt lgkmcnt(0)
    v_smfmac_f32_16x16x64_bf16 v[40:43], v[36:39], a[16:23], v14
    v_smfmac_f32_16x16x64_bf16 v[44:47], v[36:39], a[40:47], v14
    v_smfmac_f32_16x16x64_bf16 v[48:51], v[36:39], a[64:71], v14
    v_smfmac_f32_16x16x64_bf16 v[52:55], v[36:39], a[88:95], v14
    v_smfmac_f32_16x16x64_bf16 v[56:59], v[36:39], a[112:119], v14
    v_smfmac_f32_16x16x64_bf16 v[60:63], v[36:39], a[136:143], v14
    v_smfmac_f32_16x16x64_bf16 v[64:67], v[36:39], a[160:167], v14
    v_smfmac_f32_16x16x64_bf16 v[68:71], v[36:39], a[184:191], v14
    s_nop 0
    v_add_f32 v24, v40, v41
    v_add_f32 v44, v44, v45
    v_add_f32 v48, v48, v49
    v_max3_f32 v26, v24, v44, v48
    v_add_f32 v52, v52, v53
    v_add_f32 v25, v56, v57
    v_max3_f32 v26, v26, v52, v25
    v_add_f32 v60, v60, v61
    v_add_f32 v64, v64, v65
    v_max3_f32 v26, v26, v60, v64
    v_add_f32 v68, v68, v69
    v_max_f32 v26, v26, v68
    v_mov_b32_dpp v24, v44 quad_perm:[0,1,2,3] row_mask:0x2 bank_mask:0xf
    v_mov_b32_dpp v25, v60 quad_perm:[0,1,2,3] row_mask:0x2 bank_mask:0xf
    v_max_f32_dpp v26, v26, v26 row_ror:8 row_mask:0xf bank_mask:0xf
    v_mov_b32_dpp v24, v48 quad_perm:[0,1,2,3] row_mask:0x4 bank_mask:0xf
    v_mov_b32_dpp v25, v64 quad_perm:[0,1,2,3] row_mask:0x4 bank_mask:0xf
    v_max_f32_dpp v26, v26, v26 row_ror:4 row_mask:0xf bank_mask:0xf
    v_mov_b32_dpp v24, v52 quad_perm:[0,1,2,3] row_mask:0x8 bank_mask:0xf
    v_mov_b32_dpp v25, v68 quad_perm:[0,1,2,3] row_mask:0x8 bank_mask:0xf
    v_max_f32_dpp v26, v26, v26 row_ror:2 row_mask:0xf bank_mask:0xf
    v_accvgpr_read_b32 v27, a252
    s_nop 0
    v_max_f32_dpp v26, v26, v26 row_ror:1 row_mask:0xf bank_mask:0xf
    v_mul_f32 v26, v26, v18
    v_fma_f32 v24, v24, v18, -v26
    v_fma_f32 v25, v25, v18, -v26
    v_exp_f32 v24, v24
    v_exp_f32 v25, v25
    s_nop 0
    v_cvt_pk_bf16_f32 v28, v24, v25
    ds_write_b16 v19, v28
    ds_write_b16_d16_hi v19, v28 offset:128
    s_mov_b64 exec, s[88:89]
    ds_read_b128 v[72:75], v27 offset:0
    ds_read_b128 v[76:79], v27 offset:64
    ds_read_b128 v[80:83], v27 offset:128
    ds_read_b128 v[84:87], v27 offset:192
    s_mov_b64 exec, -1
    v_add_f32 v27, v24, v25
    v_mov_b32 v40, 0
    v_mov_b32 v44, 0
    v_add_f32_dpp v27, v27, v27 row_ror:8 row_mask:0xf bank_mask:0xf
    v_mov_b32 v48, 0
    v_mov_b32 v52, 0
    v_add_f32_dpp v27, v27, v27 row_ror:4 row_mask:0xf bank_mask:0xf
    v_mov_b32 v56, 0
    v_mov_b32 v60, 0
    v_add_f32_dpp v27, v27, v27 row_ror:2 row_mask:0xf bank_mask:0xf
    s_lshl_b32 s78, s72, 3
    s_add_u32 s78, s78, 125440
    v_add_f32_dpp v27, v27, v27 row_ror:1 row_mask:0xf bank_mask:0xf
    v_mov_b32 v28, v27
    s_nop 1
    v_permlane32_swap_b32 v27, v28
    v_add_f32 v27, v27, v28
    v_mov_b32 v28, v27
    s_nop 1
    v_permlane16_swap_b32 v27, v28
    v_add_f32 v27, v27, v28
    v_mov_b32 v28, s78
    ds_write_b64 v28, v[26:27]
    s_waitcnt lgkmcnt(4)
    v_smfmac_f32_16x16x64_bf16 v[40:43], v[72:75], a[192:199], v14 abid:1
    v_smfmac_f32_16x16x64_bf16 v[44:47], v[72:75], a[200:207], v14 abid:1
    v_smfmac_f32_16x16x64_bf16 v[48:51], v[72:75], a[208:215], v14 abid:1
    v_smfmac_f32_16x16x64_bf16 v[52:55], v[72:75], a[216:223], v14 abid:1
    v_smfmac_f32_16x16x64_bf16 v[56:59], v[72:75], a[224:231], v14 abid:1
    v_smfmac_f32_16x16x64_bf16 v[60:63], v[72:75], a[232:239], v14 abid:1
    s_waitcnt lgkmcnt(3)
    v_smfmac_f32_16x16x64_bf16 v[40:43], v[76:79], v[112:119], v14 abid:1
    v_smfmac_f32_16x16x64_bf16 v[44:47], v[76:79], v[120:127], v14 abid:1
    v_smfmac_f32_16x16x64_bf16 v[48:51], v[76:79], v[128:135], v14 abid:1
    v_smfmac_f32_16x16x64_bf16 v[52:55], v[76:79], v[136:143], v14 abid:1
    v_smfmac_f32_16x16x64_bf16 v[56:59], v[76:79], v[144:151], v14 abid:1
    v_smfmac_f32_16x16x64_bf16 v[60:63], v[76:79], v[152:159], v14 abid:1
    s_waitcnt lgkmcnt(2)
    v_smfmac_f32_16x16x64_bf16 v[40:43], v[80:83], v[160:167], v14 abid:1
    v_smfmac_f32_16x16x64_bf16 v[44:47], v[80:83], v[168:175], v14 abid:1
    v_smfmac_f32_16x16x64_bf16 v[48:51], v[80:83], v[176:183], v14 abid:1
    v_smfmac_f32_16x16x64_bf16 v[52:55], v[80:83], v[184:191], v14 abid:1
    v_smfmac_f32_16x16x64_bf16 v[56:59], v[80:83], v[192:199], v14 abid:1
    v_smfmac_f32_16x16x64_bf16 v[60:63], v[80:83], v[200:207], v14 abid:1
    s_waitcnt lgkmcnt(0)
ATT_LAST:
    s_waitcnt lgkmcnt(8)
    v_smfmac_f32_16x16x64_bf16 v[40:43], v[84:87], v[208:215], v14 abid:1
    v_smfmac_f32_16x16x64_bf16 v[44:47], v[84:87], v[216:223], v14 abid:1
    s_waitcnt lgkmcnt(4)
    v_smfmac_f32_16x16x64_bf16 v[48:51], v[84:87], v[224:231], v14 abid:1
    v_smfmac_f32_16x16x64_bf16 v[52:55], v[84:87], v[232:239], v14 abid:1
    s_waitcnt lgkmcnt(0)
    v_smfmac_f32_16x16x64_bf16 v[56:59], v[84:87], v[240:247], v14 abid:1
    v_smfmac_f32_16x16x64_bf16 v[60:63], v[84:87], v[248:255], v14 abid:1
    s_lshl_b32 s77, s72, 8
    s_add_u32 s77, s77, 119296
    v_lshl_add_u32 v24, v0, 2, s77
    v_permlane16_swap_b32 v40, v44
    v_add_f32 v40, v40, v44
    ds_write_b32 v15, v40 offset:0
    v_permlane16_swap_b32 v48, v52
    v_add_f32 v48, v48, v52
    ds_write_b32 v15, v48 offset:256
    v_permlane16_swap_b32 v56, v60
    v_add_f32 v56, v56, v60
    ds_write_b32 v15, v56 offset:512
    v_and_b32 v25, 3, v0
    v_mad_u32_u24 v26, v25, 48, v1
    v_lshlrev_b32 v25, 3, v25
    v_add_u32 v25, 125440, v25
    s_waitcnt lgkmcnt(0)
    s_barrier
    ds_read_b64 v[32:33], v25
    ds_read2st64_b32 v[40:41], v24 offset0:0 offset1:3
    ds_read2st64_b32 v[42:43], v24 offset0:6 offset1:9
    s_mul_i32 s77, s70, 3072
    s_lshl_b32 s78, s71, 4
    s_add_u32 s77, s77, s78
    s_lshl_b32 s78, s72, 10
    s_add_u32 s77, s77, s78
    s_add_u32 s77, s77, s3
    s_add_u32 s77, s77, 32768
    s_lshl_b32 s78, s69, 3
    s_add_u32 s78, s78, s3
    s_add_u32 s78, s78, 45056
    s_cmp_eq_u32 s72, 3
    s_waitcnt lgkmcnt(2)
    v_max_f32_dpp v34, v32, v32 quad_perm:[1,0,3,2] row_mask:0xf bank_mask:0xf
    s_nop 1
    v_max_f32_dpp v34, v34, v34 quad_perm:[2,3,0,1] row_mask:0xf bank_mask:0xf
    v_sub_f32 v32, v32, v34
    v_exp_f32 v32, v32
    s_cbranch_scc1 OML
    s_waitcnt lgkmcnt(0)
    v_mul_f32_dpp v28, v32, v40 quad_perm:[0,0,0,0] row_mask:0xf bank_mask:0xf
    v_mul_f32_dpp v29, v32, v41 quad_perm:[1,1,1,1] row_mask:0xf bank_mask:0xf
    v_mul_f32_dpp v30, v32, v42 quad_perm:[2,2,2,2] row_mask:0xf bank_mask:0xf
    v_fmac_f32_dpp v28, v32, v43 quad_perm:[3,3,3,3] row_mask:0xf bank_mask:0xf
    v_add_f32 v29, v29, v30
    v_add_f32 v28, v28, v29
    s_nop 1
    v_mov_b32_dpp v29, v28 row_shl:1 row_mask:0xf bank_mask:0xf
    v_cvt_pk_bf16_f32 v28, v28, v29
    s_nop 1
    v_mov_b32_dpp v29, v28 row_shl:4 row_mask:0xf bank_mask:0xf
    v_mov_b32_dpp v30, v28 row_shl:8 row_mask:0xf bank_mask:0xf
    v_mov_b32_dpp v31, v28 row_shl:12 row_mask:0xf bank_mask:0xf
    s_mov_b64 exec, s[82:83]
    buffer_store_dwordx4 v[28:31], v26, s[8:11], s77 offen
    s_cmp_eq_u32 s10, 0
    s_cbranch_scc1 SLOW7
BACK7:
    s_mov_b64 exec, -1
ODONE:
    s_cmp_ge_u32 s69, 20
    s_cbranch_scc1 ROLEF
    s_cmp_eq_u32 s74, 0
    s_cbranch_scc1 WLATE
    v_accvgpr_read_b32 v2, a246
    v_accvgpr_read_b32 v3, a247
    v_accvgpr_read_b32 v4, a248
    ds_read_b64_tr_b16 v[40:41], v2 offset:0
    ds_read_b64_tr_b16 v[42:43], v2 offset:256
    ds_read_b64_tr_b16 v[64:65], v2 offset:32
    ds_read_b64_tr_b16 v[66:67], v2 offset:288
    ds_read_b64_tr_b16 v[44:45], v2 offset:2048
    ds_read_b64_tr_b16 v[46:47], v2 offset:2304
    ds_read_b64_tr_b16 v[68:69], v2 offset:2080
    ds_read_b64_tr_b16 v[70:71], v2 offset:2336
    ds_read_b64_tr_b16 v[48:49], v2 offset:4096
    ds_read_b64_tr_b16 v[50:51], v2 offset:4352
    s_cmp_lg_u32 s72, 1
    s_cbranch_scc1 NOOWN0
    v_accvgpr_read_b32 v28, a244
    v_accvgpr_read_b32 v29, a245
    v_max_u32 v30, v28, v29
    v_cmp_eq_u32 vcc, -1, v30
    s_cbranch_vccnz RETRY8
OK8:
    v_lshlrev_b32 v30, 16, v28
    v_and_b32 v28, 0xffff0000, v28
    v_lshlrev_b32 v31, 16, v29
    v_and_b32 v29, 0xffff0000, v29
    v_add_f32 v30, v30, v31
    v_add_f32 v28, v28, v29
    v_mov_b32 v31, v30
    v_mov_b32 v29, v28
    s_nop 0
    v_permlane32_swap_b32 v30, v31
    v_permlane32_swap_b32 v28, v29
    v_add_f32 v30, v30, v31
    v_add_f32 v28, v28, v29
    v_mov_b32 v31, v30
    v_mov_b32 v29, v28
    s_nop 0
    v_permlane16_swap_b32 v30, v31
    v_permlane16_swap_b32 v28, v29
    v_add_f32 v30, v30, v31
    v_add_f32 v28, v28, v29
    v_add_f32 v22, v22, v30
    v_add_f32 v23, v23, v28
    v_cvt_pk_bf16_f32 v28, v22, v23
    s_lshl_b32 s77, s69, 6
    s_add_u32 s77, s77, s3
    s_add_u32 s77, s77, 47872
    v_lshlrev_b32 v32, 2, v0
    v_mov_b32_dpp v29, v28 quad_perm:[1,1,1,1] row_mask:0xf bank_mask:0xf
    v_mov_b32_dpp v30, v28 quad_perm:[2,2,2,2] row_mask:0xf bank_mask:0xf
    v_mov_b32_dpp v31, v28 quad_perm:[3,3,3,3] row_mask:0xf bank_mask:0xf
    s_mov_b32 exec_lo, 0x1111
    s_mov_b32 exec_hi, 0x0
    buffer_store_dwordx4 v[28:31], v32, s[8:11], s77 offen
    s_cmp_eq_u32 s10, 0
    s_cbranch_scc1 SLOW9
BACK9:
    s_mov_b64 exec, -1
NOOWN0:
    buffer_load_dwordx2 v[24:25], v4, s[16:19], s3 offen sc1
    buffer_load_dwordx4 v[88:91], v3, s[16:19], s3 offen offset:0 sc1
    buffer_load_dwordx4 v[92:95], v3, s[16:19], s3 offen offset:1024 sc1
    buffer_load_dwordx4 v[96:99], v3, s[16:19], s3 offen offset:2048 sc1
    ds_read_b64_tr_b16 v[72:73], v2 offset:4128
    ds_read_b64_tr_b16 v[74:75], v2 offset:4384
    ds_read_b64_tr_b16 v[52:53], v2 offset:6144
    ds_read_b64_tr_b16 v[54:55], v2 offset:6400
    ds_read_b64_tr_b16 v[76:77], v2 offset:6176
    ds_read_b64_tr_b16 v[78:79], v2 offset:6432
    ds_read_b64_tr_b16 v[56:57], v2 offset:8192
    ds_read_b64_tr_b16 v[58:59], v2 offset:8448
    ds_read_b64_tr_b16 v[80:81], v2 offset:8224
    ds_read_b64_tr_b16 v[82:83], v2 offset:8480
    ds_read_b64_tr_b16 v[60:61], v2 offset:10240
    ds_read_b64_tr_b16 v[62:63], v2 offset:10496
    ds_read_b64_tr_b16 v[84:85], v2 offset:10272
    ds_read_b64_tr_b16 v[86:87], v2 offset:10528
    v_accvgpr_read_b32 v5, a249
    v_and_b32 v18, 3, v0
    v_lshrrev_b32 v6, 5, v0
    v_lshl_add_u32 v18, v6, 2, v18
    v_mul_u32_u24 v18, 10240, v18
    v_bfe_u32 v6, v0, 3, 2
    v_lshl_add_u32 v18, v6, 4, v18
    v_and_b32 v6, 0xffffff7f, v5
    v_bfe_u32 v26, v0, 3, 1
    v_mul_u32_u24 v26, 0xaaaa, v26
    v_add_u32 v26, 0x4444, v26
    v_mov_b32 v28, 0
    v_mov_b32 v29, 0
    v_mov_b32 v30, 0
    v_mov_b32 v31, 0
    v_mov_b32 v32, 0
    v_mov_b32 v33, 0
    v_mov_b32 v34, 0
    v_mov_b32 v35, 0
WCHK:
    s_waitcnt vmcnt(0)
    v_max3_u32 v38, v88, v92, v96
    v_max_u32 v38, v38, v25
    v_cmp_eq_u32 vcc, -1, v38
    s_cbranch_vccnz AGAIN10
POLLX10:
    s_waitcnt lgkmcnt(0)
    v_max_f32_dpp v27, v24, v24 quad_perm:[1,0,3,2] row_mask:0xf bank_mask:0xf
    v_smfmac_f32_16x16x64_bf16 v[28:31], v[88:91], v[40:47], v26
    v_smfmac_f32_16x16x64_bf16 v[32:35], v[88:91], v[64:71], v26
    v_max_f32_dpp v27, v27, v27 quad_perm:[2,3,0,1] row_mask:0xf bank_mask:0xf
    v_smfmac_f32_16x16x64_bf16 v[28:31], v[92:95], v[48:55], v26
    v_smfmac_f32_16x16x64_bf16 v[32:35], v[92:95], v[72:79], v26
    v_max_f32_dpp v27, v27, v27 row_ror:4 row_mask:0xf bank_mask:0xf
    v_sub_f32 v24, v24, v27
    v_exp_f32 v24, v24
    v_smfmac_f32_16x16x64_bf16 v[28:31], v[96:99], v[56:63], v26
    v_smfmac_f32_16x16x64_bf16 v[32:35], v[96:99], v[80:87], v26
    v_mul_f32 v36, v24, v25
    s_cmp_lg_u32 s72, 0
    s_nop 0
    v_add_f32_dpp v36, v36, v36 quad_perm:[1,0,3,2] row_mask:0xf bank_mask:0xf
    s_nop 1
    v_add_f32_dpp v36, v36, v36 quad_perm:[2,3,0,1] row_mask:0xf bank_mask:0xf
    v_mul_f32_dpp v28, v24, v28 row_newbcast:0 row_mask:0xf bank_mask:0xf
    v_mul_f32_dpp v30, v24, v30 row_newbcast:2 row_mask:0xf bank_mask:0xf
    v_add_f32_dpp v36, v36, v36 row_ror:4 row_mask:0xf bank_mask:0xf
    v_mul_f32_dpp v32, v24, v32 row_newbcast:0 row_mask:0xf bank_mask:0xf
    v_mul_f32_dpp v34, v24, v34 row_newbcast:2 row_mask:0xf bank_mask:0xf
    v_rcp_f32 v36, v36
    v_fmac_f32_dpp v28, v24, v29 row_newbcast:1 row_mask:0xf bank_mask:0xf
    v_fmac_f32_dpp v30, v24, v31 row_newbcast:3 row_mask:0xf bank_mask:0xf
    v_fmac_f32_dpp v32, v24, v33 row_newbcast:1 row_mask:0xf bank_mask:0xf
    v_fmac_f32_dpp v34, v24, v35 row_newbcast:3 row_mask:0xf bank_mask:0xf
    v_add_f32 v28, v28, v30
    v_add_f32 v32, v32, v34
    s_nop 1
    v_permlane16_swap_b32 v28, v32
    v_add_f32 v37, v28, v32
    v_add_f32 v28, v28, v32
    s_nop 1
    v_permlane32_swap_b32 v28, v37
    v_add_f32 v28, v28, v37
    v_mul_f32 v28, v28, v36
    ds_write_b32 v5, v28
    s_waitcnt lgkmcnt(0)
    s_barrier
    s_cbranch_scc1 WNOT0
    ds_read2st64_b32 v[28:29], v6 offset0:0 offset1:1
    ds_read2st64_b32 v[30:31], v6 offset0:2 offset1:3
    s_waitcnt lgkmcnt(1)
    v_add_f32 v28, v28, v29
    s_waitcnt lgkmcnt(0)
    v_add_f32 v30, v30, v31
    v_add_f32 v28, v28, v30
    s_nop 1
    v_mov_b32_dpp v29, v28 row_shl:1 row_mask:0xf bank_mask:0xf
    v_cvt_pk_bf16_f32 v32, v28, v29
    s_nop 1
    v_mov_b32_dpp v28, v32 quad_perm:[0,0,0,0] row_mask:0xf bank_mask:0xf
    v_mov_b32_dpp v29, v32 quad_perm:[2,2,2,2] row_mask:0xf bank_mask:0xf
    s_nop 0
    v_mov_b32_dpp v30, v28 row_shl:4 row_mask:0xf bank_mask:0xf
    v_mov_b32_dpp v31, v29 row_shl:4 row_mask:0xf bank_mask:0xf
    s_mov_b64 exec, s[46:47]
    buffer_store_dwordx4 v[28:31], v18, s[16:19], s80 offen sc1
    s_mov_b64 exec, s[92:93]
    buffer_store_dwordx4 v[28:31], v18, s[8:11], s81 offen
    s_cmp_eq_u32 s10, 0
    s_cbranch_scc1 SLOW11
BACK11:
    s_mov_b64 exec, -1
    v_add_u32 v111, 49152, v2
    s_cmp_lg_u32 s74, 0
    s_cbranch_scc1 W2OK
    v_lshrrev_b32 v38, 2, v0
    v_mul_u32_u24 v38, 1280, v38
    v_and_b32 v39, 3, v0
    v_lshl_add_u32 v39, v39, 4, v38
    s_mul_i32 s77, s68, 245760
    s_lshl_b32 s78, s69, 6
    s_add_u32 s77, s77, s78
    s_mov_b32 m0, 106496
    s_nop 0
    buffer_load_dwordx4 v39, s[32:35], s77 offen lds
    s_add_u32 s77, s77, 20480
    s_mov_b32 m0, 107520
    s_nop 0
    buffer_load_dwordx4 v39, s[32:35], s77 offen lds
    s_add_u32 s77, s77, 20480
    s_mov_b32 m0, 108544
    s_nop 0
    buffer_load_dwordx4 v39, s[32:35], s77 offen lds
    s_add_u32 s77, s77, 20480
    s_mov_b32 m0, 109568
    s_nop 0
    buffer_load_dwordx4 v39, s[32:35], s77 offen lds
    s_add_u32 s77, s77, 20480
    s_mov_b32 m0, 110592
    s_nop 0
    buffer_load_dwordx4 v39, s[32:35], s77 offen lds
    s_add_u32 s77, s77, 20480
    s_mov_b32 m0, 111616
    s_nop 0
    buffer_load_dwordx4 v39, s[32:35], s77 offen lds
    s_add_u32 s77, s77, 20480
    s_mov_b32 m0, 112640
    s_nop 0
    buffer_load_dwordx4 v39, s[32:35], s77 offen lds
    s_add_u32 s77, s77, 20480
    s_mov_b32 m0, 113664
    s_nop 0
    buffer_load_dwordx4 v39, s[32:35], s77 offen lds
    s_add_u32 s77, s77, 20480
    s_mov_b32 m0, 114688
    s_nop 0
    buffer_load_dwordx4 v39, s[32:35], s77 offen lds
    s_add_u32 s77, s77, 20480
    s_mov_b32 m0, 115712
    s_nop 0
    buffer_load_dwordx4 v39, s[32:35], s77 offen lds
    s_add_u32 s77, s77, 20480
    s_mov_b32 m0, 116736
    s_nop 0
    buffer_load_dwordx4 v39, s[32:35], s77 offen lds
    s_add_u32 s77, s77, 20480
    s_mov_b32 m0, 117760
    s_nop 0
    buffer_load_dwordx4 v39, s[32:35], s77 offen lds
    s_add_u32 s77, s77, 20480
    s_branch W2X
W2OK:
    ds_read_b64_tr_b16 v[40:41], v111 offset:0
    ds_read_b64_tr_b16 v[42:43], v111 offset:256
    ds_read_b64_tr_b16 v[64:65], v111 offset:32
    ds_read_b64_tr_b16 v[66:67], v111 offset:288
    ds_read_b64_tr_b16 v[44:45], v111 offset:2048
    ds_read_b64_tr_b16 v[46:47], v111 offset:2304
    ds_read_b64_tr_b16 v[68:69], v111 offset:2080
    ds_read_b64_tr_b16 v[70:71], v111 offset:2336
    ds_read_b64_tr_b16 v[48:49], v111 offset:4096
    ds_read_b64_tr_b16 v[50:51], v111 offset:4352
    ds_read_b64_tr_b16 v[72:73], v111 offset:4128
    ds_read_b64_tr_b16 v[74:75], v111 offset:4384
    ds_read_b64_tr_b16 v[52:53], v111 offset:6144
    ds_read_b64_tr_b16 v[54:55], v111 offset:6400
    ds_read_b64_tr_b16 v[76:77], v111 offset:6176
    ds_read_b64_tr_b16 v[78:79], v111 offset:6432
    ds_read_b64_tr_b16 v[56:57], v111 offset:8192
    ds_read_b64_tr_b16 v[58:59], v111 offset:8448
    ds_read_b64_tr_b16 v[80:81], v111 offset:8224
    ds_read_b64_tr_b16 v[82:83], v111 offset:8480
    ds_read_b64_tr_b16 v[60:61], v111 offset:10240
    ds_read_b64_tr_b16 v[62:63], v111 offset:10496
    ds_read_b64_tr_b16 v[84:85], v111 offset:10272
    ds_read_b64_tr_b16 v[86:87], v111 offset:10528
W2X:
    v_mov_b32 v100, 0
    v_mov_b32 v101, 0
    v_mov_b32 v104, 0
    v_mov_b32 v105, 0
    s_add_u32 s96, s80, 81920
    s_add_u32 s97, s81, 1280
STB:
    s_mul_i32 s77, s72, 48
    v_min_u32 v6, 47, v0
    v_add_u32 v6, s77, v6
    v_lshlrev_b32 v4, 4, v6
    v_add_u32 v108, 7168, v4
    v_lshlrev_b32 v4, 3, v6
    v_cmp_le_u32 vcc, 48, v0
    v_mov_b32 v24, 1536
    s_nop 0
    v_cndmask_b32 v4, v4, v24, vcc
    v_add_u32 v5, 3584, v4
    v_lshrrev_b32 v24, 4, v6
    v_lshlrev_b32 v24, 5, v24
    v_bfe_u32 v25, v6, 1, 1
    v_lshl_add_u32 v24, v25, 4, v24
    v_bfe_u32 v25, v6, 2, 2
    v_lshl_add_u32 v24, v25, 2, v24
    v_and_b32 v25, 1, v6
    v_lshl_add_u32 v24, v25, 1, v24
    v_add_u32 v24, 118784, v24
    v_mov_b32 v25, 119168
    v_cndmask_b32 v6, v24, v25, vcc
    v_mov_b32 v109, 0x3727c5ac
    v_mov_b32 v110, 0x3acccccd
    s_add_u32 s79, s3, 50432
    v_accvgpr_read_b32 v2, a250
    v_accvgpr_read_b32 v3, a251
    s_add_u32 s6, s74, s72
    s_mov_b32 s76, 1
    s_cmp_eq_u32 s74, 0
    s_cbranch_scc1 GPF
GPO:
    s_cmp_eq_u32 s72, 1
    s_cbranch_scc1 WOWN
GP1:
    buffer_load_dwordx2 v[32:33], v4, s[16:19], s79 offen offset:0 sc1
    buffer_load_dwordx2 v[34:35], v4, s[16:19], s79 offen offset:1792 sc1
    buffer_load_dwordx2 v[36:37], v5, s[16:19], s79 offen offset:0 sc1
    buffer_load_dwordx2 v[38:39], v5, s[16:19], s79 offen offset:1792 sc1
    s_waitcnt vmcnt(0)
    v_add_f32 v24, v32, v34
    v_add_f32 v28, v33, v35
    v_add_f32 v26, v36, v38
    v_add_f32 v30, v37, v39
    v_add_f32 v28, v28, v30
    v_add_f32 v24, v24, v26
    v_cmp_u_f32 vcc, v24, v28
    s_cbranch_vccnz GA1
GPX:
    v_readlane_b32 s77, v28, 48
    v_readlane_b32 s78, v24, 48
    s_cmp_lg_u32 s6, 1
    s_cbranch_scc0 OWL
OWB:
    v_mul_f32 v25, s77, v110
    v_fma_f32 v26, s78, v110, v109
    v_fma_f32 v26, -v25, v25, v26
    v_add_f32 v25, 1.0, v25
    v_max_f32 v26, v26, v109
    v_fma_f32 v24, -v25, v2, v24
    v_rsq_f32 v27, v26
    v_mul_f32 v29, 0xbfb8aa3b, v24
    v_mul_f32 v29, v29, v27
    v_exp_f32 v29, v29
    v_fma_f32 v28, -v25, v3, v28
    v_fma_f32 v29, v29, v26, v26
    v_rcp_f32 v29, v29
    v_mul_f32 v28, v28, v24
    v_mul_f32 v28, v28, v29
    v_cvt_pk_bf16_f32 v28, v28, v28
    ds_write_b16 v6, v28
    v_accvgpr_write_b32 a250, v2
    v_accvgpr_write_b32 a251, v3
    s_cmp_lg_u32 s72, 0
    s_waitcnt lgkmcnt(0)
    s_barrier
    s_cbranch_scc1 STBX
    ds_read_b128 v[88:91], v13 offset:0
    ds_read_b128 v[92:95], v13 offset:128
    ds_read_b128 v[96:99], v13 offset:256
    s_waitcnt lgkmcnt(2)
    v_smfmac_f32_16x16x64_bf16 v[100:103], v[88:91], v[40:47], v14
    v_smfmac_f32_16x16x64_bf16 v[104:107], v[88:91], v[64:71], v14
    s_waitcnt lgkmcnt(1)
    v_smfmac_f32_16x16x64_bf16 v[100:103], v[92:95], v[48:55], v14
    v_smfmac_f32_16x16x64_bf16 v[104:107], v[92:95], v[72:79], v14
    s_waitcnt lgkmcnt(0)
    v_smfmac_f32_16x16x64_bf16 v[100:103], v[96:99], v[56:63], v14
    v_smfmac_f32_16x16x64_bf16 v[104:107], v[96:99], v[80:87], v14
    s_nop 6
    v_add_f32 v28, v100, v101
    s_nop 1
    v_add_f32_dpp v28, v104, v105 quad_perm:[0,1,2,3] row_mask:0xa bank_mask:0xf
    s_nop 1
    v_mov_b32_dpp v29, v28 row_shl:1 row_mask:0xf bank_mask:0xf
    v_cvt_pk_bf16_f32 v32, v28, v29
    s_nop 1
    v_mov_b32_dpp v28, v32 quad_perm:[0,0,0,0] row_mask:0xf bank_mask:0xf
    v_mov_b32_dpp v29, v32 quad_perm:[2,2,2,2] row_mask:0xf bank_mask:0xf
    s_nop 0
    v_mov_b32_dpp v30, v28 row_shl:4 row_mask:0xf bank_mask:0xf
    v_mov_b32_dpp v31, v29 row_shl:4 row_mask:0xf bank_mask:0xf
    s_mov_b64 exec, s[48:49]
    buffer_store_dwordx4 v[28:31], v18, s[16:19], s96 offen sc1
    s_mov_b64 exec, s[92:93]
    buffer_store_dwordx4 v[28:31], v18, s[8:11], s97 offen
    s_cmp_eq_u32 s10, 0
    s_cbranch_scc1 SLOW12
BACK12:
    s_mov_b64 exec, -1
    s_branch NEXT
AGAIN3:
    s_add_u32 s76, s76, 1
    s_cmp_lt_u32 s76, 32768
    s_cbranch_scc1 POLL3
    s_branch POLLX3
BR4:
    s_cmp_ge_u32 s76, 32768
    s_cbranch_scc1 BX4
    s_mov_b64 exec, vcc
    buffer_load_dwordx4 v[80:83], v8, s[16:19], 0 offen sc1
    s_add_u32 s76, s76, 1
    s_waitcnt vmcnt(0)
    s_branch BW4
AGAIN6:
    s_add_u32 s76, s76, 1
    s_cmp_lt_u32 s76, 32768
    s_cbranch_scc1 POLL6
    s_branch POLLX6
OML:
    v_mul_f32 v35, v32, v33
    s_nop 1
    v_add_f32_dpp v35, v35, v35 quad_perm:[1,0,3,2] row_mask:0xf bank_mask:0xf
    s_nop 1
    v_add_f32_dpp v35, v35, v35 quad_perm:[2,3,0,1] row_mask:0xf bank_mask:0xf
    s_mov_b64 exec, 1
    buffer_store_dwordx2 v[34:35], v1, s[8:11], s78 offen
    s_cmp_eq_u32 s10, 0
    s_cbranch_scc1 SLOW13
BACK13:
    s_mov_b64 exec, -1
    s_waitcnt lgkmcnt(0)
    s_branch ODONE
WLATE:
    v_lshrrev_b32 v38, 2, v0
    v_mul_u32_u24 v38, 1280, v38
    v_and_b32 v39, 3, v0
    v_lshl_add_u32 v39, v39, 4, v38
    s_mov_b32 m0, s67
    s_add_u32 s67, s67, 1024
    buffer_load_dwordx4 v39, s[24:27], s66 offen  lds
    s_add_u32 s66, s66, 20480
    s_mov_b32 m0, s67
    s_add_u32 s67, s67, 1024
    buffer_load_dwordx4 v39, s[24:27], s66 offen  lds
    s_add_u32 s66, s66, 20480
    s_mov_b32 m0, s67
    s_add_u32 s67, s67, 1024
    buffer_load_dwordx4 v39, s[24:27], s66 offen  lds
    s_add_u32 s66, s66, 20480
    s_mov_b32 m0, s67
    s_add_u32 s67, s67, 1024
    buffer_load_dwordx4 v39, s[24:27], s66 offen  lds
    s_add_u32 s66, s66, 20480
    s_mov_b32 m0, s67
    s_add_u32 s67, s67, 1024
    buffer_load_dwordx4 v39, s[24:27], s66 offen  lds
    s_add_u32 s66, s66, 20480
    s_mov_b32 m0, s67
    s_add_u32 s67, s67, 1024
    buffer_load_dwordx4 v39, s[24:27], s66 offen  lds
    s_add_u32 s66, s66, 20480
    v_accvgpr_read_b32 v2, a246
    v_accvgpr_read_b32 v3, a247
    v_accvgpr_read_b32 v4, a248
    buffer_load_dwordx2 v[24:25], v4, s[16:19], s3 offen sc1
    buffer_load_dwordx4 v[88:91], v3, s[16:19], s3 offen offset:0 sc1
    buffer_load_dwordx4 v[92:95], v3, s[16:19], s3 offen offset:1024 sc1
    buffer_load_dwordx4 v[96:99], v3, s[16:19], s3 offen offset:2048 sc1
    s_add_u32 s77, s3, 1638400
    buffer_store_dword v7, v10, s[8:11], s77 offen
    s_cmp_eq_u32 s10, 0
    s_cbranch_scc1 SLOW14
BACK14:
    v_accvgpr_read_b32 v5, a249
    v_and_b32 v18, 3, v0
    v_lshrrev_b32 v6, 5, v0
    v_lshl_add_u32 v18, v6, 2, v18
    v_mul_u32_u24 v18, 10240, v18
    v_bfe_u32 v6, v0, 3, 2
    v_lshl_add_u32 v18, v6, 4, v18
    v_and_b32 v6, 0xffffff7f, v5
    v_bfe_u32 v26, v0, 3, 1
    v_mul_u32_u24 v26, 0xaaaa, v26
    v_add_u32 v26, 0x4444, v26
    v_mov_b32 v28, 0
    v_mov_b32 v29, 0
    v_mov_b32 v30, 0
    v_mov_b32 v31, 0
    v_mov_b32 v32, 0
    v_mov_b32 v33, 0
    v_mov_b32 v34, 0
    v_mov_b32 v35, 0
    s_waitcnt vmcnt(11)
    ds_read_b64_tr_b16 v[40:41], v2 offset:0
    ds_read_b64_tr_b16 v[42:43], v2 offset:256
    ds_read_b64_tr_b16 v[64:65], v2 offset:32
    ds_read_b64_tr_b16 v[66:67], v2 offset:288
    ds_read_b64_tr_b16 v[44:45], v2 offset:2048
    ds_read_b64_tr_b16 v[46:47], v2 offset:2304
    ds_read_b64_tr_b16 v[68:69], v2 offset:2080
    ds_read_b64_tr_b16 v[70:71], v2 offset:2336
    ds_read_b64_tr_b16 v[48:49], v2 offset:4096
    ds_read_b64_tr_b16 v[50:51], v2 offset:4352
    ds_read_b64_tr_b16 v[72:73], v2 offset:4128
    ds_read_b64_tr_b16 v[74:75], v2 offset:4384
    s_waitcnt vmcnt(5)
    ds_read_b64_tr_b16 v[52:53], v2 offset:6144
    ds_read_b64_tr_b16 v[54:55], v2 offset:6400
    ds_read_b64_tr_b16 v[76:77], v2 offset:6176
    ds_read_b64_tr_b16 v[78:79], v2 offset:6432
    ds_read_b64_tr_b16 v[56:57], v2 offset:8192
    ds_read_b64_tr_b16 v[58:59], v2 offset:8448
    ds_read_b64_tr_b16 v[80:81], v2 offset:8224
    ds_read_b64_tr_b16 v[82:83], v2 offset:8480
    ds_read_b64_tr_b16 v[60:61], v2 offset:10240
    ds_read_b64_tr_b16 v[62:63], v2 offset:10496
    ds_read_b64_tr_b16 v[84:85], v2 offset:10272
    ds_read_b64_tr_b16 v[86:87], v2 offset:10528
    s_branch WCHK
AGAIN10:
    s_mov_b64 s[94:95], exec
    s_mov_b32 s76, 1
AG210:
    s_mov_b64 exec, vcc
    buffer_load_dwordx2 v[24:25], v4, s[16:19], s3 offen sc1
    buffer_load_dwordx4 v[88:91], v3, s[16:19], s3 offen offset:0 sc1
    buffer_load_dwordx4 v[92:95], v3, s[16:19], s3 offen offset:1024 sc1
    buffer_load_dwordx4 v[96:99], v3, s[16:19], s3 offen offset:2048 sc1
AG310_0:
    s_mov_b64 exec, s[94:95]
    s_add_u32 s76, s76, 1
    s_cmp_ge_u32 s76, 32768
    s_waitcnt vmcnt(0)
    v_max3_u32 v38, v88, v92, v96
    v_max_u32 v38, v38, v25
    v_cmp_eq_u32 vcc, -1, v38
    s_cbranch_vccz POLLX10
    s_cbranch_scc0 AG210
    s_branch POLLX10
GA1:
    s_add_u32 s76, s76, 1
    s_cmp_lt_u32 s76, 32768
    s_cbranch_scc1 GP1
    s_branch GPX
GPF:
    s_cmp_lg_u32 s72, 0
    s_cbranch_scc1 GP0
    buffer_load_dwordx4 v[32:35], v108, s[16:19], s79 offen sc1
    buffer_load_dwordx4 v[36:39], v108, s[16:19], s79 offen offset:3072 sc1
    s_waitcnt vmcnt(2)
    ds_read_b64_tr_b16 v[40:41], v111 offset:0
    ds_read_b64_tr_b16 v[42:43], v111 offset:256
    ds_read_b64_tr_b16 v[64:65], v111 offset:32
    ds_read_b64_tr_b16 v[66:67], v111 offset:288
    ds_read_b64_tr_b16 v[44:45], v111 offset:2048
    ds_read_b64_tr_b16 v[46:47], v111 offset:2304
    ds_read_b64_tr_b16 v[68:69], v111 offset:2080
    ds_read_b64_tr_b16 v[70:71], v111 offset:2336
    ds_read_b64_tr_b16 v[48:49], v111 offset:4096
    ds_read_b64_tr_b16 v[50:51], v111 offset:4352
    ds_read_b64_tr_b16 v[72:73], v111 offset:4128
    ds_read_b64_tr_b16 v[74:75], v111 offset:4384
    ds_read_b64_tr_b16 v[52:53], v111 offset:6144
    ds_read_b64_tr_b16 v[54:55], v111 offset:6400
    ds_read_b64_tr_b16 v[76:77], v111 offset:6176
    ds_read_b64_tr_b16 v[78:79], v111 offset:6432
    ds_read_b64_tr_b16 v[56:57], v111 offset:8192
    ds_read_b64_tr_b16 v[58:59], v111 offset:8448
    ds_read_b64_tr_b16 v[80:81], v111 offset:8224
    ds_read_b64_tr_b16 v[82:83], v111 offset:8480
    ds_read_b64_tr_b16 v[60:61], v111 offset:10240
    ds_read_b64_tr_b16 v[62:63], v111 offset:10496
    ds_read_b64_tr_b16 v[84:85], v111 offset:10272
    ds_read_b64_tr_b16 v[86:87], v111 offset:10528
    s_branch GPW
GP0:
    buffer_load_dwordx4 v[32:35], v108, s[16:19], s79 offen sc1
    buffer_load_dwordx4 v[36:39], v108, s[16:19], s79 offen offset:3072 sc1
GPW:
    s_add_u32 s76, s76, 1
    s_cmp_ge_u32 s76, 32768
    s_waitcnt vmcnt(0)
    v_add_f32 v2, v32, v33
    v_add_f32 v3, v36, v37
    v_add_f32 v34, v34, v35
    v_add_f32 v38, v38, v39
    v_add_f32 v2, v2, v34
    v_add_f32 v3, v3, v38
    v_cmp_u_f32 vcc, v2, v3
    s_cbranch_scc1 GPO
    s_cbranch_vccnz GP0
    s_branch GPO
OWL:
    buffer_load_dword v34, v100, s[16:19], 0 offen sc1
    buffer_load_dword v35, v101, s[16:19], 0 offen sc1
    s_branch OWB
WNOT0:
    s_cmp_lg_u32 s74, 0
    s_cbranch_scc1 STB
    s_cmp_eq_u32 s72, 1
    s_cbranch_scc1 WPREP
    s_cmp_eq_u32 s72, 3
    s_cbranch_scc1 WLC
    v_mov_b32 v52, -1
    v_mov_b32 v53, -1
    v_mov_b32 v54, -1
    v_mov_b32 v55, -1
    s_add_u32 s77, s80, 819200
    s_add_u32 s7, s77, 81920
    s_sleep 8
    s_mov_b64 exec, s[44:45]
    buffer_store_dwordx4 v[52:55], v18, s[16:19], s77 offen sc1
    s_mov_b64 exec, s[92:93]
    buffer_store_dwordx4 v[52:55], v18, s[16:19], s7 offen sc1
    s_mov_b64 exec, -1
    s_branch WPREP
WLC:
    s_mul_i32 s77, s69, 1248
    s_add_u32 s78, s3, 851968
    v_add_u32 v100, s77, v1
    v_min_u32 v100, 24816, v100
    s_add_u32 s77, s77, 1024
    v_add_u32 v101, s77, v1
    v_min_u32 v101, 24816, v101
    s_add_u32 s77, s77, 1024
    v_mov_b32 v104, -1
    v_mov_b32 v105, -1
    v_mov_b32 v106, -1
    v_mov_b32 v107, -1
    ds_read_b64_tr_b16 v[40:41], v16 offset:0
    ds_read_b64_tr_b16 v[42:43], v16 offset:1536
    ds_read_b64_tr_b16 v[44:45], v16 offset:12288
    ds_read_b64_tr_b16 v[46:47], v16 offset:13824
    ds_read_b64_tr_b16 v[48:49], v17 offset:24576
    ds_read_b64_tr_b16 v[50:51], v16 offset:32
    ds_read_b64_tr_b16 v[52:53], v16 offset:1568
    ds_read_b64_tr_b16 v[54:55], v16 offset:12320
    ds_read_b64_tr_b16 v[56:57], v16 offset:13856
    ds_read_b64_tr_b16 v[58:59], v17 offset:24608
    ds_read_b64_tr_b16 v[60:61], v16 offset:64
    ds_read_b64_tr_b16 v[62:63], v16 offset:1600
    ds_read_b64_tr_b16 v[64:65], v16 offset:12352
    ds_read_b64_tr_b16 v[66:67], v16 offset:13888
    ds_read_b64_tr_b16 v[68:69], v17 offset:24640
    v_and_b32 v25, 15, v0
    v_cmp_eq_u32 vcc, 12, v25
    v_mov_b32 v36, 0x3f803f80
    s_nop 0
    v_cndmask_b32 v70, 0, v36, vcc
    v_mov_b32 v71, v70
    v_mov_b32 v72, v70
    v_mov_b32 v73, v70
    v_mov_b32 v74, v70
    v_mov_b32 v75, v70
    v_mov_b32 v76, v70
    v_mov_b32 v77, v70
    v_mov_b32 v78, v70
    v_mov_b32 v79, v70
    s_mov_b32 s77, 4096
    v_mul_u32_u24 v96, 103, v0
    v_lshrrev_b32 v96, 10, v96
    v_lshl_add_u32 v96, v96, 4, v1
    v_add_u32 v96, s77, v96
    v_mul_u32_u24 v97, 176, v25
    v_add_u32 v97, s77, v97
    v_lshrrev_b32 v28, 4, v0
    v_lshl_add_u32 v98, v28, 3, v97
    v_lshl_add_u32 v97, v28, 4, v97
    buffer_store_dwordx4 v[104:107], v100, s[8:11], s78 offen
    s_cmp_eq_u32 s10, 0
    s_cbranch_scc1 SLOW15
BACK15:
    buffer_store_dwordx4 v[104:107], v101, s[8:11], s78 offen
    s_cmp_eq_u32 s10, 0
    s_cbranch_scc1 SLOW16
BACK16:
    s_branch STB
WPREP:
    s_nop 1
    ds_read_b64_tr_b16 v[40:41], v16 offset:0
    ds_read_b64_tr_b16 v[42:43], v16 offset:1536
    ds_read_b64_tr_b16 v[44:45], v16 offset:12288
    ds_read_b64_tr_b16 v[46:47], v16 offset:13824
    ds_read_b64_tr_b16 v[48:49], v17 offset:24576
    ds_read_b64_tr_b16 v[50:51], v16 offset:32
    ds_read_b64_tr_b16 v[52:53], v16 offset:1568
    ds_read_b64_tr_b16 v[54:55], v16 offset:12320
    ds_read_b64_tr_b16 v[56:57], v16 offset:13856
    ds_read_b64_tr_b16 v[58:59], v17 offset:24608
    ds_read_b64_tr_b16 v[60:61], v16 offset:64
    ds_read_b64_tr_b16 v[62:63], v16 offset:1600
    ds_read_b64_tr_b16 v[64:65], v16 offset:12352
    ds_read_b64_tr_b16 v[66:67], v16 offset:13888
    ds_read_b64_tr_b16 v[68:69], v17 offset:24640
    v_and_b32 v25, 15, v0
    v_cmp_eq_u32 vcc, 12, v25
    v_mov_b32 v36, 0x3f803f80
    s_nop 0
    v_cndmask_b32 v70, 0, v36, vcc
    v_mov_b32 v71, v70
    v_mov_b32 v72, v70
    v_mov_b32 v73, v70
    v_mov_b32 v74, v70
    v_mov_b32 v75, v70
    v_mov_b32 v76, v70
    v_mov_b32 v77, v70
    v_mov_b32 v78, v70
    v_mov_b32 v79, v70
    s_mov_b32 s77, 4096
    v_mul_u32_u24 v96, 103, v0
    v_lshrrev_b32 v96, 10, v96
    v_lshl_add_u32 v96, v96, 4, v1
    v_add_u32 v96, s77, v96
    v_mul_u32_u24 v97, 176, v25
    v_add_u32 v97, s77, v97
    v_lshrrev_b32 v28, 4, v0
    v_lshl_add_u32 v98, v28, 3, v97
    v_lshl_add_u32 v97, v28, 4, v97
    s_branch STB
WOWN:
    v_and_b32 v25, 15, v0
    v_lshrrev_b32 v26, 4, v0
    s_mul_i32 s7, s68, 10240
    s_cmp_eq_u32 s74, 0
    s_cselect_b32 s7, 0, s7
    s_add_u32 s7, s7, 655360
    v_mul_u32_u24 v37, 1280, v26
    v_add_u32 v37, s7, v37
    s_mul_i32 s7, s68, 81920
    s_add_u32 s7, s7, 45312
    v_mov_b32 v38, s7
    v_cmp_eq_u32 vcc, s68, v26
    s_nop 1
    v_cndmask_b32 v37, v37, v38, vcc
    v_add_u32 v39, 4, v26
    s_mul_i32 s7, s68, 10240
    s_cmp_eq_u32 s74, 0
    s_cselect_b32 s7, 0, s7
    s_add_u32 s7, s7, 655360
    v_mul_u32_u24 v38, 1280, v39
    v_add_u32 v38, s7, v38
    s_mul_i32 s7, s68, 81920
    s_add_u32 s7, s7, 45312
    v_mov_b32 v28, s7
    v_cmp_eq_u32 vcc, s68, v39
    s_nop 1
    v_cndmask_b32 v38, v38, v28, vcc
    s_lshl_b32 s77, s69, 6
    s_add_u32 s77, s77, s74
    v_lshl_add_u32 v25, v25, 2, s77
    v_add_u32 v100, v25, v37
    v_add_u32 v101, v25, v38
    s_cmp_eq_u32 s74, 0
    s_cbranch_scc1 GP1
    s_sleep 9
    s_mov_b32 s76, 1
POLL17:
    buffer_load_dword v28, v100, s[16:19], 0 offen sc1
    buffer_load_dword v29, v101, s[16:19], 0 offen sc1
POLLW17:
    s_waitcnt vmcnt(0)
    v_max_u32 v30, v28, v29
    v_cmp_eq_u32 vcc, -1, v30
    s_cbranch_vccnz AGAIN17
POLLX17:
    v_lshlrev_b32 v30, 16, v28
    v_and_b32 v28, 0xffff0000, v28
    v_lshlrev_b32 v31, 16, v29
    v_and_b32 v29, 0xffff0000, v29
    v_add_f32 v30, v30, v31
    v_add_f32 v28, v28, v29
    v_mov_b32 v31, v30
    v_mov_b32 v29, v28
    s_nop 0
    v_permlane32_swap_b32 v30, v31
    v_permlane32_swap_b32 v28, v29
    v_add_f32 v30, v30, v31
    v_add_f32 v28, v28, v29
    v_mov_b32 v31, v30
    v_mov_b32 v29, v28
    s_nop 0
    v_permlane16_swap_b32 v30, v31
    v_permlane16_swap_b32 v28, v29
    v_add_f32 v30, v30, v31
    v_add_f32 v28, v28, v29
    v_add_f32 v22, v22, v30
    v_add_f32 v23, v23, v28
    v_cvt_pk_bf16_f32 v28, v22, v23
    s_branch GP1
STBX:
    s_cmp_lg_u32 s72, 1
    s_cbranch_scc1 NEXT
    s_cmp_lg_u32 s74, 0
    s_cbranch_scc1 FINAL
    s_waitcnt vmcnt(0)
    v_mov_b32 v28, v34
    v_mov_b32 v29, v35
    v_max_u32 v30, v28, v29
    v_cmp_eq_u32 vcc, -1, v30
    s_cbranch_vccnz RETRY18
OK18:
    v_lshlrev_b32 v30, 16, v28
    v_and_b32 v28, 0xffff0000, v28
    v_lshlrev_b32 v31, 16, v29
    v_and_b32 v29, 0xffff0000, v29
    v_add_f32 v30, v30, v31
    v_add_f32 v28, v28, v29
    v_mov_b32 v31, v30
    v_mov_b32 v29, v28
    s_nop 0
    v_permlane32_swap_b32 v30, v31
    v_permlane32_swap_b32 v28, v29
    v_add_f32 v30, v30, v31
    v_add_f32 v28, v28, v29
    v_mov_b32 v31, v30
    v_mov_b32 v29, v28
    s_nop 0
    v_permlane16_swap_b32 v30, v31
    v_permlane16_swap_b32 v28, v29
    v_add_f32 v30, v30, v31
    v_add_f32 v28, v28, v29
    v_add_f32 v22, v22, v30
    v_add_f32 v23, v23, v28
    v_cvt_pk_bf16_f32 v28, v22, v23
    s_lshl_b32 s77, s69, 6
    s_add_u32 s77, s77, s3
    s_add_u32 s77, s77, 49152
    v_lshlrev_b32 v32, 2, v0
    v_mov_b32_dpp v29, v28 quad_perm:[1,1,1,1] row_mask:0xf bank_mask:0xf
    v_mov_b32_dpp v30, v28 quad_perm:[2,2,2,2] row_mask:0xf bank_mask:0xf
    v_mov_b32_dpp v31, v28 quad_perm:[3,3,3,3] row_mask:0xf bank_mask:0xf
    s_mov_b32 exec_lo, 0x1111
    s_mov_b32 exec_hi, 0x0
    buffer_store_dwordx4 v[28:31], v32, s[8:11], s77 offen
    s_cmp_eq_u32 s10, 0
    s_cbranch_scc1 SLOW19
BACK19:
    s_mov_b64 exec, -1
    s_branch NEXT
FINAL:
    s_cmp_lg_u32 s68, 0
    s_cbranch_scc1 DONE
    s_lshl_b32 s77, s69, 6
    v_lshlrev_b32 v37, 2, v0
    s_add_u32 s79, s77, s3
    s_add_u32 s79, s79, 46592
    s_mov_b64 exec, 15
    s_mov_b32 s76, 1
POLL20:
    buffer_load_dword v28, v1, s[16:19], s79 offen sc1
POLLW20:
    s_waitcnt vmcnt(0)
    v_cmp_eq_u32 vcc, -1, v28
    s_cbranch_vccnz AGAIN20
POLLX20:
    s_mov_b64 exec, -1
    s_mov_b32 s76, 1
POLL21:
    buffer_load_dword v28, v20, s[16:19], s74 offen sc1
    buffer_load_dword v29, v21, s[16:19], s74 offen sc1
POLLW21:
    s_waitcnt vmcnt(0)
    v_max_u32 v30, v28, v29
    v_cmp_eq_u32 vcc, -1, v30
    s_cbranch_vccnz AGAIN21
POLLX21:
    v_lshlrev_b32 v30, 16, v28
    v_and_b32 v28, 0xffff0000, v28
    v_lshlrev_b32 v31, 16, v29
    v_and_b32 v29, 0xffff0000, v29
    v_add_f32 v30, v30, v31
    v_add_f32 v28, v28, v29
    v_mov_b32 v31, v30
    v_mov_b32 v29, v28
    s_nop 0
    v_permlane32_swap_b32 v30, v31
    v_permlane32_swap_b32 v28, v29
    v_add_f32 v30, v30, v31
    v_add_f32 v28, v28, v29
    v_mov_b32 v31, v30
    v_mov_b32 v29, v28
    s_nop 0
    v_permlane16_swap_b32 v30, v31
    v_permlane16_swap_b32 v28, v29
    v_add_f32 v30, v30, v31
    v_add_f32 v28, v28, v29
    v_add_f32 v22, v22, v30
    v_add_f32 v23, v23, v28
    v_cvt_pk_bf16_f32 v28, v22, v23
    s_mov_b32 exec_lo, 0xffff
    s_mov_b32 exec_hi, 0x0
    buffer_store_dword v28, v37, s[40:43], s77 offen
    s_mov_b64 exec, -1
    s_endpgm
AGAIN17:
    s_sleep 2
    s_add_u32 s76, s76, 1
    s_cmp_lt_u32 s76, 32768
    s_cbranch_scc1 POLL17
    s_branch POLLX17
AGAIN20:
    s_add_u32 s76, s76, 1
    s_cmp_lt_u32 s76, 32768
    s_cbranch_scc1 POLL20
    s_branch POLLX20
AGAIN21:
    s_add_u32 s76, s76, 1
    s_cmp_lt_u32 s76, 32768
    s_cbranch_scc1 POLL21
    s_branch POLLX21
ROLEF:
    v_and_b32 v25, 15, v0
    v_lshrrev_b32 v26, 4, v0
    v_bfe_u32 v27, v0, 2, 2
    v_and_b32 v36, 3, v0
    s_cmp_lg_u32 s74, 0
    s_cbranch_scc1 FW
    s_sub_u32 s96, s69, 20
    s_lshl_b32 s96, s96, 2
    s_add_u32 s96, s96, s72
    s_mul_i32 s96, s96, 688
    v_add_u32 v21, s96, v1
    v_min_u32 v21, 32752, v21
    s_add_u32 s97, s3, 819200
    v_mov_b32 v28, -1
    v_mov_b32 v29, -1
    v_mov_b32 v30, -1
    v_mov_b32 v31, -1
    buffer_store_dwordx4 v[28:31], v21, s[8:11], s97 offen
    s_cmp_eq_u32 s10, 0
    s_cbranch_scc1 SLOW22
BACK22:
    s_add_u32 s77, s3, 1638400
    buffer_store_dword v7, v10, s[8:11], s77 offen
    s_cmp_eq_u32 s10, 0
    s_cbranch_scc1 SLOW23
BACK23:
    v_lshrrev_b32 v38, 3, v0
    v_mul_u32_u24 v38, 3072, v38
    v_and_b32 v39, 7, v0
    v_lshl_add_u32 v38, v39, 4, v38
    v_bfe_u32 v39, v0, 4, 1
    v_lshlrev_b32 v39, 5, v39
    v_xor_b32 v38, v38, v39
    v_xor_b32 v39, 64, v38
    s_mov_b32 m0, s67
    s_add_u32 s67, s67, 1024
    buffer_load_dwordx4 v38, s[36:39], s66 offen nt lds
    s_add_u32 s66, s66, 24576
    s_mov_b32 m0, s67
    s_add_u32 s67, s67, 1024
    buffer_load_dwordx4 v39, s[36:39], s66 offen nt lds
    s_add_u32 s66, s66, 24576
    s_mov_b32 m0, s67
    s_add_u32 s67, s67, 1024
    buffer_load_dwordx4 v38, s[36:39], s66 offen nt lds
    s_add_u32 s66, s66, 24576
    s_mov_b32 m0, s67
    s_add_u32 s67, s67, 1024
    buffer_load_dwordx4 v39, s[36:39], s66 offen nt lds
    s_add_u32 s66, s66, 24576
    s_mov_b32 m0, s67
    s_add_u32 s67, s67, 1024
    buffer_load_dwordx4 v38, s[36:39], s66 offen nt lds
    s_add_u32 s66, s66, 24576
    s_mov_b32 m0, s67
    s_add_u32 s67, s67, 1024
    buffer_load_dwordx4 v39, s[36:39], s66 offen nt lds
    s_add_u32 s66, s66, 24576
    s_mov_b32 m0, s67
    s_add_u32 s67, s67, 1024
    buffer_load_dwordx4 v38, s[36:39], s66 offen nt lds
    s_add_u32 s66, s66, 24576
    s_mov_b32 m0, s67
    s_add_u32 s67, s67, 1024
    buffer_load_dwordx4 v39, s[36:39], s66 offen nt lds
    s_add_u32 s66, s66, 24576
    s_mov_b32 m0, s67
    s_add_u32 s67, s67, 1024
    buffer_load_dwordx4 v38, s[36:39], s66 offen nt lds
    s_add_u32 s66, s66, 24576
    s_mov_b32 m0, s67
    s_add_u32 s67, s67, 1024
    buffer_load_dwordx4 v39, s[36:39], s66 offen nt lds
    s_add_u32 s66, s66, 24576
FW:
    s_lshl_b32 s77, s72, 5
    v_lshl_add_u32 v80, v36, 3, s77
    v_lshrrev_b32 v37, 1, v27
    v_and_b32 v38, 1, v26
    v_lshl_add_u32 v37, v38, 1, v37
    v_lshlrev_b32 v37, 5, v37
    v_xor_b32 v80, v80, v37
    v_lshl_add_u32 v37, v26, 3, v27
    v_lshl_add_u32 v80, v37, 7, v80
    v_add_u32 v80, 57344, v80
    s_sub_u32 s79, s69, 20
    s_and_b32 s7, s79, 12
    s_add_u32 s7, s7, s72
    s_lshl_b32 s78, s7, 8
    v_lshl_add_u32 v83, v25, 4, s78
    v_lshrrev_b32 v84, 1, v83
    v_mov_b32 v37, 1536
    v_cmp_le_u32 vcc, 2, v26
    s_nop 1
    v_cndmask_b32 v84, v84, v37, vcc
    v_and_b32 v37, 1, v26
    v_mul_u32_u24 v37, 4, v37
    v_add_u32 v84, v84, v37
    s_cmp_eq_u32 s7, 0
    s_mov_b32 s52, -1
    s_cselect_b32 s53, 0x10001, 0
    s_and_b32 s79, s79, 3
    s_mul_i32 s78, s79, 1788
    s_sub_u32 s78, 7168, s78
    v_add_u32 v83, s78, v83
    s_mul_i32 s78, s79, 1792
    s_add_u32 s78, s78, s3
    s_add_u32 s78, s78, 50432
    s_mul_i32 s79, s79, 320
    v_cmp_eq_u32 vcc, 12, v25
    v_mov_b32 v38, 0x3f803f80
    s_nop 0
    v_cndmask_b32 v88, 0, v38, vcc
    v_mov_b32 v89, v88
    v_mov_b32 v90, v88
    v_mov_b32 v91, v88
    v_mov_b32 v92, v88
    v_mov_b32 v93, v88
    v_mov_b32 v94, v88
    v_mov_b32 v95, v88
    v_mov_b32 v96, v88
    v_mov_b32 v97, v88
    v_mov_b32 v98, v88
    v_mov_b32 v99, v88
    v_mov_b32 v100, v88
    v_mov_b32 v101, v88
    v_mov_b32 v102, v88
    v_mov_b32 v103, v88
    v_mov_b32 v104, v88
    v_mov_b32 v105, v88
    v_mov_b32 v106, v88
    v_mov_b32 v107, v88
    v_mul_u32_u24 v6, 336, v25
    v_lshl_add_u32 v6, v26, 4, v6
    s_mul_i32 s77, s72, 45
    v_min_u32 v27, 44, v0
    v_add_u32 v27, s77, v27
    v_mul_u32_u24 v37, 205, v27
    v_lshrrev_b32 v37, 12, v37
    v_add_u32 v87, v37, v27
    v_lshlrev_b32 v87, 4, v87
    v_mul_u32_u24 v38, 20, v37
    v_sub_u32 v27, v27, v38
    v_lshlrev_b32 v27, 4, v27
    s_mul_i32 s7, s68, 10240
    s_cmp_eq_u32 s74, 0
    s_cselect_b32 s7, 0, s7
    s_add_u32 s7, s7, 655360
    v_mul_u32_u24 v86, 1280, v37
    v_add_u32 v86, s7, v86
    s_mul_i32 s7, s68, 81920
    s_add_u32 s7, s7, 45312
    v_mov_b32 v38, s7
    v_cmp_eq_u32 vcc, s68, v37
    s_nop 1
    v_cndmask_b32 v86, v86, v38, vcc
    v_add_u32 v38, 2560, v38
    v_cmp_le_u32 vcc, 8, v37
    s_nop 1
    v_cndmask_b32 v86, v86, v38, vcc
    v_add_u32 v86, v86, v27
    s_add_u32 s77, s79, s74
    s_add_u32 s79, s79, s3
    s_add_u32 s79, s79, 45312
    s_cmp_lg_u32 s74, 0
    s_cbranch_scc1 FW1
    s_waitcnt vmcnt(0)
    s_barrier
FW1:
    s_mov_b32 exec_lo, 0xfffff
    s_mov_b32 exec_hi, 0x0
    s_mov_b32 s76, 1
    buffer_load_dword v36, v1, s[16:19], s79 offen sc1
    s_mov_b64 exec, -1
    ds_read_b64_tr_b16 v[40:41], v80 offset:0
    ds_read_b64_tr_b16 v[42:43], v80 offset:512
    ds_read_b64_tr_b16 v[44:45], v80 offset:4096
    ds_read_b64_tr_b16 v[46:47], v80 offset:4608
    ds_read_b64_tr_b16 v[48:49], v80 offset:8192
    ds_read_b64_tr_b16 v[50:51], v80 offset:8704
    ds_read_b64_tr_b16 v[52:53], v80 offset:12288
    ds_read_b64_tr_b16 v[54:55], v80 offset:12800
    ds_read_b64_tr_b16 v[56:57], v80 offset:16384
    ds_read_b64_tr_b16 v[58:59], v80 offset:16896
    ds_read_b64_tr_b16 v[60:61], v80 offset:20480
    ds_read_b64_tr_b16 v[62:63], v80 offset:20992
    ds_read_b64_tr_b16 v[64:65], v80 offset:24576
    ds_read_b64_tr_b16 v[66:67], v80 offset:25088
    ds_read_b64_tr_b16 v[68:69], v80 offset:28672
    ds_read_b64_tr_b16 v[70:71], v80 offset:29184
    ds_read_b64_tr_b16 v[72:73], v80 offset:32768
    ds_read_b64_tr_b16 v[74:75], v80 offset:33280
    ds_read_b64_tr_b16 v[76:77], v80 offset:36864
    ds_read_b64_tr_b16 v[78:79], v80 offset:37376
    s_mov_b32 exec_lo, 0xfffff
    s_mov_b32 exec_hi, 0x0
    s_branch POLLW24
POLL24:
    buffer_load_dword v36, v1, s[16:19], s79 offen sc1
POLLW24:
    s_waitcnt vmcnt(0)
    v_cmp_eq_u32 vcc, -1, v36
    s_cbranch_vccnz AGAIN24
POLLX24:
    s_mov_b64 exec, s[86:87]
    buffer_load_dwordx4 v[24:27], v86, s[16:19], s77 offen sc1
    s_cmp_eq_u32 s74, 0
    s_cbranch_scc1 CSP
    s_waitcnt vmcnt(0)
CSB:
    s_waitcnt vmcnt(2)
BW25:
    ds_write_b128 v87, v[24:27]
    v_cmp_eq_u32 vcc, -1, v24
    s_cbranch_vccnz BR25
BX25:
    s_mov_b64 exec, s[84:85]
    s_waitcnt lgkmcnt(0)
    s_barrier
    ds_read_b128 v[88:91], v6 offset:0
    ds_read_b128 v[92:95], v6 offset:64
    ds_read_b128 v[96:99], v6 offset:128
    ds_read_b128 v[100:103], v6 offset:192
    ds_read_b128 v[104:107], v6 offset:256
    s_mov_b64 exec, -1
    s_waitcnt lgkmcnt(4)
    v_mfma_f32_16x16x32_bf16 v[32:35], v[88:91], v[88:91], 0
    s_waitcnt lgkmcnt(3)
    v_mfma_f32_16x16x32_bf16 v[32:35], v[92:95], v[92:95], v[32:35]
    s_waitcnt lgkmcnt(2)
    v_mfma_f32_16x16x32_bf16 v[32:35], v[96:99], v[96:99], v[32:35]
    s_waitcnt lgkmcnt(1)
    v_mfma_f32_16x16x32_bf16 v[32:35], v[100:103], v[100:103], v[32:35]
    s_waitcnt lgkmcnt(0)
    v_mfma_f32_16x16x32_bf16 v[32:35], v[104:107], v[104:107], v[32:35]
    v_mfma_f32_16x16x32_bf16 v[24:27], v[88:91], v[40:43], 0
    v_mov_b32 v36, 0
    v_mov_b32 v37, 0
    v_mfma_f32_16x16x32_bf16 v[24:27], v[92:95], v[44:47], v[24:27]
    v_mov_b32 v38, 0
    s_nop 0
    v_mfma_f32_16x16x32_bf16 v[24:27], v[96:99], v[48:51], v[24:27]
    v_mfma_f32_16x16x32_bf16 v[24:27], v[100:103], v[52:55], v[24:27]
    v_add_f32 v32, v32, v33
    v_add_f32 v34, v34, v35
    v_mfma_f32_16x16x32_bf16 v[24:27], v[104:107], v[56:59], v[24:27]
    v_mfma_f32_16x16x32_bf16 v[28:31], v[88:91], v[60:63], 0
    v_add_f32_dpp v36, v32, v34 quad_perm:[0,1,2,3] row_mask:0xf bank_mask:0x7
    v_mfma_f32_16x16x32_bf16 v[28:31], v[92:95], v[64:67], v[28:31]
    s_nop 0
    v_add_f32_dpp v36, v36, v36 row_ror:8 row_mask:0xf bank_mask:0xf
    v_mfma_f32_16x16x32_bf16 v[28:31], v[96:99], v[68:71], v[28:31]
    s_nop 0
    v_add_f32_dpp v36, v36, v36 row_ror:4 row_mask:0xf bank_mask:0xf
    v_mfma_f32_16x16x32_bf16 v[28:31], v[100:103], v[72:75], v[28:31]
    s_nop 0
    v_add_f32_dpp v36, v36, v36 row_ror:2 row_mask:0xf bank_mask:0xf
    v_mfma_f32_16x16x32_bf16 v[28:31], v[104:107], v[76:79], v[28:31]
    v_add_f32 v25, v24, v25
    v_add_f32_dpp v37, v36, v36 row_ror:1 row_mask:0x7 bank_mask:0xf
    v_add_f32_dpp v38, v36, v36 row_ror:1 row_mask:0x8 bank_mask:0xf
    v_add_f32 v26, v26, v27
    v_add_f32 v25, v25, v26
    s_nop 1
    v_permlane32_swap_b32 v25, v37
    v_add_f32 v29, v28, v29
    v_add_f32 v30, v30, v31
    v_add_f32 v29, v29, v30
    v_add_f32 v25, v25, v37
    s_nop 0
    v_permlane32_swap_b32 v29, v38
    v_add_f32 v29, v29, v38
    s_nop 1
    v_permlane16_swap_b32 v25, v29
    s_mov_b64 exec, s[52:53]
    v_add_f32 v25, v25, v29
    buffer_store_dword v25, v84, s[8:11], s78 offen
    s_cmp_eq_u32 s10, 0
    s_cbranch_scc1 SLOW26
BACK26:
    s_mov_b64 exec, -1
NEXT:
    s_cmp_lg_u32 s74, 0
    s_cbranch_scc1 DONE
    s_mov_b32 s74, 819200
    s_add_u32 s3, s3, 819200
    s_add_u32 s80, s80, 819200
    s_add_u32 s81, s81, 819200
    s_mov_b64 s[46:47], s[44:45]
    s_mov_b64 s[48:49], s[92:93]
    s_branch LOOP
AGAIN24:
    s_add_u32 s76, s76, 1
    s_cmp_lt_u32 s76, 32768
    s_cbranch_scc1 POLL24
    s_branch POLLX24
CSP:
    s_mov_b64 exec, -1
    s_waitcnt lgkmcnt(0)
    v_mfma_f32_16x16x32_bf16 v[108:111], v[88:91], v[40:43], 0
    v_mfma_f32_16x16x32_bf16 v[2:5], v[88:91], v[60:63], 0
    v_mfma_f32_16x16x32_bf16 v[108:111], v[92:95], v[44:47], v[108:111]
    v_mfma_f32_16x16x32_bf16 v[2:5], v[92:95], v[64:67], v[2:5]
    v_mfma_f32_16x16x32_bf16 v[108:111], v[96:99], v[48:51], v[108:111]
    v_mfma_f32_16x16x32_bf16 v[2:5], v[96:99], v[68:71], v[2:5]
    v_mfma_f32_16x16x32_bf16 v[108:111], v[100:103], v[52:55], v[108:111]
    v_mfma_f32_16x16x32_bf16 v[2:5], v[100:103], v[72:75], v[2:5]
    v_mfma_f32_16x16x32_bf16 v[108:111], v[104:107], v[56:59], v[108:111]
    v_mfma_f32_16x16x32_bf16 v[2:5], v[104:107], v[76:79], v[2:5]
    s_mov_b32 exec_lo, 0x0
    s_mov_b32 exec_hi, 0xffff0000
    s_nop 4
    buffer_store_dword v108, v83, s[8:11], s78 offen
    s_cmp_eq_u32 s10, 0
    s_cbranch_scc1 SLOW27
BACK27:
    buffer_store_dword v2, v83, s[8:11], s78 offen offset:3072
    s_cmp_eq_u32 s10, 0
    s_cbranch_scc1 SLOW28
BACK28:
    s_mov_b64 exec, s[86:87]
    s_branch CSB
BR25:
    s_cmp_ge_u32 s76, 32768
    s_cbranch_scc1 BX25
    s_mov_b64 exec, vcc
    buffer_load_dwordx4 v[24:27], v86, s[16:19], s77 offen sc1
    s_add_u32 s76, s76, 1
    s_waitcnt vmcnt(0)
    s_branch BW25
DONE:
    s_endpgm
TAGLOOP:
    s_mov_b32 s76, 0
TAGL2:
    s_sleep 8
    global_load_dword v98, v100, s[64:65] sc1
    s_waitcnt vmcnt(0)
    v_readfirstlane_b32 s96, v98
    s_nop 0
    s_cmp_lg_u32 s96, 0
    s_cbranch_scc1 TAGOK
    s_add_u32 s76, s76, 1
    s_cmp_lt_u32 s76, 32768
    s_cbranch_scc1 TAGL2
    s_branch TAGOK
DMAF:
    s_sub_u32 s78, s69, 20
    s_and_b32 s66, s78, 3
    s_lshl_b32 s66, s66, 1
    s_and_b32 s79, s72, 1
    s_add_u32 s66, s66, s79
    s_mul_i32 s66, s66, 245760
    s_lshr_b32 s78, s78, 2
    s_lshl_b32 s78, s78, 7
    s_add_u32 s66, s66, s78
    s_mul_i32 s78, s68, 384
    s_add_u32 s66, s66, s78
    s_mul_i32 s67, s72, 10240
    s_add_u32 s67, s67, 57344
    s_branch DMAX
RDYLOOP:
    s_mov_b32 s76, 0
RDYL2:
    s_sleep 8
    buffer_load_dwordx2 v[98:99], v100, s[16:19], 0 offen offset:384 sc1
    s_waitcnt vmcnt(0)
    v_cmp_ne_u32 vcc, s96, v98
    s_cbranch_vccz RDYOK
    s_add_u32 s76, s76, 1
    s_cmp_lt_u32 s76, 32768
    s_cbranch_scc1 RDYL2
    s_branch RDYOK
SLOW1:
    buffer_store_dwordx4 v[28:31], v27, s[16:19], s77 offen sc1
    s_branch BACK1
SLOW2:
    buffer_store_dwordx4 v[24:27], v106, s[16:19], 0 offen sc1
    s_branch BACK2
SLOW5:
    buffer_store_dword v24, v10, s[16:19], s3 offen sc1
    s_branch BACK5
SLOW7:
    buffer_store_dwordx4 v[28:31], v26, s[16:19], s77 offen sc1
    s_branch BACK7
RETRY8:
    s_mov_b32 s76, 1
POLL29:
    buffer_load_dword v28, v20, s[16:19], 0 offen sc1
    buffer_load_dword v29, v21, s[16:19], 0 offen sc1
POLLW29:
    s_waitcnt vmcnt(0)
    v_max_u32 v30, v28, v29
    v_cmp_eq_u32 vcc, -1, v30
    s_cbranch_vccnz AGAIN29
POLLX29:
    s_branch OK8
AGAIN29:
    s_add_u32 s76, s76, 1
    s_cmp_lt_u32 s76, 32768
    s_cbranch_scc1 POLL29
    s_branch POLLX29
SLOW9:
    buffer_store_dwordx4 v[28:31], v32, s[16:19], s77 offen sc1
    s_branch BACK9
SLOW11:
    buffer_store_dwordx4 v[28:31], v18, s[16:19], s81 offen sc1
    s_branch BACK11
SLOW12:
    buffer_store_dwordx4 v[28:31], v18, s[16:19], s97 offen sc1
    s_branch BACK12
SLOW13:
    buffer_store_dwordx2 v[34:35], v1, s[16:19], s78 offen sc1
    s_branch BACK13
SLOW14:
    buffer_store_dword v7, v10, s[16:19], s77 offen sc1
    s_branch BACK14
SLOW15:
    buffer_store_dwordx4 v[104:107], v100, s[16:19], s78 offen sc1
    s_branch BACK15
SLOW16:
    buffer_store_dwordx4 v[104:107], v101, s[16:19], s78 offen sc1
    s_branch BACK16
RETRY18:
    s_mov_b32 s76, 1
POLL30:
    buffer_load_dword v28, v100, s[16:19], 0 offen sc1
    buffer_load_dword v29, v101, s[16:19], 0 offen sc1
POLLW30:
    s_waitcnt vmcnt(0)
    v_max_u32 v30, v28, v29
    v_cmp_eq_u32 vcc, -1, v30
    s_cbranch_vccnz AGAIN30
POLLX30:
    s_branch OK18
AGAIN30:
    s_add_u32 s76, s76, 1
    s_cmp_lt_u32 s76, 32768
    s_cbranch_scc1 POLL30
    s_branch POLLX30
SLOW19:
    buffer_store_dwordx4 v[28:31], v32, s[16:19], s77 offen sc1
    s_branch BACK19
SLOW22:
    buffer_store_dwordx4 v[28:31], v21, s[16:19], s97 offen sc1
    s_branch BACK22
SLOW23:
    buffer_store_dword v7, v10, s[16:19], s77 offen sc1
    s_branch BACK23
SLOW26:
    buffer_store_dword v25, v84, s[16:19], s78 offen sc1
    s_branch BACK26
SLOW27:
    buffer_store_dword v108, v83, s[16:19], s78 offen sc1
    s_branch BACK27
SLOW28:
    buffer_store_dword v2, v83, s[16:19], s78 offen offset:3072 sc1
    s_branch BACK28
CODE_END:
    s_endpgm
.section .rodata,"a"
.p2align 6
.amdhsa_kernel interleave_layers__sliding_block_cached__glu_gated_swiglu__decode_kernel
  .amdhsa_next_free_vgpr 512
  .amdhsa_next_free_sgpr 102
  .amdhsa_accum_offset 256
  .amdhsa_group_segment_fixed_size 0
  .amdhsa_kernarg_size 96
  .amdhsa_user_sgpr_count 2
  .amdhsa_user_sgpr_kernarg_segment_ptr 1
  .amdhsa_system_sgpr_workgroup_id_x 1
.end_amdhsa_kernel
```

```asm
; @launch grid=(256,1,1) block=(256,1,1) lds=125568
.amdgcn_target "amdgcn-amd-amdhsa--gfx950"
.text
.globl interleave_layers__sliding_block_cached__glu_gated_swiglu__decode_kernel
.p2align 8
.type interleave_layers__sliding_block_cached__glu_gated_swiglu__decode_kernel,@function
interleave_layers__sliding_block_cached__glu_gated_swiglu__decode_kernel:
    s_load_dwordx16 s[44:59], s[0:1], 0
    s_load_dwordx8 s[60:67], s[0:1], 64
    s_cmp_ge_u32 s2, 256
    s_cbranch_scc1 CODE_END
    s_memrealtime s[96:97]
    v_lshrrev_b32 v2, 6, v0
    v_and_b32 v24, 63, v0
    v_readfirstlane_b32 s72, v2
    s_and_b32 s68, s2, 7
    s_lshr_b32 s69, s2, 3
    s_lshr_b32 s70, s69, 3
    s_and_b32 s71, s69, 7
    v_lshlrev_b32 v1, 4, v24
    s_lshl_b32 s77, s68, 2
    s_add_u32 s77, s77, s70
    s_mul_i32 s73, s77, 12582912
    s_lshl_b32 s78, s71, 2
    s_add_u32 s78, s78, s72
    s_mul_i32 s78, s78, 6144
    s_add_u32 s73, s73, s78
    s_add_u32 s73, s73, 11010048
    v_add_u32 v23, 4096, v1
    s_mov_b32 s10, 402653184
    s_mov_b32 s11, 0x20000
    s_getpc_b64 s[100:101]
PCREF:
    s_sub_u32 s100, s100, PCREF-interleave_layers__sliding_block_cached__glu_gated_swiglu__decode_kernel
    s_subb_u32 s101, s101, 0
    s_lshl_b32 s78, s71, 12
    v_lshl_add_u32 v25, v0, 4, s78
    v_cmp_gt_u32 vcc, CODE_END-interleave_layers__sliding_block_cached__glu_gated_swiglu__decode_kernel-16, v25
    s_nop 0
    s_and_saveexec_b64 s[98:99], vcc
    s_cbranch_execz NOCPF
    global_load_dwordx4 a[240:243], v25, s[100:101]
NOCPF:
    s_mov_b64 exec, -1
    s_mul_i32 s79, s77, 384
    s_mov_b32 s74, 0
    s_mul_i32 s3, s68, 81920
    s_getreg_b32 s75, hwreg(HW_REG_XCC_ID, 0, 4)
    s_lshl_b32 s77, s69, 9
    s_add_u32 s77, s77, s3
    s_add_u32 s77, s77, 32768
    v_add_u32 v20, s77, v1
    s_lshl_b32 s77, s68, 2
    s_add_u32 s77, s77, s69
    s_mul_i32 s77, s77, 320
    s_add_u32 s77, s77, 654848
    s_add_u32 s4, s77, 1024
    v_add_u32 v25, s77, v1
    v_cmp_le_u32 vcc, 32, v0
    s_nop 1
    v_cndmask_b32 v21, v20, v25, vcc
    v_mov_b32 v25, 2147483632
    v_cndmask_b32 v20, v20, v25, vcc
    s_cmp_lt_u32 s69, 4
    s_cselect_b32 s77, 52, 32
    v_cmp_le_u32 vcc, s77, v0
    s_nop 1
    v_cndmask_b32 v21, v21, v25, vcc
    s_mov_b32 s18, 1610612736
    s_mov_b32 s19, 0x20000
    s_waitcnt lgkmcnt(0)
    s_mov_b32 s8, s46
    s_and_b32 s9, s47, 0xffff
    s_mov_b32 s16, s66
    s_and_b32 s17, s67, 0xffff
    buffer_load_dwordx4 a[0:3], v1, s[8:11], s73 offen offset:0 nt
    buffer_load_dwordx4 a[4:7], v1, s[8:11], s73 offen offset:1024 nt
    s_or_b32 s77, s2, s72
    s_cbranch_scc1 NOTAG
    s_or_b32 s77, s96, 1
    v_mov_b32 v26, s77
    s_mov_b64 exec, 1
    global_store_dword v1, v26, s[64:65] sc1
    s_mov_b64 exec, -1
NOTAG:
    s_add_u32 s83, s73, 196608
    s_mov_b32 s12, s48
    s_and_b32 s13, s49, 0xffff
    s_mov_b32 s14, 402653184
    s_mov_b32 s15, 0x20000
    s_mov_b32 s20, s50
    s_and_b32 s21, s51, 0xffff
    s_mov_b32 s22, 7864320
    s_mov_b32 s23, 0x20000
    s_mov_b32 s36, s44
    s_and_b32 s37, s45, 0xffff
    s_mov_b32 s38, 1280
    s_mov_b32 s39, 0x20000
    s_mov_b32 s40, s62
    s_and_b32 s41, s63, 0xffff
    s_mov_b32 s42, 1280
    s_mov_b32 s43, 0x20000
    s_mov_b32 s28, s58
    s_and_b32 s29, s59, 0xffff
    s_mov_b32 s30, 1966080
    s_mov_b32 s31, 0x20000
    s_mov_b32 s32, s60
    s_and_b32 s33, s61, 0xffff
    s_mov_b32 s34, 1966080
    s_mov_b32 s35, 0x20000
    s_cmp_lt_u32 s69, 20
    s_cselect_b32 s24, s52, s56
    s_cselect_b32 s25, s53, s57
    s_cselect_b32 s26, s22, s30
    s_and_b32 s25, s25, 0xffff
    s_mov_b32 s27, 0x20000
    s_add_u32 s84, s83, 196608
    s_add_u32 s85, s84, 196608
    s_add_u32 s86, s85, 196608
    s_add_u32 s87, s86, 196608
    s_add_u32 s88, s87, 196608
    s_add_u32 s89, s88, 196608
    v_mov_b32 v0, v24
    s_mul_i32 s77, s72, 6656
    v_add_u32 v25, 0, v0
    v_mul_u32_u24 v26, 171, v25
    v_lshrrev_b32 v26, 12, v26
    v_mul_u32_u24 v27, 24, v26
    v_sub_u32 v27, v25, v27
    v_lshlrev_b32 v27, 4, v27
    v_mul_u32_u24 v25, 416, v26
    v_add3_u32 v2, v25, v27, s77
    v_mul_u32_u24 v25, 12288, v26
    v_add_u32 v40, v25, v27
    v_add_u32 v25, 64, v0
    v_mul_u32_u24 v26, 171, v25
    v_lshrrev_b32 v26, 12, v26
    v_mul_u32_u24 v27, 24, v26
    v_sub_u32 v27, v25, v27
    v_lshlrev_b32 v27, 4, v27
    v_mul_u32_u24 v25, 416, v26
    v_add3_u32 v3, v25, v27, s77
    v_mul_u32_u24 v25, 12288, v26
    v_add_u32 v41, v25, v27
    v_add_u32 v25, 128, v0
    v_mul_u32_u24 v26, 171, v25
    v_lshrrev_b32 v26, 12, v26
    v_mul_u32_u24 v27, 24, v26
    v_sub_u32 v27, v25, v27
    v_lshlrev_b32 v27, 4, v27
    v_mul_u32_u24 v25, 416, v26
    v_add3_u32 v4, v25, v27, s77
    v_mul_u32_u24 v25, 12288, v26
    v_add_u32 v42, v25, v27
    v_and_b32 v25, 15, v0
    v_lshrrev_b32 v26, 4, v0
    v_bfe_u32 v27, v0, 2, 2
    v_and_b32 v28, 3, v0
    s_mul_i32 s78, s71, 160
    v_lshlrev_b32 v36, 4, v26
    v_lshlrev_b32 v37, 3, v26
    v_lshlrev_b32 v39, 2, v0
    buffer_load_dwordx4 v[70:73], v36, s[36:39], s78 offen
    buffer_load_dwordx4 v[74:77], v36, s[36:39], s78 offen offset:64
    buffer_load_dwordx2 v[78:79], v37, s[36:39], s78 offen offset:128
    buffer_load_dwordx4 v[80:83], v1, s[36:39], 0 offen
    buffer_load_dword v84, v39, s[36:39], 0 offen offset:1024
    s_lshl_b32 s7, s69, 6
    v_lshlrev_b32 v38, 2, v25
    buffer_load_dword v22, v38, s[36:39], s7 offen
    s_mul_i32 s78, s71, 983040
    s_add_u32 s79, s79, s78
    s_mul_i32 s78, s72, 98304
    s_add_u32 s79, s79, s78
    s_mul_i32 s78, s72, 3072
    s_add_u32 s78, s78, 26624
    s_add_u32 m0, s78, 0
    s_nop 0
    buffer_load_dwordx4 v40, s[20:23], s79 offen nt lds
    s_add_u32 m0, s78, 1024
    s_nop 0
    buffer_load_dwordx4 v41, s[20:23], s79 offen nt lds
    s_add_u32 m0, s78, 2048
    s_nop 0
    buffer_load_dwordx4 v42, s[20:23], s79 offen nt lds
    s_add_u32 s79, s79, 393216
    s_add_u32 m0, s78, 12288
    s_nop 0
    buffer_load_dwordx4 v40, s[20:23], s79 offen nt lds
    s_add_u32 m0, s78, 13312
    s_nop 0
    buffer_load_dwordx4 v41, s[20:23], s79 offen nt lds
    s_add_u32 m0, s78, 14336
    s_nop 0
    buffer_load_dwordx4 v42, s[20:23], s79 offen nt lds
    s_add_u32 s79, s79, 393216
    s_cmp_ge_u32 s72, 2
    s_cbranch_scc1 NOWQ3
    s_add_u32 m0, s78, 24576
    s_nop 0
    buffer_load_dwordx4 v40, s[20:23], s79 offen nt lds
    s_add_u32 m0, s78, 25600
    s_nop 0
    buffer_load_dwordx4 v41, s[20:23], s79 offen nt lds
    s_add_u32 m0, s78, 26624
    s_nop 0
    buffer_load_dwordx4 v42, s[20:23], s79 offen nt lds
NOWQ3:
    s_mul_i32 s78, s71, 160
    s_mov_b32 s20, s52
    s_and_b32 s21, s53, 0xffff
    s_mov_b32 s22, 7864320
    s_mov_b32 s23, 0x20000
    s_cmp_lt_u32 s72, 2
    s_cselect_b32 s36, s56, s58
    s_cselect_b32 s37, s57, s59
    s_and_b32 s37, s37, 0xffff
    s_mov_b32 s38, 1966080
    buffer_load_dwordx4 a[8:11], v1, s[8:11], s73 offen offset:2048 nt
    buffer_load_dwordx4 a[12:15], v1, s[8:11], s73 offen offset:3072 nt
    buffer_load_dwordx4 a[16:19], v23, s[8:11], s73 offen offset:0 nt
    v_mul_u32_u24 v29, 416, v25
    v_lshl_add_u32 v29, v26, 4, v29
    v_add_u32 v5, s77, v29
    v_lshrrev_b32 v29, 2, v0
    v_mul_u32_u24 v29, 416, v29
    v_lshl_add_u32 v29, v28, 3, v29
    v_add_u32 v6, s77, v29
    s_mul_i32 s79, s72, 96
    s_add_u32 s79, s79, 26624
    v_lshl_add_u32 v29, v26, 3, v27
    v_mul_u32_u24 v29, 384, v29
    v_lshl_add_u32 v29, v28, 3, v29
    v_add_u32 v16, s79, v29
    v_lshl_add_u32 v29, v26, 2, v27
    v_mul_u32_u24 v29, 384, v29
    v_lshl_add_u32 v29, v28, 3, v29
    v_add_u32 v17, s79, v29
    buffer_load_dwordx4 a[20:23], v23, s[8:11], s73 offen offset:1024 nt
    s_mul_i32 s79, s72, 23
    v_min_u32 v32, 22, v0
    v_add_u32 v32, s79, v32
    v_min_u32 v32, 89, v32
    v_mul_u32_u24 v31, 103, v32
    v_lshrrev_b32 v31, 10, v31
    v_mul_u32_u24 v30, 10, v31
    v_sub_u32 v30, v32, v30
    v_lshl_add_u32 v29, v30, 4, s78
    s_mul_i32 s7, s68, 10240
    s_add_u32 s7, s7, 737280
    v_mul_u32_u24 v8, 1280, v31
    v_add_u32 v8, s7, v8
    s_mul_i32 s7, s68, 81920
    s_add_u32 s7, s7, 46592
    v_mov_b32 v30, s7
    v_cmp_eq_u32 vcc, s68, v31
    s_nop 1
    v_cndmask_b32 v8, v8, v30, vcc
    v_add_u32 v30, 2560, v30
    v_cmp_le_u32 vcc, 8, v31
    s_nop 1
    v_cndmask_b32 v8, v8, v30, vcc
    v_add_u32 v8, v8, v29
    v_add_u32 v33, v31, v32
    v_lshlrev_b32 v33, 4, v33
    v_add_u32 v33, 4096, v33
    v_add_u32 v31, 6, v31
    s_mul_i32 s7, s68, 10240
    s_add_u32 s7, s7, 737280
    v_mul_u32_u24 v9, 1280, v31
    v_add_u32 v9, s7, v9
    s_mul_i32 s7, s68, 81920
    s_add_u32 s7, s7, 46592
    v_mov_b32 v30, s7
    v_cmp_eq_u32 vcc, s68, v31
    s_nop 1
    v_cndmask_b32 v9, v9, v30, vcc
    v_add_u32 v30, 2560, v30
    v_cmp_le_u32 vcc, 8, v31
    s_nop 1
    v_cndmask_b32 v9, v9, v30, vcc
    v_add_u32 v9, v9, v29
    v_mov_b32 v30, 2147483632
    v_cmp_le_u32 vcc, 30, v0
    s_nop 1
    v_cndmask_b32 v9, v9, v30, vcc
    v_mov_b32 v9, v33
    s_lshl_b32 s78, s69, 10
    s_lshl_b32 s79, s72, 8
    s_add_u32 s78, s78, s79
    v_lshl_add_u32 v10, v0, 2, s78
    s_lshl_b32 s78, s70, 13
    s_add_u32 s78, s78, s79
    v_lshlrev_b32 v29, 10, v26
    v_lshl_add_u32 v29, v25, 4, v29
    v_add_u32 v11, s78, v29
    buffer_load_dwordx4 a[24:27], v1, s[8:11], s83 offen offset:0 nt
    s_mul_i32 s78, s72, 96
    s_add_u32 s78, s78, 118784
    v_lshl_add_u32 v29, v27, 5, s78
    v_lshl_add_u32 v29, v28, 2, v29
    v_lshrrev_b32 v30, 1, v26
    v_lshl_add_u32 v29, v30, 4, v29
    v_and_b32 v30, 1, v26
    v_lshl_add_u32 v29, v30, 1, v29
    v_mov_b32 v30, 119168
    v_cmp_le_u32 vcc, 12, v25
    s_nop 1
    v_cndmask_b32 v12, v29, v30, vcc
    v_and_b32 v30, 1, v0
    v_lshlrev_b32 v29, 5, v26
    v_lshl_add_u32 v29, v30, 4, v29
    v_add_u32 v13, 118784, v29
    v_mul_u32_u24 v30, 0xaaaa, v30
    v_and_b32 v29, 1, v27
    v_mul_u32_u24 v29, 0xaaaa, v29
    v_lshl_or_b32 v29, v29, 16, v30
    v_add_u32 v14, 0x44444444, v29
    buffer_load_dwordx4 a[28:31], v1, s[8:11], s83 offen offset:1024 nt
    s_lshl_b32 s78, s72, 8
    s_add_u32 s78, s78, 124416
    v_lshrrev_b32 v29, 5, v0
    v_lshl_add_u32 v29, v29, 6, s78
    v_bfe_u32 v30, v0, 3, 1
    v_lshl_add_u32 v29, v30, 5, v29
    v_bfe_u32 v30, v0, 1, 1
    v_lshl_add_u32 v29, v30, 4, v29
    v_bfe_u32 v30, v0, 2, 1
    v_lshl_add_u32 v29, v30, 3, v29
    v_bfe_u32 v30, v0, 4, 1
    v_lshl_add_u32 v29, v30, 2, v29
    v_bfe_u32 v30, v0, 0, 1
    v_lshl_add_u32 v29, v30, 1, v29
    v_mov_b32 v19, v29
    v_bfe_u32 v29, v0, 4, 1
    v_bfe_u32 v30, v0, 2, 1
    v_lshl_add_u32 v29, v29, 5, s78
    v_lshl_add_u32 v29, v30, 4, v29
    v_accvgpr_write_b32 a252, v29
    s_mul_i32 s78, s72, 768
    s_add_u32 s78, s78, 119296
    v_lshl_add_u32 v29, v25, 2, s78
    v_bfe_u32 v30, v0, 4, 1
    v_lshl_add_u32 v29, v30, 7, v29
    v_lshrrev_b32 v30, 5, v0
    v_lshl_add_u32 v15, v30, 6, v29
    s_waitcnt vmcnt(12)
    v_lshlrev_b32 v88, 16, v80
    v_and_b32 v89, 0xffff0000, v80
    v_lshlrev_b32 v90, 16, v81
    v_and_b32 v91, 0xffff0000, v81
    v_lshlrev_b32 v92, 16, v82
    v_and_b32 v93, 0xffff0000, v82
    v_lshlrev_b32 v94, 16, v83
    v_and_b32 v95, 0xffff0000, v83
    v_lshlrev_b32 v96, 16, v84
    v_and_b32 v97, 0xffff0000, v84
    v_add_f32 v80, v88, v89
    v_add_f32 v80, v80, v90
    v_add_f32 v80, v80, v91
    v_add_f32 v80, v80, v92
    v_add_f32 v80, v80, v93
    v_add_f32 v80, v80, v94
    v_add_f32 v80, v80, v95
    v_add_f32 v80, v80, v96
    v_add_f32 v80, v80, v97
    s_nop 1
    v_add_f32_dpp v80, v80, v80 row_ror:8 row_mask:0xf bank_mask:0xf
    s_nop 1
    v_add_f32_dpp v80, v80, v80 row_ror:4 row_mask:0xf bank_mask:0xf
    s_nop 1
    v_add_f32_dpp v80, v80, v80 row_ror:2 row_mask:0xf bank_mask:0xf
    s_nop 1
    v_add_f32_dpp v80, v80, v80 row_ror:1 row_mask:0xf bank_mask:0xf
    v_mov_b32 v81, v80
    s_nop 1
    v_permlane32_swap_b32 v80, v81
    v_add_f32 v80, v80, v81
    v_mov_b32 v81, v80
    s_nop 1
    v_permlane16_swap_b32 v80, v81
    v_add_f32 v80, v80, v81
    v_mul_f32 v80, 0x3acccccd, v80
    v_sub_f32 v88, v88, v80
    v_sub_f32 v89, v89, v80
    v_sub_f32 v90, v90, v80
    v_sub_f32 v91, v91, v80
    v_sub_f32 v92, v92, v80
    v_sub_f32 v93, v93, v80
    v_sub_f32 v94, v94, v80
    v_sub_f32 v95, v95, v80
    v_sub_f32 v96, v96, v80
    v_sub_f32 v97, v97, v80
    v_mul_f32 v82, v88, v88
    v_fmac_f32 v82, v89, v89
    v_fmac_f32 v82, v90, v90
    v_fmac_f32 v82, v91, v91
    v_fmac_f32 v82, v92, v92
    v_fmac_f32 v82, v93, v93
    v_fmac_f32 v82, v94, v94
    v_fmac_f32 v82, v95, v95
    v_fmac_f32 v82, v96, v96
    v_fmac_f32 v82, v97, v97
    buffer_load_dwordx4 a[32:35], v1, s[8:11], s83 offen offset:2048 nt
    s_nop 0
    v_add_f32_dpp v82, v82, v82 row_ror:8 row_mask:0xf bank_mask:0xf
    s_nop 1
    v_add_f32_dpp v82, v82, v82 row_ror:4 row_mask:0xf bank_mask:0xf
    s_nop 1
    v_add_f32_dpp v82, v82, v82 row_ror:2 row_mask:0xf bank_mask:0xf
    s_nop 1
    v_add_f32_dpp v82, v82, v82 row_ror:1 row_mask:0xf bank_mask:0xf
    v_mov_b32 v81, v82
    s_nop 1
    v_permlane32_swap_b32 v82, v81
    v_add_f32 v82, v82, v81
    v_mov_b32 v81, v82
    s_nop 1
    v_permlane16_swap_b32 v82, v81
    v_add_f32 v82, v82, v81
    v_mul_f32 v82, 0x3acccccd, v82
    v_add_f32 v82, 0x3727c5ac, v82
    v_rsq_f32 v82, v82
    s_mov_b32 vcc_lo, 0xaaaaaaaa
    s_mov_b32 vcc_hi, 0xaaaaaaaa
    v_mov_b32 v85, 0x3f803f80
    v_lshlrev_b32 v83, 16, v70
    v_and_b32 v84, 0xffff0000, v70
    v_sub_f32 v83, v83, v80
    v_sub_f32 v84, v84, v80
    v_mul_f32 v83, v83, v82
    v_mul_f32 v84, v84, v82
    v_cvt_pk_bf16_f32 v83, v83, v84
    v_cndmask_b32 v70, v83, v85, vcc
    v_lshlrev_b32 v83, 16, v71
    v_and_b32 v84, 0xffff0000, v71
    v_sub_f32 v83, v83, v80
    v_sub_f32 v84, v84, v80
    v_mul_f32 v83, v83, v82
    v_mul_f32 v84, v84, v82
    v_cvt_pk_bf16_f32 v83, v83, v84
    v_cndmask_b32 v71, v83, v85, vcc
    v_lshlrev_b32 v83, 16, v72
    v_and_b32 v84, 0xffff0000, v72
    v_sub_f32 v83, v83, v80
    v_sub_f32 v84, v84, v80
    v_mul_f32 v83, v83, v82
    v_mul_f32 v84, v84, v82
    v_cvt_pk_bf16_f32 v83, v83, v84
    v_cndmask_b32 v72, v83, v85, vcc
    v_lshlrev_b32 v83, 16, v73
    v_and_b32 v84, 0xffff0000, v73
    v_sub_f32 v83, v83, v80
    v_sub_f32 v84, v84, v80
    v_mul_f32 v83, v83, v82
    v_mul_f32 v84, v84, v82
    v_cvt_pk_bf16_f32 v83, v83, v84
    v_cndmask_b32 v73, v83, v85, vcc
    v_lshlrev_b32 v83, 16, v74
    v_and_b32 v84, 0xffff0000, v74
    v_sub_f32 v83, v83, v80
    v_sub_f32 v84, v84, v80
    v_mul_f32 v83, v83, v82
    v_mul_f32 v84, v84, v82
    v_cvt_pk_bf16_f32 v83, v83, v84
    v_cndmask_b32 v74, v83, v85, vcc
    v_lshlrev_b32 v83, 16, v75
    v_and_b32 v84, 0xffff0000, v75
    v_sub_f32 v83, v83, v80
    v_sub_f32 v84, v84, v80
    v_mul_f32 v83, v83, v82
    v_mul_f32 v84, v84, v82
    v_cvt_pk_bf16_f32 v83, v83, v84
    v_cndmask_b32 v75, v83, v85, vcc
    buffer_load_dwordx4 a[36:39], v1, s[8:11], s83 offen offset:3072 nt
    v_lshlrev_b32 v83, 16, v76
    v_and_b32 v84, 0xffff0000, v76
    v_sub_f32 v83, v83, v80
    v_sub_f32 v84, v84, v80
    v_mul_f32 v83, v83, v82
    v_mul_f32 v84, v84, v82
    v_cvt_pk_bf16_f32 v83, v83, v84
    v_cndmask_b32 v76, v83, v85, vcc
    v_lshlrev_b32 v83, 16, v77
    v_and_b32 v84, 0xffff0000, v77
    v_sub_f32 v83, v83, v80
    v_sub_f32 v84, v84, v80
    v_mul_f32 v83, v83, v82
    v_mul_f32 v84, v84, v82
    v_cvt_pk_bf16_f32 v83, v83, v84
    v_cndmask_b32 v77, v83, v85, vcc
    v_lshlrev_b32 v83, 16, v78
    v_and_b32 v84, 0xffff0000, v78
    v_sub_f32 v83, v83, v80
    v_sub_f32 v84, v84, v80
    v_mul_f32 v83, v83, v82
    v_mul_f32 v84, v84, v82
    v_cvt_pk_bf16_f32 v83, v83, v84
    v_cndmask_b32 v78, v83, v85, vcc
    v_lshlrev_b32 v83, 16, v79
    v_and_b32 v84, 0xffff0000, v79
    v_sub_f32 v83, v83, v80
    v_sub_f32 v84, v84, v80
    v_mul_f32 v83, v83, v82
    v_mul_f32 v84, v84, v82
    v_cvt_pk_bf16_f32 v83, v83, v84
    v_cndmask_b32 v79, v83, v85, vcc
    s_waitcnt vmcnt(8)
    s_barrier
    ds_read_b64_tr_b16 v[40:41], v16 offset:0
    ds_read_b64_tr_b16 v[42:43], v16 offset:1536
    ds_read_b64_tr_b16 v[44:45], v16 offset:12288
    ds_read_b64_tr_b16 v[46:47], v16 offset:13824
    ds_read_b64_tr_b16 v[48:49], v17 offset:24576
    ds_read_b64_tr_b16 v[50:51], v16 offset:32
    ds_read_b64_tr_b16 v[52:53], v16 offset:1568
    ds_read_b64_tr_b16 v[54:55], v16 offset:12320
    ds_read_b64_tr_b16 v[56:57], v16 offset:13856
    ds_read_b64_tr_b16 v[58:59], v17 offset:24608
    ds_read_b64_tr_b16 v[60:61], v16 offset:64
    ds_read_b64_tr_b16 v[62:63], v16 offset:1600
    ds_read_b64_tr_b16 v[64:65], v16 offset:12352
    ds_read_b64_tr_b16 v[66:67], v16 offset:13888
    ds_read_b64_tr_b16 v[68:69], v17 offset:24640
    v_mov_b32 v100, 0
    s_cmp_lg_u32 s72, 0
    s_cbranch_scc1 NOTL
    s_mov_b64 exec, 1
    global_load_dword v98, v100, s[64:65] sc1
    s_mov_b64 exec, -1
NOTL:
    buffer_load_dwordx4 a[40:43], v23, s[8:11], s83 offen offset:0 nt
    buffer_load_dwordx4 a[44:47], v23, s[8:11], s83 offen offset:1024 nt
    s_mul_i32 s79, s72, 96
    s_add_u32 s79, s79, 119296
    v_min_u32 v36, 48, v0
    v_lshl_add_u32 v36, v36, 1, s79
    v_mov_b32 v37, 119808
    v_cmp_le_u32 vcc, 48, v0
    s_nop 1
    v_cndmask_b32 v36, v36, v37, vcc
    v_add_u32 v37, 119296, v1
    s_waitcnt lgkmcnt(0)
    v_mfma_f32_16x16x32_bf16 v[24:27], v[70:73], v[40:43], 0
    v_mfma_f32_16x16x32_bf16 v[28:31], v[70:73], v[50:53], 0
    v_mfma_f32_16x16x32_bf16 v[32:35], v[70:73], v[60:63], 0
    v_mfma_f32_16x16x32_bf16 v[24:27], v[74:77], v[44:47], v[24:27]
    v_mfma_f32_16x16x32_bf16 v[28:31], v[74:77], v[54:57], v[28:31]
    v_mfma_f32_16x16x32_bf16 v[32:35], v[74:77], v[64:67], v[32:35]
    v_mfma_f32_16x16x16_bf16 v[24:27], v[78:79], v[48:49], v[24:27]
    v_mfma_f32_16x16x16_bf16 v[28:31], v[78:79], v[58:59], v[28:31]
    v_mfma_f32_16x16x16_bf16 v[32:35], v[78:79], v[68:69], v[32:35]
    buffer_load_dwordx4 a[48:51], v1, s[8:11], s84 offen offset:0 nt
    s_nop 4
    v_mov_b32 v7, v25
    v_mov_b32_dpp v24, v28 quad_perm:[0,1,2,3] row_mask:0x2 bank_mask:0xf
    s_nop 0
    v_mov_b32_dpp v7, v29 quad_perm:[0,1,2,3] row_mask:0x2 bank_mask:0xf
    v_mov_b32_dpp v24, v32 quad_perm:[0,1,2,3] row_mask:0x4 bank_mask:0xf
    s_nop 0
    v_mov_b32_dpp v7, v33 quad_perm:[0,1,2,3] row_mask:0x4 bank_mask:0xf
    v_cvt_pk_bf16_f32 v24, v24, v24
    ds_write_b16 v36, v24
    buffer_load_dwordx4 a[52:55], v1, s[8:11], s84 offen offset:1024 nt
    buffer_load_dwordx4 a[56:59], v1, s[8:11], s84 offen offset:2048 nt
    s_waitcnt lgkmcnt(0)
    s_barrier
    ds_read_b128 v[28:31], v37
    s_lshl_b32 s79, s69, 9
    s_add_u32 s79, s79, s3
    s_cmp_eq_u32 s72, 0
    s_cselect_b32 exec_lo, 0xffffff, 1
    s_mov_b32 exec_hi, 0
    s_cselect_b32 s78, 0, 1879048176
    v_add_u32 v37, s78, v1
    s_waitcnt lgkmcnt(0)
    buffer_store_dwordx4 v[28:31], v37, s[16:19], s79 offen sc1
    s_mov_b64 exec, -1
    v_mov_b32 v32, -1
    v_mov_b32 v33, -1
    v_mov_b32 v34, -1
    v_mov_b32 v35, -1
    buffer_store_dwordx4 v[32:35], v21, s[16:19], 0 offen sc1
    buffer_load_dwordx4 a[60:63], v1, s[8:11], s84 offen offset:3072 nt
    s_waitcnt vmcnt(12)
    ds_write_b128 v2, a[0:3] offset:0
    ds_write_b128 v3, a[4:7] offset:0
    ds_write_b128 v4, a[8:11] offset:0
    ds_write_b128 v2, a[12:15] offset:3328
    ds_write_b128 v3, a[16:19] offset:3328
    ds_write_b128 v4, a[20:23] offset:3328
    ds_read_b128 a[0:3], v5 offset:0
    ds_read_b128 a[4:7], v5 offset:64
    ds_read_b128 a[8:11], v5 offset:128
    ds_read_b128 a[12:15], v5 offset:192
    ds_read_b128 a[16:19], v5 offset:256
    ds_read_b128 a[20:23], v5 offset:320
    buffer_load_dwordx4 a[64:67], v23, s[8:11], s84 offen offset:0 nt
    buffer_load_dwordx4 a[68:71], v23, s[8:11], s84 offen offset:1024 nt
    s_barrier
    buffer_load_dwordx4 a[72:75], v1, s[8:11], s85 offen offset:0 nt
    buffer_load_dwordx4 a[76:79], v1, s[8:11], s85 offen offset:1024 nt
    buffer_load_dwordx4 a[80:83], v1, s[8:11], s85 offen offset:2048 nt
    buffer_load_dwordx4 a[84:87], v1, s[8:11], s85 offen offset:3072 nt
    buffer_load_dwordx4 a[88:91], v23, s[8:11], s85 offen offset:0 nt
    buffer_load_dwordx4 a[92:95], v23, s[8:11], s85 offen offset:1024 nt
    s_barrier
    s_getreg_b32 s5, hwreg(HW_REG_XCC_ID, 0, 4)
    s_cmp_lg_u32 s72, 0
    s_cbranch_scc1 NOHDR
    s_waitcnt vmcnt(9)
    v_readfirstlane_b32 s96, v98
    s_nop 0
    s_cmp_eq_u32 s96, 0
    s_cbranch_scc1 TAGLOOP
TAGOK:
    v_mov_b32 v99, s5
    s_mov_b64 exec, 1
    buffer_store_dwordx2 v[98:99], v1, s[16:19], s79 offen offset:384 sc1
    s_mov_b64 exec, -1
NOHDR:
    s_waitcnt vmcnt(14)
    ds_write_b128 v2, a[24:27] offset:0
    ds_write_b128 v3, a[28:31] offset:0
    ds_write_b128 v4, a[32:35] offset:0
    ds_write_b128 v2, a[36:39] offset:3328
    ds_write_b128 v3, a[40:43] offset:3328
    ds_write_b128 v4, a[44:47] offset:3328
    ds_read_b128 a[24:27], v5 offset:0
    ds_read_b128 a[28:31], v5 offset:64
    ds_read_b128 a[32:35], v5 offset:128
    ds_read_b128 a[36:39], v5 offset:192
    ds_read_b128 a[40:43], v5 offset:256
    ds_read_b128 a[44:47], v5 offset:320
    buffer_load_dwordx4 a[96:99], v1, s[8:11], s86 offen offset:0 nt
    buffer_load_dwordx4 a[100:103], v1, s[8:11], s86 offen offset:1024 nt
    buffer_load_dwordx4 a[104:107], v1, s[8:11], s86 offen offset:2048 nt
    buffer_load_dwordx4 a[108:111], v1, s[8:11], s86 offen offset:3072 nt
    buffer_load_dwordx4 a[112:115], v23, s[8:11], s86 offen offset:0 nt
    buffer_load_dwordx4 a[116:119], v23, s[8:11], s86 offen offset:1024 nt
    s_barrier
    s_waitcnt vmcnt(12)
    ds_write_b128 v2, a[48:51] offset:0
    ds_write_b128 v3, a[52:55] offset:0
    ds_write_b128 v4, a[56:59] offset:0
    ds_write_b128 v2, a[60:63] offset:3328
    ds_write_b128 v3, a[64:67] offset:3328
    ds_write_b128 v4, a[68:71] offset:3328
    ds_read_b128 a[48:51], v5 offset:0
    ds_read_b128 a[52:55], v5 offset:64
    ds_read_b128 a[56:59], v5 offset:128
    ds_read_b128 a[60:63], v5 offset:192
    ds_read_b128 a[64:67], v5 offset:256
    ds_read_b128 a[68:71], v5 offset:320
    v_lshlrev_b32 v100, 9, v0
    v_add_u32 v100, s3, v100
    v_bfe_u32 v96, v0, 2, 3
    v_mul_u32_u24 v96, 81920, v96
    v_and_b32 v97, 3, v0
    v_lshl_add_u32 v96, v97, 9, v96
    v_cmp_le_u32 vcc, 32, v0
    s_nop 1
    v_cndmask_b32 v100, v100, v96, vcc
    s_cmp_eq_u32 s72, 0
    s_cselect_b32 s77, 0, 1879048176
    v_add_u32 v100, s77, v100
    buffer_load_dwordx4 a[120:123], v1, s[8:11], s87 offen offset:0 nt
    buffer_load_dwordx4 a[124:127], v1, s[8:11], s87 offen offset:1024 nt
    buffer_load_dwordx4 a[128:131], v1, s[8:11], s87 offen offset:2048 nt
    buffer_load_dwordx4 a[132:135], v1, s[8:11], s87 offen offset:3072 nt
    buffer_load_dwordx4 a[136:139], v23, s[8:11], s87 offen offset:0 nt
    buffer_load_dwordx4 a[140:143], v23, s[8:11], s87 offen offset:1024 nt
    s_barrier
    s_waitcnt vmcnt(12)
    ds_write_b128 v2, a[72:75] offset:0
    ds_write_b128 v3, a[76:79] offset:0
    ds_write_b128 v4, a[80:83] offset:0
    ds_write_b128 v2, a[84:87] offset:3328
    ds_write_b128 v3, a[88:91] offset:3328
    ds_write_b128 v4, a[92:95] offset:3328
    ds_read_b128 a[72:75], v5 offset:0
    ds_read_b128 a[76:79], v5 offset:64
    ds_read_b128 a[80:83], v5 offset:128
    ds_read_b128 a[84:87], v5 offset:192
    ds_read_b128 a[88:91], v5 offset:256
    ds_read_b128 a[92:95], v5 offset:320
    buffer_load_dwordx4 a[144:147], v1, s[8:11], s88 offen offset:0 nt
    buffer_load_dwordx4 a[148:151], v1, s[8:11], s88 offen offset:1024 nt
    buffer_load_dwordx4 a[152:155], v1, s[8:11], s88 offen offset:2048 nt
    buffer_load_dwordx4 a[156:159], v1, s[8:11], s88 offen offset:3072 nt
    buffer_load_dwordx4 a[160:163], v23, s[8:11], s88 offen offset:0 nt
    buffer_load_dwordx4 a[164:167], v23, s[8:11], s88 offen offset:1024 nt
    s_barrier
    s_waitcnt vmcnt(12)
    ds_write_b128 v2, a[96:99] offset:0
    ds_write_b128 v3, a[100:103] offset:0
    ds_write_b128 v4, a[104:107] offset:0
    ds_write_b128 v2, a[108:111] offset:3328
    ds_write_b128 v3, a[112:115] offset:3328
    ds_write_b128 v4, a[116:119] offset:3328
    ds_read_b128 a[96:99], v5 offset:0
    ds_read_b128 a[100:103], v5 offset:64
    ds_read_b128 a[104:107], v5 offset:128
    ds_read_b128 a[108:111], v5 offset:192
    ds_read_b128 a[112:115], v5 offset:256
    ds_read_b128 a[116:119], v5 offset:320
    buffer_load_dwordx4 a[168:171], v1, s[8:11], s89 offen offset:0 nt
    buffer_load_dwordx4 a[172:175], v1, s[8:11], s89 offen offset:1024 nt
    buffer_load_dwordx4 a[176:179], v1, s[8:11], s89 offen offset:2048 nt
    buffer_load_dwordx4 a[180:183], v1, s[8:11], s89 offen offset:3072 nt
    buffer_load_dwordx4 a[184:187], v23, s[8:11], s89 offen offset:0 nt
    buffer_load_dwordx4 a[188:191], v23, s[8:11], s89 offen offset:1024 nt
    s_barrier
    s_cmp_ge_u32 s69, 20
    s_cbranch_scc1 DMAF
    s_lshl_b32 s66, s68, 2
    s_add_u32 s66, s66, s72
    s_mul_i32 s66, s66, 245760
    s_lshl_b32 s78, s69, 6
    s_add_u32 s66, s66, s78
    s_mul_i32 s67, s72, 12288
    s_add_u32 s67, s67, 57344
DMAX:
    v_mov_b32 v109, v20
    v_and_b32 v25, 15, v0
    v_lshrrev_b32 v26, 4, v0
    v_add_u32 v27, 4, v26
    s_mul_i32 s7, s68, 10240
    s_add_u32 s7, s7, 737280
    v_mul_u32_u24 v20, 1280, v26
    v_add_u32 v20, s7, v20
    s_mul_i32 s7, s68, 81920
    s_add_u32 s7, s7, 46592
    v_mov_b32 v28, s7
    v_cmp_eq_u32 vcc, s68, v26
    s_nop 1
    v_cndmask_b32 v20, v20, v28, vcc
    s_mul_i32 s7, s68, 10240
    s_add_u32 s7, s7, 737280
    v_mul_u32_u24 v21, 1280, v27
    v_add_u32 v21, s7, v21
    s_mul_i32 s7, s68, 81920
    s_add_u32 s7, s7, 46592
    v_mov_b32 v28, s7
    v_cmp_eq_u32 vcc, s68, v27
    s_nop 1
    v_cndmask_b32 v21, v21, v28, vcc
    s_min_u32 s7, s69, 19
    s_lshl_b32 s7, s7, 6
    v_lshl_add_u32 v25, v25, 2, s7
    v_add_u32 v20, v20, v25
    v_add_u32 v21, v21, v25
    buffer_load_dwordx4 a[216:219], v1, s[12:15], s73 offen offset:0 nt
    v_and_b32 v25, 15, v0
    v_bfe_u32 v27, v0, 2, 2
    v_and_b32 v28, 3, v0
    s_mul_i32 s7, s72, 12288
    s_add_u32 s7, s7, 57344
    v_lshl_add_u32 v29, v26, 3, v27
    v_lshlrev_b32 v29, 6, v29
    v_lshl_add_u32 v29, v28, 3, v29
    v_add_u32 v29, s7, v29
    v_accvgpr_write_b32 a246, v29
    s_mul_i32 s7, s72, 3072
    s_add_u32 s7, s7, 32768
    v_add_u32 v29, s7, v1
    v_accvgpr_write_b32 a247, v29
    s_lshl_b32 s7, s72, 6
    s_add_u32 s7, s7, 45056
    v_xor_b32 v29, v26, v27
    v_and_b32 v29, 1, v29
    v_lshl_add_u32 v29, v29, 2, v28
    v_lshl_add_u32 v29, v29, 3, s7
    v_accvgpr_write_b32 a248, v29
    s_lshl_b32 s7, s72, 8
    s_add_u32 s7, s7, 122368
    v_lshl_add_u32 v29, v0, 2, s7
    v_accvgpr_write_b32 a249, v29
    s_lshl_b32 s81, s69, 6
    s_mul_i32 s80, s68, 1280
    s_add_u32 s80, s80, s81
    s_add_u32 s80, s80, 655360
    s_add_u32 s81, s81, s3
    s_add_u32 s81, s81, 45312
    s_waitcnt vmcnt(13)
    ds_write_b128 v2, a[120:123] offset:0
    ds_write_b128 v3, a[124:127] offset:0
    ds_write_b128 v4, a[128:131] offset:0
    ds_write_b128 v2, a[132:135] offset:3328
    ds_write_b128 v3, a[136:139] offset:3328
    ds_write_b128 v4, a[140:143] offset:3328
    ds_read_b128 a[120:123], v5 offset:0
    ds_read_b128 a[124:127], v5 offset:64
    ds_read_b128 a[128:131], v5 offset:128
    ds_read_b128 a[132:135], v5 offset:192
    ds_read_b128 a[136:139], v5 offset:256
    ds_read_b128 a[140:143], v5 offset:320
    buffer_load_dwordx4 a[220:223], v1, s[12:15], s73 offen offset:1024 nt
    buffer_load_dwordx4 a[224:227], v1, s[12:15], s73 offen offset:2048 nt
    buffer_load_dwordx4 a[228:231], v1, s[12:15], s73 offen offset:3072 nt
    buffer_load_dwordx4 a[232:235], v23, s[12:15], s73 offen offset:0 nt
    buffer_load_dwordx4 a[236:239], v23, s[12:15], s73 offen offset:1024 nt
    s_barrier
    s_waitcnt vmcnt(12)
    ds_write_b128 v2, a[144:147] offset:0
    ds_write_b128 v3, a[148:151] offset:0
    ds_write_b128 v4, a[152:155] offset:0
    ds_write_b128 v2, a[156:159] offset:3328
    ds_write_b128 v3, a[160:163] offset:3328
    ds_write_b128 v4, a[164:167] offset:3328
    ds_read_b128 a[144:147], v5 offset:0
    ds_read_b128 a[148:151], v5 offset:64
    ds_read_b128 a[152:155], v5 offset:128
    ds_read_b128 a[156:159], v5 offset:192
    ds_read_b128 a[160:163], v5 offset:256
    ds_read_b128 a[164:167], v5 offset:320
    buffer_load_dwordx4 v[112:115], v1, s[12:15], s83 offen offset:0 nt
    buffer_load_dwordx4 v[116:119], v1, s[12:15], s83 offen offset:1024 nt
    buffer_load_dwordx4 v[120:123], v1, s[12:15], s83 offen offset:2048 nt
    buffer_load_dwordx4 v[124:127], v1, s[12:15], s83 offen offset:3072 nt
    buffer_load_dwordx4 v[128:131], v23, s[12:15], s83 offen offset:0 nt
    buffer_load_dwordx4 v[132:135], v23, s[12:15], s83 offen offset:1024 nt
    s_barrier
    buffer_load_dwordx2 v[98:99], v100, s[16:19], 0 offen offset:384 sc1
    s_waitcnt vmcnt(13)
    ds_write_b128 v2, a[168:171] offset:0
    ds_write_b128 v3, a[172:175] offset:0
    ds_write_b128 v4, a[176:179] offset:0
    ds_write_b128 v2, a[180:183] offset:3328
    ds_write_b128 v3, a[184:187] offset:3328
    ds_write_b128 v4, a[188:191] offset:3328
    ds_read_b128 a[168:171], v5 offset:0
    ds_read_b128 a[172:175], v5 offset:64
    ds_read_b128 a[176:179], v5 offset:128
    ds_read_b128 a[180:183], v5 offset:192
    ds_read_b128 a[184:187], v5 offset:256
    ds_read_b128 a[188:191], v5 offset:320
    buffer_load_dwordx4 v[136:139], v1, s[12:15], s84 offen offset:0 nt
    buffer_load_dwordx4 v[140:143], v1, s[12:15], s84 offen offset:1024 nt
    buffer_load_dwordx4 v[144:147], v1, s[12:15], s84 offen offset:2048 nt
    buffer_load_dwordx4 v[148:151], v1, s[12:15], s84 offen offset:3072 nt
    buffer_load_dwordx4 v[152:155], v23, s[12:15], s84 offen offset:0 nt
    buffer_load_dwordx4 v[156:159], v23, s[12:15], s84 offen offset:1024 nt
    s_barrier
    s_waitcnt vmcnt(13)
    ds_write_b128 v2, a[216:219] offset:0
    ds_write_b128 v3, a[220:223] offset:0
    ds_write_b128 v4, a[224:227] offset:0
    ds_write_b128 v2, a[228:231] offset:3328
    ds_write_b128 v3, a[232:235] offset:3328
    ds_write_b128 v4, a[236:239] offset:3328
    ds_read_b64_tr_b16 a[192:193], v6 offset:0
    ds_read_b64_tr_b16 a[196:197], v6 offset:32
    ds_read_b64_tr_b16 a[200:201], v6 offset:64
    ds_read_b64_tr_b16 a[204:205], v6 offset:96
    ds_read_b64_tr_b16 a[208:209], v6 offset:128
    ds_read_b64_tr_b16 a[212:213], v6 offset:160
    ds_read_b64_tr_b16 a[216:217], v6 offset:192
    ds_read_b64_tr_b16 a[220:221], v6 offset:224
    ds_read_b64_tr_b16 a[224:225], v6 offset:256
    ds_read_b64_tr_b16 a[228:229], v6 offset:288
    ds_read_b64_tr_b16 a[232:233], v6 offset:320
    ds_read_b64_tr_b16 a[236:237], v6 offset:352
    buffer_load_dwordx4 v[160:163], v1, s[12:15], s85 offen offset:0 nt
    buffer_load_dwordx4 v[164:167], v1, s[12:15], s85 offen offset:1024 nt
    buffer_load_dwordx4 v[168:171], v1, s[12:15], s85 offen offset:2048 nt
    buffer_load_dwordx4 v[172:175], v1, s[12:15], s85 offen offset:3072 nt
    buffer_load_dwordx4 v[176:179], v23, s[12:15], s85 offen offset:0 nt
    buffer_load_dwordx4 v[180:183], v23, s[12:15], s85 offen offset:1024 nt
    s_barrier
    s_waitcnt vmcnt(12)
    s_mov_b32 s76, -1
    v_mov_b32 v97, 125504
    s_cmp_lg_u32 s72, 0
    s_cbranch_scc1 RDYX
    v_cmp_ne_u32 vcc, s96, v98
    s_cbranch_vccnz RDYLOOP
RDYOK:
    v_cmp_ne_u32 vcc, s5, v99
    s_nop 1
    v_mov_b32 v96, vcc_lo
    ds_write_b32 v97, v96
RDYX:
    buffer_load_dwordx4 v[184:187], v1, s[12:15], s86 offen offset:0 nt
    buffer_load_dwordx4 v[188:191], v1, s[12:15], s86 offen offset:1024 nt
    s_waitcnt lgkmcnt(0)
    s_barrier
    ds_read_b32 v96, v97
    s_waitcnt lgkmcnt(0)
    v_readfirstlane_b32 s77, v96
    s_nop 0
    s_cmp_eq_u32 s77, 0
    s_cselect_b32 s10, s18, 0
    s_mov_b32 s8, s16
    s_mov_b32 s9, s17
    s_mov_b32 s11, 0x20000
    buffer_load_dwordx4 a[240:243], v109, s[16:19], 0 offen sc1
    s_mul_i32 s77, s69, 464
    s_add_u32 s77, s77, s3
    s_add_u32 s77, s77, 49152
    s_cmp_eq_u32 s72, 3
    s_cselect_b32 s77, s77, 1879048176
    v_add_u32 v106, s77, v1
    v_mov_b32 v107, 2147483632
    v_cmp_le_u32 vcc, 29, v0
    s_nop 1
    v_cndmask_b32 v106, v106, v107, vcc
    buffer_load_dwordx4 a[240:243], v106, s[16:19], 0 offen sc1
    s_lshl_b32 s77, s69, 2
    s_add_u32 s77, s77, s72
    s_lshl_b32 s78, s77, 8
    s_add_u32 s78, s78, 819200
    s_lshl_b32 s77, s77, 9
    s_sub_u32 s77, s77, 256
    v_lshlrev_b32 v24, 7, v0
    v_add_u32 v25, s77, v24
    v_min_u32 v25, 57472, v25
    v_add_u32 v24, s78, v24
    v_cmp_gt_u32 vcc, 2, v0
    s_nop 1
    v_cndmask_b32 v24, v25, v24, vcc
    s_add_u32 s77, s3, 819200
    s_mov_b64 exec, 63
    buffer_load_dword a243, v24, s[16:19], s77 offen sc1
    s_mov_b64 exec, -1
    s_lshl_b32 s77, s70, 12
    s_mul_i32 s78, s72, 96
    s_add_u32 s77, s77, s78
    s_add_u32 s77, s77, s3
    v_lshrrev_b32 v24, 4, v0
    v_lshlrev_b32 v24, 9, v24
    v_and_b32 v25, 15, v0
    v_min_u32 v25, 11, v25
    v_lshl_add_u32 v24, v25, 3, v24
    buffer_load_dwordx2 v[64:65], v24, s[16:19], s77 offen offset:0 sc1
    buffer_load_dwordx2 v[66:67], v24, s[16:19], s77 offen offset:2048 sc1
    s_cmp_lg_u32 s72, 1
    s_cbranch_scc1 NOBASE0
    s_cmp_ge_u32 s69, 20
    s_cbranch_scc1 NOBASE0
    v_mov_b32 v28, v22
    s_lshl_b32 s77, s69, 6
    s_add_u32 s77, s77, s3
    s_add_u32 s77, s77, 47872
    v_lshlrev_b32 v27, 2, v0
    v_mov_b32_dpp v29, v28 quad_perm:[1,1,1,1] row_mask:0xf bank_mask:0xf
    v_mov_b32_dpp v30, v28 quad_perm:[2,2,2,2] row_mask:0xf bank_mask:0xf
    v_mov_b32_dpp v31, v28 quad_perm:[3,3,3,3] row_mask:0xf bank_mask:0xf
    s_mov_b32 exec_lo, 0x1111
    s_mov_b32 exec_hi, 0x0
    buffer_store_dwordx4 v[28:31], v27, s[8:11], s77 offen
    s_cmp_eq_u32 s10, 0
    s_cbranch_scc1 SLOW1
BACK1:
    s_mov_b64 exec, -1
NOBASE0:
    ds_write_b128 v2, v[112:115] offset:0
    ds_write_b128 v3, v[116:119] offset:0
    ds_write_b128 v4, v[120:123] offset:0
    ds_write_b128 v2, v[124:127] offset:3328
    ds_write_b128 v3, v[128:131] offset:3328
    ds_write_b128 v4, v[132:135] offset:3328
    ds_read_b64_tr_b16 a[194:195], v6 offset:0
    ds_read_b64_tr_b16 a[198:199], v6 offset:32
    ds_read_b64_tr_b16 a[202:203], v6 offset:64
    ds_read_b64_tr_b16 a[206:207], v6 offset:96
    ds_read_b64_tr_b16 a[210:211], v6 offset:128
    ds_read_b64_tr_b16 a[214:215], v6 offset:160
    ds_read_b64_tr_b16 a[218:219], v6 offset:192
    ds_read_b64_tr_b16 a[222:223], v6 offset:224
    ds_read_b64_tr_b16 a[226:227], v6 offset:256
    ds_read_b64_tr_b16 a[230:231], v6 offset:288
    ds_read_b64_tr_b16 a[234:235], v6 offset:320
    ds_read_b64_tr_b16 a[238:239], v6 offset:352
    s_waitcnt vmcnt(13)
    ds_write_b128 v2, v[136:139] offset:0
    ds_write_b128 v3, v[140:143] offset:0
    ds_write_b128 v4, v[144:147] offset:0
    ds_write_b128 v2, v[148:151] offset:3328
    ds_write_b128 v3, v[152:155] offset:3328
    ds_write_b128 v4, v[156:159] offset:3328
    ds_read_b64_tr_b16 v[112:113], v6 offset:0
    ds_read_b64_tr_b16 v[116:117], v6 offset:32
    ds_read_b64_tr_b16 v[120:121], v6 offset:64
    ds_read_b64_tr_b16 v[124:125], v6 offset:96
    ds_read_b64_tr_b16 v[128:129], v6 offset:128
    ds_read_b64_tr_b16 v[132:133], v6 offset:160
    ds_read_b64_tr_b16 v[136:137], v6 offset:192
    ds_read_b64_tr_b16 v[140:141], v6 offset:224
    ds_read_b64_tr_b16 v[144:145], v6 offset:256
    ds_read_b64_tr_b16 v[148:149], v6 offset:288
    ds_read_b64_tr_b16 v[152:153], v6 offset:320
    ds_read_b64_tr_b16 v[156:157], v6 offset:352
    buffer_load_dwordx4 v[192:195], v1, s[12:15], s86 offen offset:2048 nt
    buffer_load_dwordx4 v[196:199], v1, s[12:15], s86 offen offset:3072 nt
    buffer_load_dwordx4 v[200:203], v23, s[12:15], s86 offen offset:0 nt
    buffer_load_dwordx4 v[204:207], v23, s[12:15], s86 offen offset:1024 nt
    s_barrier
    buffer_load_dwordx4 v[208:211], v1, s[12:15], s87 offen offset:0 nt
    s_waitcnt vmcnt(12)
    ds_write_b128 v2, v[160:163] offset:0
    ds_write_b128 v3, v[164:167] offset:0
    ds_write_b128 v4, v[168:171] offset:0
    ds_write_b128 v2, v[172:175] offset:3328
    ds_write_b128 v3, v[176:179] offset:3328
    ds_write_b128 v4, v[180:183] offset:3328
    ds_read_b64_tr_b16 v[114:115], v6 offset:0
    ds_read_b64_tr_b16 v[118:119], v6 offset:32
    ds_read_b64_tr_b16 v[122:123], v6 offset:64
    ds_read_b64_tr_b16 v[126:127], v6 offset:96
    ds_read_b64_tr_b16 v[130:131], v6 offset:128
    ds_read_b64_tr_b16 v[134:135], v6 offset:160
    ds_read_b64_tr_b16 v[138:139], v6 offset:192
    ds_read_b64_tr_b16 v[142:143], v6 offset:224
    ds_read_b64_tr_b16 v[146:147], v6 offset:256
    ds_read_b64_tr_b16 v[150:151], v6 offset:288
    ds_read_b64_tr_b16 v[154:155], v6 offset:320
    ds_read_b64_tr_b16 v[158:159], v6 offset:352
    buffer_load_dwordx4 v[212:215], v1, s[12:15], s87 offen offset:1024 nt
    buffer_load_dwordx4 v[216:219], v1, s[12:15], s87 offen offset:2048 nt
    buffer_load_dwordx4 v[220:223], v1, s[12:15], s87 offen offset:3072 nt
    buffer_load_dwordx4 v[224:227], v23, s[12:15], s87 offen offset:0 nt
    buffer_load_dwordx4 v[228:231], v23, s[12:15], s87 offen offset:1024 nt
    s_barrier
    buffer_load_dwordx4 v[232:235], v1, s[12:15], s88 offen offset:0 nt
    buffer_load_dwordx4 v[236:239], v1, s[12:15], s88 offen offset:1024 nt
    s_waitcnt vmcnt(12)
    v_lshlrev_b32 v24, 16, v64
    v_and_b32 v25, 0xffff0000, v64
    v_lshlrev_b32 v26, 16, v65
    v_and_b32 v27, 0xffff0000, v65
    v_lshlrev_b32 v28, 16, v66
    v_and_b32 v29, 0xffff0000, v66
    v_lshlrev_b32 v30, 16, v67
    v_and_b32 v31, 0xffff0000, v67
    v_add_f32 v24, v24, v28
    v_add_f32 v25, v25, v29
    v_add_f32 v26, v26, v30
    v_add_f32 v27, v27, v31
    s_nop 0
    v_permlane32_swap_b32 v24, v26
    v_permlane32_swap_b32 v25, v27
    v_add_f32 v24, v24, v26
    v_add_f32 v25, v25, v27
    s_nop 1
    v_permlane16_swap_b32 v24, v25
    v_add_f32 v24, v24, v25
    v_cvt_pk_bf16_f32 v24, v24, v24
    ds_write_b16 v12, v24
    buffer_load_dwordx4 v[240:243], v1, s[12:15], s88 offen offset:2048 nt
    v_mov_b32 v40, 0
    v_mov_b32 v41, 0
    v_mov_b32 v44, 0
    v_mov_b32 v45, 0
    v_mov_b32 v48, 0
    v_mov_b32 v49, 0
    v_mov_b32 v52, 0
    v_mov_b32 v53, 0
    v_mov_b32 v56, 0
    v_mov_b32 v57, 0
    v_mov_b32 v60, 0
    v_mov_b32 v61, 0
    v_mov_b32 v64, 0
    v_mov_b32 v65, 0
    v_mov_b32 v68, 0
    v_mov_b32 v69, 0
    v_mov_b32 v72, 0
    v_mov_b32 v73, 0
    v_mov_b32 v74, 0
    v_mov_b32 v75, 0
    v_mov_b32 v76, 0
    v_mov_b32 v77, 0
    v_mov_b32 v78, 0
    v_mov_b32 v79, 0
    v_mov_b32 v80, 0
    v_mov_b32 v81, 0
    v_mov_b32 v82, 0
    v_mov_b32 v83, 0
    v_mov_b32 v84, 0
    v_mov_b32 v85, 0
    v_mov_b32 v86, 0
    v_mov_b32 v87, 0
    buffer_load_dwordx4 v[244:247], v1, s[12:15], s88 offen offset:3072 nt
    buffer_load_dwordx4 v[248:251], v23, s[12:15], s88 offen offset:0 nt
    s_waitcnt lgkmcnt(0)
    s_barrier
    ds_read_b128 v[28:31], v13 offset:0
    ds_read_b128 v[32:35], v13 offset:128
    ds_read_b128 v[36:39], v13 offset:256
    v_mov_b32 v18, 0x3dd53b94
    s_waitcnt lgkmcnt(2)
    v_smfmac_f32_16x16x64_bf16 v[40:43], v[28:31], a[0:7], v14
    v_smfmac_f32_16x16x64_bf16 v[44:47], v[28:31], a[24:31], v14
    v_smfmac_f32_16x16x64_bf16 v[48:51], v[28:31], a[48:55], v14
    v_smfmac_f32_16x16x64_bf16 v[52:55], v[28:31], a[72:79], v14
    v_smfmac_f32_16x16x64_bf16 v[56:59], v[28:31], a[96:103], v14
    v_smfmac_f32_16x16x64_bf16 v[60:63], v[28:31], a[120:127], v14
    v_smfmac_f32_16x16x64_bf16 v[64:67], v[28:31], a[144:151], v14
    v_smfmac_f32_16x16x64_bf16 v[68:71], v[28:31], a[168:175], v14
    buffer_load_dwordx4 v[252:255], v23, s[12:15], s88 offen offset:1024 nt
    s_barrier
    s_waitcnt lgkmcnt(1)
    v_smfmac_f32_16x16x64_bf16 v[40:43], v[32:35], a[8:15], v14
    v_smfmac_f32_16x16x64_bf16 v[44:47], v[32:35], a[32:39], v14
    v_smfmac_f32_16x16x64_bf16 v[48:51], v[32:35], a[56:63], v14
    v_smfmac_f32_16x16x64_bf16 v[52:55], v[32:35], a[80:87], v14
    v_smfmac_f32_16x16x64_bf16 v[56:59], v[32:35], a[104:111], v14
    v_smfmac_f32_16x16x64_bf16 v[60:63], v[32:35], a[128:135], v14
    v_smfmac_f32_16x16x64_bf16 v[64:67], v[32:35], a[152:159], v14
    v_smfmac_f32_16x16x64_bf16 v[68:71], v[32:35], a[176:183], v14
    s_waitcnt lgkmcnt(0)
    v_smfmac_f32_16x16x64_bf16 v[40:43], v[36:39], a[16:23], v14
    v_smfmac_f32_16x16x64_bf16 v[44:47], v[36:39], a[40:47], v14
    v_smfmac_f32_16x16x64_bf16 v[48:51], v[36:39], a[64:71], v14
    v_smfmac_f32_16x16x64_bf16 v[52:55], v[36:39], a[88:95], v14
    v_smfmac_f32_16x16x64_bf16 v[56:59], v[36:39], a[112:119], v14
    v_smfmac_f32_16x16x64_bf16 v[60:63], v[36:39], a[136:143], v14
    v_smfmac_f32_16x16x64_bf16 v[64:67], v[36:39], a[160:167], v14
    v_smfmac_f32_16x16x64_bf16 v[68:71], v[36:39], a[184:191], v14
    s_nop 0
    v_add_f32 v24, v40, v41
    v_add_f32 v44, v44, v45
    v_add_f32 v48, v48, v49
    v_max3_f32 v26, v24, v44, v48
    v_add_f32 v52, v52, v53
    v_add_f32 v25, v56, v57
    v_max3_f32 v26, v26, v52, v25
    v_add_f32 v60, v60, v61
    v_add_f32 v64, v64, v65
    v_max3_f32 v26, v26, v60, v64
    v_add_f32 v68, v68, v69
    v_max_f32 v26, v26, v68
    v_mov_b32_dpp v24, v44 quad_perm:[0,1,2,3] row_mask:0x2 bank_mask:0xf
    v_mov_b32_dpp v25, v60 quad_perm:[0,1,2,3] row_mask:0x2 bank_mask:0xf
    v_max_f32_dpp v26, v26, v26 row_ror:8 row_mask:0xf bank_mask:0xf
    v_mov_b32_dpp v24, v48 quad_perm:[0,1,2,3] row_mask:0x4 bank_mask:0xf
    v_mov_b32_dpp v25, v64 quad_perm:[0,1,2,3] row_mask:0x4 bank_mask:0xf
    v_max_f32_dpp v26, v26, v26 row_ror:4 row_mask:0xf bank_mask:0xf
    v_mov_b32_dpp v24, v52 quad_perm:[0,1,2,3] row_mask:0x8 bank_mask:0xf
    v_mov_b32_dpp v25, v68 quad_perm:[0,1,2,3] row_mask:0x8 bank_mask:0xf
    v_max_f32_dpp v26, v26, v26 row_ror:2 row_mask:0xf bank_mask:0xf
    v_accvgpr_read_b32 v27, a252
    s_nop 0
    v_max_f32_dpp v26, v26, v26 row_ror:1 row_mask:0xf bank_mask:0xf
    v_mul_f32 v26, v26, v18
    v_fma_f32 v24, v24, v18, -v26
    v_fma_f32 v25, v25, v18, -v26
    v_exp_f32 v24, v24
    v_exp_f32 v25, v25
    s_nop 0
    v_cvt_pk_bf16_f32 v28, v24, v25
    ds_write_b16 v19, v28
    ds_write_b16_d16_hi v19, v28 offset:128
    s_mov_b32 exec_lo, 0xff00ff
    s_mov_b32 exec_hi, 0xff00ff00
    ds_read_b128 v[72:75], v27 offset:0
    ds_read_b128 v[76:79], v27 offset:64
    ds_read_b128 v[80:83], v27 offset:128
    ds_read_b128 v[84:87], v27 offset:192
    s_mov_b64 exec, -1
    v_add_f32 v27, v24, v25
    v_mov_b32 v40, 0
    v_mov_b32 v44, 0
    v_add_f32_dpp v27, v27, v27 row_ror:8 row_mask:0xf bank_mask:0xf
    v_mov_b32 v48, 0
    v_mov_b32 v52, 0
    v_add_f32_dpp v27, v27, v27 row_ror:4 row_mask:0xf bank_mask:0xf
    v_mov_b32 v56, 0
    v_mov_b32 v60, 0
    v_add_f32_dpp v27, v27, v27 row_ror:2 row_mask:0xf bank_mask:0xf
    s_lshl_b32 s78, s72, 3
    s_add_u32 s78, s78, 125440
    v_add_f32_dpp v27, v27, v27 row_ror:1 row_mask:0xf bank_mask:0xf
    v_mov_b32 v28, v27
    s_nop 1
    v_permlane32_swap_b32 v27, v28
    v_add_f32 v27, v27, v28
    v_mov_b32 v28, v27
    s_nop 1
    v_permlane16_swap_b32 v27, v28
    v_add_f32 v27, v27, v28
    v_mov_b32 v28, s78
    ds_write_b64 v28, v[26:27]
    s_waitcnt lgkmcnt(0)
    v_smfmac_f32_16x16x64_bf16 v[40:43], v[72:75], a[192:199], v14 abid:1
    v_smfmac_f32_16x16x64_bf16 v[44:47], v[72:75], a[200:207], v14 abid:1
    v_smfmac_f32_16x16x64_bf16 v[48:51], v[72:75], a[208:215], v14 abid:1
    v_smfmac_f32_16x16x64_bf16 v[52:55], v[72:75], a[216:223], v14 abid:1
    v_smfmac_f32_16x16x64_bf16 v[56:59], v[72:75], a[224:231], v14 abid:1
    v_smfmac_f32_16x16x64_bf16 v[60:63], v[72:75], a[232:239], v14 abid:1
    v_smfmac_f32_16x16x64_bf16 v[40:43], v[76:79], v[112:119], v14 abid:1
    v_smfmac_f32_16x16x64_bf16 v[44:47], v[76:79], v[120:127], v14 abid:1
    v_smfmac_f32_16x16x64_bf16 v[48:51], v[76:79], v[128:135], v14 abid:1
    v_smfmac_f32_16x16x64_bf16 v[52:55], v[76:79], v[136:143], v14 abid:1
    v_smfmac_f32_16x16x64_bf16 v[56:59], v[76:79], v[144:151], v14 abid:1
    v_smfmac_f32_16x16x64_bf16 v[60:63], v[76:79], v[152:159], v14 abid:1
    s_waitcnt vmcnt(12)
    ds_write_b128 v2, v[184:187] offset:0
    ds_write_b128 v3, v[188:191] offset:0
    ds_write_b128 v4, v[192:195] offset:0
    ds_write_b128 v2, v[196:199] offset:3328
    ds_write_b128 v3, v[200:203] offset:3328
    ds_write_b128 v4, v[204:207] offset:3328
    ds_read_b64_tr_b16 v[160:161], v6 offset:0
    ds_read_b64_tr_b16 v[164:165], v6 offset:32
    ds_read_b64_tr_b16 v[168:169], v6 offset:64
    ds_read_b64_tr_b16 v[172:173], v6 offset:96
    ds_read_b64_tr_b16 v[176:177], v6 offset:128
    ds_read_b64_tr_b16 v[180:181], v6 offset:160
    ds_read_b64_tr_b16 v[184:185], v6 offset:192
    ds_read_b64_tr_b16 v[188:189], v6 offset:224
    ds_read_b64_tr_b16 v[192:193], v6 offset:256
    ds_read_b64_tr_b16 v[196:197], v6 offset:288
    ds_read_b64_tr_b16 v[200:201], v6 offset:320
    ds_read_b64_tr_b16 v[204:205], v6 offset:352
    v_mov_b32 v24, -1
    v_mov_b32 v25, -1
    v_mov_b32 v26, -1
    v_mov_b32 v27, -1
    buffer_store_dwordx4 v[24:27], v106, s[8:11], 0 offen
    s_cmp_eq_u32 s10, 0
    s_cbranch_scc1 SLOW2
BACK2:
    buffer_load_dwordx4 v[88:91], v1, s[12:15], s89 offen offset:0 nt
    buffer_load_dwordx4 v[92:95], v1, s[12:15], s89 offen offset:1024 nt
    buffer_load_dwordx4 v[96:99], v1, s[12:15], s89 offen offset:2048 nt
    buffer_load_dwordx4 v[100:103], v1, s[12:15], s89 offen offset:3072 nt
    buffer_load_dwordx4 v[104:107], v23, s[12:15], s89 offen offset:0 nt
    buffer_load_dwordx4 v[108:111], v23, s[12:15], s89 offen offset:1024 nt
    s_waitcnt vmcnt(13)
    ds_write_b128 v2, v[208:211] offset:0
    ds_write_b128 v3, v[212:215] offset:0
    ds_write_b128 v4, v[216:219] offset:0
    ds_write_b128 v2, v[220:223] offset:3328
    ds_write_b128 v3, v[224:227] offset:3328
    ds_write_b128 v4, v[228:231] offset:3328
    ds_read_b64_tr_b16 v[162:163], v6 offset:0
    ds_read_b64_tr_b16 v[166:167], v6 offset:32
    ds_read_b64_tr_b16 v[170:171], v6 offset:64
    ds_read_b64_tr_b16 v[174:175], v6 offset:96
    ds_read_b64_tr_b16 v[178:179], v6 offset:128
    ds_read_b64_tr_b16 v[182:183], v6 offset:160
    ds_read_b64_tr_b16 v[186:187], v6 offset:192
    ds_read_b64_tr_b16 v[190:191], v6 offset:224
    ds_read_b64_tr_b16 v[194:195], v6 offset:256
    ds_read_b64_tr_b16 v[198:199], v6 offset:288
    ds_read_b64_tr_b16 v[202:203], v6 offset:320
    ds_read_b64_tr_b16 v[206:207], v6 offset:352
    v_and_b32 v23, 0xffff0000, v22
    v_lshlrev_b32 v22, 16, v22
    s_mov_b32 s82, 0x50005
    s_mov_b32 s83, 0x50005
    s_mov_b32 s84, 0x1ff01ff
    s_mov_b32 s85, 0x1ff01ff
    s_mov_b32 s86, 0xffffffff
    s_mov_b32 s87, 0x1fff
    s_mov_b32 s50, 0x7fffff
    s_mov_b32 s51, 0x0
    s_mov_b32 s88, 0xff00ff
    s_mov_b32 s89, 0xff00ff00
    s_mov_b32 s92, 0x1010101
    s_mov_b32 s93, 0x0
    s_mov_b32 s44, 0xf0f0f0f
    s_mov_b32 s45, 0xf0f0f0f
    s_mov_b64 s[46:47], s[92:93]
    s_mov_b64 s[48:49], s[44:45]
    s_cmp_ge_u32 s69, 20
    s_cbranch_scc1 TAILF
    v_mov_b32 v24, -1
    v_mov_b32 v25, -1
    v_mov_b32 v26, -1
    v_mov_b32 v27, -1
    v_and_b32 v28, 3, v0
    v_lshrrev_b32 v29, 5, v0
    v_lshl_add_u32 v28, v29, 2, v28
    v_mul_u32_u24 v28, 10240, v28
    v_bfe_u32 v29, v0, 3, 2
    v_lshl_add_u32 v28, v29, 4, v28
    s_cmp_eq_u32 s72, 3
    s_cselect_b32 s77, 0, 1879048176
    v_add_u32 v28, s77, v28
    s_add_u32 s77, s80, 81920
    s_mov_b64 exec, s[44:45]
    buffer_store_dwordx4 v[24:27], v28, s[16:19], s77 offen sc1
    s_mov_b64 exec, -1
    v_lshrrev_b32 v38, 2, v0
    v_mul_u32_u24 v38, 1280, v38
    v_and_b32 v39, 3, v0
    v_lshl_add_u32 v39, v39, 4, v38
    s_mov_b32 m0, s67
    s_add_u32 s67, s67, 1024
    buffer_load_dwordx4 v39, s[24:27], s66 offen  lds
    s_add_u32 s66, s66, 20480
    s_mov_b32 m0, s67
    s_add_u32 s67, s67, 1024
    buffer_load_dwordx4 v39, s[24:27], s66 offen  lds
    s_add_u32 s66, s66, 20480
    s_mov_b32 m0, s67
    s_add_u32 s67, s67, 1024
    buffer_load_dwordx4 v39, s[24:27], s66 offen  lds
    s_add_u32 s66, s66, 20480
    s_waitcnt lgkmcnt(0)
    v_smfmac_f32_16x16x64_bf16 v[40:43], v[80:83], v[160:167], v14 abid:1
    v_smfmac_f32_16x16x64_bf16 v[44:47], v[80:83], v[168:175], v14 abid:1
    v_smfmac_f32_16x16x64_bf16 v[48:51], v[80:83], v[176:183], v14 abid:1
    v_smfmac_f32_16x16x64_bf16 v[52:55], v[80:83], v[184:191], v14 abid:1
    v_smfmac_f32_16x16x64_bf16 v[56:59], v[80:83], v[192:199], v14 abid:1
    v_smfmac_f32_16x16x64_bf16 v[60:63], v[80:83], v[200:207], v14 abid:1
    s_waitcnt vmcnt(11)
    ds_write_b128 v2, v[232:235] offset:0
    ds_write_b128 v3, v[236:239] offset:0
    ds_write_b128 v4, v[240:243] offset:0
    ds_write_b128 v2, v[244:247] offset:3328
    ds_write_b128 v3, v[248:251] offset:3328
    ds_write_b128 v4, v[252:255] offset:3328
    ds_read_b64_tr_b16 v[208:209], v6 offset:0
    ds_read_b64_tr_b16 v[212:213], v6 offset:32
    ds_read_b64_tr_b16 v[216:217], v6 offset:64
    ds_read_b64_tr_b16 v[220:221], v6 offset:96
    ds_read_b64_tr_b16 v[224:225], v6 offset:128
    ds_read_b64_tr_b16 v[228:229], v6 offset:160
    ds_read_b64_tr_b16 v[232:233], v6 offset:192
    ds_read_b64_tr_b16 v[236:237], v6 offset:224
    ds_read_b64_tr_b16 v[240:241], v6 offset:256
    ds_read_b64_tr_b16 v[244:245], v6 offset:288
    ds_read_b64_tr_b16 v[248:249], v6 offset:320
    ds_read_b64_tr_b16 v[252:253], v6 offset:352
    s_mov_b32 m0, s67
    s_add_u32 s67, s67, 1024
    buffer_load_dwordx4 v39, s[24:27], s66 offen  lds
    s_add_u32 s66, s66, 20480
    s_mov_b32 m0, s67
    s_add_u32 s67, s67, 1024
    buffer_load_dwordx4 v39, s[24:27], s66 offen  lds
    s_add_u32 s66, s66, 20480
    s_mov_b32 m0, s67
    s_add_u32 s67, s67, 1024
    buffer_load_dwordx4 v39, s[24:27], s66 offen  lds
    s_add_u32 s66, s66, 20480
    s_waitcnt vmcnt(12)
    ds_write_b128 v2, v[88:91] offset:0
    s_waitcnt vmcnt(11)
    ds_write_b128 v3, v[92:95] offset:0
    s_waitcnt vmcnt(10)
    ds_write_b128 v4, v[96:99] offset:0
    s_waitcnt vmcnt(9)
    ds_write_b128 v2, v[100:103] offset:3328
    s_waitcnt vmcnt(8)
    ds_write_b128 v3, v[104:107] offset:3328
    s_waitcnt vmcnt(7)
    ds_write_b128 v4, v[108:111] offset:3328
    ds_read_b64_tr_b16 v[210:211], v6 offset:0
    ds_read_b64_tr_b16 v[214:215], v6 offset:32
    ds_read_b64_tr_b16 v[218:219], v6 offset:64
    ds_read_b64_tr_b16 v[222:223], v6 offset:96
    ds_read_b64_tr_b16 v[226:227], v6 offset:128
    ds_read_b64_tr_b16 v[230:231], v6 offset:160
    ds_read_b64_tr_b16 v[234:235], v6 offset:192
    ds_read_b64_tr_b16 v[238:239], v6 offset:224
    ds_read_b64_tr_b16 v[242:243], v6 offset:256
    ds_read_b64_tr_b16 v[246:247], v6 offset:288
    ds_read_b64_tr_b16 v[250:251], v6 offset:320
    ds_read_b64_tr_b16 v[254:255], v6 offset:352
    s_branch ATT_LAST
TAILF:
    s_lshl_b32 s90, s68, 2
    s_add_u32 s90, s90, s72
    s_add_u32 s90, s90, 1
    s_mul_i32 s90, s90, 245760
    s_sub_u32 s78, 32, s69
    s_mul_i32 s78, s78, 10240
    s_sub_u32 s90, s90, s78
    buffer_load_dwordx4 a[240:243], v1, s[20:23], s90 offen offset:0
    buffer_load_dwordx4 a[240:243], v1, s[20:23], s90 offen offset:1024
    buffer_load_dwordx4 a[240:243], v1, s[20:23], s90 offen offset:2048
    buffer_load_dwordx4 a[240:243], v1, s[20:23], s90 offen offset:3072
    s_add_u32 s90, s90, 4096
    buffer_load_dwordx4 a[240:243], v1, s[20:23], s90 offen offset:0
    buffer_load_dwordx4 a[240:243], v1, s[20:23], s90 offen offset:1024
    buffer_load_dwordx4 a[240:243], v1, s[20:23], s90 offen offset:2048
    v_lshrrev_b32 v38, 3, v0
    v_mul_u32_u24 v38, 3072, v38
    v_and_b32 v39, 7, v0
    v_lshl_add_u32 v38, v39, 4, v38
    v_bfe_u32 v39, v0, 4, 1
    v_lshlrev_b32 v39, 5, v39
    v_xor_b32 v38, v38, v39
    v_xor_b32 v39, 64, v38
    s_waitcnt lgkmcnt(0)
    v_smfmac_f32_16x16x64_bf16 v[40:43], v[80:83], v[160:167], v14 abid:1
    v_smfmac_f32_16x16x64_bf16 v[44:47], v[80:83], v[168:175], v14 abid:1
    v_smfmac_f32_16x16x64_bf16 v[48:51], v[80:83], v[176:183], v14 abid:1
    v_smfmac_f32_16x16x64_bf16 v[52:55], v[80:83], v[184:191], v14 abid:1
    v_smfmac_f32_16x16x64_bf16 v[56:59], v[80:83], v[192:199], v14 abid:1
    v_smfmac_f32_16x16x64_bf16 v[60:63], v[80:83], v[200:207], v14 abid:1
    s_waitcnt vmcnt(14)
    ds_write_b128 v2, v[232:235] offset:0
    ds_write_b128 v3, v[236:239] offset:0
    ds_write_b128 v4, v[240:243] offset:0
    ds_write_b128 v2, v[244:247] offset:3328
    ds_write_b128 v3, v[248:251] offset:3328
    ds_write_b128 v4, v[252:255] offset:3328
    ds_read_b64_tr_b16 v[208:209], v6 offset:0
    ds_read_b64_tr_b16 v[212:213], v6 offset:32
    ds_read_b64_tr_b16 v[216:217], v6 offset:64
    ds_read_b64_tr_b16 v[220:221], v6 offset:96
    ds_read_b64_tr_b16 v[224:225], v6 offset:128
    ds_read_b64_tr_b16 v[228:229], v6 offset:160
    ds_read_b64_tr_b16 v[232:233], v6 offset:192
    ds_read_b64_tr_b16 v[236:237], v6 offset:224
    ds_read_b64_tr_b16 v[240:241], v6 offset:256
    ds_read_b64_tr_b16 v[244:245], v6 offset:288
    ds_read_b64_tr_b16 v[248:249], v6 offset:320
    ds_read_b64_tr_b16 v[252:253], v6 offset:352
    buffer_load_dwordx4 a[240:243], v1, s[20:23], s90 offen offset:3072
    s_add_u32 s90, s90, 4096
    buffer_load_dwordx4 a[240:243], v1, s[20:23], s90 offen offset:0
    buffer_load_dwordx4 a[240:243], v1, s[20:23], s90 offen offset:1024
    s_waitcnt vmcnt(15)
    ds_write_b128 v2, v[88:91] offset:0
    s_waitcnt vmcnt(14)
    ds_write_b128 v3, v[92:95] offset:0
    s_waitcnt vmcnt(13)
    ds_write_b128 v4, v[96:99] offset:0
    s_waitcnt vmcnt(12)
    ds_write_b128 v2, v[100:103] offset:3328
    s_waitcnt vmcnt(11)
    ds_write_b128 v3, v[104:107] offset:3328
    s_waitcnt vmcnt(10)
    ds_write_b128 v4, v[108:111] offset:3328
    ds_read_b64_tr_b16 v[210:211], v6 offset:0
    ds_read_b64_tr_b16 v[214:215], v6 offset:32
    ds_read_b64_tr_b16 v[218:219], v6 offset:64
    ds_read_b64_tr_b16 v[222:223], v6 offset:96
    ds_read_b64_tr_b16 v[226:227], v6 offset:128
    ds_read_b64_tr_b16 v[230:231], v6 offset:160
    ds_read_b64_tr_b16 v[234:235], v6 offset:192
    ds_read_b64_tr_b16 v[238:239], v6 offset:224
    ds_read_b64_tr_b16 v[242:243], v6 offset:256
    ds_read_b64_tr_b16 v[246:247], v6 offset:288
    ds_read_b64_tr_b16 v[250:251], v6 offset:320
    ds_read_b64_tr_b16 v[254:255], v6 offset:352
    s_mov_b32 m0, s67
    s_add_u32 s67, s67, 1024
    buffer_load_dwordx4 v38, s[36:39], s66 offen nt lds
    s_add_u32 s66, s66, 24576
    s_mov_b32 m0, s67
    s_add_u32 s67, s67, 1024
    buffer_load_dwordx4 v39, s[36:39], s66 offen nt lds
    s_add_u32 s66, s66, 24576
    s_branch ATT_LAST
LOOP:
    s_cmp_lt_u32 s69, 20
    s_cselect_b32 s5, s72, 4
    s_add_u32 s96, s3, 819200
    s_add_u32 s97, s96, 4096
    s_and_b32 s77, s5, 3
    s_cbranch_scc1 LOOP2
    ds_read_b64_tr_b16 v[40:41], v16 offset:0
    ds_read_b64_tr_b16 v[42:43], v16 offset:1536
    ds_read_b64_tr_b16 v[44:45], v16 offset:12288
    ds_read_b64_tr_b16 v[46:47], v16 offset:13824
    ds_read_b64_tr_b16 v[48:49], v17 offset:24576
    ds_read_b64_tr_b16 v[50:51], v16 offset:32
    ds_read_b64_tr_b16 v[52:53], v16 offset:1568
    ds_read_b64_tr_b16 v[54:55], v16 offset:12320
    ds_read_b64_tr_b16 v[56:57], v16 offset:13856
    ds_read_b64_tr_b16 v[58:59], v17 offset:24608
    ds_read_b64_tr_b16 v[60:61], v16 offset:64
    ds_read_b64_tr_b16 v[62:63], v16 offset:1600
    ds_read_b64_tr_b16 v[64:65], v16 offset:12352
    ds_read_b64_tr_b16 v[66:67], v16 offset:13888
    ds_read_b64_tr_b16 v[68:69], v17 offset:24640
    v_and_b32 v25, 15, v0
    v_cmp_eq_u32 vcc, 12, v25
    v_mov_b32 v36, 0x3f803f80
    s_nop 0
    v_cndmask_b32 v70, 0, v36, vcc
    v_mov_b32 v71, v70
    v_mov_b32 v72, v70
    v_mov_b32 v73, v70
    v_mov_b32 v74, v70
    v_mov_b32 v75, v70
    v_mov_b32 v76, v70
    v_mov_b32 v77, v70
    v_mov_b32 v78, v70
    v_mov_b32 v79, v70
    s_mov_b32 s77, 4096
    v_mul_u32_u24 v96, 103, v0
    v_lshrrev_b32 v96, 10, v96
    v_lshl_add_u32 v96, v96, 4, v1
    v_add_u32 v96, s77, v96
    v_mul_u32_u24 v97, 176, v25
    v_add_u32 v97, s77, v97
    v_lshrrev_b32 v28, 4, v0
    v_lshl_add_u32 v98, v28, 3, v97
    v_lshl_add_u32 v97, v28, 4, v97
LOOP2:
    s_add_u32 s79, s3, 4096
    s_mul_i32 s77, s71, 160
    s_add_u32 s77, s77, s3
    s_sub_u32 s77, s77, 772608
    s_mov_b32 exec_lo, 0x3ff
    s_mov_b32 exec_hi, 0x0
    s_mov_b32 s76, 1
POLL3:
    buffer_load_dword v24, v1, s[16:19], s77 offen sc1
POLLW3:
    s_waitcnt vmcnt(0)
    v_cmp_eq_u32 vcc, -1, v24
    s_cbranch_vccnz AGAIN3
POLLX3:
    s_mov_b64 exec, s[50:51]
    buffer_load_dwordx4 v[80:83], v8, s[16:19], 0 offen sc1
    s_waitcnt vmcnt(0)
BW4:
    ds_write_b128 v9, v[80:83]
    v_cmp_eq_u32 vcc, -1, v80
    s_cbranch_vccnz BR4
BX4:
    s_mov_b64 exec, s[84:85]
    s_waitcnt lgkmcnt(0)
    s_barrier
    ds_read_b128 v[70:73], v97
    ds_read_b128 v[74:77], v97 offset:64
    ds_read_b64 v[78:79], v98 offset:128
    s_mov_b64 exec, -1
    s_cmp_lg_u32 s5, 1
    s_cbranch_scc1 NOOWL
    buffer_load_dword a244, v20, s[16:19], 0 offen sc1
    buffer_load_dword a245, v21, s[16:19], 0 offen sc1
NOOWL:
    buffer_load_dwordx4 v[88:91], v11, s[16:19], s96 offen sc1
    buffer_load_dwordx4 v[92:95], v11, s[16:19], s97 offen sc1
    s_waitcnt lgkmcnt(2)
    v_mfma_f32_16x16x32_bf16 v[24:27], v[70:73], v[40:43], 0
    v_mfma_f32_16x16x32_bf16 v[32:35], v[70:73], v[60:63], 0
    s_waitcnt lgkmcnt(0)
    v_mfma_f32_16x16x32_bf16 v[24:27], v[74:77], v[44:47], v[24:27]
    v_mfma_f32_16x16x32_bf16 v[32:35], v[74:77], v[64:67], v[32:35]
    v_mfma_f32_16x16x16_bf16 v[24:27], v[78:79], v[48:49], v[24:27]
    v_mfma_f32_16x16x16_bf16 v[32:35], v[78:79], v[68:69], v[32:35]
    v_mfma_f32_16x16x32_bf16 v[28:31], v[70:73], v[50:53], 0
    v_mfma_f32_16x16x32_bf16 v[36:39], v[70:73], v[70:73], 0
    v_mfma_f32_16x16x32_bf16 v[28:31], v[74:77], v[54:57], v[28:31]
    v_mfma_f32_16x16x32_bf16 v[36:39], v[74:77], v[74:77], v[36:39]
    v_mfma_f32_16x16x16_bf16 v[28:31], v[78:79], v[58:59], v[28:31]
    v_mfma_f32_16x16x16_bf16 v[36:39], v[78:79], v[78:79], v[36:39]
    s_nop 0
    v_add_f32 v24, v24, v25
    v_add_f32 v26, v26, v27
    v_add_f32 v24, v24, v26
    v_add_f32 v32, v32, v33
    v_add_f32 v34, v34, v35
    v_add_f32 v32, v32, v34
    s_nop 1
    v_permlane32_swap_b32 v24, v32
    v_add_f32 v28, v28, v29
    v_add_f32 v30, v30, v31
    v_add_f32 v36, v36, v37
    v_add_f32 v38, v38, v39
    v_add_f32 v24, v24, v32
    v_add_f32 v28, v28, v30
    v_add_f32 v36, v36, v38
    s_nop 1
    v_permlane32_swap_b32 v28, v36
    v_add_f32 v28, v28, v36
    s_nop 1
    v_permlane16_swap_b32 v24, v28
    v_add_f32 v24, v24, v28
    buffer_store_dword v24, v10, s[8:11], s3 offen
    s_cmp_eq_u32 s10, 0
    s_cbranch_scc1 SLOW5
BACK5:
    v_mov_b32 v40, 0
    v_mov_b32 v41, 0
    v_mov_b32 v44, 0
    v_mov_b32 v45, 0
    v_mov_b32 v48, 0
    v_mov_b32 v49, 0
    v_mov_b32 v52, 0
    v_mov_b32 v53, 0
    v_mov_b32 v56, 0
    v_mov_b32 v57, 0
    v_mov_b32 v60, 0
    v_mov_b32 v61, 0
    v_mov_b32 v64, 0
    v_mov_b32 v65, 0
    v_mov_b32 v68, 0
    v_mov_b32 v69, 0
    v_mov_b32 v72, 0
    v_mov_b32 v73, 0
    v_mov_b32 v74, 0
    v_mov_b32 v75, 0
    v_mov_b32 v76, 0
    v_mov_b32 v77, 0
    v_mov_b32 v78, 0
    v_mov_b32 v79, 0
    v_mov_b32 v80, 0
    v_mov_b32 v81, 0
    v_mov_b32 v82, 0
    v_mov_b32 v83, 0
    v_mov_b32 v84, 0
    v_mov_b32 v85, 0
    v_mov_b32 v86, 0
    v_mov_b32 v87, 0
    s_waitcnt vmcnt(1)
    v_add_f32 v88, v88, v92
    v_add_f32 v89, v89, v93
    v_add_f32 v90, v90, v94
    v_add_f32 v91, v91, v95
    s_nop 0
    v_permlane32_swap_b32 v88, v90
    v_permlane32_swap_b32 v89, v91
    v_add_f32 v88, v88, v90
    v_add_f32 v89, v89, v91
    s_nop 1
    v_permlane16_swap_b32 v88, v89
    v_add_f32 v88, v88, v89
    v_mul_f32 v7, 0x3acccccd, v88
    s_mov_b32 s76, 1
POLL6:
    buffer_load_dwordx4 v[24:27], v11, s[16:19], s3 offen sc1
    buffer_load_dwordx4 v[28:31], v11, s[16:19], s79 offen sc1
    s_waitcnt vmcnt(0)
    v_add_f32 v24, v24, v28
    v_add_f32 v25, v25, v29
    v_add_f32 v26, v26, v30
    v_add_f32 v27, v27, v31
    s_nop 0
    v_permlane32_swap_b32 v24, v26
    v_permlane32_swap_b32 v25, v27
    v_add_f32 v24, v24, v26
    v_add_f32 v25, v25, v27
    s_nop 1
    v_permlane16_swap_b32 v24, v25
    v_add_f32 v24, v24, v25
    v_cmp_u_f32 vcc, v24, v24
    s_cbranch_vccnz AGAIN6
POLLX6:
    v_readlane_b32 s77, v24, 15
    s_mov_b32 vcc_lo, 0x70007000
    s_mov_b32 vcc_hi, 0x70007000
    v_fma_f32 v25, -s77, v7, v24
    v_cvt_pk_bf16_f32 v25, v25, v25
    ds_write_b16 v12, v25
    v_cndmask_b32 v26, 0, v24, vcc
    s_nop 1
    v_add_f32_dpp v26, v26, v26 quad_perm:[1,0,3,2] row_mask:0xf bank_mask:0xf
    s_nop 1
    v_add_f32_dpp v26, v26, v26 quad_perm:[2,3,0,1] row_mask:0xf bank_mask:0xf
    v_mov_b32 v27, v26
    s_nop 1
    v_permlane32_swap_b32 v26, v27
    v_add_f32 v26, v26, v27
    s_waitcnt lgkmcnt(0)
    s_barrier
    ds_read_b128 v[28:31], v13 offset:0
    ds_read_b128 v[32:35], v13 offset:128
    ds_read_b128 v[36:39], v13 offset:256
    v_mov_b32 v27, v26
    v_mov_b32 v25, s77
    v_subrev_f32 v25, 0x44200000, v25
    v_permlane16_swap_b32 v26, v27
    v_add_f32 v26, v26, v27
    v_mul_f32 v24, 0x3acccccd, v25
    v_readlane_b32 s77, v26, 15
    v_mul_f32 v24, v24, v24
    s_mov_b32 s78, 0x3acccccd
    v_sub_f32 v26, s77, v25
    v_fma_f32 v26, v26, s78, -v24
    v_max_f32 v26, 0, v26
    v_add_f32 v26, 0x3727c5ac, v26
    v_rsq_f32 v26, v26
    s_nop 0
    v_mul_f32 v18, 0x3dd53b94, v26
    s_waitcnt lgkmcnt(2)
    v_smfmac_f32_16x16x64_bf16 v[40:43], v[28:31], a[0:7], v14
    v_smfmac_f32_16x16x64_bf16 v[44:47], v[28:31], a[24:31], v14
    v_smfmac_f32_16x16x64_bf16 v[48:51], v[28:31], a[48:55], v14
    v_smfmac_f32_16x16x64_bf16 v[52:55], v[28:31], a[72:79], v14
    v_smfmac_f32_16x16x64_bf16 v[56:59], v[28:31], a[96:103], v14
    v_smfmac_f32_16x16x64_bf16 v[60:63], v[28:31], a[120:127], v14
    v_smfmac_f32_16x16x64_bf16 v[64:67], v[28:31], a[144:151], v14
    v_smfmac_f32_16x16x64_bf16 v[68:71], v[28:31], a[168:175], v14
    s_waitcnt lgkmcnt(1)
    v_smfmac_f32_16x16x64_bf16 v[40:43], v[32:35], a[8:15], v14
    v_smfmac_f32_16x16x64_bf16 v[44:47], v[32:35], a[32:39], v14
    v_smfmac_f32_16x16x64_bf16 v[48:51], v[32:35], a[56:63], v14
    v_smfmac_f32_16x16x64_bf16 v[52:55], v[32:35], a[80:87], v14
    v_smfmac_f32_16x16x64_bf16 v[56:59], v[32:35], a[104:111], v14
    v_smfmac_f32_16x16x64_bf16 v[60:63], v[32:35], a[128:135], v14
    v_smfmac_f32_16x16x64_bf16 v[64:67], v[32:35], a[152:159], v14
    v_smfmac_f32_16x16x64_bf16 v[68:71], v[32:35], a[176:183], v14
    s_waitcnt lgkmcnt(0)
    v_smfmac_f32_16x16x64_bf16 v[40:43], v[36:39], a[16:23], v14
    v_smfmac_f32_16x16x64_bf16 v[44:47], v[36:39], a[40:47], v14
    v_smfmac_f32_16x16x64_bf16 v[48:51], v[36:39], a[64:71], v14
    v_smfmac_f32_16x16x64_bf16 v[52:55], v[36:39], a[88:95], v14
    v_smfmac_f32_16x16x64_bf16 v[56:59], v[36:39], a[112:119], v14
    v_smfmac_f32_16x16x64_bf16 v[60:63], v[36:39], a[136:143], v14
    v_smfmac_f32_16x16x64_bf16 v[64:67], v[36:39], a[160:167], v14
    v_smfmac_f32_16x16x64_bf16 v[68:71], v[36:39], a[184:191], v14
    s_nop 0
    v_add_f32 v24, v40, v41
    v_add_f32 v44, v44, v45
    v_add_f32 v48, v48, v49
    v_max3_f32 v26, v24, v44, v48
    v_add_f32 v52, v52, v53
    v_add_f32 v25, v56, v57
    v_max3_f32 v26, v26, v52, v25
    v_add_f32 v60, v60, v61
    v_add_f32 v64, v64, v65
    v_max3_f32 v26, v26, v60, v64
    v_add_f32 v68, v68, v69
    v_max_f32 v26, v26, v68
    v_mov_b32_dpp v24, v44 quad_perm:[0,1,2,3] row_mask:0x2 bank_mask:0xf
    v_mov_b32_dpp v25, v60 quad_perm:[0,1,2,3] row_mask:0x2 bank_mask:0xf
    v_max_f32_dpp v26, v26, v26 row_ror:8 row_mask:0xf bank_mask:0xf
    v_mov_b32_dpp v24, v48 quad_perm:[0,1,2,3] row_mask:0x4 bank_mask:0xf
    v_mov_b32_dpp v25, v64 quad_perm:[0,1,2,3] row_mask:0x4 bank_mask:0xf
    v_max_f32_dpp v26, v26, v26 row_ror:4 row_mask:0xf bank_mask:0xf
    v_mov_b32_dpp v24, v52 quad_perm:[0,1,2,3] row_mask:0x8 bank_mask:0xf
    v_mov_b32_dpp v25, v68 quad_perm:[0,1,2,3] row_mask:0x8 bank_mask:0xf
    v_max_f32_dpp v26, v26, v26 row_ror:2 row_mask:0xf bank_mask:0xf
    v_accvgpr_read_b32 v27, a252
    s_nop 0
    v_max_f32_dpp v26, v26, v26 row_ror:1 row_mask:0xf bank_mask:0xf
    v_mul_f32 v26, v26, v18
    v_fma_f32 v24, v24, v18, -v26
    v_fma_f32 v25, v25, v18, -v26
    v_exp_f32 v24, v24
    v_exp_f32 v25, v25
    s_nop 0
    v_cvt_pk_bf16_f32 v28, v24, v25
    ds_write_b16 v19, v28
    ds_write_b16_d16_hi v19, v28 offset:128
    s_mov_b64 exec, s[88:89]
    ds_read_b128 v[72:75], v27 offset:0
    ds_read_b128 v[76:79], v27 offset:64
    ds_read_b128 v[80:83], v27 offset:128
    ds_read_b128 v[84:87], v27 offset:192
    s_mov_b64 exec, -1
    v_add_f32 v27, v24, v25
    v_mov_b32 v40, 0
    v_mov_b32 v44, 0
    v_add_f32_dpp v27, v27, v27 row_ror:8 row_mask:0xf bank_mask:0xf
    v_mov_b32 v48, 0
    v_mov_b32 v52, 0
    v_add_f32_dpp v27, v27, v27 row_ror:4 row_mask:0xf bank_mask:0xf
    v_mov_b32 v56, 0
    v_mov_b32 v60, 0
    v_add_f32_dpp v27, v27, v27 row_ror:2 row_mask:0xf bank_mask:0xf
    s_lshl_b32 s78, s72, 3
    s_add_u32 s78, s78, 125440
    v_add_f32_dpp v27, v27, v27 row_ror:1 row_mask:0xf bank_mask:0xf
    v_mov_b32 v28, v27
    s_nop 1
    v_permlane32_swap_b32 v27, v28
    v_add_f32 v27, v27, v28
    v_mov_b32 v28, v27
    s_nop 1
    v_permlane16_swap_b32 v27, v28
    v_add_f32 v27, v27, v28
    v_mov_b32 v28, s78
    ds_write_b64 v28, v[26:27]
    s_waitcnt lgkmcnt(4)
    v_smfmac_f32_16x16x64_bf16 v[40:43], v[72:75], a[192:199], v14 abid:1
    v_smfmac_f32_16x16x64_bf16 v[44:47], v[72:75], a[200:207], v14 abid:1
    v_smfmac_f32_16x16x64_bf16 v[48:51], v[72:75], a[208:215], v14 abid:1
    v_smfmac_f32_16x16x64_bf16 v[52:55], v[72:75], a[216:223], v14 abid:1
    v_smfmac_f32_16x16x64_bf16 v[56:59], v[72:75], a[224:231], v14 abid:1
    v_smfmac_f32_16x16x64_bf16 v[60:63], v[72:75], a[232:239], v14 abid:1
    s_waitcnt lgkmcnt(3)
    v_smfmac_f32_16x16x64_bf16 v[40:43], v[76:79], v[112:119], v14 abid:1
    v_smfmac_f32_16x16x64_bf16 v[44:47], v[76:79], v[120:127], v14 abid:1
    v_smfmac_f32_16x16x64_bf16 v[48:51], v[76:79], v[128:135], v14 abid:1
    v_smfmac_f32_16x16x64_bf16 v[52:55], v[76:79], v[136:143], v14 abid:1
    v_smfmac_f32_16x16x64_bf16 v[56:59], v[76:79], v[144:151], v14 abid:1
    v_smfmac_f32_16x16x64_bf16 v[60:63], v[76:79], v[152:159], v14 abid:1
    s_waitcnt lgkmcnt(2)
    v_smfmac_f32_16x16x64_bf16 v[40:43], v[80:83], v[160:167], v14 abid:1
    v_smfmac_f32_16x16x64_bf16 v[44:47], v[80:83], v[168:175], v14 abid:1
    v_smfmac_f32_16x16x64_bf16 v[48:51], v[80:83], v[176:183], v14 abid:1
    v_smfmac_f32_16x16x64_bf16 v[52:55], v[80:83], v[184:191], v14 abid:1
    v_smfmac_f32_16x16x64_bf16 v[56:59], v[80:83], v[192:199], v14 abid:1
    v_smfmac_f32_16x16x64_bf16 v[60:63], v[80:83], v[200:207], v14 abid:1
    s_waitcnt lgkmcnt(0)
ATT_LAST:
    s_waitcnt lgkmcnt(8)
    v_smfmac_f32_16x16x64_bf16 v[40:43], v[84:87], v[208:215], v14 abid:1
    v_smfmac_f32_16x16x64_bf16 v[44:47], v[84:87], v[216:223], v14 abid:1
    s_waitcnt lgkmcnt(4)
    v_smfmac_f32_16x16x64_bf16 v[48:51], v[84:87], v[224:231], v14 abid:1
    v_smfmac_f32_16x16x64_bf16 v[52:55], v[84:87], v[232:239], v14 abid:1
    s_waitcnt lgkmcnt(0)
    v_smfmac_f32_16x16x64_bf16 v[56:59], v[84:87], v[240:247], v14 abid:1
    v_smfmac_f32_16x16x64_bf16 v[60:63], v[84:87], v[248:255], v14 abid:1
    s_lshl_b32 s77, s72, 8
    s_add_u32 s77, s77, 119296
    v_lshl_add_u32 v24, v0, 2, s77
    v_permlane16_swap_b32 v40, v44
    v_add_f32 v40, v40, v44
    ds_write_b32 v15, v40 offset:0
    v_permlane16_swap_b32 v48, v52
    v_add_f32 v48, v48, v52
    ds_write_b32 v15, v48 offset:256
    v_permlane16_swap_b32 v56, v60
    v_add_f32 v56, v56, v60
    ds_write_b32 v15, v56 offset:512
    v_and_b32 v25, 3, v0
    v_mad_u32_u24 v26, v25, 48, v1
    v_lshlrev_b32 v25, 3, v25
    v_add_u32 v25, 125440, v25
    s_waitcnt lgkmcnt(0)
    s_barrier
    ds_read_b64 v[32:33], v25
    ds_read2st64_b32 v[40:41], v24 offset0:0 offset1:3
    ds_read2st64_b32 v[42:43], v24 offset0:6 offset1:9
    s_mul_i32 s77, s70, 3072
    s_lshl_b32 s78, s71, 4
    s_add_u32 s77, s77, s78
    s_lshl_b32 s78, s72, 10
    s_add_u32 s77, s77, s78
    s_add_u32 s77, s77, s3
    s_add_u32 s77, s77, 32768
    s_lshl_b32 s78, s69, 3
    s_add_u32 s78, s78, s3
    s_add_u32 s78, s78, 45056
    s_cmp_eq_u32 s72, 3
    s_waitcnt lgkmcnt(2)
    v_max_f32_dpp v34, v32, v32 quad_perm:[1,0,3,2] row_mask:0xf bank_mask:0xf
    s_nop 1
    v_max_f32_dpp v34, v34, v34 quad_perm:[2,3,0,1] row_mask:0xf bank_mask:0xf
    v_sub_f32 v32, v32, v34
    v_exp_f32 v32, v32
    s_cbranch_scc1 OML
    s_waitcnt lgkmcnt(0)
    v_mul_f32_dpp v28, v32, v40 quad_perm:[0,0,0,0] row_mask:0xf bank_mask:0xf
    v_mul_f32_dpp v29, v32, v41 quad_perm:[1,1,1,1] row_mask:0xf bank_mask:0xf
    v_mul_f32_dpp v30, v32, v42 quad_perm:[2,2,2,2] row_mask:0xf bank_mask:0xf
    v_fmac_f32_dpp v28, v32, v43 quad_perm:[3,3,3,3] row_mask:0xf bank_mask:0xf
    v_add_f32 v29, v29, v30
    v_add_f32 v28, v28, v29
    s_nop 1
    v_mov_b32_dpp v29, v28 row_shl:1 row_mask:0xf bank_mask:0xf
    v_cvt_pk_bf16_f32 v28, v28, v29
    s_nop 1
    v_mov_b32_dpp v29, v28 row_shl:4 row_mask:0xf bank_mask:0xf
    v_mov_b32_dpp v30, v28 row_shl:8 row_mask:0xf bank_mask:0xf
    v_mov_b32_dpp v31, v28 row_shl:12 row_mask:0xf bank_mask:0xf
    s_mov_b64 exec, s[82:83]
    buffer_store_dwordx4 v[28:31], v26, s[8:11], s77 offen
    s_cmp_eq_u32 s10, 0
    s_cbranch_scc1 SLOW7
BACK7:
    s_mov_b64 exec, -1
ODONE:
    s_cmp_ge_u32 s69, 20
    s_cbranch_scc1 ROLEF
    s_cmp_eq_u32 s74, 0
    s_cbranch_scc1 WLATE
    v_accvgpr_read_b32 v2, a246
    v_accvgpr_read_b32 v3, a247
    v_accvgpr_read_b32 v4, a248
    ds_read_b64_tr_b16 v[40:41], v2 offset:0
    ds_read_b64_tr_b16 v[42:43], v2 offset:256
    ds_read_b64_tr_b16 v[64:65], v2 offset:32
    ds_read_b64_tr_b16 v[66:67], v2 offset:288
    ds_read_b64_tr_b16 v[44:45], v2 offset:2048
    ds_read_b64_tr_b16 v[46:47], v2 offset:2304
    ds_read_b64_tr_b16 v[68:69], v2 offset:2080
    ds_read_b64_tr_b16 v[70:71], v2 offset:2336
    ds_read_b64_tr_b16 v[48:49], v2 offset:4096
    ds_read_b64_tr_b16 v[50:51], v2 offset:4352
    s_cmp_lg_u32 s72, 1
    s_cbranch_scc1 NOOWN0
    v_accvgpr_read_b32 v28, a244
    v_accvgpr_read_b32 v29, a245
    v_max_u32 v30, v28, v29
    v_cmp_eq_u32 vcc, -1, v30
    s_cbranch_vccnz RETRY8
OK8:
    v_lshlrev_b32 v30, 16, v28
    v_and_b32 v28, 0xffff0000, v28
    v_lshlrev_b32 v31, 16, v29
    v_and_b32 v29, 0xffff0000, v29
    v_add_f32 v30, v30, v31
    v_add_f32 v28, v28, v29
    v_mov_b32 v31, v30
    v_mov_b32 v29, v28
    s_nop 0
    v_permlane32_swap_b32 v30, v31
    v_permlane32_swap_b32 v28, v29
    v_add_f32 v30, v30, v31
    v_add_f32 v28, v28, v29
    v_mov_b32 v31, v30
    v_mov_b32 v29, v28
    s_nop 0
    v_permlane16_swap_b32 v30, v31
    v_permlane16_swap_b32 v28, v29
    v_add_f32 v30, v30, v31
    v_add_f32 v28, v28, v29
    v_add_f32 v22, v22, v30
    v_add_f32 v23, v23, v28
    v_cvt_pk_bf16_f32 v28, v22, v23
    s_lshl_b32 s77, s69, 6
    s_add_u32 s77, s77, s3
    s_add_u32 s77, s77, 47872
    v_lshlrev_b32 v32, 2, v0
    v_mov_b32_dpp v29, v28 quad_perm:[1,1,1,1] row_mask:0xf bank_mask:0xf
    v_mov_b32_dpp v30, v28 quad_perm:[2,2,2,2] row_mask:0xf bank_mask:0xf
    v_mov_b32_dpp v31, v28 quad_perm:[3,3,3,3] row_mask:0xf bank_mask:0xf
    s_mov_b32 exec_lo, 0x1111
    s_mov_b32 exec_hi, 0x0
    buffer_store_dwordx4 v[28:31], v32, s[8:11], s77 offen
    s_cmp_eq_u32 s10, 0
    s_cbranch_scc1 SLOW9
BACK9:
    s_mov_b64 exec, -1
NOOWN0:
    buffer_load_dwordx2 v[24:25], v4, s[16:19], s3 offen sc1
    buffer_load_dwordx4 v[88:91], v3, s[16:19], s3 offen offset:0 sc1
    buffer_load_dwordx4 v[92:95], v3, s[16:19], s3 offen offset:1024 sc1
    buffer_load_dwordx4 v[96:99], v3, s[16:19], s3 offen offset:2048 sc1
    ds_read_b64_tr_b16 v[72:73], v2 offset:4128
    ds_read_b64_tr_b16 v[74:75], v2 offset:4384
    ds_read_b64_tr_b16 v[52:53], v2 offset:6144
    ds_read_b64_tr_b16 v[54:55], v2 offset:6400
    ds_read_b64_tr_b16 v[76:77], v2 offset:6176
    ds_read_b64_tr_b16 v[78:79], v2 offset:6432
    ds_read_b64_tr_b16 v[56:57], v2 offset:8192
    ds_read_b64_tr_b16 v[58:59], v2 offset:8448
    ds_read_b64_tr_b16 v[80:81], v2 offset:8224
    ds_read_b64_tr_b16 v[82:83], v2 offset:8480
    ds_read_b64_tr_b16 v[60:61], v2 offset:10240
    ds_read_b64_tr_b16 v[62:63], v2 offset:10496
    ds_read_b64_tr_b16 v[84:85], v2 offset:10272
    ds_read_b64_tr_b16 v[86:87], v2 offset:10528
    v_accvgpr_read_b32 v5, a249
    v_and_b32 v18, 3, v0
    v_lshrrev_b32 v6, 5, v0
    v_lshl_add_u32 v18, v6, 2, v18
    v_mul_u32_u24 v18, 10240, v18
    v_bfe_u32 v6, v0, 3, 2
    v_lshl_add_u32 v18, v6, 4, v18
    v_and_b32 v6, 0xffffff7f, v5
    v_bfe_u32 v26, v0, 3, 1
    v_mul_u32_u24 v26, 0xaaaa, v26
    v_add_u32 v26, 0x4444, v26
    v_mov_b32 v28, 0
    v_mov_b32 v29, 0
    v_mov_b32 v30, 0
    v_mov_b32 v31, 0
    v_mov_b32 v32, 0
    v_mov_b32 v33, 0
    v_mov_b32 v34, 0
    v_mov_b32 v35, 0
WCHK:
    s_waitcnt vmcnt(0)
    v_max3_u32 v38, v88, v92, v96
    v_max_u32 v38, v38, v25
    v_cmp_eq_u32 vcc, -1, v38
    s_cbranch_vccnz AGAIN10
POLLX10:
    s_waitcnt lgkmcnt(0)
    v_max_f32_dpp v27, v24, v24 quad_perm:[1,0,3,2] row_mask:0xf bank_mask:0xf
    v_smfmac_f32_16x16x64_bf16 v[28:31], v[88:91], v[40:47], v26
    v_smfmac_f32_16x16x64_bf16 v[32:35], v[88:91], v[64:71], v26
    v_max_f32_dpp v27, v27, v27 quad_perm:[2,3,0,1] row_mask:0xf bank_mask:0xf
    v_smfmac_f32_16x16x64_bf16 v[28:31], v[92:95], v[48:55], v26
    v_smfmac_f32_16x16x64_bf16 v[32:35], v[92:95], v[72:79], v26
    v_max_f32_dpp v27, v27, v27 row_ror:4 row_mask:0xf bank_mask:0xf
    v_sub_f32 v24, v24, v27
    v_exp_f32 v24, v24
    v_smfmac_f32_16x16x64_bf16 v[28:31], v[96:99], v[56:63], v26
    v_smfmac_f32_16x16x64_bf16 v[32:35], v[96:99], v[80:87], v26
    v_mul_f32 v36, v24, v25
    s_cmp_lg_u32 s72, 0
    s_nop 0
    v_add_f32_dpp v36, v36, v36 quad_perm:[1,0,3,2] row_mask:0xf bank_mask:0xf
    s_nop 1
    v_add_f32_dpp v36, v36, v36 quad_perm:[2,3,0,1] row_mask:0xf bank_mask:0xf
    v_mul_f32_dpp v28, v24, v28 row_newbcast:0 row_mask:0xf bank_mask:0xf
    v_mul_f32_dpp v30, v24, v30 row_newbcast:2 row_mask:0xf bank_mask:0xf
    v_add_f32_dpp v36, v36, v36 row_ror:4 row_mask:0xf bank_mask:0xf
    v_mul_f32_dpp v32, v24, v32 row_newbcast:0 row_mask:0xf bank_mask:0xf
    v_mul_f32_dpp v34, v24, v34 row_newbcast:2 row_mask:0xf bank_mask:0xf
    v_rcp_f32 v36, v36
    v_fmac_f32_dpp v28, v24, v29 row_newbcast:1 row_mask:0xf bank_mask:0xf
    v_fmac_f32_dpp v30, v24, v31 row_newbcast:3 row_mask:0xf bank_mask:0xf
    v_fmac_f32_dpp v32, v24, v33 row_newbcast:1 row_mask:0xf bank_mask:0xf
    v_fmac_f32_dpp v34, v24, v35 row_newbcast:3 row_mask:0xf bank_mask:0xf
    v_add_f32 v28, v28, v30
    v_add_f32 v32, v32, v34
    s_nop 1
    v_permlane16_swap_b32 v28, v32
    v_add_f32 v37, v28, v32
    v_add_f32 v28, v28, v32
    s_nop 1
    v_permlane32_swap_b32 v28, v37
    v_add_f32 v28, v28, v37
    v_mul_f32 v28, v28, v36
    ds_write_b32 v5, v28
    s_waitcnt lgkmcnt(0)
    s_barrier
    s_cbranch_scc1 WNOT0
    ds_read2st64_b32 v[28:29], v6 offset0:0 offset1:1
    ds_read2st64_b32 v[30:31], v6 offset0:2 offset1:3
    s_waitcnt lgkmcnt(1)
    v_add_f32 v28, v28, v29
    s_waitcnt lgkmcnt(0)
    v_add_f32 v30, v30, v31
    v_add_f32 v28, v28, v30
    s_nop 1
    v_mov_b32_dpp v29, v28 row_shl:1 row_mask:0xf bank_mask:0xf
    v_cvt_pk_bf16_f32 v32, v28, v29
    s_nop 1
    v_mov_b32_dpp v28, v32 quad_perm:[0,0,0,0] row_mask:0xf bank_mask:0xf
    v_mov_b32_dpp v29, v32 quad_perm:[2,2,2,2] row_mask:0xf bank_mask:0xf
    s_nop 0
    v_mov_b32_dpp v30, v28 row_shl:4 row_mask:0xf bank_mask:0xf
    v_mov_b32_dpp v31, v29 row_shl:4 row_mask:0xf bank_mask:0xf
    s_mov_b64 exec, s[46:47]
    buffer_store_dwordx4 v[28:31], v18, s[16:19], s80 offen sc1
    s_mov_b64 exec, s[92:93]
    buffer_store_dwordx4 v[28:31], v18, s[8:11], s81 offen
    s_cmp_eq_u32 s10, 0
    s_cbranch_scc1 SLOW11
BACK11:
    s_mov_b64 exec, -1
    v_add_u32 v111, 49152, v2
    s_cmp_lg_u32 s74, 0
    s_cbranch_scc1 W2OK
    v_lshrrev_b32 v38, 2, v0
    v_mul_u32_u24 v38, 1280, v38
    v_and_b32 v39, 3, v0
    v_lshl_add_u32 v39, v39, 4, v38
    s_mul_i32 s77, s68, 245760
    s_lshl_b32 s78, s69, 6
    s_add_u32 s77, s77, s78
    s_mov_b32 m0, 106496
    s_nop 0
    buffer_load_dwordx4 v39, s[32:35], s77 offen lds
    s_add_u32 s77, s77, 20480
    s_mov_b32 m0, 107520
    s_nop 0
    buffer_load_dwordx4 v39, s[32:35], s77 offen lds
    s_add_u32 s77, s77, 20480
    s_mov_b32 m0, 108544
    s_nop 0
    buffer_load_dwordx4 v39, s[32:35], s77 offen lds
    s_add_u32 s77, s77, 20480
    s_mov_b32 m0, 109568
    s_nop 0
    buffer_load_dwordx4 v39, s[32:35], s77 offen lds
    s_add_u32 s77, s77, 20480
    s_mov_b32 m0, 110592
    s_nop 0
    buffer_load_dwordx4 v39, s[32:35], s77 offen lds
    s_add_u32 s77, s77, 20480
    s_mov_b32 m0, 111616
    s_nop 0
    buffer_load_dwordx4 v39, s[32:35], s77 offen lds
    s_add_u32 s77, s77, 20480
    s_mov_b32 m0, 112640
    s_nop 0
    buffer_load_dwordx4 v39, s[32:35], s77 offen lds
    s_add_u32 s77, s77, 20480
    s_mov_b32 m0, 113664
    s_nop 0
    buffer_load_dwordx4 v39, s[32:35], s77 offen lds
    s_add_u32 s77, s77, 20480
    s_mov_b32 m0, 114688
    s_nop 0
    buffer_load_dwordx4 v39, s[32:35], s77 offen lds
    s_add_u32 s77, s77, 20480
    s_mov_b32 m0, 115712
    s_nop 0
    buffer_load_dwordx4 v39, s[32:35], s77 offen lds
    s_add_u32 s77, s77, 20480
    s_mov_b32 m0, 116736
    s_nop 0
    buffer_load_dwordx4 v39, s[32:35], s77 offen lds
    s_add_u32 s77, s77, 20480
    s_mov_b32 m0, 117760
    s_nop 0
    buffer_load_dwordx4 v39, s[32:35], s77 offen lds
    s_add_u32 s77, s77, 20480
    s_branch W2X
W2OK:
    ds_read_b64_tr_b16 v[40:41], v111 offset:0
    ds_read_b64_tr_b16 v[42:43], v111 offset:256
    ds_read_b64_tr_b16 v[64:65], v111 offset:32
    ds_read_b64_tr_b16 v[66:67], v111 offset:288
    ds_read_b64_tr_b16 v[44:45], v111 offset:2048
    ds_read_b64_tr_b16 v[46:47], v111 offset:2304
    ds_read_b64_tr_b16 v[68:69], v111 offset:2080
    ds_read_b64_tr_b16 v[70:71], v111 offset:2336
    ds_read_b64_tr_b16 v[48:49], v111 offset:4096
    ds_read_b64_tr_b16 v[50:51], v111 offset:4352
    ds_read_b64_tr_b16 v[72:73], v111 offset:4128
    ds_read_b64_tr_b16 v[74:75], v111 offset:4384
    ds_read_b64_tr_b16 v[52:53], v111 offset:6144
    ds_read_b64_tr_b16 v[54:55], v111 offset:6400
    ds_read_b64_tr_b16 v[76:77], v111 offset:6176
    ds_read_b64_tr_b16 v[78:79], v111 offset:6432
    ds_read_b64_tr_b16 v[56:57], v111 offset:8192
    ds_read_b64_tr_b16 v[58:59], v111 offset:8448
    ds_read_b64_tr_b16 v[80:81], v111 offset:8224
    ds_read_b64_tr_b16 v[82:83], v111 offset:8480
    ds_read_b64_tr_b16 v[60:61], v111 offset:10240
    ds_read_b64_tr_b16 v[62:63], v111 offset:10496
    ds_read_b64_tr_b16 v[84:85], v111 offset:10272
    ds_read_b64_tr_b16 v[86:87], v111 offset:10528
W2X:
    v_mov_b32 v100, 0
    v_mov_b32 v101, 0
    v_mov_b32 v104, 0
    v_mov_b32 v105, 0
    s_add_u32 s96, s80, 81920
    s_add_u32 s97, s81, 1280
STB:
    s_mul_i32 s77, s72, 48
    v_min_u32 v6, 47, v0
    v_add_u32 v6, s77, v6
    v_lshlrev_b32 v4, 4, v6
    v_add_u32 v108, 7168, v4
    v_lshlrev_b32 v4, 3, v6
    v_cmp_le_u32 vcc, 48, v0
    v_mov_b32 v24, 1536
    s_nop 0
    v_cndmask_b32 v4, v4, v24, vcc
    v_add_u32 v5, 3584, v4
    v_lshrrev_b32 v24, 4, v6
    v_lshlrev_b32 v24, 5, v24
    v_bfe_u32 v25, v6, 1, 1
    v_lshl_add_u32 v24, v25, 4, v24
    v_bfe_u32 v25, v6, 2, 2
    v_lshl_add_u32 v24, v25, 2, v24
    v_and_b32 v25, 1, v6
    v_lshl_add_u32 v24, v25, 1, v24
    v_add_u32 v24, 118784, v24
    v_mov_b32 v25, 119168
    v_cndmask_b32 v6, v24, v25, vcc
    v_mov_b32 v109, 0x3727c5ac
    v_mov_b32 v110, 0x3acccccd
    s_add_u32 s79, s3, 50432
    v_accvgpr_read_b32 v2, a250
    v_accvgpr_read_b32 v3, a251
    s_add_u32 s6, s74, s72
    s_mov_b32 s76, 1
    s_cmp_eq_u32 s74, 0
    s_cbranch_scc1 GPF
GPO:
    s_cmp_eq_u32 s72, 1
    s_cbranch_scc1 WOWN
GP1:
    buffer_load_dwordx2 v[32:33], v4, s[16:19], s79 offen offset:0 sc1
    buffer_load_dwordx2 v[34:35], v4, s[16:19], s79 offen offset:1792 sc1
    buffer_load_dwordx2 v[36:37], v5, s[16:19], s79 offen offset:0 sc1
    buffer_load_dwordx2 v[38:39], v5, s[16:19], s79 offen offset:1792 sc1
    s_waitcnt vmcnt(0)
    v_add_f32 v24, v32, v34
    v_add_f32 v28, v33, v35
    v_add_f32 v26, v36, v38
    v_add_f32 v30, v37, v39
    v_add_f32 v28, v28, v30
    v_add_f32 v24, v24, v26
    v_cmp_u_f32 vcc, v24, v28
    s_cbranch_vccnz GA1
GPX:
    v_readlane_b32 s77, v28, 48
    v_readlane_b32 s78, v24, 48
    s_cmp_lg_u32 s6, 1
    s_cbranch_scc0 OWL
OWB:
    v_mul_f32 v25, s77, v110
    v_fma_f32 v26, s78, v110, v109
    v_fma_f32 v26, -v25, v25, v26
    v_add_f32 v25, 1.0, v25
    v_max_f32 v26, v26, v109
    v_fma_f32 v24, -v25, v2, v24
    v_rsq_f32 v27, v26
    v_mul_f32 v29, 0xbfb8aa3b, v24
    v_mul_f32 v29, v29, v27
    v_exp_f32 v29, v29
    v_fma_f32 v28, -v25, v3, v28
    v_fma_f32 v29, v29, v26, v26
    v_rcp_f32 v29, v29
    v_mul_f32 v28, v28, v24
    v_mul_f32 v28, v28, v29
    v_cvt_pk_bf16_f32 v28, v28, v28
    ds_write_b16 v6, v28
    v_accvgpr_write_b32 a250, v2
    v_accvgpr_write_b32 a251, v3
    s_cmp_lg_u32 s72, 0
    s_waitcnt lgkmcnt(0)
    s_barrier
    s_cbranch_scc1 STBX
    ds_read_b128 v[88:91], v13 offset:0
    ds_read_b128 v[92:95], v13 offset:128
    ds_read_b128 v[96:99], v13 offset:256
    s_waitcnt lgkmcnt(2)
    v_smfmac_f32_16x16x64_bf16 v[100:103], v[88:91], v[40:47], v14
    v_smfmac_f32_16x16x64_bf16 v[104:107], v[88:91], v[64:71], v14
    s_waitcnt lgkmcnt(1)
    v_smfmac_f32_16x16x64_bf16 v[100:103], v[92:95], v[48:55], v14
    v_smfmac_f32_16x16x64_bf16 v[104:107], v[92:95], v[72:79], v14
    s_waitcnt lgkmcnt(0)
    v_smfmac_f32_16x16x64_bf16 v[100:103], v[96:99], v[56:63], v14
    v_smfmac_f32_16x16x64_bf16 v[104:107], v[96:99], v[80:87], v14
    s_nop 6
    v_add_f32 v28, v100, v101
    s_nop 1
    v_add_f32_dpp v28, v104, v105 quad_perm:[0,1,2,3] row_mask:0xa bank_mask:0xf
    s_nop 1
    v_mov_b32_dpp v29, v28 row_shl:1 row_mask:0xf bank_mask:0xf
    v_cvt_pk_bf16_f32 v32, v28, v29
    s_nop 1
    v_mov_b32_dpp v28, v32 quad_perm:[0,0,0,0] row_mask:0xf bank_mask:0xf
    v_mov_b32_dpp v29, v32 quad_perm:[2,2,2,2] row_mask:0xf bank_mask:0xf
    s_nop 0
    v_mov_b32_dpp v30, v28 row_shl:4 row_mask:0xf bank_mask:0xf
    v_mov_b32_dpp v31, v29 row_shl:4 row_mask:0xf bank_mask:0xf
    s_mov_b64 exec, s[48:49]
    buffer_store_dwordx4 v[28:31], v18, s[16:19], s96 offen sc1
    s_mov_b64 exec, s[92:93]
    buffer_store_dwordx4 v[28:31], v18, s[8:11], s97 offen
    s_cmp_eq_u32 s10, 0
    s_cbranch_scc1 SLOW12
BACK12:
    s_mov_b64 exec, -1
    s_branch NEXT
AGAIN3:
    s_add_u32 s76, s76, 1
    s_cmp_lt_u32 s76, 32768
    s_cbranch_scc1 POLL3
    s_branch POLLX3
BR4:
    s_cmp_ge_u32 s76, 32768
    s_cbranch_scc1 BX4
    s_mov_b64 exec, vcc
    buffer_load_dwordx4 v[80:83], v8, s[16:19], 0 offen sc1
    s_add_u32 s76, s76, 1
    s_waitcnt vmcnt(0)
    s_branch BW4
AGAIN6:
    s_add_u32 s76, s76, 1
    s_cmp_lt_u32 s76, 32768
    s_cbranch_scc1 POLL6
    s_branch POLLX6
OML:
    v_mul_f32 v35, v32, v33
    s_nop 1
    v_add_f32_dpp v35, v35, v35 quad_perm:[1,0,3,2] row_mask:0xf bank_mask:0xf
    s_nop 1
    v_add_f32_dpp v35, v35, v35 quad_perm:[2,3,0,1] row_mask:0xf bank_mask:0xf
    s_mov_b64 exec, 1
    buffer_store_dwordx2 v[34:35], v1, s[8:11], s78 offen
    s_cmp_eq_u32 s10, 0
    s_cbranch_scc1 SLOW13
BACK13:
    s_mov_b64 exec, -1
    s_waitcnt lgkmcnt(0)
    s_branch ODONE
WLATE:
    v_lshrrev_b32 v38, 2, v0
    v_mul_u32_u24 v38, 1280, v38
    v_and_b32 v39, 3, v0
    v_lshl_add_u32 v39, v39, 4, v38
    s_mov_b32 m0, s67
    s_add_u32 s67, s67, 1024
    buffer_load_dwordx4 v39, s[24:27], s66 offen  lds
    s_add_u32 s66, s66, 20480
    s_mov_b32 m0, s67
    s_add_u32 s67, s67, 1024
    buffer_load_dwordx4 v39, s[24:27], s66 offen  lds
    s_add_u32 s66, s66, 20480
    s_mov_b32 m0, s67
    s_add_u32 s67, s67, 1024
    buffer_load_dwordx4 v39, s[24:27], s66 offen  lds
    s_add_u32 s66, s66, 20480
    s_mov_b32 m0, s67
    s_add_u32 s67, s67, 1024
    buffer_load_dwordx4 v39, s[24:27], s66 offen  lds
    s_add_u32 s66, s66, 20480
    s_mov_b32 m0, s67
    s_add_u32 s67, s67, 1024
    buffer_load_dwordx4 v39, s[24:27], s66 offen  lds
    s_add_u32 s66, s66, 20480
    s_mov_b32 m0, s67
    s_add_u32 s67, s67, 1024
    buffer_load_dwordx4 v39, s[24:27], s66 offen  lds
    s_add_u32 s66, s66, 20480
    v_accvgpr_read_b32 v2, a246
    v_accvgpr_read_b32 v3, a247
    v_accvgpr_read_b32 v4, a248
    buffer_load_dwordx2 v[24:25], v4, s[16:19], s3 offen sc1
    buffer_load_dwordx4 v[88:91], v3, s[16:19], s3 offen offset:0 sc1
    buffer_load_dwordx4 v[92:95], v3, s[16:19], s3 offen offset:1024 sc1
    buffer_load_dwordx4 v[96:99], v3, s[16:19], s3 offen offset:2048 sc1
    s_add_u32 s77, s3, 1638400
    buffer_store_dword v7, v10, s[8:11], s77 offen
    s_cmp_eq_u32 s10, 0
    s_cbranch_scc1 SLOW14
BACK14:
    v_accvgpr_read_b32 v5, a249
    v_and_b32 v18, 3, v0
    v_lshrrev_b32 v6, 5, v0
    v_lshl_add_u32 v18, v6, 2, v18
    v_mul_u32_u24 v18, 10240, v18
    v_bfe_u32 v6, v0, 3, 2
    v_lshl_add_u32 v18, v6, 4, v18
    v_and_b32 v6, 0xffffff7f, v5
    v_bfe_u32 v26, v0, 3, 1
    v_mul_u32_u24 v26, 0xaaaa, v26
    v_add_u32 v26, 0x4444, v26
    v_mov_b32 v28, 0
    v_mov_b32 v29, 0
    v_mov_b32 v30, 0
    v_mov_b32 v31, 0
    v_mov_b32 v32, 0
    v_mov_b32 v33, 0
    v_mov_b32 v34, 0
    v_mov_b32 v35, 0
    s_waitcnt vmcnt(11)
    ds_read_b64_tr_b16 v[40:41], v2 offset:0
    ds_read_b64_tr_b16 v[42:43], v2 offset:256
    ds_read_b64_tr_b16 v[64:65], v2 offset:32
    ds_read_b64_tr_b16 v[66:67], v2 offset:288
    ds_read_b64_tr_b16 v[44:45], v2 offset:2048
    ds_read_b64_tr_b16 v[46:47], v2 offset:2304
    ds_read_b64_tr_b16 v[68:69], v2 offset:2080
    ds_read_b64_tr_b16 v[70:71], v2 offset:2336
    ds_read_b64_tr_b16 v[48:49], v2 offset:4096
    ds_read_b64_tr_b16 v[50:51], v2 offset:4352
    ds_read_b64_tr_b16 v[72:73], v2 offset:4128
    ds_read_b64_tr_b16 v[74:75], v2 offset:4384
    s_waitcnt vmcnt(5)
    ds_read_b64_tr_b16 v[52:53], v2 offset:6144
    ds_read_b64_tr_b16 v[54:55], v2 offset:6400
    ds_read_b64_tr_b16 v[76:77], v2 offset:6176
    ds_read_b64_tr_b16 v[78:79], v2 offset:6432
    ds_read_b64_tr_b16 v[56:57], v2 offset:8192
    ds_read_b64_tr_b16 v[58:59], v2 offset:8448
    ds_read_b64_tr_b16 v[80:81], v2 offset:8224
    ds_read_b64_tr_b16 v[82:83], v2 offset:8480
    ds_read_b64_tr_b16 v[60:61], v2 offset:10240
    ds_read_b64_tr_b16 v[62:63], v2 offset:10496
    ds_read_b64_tr_b16 v[84:85], v2 offset:10272
    ds_read_b64_tr_b16 v[86:87], v2 offset:10528
    s_branch WCHK
AGAIN10:
    s_mov_b64 s[94:95], exec
    s_mov_b32 s76, 1
AG210:
    s_mov_b64 exec, vcc
    buffer_load_dwordx2 v[24:25], v4, s[16:19], s3 offen sc1
    buffer_load_dwordx4 v[88:91], v3, s[16:19], s3 offen offset:0 sc1
    buffer_load_dwordx4 v[92:95], v3, s[16:19], s3 offen offset:1024 sc1
    buffer_load_dwordx4 v[96:99], v3, s[16:19], s3 offen offset:2048 sc1
AG310_0:
    s_mov_b64 exec, s[94:95]
    s_add_u32 s76, s76, 1
    s_cmp_ge_u32 s76, 32768
    s_waitcnt vmcnt(0)
    v_max3_u32 v38, v88, v92, v96
    v_max_u32 v38, v38, v25
    v_cmp_eq_u32 vcc, -1, v38
    s_cbranch_vccz POLLX10
    s_cbranch_scc0 AG210
    s_branch POLLX10
GA1:
    s_add_u32 s76, s76, 1
    s_cmp_lt_u32 s76, 32768
    s_cbranch_scc1 GP1
    s_branch GPX
GPF:
    s_cmp_lg_u32 s72, 0
    s_cbranch_scc1 GP0
    buffer_load_dwordx4 v[32:35], v108, s[16:19], s79 offen sc1
    buffer_load_dwordx4 v[36:39], v108, s[16:19], s79 offen offset:3072 sc1
    s_waitcnt vmcnt(2)
    ds_read_b64_tr_b16 v[40:41], v111 offset:0
    ds_read_b64_tr_b16 v[42:43], v111 offset:256
    ds_read_b64_tr_b16 v[64:65], v111 offset:32
    ds_read_b64_tr_b16 v[66:67], v111 offset:288
    ds_read_b64_tr_b16 v[44:45], v111 offset:2048
    ds_read_b64_tr_b16 v[46:47], v111 offset:2304
    ds_read_b64_tr_b16 v[68:69], v111 offset:2080
    ds_read_b64_tr_b16 v[70:71], v111 offset:2336
    ds_read_b64_tr_b16 v[48:49], v111 offset:4096
    ds_read_b64_tr_b16 v[50:51], v111 offset:4352
    ds_read_b64_tr_b16 v[72:73], v111 offset:4128
    ds_read_b64_tr_b16 v[74:75], v111 offset:4384
    ds_read_b64_tr_b16 v[52:53], v111 offset:6144
    ds_read_b64_tr_b16 v[54:55], v111 offset:6400
    ds_read_b64_tr_b16 v[76:77], v111 offset:6176
    ds_read_b64_tr_b16 v[78:79], v111 offset:6432
    ds_read_b64_tr_b16 v[56:57], v111 offset:8192
    ds_read_b64_tr_b16 v[58:59], v111 offset:8448
    ds_read_b64_tr_b16 v[80:81], v111 offset:8224
    ds_read_b64_tr_b16 v[82:83], v111 offset:8480
    ds_read_b64_tr_b16 v[60:61], v111 offset:10240
    ds_read_b64_tr_b16 v[62:63], v111 offset:10496
    ds_read_b64_tr_b16 v[84:85], v111 offset:10272
    ds_read_b64_tr_b16 v[86:87], v111 offset:10528
    s_branch GPW
GP0:
    buffer_load_dwordx4 v[32:35], v108, s[16:19], s79 offen sc1
    buffer_load_dwordx4 v[36:39], v108, s[16:19], s79 offen offset:3072 sc1
GPW:
    s_add_u32 s76, s76, 1
    s_cmp_ge_u32 s76, 32768
    s_waitcnt vmcnt(0)
    v_add_f32 v2, v32, v33
    v_add_f32 v3, v36, v37
    v_add_f32 v34, v34, v35
    v_add_f32 v38, v38, v39
    v_add_f32 v2, v2, v34
    v_add_f32 v3, v3, v38
    v_cmp_u_f32 vcc, v2, v3
    s_cbranch_scc1 GPO
    s_cbranch_vccnz GP0
    s_branch GPO
OWL:
    buffer_load_dword v34, v100, s[16:19], 0 offen sc1
    buffer_load_dword v35, v101, s[16:19], 0 offen sc1
    s_branch OWB
WNOT0:
    s_cmp_lg_u32 s74, 0
    s_cbranch_scc1 STB
    s_cmp_eq_u32 s72, 1
    s_cbranch_scc1 WPREP
    s_cmp_eq_u32 s72, 3
    s_cbranch_scc1 WLC
    v_mov_b32 v52, -1
    v_mov_b32 v53, -1
    v_mov_b32 v54, -1
    v_mov_b32 v55, -1
    s_add_u32 s77, s80, 819200
    s_add_u32 s7, s77, 81920
    s_sleep 8
    s_mov_b64 exec, s[44:45]
    buffer_store_dwordx4 v[52:55], v18, s[16:19], s77 offen sc1
    s_mov_b64 exec, s[92:93]
    buffer_store_dwordx4 v[52:55], v18, s[16:19], s7 offen sc1
    s_mov_b64 exec, -1
    s_branch WPREP
WLC:
    s_mul_i32 s77, s69, 1248
    s_add_u32 s78, s3, 851968
    v_add_u32 v100, s77, v1
    v_min_u32 v100, 24816, v100
    s_add_u32 s77, s77, 1024
    v_add_u32 v101, s77, v1
    v_min_u32 v101, 24816, v101
    s_add_u32 s77, s77, 1024
    v_mov_b32 v104, -1
    v_mov_b32 v105, -1
    v_mov_b32 v106, -1
    v_mov_b32 v107, -1
    ds_read_b64_tr_b16 v[40:41], v16 offset:0
    ds_read_b64_tr_b16 v[42:43], v16 offset:1536
    ds_read_b64_tr_b16 v[44:45], v16 offset:12288
    ds_read_b64_tr_b16 v[46:47], v16 offset:13824
    ds_read_b64_tr_b16 v[48:49], v17 offset:24576
    ds_read_b64_tr_b16 v[50:51], v16 offset:32
    ds_read_b64_tr_b16 v[52:53], v16 offset:1568
    ds_read_b64_tr_b16 v[54:55], v16 offset:12320
    ds_read_b64_tr_b16 v[56:57], v16 offset:13856
    ds_read_b64_tr_b16 v[58:59], v17 offset:24608
    ds_read_b64_tr_b16 v[60:61], v16 offset:64
    ds_read_b64_tr_b16 v[62:63], v16 offset:1600
    ds_read_b64_tr_b16 v[64:65], v16 offset:12352
    ds_read_b64_tr_b16 v[66:67], v16 offset:13888
    ds_read_b64_tr_b16 v[68:69], v17 offset:24640
    v_and_b32 v25, 15, v0
    v_cmp_eq_u32 vcc, 12, v25
    v_mov_b32 v36, 0x3f803f80
    s_nop 0
    v_cndmask_b32 v70, 0, v36, vcc
    v_mov_b32 v71, v70
    v_mov_b32 v72, v70
    v_mov_b32 v73, v70
    v_mov_b32 v74, v70
    v_mov_b32 v75, v70
    v_mov_b32 v76, v70
    v_mov_b32 v77, v70
    v_mov_b32 v78, v70
    v_mov_b32 v79, v70
    s_mov_b32 s77, 4096
    v_mul_u32_u24 v96, 103, v0
    v_lshrrev_b32 v96, 10, v96
    v_lshl_add_u32 v96, v96, 4, v1
    v_add_u32 v96, s77, v96
    v_mul_u32_u24 v97, 176, v25
    v_add_u32 v97, s77, v97
    v_lshrrev_b32 v28, 4, v0
    v_lshl_add_u32 v98, v28, 3, v97
    v_lshl_add_u32 v97, v28, 4, v97
    buffer_store_dwordx4 v[104:107], v100, s[8:11], s78 offen
    s_cmp_eq_u32 s10, 0
    s_cbranch_scc1 SLOW15
BACK15:
    buffer_store_dwordx4 v[104:107], v101, s[8:11], s78 offen
    s_cmp_eq_u32 s10, 0
    s_cbranch_scc1 SLOW16
BACK16:
    s_branch STB
WPREP:
    s_nop 1
    ds_read_b64_tr_b16 v[40:41], v16 offset:0
    ds_read_b64_tr_b16 v[42:43], v16 offset:1536
    ds_read_b64_tr_b16 v[44:45], v16 offset:12288
    ds_read_b64_tr_b16 v[46:47], v16 offset:13824
    ds_read_b64_tr_b16 v[48:49], v17 offset:24576
    ds_read_b64_tr_b16 v[50:51], v16 offset:32
    ds_read_b64_tr_b16 v[52:53], v16 offset:1568
    ds_read_b64_tr_b16 v[54:55], v16 offset:12320
    ds_read_b64_tr_b16 v[56:57], v16 offset:13856
    ds_read_b64_tr_b16 v[58:59], v17 offset:24608
    ds_read_b64_tr_b16 v[60:61], v16 offset:64
    ds_read_b64_tr_b16 v[62:63], v16 offset:1600
    ds_read_b64_tr_b16 v[64:65], v16 offset:12352
    ds_read_b64_tr_b16 v[66:67], v16 offset:13888
    ds_read_b64_tr_b16 v[68:69], v17 offset:24640
    v_and_b32 v25, 15, v0
    v_cmp_eq_u32 vcc, 12, v25
    v_mov_b32 v36, 0x3f803f80
    s_nop 0
    v_cndmask_b32 v70, 0, v36, vcc
    v_mov_b32 v71, v70
    v_mov_b32 v72, v70
    v_mov_b32 v73, v70
    v_mov_b32 v74, v70
    v_mov_b32 v75, v70
    v_mov_b32 v76, v70
    v_mov_b32 v77, v70
    v_mov_b32 v78, v70
    v_mov_b32 v79, v70
    s_mov_b32 s77, 4096
    v_mul_u32_u24 v96, 103, v0
    v_lshrrev_b32 v96, 10, v96
    v_lshl_add_u32 v96, v96, 4, v1
    v_add_u32 v96, s77, v96
    v_mul_u32_u24 v97, 176, v25
    v_add_u32 v97, s77, v97
    v_lshrrev_b32 v28, 4, v0
    v_lshl_add_u32 v98, v28, 3, v97
    v_lshl_add_u32 v97, v28, 4, v97
    s_branch STB
WOWN:
    v_and_b32 v25, 15, v0
    v_lshrrev_b32 v26, 4, v0
    s_mul_i32 s7, s68, 10240
    s_cmp_eq_u32 s74, 0
    s_cselect_b32 s7, 0, s7
    s_add_u32 s7, s7, 655360
    v_mul_u32_u24 v37, 1280, v26
    v_add_u32 v37, s7, v37
    s_mul_i32 s7, s68, 81920
    s_add_u32 s7, s7, 45312
    v_mov_b32 v38, s7
    v_cmp_eq_u32 vcc, s68, v26
    s_nop 1
    v_cndmask_b32 v37, v37, v38, vcc
    v_add_u32 v39, 4, v26
    s_mul_i32 s7, s68, 10240
    s_cmp_eq_u32 s74, 0
    s_cselect_b32 s7, 0, s7
    s_add_u32 s7, s7, 655360
    v_mul_u32_u24 v38, 1280, v39
    v_add_u32 v38, s7, v38
    s_mul_i32 s7, s68, 81920
    s_add_u32 s7, s7, 45312
    v_mov_b32 v28, s7
    v_cmp_eq_u32 vcc, s68, v39
    s_nop 1
    v_cndmask_b32 v38, v38, v28, vcc
    s_lshl_b32 s77, s69, 6
    s_add_u32 s77, s77, s74
    v_lshl_add_u32 v25, v25, 2, s77
    v_add_u32 v100, v25, v37
    v_add_u32 v101, v25, v38
    s_cmp_eq_u32 s74, 0
    s_cbranch_scc1 GP1
    s_sleep 9
    s_mov_b32 s76, 1
POLL17:
    buffer_load_dword v28, v100, s[16:19], 0 offen sc1
    buffer_load_dword v29, v101, s[16:19], 0 offen sc1
POLLW17:
    s_waitcnt vmcnt(0)
    v_max_u32 v30, v28, v29
    v_cmp_eq_u32 vcc, -1, v30
    s_cbranch_vccnz AGAIN17
POLLX17:
    v_lshlrev_b32 v30, 16, v28
    v_and_b32 v28, 0xffff0000, v28
    v_lshlrev_b32 v31, 16, v29
    v_and_b32 v29, 0xffff0000, v29
    v_add_f32 v30, v30, v31
    v_add_f32 v28, v28, v29
    v_mov_b32 v31, v30
    v_mov_b32 v29, v28
    s_nop 0
    v_permlane32_swap_b32 v30, v31
    v_permlane32_swap_b32 v28, v29
    v_add_f32 v30, v30, v31
    v_add_f32 v28, v28, v29
    v_mov_b32 v31, v30
    v_mov_b32 v29, v28
    s_nop 0
    v_permlane16_swap_b32 v30, v31
    v_permlane16_swap_b32 v28, v29
    v_add_f32 v30, v30, v31
    v_add_f32 v28, v28, v29
    v_add_f32 v22, v22, v30
    v_add_f32 v23, v23, v28
    v_cvt_pk_bf16_f32 v28, v22, v23
    s_branch GP1
STBX:
    s_cmp_lg_u32 s72, 1
    s_cbranch_scc1 NEXT
    s_cmp_lg_u32 s74, 0
    s_cbranch_scc1 FINAL
    s_waitcnt vmcnt(0)
    v_mov_b32 v28, v34
    v_mov_b32 v29, v35
    v_max_u32 v30, v28, v29
    v_cmp_eq_u32 vcc, -1, v30
    s_cbranch_vccnz RETRY18
OK18:
    v_lshlrev_b32 v30, 16, v28
    v_and_b32 v28, 0xffff0000, v28
    v_lshlrev_b32 v31, 16, v29
    v_and_b32 v29, 0xffff0000, v29
    v_add_f32 v30, v30, v31
    v_add_f32 v28, v28, v29
    v_mov_b32 v31, v30
    v_mov_b32 v29, v28
    s_nop 0
    v_permlane32_swap_b32 v30, v31
    v_permlane32_swap_b32 v28, v29
    v_add_f32 v30, v30, v31
    v_add_f32 v28, v28, v29
    v_mov_b32 v31, v30
    v_mov_b32 v29, v28
    s_nop 0
    v_permlane16_swap_b32 v30, v31
    v_permlane16_swap_b32 v28, v29
    v_add_f32 v30, v30, v31
    v_add_f32 v28, v28, v29
    v_add_f32 v22, v22, v30
    v_add_f32 v23, v23, v28
    v_cvt_pk_bf16_f32 v28, v22, v23
    s_lshl_b32 s77, s69, 6
    s_add_u32 s77, s77, s3
    s_add_u32 s77, s77, 49152
    v_lshlrev_b32 v32, 2, v0
    v_mov_b32_dpp v29, v28 quad_perm:[1,1,1,1] row_mask:0xf bank_mask:0xf
    v_mov_b32_dpp v30, v28 quad_perm:[2,2,2,2] row_mask:0xf bank_mask:0xf
    v_mov_b32_dpp v31, v28 quad_perm:[3,3,3,3] row_mask:0xf bank_mask:0xf
    s_mov_b32 exec_lo, 0x1111
    s_mov_b32 exec_hi, 0x0
    buffer_store_dwordx4 v[28:31], v32, s[8:11], s77 offen
    s_cmp_eq_u32 s10, 0
    s_cbranch_scc1 SLOW19
BACK19:
    s_mov_b64 exec, -1
    s_branch NEXT
FINAL:
    s_cmp_lg_u32 s68, 0
    s_cbranch_scc1 DONE
    s_lshl_b32 s77, s69, 6
    v_lshlrev_b32 v37, 2, v0
    s_add_u32 s79, s77, s3
    s_add_u32 s79, s79, 46592
    s_mov_b64 exec, 15
    s_mov_b32 s76, 1
POLL20:
    buffer_load_dword v28, v1, s[16:19], s79 offen sc1
POLLW20:
    s_waitcnt vmcnt(0)
    v_cmp_eq_u32 vcc, -1, v28
    s_cbranch_vccnz AGAIN20
POLLX20:
    s_mov_b64 exec, -1
    s_mov_b32 s76, 1
POLL21:
    buffer_load_dword v28, v20, s[16:19], s74 offen sc1
    buffer_load_dword v29, v21, s[16:19], s74 offen sc1
POLLW21:
    s_waitcnt vmcnt(0)
    v_max_u32 v30, v28, v29
    v_cmp_eq_u32 vcc, -1, v30
    s_cbranch_vccnz AGAIN21
POLLX21:
    v_lshlrev_b32 v30, 16, v28
    v_and_b32 v28, 0xffff0000, v28
    v_lshlrev_b32 v31, 16, v29
    v_and_b32 v29, 0xffff0000, v29
    v_add_f32 v30, v30, v31
    v_add_f32 v28, v28, v29
    v_mov_b32 v31, v30
    v_mov_b32 v29, v28
    s_nop 0
    v_permlane32_swap_b32 v30, v31
    v_permlane32_swap_b32 v28, v29
    v_add_f32 v30, v30, v31
    v_add_f32 v28, v28, v29
    v_mov_b32 v31, v30
    v_mov_b32 v29, v28
    s_nop 0
    v_permlane16_swap_b32 v30, v31
    v_permlane16_swap_b32 v28, v29
    v_add_f32 v30, v30, v31
    v_add_f32 v28, v28, v29
    v_add_f32 v22, v22, v30
    v_add_f32 v23, v23, v28
    v_cvt_pk_bf16_f32 v28, v22, v23
    s_mov_b32 exec_lo, 0xffff
    s_mov_b32 exec_hi, 0x0
    buffer_store_dword v28, v37, s[40:43], s77 offen
    s_mov_b64 exec, -1
    s_endpgm
AGAIN17:
    s_sleep 2
    s_add_u32 s76, s76, 1
    s_cmp_lt_u32 s76, 32768
    s_cbranch_scc1 POLL17
    s_branch POLLX17
AGAIN20:
    s_add_u32 s76, s76, 1
    s_cmp_lt_u32 s76, 32768
    s_cbranch_scc1 POLL20
    s_branch POLLX20
AGAIN21:
    s_add_u32 s76, s76, 1
    s_cmp_lt_u32 s76, 32768
    s_cbranch_scc1 POLL21
    s_branch POLLX21
ROLEF:
    v_and_b32 v25, 15, v0
    v_lshrrev_b32 v26, 4, v0
    v_bfe_u32 v27, v0, 2, 2
    v_and_b32 v36, 3, v0
    s_cmp_lg_u32 s74, 0
    s_cbranch_scc1 FW
    s_sub_u32 s96, s69, 20
    s_lshl_b32 s96, s96, 2
    s_add_u32 s96, s96, s72
    s_mul_i32 s96, s96, 688
    v_add_u32 v21, s96, v1
    v_min_u32 v21, 32752, v21
    s_add_u32 s97, s3, 819200
    v_mov_b32 v28, -1
    v_mov_b32 v29, -1
    v_mov_b32 v30, -1
    v_mov_b32 v31, -1
    buffer_store_dwordx4 v[28:31], v21, s[8:11], s97 offen
    s_cmp_eq_u32 s10, 0
    s_cbranch_scc1 SLOW22
BACK22:
    s_add_u32 s77, s3, 1638400
    buffer_store_dword v7, v10, s[8:11], s77 offen
    s_cmp_eq_u32 s10, 0
    s_cbranch_scc1 SLOW23
BACK23:
    v_lshrrev_b32 v38, 3, v0
    v_mul_u32_u24 v38, 3072, v38
    v_and_b32 v39, 7, v0
    v_lshl_add_u32 v38, v39, 4, v38
    v_bfe_u32 v39, v0, 4, 1
    v_lshlrev_b32 v39, 5, v39
    v_xor_b32 v38, v38, v39
    v_xor_b32 v39, 64, v38
    s_mov_b32 m0, s67
    s_add_u32 s67, s67, 1024
    buffer_load_dwordx4 v38, s[36:39], s66 offen nt lds
    s_add_u32 s66, s66, 24576
    s_mov_b32 m0, s67
    s_add_u32 s67, s67, 1024
    buffer_load_dwordx4 v39, s[36:39], s66 offen nt lds
    s_add_u32 s66, s66, 24576
    s_mov_b32 m0, s67
    s_add_u32 s67, s67, 1024
    buffer_load_dwordx4 v38, s[36:39], s66 offen nt lds
    s_add_u32 s66, s66, 24576
    s_mov_b32 m0, s67
    s_add_u32 s67, s67, 1024
    buffer_load_dwordx4 v39, s[36:39], s66 offen nt lds
    s_add_u32 s66, s66, 24576
    s_mov_b32 m0, s67
    s_add_u32 s67, s67, 1024
    buffer_load_dwordx4 v38, s[36:39], s66 offen nt lds
    s_add_u32 s66, s66, 24576
    s_mov_b32 m0, s67
    s_add_u32 s67, s67, 1024
    buffer_load_dwordx4 v39, s[36:39], s66 offen nt lds
    s_add_u32 s66, s66, 24576
    s_mov_b32 m0, s67
    s_add_u32 s67, s67, 1024
    buffer_load_dwordx4 v38, s[36:39], s66 offen nt lds
    s_add_u32 s66, s66, 24576
    s_mov_b32 m0, s67
    s_add_u32 s67, s67, 1024
    buffer_load_dwordx4 v39, s[36:39], s66 offen nt lds
    s_add_u32 s66, s66, 24576
FW:
    s_lshl_b32 s77, s72, 5
    v_lshl_add_u32 v80, v36, 3, s77
    v_lshrrev_b32 v37, 1, v27
    v_and_b32 v38, 1, v26
    v_lshl_add_u32 v37, v38, 1, v37
    v_lshlrev_b32 v37, 5, v37
    v_xor_b32 v80, v80, v37
    v_lshl_add_u32 v37, v26, 3, v27
    v_lshl_add_u32 v80, v37, 7, v80
    v_add_u32 v80, 57344, v80
    s_sub_u32 s79, s69, 20
    s_and_b32 s7, s79, 12
    s_add_u32 s7, s7, s72
    s_lshl_b32 s78, s7, 8
    v_lshl_add_u32 v83, v25, 4, s78
    v_lshrrev_b32 v84, 1, v83
    v_mov_b32 v37, 1536
    v_cmp_le_u32 vcc, 2, v26
    s_nop 1
    v_cndmask_b32 v84, v84, v37, vcc
    v_and_b32 v37, 1, v26
    v_mul_u32_u24 v37, 4, v37
    v_add_u32 v84, v84, v37
    s_cmp_eq_u32 s7, 0
    s_mov_b32 s52, -1
    s_cselect_b32 s53, 0x10001, 0
    s_and_b32 s79, s79, 3
    s_mul_i32 s78, s79, 1788
    s_sub_u32 s78, 7168, s78
    v_add_u32 v83, s78, v83
    s_mul_i32 s78, s79, 1792
    s_add_u32 s78, s78, s3
    s_add_u32 s78, s78, 50432
    s_mul_i32 s79, s79, 320
    v_cmp_eq_u32 vcc, 12, v25
    v_mov_b32 v38, 0x3f803f80
    s_nop 0
    v_cndmask_b32 v88, 0, v38, vcc
    v_mov_b32 v89, v88
    v_mov_b32 v90, v88
    v_mov_b32 v91, v88
    v_mov_b32 v92, v88
    v_mov_b32 v93, v88
    v_mov_b32 v94, v88
    v_mov_b32 v95, v88
    v_mov_b32 v96, v88
    v_mov_b32 v97, v88
    v_mov_b32 v98, v88
    v_mov_b32 v99, v88
    v_mov_b32 v100, v88
    v_mov_b32 v101, v88
    v_mov_b32 v102, v88
    v_mov_b32 v103, v88
    v_mov_b32 v104, v88
    v_mov_b32 v105, v88
    v_mov_b32 v106, v88
    v_mov_b32 v107, v88
    v_mul_u32_u24 v6, 336, v25
    v_lshl_add_u32 v6, v26, 4, v6
    s_mul_i32 s77, s72, 45
    v_min_u32 v27, 44, v0
    v_add_u32 v27, s77, v27
    v_mul_u32_u24 v37, 205, v27
    v_lshrrev_b32 v37, 12, v37
    v_add_u32 v87, v37, v27
    v_lshlrev_b32 v87, 4, v87
    v_mul_u32_u24 v38, 20, v37
    v_sub_u32 v27, v27, v38
    v_lshlrev_b32 v27, 4, v27
    s_mul_i32 s7, s68, 10240
    s_cmp_eq_u32 s74, 0
    s_cselect_b32 s7, 0, s7
    s_add_u32 s7, s7, 655360
    v_mul_u32_u24 v86, 1280, v37
    v_add_u32 v86, s7, v86
    s_mul_i32 s7, s68, 81920
    s_add_u32 s7, s7, 45312
    v_mov_b32 v38, s7
    v_cmp_eq_u32 vcc, s68, v37
    s_nop 1
    v_cndmask_b32 v86, v86, v38, vcc
    v_add_u32 v38, 2560, v38
    v_cmp_le_u32 vcc, 8, v37
    s_nop 1
    v_cndmask_b32 v86, v86, v38, vcc
    v_add_u32 v86, v86, v27
    s_add_u32 s77, s79, s74
    s_add_u32 s79, s79, s3
    s_add_u32 s79, s79, 45312
    s_cmp_lg_u32 s74, 0
    s_cbranch_scc1 FW1
    s_waitcnt vmcnt(0)
    s_barrier
FW1:
    s_mov_b32 exec_lo, 0xfffff
    s_mov_b32 exec_hi, 0x0
    s_mov_b32 s76, 1
    buffer_load_dword v36, v1, s[16:19], s79 offen sc1
    s_mov_b64 exec, -1
    ds_read_b64_tr_b16 v[40:41], v80 offset:0
    ds_read_b64_tr_b16 v[42:43], v80 offset:512
    ds_read_b64_tr_b16 v[44:45], v80 offset:4096
    ds_read_b64_tr_b16 v[46:47], v80 offset:4608
    ds_read_b64_tr_b16 v[48:49], v80 offset:8192
    ds_read_b64_tr_b16 v[50:51], v80 offset:8704
    ds_read_b64_tr_b16 v[52:53], v80 offset:12288
    ds_read_b64_tr_b16 v[54:55], v80 offset:12800
    ds_read_b64_tr_b16 v[56:57], v80 offset:16384
    ds_read_b64_tr_b16 v[58:59], v80 offset:16896
    ds_read_b64_tr_b16 v[60:61], v80 offset:20480
    ds_read_b64_tr_b16 v[62:63], v80 offset:20992
    ds_read_b64_tr_b16 v[64:65], v80 offset:24576
    ds_read_b64_tr_b16 v[66:67], v80 offset:25088
    ds_read_b64_tr_b16 v[68:69], v80 offset:28672
    ds_read_b64_tr_b16 v[70:71], v80 offset:29184
    ds_read_b64_tr_b16 v[72:73], v80 offset:32768
    ds_read_b64_tr_b16 v[74:75], v80 offset:33280
    ds_read_b64_tr_b16 v[76:77], v80 offset:36864
    ds_read_b64_tr_b16 v[78:79], v80 offset:37376
    s_mov_b32 exec_lo, 0xfffff
    s_mov_b32 exec_hi, 0x0
    s_branch POLLW24
POLL24:
    buffer_load_dword v36, v1, s[16:19], s79 offen sc1
POLLW24:
    s_waitcnt vmcnt(0)
    v_cmp_eq_u32 vcc, -1, v36
    s_cbranch_vccnz AGAIN24
POLLX24:
    s_mov_b64 exec, s[86:87]
    buffer_load_dwordx4 v[24:27], v86, s[16:19], s77 offen sc1
    s_cmp_eq_u32 s74, 0
    s_cbranch_scc1 CSP
    s_waitcnt vmcnt(0)
CSB:
    s_waitcnt vmcnt(2)
BW25:
    ds_write_b128 v87, v[24:27]
    v_cmp_eq_u32 vcc, -1, v24
    s_cbranch_vccnz BR25
BX25:
    s_mov_b64 exec, s[84:85]
    s_waitcnt lgkmcnt(0)
    s_barrier
    ds_read_b128 v[88:91], v6 offset:0
    ds_read_b128 v[92:95], v6 offset:64
    ds_read_b128 v[96:99], v6 offset:128
    ds_read_b128 v[100:103], v6 offset:192
    ds_read_b128 v[104:107], v6 offset:256
    s_mov_b64 exec, -1
    s_waitcnt lgkmcnt(4)
    v_mfma_f32_16x16x32_bf16 v[32:35], v[88:91], v[88:91], 0
    s_waitcnt lgkmcnt(3)
    v_mfma_f32_16x16x32_bf16 v[32:35], v[92:95], v[92:95], v[32:35]
    s_waitcnt lgkmcnt(2)
    v_mfma_f32_16x16x32_bf16 v[32:35], v[96:99], v[96:99], v[32:35]
    s_waitcnt lgkmcnt(1)
    v_mfma_f32_16x16x32_bf16 v[32:35], v[100:103], v[100:103], v[32:35]
    s_waitcnt lgkmcnt(0)
    v_mfma_f32_16x16x32_bf16 v[32:35], v[104:107], v[104:107], v[32:35]
    v_mfma_f32_16x16x32_bf16 v[24:27], v[88:91], v[40:43], 0
    v_mov_b32 v36, 0
    v_mov_b32 v37, 0
    v_mfma_f32_16x16x32_bf16 v[24:27], v[92:95], v[44:47], v[24:27]
    v_mov_b32 v38, 0
    s_nop 0
    v_mfma_f32_16x16x32_bf16 v[24:27], v[96:99], v[48:51], v[24:27]
    v_mfma_f32_16x16x32_bf16 v[24:27], v[100:103], v[52:55], v[24:27]
    v_add_f32 v32, v32, v33
    v_add_f32 v34, v34, v35
    v_mfma_f32_16x16x32_bf16 v[24:27], v[104:107], v[56:59], v[24:27]
    v_mfma_f32_16x16x32_bf16 v[28:31], v[88:91], v[60:63], 0
    v_add_f32_dpp v36, v32, v34 quad_perm:[0,1,2,3] row_mask:0xf bank_mask:0x7
    v_mfma_f32_16x16x32_bf16 v[28:31], v[92:95], v[64:67], v[28:31]
    s_nop 0
    v_add_f32_dpp v36, v36, v36 row_ror:8 row_mask:0xf bank_mask:0xf
    v_mfma_f32_16x16x32_bf16 v[28:31], v[96:99], v[68:71], v[28:31]
    s_nop 0
    v_add_f32_dpp v36, v36, v36 row_ror:4 row_mask:0xf bank_mask:0xf
    v_mfma_f32_16x16x32_bf16 v[28:31], v[100:103], v[72:75], v[28:31]
    s_nop 0
    v_add_f32_dpp v36, v36, v36 row_ror:2 row_mask:0xf bank_mask:0xf
    v_mfma_f32_16x16x32_bf16 v[28:31], v[104:107], v[76:79], v[28:31]
    v_add_f32 v25, v24, v25
    v_add_f32_dpp v37, v36, v36 row_ror:1 row_mask:0x7 bank_mask:0xf
    v_add_f32_dpp v38, v36, v36 row_ror:1 row_mask:0x8 bank_mask:0xf
    v_add_f32 v26, v26, v27
    v_add_f32 v25, v25, v26
    s_nop 1
    v_permlane32_swap_b32 v25, v37
    v_add_f32 v29, v28, v29
    v_add_f32 v30, v30, v31
    v_add_f32 v29, v29, v30
    v_add_f32 v25, v25, v37
    s_nop 0
    v_permlane32_swap_b32 v29, v38
    v_add_f32 v29, v29, v38
    s_nop 1
    v_permlane16_swap_b32 v25, v29
    s_mov_b64 exec, s[52:53]
    v_add_f32 v25, v25, v29
    buffer_store_dword v25, v84, s[8:11], s78 offen
    s_cmp_eq_u32 s10, 0
    s_cbranch_scc1 SLOW26
BACK26:
    s_mov_b64 exec, -1
NEXT:
    s_cmp_lg_u32 s74, 0
    s_cbranch_scc1 DONE
    s_mov_b32 s74, 819200
    s_add_u32 s3, s3, 819200
    s_add_u32 s80, s80, 819200
    s_add_u32 s81, s81, 819200
    s_mov_b64 s[46:47], s[44:45]
    s_mov_b64 s[48:49], s[92:93]
    s_branch LOOP
AGAIN24:
    s_add_u32 s76, s76, 1
    s_cmp_lt_u32 s76, 32768
    s_cbranch_scc1 POLL24
    s_branch POLLX24
CSP:
    s_mov_b64 exec, -1
    s_waitcnt lgkmcnt(0)
    v_mfma_f32_16x16x32_bf16 v[108:111], v[88:91], v[40:43], 0
    v_mfma_f32_16x16x32_bf16 v[2:5], v[88:91], v[60:63], 0
    v_mfma_f32_16x16x32_bf16 v[108:111], v[92:95], v[44:47], v[108:111]
    v_mfma_f32_16x16x32_bf16 v[2:5], v[92:95], v[64:67], v[2:5]
    v_mfma_f32_16x16x32_bf16 v[108:111], v[96:99], v[48:51], v[108:111]
    v_mfma_f32_16x16x32_bf16 v[2:5], v[96:99], v[68:71], v[2:5]
    v_mfma_f32_16x16x32_bf16 v[108:111], v[100:103], v[52:55], v[108:111]
    v_mfma_f32_16x16x32_bf16 v[2:5], v[100:103], v[72:75], v[2:5]
    v_mfma_f32_16x16x32_bf16 v[108:111], v[104:107], v[56:59], v[108:111]
    v_mfma_f32_16x16x32_bf16 v[2:5], v[104:107], v[76:79], v[2:5]
    s_mov_b32 exec_lo, 0x0
    s_mov_b32 exec_hi, 0xffff0000
    s_nop 4
    buffer_store_dword v108, v83, s[8:11], s78 offen
    s_cmp_eq_u32 s10, 0
    s_cbranch_scc1 SLOW27
BACK27:
    buffer_store_dword v2, v83, s[8:11], s78 offen offset:3072
    s_cmp_eq_u32 s10, 0
    s_cbranch_scc1 SLOW28
BACK28:
    s_mov_b64 exec, s[86:87]
    s_branch CSB
BR25:
    s_cmp_ge_u32 s76, 32768
    s_cbranch_scc1 BX25
    s_mov_b64 exec, vcc
    buffer_load_dwordx4 v[24:27], v86, s[16:19], s77 offen sc1
    s_add_u32 s76, s76, 1
    s_waitcnt vmcnt(0)
    s_branch BW25
DONE:
    s_endpgm
TAGLOOP:
    s_mov_b32 s76, 0
TAGL2:
    s_sleep 8
    global_load_dword v98, v100, s[64:65] sc1
    s_waitcnt vmcnt(0)
    v_readfirstlane_b32 s96, v98
    s_nop 0
    s_cmp_lg_u32 s96, 0
    s_cbranch_scc1 TAGOK
    s_add_u32 s76, s76, 1
    s_cmp_lt_u32 s76, 32768
    s_cbranch_scc1 TAGL2
    s_branch TAGOK
DMAF:
    s_sub_u32 s78, s69, 20
    s_and_b32 s66, s78, 3
    s_lshl_b32 s66, s66, 1
    s_and_b32 s79, s72, 1
    s_add_u32 s66, s66, s79
    s_mul_i32 s66, s66, 245760
    s_lshr_b32 s78, s78, 2
    s_lshl_b32 s78, s78, 7
    s_add_u32 s66, s66, s78
    s_mul_i32 s78, s68, 384
    s_add_u32 s66, s66, s78
    s_mul_i32 s67, s72, 10240
    s_add_u32 s67, s67, 57344
    s_branch DMAX
RDYLOOP:
    s_mov_b32 s76, 0
RDYL2:
    s_sleep 8
    buffer_load_dwordx2 v[98:99], v100, s[16:19], 0 offen offset:384 sc1
    s_waitcnt vmcnt(0)
    v_cmp_ne_u32 vcc, s96, v98
    s_cbranch_vccz RDYOK
    s_add_u32 s76, s76, 1
    s_cmp_lt_u32 s76, 32768
    s_cbranch_scc1 RDYL2
    s_branch RDYOK
SLOW1:
    buffer_store_dwordx4 v[28:31], v27, s[16:19], s77 offen sc1
    s_branch BACK1
SLOW2:
    buffer_store_dwordx4 v[24:27], v106, s[16:19], 0 offen sc1
    s_branch BACK2
SLOW5:
    buffer_store_dword v24, v10, s[16:19], s3 offen sc1
    s_branch BACK5
SLOW7:
    buffer_store_dwordx4 v[28:31], v26, s[16:19], s77 offen sc1
    s_branch BACK7
RETRY8:
    s_mov_b32 s76, 1
POLL29:
    buffer_load_dword v28, v20, s[16:19], 0 offen sc1
    buffer_load_dword v29, v21, s[16:19], 0 offen sc1
POLLW29:
    s_waitcnt vmcnt(0)
    v_max_u32 v30, v28, v29
    v_cmp_eq_u32 vcc, -1, v30
    s_cbranch_vccnz AGAIN29
POLLX29:
    s_branch OK8
AGAIN29:
    s_add_u32 s76, s76, 1
    s_cmp_lt_u32 s76, 32768
    s_cbranch_scc1 POLL29
    s_branch POLLX29
SLOW9:
    buffer_store_dwordx4 v[28:31], v32, s[16:19], s77 offen sc1
    s_branch BACK9
SLOW11:
    buffer_store_dwordx4 v[28:31], v18, s[16:19], s81 offen sc1
    s_branch BACK11
SLOW12:
    buffer_store_dwordx4 v[28:31], v18, s[16:19], s97 offen sc1
    s_branch BACK12
SLOW13:
    buffer_store_dwordx2 v[34:35], v1, s[16:19], s78 offen sc1
    s_branch BACK13
SLOW14:
    buffer_store_dword v7, v10, s[16:19], s77 offen sc1
    s_branch BACK14
SLOW15:
    buffer_store_dwordx4 v[104:107], v100, s[16:19], s78 offen sc1
    s_branch BACK15
SLOW16:
    buffer_store_dwordx4 v[104:107], v101, s[16:19], s78 offen sc1
    s_branch BACK16
RETRY18:
    s_mov_b32 s76, 1
POLL30:
    buffer_load_dword v28, v100, s[16:19], 0 offen sc1
    buffer_load_dword v29, v101, s[16:19], 0 offen sc1
POLLW30:
    s_waitcnt vmcnt(0)
    v_max_u32 v30, v28, v29
    v_cmp_eq_u32 vcc, -1, v30
    s_cbranch_vccnz AGAIN30
POLLX30:
    s_branch OK18
AGAIN30:
    s_add_u32 s76, s76, 1
    s_cmp_lt_u32 s76, 32768
    s_cbranch_scc1 POLL30
    s_branch POLLX30
SLOW19:
    buffer_store_dwordx4 v[28:31], v32, s[16:19], s77 offen sc1
    s_branch BACK19
SLOW22:
    buffer_store_dwordx4 v[28:31], v21, s[16:19], s97 offen sc1
    s_branch BACK22
SLOW23:
    buffer_store_dword v7, v10, s[16:19], s77 offen sc1
    s_branch BACK23
SLOW26:
    buffer_store_dword v25, v84, s[16:19], s78 offen sc1
    s_branch BACK26
SLOW27:
    buffer_store_dword v108, v83, s[16:19], s78 offen sc1
    s_branch BACK27
SLOW28:
    buffer_store_dword v2, v83, s[16:19], s78 offen offset:3072 sc1
    s_branch BACK28
CODE_END:
    s_endpgm
.section .rodata,"a"
.p2align 6
.amdhsa_kernel interleave_layers__sliding_block_cached__glu_gated_swiglu__decode_kernel
  .amdhsa_next_free_vgpr 512
  .amdhsa_next_free_sgpr 102
  .amdhsa_accum_offset 256
  .amdhsa_group_segment_fixed_size 0
  .amdhsa_kernarg_size 96
  .amdhsa_user_sgpr_count 2
  .amdhsa_user_sgpr_kernarg_segment_ptr 1
  .amdhsa_system_sgpr_workgroup_id_x 1
.end_amdhsa_kernel
```

```asm
; @launch grid=(256,1,1) block=(256,1,1) lds=125568
.amdgcn_target "amdgcn-amd-amdhsa--gfx950"
.text
.globl interleave_layers__sliding_block_cached__glu_gated_swiglu__decode_kernel
.p2align 8
.type interleave_layers__sliding_block_cached__glu_gated_swiglu__decode_kernel,@function
interleave_layers__sliding_block_cached__glu_gated_swiglu__decode_kernel:
    s_load_dwordx16 s[44:59], s[0:1], 0
    s_load_dwordx8 s[60:67], s[0:1], 64
    s_cmp_ge_u32 s2, 256
    s_cbranch_scc1 CODE_END
    s_memrealtime s[96:97]
    v_lshrrev_b32 v2, 6, v0
    v_and_b32 v24, 63, v0
    v_readfirstlane_b32 s72, v2
    s_and_b32 s68, s2, 7
    s_lshr_b32 s69, s2, 3
    s_lshr_b32 s70, s69, 3
    s_and_b32 s71, s69, 7
    v_lshlrev_b32 v1, 4, v24
    s_lshl_b32 s77, s68, 2
    s_add_u32 s77, s77, s70
    s_mul_i32 s73, s77, 12582912
    s_lshl_b32 s78, s71, 2
    s_add_u32 s78, s78, s72
    s_mul_i32 s78, s78, 6144
    s_add_u32 s73, s73, s78
    s_add_u32 s73, s73, 11010048
    v_add_u32 v23, 4096, v1
    s_mov_b32 s10, 402653184
    s_mov_b32 s11, 0x20000
    s_getpc_b64 s[100:101]
PCREF:
    s_sub_u32 s100, s100, PCREF-interleave_layers__sliding_block_cached__glu_gated_swiglu__decode_kernel
    s_subb_u32 s101, s101, 0
    s_lshl_b32 s78, s71, 12
    v_lshl_add_u32 v25, v0, 4, s78
    v_cmp_gt_u32 vcc, CODE_END-interleave_layers__sliding_block_cached__glu_gated_swiglu__decode_kernel-16, v25
    s_nop 0
    s_and_saveexec_b64 s[98:99], vcc
    s_cbranch_execz NOCPF
    global_load_dwordx4 a[240:243], v25, s[100:101]
NOCPF:
    s_mov_b64 exec, -1
    s_mul_i32 s79, s77, 384
    s_mov_b32 s74, 0
    s_mul_i32 s3, s68, 81920
    s_getreg_b32 s75, hwreg(HW_REG_XCC_ID, 0, 4)
    s_mov_b32 s18, 1610612736
    s_mov_b32 s19, 0x20000
    s_waitcnt lgkmcnt(0)
    s_mov_b32 s8, s46
    s_and_b32 s9, s47, 0xffff
    s_mov_b32 s16, s66
    s_and_b32 s17, s67, 0xffff
    buffer_load_dwordx4 a[0:3], v1, s[8:11], s73 offen offset:0 nt
    buffer_load_dwordx4 a[4:7], v1, s[8:11], s73 offen offset:1024 nt
    s_or_b32 s77, s2, s72
    s_cbranch_scc1 NOTAG
    s_or_b32 s77, s96, 1
    v_mov_b32 v26, s77
    s_mov_b64 exec, 1
    global_store_dword v1, v26, s[64:65] sc1
    s_mov_b64 exec, -1
NOTAG:
    s_add_u32 s83, s73, 196608
    s_mov_b32 s12, s48
    s_and_b32 s13, s49, 0xffff
    s_mov_b32 s14, 402653184
    s_mov_b32 s15, 0x20000
    s_mov_b32 s20, s50
    s_and_b32 s21, s51, 0xffff
    s_mov_b32 s22, 7864320
    s_mov_b32 s23, 0x20000
    s_mov_b32 s36, s44
    s_and_b32 s37, s45, 0xffff
    s_mov_b32 s38, 1280
    s_mov_b32 s39, 0x20000
    s_mov_b32 s40, s62
    s_and_b32 s41, s63, 0xffff
    s_mov_b32 s42, 1280
    s_mov_b32 s43, 0x20000
    s_mov_b32 s28, s58
    s_and_b32 s29, s59, 0xffff
    s_mov_b32 s30, 1966080
    s_mov_b32 s31, 0x20000
    s_mov_b32 s32, s60
    s_and_b32 s33, s61, 0xffff
    s_mov_b32 s34, 1966080
    s_mov_b32 s35, 0x20000
    s_cmp_lt_u32 s69, 20
    s_cselect_b32 s24, s52, s56
    s_cselect_b32 s25, s53, s57
    s_cselect_b32 s26, s22, s30
    s_and_b32 s25, s25, 0xffff
    s_mov_b32 s27, 0x20000
    s_add_u32 s84, s83, 196608
    s_add_u32 s85, s84, 196608
    s_add_u32 s86, s85, 196608
    s_add_u32 s87, s86, 196608
    s_add_u32 s88, s87, 196608
    s_add_u32 s89, s88, 196608
    v_mov_b32 v109, v0
    v_mov_b32 v0, v24
    s_mul_i32 s77, s72, 6656
    v_add_u32 v25, 0, v0
    v_mul_u32_u24 v26, 171, v25
    v_lshrrev_b32 v26, 12, v26
    v_mul_u32_u24 v27, 24, v26
    v_sub_u32 v27, v25, v27
    v_lshlrev_b32 v27, 4, v27
    v_mul_u32_u24 v25, 416, v26
    v_add3_u32 v2, v25, v27, s77
    v_mul_u32_u24 v25, 12288, v26
    v_add_u32 v40, v25, v27
    v_add_u32 v25, 64, v0
    v_mul_u32_u24 v26, 171, v25
    v_lshrrev_b32 v26, 12, v26
    v_mul_u32_u24 v27, 24, v26
    v_sub_u32 v27, v25, v27
    v_lshlrev_b32 v27, 4, v27
    v_mul_u32_u24 v25, 416, v26
    v_add3_u32 v3, v25, v27, s77
    v_mul_u32_u24 v25, 12288, v26
    v_add_u32 v41, v25, v27
    v_add_u32 v25, 128, v0
    v_mul_u32_u24 v26, 171, v25
    v_lshrrev_b32 v26, 12, v26
    v_mul_u32_u24 v27, 24, v26
    v_sub_u32 v27, v25, v27
    v_lshlrev_b32 v27, 4, v27
    v_mul_u32_u24 v25, 416, v26
    v_add3_u32 v4, v25, v27, s77
    v_mul_u32_u24 v25, 12288, v26
    v_add_u32 v42, v25, v27
    v_and_b32 v25, 15, v0
    v_lshrrev_b32 v26, 4, v0
    v_bfe_u32 v27, v0, 2, 2
    v_and_b32 v28, 3, v0
    s_mul_i32 s78, s71, 160
    v_lshlrev_b32 v36, 4, v26
    v_lshlrev_b32 v37, 3, v26
    v_lshlrev_b32 v39, 2, v0
    buffer_load_dwordx4 v[70:73], v36, s[36:39], s78 offen
    buffer_load_dwordx4 v[74:77], v36, s[36:39], s78 offen offset:64
    buffer_load_dwordx2 v[78:79], v37, s[36:39], s78 offen offset:128
    buffer_load_dwordx4 v[80:83], v1, s[36:39], 0 offen
    buffer_load_dword v84, v39, s[36:39], 0 offen offset:1024
    s_lshl_b32 s7, s69, 6
    v_lshlrev_b32 v38, 2, v25
    buffer_load_dword v22, v38, s[36:39], s7 offen
    s_mul_i32 s78, s71, 983040
    s_add_u32 s79, s79, s78
    s_mul_i32 s78, s72, 98304
    s_add_u32 s79, s79, s78
    s_mul_i32 s78, s72, 3072
    s_add_u32 s78, s78, 26624
    s_add_u32 m0, s78, 0
    s_nop 0
    buffer_load_dwordx4 v40, s[20:23], s79 offen nt lds
    s_add_u32 m0, s78, 1024
    s_nop 0
    buffer_load_dwordx4 v41, s[20:23], s79 offen nt lds
    s_add_u32 m0, s78, 2048
    s_nop 0
    buffer_load_dwordx4 v42, s[20:23], s79 offen nt lds
    s_add_u32 s79, s79, 393216
    s_add_u32 m0, s78, 12288
    s_nop 0
    buffer_load_dwordx4 v40, s[20:23], s79 offen nt lds
    s_add_u32 m0, s78, 13312
    s_nop 0
    buffer_load_dwordx4 v41, s[20:23], s79 offen nt lds
    s_add_u32 m0, s78, 14336
    s_nop 0
    buffer_load_dwordx4 v42, s[20:23], s79 offen nt lds
    s_add_u32 s79, s79, 393216
    s_cmp_ge_u32 s72, 2
    s_cbranch_scc1 NOWQ3
    s_add_u32 m0, s78, 24576
    s_nop 0
    buffer_load_dwordx4 v40, s[20:23], s79 offen nt lds
    s_add_u32 m0, s78, 25600
    s_nop 0
    buffer_load_dwordx4 v41, s[20:23], s79 offen nt lds
    s_add_u32 m0, s78, 26624
    s_nop 0
    buffer_load_dwordx4 v42, s[20:23], s79 offen nt lds
NOWQ3:
    s_lshl_b32 s7, s69, 9
    s_add_u32 s7, s7, s3
    s_add_u32 s7, s7, 32768
    v_add_u32 v20, s7, v1
    s_lshl_b32 s7, s68, 2
    s_add_u32 s7, s7, s69
    s_mul_i32 s7, s7, 320
    s_add_u32 s7, s7, 654848
    s_add_u32 s4, s7, 1024
    v_add_u32 v29, s7, v1
    v_cmp_le_u32 vcc, 32, v109
    s_nop 1
    v_cndmask_b32 v21, v20, v29, vcc
    v_mov_b32 v29, 2147483632
    v_cndmask_b32 v20, v20, v29, vcc
    s_cmp_lt_u32 s69, 4
    s_cselect_b32 s7, 52, 32
    v_cmp_le_u32 vcc, s7, v109
    s_nop 1
    v_cndmask_b32 v21, v21, v29, vcc
    s_mul_i32 s78, s71, 160
    s_mov_b32 s20, s52
    s_and_b32 s21, s53, 0xffff
    s_mov_b32 s22, 7864320
    s_mov_b32 s23, 0x20000
    s_cmp_lt_u32 s72, 2
    s_cselect_b32 s36, s56, s58
    s_cselect_b32 s37, s57, s59
    s_and_b32 s37, s37, 0xffff
    s_mov_b32 s38, 1966080
    buffer_load_dwordx4 a[8:11], v1, s[8:11], s73 offen offset:2048 nt
    buffer_load_dwordx4 a[12:15], v1, s[8:11], s73 offen offset:3072 nt
    buffer_load_dwordx4 a[16:19], v23, s[8:11], s73 offen offset:0 nt
    v_mul_u32_u24 v29, 416, v25
    v_lshl_add_u32 v29, v26, 4, v29
    v_add_u32 v5, s77, v29
    v_lshrrev_b32 v29, 2, v0
    v_mul_u32_u24 v29, 416, v29
    v_lshl_add_u32 v29, v28, 3, v29
    v_add_u32 v6, s77, v29
    s_mul_i32 s79, s72, 96
    s_add_u32 s79, s79, 26624
    v_lshl_add_u32 v29, v26, 3, v27
    v_mul_u32_u24 v29, 384, v29
    v_lshl_add_u32 v29, v28, 3, v29
    v_add_u32 v16, s79, v29
    v_lshl_add_u32 v29, v26, 2, v27
    v_mul_u32_u24 v29, 384, v29
    v_lshl_add_u32 v29, v28, 3, v29
    v_add_u32 v17, s79, v29
    buffer_load_dwordx4 a[20:23], v23, s[8:11], s73 offen offset:1024 nt
    s_mul_i32 s79, s72, 23
    v_min_u32 v32, 22, v0
    v_add_u32 v32, s79, v32
    v_min_u32 v32, 89, v32
    v_mul_u32_u24 v31, 103, v32
    v_lshrrev_b32 v31, 10, v31
    v_mul_u32_u24 v30, 10, v31
    v_sub_u32 v30, v32, v30
    v_lshl_add_u32 v29, v30, 4, s78
    s_mul_i32 s7, s68, 10240
    s_add_u32 s7, s7, 737280
    v_mul_u32_u24 v8, 1280, v31
    v_add_u32 v8, s7, v8
    s_mul_i32 s7, s68, 81920
    s_add_u32 s7, s7, 46592
    v_mov_b32 v30, s7
    v_cmp_eq_u32 vcc, s68, v31
    s_nop 1
    v_cndmask_b32 v8, v8, v30, vcc
    v_add_u32 v30, 2560, v30
    v_cmp_le_u32 vcc, 8, v31
    s_nop 1
    v_cndmask_b32 v8, v8, v30, vcc
    v_add_u32 v8, v8, v29
    v_add_u32 v33, v31, v32
    v_lshlrev_b32 v33, 4, v33
    v_add_u32 v33, 4096, v33
    v_add_u32 v31, 6, v31
    s_mul_i32 s7, s68, 10240
    s_add_u32 s7, s7, 737280
    v_mul_u32_u24 v9, 1280, v31
    v_add_u32 v9, s7, v9
    s_mul_i32 s7, s68, 81920
    s_add_u32 s7, s7, 46592
    v_mov_b32 v30, s7
    v_cmp_eq_u32 vcc, s68, v31
    s_nop 1
    v_cndmask_b32 v9, v9, v30, vcc
    v_add_u32 v30, 2560, v30
    v_cmp_le_u32 vcc, 8, v31
    s_nop 1
    v_cndmask_b32 v9, v9, v30, vcc
    v_add_u32 v9, v9, v29
    v_mov_b32 v30, 2147483632
    v_cmp_le_u32 vcc, 30, v0
    s_nop 1
    v_cndmask_b32 v9, v9, v30, vcc
    v_mov_b32 v9, v33
    s_lshl_b32 s78, s69, 10
    s_lshl_b32 s79, s72, 8
    s_add_u32 s78, s78, s79
    v_lshl_add_u32 v10, v0, 2, s78
    s_lshl_b32 s78, s70, 13
    s_add_u32 s78, s78, s79
    v_lshlrev_b32 v29, 10, v26
    v_lshl_add_u32 v29, v25, 4, v29
    v_add_u32 v11, s78, v29
    buffer_load_dwordx4 a[24:27], v1, s[8:11], s83 offen offset:0 nt
    s_mul_i32 s78, s72, 96
    s_add_u32 s78, s78, 118784
    v_lshl_add_u32 v29, v27, 5, s78
    v_lshl_add_u32 v29, v28, 2, v29
    v_lshrrev_b32 v30, 1, v26
    v_lshl_add_u32 v29, v30, 4, v29
    v_and_b32 v30, 1, v26
    v_lshl_add_u32 v29, v30, 1, v29
    v_mov_b32 v30, 119168
    v_cmp_le_u32 vcc, 12, v25
    s_nop 1
    v_cndmask_b32 v12, v29, v30, vcc
    v_and_b32 v30, 1, v0
    v_lshlrev_b32 v29, 5, v26
    v_lshl_add_u32 v29, v30, 4, v29
    v_add_u32 v13, 118784, v29
    v_mul_u32_u24 v30, 0xaaaa, v30
    v_and_b32 v29, 1, v27
    v_mul_u32_u24 v29, 0xaaaa, v29
    v_lshl_or_b32 v29, v29, 16, v30
    v_add_u32 v14, 0x44444444, v29
    buffer_load_dwordx4 a[28:31], v1, s[8:11], s83 offen offset:1024 nt
    s_lshl_b32 s78, s72, 8
    s_add_u32 s78, s78, 124416
    v_lshrrev_b32 v29, 5, v0
    v_lshl_add_u32 v29, v29, 6, s78
    v_bfe_u32 v30, v0, 3, 1
    v_lshl_add_u32 v29, v30, 5, v29
    v_bfe_u32 v30, v0, 1, 1
    v_lshl_add_u32 v29, v30, 4, v29
    v_bfe_u32 v30, v0, 2, 1
    v_lshl_add_u32 v29, v30, 3, v29
    v_bfe_u32 v30, v0, 4, 1
    v_lshl_add_u32 v29, v30, 2, v29
    v_bfe_u32 v30, v0, 0, 1
    v_lshl_add_u32 v29, v30, 1, v29
    v_mov_b32 v19, v29
    v_bfe_u32 v29, v0, 4, 1
    v_bfe_u32 v30, v0, 2, 1
    v_lshl_add_u32 v29, v29, 5, s78
    v_lshl_add_u32 v29, v30, 4, v29
    v_accvgpr_write_b32 a252, v29
    s_mul_i32 s78, s72, 768
    s_add_u32 s78, s78, 119296
    v_lshl_add_u32 v29, v25, 2, s78
    v_bfe_u32 v30, v0, 4, 1
    v_lshl_add_u32 v29, v30, 7, v29
    v_lshrrev_b32 v30, 5, v0
    v_lshl_add_u32 v15, v30, 6, v29
    s_waitcnt vmcnt(12)
    v_lshlrev_b32 v88, 16, v80
    v_and_b32 v89, 0xffff0000, v80
    v_lshlrev_b32 v90, 16, v81
    v_and_b32 v91, 0xffff0000, v81
    v_lshlrev_b32 v92, 16, v82
    v_and_b32 v93, 0xffff0000, v82
    v_lshlrev_b32 v94, 16, v83
    v_and_b32 v95, 0xffff0000, v83
    v_lshlrev_b32 v96, 16, v84
    v_and_b32 v97, 0xffff0000, v84
    v_add_f32 v80, v88, v89
    v_add_f32 v80, v80, v90
    v_add_f32 v80, v80, v91
    v_add_f32 v80, v80, v92
    v_add_f32 v80, v80, v93
    v_add_f32 v80, v80, v94
    v_add_f32 v80, v80, v95
    v_add_f32 v80, v80, v96
    v_add_f32 v80, v80, v97
    s_nop 1
    v_add_f32_dpp v80, v80, v80 row_ror:8 row_mask:0xf bank_mask:0xf
    s_nop 1
    v_add_f32_dpp v80, v80, v80 row_ror:4 row_mask:0xf bank_mask:0xf
    s_nop 1
    v_add_f32_dpp v80, v80, v80 row_ror:2 row_mask:0xf bank_mask:0xf
    s_nop 1
    v_add_f32_dpp v80, v80, v80 row_ror:1 row_mask:0xf bank_mask:0xf
    v_mov_b32 v81, v80
    s_nop 1
    v_permlane32_swap_b32 v80, v81
    v_add_f32 v80, v80, v81
    v_mov_b32 v81, v80
    s_nop 1
    v_permlane16_swap_b32 v80, v81
    v_add_f32 v80, v80, v81
    v_mul_f32 v80, 0x3acccccd, v80
    v_sub_f32 v88, v88, v80
    v_sub_f32 v89, v89, v80
    v_sub_f32 v90, v90, v80
    v_sub_f32 v91, v91, v80
    v_sub_f32 v92, v92, v80
    v_sub_f32 v93, v93, v80
    v_sub_f32 v94, v94, v80
    v_sub_f32 v95, v95, v80
    v_sub_f32 v96, v96, v80
    v_sub_f32 v97, v97, v80
    v_mul_f32 v82, v88, v88
    v_fmac_f32 v82, v89, v89
    v_fmac_f32 v82, v90, v90
    v_fmac_f32 v82, v91, v91
    v_fmac_f32 v82, v92, v92
    v_fmac_f32 v82, v93, v93
    v_fmac_f32 v82, v94, v94
    v_fmac_f32 v82, v95, v95
    v_fmac_f32 v82, v96, v96
    v_fmac_f32 v82, v97, v97
    buffer_load_dwordx4 a[32:35], v1, s[8:11], s83 offen offset:2048 nt
    s_nop 0
    v_add_f32_dpp v82, v82, v82 row_ror:8 row_mask:0xf bank_mask:0xf
    s_nop 1
    v_add_f32_dpp v82, v82, v82 row_ror:4 row_mask:0xf bank_mask:0xf
    s_nop 1
    v_add_f32_dpp v82, v82, v82 row_ror:2 row_mask:0xf bank_mask:0xf
    s_nop 1
    v_add_f32_dpp v82, v82, v82 row_ror:1 row_mask:0xf bank_mask:0xf
    v_mov_b32 v81, v82
    s_nop 1
    v_permlane32_swap_b32 v82, v81
    v_add_f32 v82, v82, v81
    v_mov_b32 v81, v82
    s_nop 1
    v_permlane16_swap_b32 v82, v81
    v_add_f32 v82, v82, v81
    v_mul_f32 v82, 0x3acccccd, v82
    v_add_f32 v82, 0x3727c5ac, v82
    v_rsq_f32 v82, v82
    s_mov_b32 vcc_lo, 0xaaaaaaaa
    s_mov_b32 vcc_hi, 0xaaaaaaaa
    v_mov_b32 v85, 0x3f803f80
    v_lshlrev_b32 v83, 16, v70
    v_and_b32 v84, 0xffff0000, v70
    v_sub_f32 v83, v83, v80
    v_sub_f32 v84, v84, v80
    v_mul_f32 v83, v83, v82
    v_mul_f32 v84, v84, v82
    v_cvt_pk_bf16_f32 v83, v83, v84
    v_cndmask_b32 v70, v83, v85, vcc
    v_lshlrev_b32 v83, 16, v71
    v_and_b32 v84, 0xffff0000, v71
    v_sub_f32 v83, v83, v80
    v_sub_f32 v84, v84, v80
    v_mul_f32 v83, v83, v82
    v_mul_f32 v84, v84, v82
    v_cvt_pk_bf16_f32 v83, v83, v84
    v_cndmask_b32 v71, v83, v85, vcc
    v_lshlrev_b32 v83, 16, v72
    v_and_b32 v84, 0xffff0000, v72
    v_sub_f32 v83, v83, v80
    v_sub_f32 v84, v84, v80
    v_mul_f32 v83, v83, v82
    v_mul_f32 v84, v84, v82
    v_cvt_pk_bf16_f32 v83, v83, v84
    v_cndmask_b32 v72, v83, v85, vcc
    v_lshlrev_b32 v83, 16, v73
    v_and_b32 v84, 0xffff0000, v73
    v_sub_f32 v83, v83, v80
    v_sub_f32 v84, v84, v80
    v_mul_f32 v83, v83, v82
    v_mul_f32 v84, v84, v82
    v_cvt_pk_bf16_f32 v83, v83, v84
    v_cndmask_b32 v73, v83, v85, vcc
    v_lshlrev_b32 v83, 16, v74
    v_and_b32 v84, 0xffff0000, v74
    v_sub_f32 v83, v83, v80
    v_sub_f32 v84, v84, v80
    v_mul_f32 v83, v83, v82
    v_mul_f32 v84, v84, v82
    v_cvt_pk_bf16_f32 v83, v83, v84
    v_cndmask_b32 v74, v83, v85, vcc
    v_lshlrev_b32 v83, 16, v75
    v_and_b32 v84, 0xffff0000, v75
    v_sub_f32 v83, v83, v80
    v_sub_f32 v84, v84, v80
    v_mul_f32 v83, v83, v82
    v_mul_f32 v84, v84, v82
    v_cvt_pk_bf16_f32 v83, v83, v84
    v_cndmask_b32 v75, v83, v85, vcc
    buffer_load_dwordx4 a[36:39], v1, s[8:11], s83 offen offset:3072 nt
    v_lshlrev_b32 v83, 16, v76
    v_and_b32 v84, 0xffff0000, v76
    v_sub_f32 v83, v83, v80
    v_sub_f32 v84, v84, v80
    v_mul_f32 v83, v83, v82
    v_mul_f32 v84, v84, v82
    v_cvt_pk_bf16_f32 v83, v83, v84
    v_cndmask_b32 v76, v83, v85, vcc
    v_lshlrev_b32 v83, 16, v77
    v_and_b32 v84, 0xffff0000, v77
    v_sub_f32 v83, v83, v80
    v_sub_f32 v84, v84, v80
    v_mul_f32 v83, v83, v82
    v_mul_f32 v84, v84, v82
    v_cvt_pk_bf16_f32 v83, v83, v84
    v_cndmask_b32 v77, v83, v85, vcc
    v_lshlrev_b32 v83, 16, v78
    v_and_b32 v84, 0xffff0000, v78
    v_sub_f32 v83, v83, v80
    v_sub_f32 v84, v84, v80
    v_mul_f32 v83, v83, v82
    v_mul_f32 v84, v84, v82
    v_cvt_pk_bf16_f32 v83, v83, v84
    v_cndmask_b32 v78, v83, v85, vcc
    v_lshlrev_b32 v83, 16, v79
    v_and_b32 v84, 0xffff0000, v79
    v_sub_f32 v83, v83, v80
    v_sub_f32 v84, v84, v80
    v_mul_f32 v83, v83, v82
    v_mul_f32 v84, v84, v82
    v_cvt_pk_bf16_f32 v83, v83, v84
    v_cndmask_b32 v79, v83, v85, vcc
    s_waitcnt vmcnt(8)
    s_barrier
    ds_read_b64_tr_b16 v[40:41], v16 offset:0
    ds_read_b64_tr_b16 v[42:43], v16 offset:1536
    ds_read_b64_tr_b16 v[44:45], v16 offset:12288
    ds_read_b64_tr_b16 v[46:47], v16 offset:13824
    ds_read_b64_tr_b16 v[48:49], v17 offset:24576
    ds_read_b64_tr_b16 v[50:51], v16 offset:32
    ds_read_b64_tr_b16 v[52:53], v16 offset:1568
    ds_read_b64_tr_b16 v[54:55], v16 offset:12320
    ds_read_b64_tr_b16 v[56:57], v16 offset:13856
    ds_read_b64_tr_b16 v[58:59], v17 offset:24608
    ds_read_b64_tr_b16 v[60:61], v16 offset:64
    ds_read_b64_tr_b16 v[62:63], v16 offset:1600
    ds_read_b64_tr_b16 v[64:65], v16 offset:12352
    ds_read_b64_tr_b16 v[66:67], v16 offset:13888
    ds_read_b64_tr_b16 v[68:69], v17 offset:24640
    v_mov_b32 v100, 0
    s_cmp_lg_u32 s72, 0
    s_cbranch_scc1 NOTL
    s_mov_b64 exec, 1
    global_load_dword v98, v100, s[64:65] sc1
    s_mov_b64 exec, -1
NOTL:
    buffer_load_dwordx4 a[40:43], v23, s[8:11], s83 offen offset:0 nt
    buffer_load_dwordx4 a[44:47], v23, s[8:11], s83 offen offset:1024 nt
    s_mul_i32 s79, s72, 96
    s_add_u32 s79, s79, 119296
    v_min_u32 v36, 48, v0
    v_lshl_add_u32 v36, v36, 1, s79
    v_mov_b32 v37, 119808
    v_cmp_le_u32 vcc, 48, v0
    s_nop 1
    v_cndmask_b32 v36, v36, v37, vcc
    v_add_u32 v37, 119296, v1
    s_waitcnt lgkmcnt(0)
    v_mfma_f32_16x16x32_bf16 v[24:27], v[70:73], v[40:43], 0
    v_mfma_f32_16x16x32_bf16 v[28:31], v[70:73], v[50:53], 0
    v_mfma_f32_16x16x32_bf16 v[32:35], v[70:73], v[60:63], 0
    v_mfma_f32_16x16x32_bf16 v[24:27], v[74:77], v[44:47], v[24:27]
    v_mfma_f32_16x16x32_bf16 v[28:31], v[74:77], v[54:57], v[28:31]
    v_mfma_f32_16x16x32_bf16 v[32:35], v[74:77], v[64:67], v[32:35]
    v_mfma_f32_16x16x16_bf16 v[24:27], v[78:79], v[48:49], v[24:27]
    v_mfma_f32_16x16x16_bf16 v[28:31], v[78:79], v[58:59], v[28:31]
    v_mfma_f32_16x16x16_bf16 v[32:35], v[78:79], v[68:69], v[32:35]
    buffer_load_dwordx4 a[48:51], v1, s[8:11], s84 offen offset:0 nt
    s_nop 4
    v_mov_b32 v7, v25
    v_mov_b32_dpp v24, v28 quad_perm:[0,1,2,3] row_mask:0x2 bank_mask:0xf
    s_nop 0
    v_mov_b32_dpp v7, v29 quad_perm:[0,1,2,3] row_mask:0x2 bank_mask:0xf
    v_mov_b32_dpp v24, v32 quad_perm:[0,1,2,3] row_mask:0x4 bank_mask:0xf
    s_nop 0
    v_mov_b32_dpp v7, v33 quad_perm:[0,1,2,3] row_mask:0x4 bank_mask:0xf
    v_cvt_pk_bf16_f32 v24, v24, v24
    ds_write_b16 v36, v24
    buffer_load_dwordx4 a[52:55], v1, s[8:11], s84 offen offset:1024 nt
    buffer_load_dwordx4 a[56:59], v1, s[8:11], s84 offen offset:2048 nt
    s_waitcnt lgkmcnt(0)
    s_barrier
    ds_read_b128 v[28:31], v37
    s_lshl_b32 s79, s69, 9
    s_add_u32 s79, s79, s3
    s_cmp_eq_u32 s72, 0
    s_cselect_b32 exec_lo, 0xffffff, 1
    s_mov_b32 exec_hi, 0
    s_cselect_b32 s78, 0, 1879048176
    v_add_u32 v37, s78, v1
    s_waitcnt lgkmcnt(0)
    buffer_store_dwordx4 v[28:31], v37, s[16:19], s79 offen sc1
    s_mov_b64 exec, -1
    v_mov_b32 v32, -1
    v_mov_b32 v33, -1
    v_mov_b32 v34, -1
    v_mov_b32 v35, -1
    buffer_store_dwordx4 v[32:35], v21, s[16:19], 0 offen sc1
    buffer_load_dwordx4 a[60:63], v1, s[8:11], s84 offen offset:3072 nt
    s_waitcnt vmcnt(12)
    ds_write_b128 v2, a[0:3] offset:0
    ds_write_b128 v3, a[4:7] offset:0
    ds_write_b128 v4, a[8:11] offset:0
    ds_write_b128 v2, a[12:15] offset:3328
    ds_write_b128 v3, a[16:19] offset:3328
    ds_write_b128 v4, a[20:23] offset:3328
    ds_read_b128 a[0:3], v5 offset:0
    ds_read_b128 a[4:7], v5 offset:64
    ds_read_b128 a[8:11], v5 offset:128
    ds_read_b128 a[12:15], v5 offset:192
    ds_read_b128 a[16:19], v5 offset:256
    ds_read_b128 a[20:23], v5 offset:320
    buffer_load_dwordx4 a[64:67], v23, s[8:11], s84 offen offset:0 nt
    buffer_load_dwordx4 a[68:71], v23, s[8:11], s84 offen offset:1024 nt
    s_barrier
    buffer_load_dwordx4 a[72:75], v1, s[8:11], s85 offen offset:0 nt
    buffer_load_dwordx4 a[76:79], v1, s[8:11], s85 offen offset:1024 nt
    buffer_load_dwordx4 a[80:83], v1, s[8:11], s85 offen offset:2048 nt
    buffer_load_dwordx4 a[84:87], v1, s[8:11], s85 offen offset:3072 nt
    buffer_load_dwordx4 a[88:91], v23, s[8:11], s85 offen offset:0 nt
    buffer_load_dwordx4 a[92:95], v23, s[8:11], s85 offen offset:1024 nt
    s_barrier
    s_getreg_b32 s5, hwreg(HW_REG_XCC_ID, 0, 4)
    s_cmp_lg_u32 s72, 0
    s_cbranch_scc1 NOHDR
    s_waitcnt vmcnt(9)
    v_readfirstlane_b32 s96, v98
    s_nop 0
    s_cmp_eq_u32 s96, 0
    s_cbranch_scc1 TAGLOOP
TAGOK:
    v_mov_b32 v99, s5
    s_mov_b64 exec, 1
    buffer_store_dwordx2 v[98:99], v1, s[16:19], s79 offen offset:384 sc1
    s_mov_b64 exec, -1
NOHDR:
    s_waitcnt vmcnt(14)
    ds_write_b128 v2, a[24:27] offset:0
    ds_write_b128 v3, a[28:31] offset:0
    ds_write_b128 v4, a[32:35] offset:0
    ds_write_b128 v2, a[36:39] offset:3328
    ds_write_b128 v3, a[40:43] offset:3328
    ds_write_b128 v4, a[44:47] offset:3328
    ds_read_b128 a[24:27], v5 offset:0
    ds_read_b128 a[28:31], v5 offset:64
    ds_read_b128 a[32:35], v5 offset:128
    ds_read_b128 a[36:39], v5 offset:192
    ds_read_b128 a[40:43], v5 offset:256
    ds_read_b128 a[44:47], v5 offset:320
    buffer_load_dwordx4 a[96:99], v1, s[8:11], s86 offen offset:0 nt
    buffer_load_dwordx4 a[100:103], v1, s[8:11], s86 offen offset:1024 nt
    buffer_load_dwordx4 a[104:107], v1, s[8:11], s86 offen offset:2048 nt
    buffer_load_dwordx4 a[108:111], v1, s[8:11], s86 offen offset:3072 nt
    buffer_load_dwordx4 a[112:115], v23, s[8:11], s86 offen offset:0 nt
    buffer_load_dwordx4 a[116:119], v23, s[8:11], s86 offen offset:1024 nt
    s_barrier
    s_waitcnt vmcnt(12)
    ds_write_b128 v2, a[48:51] offset:0
    ds_write_b128 v3, a[52:55] offset:0
    ds_write_b128 v4, a[56:59] offset:0
    ds_write_b128 v2, a[60:63] offset:3328
    ds_write_b128 v3, a[64:67] offset:3328
    ds_write_b128 v4, a[68:71] offset:3328
    ds_read_b128 a[48:51], v5 offset:0
    ds_read_b128 a[52:55], v5 offset:64
    ds_read_b128 a[56:59], v5 offset:128
    ds_read_b128 a[60:63], v5 offset:192
    ds_read_b128 a[64:67], v5 offset:256
    ds_read_b128 a[68:71], v5 offset:320
    v_lshlrev_b32 v100, 9, v0
    v_add_u32 v100, s3, v100
    v_bfe_u32 v96, v0, 2, 3
    v_mul_u32_u24 v96, 81920, v96
    v_and_b32 v97, 3, v0
    v_lshl_add_u32 v96, v97, 9, v96
    v_cmp_le_u32 vcc, 32, v0
    s_nop 1
    v_cndmask_b32 v100, v100, v96, vcc
    s_cmp_eq_u32 s72, 0
    s_cselect_b32 s77, 0, 1879048176
    v_add_u32 v100, s77, v100
    buffer_load_dwordx4 a[120:123], v1, s[8:11], s87 offen offset:0 nt
    buffer_load_dwordx4 a[124:127], v1, s[8:11], s87 offen offset:1024 nt
    buffer_load_dwordx4 a[128:131], v1, s[8:11], s87 offen offset:2048 nt
    buffer_load_dwordx4 a[132:135], v1, s[8:11], s87 offen offset:3072 nt
    buffer_load_dwordx4 a[136:139], v23, s[8:11], s87 offen offset:0 nt
    buffer_load_dwordx4 a[140:143], v23, s[8:11], s87 offen offset:1024 nt
    s_barrier
    s_waitcnt vmcnt(12)
    ds_write_b128 v2, a[72:75] offset:0
    ds_write_b128 v3, a[76:79] offset:0
    ds_write_b128 v4, a[80:83] offset:0
    ds_write_b128 v2, a[84:87] offset:3328
    ds_write_b128 v3, a[88:91] offset:3328
    ds_write_b128 v4, a[92:95] offset:3328
    ds_read_b128 a[72:75], v5 offset:0
    ds_read_b128 a[76:79], v5 offset:64
    ds_read_b128 a[80:83], v5 offset:128
    ds_read_b128 a[84:87], v5 offset:192
    ds_read_b128 a[88:91], v5 offset:256
    ds_read_b128 a[92:95], v5 offset:320
    buffer_load_dwordx4 a[144:147], v1, s[8:11], s88 offen offset:0 nt
    buffer_load_dwordx4 a[148:151], v1, s[8:11], s88 offen offset:1024 nt
    buffer_load_dwordx4 a[152:155], v1, s[8:11], s88 offen offset:2048 nt
    buffer_load_dwordx4 a[156:159], v1, s[8:11], s88 offen offset:3072 nt
    buffer_load_dwordx4 a[160:163], v23, s[8:11], s88 offen offset:0 nt
    buffer_load_dwordx4 a[164:167], v23, s[8:11], s88 offen offset:1024 nt
    s_barrier
    s_waitcnt vmcnt(12)
    ds_write_b128 v2, a[96:99] offset:0
    ds_write_b128 v3, a[100:103] offset:0
    ds_write_b128 v4, a[104:107] offset:0
    ds_write_b128 v2, a[108:111] offset:3328
    ds_write_b128 v3, a[112:115] offset:3328
    ds_write_b128 v4, a[116:119] offset:3328
    ds_read_b128 a[96:99], v5 offset:0
    ds_read_b128 a[100:103], v5 offset:64
    ds_read_b128 a[104:107], v5 offset:128
    ds_read_b128 a[108:111], v5 offset:192
    ds_read_b128 a[112:115], v5 offset:256
    ds_read_b128 a[116:119], v5 offset:320
    buffer_load_dwordx4 a[168:171], v1, s[8:11], s89 offen offset:0 nt
    buffer_load_dwordx4 a[172:175], v1, s[8:11], s89 offen offset:1024 nt
    buffer_load_dwordx4 a[176:179], v1, s[8:11], s89 offen offset:2048 nt
    buffer_load_dwordx4 a[180:183], v1, s[8:11], s89 offen offset:3072 nt
    buffer_load_dwordx4 a[184:187], v23, s[8:11], s89 offen offset:0 nt
    buffer_load_dwordx4 a[188:191], v23, s[8:11], s89 offen offset:1024 nt
    s_barrier
    s_cmp_ge_u32 s69, 20
    s_cbranch_scc1 DMAF
    s_lshl_b32 s66, s68, 2
    s_add_u32 s66, s66, s72
    s_mul_i32 s66, s66, 245760
    s_lshl_b32 s78, s69, 6
    s_add_u32 s66, s66, s78
    s_mul_i32 s67, s72, 12288
    s_add_u32 s67, s67, 57344
DMAX:
    v_mov_b32 v109, v20
    v_and_b32 v25, 15, v0
    v_lshrrev_b32 v26, 4, v0
    v_add_u32 v27, 4, v26
    s_mul_i32 s7, s68, 10240
    s_add_u32 s7, s7, 737280
    v_mul_u32_u24 v20, 1280, v26
    v_add_u32 v20, s7, v20
    s_mul_i32 s7, s68, 81920
    s_add_u32 s7, s7, 46592
    v_mov_b32 v28, s7
    v_cmp_eq_u32 vcc, s68, v26
    s_nop 1
    v_cndmask_b32 v20, v20, v28, vcc
    s_mul_i32 s7, s68, 10240
    s_add_u32 s7, s7, 737280
    v_mul_u32_u24 v21, 1280, v27
    v_add_u32 v21, s7, v21
    s_mul_i32 s7, s68, 81920
    s_add_u32 s7, s7, 46592
    v_mov_b32 v28, s7
    v_cmp_eq_u32 vcc, s68, v27
    s_nop 1
    v_cndmask_b32 v21, v21, v28, vcc
    s_min_u32 s7, s69, 19
    s_lshl_b32 s7, s7, 6
    v_lshl_add_u32 v25, v25, 2, s7
    v_add_u32 v20, v20, v25
    v_add_u32 v21, v21, v25
    buffer_load_dwordx4 a[216:219], v1, s[12:15], s73 offen offset:0 nt
    v_and_b32 v25, 15, v0
    v_bfe_u32 v27, v0, 2, 2
    v_and_b32 v28, 3, v0
    s_mul_i32 s7, s72, 12288
    s_add_u32 s7, s7, 57344
    v_lshl_add_u32 v29, v26, 3, v27
    v_lshlrev_b32 v29, 6, v29
    v_lshl_add_u32 v29, v28, 3, v29
    v_add_u32 v29, s7, v29
    v_accvgpr_write_b32 a246, v29
    s_mul_i32 s7, s72, 3072
    s_add_u32 s7, s7, 32768
    v_add_u32 v29, s7, v1
    v_accvgpr_write_b32 a247, v29
    s_lshl_b32 s7, s72, 6
    s_add_u32 s7, s7, 45056
    v_xor_b32 v29, v26, v27
    v_and_b32 v29, 1, v29
    v_lshl_add_u32 v29, v29, 2, v28
    v_lshl_add_u32 v29, v29, 3, s7
    v_accvgpr_write_b32 a248, v29
    s_lshl_b32 s7, s72, 8
    s_add_u32 s7, s7, 122368
    v_lshl_add_u32 v29, v0, 2, s7
    v_accvgpr_write_b32 a249, v29
    s_lshl_b32 s81, s69, 6
    s_mul_i32 s80, s68, 1280
    s_add_u32 s80, s80, s81
    s_add_u32 s80, s80, 655360
    s_add_u32 s81, s81, s3
    s_add_u32 s81, s81, 45312
    s_waitcnt vmcnt(13)
    ds_write_b128 v2, a[120:123] offset:0
    ds_write_b128 v3, a[124:127] offset:0
    ds_write_b128 v4, a[128:131] offset:0
    ds_write_b128 v2, a[132:135] offset:3328
    ds_write_b128 v3, a[136:139] offset:3328
    ds_write_b128 v4, a[140:143] offset:3328
    ds_read_b128 a[120:123], v5 offset:0
    ds_read_b128 a[124:127], v5 offset:64
    ds_read_b128 a[128:131], v5 offset:128
    ds_read_b128 a[132:135], v5 offset:192
    ds_read_b128 a[136:139], v5 offset:256
    ds_read_b128 a[140:143], v5 offset:320
    buffer_load_dwordx4 a[220:223], v1, s[12:15], s73 offen offset:1024 nt
    buffer_load_dwordx4 a[224:227], v1, s[12:15], s73 offen offset:2048 nt
    buffer_load_dwordx4 a[228:231], v1, s[12:15], s73 offen offset:3072 nt
    buffer_load_dwordx4 a[232:235], v23, s[12:15], s73 offen offset:0 nt
    buffer_load_dwordx4 a[236:239], v23, s[12:15], s73 offen offset:1024 nt
    s_barrier
    s_waitcnt vmcnt(12)
    ds_write_b128 v2, a[144:147] offset:0
    ds_write_b128 v3, a[148:151] offset:0
    ds_write_b128 v4, a[152:155] offset:0
    ds_write_b128 v2, a[156:159] offset:3328
    ds_write_b128 v3, a[160:163] offset:3328
    ds_write_b128 v4, a[164:167] offset:3328
    ds_read_b128 a[144:147], v5 offset:0
    ds_read_b128 a[148:151], v5 offset:64
    ds_read_b128 a[152:155], v5 offset:128
    ds_read_b128 a[156:159], v5 offset:192
    ds_read_b128 a[160:163], v5 offset:256
    ds_read_b128 a[164:167], v5 offset:320
    buffer_load_dwordx4 v[112:115], v1, s[12:15], s83 offen offset:0 nt
    buffer_load_dwordx4 v[116:119], v1, s[12:15], s83 offen offset:1024 nt
    buffer_load_dwordx4 v[120:123], v1, s[12:15], s83 offen offset:2048 nt
    buffer_load_dwordx4 v[124:127], v1, s[12:15], s83 offen offset:3072 nt
    buffer_load_dwordx4 v[128:131], v23, s[12:15], s83 offen offset:0 nt
    buffer_load_dwordx4 v[132:135], v23, s[12:15], s83 offen offset:1024 nt
    s_barrier
    buffer_load_dwordx2 v[98:99], v100, s[16:19], 0 offen offset:384 sc1
    s_waitcnt vmcnt(13)
    ds_write_b128 v2, a[168:171] offset:0
    ds_write_b128 v3, a[172:175] offset:0
    ds_write_b128 v4, a[176:179] offset:0
    ds_write_b128 v2, a[180:183] offset:3328
    ds_write_b128 v3, a[184:187] offset:3328
    ds_write_b128 v4, a[188:191] offset:3328
    ds_read_b128 a[168:171], v5 offset:0
    ds_read_b128 a[172:175], v5 offset:64
    ds_read_b128 a[176:179], v5 offset:128
    ds_read_b128 a[180:183], v5 offset:192
    ds_read_b128 a[184:187], v5 offset:256
    ds_read_b128 a[188:191], v5 offset:320
    buffer_load_dwordx4 v[136:139], v1, s[12:15], s84 offen offset:0 nt
    buffer_load_dwordx4 v[140:143], v1, s[12:15], s84 offen offset:1024 nt
    buffer_load_dwordx4 v[144:147], v1, s[12:15], s84 offen offset:2048 nt
    buffer_load_dwordx4 v[148:151], v1, s[12:15], s84 offen offset:3072 nt
    buffer_load_dwordx4 v[152:155], v23, s[12:15], s84 offen offset:0 nt
    buffer_load_dwordx4 v[156:159], v23, s[12:15], s84 offen offset:1024 nt
    s_barrier
    s_waitcnt vmcnt(13)
    ds_write_b128 v2, a[216:219] offset:0
    ds_write_b128 v3, a[220:223] offset:0
    ds_write_b128 v4, a[224:227] offset:0
    ds_write_b128 v2, a[228:231] offset:3328
    ds_write_b128 v3, a[232:235] offset:3328
    ds_write_b128 v4, a[236:239] offset:3328
    ds_read_b64_tr_b16 a[192:193], v6 offset:0
    ds_read_b64_tr_b16 a[196:197], v6 offset:32
    ds_read_b64_tr_b16 a[200:201], v6 offset:64
    ds_read_b64_tr_b16 a[204:205], v6 offset:96
    ds_read_b64_tr_b16 a[208:209], v6 offset:128
    ds_read_b64_tr_b16 a[212:213], v6 offset:160
    ds_read_b64_tr_b16 a[216:217], v6 offset:192
    ds_read_b64_tr_b16 a[220:221], v6 offset:224
    ds_read_b64_tr_b16 a[224:225], v6 offset:256
    ds_read_b64_tr_b16 a[228:229], v6 offset:288
    ds_read_b64_tr_b16 a[232:233], v6 offset:320
    ds_read_b64_tr_b16 a[236:237], v6 offset:352
    buffer_load_dwordx4 v[160:163], v1, s[12:15], s85 offen offset:0 nt
    buffer_load_dwordx4 v[164:167], v1, s[12:15], s85 offen offset:1024 nt
    buffer_load_dwordx4 v[168:171], v1, s[12:15], s85 offen offset:2048 nt
    buffer_load_dwordx4 v[172:175], v1, s[12:15], s85 offen offset:3072 nt
    buffer_load_dwordx4 v[176:179], v23, s[12:15], s85 offen offset:0 nt
    buffer_load_dwordx4 v[180:183], v23, s[12:15], s85 offen offset:1024 nt
    s_barrier
    s_waitcnt vmcnt(12)
    s_mov_b32 s76, -1
    v_mov_b32 v97, 125504
    s_cmp_lg_u32 s72, 0
    s_cbranch_scc1 RDYX
    v_cmp_ne_u32 vcc, s96, v98
    s_cbranch_vccnz RDYLOOP
RDYOK:
    v_cmp_ne_u32 vcc, s5, v99
    s_nop 1
    v_mov_b32 v96, vcc_lo
    ds_write_b32 v97, v96
RDYX:
    buffer_load_dwordx4 v[184:187], v1, s[12:15], s86 offen offset:0 nt
    buffer_load_dwordx4 v[188:191], v1, s[12:15], s86 offen offset:1024 nt
    s_waitcnt lgkmcnt(0)
    s_barrier
    ds_read_b32 v96, v97
    s_waitcnt lgkmcnt(0)
    v_readfirstlane_b32 s77, v96
    s_nop 0
    s_cmp_eq_u32 s77, 0
    s_cselect_b32 s10, s18, 0
    s_mov_b32 s8, s16
    s_mov_b32 s9, s17
    s_mov_b32 s11, 0x20000
    buffer_load_dwordx4 a[240:243], v109, s[16:19], 0 offen sc1
    s_mul_i32 s77, s69, 464
    s_add_u32 s77, s77, s3
    s_add_u32 s77, s77, 49152
    s_cmp_eq_u32 s72, 3
    s_cselect_b32 s77, s77, 1879048176
    v_add_u32 v106, s77, v1
    v_mov_b32 v107, 2147483632
    v_cmp_le_u32 vcc, 29, v0
    s_nop 1
    v_cndmask_b32 v106, v106, v107, vcc
    buffer_load_dwordx4 a[240:243], v106, s[16:19], 0 offen sc1
    s_lshl_b32 s77, s69, 2
    s_add_u32 s77, s77, s72
    s_lshl_b32 s78, s77, 8
    s_add_u32 s78, s78, 819200
    s_lshl_b32 s77, s77, 9
    s_sub_u32 s77, s77, 256
    v_lshlrev_b32 v24, 7, v0
    v_add_u32 v25, s77, v24
    v_min_u32 v25, 57472, v25
    v_add_u32 v24, s78, v24
    v_cmp_gt_u32 vcc, 2, v0
    s_nop 1
    v_cndmask_b32 v24, v25, v24, vcc
    s_add_u32 s77, s3, 819200
    s_mov_b64 exec, 63
    buffer_load_dword a243, v24, s[16:19], s77 offen sc1
    s_mov_b64 exec, -1
    s_lshl_b32 s77, s70, 12
    s_mul_i32 s78, s72, 96
    s_add_u32 s77, s77, s78
    s_add_u32 s77, s77, s3
    v_lshrrev_b32 v24, 4, v0
    v_lshlrev_b32 v24, 9, v24
    v_and_b32 v25, 15, v0
    v_min_u32 v25, 11, v25
    v_lshl_add_u32 v24, v25, 3, v24
    buffer_load_dwordx2 v[64:65], v24, s[16:19], s77 offen offset:0 sc1
    buffer_load_dwordx2 v[66:67], v24, s[16:19], s77 offen offset:2048 sc1
    s_cmp_lg_u32 s72, 1
    s_cbranch_scc1 NOBASE0
    s_cmp_ge_u32 s69, 20
    s_cbranch_scc1 NOBASE0
    v_mov_b32 v28, v22
    s_lshl_b32 s77, s69, 6
    s_add_u32 s77, s77, s3
    s_add_u32 s77, s77, 47872
    v_lshlrev_b32 v27, 2, v0
    v_mov_b32_dpp v29, v28 quad_perm:[1,1,1,1] row_mask:0xf bank_mask:0xf
    v_mov_b32_dpp v30, v28 quad_perm:[2,2,2,2] row_mask:0xf bank_mask:0xf
    v_mov_b32_dpp v31, v28 quad_perm:[3,3,3,3] row_mask:0xf bank_mask:0xf
    s_mov_b32 exec_lo, 0x1111
    s_mov_b32 exec_hi, 0x0
    buffer_store_dwordx4 v[28:31], v27, s[8:11], s77 offen
    s_cmp_eq_u32 s10, 0
    s_cbranch_scc1 SLOW1
BACK1:
    s_mov_b64 exec, -1
NOBASE0:
    ds_write_b128 v2, v[112:115] offset:0
    ds_write_b128 v3, v[116:119] offset:0
    ds_write_b128 v4, v[120:123] offset:0
    ds_write_b128 v2, v[124:127] offset:3328
    ds_write_b128 v3, v[128:131] offset:3328
    ds_write_b128 v4, v[132:135] offset:3328
    ds_read_b64_tr_b16 a[194:195], v6 offset:0
    ds_read_b64_tr_b16 a[198:199], v6 offset:32
    ds_read_b64_tr_b16 a[202:203], v6 offset:64
    ds_read_b64_tr_b16 a[206:207], v6 offset:96
    ds_read_b64_tr_b16 a[210:211], v6 offset:128
    ds_read_b64_tr_b16 a[214:215], v6 offset:160
    ds_read_b64_tr_b16 a[218:219], v6 offset:192
    ds_read_b64_tr_b16 a[222:223], v6 offset:224
    ds_read_b64_tr_b16 a[226:227], v6 offset:256
    ds_read_b64_tr_b16 a[230:231], v6 offset:288
    ds_read_b64_tr_b16 a[234:235], v6 offset:320
    ds_read_b64_tr_b16 a[238:239], v6 offset:352
    s_waitcnt vmcnt(13)
    ds_write_b128 v2, v[136:139] offset:0
    ds_write_b128 v3, v[140:143] offset:0
    ds_write_b128 v4, v[144:147] offset:0
    ds_write_b128 v2, v[148:151] offset:3328
    ds_write_b128 v3, v[152:155] offset:3328
    ds_write_b128 v4, v[156:159] offset:3328
    ds_read_b64_tr_b16 v[112:113], v6 offset:0
    ds_read_b64_tr_b16 v[116:117], v6 offset:32
    ds_read_b64_tr_b16 v[120:121], v6 offset:64
    ds_read_b64_tr_b16 v[124:125], v6 offset:96
    ds_read_b64_tr_b16 v[128:129], v6 offset:128
    ds_read_b64_tr_b16 v[132:133], v6 offset:160
    ds_read_b64_tr_b16 v[136:137], v6 offset:192
    ds_read_b64_tr_b16 v[140:141], v6 offset:224
    ds_read_b64_tr_b16 v[144:145], v6 offset:256
    ds_read_b64_tr_b16 v[148:149], v6 offset:288
    ds_read_b64_tr_b16 v[152:153], v6 offset:320
    ds_read_b64_tr_b16 v[156:157], v6 offset:352
    buffer_load_dwordx4 v[192:195], v1, s[12:15], s86 offen offset:2048 nt
    buffer_load_dwordx4 v[196:199], v1, s[12:15], s86 offen offset:3072 nt
    buffer_load_dwordx4 v[200:203], v23, s[12:15], s86 offen offset:0 nt
    buffer_load_dwordx4 v[204:207], v23, s[12:15], s86 offen offset:1024 nt
    s_barrier
    buffer_load_dwordx4 v[208:211], v1, s[12:15], s87 offen offset:0 nt
    s_waitcnt vmcnt(12)
    ds_write_b128 v2, v[160:163] offset:0
    ds_write_b128 v3, v[164:167] offset:0
    ds_write_b128 v4, v[168:171] offset:0
    ds_write_b128 v2, v[172:175] offset:3328
    ds_write_b128 v3, v[176:179] offset:3328
    ds_write_b128 v4, v[180:183] offset:3328
    ds_read_b64_tr_b16 v[114:115], v6 offset:0
    ds_read_b64_tr_b16 v[118:119], v6 offset:32
    ds_read_b64_tr_b16 v[122:123], v6 offset:64
    ds_read_b64_tr_b16 v[126:127], v6 offset:96
    ds_read_b64_tr_b16 v[130:131], v6 offset:128
    ds_read_b64_tr_b16 v[134:135], v6 offset:160
    ds_read_b64_tr_b16 v[138:139], v6 offset:192
    ds_read_b64_tr_b16 v[142:143], v6 offset:224
    ds_read_b64_tr_b16 v[146:147], v6 offset:256
    ds_read_b64_tr_b16 v[150:151], v6 offset:288
    ds_read_b64_tr_b16 v[154:155], v6 offset:320
    ds_read_b64_tr_b16 v[158:159], v6 offset:352
    buffer_load_dwordx4 v[212:215], v1, s[12:15], s87 offen offset:1024 nt
    buffer_load_dwordx4 v[216:219], v1, s[12:15], s87 offen offset:2048 nt
    buffer_load_dwordx4 v[220:223], v1, s[12:15], s87 offen offset:3072 nt
    buffer_load_dwordx4 v[224:227], v23, s[12:15], s87 offen offset:0 nt
    buffer_load_dwordx4 v[228:231], v23, s[12:15], s87 offen offset:1024 nt
    s_barrier
    buffer_load_dwordx4 v[232:235], v1, s[12:15], s88 offen offset:0 nt
    buffer_load_dwordx4 v[236:239], v1, s[12:15], s88 offen offset:1024 nt
    s_waitcnt vmcnt(12)
    v_lshlrev_b32 v24, 16, v64
    v_and_b32 v25, 0xffff0000, v64
    v_lshlrev_b32 v26, 16, v65
    v_and_b32 v27, 0xffff0000, v65
    v_lshlrev_b32 v28, 16, v66
    v_and_b32 v29, 0xffff0000, v66
    v_lshlrev_b32 v30, 16, v67
    v_and_b32 v31, 0xffff0000, v67
    v_add_f32 v24, v24, v28
    v_add_f32 v25, v25, v29
    v_add_f32 v26, v26, v30
    v_add_f32 v27, v27, v31
    s_nop 0
    v_permlane32_swap_b32 v24, v26
    v_permlane32_swap_b32 v25, v27
    v_add_f32 v24, v24, v26
    v_add_f32 v25, v25, v27
    s_nop 1
    v_permlane16_swap_b32 v24, v25
    v_add_f32 v24, v24, v25
    v_cvt_pk_bf16_f32 v24, v24, v24
    ds_write_b16 v12, v24
    buffer_load_dwordx4 v[240:243], v1, s[12:15], s88 offen offset:2048 nt
    v_mov_b32 v40, 0
    v_mov_b32 v41, 0
    v_mov_b32 v44, 0
    v_mov_b32 v45, 0
    v_mov_b32 v48, 0
    v_mov_b32 v49, 0
    v_mov_b32 v52, 0
    v_mov_b32 v53, 0
    v_mov_b32 v56, 0
    v_mov_b32 v57, 0
    v_mov_b32 v60, 0
    v_mov_b32 v61, 0
    v_mov_b32 v64, 0
    v_mov_b32 v65, 0
    v_mov_b32 v68, 0
    v_mov_b32 v69, 0
    v_mov_b32 v72, 0
    v_mov_b32 v73, 0
    v_mov_b32 v74, 0
    v_mov_b32 v75, 0
    v_mov_b32 v76, 0
    v_mov_b32 v77, 0
    v_mov_b32 v78, 0
    v_mov_b32 v79, 0
    v_mov_b32 v80, 0
    v_mov_b32 v81, 0
    v_mov_b32 v82, 0
    v_mov_b32 v83, 0
    v_mov_b32 v84, 0
    v_mov_b32 v85, 0
    v_mov_b32 v86, 0
    v_mov_b32 v87, 0
    buffer_load_dwordx4 v[244:247], v1, s[12:15], s88 offen offset:3072 nt
    buffer_load_dwordx4 v[248:251], v23, s[12:15], s88 offen offset:0 nt
    s_waitcnt lgkmcnt(0)
    s_barrier
    ds_read_b128 v[28:31], v13 offset:0
    ds_read_b128 v[32:35], v13 offset:128
    ds_read_b128 v[36:39], v13 offset:256
    v_mov_b32 v18, 0x3dd53b94
    s_waitcnt lgkmcnt(2)
    v_smfmac_f32_16x16x64_bf16 v[40:43], v[28:31], a[0:7], v14
    v_smfmac_f32_16x16x64_bf16 v[44:47], v[28:31], a[24:31], v14
    v_smfmac_f32_16x16x64_bf16 v[48:51], v[28:31], a[48:55], v14
    v_smfmac_f32_16x16x64_bf16 v[52:55], v[28:31], a[72:79], v14
    v_smfmac_f32_16x16x64_bf16 v[56:59], v[28:31], a[96:103], v14
    v_smfmac_f32_16x16x64_bf16 v[60:63], v[28:31], a[120:127], v14
    v_smfmac_f32_16x16x64_bf16 v[64:67], v[28:31], a[144:151], v14
    v_smfmac_f32_16x16x64_bf16 v[68:71], v[28:31], a[168:175], v14
    buffer_load_dwordx4 v[252:255], v23, s[12:15], s88 offen offset:1024 nt
    s_barrier
    s_waitcnt lgkmcnt(1)
    v_smfmac_f32_16x16x64_bf16 v[40:43], v[32:35], a[8:15], v14
    v_smfmac_f32_16x16x64_bf16 v[44:47], v[32:35], a[32:39], v14
    v_smfmac_f32_16x16x64_bf16 v[48:51], v[32:35], a[56:63], v14
    v_smfmac_f32_16x16x64_bf16 v[52:55], v[32:35], a[80:87], v14
    v_smfmac_f32_16x16x64_bf16 v[56:59], v[32:35], a[104:111], v14
    v_smfmac_f32_16x16x64_bf16 v[60:63], v[32:35], a[128:135], v14
    v_smfmac_f32_16x16x64_bf16 v[64:67], v[32:35], a[152:159], v14
    v_smfmac_f32_16x16x64_bf16 v[68:71], v[32:35], a[176:183], v14
    s_waitcnt lgkmcnt(0)
    v_smfmac_f32_16x16x64_bf16 v[40:43], v[36:39], a[16:23], v14
    v_smfmac_f32_16x16x64_bf16 v[44:47], v[36:39], a[40:47], v14
    v_smfmac_f32_16x16x64_bf16 v[48:51], v[36:39], a[64:71], v14
    v_smfmac_f32_16x16x64_bf16 v[52:55], v[36:39], a[88:95], v14
    v_smfmac_f32_16x16x64_bf16 v[56:59], v[36:39], a[112:119], v14
    v_smfmac_f32_16x16x64_bf16 v[60:63], v[36:39], a[136:143], v14
    v_smfmac_f32_16x16x64_bf16 v[64:67], v[36:39], a[160:167], v14
    v_smfmac_f32_16x16x64_bf16 v[68:71], v[36:39], a[184:191], v14
    s_nop 0
    v_add_f32 v24, v40, v41
    v_add_f32 v44, v44, v45
    v_add_f32 v48, v48, v49
    v_max3_f32 v26, v24, v44, v48
    v_add_f32 v52, v52, v53
    v_add_f32 v25, v56, v57
    v_max3_f32 v26, v26, v52, v25
    v_add_f32 v60, v60, v61
    v_add_f32 v64, v64, v65
    v_max3_f32 v26, v26, v60, v64
    v_add_f32 v68, v68, v69
    v_max_f32 v26, v26, v68
    v_mov_b32_dpp v24, v44 quad_perm:[0,1,2,3] row_mask:0x2 bank_mask:0xf
    v_mov_b32_dpp v25, v60 quad_perm:[0,1,2,3] row_mask:0x2 bank_mask:0xf
    v_max_f32_dpp v26, v26, v26 row_ror:8 row_mask:0xf bank_mask:0xf
    v_mov_b32_dpp v24, v48 quad_perm:[0,1,2,3] row_mask:0x4 bank_mask:0xf
    v_mov_b32_dpp v25, v64 quad_perm:[0,1,2,3] row_mask:0x4 bank_mask:0xf
    v_max_f32_dpp v26, v26, v26 row_ror:4 row_mask:0xf bank_mask:0xf
    v_mov_b32_dpp v24, v52 quad_perm:[0,1,2,3] row_mask:0x8 bank_mask:0xf
    v_mov_b32_dpp v25, v68 quad_perm:[0,1,2,3] row_mask:0x8 bank_mask:0xf
    v_max_f32_dpp v26, v26, v26 row_ror:2 row_mask:0xf bank_mask:0xf
    v_accvgpr_read_b32 v27, a252
    s_nop 0
    v_max_f32_dpp v26, v26, v26 row_ror:1 row_mask:0xf bank_mask:0xf
    v_mul_f32 v26, v26, v18
    v_fma_f32 v24, v24, v18, -v26
    v_fma_f32 v25, v25, v18, -v26
    v_exp_f32 v24, v24
    v_exp_f32 v25, v25
    s_nop 0
    v_cvt_pk_bf16_f32 v28, v24, v25
    ds_write_b16 v19, v28
    ds_write_b16_d16_hi v19, v28 offset:128
    s_mov_b32 exec_lo, 0xff00ff
    s_mov_b32 exec_hi, 0xff00ff00
    ds_read_b128 v[72:75], v27 offset:0
    ds_read_b128 v[76:79], v27 offset:64
    ds_read_b128 v[80:83], v27 offset:128
    ds_read_b128 v[84:87], v27 offset:192
    s_mov_b64 exec, -1
    v_add_f32 v27, v24, v25
    v_mov_b32 v40, 0
    v_mov_b32 v44, 0
    v_add_f32_dpp v27, v27, v27 row_ror:8 row_mask:0xf bank_mask:0xf
    v_mov_b32 v48, 0
    v_mov_b32 v52, 0
    v_add_f32_dpp v27, v27, v27 row_ror:4 row_mask:0xf bank_mask:0xf
    v_mov_b32 v56, 0
    v_mov_b32 v60, 0
    v_add_f32_dpp v27, v27, v27 row_ror:2 row_mask:0xf bank_mask:0xf
    s_lshl_b32 s78, s72, 3
    s_add_u32 s78, s78, 125440
    v_add_f32_dpp v27, v27, v27 row_ror:1 row_mask:0xf bank_mask:0xf
    v_mov_b32 v28, v27
    s_nop 1
    v_permlane32_swap_b32 v27, v28
    v_add_f32 v27, v27, v28
    v_mov_b32 v28, v27
    s_nop 1
    v_permlane16_swap_b32 v27, v28
    v_add_f32 v27, v27, v28
    v_mov_b32 v28, s78
    ds_write_b64 v28, v[26:27]
    s_waitcnt lgkmcnt(0)
    v_smfmac_f32_16x16x64_bf16 v[40:43], v[72:75], a[192:199], v14 abid:1
    v_smfmac_f32_16x16x64_bf16 v[44:47], v[72:75], a[200:207], v14 abid:1
    v_smfmac_f32_16x16x64_bf16 v[48:51], v[72:75], a[208:215], v14 abid:1
    v_smfmac_f32_16x16x64_bf16 v[52:55], v[72:75], a[216:223], v14 abid:1
    v_smfmac_f32_16x16x64_bf16 v[56:59], v[72:75], a[224:231], v14 abid:1
    v_smfmac_f32_16x16x64_bf16 v[60:63], v[72:75], a[232:239], v14 abid:1
    v_smfmac_f32_16x16x64_bf16 v[40:43], v[76:79], v[112:119], v14 abid:1
    v_smfmac_f32_16x16x64_bf16 v[44:47], v[76:79], v[120:127], v14 abid:1
    v_smfmac_f32_16x16x64_bf16 v[48:51], v[76:79], v[128:135], v14 abid:1
    v_smfmac_f32_16x16x64_bf16 v[52:55], v[76:79], v[136:143], v14 abid:1
    v_smfmac_f32_16x16x64_bf16 v[56:59], v[76:79], v[144:151], v14 abid:1
    v_smfmac_f32_16x16x64_bf16 v[60:63], v[76:79], v[152:159], v14 abid:1
    s_waitcnt vmcnt(12)
    ds_write_b128 v2, v[184:187] offset:0
    ds_write_b128 v3, v[188:191] offset:0
    ds_write_b128 v4, v[192:195] offset:0
    ds_write_b128 v2, v[196:199] offset:3328
    ds_write_b128 v3, v[200:203] offset:3328
    ds_write_b128 v4, v[204:207] offset:3328
    ds_read_b64_tr_b16 v[160:161], v6 offset:0
    ds_read_b64_tr_b16 v[164:165], v6 offset:32
    ds_read_b64_tr_b16 v[168:169], v6 offset:64
    ds_read_b64_tr_b16 v[172:173], v6 offset:96
    ds_read_b64_tr_b16 v[176:177], v6 offset:128
    ds_read_b64_tr_b16 v[180:181], v6 offset:160
    ds_read_b64_tr_b16 v[184:185], v6 offset:192
    ds_read_b64_tr_b16 v[188:189], v6 offset:224
    ds_read_b64_tr_b16 v[192:193], v6 offset:256
    ds_read_b64_tr_b16 v[196:197], v6 offset:288
    ds_read_b64_tr_b16 v[200:201], v6 offset:320
    ds_read_b64_tr_b16 v[204:205], v6 offset:352
    v_mov_b32 v24, -1
    v_mov_b32 v25, -1
    v_mov_b32 v26, -1
    v_mov_b32 v27, -1
    buffer_store_dwordx4 v[24:27], v106, s[8:11], 0 offen
    s_cmp_eq_u32 s10, 0
    s_cbranch_scc1 SLOW2
BACK2:
    buffer_load_dwordx4 v[88:91], v1, s[12:15], s89 offen offset:0 nt
    buffer_load_dwordx4 v[92:95], v1, s[12:15], s89 offen offset:1024 nt
    buffer_load_dwordx4 v[96:99], v1, s[12:15], s89 offen offset:2048 nt
    buffer_load_dwordx4 v[100:103], v1, s[12:15], s89 offen offset:3072 nt
    buffer_load_dwordx4 v[104:107], v23, s[12:15], s89 offen offset:0 nt
    buffer_load_dwordx4 v[108:111], v23, s[12:15], s89 offen offset:1024 nt
    s_waitcnt vmcnt(13)
    ds_write_b128 v2, v[208:211] offset:0
    ds_write_b128 v3, v[212:215] offset:0
    ds_write_b128 v4, v[216:219] offset:0
    ds_write_b128 v2, v[220:223] offset:3328
    ds_write_b128 v3, v[224:227] offset:3328
    ds_write_b128 v4, v[228:231] offset:3328
    ds_read_b64_tr_b16 v[162:163], v6 offset:0
    ds_read_b64_tr_b16 v[166:167], v6 offset:32
    ds_read_b64_tr_b16 v[170:171], v6 offset:64
    ds_read_b64_tr_b16 v[174:175], v6 offset:96
    ds_read_b64_tr_b16 v[178:179], v6 offset:128
    ds_read_b64_tr_b16 v[182:183], v6 offset:160
    ds_read_b64_tr_b16 v[186:187], v6 offset:192
    ds_read_b64_tr_b16 v[190:191], v6 offset:224
    ds_read_b64_tr_b16 v[194:195], v6 offset:256
    ds_read_b64_tr_b16 v[198:199], v6 offset:288
    ds_read_b64_tr_b16 v[202:203], v6 offset:320
    ds_read_b64_tr_b16 v[206:207], v6 offset:352
    v_and_b32 v23, 0xffff0000, v22
    v_lshlrev_b32 v22, 16, v22
    s_mov_b32 s82, 0x50005
    s_mov_b32 s83, 0x50005
    s_mov_b32 s84, 0x1ff01ff
    s_mov_b32 s85, 0x1ff01ff
    s_mov_b32 s86, 0xffffffff
    s_mov_b32 s87, 0x1fff
    s_mov_b32 s50, 0x7fffff
    s_mov_b32 s51, 0x0
    s_mov_b32 s88, 0xff00ff
    s_mov_b32 s89, 0xff00ff00
    s_mov_b32 s92, 0x1010101
    s_mov_b32 s93, 0x0
    s_mov_b32 s44, 0xf0f0f0f
    s_mov_b32 s45, 0xf0f0f0f
    s_mov_b64 s[46:47], s[92:93]
    s_mov_b64 s[48:49], s[44:45]
    s_cmp_ge_u32 s69, 20
    s_cbranch_scc1 TAILF
    v_mov_b32 v24, -1
    v_mov_b32 v25, -1
    v_mov_b32 v26, -1
    v_mov_b32 v27, -1
    v_and_b32 v28, 3, v0
    v_lshrrev_b32 v29, 5, v0
    v_lshl_add_u32 v28, v29, 2, v28
    v_mul_u32_u24 v28, 10240, v28
    v_bfe_u32 v29, v0, 3, 2
    v_lshl_add_u32 v28, v29, 4, v28
    s_cmp_eq_u32 s72, 3
    s_cselect_b32 s77, 0, 1879048176
    v_add_u32 v28, s77, v28
    s_add_u32 s77, s80, 81920
    s_mov_b64 exec, s[44:45]
    buffer_store_dwordx4 v[24:27], v28, s[16:19], s77 offen sc1
    s_mov_b64 exec, -1
    v_lshrrev_b32 v38, 2, v0
    v_mul_u32_u24 v38, 1280, v38
    v_and_b32 v39, 3, v0
    v_lshl_add_u32 v39, v39, 4, v38
    s_mov_b32 m0, s67
    s_add_u32 s67, s67, 1024
    buffer_load_dwordx4 v39, s[24:27], s66 offen  lds
    s_add_u32 s66, s66, 20480
    s_mov_b32 m0, s67
    s_add_u32 s67, s67, 1024
    buffer_load_dwordx4 v39, s[24:27], s66 offen  lds
    s_add_u32 s66, s66, 20480
    s_mov_b32 m0, s67
    s_add_u32 s67, s67, 1024
    buffer_load_dwordx4 v39, s[24:27], s66 offen  lds
    s_add_u32 s66, s66, 20480
    s_waitcnt lgkmcnt(0)
    v_smfmac_f32_16x16x64_bf16 v[40:43], v[80:83], v[160:167], v14 abid:1
    v_smfmac_f32_16x16x64_bf16 v[44:47], v[80:83], v[168:175], v14 abid:1
    v_smfmac_f32_16x16x64_bf16 v[48:51], v[80:83], v[176:183], v14 abid:1
    v_smfmac_f32_16x16x64_bf16 v[52:55], v[80:83], v[184:191], v14 abid:1
    v_smfmac_f32_16x16x64_bf16 v[56:59], v[80:83], v[192:199], v14 abid:1
    v_smfmac_f32_16x16x64_bf16 v[60:63], v[80:83], v[200:207], v14 abid:1
    s_waitcnt vmcnt(11)
    ds_write_b128 v2, v[232:235] offset:0
    ds_write_b128 v3, v[236:239] offset:0
    ds_write_b128 v4, v[240:243] offset:0
    ds_write_b128 v2, v[244:247] offset:3328
    ds_write_b128 v3, v[248:251] offset:3328
    ds_write_b128 v4, v[252:255] offset:3328
    ds_read_b64_tr_b16 v[208:209], v6 offset:0
    ds_read_b64_tr_b16 v[212:213], v6 offset:32
    ds_read_b64_tr_b16 v[216:217], v6 offset:64
    ds_read_b64_tr_b16 v[220:221], v6 offset:96
    ds_read_b64_tr_b16 v[224:225], v6 offset:128
    ds_read_b64_tr_b16 v[228:229], v6 offset:160
    ds_read_b64_tr_b16 v[232:233], v6 offset:192
    ds_read_b64_tr_b16 v[236:237], v6 offset:224
    ds_read_b64_tr_b16 v[240:241], v6 offset:256
    ds_read_b64_tr_b16 v[244:245], v6 offset:288
    ds_read_b64_tr_b16 v[248:249], v6 offset:320
    ds_read_b64_tr_b16 v[252:253], v6 offset:352
    s_mov_b32 m0, s67
    s_add_u32 s67, s67, 1024
    buffer_load_dwordx4 v39, s[24:27], s66 offen  lds
    s_add_u32 s66, s66, 20480
    s_mov_b32 m0, s67
    s_add_u32 s67, s67, 1024
    buffer_load_dwordx4 v39, s[24:27], s66 offen  lds
    s_add_u32 s66, s66, 20480
    s_mov_b32 m0, s67
    s_add_u32 s67, s67, 1024
    buffer_load_dwordx4 v39, s[24:27], s66 offen  lds
    s_add_u32 s66, s66, 20480
    s_waitcnt vmcnt(12)
    ds_write_b128 v2, v[88:91] offset:0
    s_waitcnt vmcnt(11)
    ds_write_b128 v3, v[92:95] offset:0
    s_waitcnt vmcnt(10)
    ds_write_b128 v4, v[96:99] offset:0
    s_waitcnt vmcnt(9)
    ds_write_b128 v2, v[100:103] offset:3328
    s_waitcnt vmcnt(8)
    ds_write_b128 v3, v[104:107] offset:3328
    s_waitcnt vmcnt(7)
    ds_write_b128 v4, v[108:111] offset:3328
    ds_read_b64_tr_b16 v[210:211], v6 offset:0
    ds_read_b64_tr_b16 v[214:215], v6 offset:32
    ds_read_b64_tr_b16 v[218:219], v6 offset:64
    ds_read_b64_tr_b16 v[222:223], v6 offset:96
    ds_read_b64_tr_b16 v[226:227], v6 offset:128
    ds_read_b64_tr_b16 v[230:231], v6 offset:160
    ds_read_b64_tr_b16 v[234:235], v6 offset:192
    ds_read_b64_tr_b16 v[238:239], v6 offset:224
    ds_read_b64_tr_b16 v[242:243], v6 offset:256
    ds_read_b64_tr_b16 v[246:247], v6 offset:288
    ds_read_b64_tr_b16 v[250:251], v6 offset:320
    ds_read_b64_tr_b16 v[254:255], v6 offset:352
    s_branch ATT_LAST
TAILF:
    s_lshl_b32 s90, s68, 2
    s_add_u32 s90, s90, s72
    s_add_u32 s90, s90, 1
    s_mul_i32 s90, s90, 245760
    s_sub_u32 s78, 32, s69
    s_mul_i32 s78, s78, 10240
    s_sub_u32 s90, s90, s78
    buffer_load_dwordx4 a[240:243], v1, s[20:23], s90 offen offset:0
    buffer_load_dwordx4 a[240:243], v1, s[20:23], s90 offen offset:1024
    buffer_load_dwordx4 a[240:243], v1, s[20:23], s90 offen offset:2048
    buffer_load_dwordx4 a[240:243], v1, s[20:23], s90 offen offset:3072
    s_add_u32 s90, s90, 4096
    buffer_load_dwordx4 a[240:243], v1, s[20:23], s90 offen offset:0
    buffer_load_dwordx4 a[240:243], v1, s[20:23], s90 offen offset:1024
    buffer_load_dwordx4 a[240:243], v1, s[20:23], s90 offen offset:2048
    v_lshrrev_b32 v38, 3, v0
    v_mul_u32_u24 v38, 3072, v38
    v_and_b32 v39, 7, v0
    v_lshl_add_u32 v38, v39, 4, v38
    v_bfe_u32 v39, v0, 4, 1
    v_lshlrev_b32 v39, 5, v39
    v_xor_b32 v38, v38, v39
    v_xor_b32 v39, 64, v38
    s_waitcnt lgkmcnt(0)
    v_smfmac_f32_16x16x64_bf16 v[40:43], v[80:83], v[160:167], v14 abid:1
    v_smfmac_f32_16x16x64_bf16 v[44:47], v[80:83], v[168:175], v14 abid:1
    v_smfmac_f32_16x16x64_bf16 v[48:51], v[80:83], v[176:183], v14 abid:1
    v_smfmac_f32_16x16x64_bf16 v[52:55], v[80:83], v[184:191], v14 abid:1
    v_smfmac_f32_16x16x64_bf16 v[56:59], v[80:83], v[192:199], v14 abid:1
    v_smfmac_f32_16x16x64_bf16 v[60:63], v[80:83], v[200:207], v14 abid:1
    s_waitcnt vmcnt(14)
    ds_write_b128 v2, v[232:235] offset:0
    ds_write_b128 v3, v[236:239] offset:0
    ds_write_b128 v4, v[240:243] offset:0
    ds_write_b128 v2, v[244:247] offset:3328
    ds_write_b128 v3, v[248:251] offset:3328
    ds_write_b128 v4, v[252:255] offset:3328
    ds_read_b64_tr_b16 v[208:209], v6 offset:0
    ds_read_b64_tr_b16 v[212:213], v6 offset:32
    ds_read_b64_tr_b16 v[216:217], v6 offset:64
    ds_read_b64_tr_b16 v[220:221], v6 offset:96
    ds_read_b64_tr_b16 v[224:225], v6 offset:128
    ds_read_b64_tr_b16 v[228:229], v6 offset:160
    ds_read_b64_tr_b16 v[232:233], v6 offset:192
    ds_read_b64_tr_b16 v[236:237], v6 offset:224
    ds_read_b64_tr_b16 v[240:241], v6 offset:256
    ds_read_b64_tr_b16 v[244:245], v6 offset:288
    ds_read_b64_tr_b16 v[248:249], v6 offset:320
    ds_read_b64_tr_b16 v[252:253], v6 offset:352
    buffer_load_dwordx4 a[240:243], v1, s[20:23], s90 offen offset:3072
    s_add_u32 s90, s90, 4096
    buffer_load_dwordx4 a[240:243], v1, s[20:23], s90 offen offset:0
    buffer_load_dwordx4 a[240:243], v1, s[20:23], s90 offen offset:1024
    s_waitcnt vmcnt(15)
    ds_write_b128 v2, v[88:91] offset:0
    s_waitcnt vmcnt(14)
    ds_write_b128 v3, v[92:95] offset:0
    s_waitcnt vmcnt(13)
    ds_write_b128 v4, v[96:99] offset:0
    s_waitcnt vmcnt(12)
    ds_write_b128 v2, v[100:103] offset:3328
    s_waitcnt vmcnt(11)
    ds_write_b128 v3, v[104:107] offset:3328
    s_waitcnt vmcnt(10)
    ds_write_b128 v4, v[108:111] offset:3328
    ds_read_b64_tr_b16 v[210:211], v6 offset:0
    ds_read_b64_tr_b16 v[214:215], v6 offset:32
    ds_read_b64_tr_b16 v[218:219], v6 offset:64
    ds_read_b64_tr_b16 v[222:223], v6 offset:96
    ds_read_b64_tr_b16 v[226:227], v6 offset:128
    ds_read_b64_tr_b16 v[230:231], v6 offset:160
    ds_read_b64_tr_b16 v[234:235], v6 offset:192
    ds_read_b64_tr_b16 v[238:239], v6 offset:224
    ds_read_b64_tr_b16 v[242:243], v6 offset:256
    ds_read_b64_tr_b16 v[246:247], v6 offset:288
    ds_read_b64_tr_b16 v[250:251], v6 offset:320
    ds_read_b64_tr_b16 v[254:255], v6 offset:352
    s_mov_b32 m0, s67
    s_add_u32 s67, s67, 1024
    buffer_load_dwordx4 v38, s[36:39], s66 offen nt lds
    s_add_u32 s66, s66, 24576
    s_mov_b32 m0, s67
    s_add_u32 s67, s67, 1024
    buffer_load_dwordx4 v39, s[36:39], s66 offen nt lds
    s_add_u32 s66, s66, 24576
    s_branch ATT_LAST
LOOP:
    s_cmp_lt_u32 s69, 20
    s_cselect_b32 s5, s72, 4
    s_add_u32 s96, s3, 819200
    s_add_u32 s97, s96, 4096
    s_and_b32 s77, s5, 3
    s_cbranch_scc1 LOOP2
    ds_read_b64_tr_b16 v[40:41], v16 offset:0
    ds_read_b64_tr_b16 v[42:43], v16 offset:1536
    ds_read_b64_tr_b16 v[44:45], v16 offset:12288
    ds_read_b64_tr_b16 v[46:47], v16 offset:13824
    ds_read_b64_tr_b16 v[48:49], v17 offset:24576
    ds_read_b64_tr_b16 v[50:51], v16 offset:32
    ds_read_b64_tr_b16 v[52:53], v16 offset:1568
    ds_read_b64_tr_b16 v[54:55], v16 offset:12320
    ds_read_b64_tr_b16 v[56:57], v16 offset:13856
    ds_read_b64_tr_b16 v[58:59], v17 offset:24608
    ds_read_b64_tr_b16 v[60:61], v16 offset:64
    ds_read_b64_tr_b16 v[62:63], v16 offset:1600
    ds_read_b64_tr_b16 v[64:65], v16 offset:12352
    ds_read_b64_tr_b16 v[66:67], v16 offset:13888
    ds_read_b64_tr_b16 v[68:69], v17 offset:24640
    v_and_b32 v25, 15, v0
    v_cmp_eq_u32 vcc, 12, v25
    v_mov_b32 v36, 0x3f803f80
    s_nop 0
    v_cndmask_b32 v70, 0, v36, vcc
    v_mov_b32 v71, v70
    v_mov_b32 v72, v70
    v_mov_b32 v73, v70
    v_mov_b32 v74, v70
    v_mov_b32 v75, v70
    v_mov_b32 v76, v70
    v_mov_b32 v77, v70
    v_mov_b32 v78, v70
    v_mov_b32 v79, v70
    s_mov_b32 s77, 4096
    v_mul_u32_u24 v96, 103, v0
    v_lshrrev_b32 v96, 10, v96
    v_lshl_add_u32 v96, v96, 4, v1
    v_add_u32 v96, s77, v96
    v_mul_u32_u24 v97, 176, v25
    v_add_u32 v97, s77, v97
    v_lshrrev_b32 v28, 4, v0
    v_lshl_add_u32 v98, v28, 3, v97
    v_lshl_add_u32 v97, v28, 4, v97
LOOP2:
    s_add_u32 s79, s3, 4096
    s_mul_i32 s77, s71, 160
    s_add_u32 s77, s77, s3
    s_sub_u32 s77, s77, 772608
    s_mov_b32 exec_lo, 0x3ff
    s_mov_b32 exec_hi, 0x0
    s_mov_b32 s76, 1
POLL3:
    buffer_load_dword v24, v1, s[16:19], s77 offen sc1
POLLW3:
    s_waitcnt vmcnt(0)
    v_cmp_eq_u32 vcc, -1, v24
    s_cbranch_vccnz AGAIN3
POLLX3:
    s_mov_b64 exec, s[50:51]
    buffer_load_dwordx4 v[80:83], v8, s[16:19], 0 offen sc1
    s_waitcnt vmcnt(0)
BW4:
    ds_write_b128 v9, v[80:83]
    v_cmp_eq_u32 vcc, -1, v80
    s_cbranch_vccnz BR4
BX4:
    s_mov_b64 exec, s[84:85]
    s_waitcnt lgkmcnt(0)
    s_barrier
    ds_read_b128 v[70:73], v97
    ds_read_b128 v[74:77], v97 offset:64
    ds_read_b64 v[78:79], v98 offset:128
    s_mov_b64 exec, -1
    s_cmp_lg_u32 s5, 1
    s_cbranch_scc1 NOOWL
    buffer_load_dword a244, v20, s[16:19], 0 offen sc1
    buffer_load_dword a245, v21, s[16:19], 0 offen sc1
NOOWL:
    buffer_load_dwordx4 v[88:91], v11, s[16:19], s96 offen sc1
    buffer_load_dwordx4 v[92:95], v11, s[16:19], s97 offen sc1
    s_waitcnt lgkmcnt(2)
    v_mfma_f32_16x16x32_bf16 v[24:27], v[70:73], v[40:43], 0
    v_mfma_f32_16x16x32_bf16 v[32:35], v[70:73], v[60:63], 0
    s_waitcnt lgkmcnt(0)
    v_mfma_f32_16x16x32_bf16 v[24:27], v[74:77], v[44:47], v[24:27]
    v_mfma_f32_16x16x32_bf16 v[32:35], v[74:77], v[64:67], v[32:35]
    v_mfma_f32_16x16x16_bf16 v[24:27], v[78:79], v[48:49], v[24:27]
    v_mfma_f32_16x16x16_bf16 v[32:35], v[78:79], v[68:69], v[32:35]
    v_mfma_f32_16x16x32_bf16 v[28:31], v[70:73], v[50:53], 0
    v_mfma_f32_16x16x32_bf16 v[36:39], v[70:73], v[70:73], 0
    v_mfma_f32_16x16x32_bf16 v[28:31], v[74:77], v[54:57], v[28:31]
    v_mfma_f32_16x16x32_bf16 v[36:39], v[74:77], v[74:77], v[36:39]
    v_mfma_f32_16x16x16_bf16 v[28:31], v[78:79], v[58:59], v[28:31]
    v_mfma_f32_16x16x16_bf16 v[36:39], v[78:79], v[78:79], v[36:39]
    s_nop 0
    v_add_f32 v24, v24, v25
    v_add_f32 v26, v26, v27
    v_add_f32 v24, v24, v26
    v_add_f32 v32, v32, v33
    v_add_f32 v34, v34, v35
    v_add_f32 v32, v32, v34
    s_nop 1
    v_permlane32_swap_b32 v24, v32
    v_add_f32 v28, v28, v29
    v_add_f32 v30, v30, v31
    v_add_f32 v36, v36, v37
    v_add_f32 v38, v38, v39
    v_add_f32 v24, v24, v32
    v_add_f32 v28, v28, v30
    v_add_f32 v36, v36, v38
    s_nop 1
    v_permlane32_swap_b32 v28, v36
    v_add_f32 v28, v28, v36
    s_nop 1
    v_permlane16_swap_b32 v24, v28
    v_add_f32 v24, v24, v28
    buffer_store_dword v24, v10, s[8:11], s3 offen
    s_cmp_eq_u32 s10, 0
    s_cbranch_scc1 SLOW5
BACK5:
    v_mov_b32 v40, 0
    v_mov_b32 v41, 0
    v_mov_b32 v44, 0
    v_mov_b32 v45, 0
    v_mov_b32 v48, 0
    v_mov_b32 v49, 0
    v_mov_b32 v52, 0
    v_mov_b32 v53, 0
    v_mov_b32 v56, 0
    v_mov_b32 v57, 0
    v_mov_b32 v60, 0
    v_mov_b32 v61, 0
    v_mov_b32 v64, 0
    v_mov_b32 v65, 0
    v_mov_b32 v68, 0
    v_mov_b32 v69, 0
    v_mov_b32 v72, 0
    v_mov_b32 v73, 0
    v_mov_b32 v74, 0
    v_mov_b32 v75, 0
    v_mov_b32 v76, 0
    v_mov_b32 v77, 0
    v_mov_b32 v78, 0
    v_mov_b32 v79, 0
    v_mov_b32 v80, 0
    v_mov_b32 v81, 0
    v_mov_b32 v82, 0
    v_mov_b32 v83, 0
    v_mov_b32 v84, 0
    v_mov_b32 v85, 0
    v_mov_b32 v86, 0
    v_mov_b32 v87, 0
    s_waitcnt vmcnt(1)
    v_add_f32 v88, v88, v92
    v_add_f32 v89, v89, v93
    v_add_f32 v90, v90, v94
    v_add_f32 v91, v91, v95
    s_nop 0
    v_permlane32_swap_b32 v88, v90
    v_permlane32_swap_b32 v89, v91
    v_add_f32 v88, v88, v90
    v_add_f32 v89, v89, v91
    s_nop 1
    v_permlane16_swap_b32 v88, v89
    v_add_f32 v88, v88, v89
    v_mul_f32 v7, 0x3acccccd, v88
    s_mov_b32 s76, 1
POLL6:
    buffer_load_dwordx4 v[24:27], v11, s[16:19], s3 offen sc1
    buffer_load_dwordx4 v[28:31], v11, s[16:19], s79 offen sc1
    s_waitcnt vmcnt(0)
    v_add_f32 v24, v24, v28
    v_add_f32 v25, v25, v29
    v_add_f32 v26, v26, v30
    v_add_f32 v27, v27, v31
    s_nop 0
    v_permlane32_swap_b32 v24, v26
    v_permlane32_swap_b32 v25, v27
    v_add_f32 v24, v24, v26
    v_add_f32 v25, v25, v27
    s_nop 1
    v_permlane16_swap_b32 v24, v25
    v_add_f32 v24, v24, v25
    v_cmp_u_f32 vcc, v24, v24
    s_cbranch_vccnz AGAIN6
POLLX6:
    v_readlane_b32 s77, v24, 15
    s_mov_b32 vcc_lo, 0x70007000
    s_mov_b32 vcc_hi, 0x70007000
    v_fma_f32 v25, -s77, v7, v24
    v_cvt_pk_bf16_f32 v25, v25, v25
    ds_write_b16 v12, v25
    v_cndmask_b32 v26, 0, v24, vcc
    s_nop 1
    v_add_f32_dpp v26, v26, v26 quad_perm:[1,0,3,2] row_mask:0xf bank_mask:0xf
    s_nop 1
    v_add_f32_dpp v26, v26, v26 quad_perm:[2,3,0,1] row_mask:0xf bank_mask:0xf
    v_mov_b32 v27, v26
    s_nop 1
    v_permlane32_swap_b32 v26, v27
    v_add_f32 v26, v26, v27
    s_waitcnt lgkmcnt(0)
    s_barrier
    ds_read_b128 v[28:31], v13 offset:0
    ds_read_b128 v[32:35], v13 offset:128
    ds_read_b128 v[36:39], v13 offset:256
    v_mov_b32 v27, v26
    v_mov_b32 v25, s77
    v_subrev_f32 v25, 0x44200000, v25
    v_permlane16_swap_b32 v26, v27
    v_add_f32 v26, v26, v27
    v_mul_f32 v24, 0x3acccccd, v25
    v_readlane_b32 s77, v26, 15
    v_mul_f32 v24, v24, v24
    s_mov_b32 s78, 0x3acccccd
    v_sub_f32 v26, s77, v25
    v_fma_f32 v26, v26, s78, -v24
    v_max_f32 v26, 0, v26
    v_add_f32 v26, 0x3727c5ac, v26
    v_rsq_f32 v26, v26
    s_nop 0
    v_mul_f32 v18, 0x3dd53b94, v26
    s_waitcnt lgkmcnt(2)
    v_smfmac_f32_16x16x64_bf16 v[40:43], v[28:31], a[0:7], v14
    v_smfmac_f32_16x16x64_bf16 v[44:47], v[28:31], a[24:31], v14
    v_smfmac_f32_16x16x64_bf16 v[48:51], v[28:31], a[48:55], v14
    v_smfmac_f32_16x16x64_bf16 v[52:55], v[28:31], a[72:79], v14
    v_smfmac_f32_16x16x64_bf16 v[56:59], v[28:31], a[96:103], v14
    v_smfmac_f32_16x16x64_bf16 v[60:63], v[28:31], a[120:127], v14
    v_smfmac_f32_16x16x64_bf16 v[64:67], v[28:31], a[144:151], v14
    v_smfmac_f32_16x16x64_bf16 v[68:71], v[28:31], a[168:175], v14
    s_waitcnt lgkmcnt(1)
    v_smfmac_f32_16x16x64_bf16 v[40:43], v[32:35], a[8:15], v14
    v_smfmac_f32_16x16x64_bf16 v[44:47], v[32:35], a[32:39], v14
    v_smfmac_f32_16x16x64_bf16 v[48:51], v[32:35], a[56:63], v14
    v_smfmac_f32_16x16x64_bf16 v[52:55], v[32:35], a[80:87], v14
    v_smfmac_f32_16x16x64_bf16 v[56:59], v[32:35], a[104:111], v14
    v_smfmac_f32_16x16x64_bf16 v[60:63], v[32:35], a[128:135], v14
    v_smfmac_f32_16x16x64_bf16 v[64:67], v[32:35], a[152:159], v14
    v_smfmac_f32_16x16x64_bf16 v[68:71], v[32:35], a[176:183], v14
    s_waitcnt lgkmcnt(0)
    v_smfmac_f32_16x16x64_bf16 v[40:43], v[36:39], a[16:23], v14
    v_smfmac_f32_16x16x64_bf16 v[44:47], v[36:39], a[40:47], v14
    v_smfmac_f32_16x16x64_bf16 v[48:51], v[36:39], a[64:71], v14
    v_smfmac_f32_16x16x64_bf16 v[52:55], v[36:39], a[88:95], v14
    v_smfmac_f32_16x16x64_bf16 v[56:59], v[36:39], a[112:119], v14
    v_smfmac_f32_16x16x64_bf16 v[60:63], v[36:39], a[136:143], v14
    v_smfmac_f32_16x16x64_bf16 v[64:67], v[36:39], a[160:167], v14
    v_smfmac_f32_16x16x64_bf16 v[68:71], v[36:39], a[184:191], v14
    s_nop 0
    v_add_f32 v24, v40, v41
    v_add_f32 v44, v44, v45
    v_add_f32 v48, v48, v49
    v_max3_f32 v26, v24, v44, v48
    v_add_f32 v52, v52, v53
    v_add_f32 v25, v56, v57
    v_max3_f32 v26, v26, v52, v25
    v_add_f32 v60, v60, v61
    v_add_f32 v64, v64, v65
    v_max3_f32 v26, v26, v60, v64
    v_add_f32 v68, v68, v69
    v_max_f32 v26, v26, v68
    v_mov_b32_dpp v24, v44 quad_perm:[0,1,2,3] row_mask:0x2 bank_mask:0xf
    v_mov_b32_dpp v25, v60 quad_perm:[0,1,2,3] row_mask:0x2 bank_mask:0xf
    v_max_f32_dpp v26, v26, v26 row_ror:8 row_mask:0xf bank_mask:0xf
    v_mov_b32_dpp v24, v48 quad_perm:[0,1,2,3] row_mask:0x4 bank_mask:0xf
    v_mov_b32_dpp v25, v64 quad_perm:[0,1,2,3] row_mask:0x4 bank_mask:0xf
    v_max_f32_dpp v26, v26, v26 row_ror:4 row_mask:0xf bank_mask:0xf
    v_mov_b32_dpp v24, v52 quad_perm:[0,1,2,3] row_mask:0x8 bank_mask:0xf
    v_mov_b32_dpp v25, v68 quad_perm:[0,1,2,3] row_mask:0x8 bank_mask:0xf
    v_max_f32_dpp v26, v26, v26 row_ror:2 row_mask:0xf bank_mask:0xf
    v_accvgpr_read_b32 v27, a252
    s_nop 0
    v_max_f32_dpp v26, v26, v26 row_ror:1 row_mask:0xf bank_mask:0xf
    v_mul_f32 v26, v26, v18
    v_fma_f32 v24, v24, v18, -v26
    v_fma_f32 v25, v25, v18, -v26
    v_exp_f32 v24, v24
    v_exp_f32 v25, v25
    s_nop 0
    v_cvt_pk_bf16_f32 v28, v24, v25
    ds_write_b16 v19, v28
    ds_write_b16_d16_hi v19, v28 offset:128
    s_mov_b64 exec, s[88:89]
    ds_read_b128 v[72:75], v27 offset:0
    ds_read_b128 v[76:79], v27 offset:64
    ds_read_b128 v[80:83], v27 offset:128
    ds_read_b128 v[84:87], v27 offset:192
    s_mov_b64 exec, -1
    v_add_f32 v27, v24, v25
    v_mov_b32 v40, 0
    v_mov_b32 v44, 0
    v_add_f32_dpp v27, v27, v27 row_ror:8 row_mask:0xf bank_mask:0xf
    v_mov_b32 v48, 0
    v_mov_b32 v52, 0
    v_add_f32_dpp v27, v27, v27 row_ror:4 row_mask:0xf bank_mask:0xf
    v_mov_b32 v56, 0
    v_mov_b32 v60, 0
    v_add_f32_dpp v27, v27, v27 row_ror:2 row_mask:0xf bank_mask:0xf
    s_lshl_b32 s78, s72, 3
    s_add_u32 s78, s78, 125440
    v_add_f32_dpp v27, v27, v27 row_ror:1 row_mask:0xf bank_mask:0xf
    v_mov_b32 v28, v27
    s_nop 1
    v_permlane32_swap_b32 v27, v28
    v_add_f32 v27, v27, v28
    v_mov_b32 v28, v27
    s_nop 1
    v_permlane16_swap_b32 v27, v28
    v_add_f32 v27, v27, v28
    v_mov_b32 v28, s78
    ds_write_b64 v28, v[26:27]
    s_waitcnt lgkmcnt(4)
    v_smfmac_f32_16x16x64_bf16 v[40:43], v[72:75], a[192:199], v14 abid:1
    v_smfmac_f32_16x16x64_bf16 v[44:47], v[72:75], a[200:207], v14 abid:1
    v_smfmac_f32_16x16x64_bf16 v[48:51], v[72:75], a[208:215], v14 abid:1
    v_smfmac_f32_16x16x64_bf16 v[52:55], v[72:75], a[216:223], v14 abid:1
    v_smfmac_f32_16x16x64_bf16 v[56:59], v[72:75], a[224:231], v14 abid:1
    v_smfmac_f32_16x16x64_bf16 v[60:63], v[72:75], a[232:239], v14 abid:1
    s_waitcnt lgkmcnt(3)
    v_smfmac_f32_16x16x64_bf16 v[40:43], v[76:79], v[112:119], v14 abid:1
    v_smfmac_f32_16x16x64_bf16 v[44:47], v[76:79], v[120:127], v14 abid:1
    v_smfmac_f32_16x16x64_bf16 v[48:51], v[76:79], v[128:135], v14 abid:1
    v_smfmac_f32_16x16x64_bf16 v[52:55], v[76:79], v[136:143], v14 abid:1
    v_smfmac_f32_16x16x64_bf16 v[56:59], v[76:79], v[144:151], v14 abid:1
    v_smfmac_f32_16x16x64_bf16 v[60:63], v[76:79], v[152:159], v14 abid:1
    s_waitcnt lgkmcnt(2)
    v_smfmac_f32_16x16x64_bf16 v[40:43], v[80:83], v[160:167], v14 abid:1
    v_smfmac_f32_16x16x64_bf16 v[44:47], v[80:83], v[168:175], v14 abid:1
    v_smfmac_f32_16x16x64_bf16 v[48:51], v[80:83], v[176:183], v14 abid:1
    v_smfmac_f32_16x16x64_bf16 v[52:55], v[80:83], v[184:191], v14 abid:1
    v_smfmac_f32_16x16x64_bf16 v[56:59], v[80:83], v[192:199], v14 abid:1
    v_smfmac_f32_16x16x64_bf16 v[60:63], v[80:83], v[200:207], v14 abid:1
    s_waitcnt lgkmcnt(0)
ATT_LAST:
    s_waitcnt lgkmcnt(8)
    v_smfmac_f32_16x16x64_bf16 v[40:43], v[84:87], v[208:215], v14 abid:1
    v_smfmac_f32_16x16x64_bf16 v[44:47], v[84:87], v[216:223], v14 abid:1
    s_waitcnt lgkmcnt(4)
    v_smfmac_f32_16x16x64_bf16 v[48:51], v[84:87], v[224:231], v14 abid:1
    v_smfmac_f32_16x16x64_bf16 v[52:55], v[84:87], v[232:239], v14 abid:1
    s_waitcnt lgkmcnt(0)
    v_smfmac_f32_16x16x64_bf16 v[56:59], v[84:87], v[240:247], v14 abid:1
    v_smfmac_f32_16x16x64_bf16 v[60:63], v[84:87], v[248:255], v14 abid:1
    s_lshl_b32 s77, s72, 8
    s_add_u32 s77, s77, 119296
    v_lshl_add_u32 v24, v0, 2, s77
    v_permlane16_swap_b32 v40, v44
    v_add_f32 v40, v40, v44
    ds_write_b32 v15, v40 offset:0
    v_permlane16_swap_b32 v48, v52
    v_add_f32 v48, v48, v52
    ds_write_b32 v15, v48 offset:256
    v_permlane16_swap_b32 v56, v60
    v_add_f32 v56, v56, v60
    ds_write_b32 v15, v56 offset:512
    v_and_b32 v25, 3, v0
    v_mad_u32_u24 v26, v25, 48, v1
    v_lshlrev_b32 v25, 3, v25
    v_add_u32 v25, 125440, v25
    s_waitcnt lgkmcnt(0)
    s_barrier
    ds_read_b64 v[32:33], v25
    ds_read2st64_b32 v[40:41], v24 offset0:0 offset1:3
    ds_read2st64_b32 v[42:43], v24 offset0:6 offset1:9
    s_mul_i32 s77, s70, 3072
    s_lshl_b32 s78, s71, 4
    s_add_u32 s77, s77, s78
    s_lshl_b32 s78, s72, 10
    s_add_u32 s77, s77, s78
    s_add_u32 s77, s77, s3
    s_add_u32 s77, s77, 32768
    s_lshl_b32 s78, s69, 3
    s_add_u32 s78, s78, s3
    s_add_u32 s78, s78, 45056
    s_cmp_eq_u32 s72, 3
    s_waitcnt lgkmcnt(2)
    v_max_f32_dpp v34, v32, v32 quad_perm:[1,0,3,2] row_mask:0xf bank_mask:0xf
    s_nop 1
    v_max_f32_dpp v34, v34, v34 quad_perm:[2,3,0,1] row_mask:0xf bank_mask:0xf
    v_sub_f32 v32, v32, v34
    v_exp_f32 v32, v32
    s_cbranch_scc1 OML
    s_waitcnt lgkmcnt(0)
    v_mul_f32_dpp v28, v32, v40 quad_perm:[0,0,0,0] row_mask:0xf bank_mask:0xf
    v_mul_f32_dpp v29, v32, v41 quad_perm:[1,1,1,1] row_mask:0xf bank_mask:0xf
    v_mul_f32_dpp v30, v32, v42 quad_perm:[2,2,2,2] row_mask:0xf bank_mask:0xf
    v_fmac_f32_dpp v28, v32, v43 quad_perm:[3,3,3,3] row_mask:0xf bank_mask:0xf
    v_add_f32 v29, v29, v30
    v_add_f32 v28, v28, v29
    s_nop 1
    v_mov_b32_dpp v29, v28 row_shl:1 row_mask:0xf bank_mask:0xf
    v_cvt_pk_bf16_f32 v28, v28, v29
    s_nop 1
    v_mov_b32_dpp v29, v28 row_shl:4 row_mask:0xf bank_mask:0xf
    v_mov_b32_dpp v30, v28 row_shl:8 row_mask:0xf bank_mask:0xf
    v_mov_b32_dpp v31, v28 row_shl:12 row_mask:0xf bank_mask:0xf
    s_mov_b64 exec, s[82:83]
    buffer_store_dwordx4 v[28:31], v26, s[8:11], s77 offen
    s_cmp_eq_u32 s10, 0
    s_cbranch_scc1 SLOW7
BACK7:
    s_mov_b64 exec, -1
ODONE:
    s_cmp_ge_u32 s69, 20
    s_cbranch_scc1 ROLEF
    s_cmp_eq_u32 s74, 0
    s_cbranch_scc1 WLATE
    v_accvgpr_read_b32 v2, a246
    v_accvgpr_read_b32 v3, a247
    v_accvgpr_read_b32 v4, a248
    ds_read_b64_tr_b16 v[40:41], v2 offset:0
    ds_read_b64_tr_b16 v[42:43], v2 offset:256
    ds_read_b64_tr_b16 v[64:65], v2 offset:32
    ds_read_b64_tr_b16 v[66:67], v2 offset:288
    ds_read_b64_tr_b16 v[44:45], v2 offset:2048
    ds_read_b64_tr_b16 v[46:47], v2 offset:2304
    ds_read_b64_tr_b16 v[68:69], v2 offset:2080
    ds_read_b64_tr_b16 v[70:71], v2 offset:2336
    ds_read_b64_tr_b16 v[48:49], v2 offset:4096
    ds_read_b64_tr_b16 v[50:51], v2 offset:4352
    s_cmp_lg_u32 s72, 1
    s_cbranch_scc1 NOOWN0
    v_accvgpr_read_b32 v28, a244
    v_accvgpr_read_b32 v29, a245
    v_max_u32 v30, v28, v29
    v_cmp_eq_u32 vcc, -1, v30
    s_cbranch_vccnz RETRY8
OK8:
    v_lshlrev_b32 v30, 16, v28
    v_and_b32 v28, 0xffff0000, v28
    v_lshlrev_b32 v31, 16, v29
    v_and_b32 v29, 0xffff0000, v29
    v_add_f32 v30, v30, v31
    v_add_f32 v28, v28, v29
    v_mov_b32 v31, v30
    v_mov_b32 v29, v28
    s_nop 0
    v_permlane32_swap_b32 v30, v31
    v_permlane32_swap_b32 v28, v29
    v_add_f32 v30, v30, v31
    v_add_f32 v28, v28, v29
    v_mov_b32 v31, v30
    v_mov_b32 v29, v28
    s_nop 0
    v_permlane16_swap_b32 v30, v31
    v_permlane16_swap_b32 v28, v29
    v_add_f32 v30, v30, v31
    v_add_f32 v28, v28, v29
    v_add_f32 v22, v22, v30
    v_add_f32 v23, v23, v28
    v_cvt_pk_bf16_f32 v28, v22, v23
    s_lshl_b32 s77, s69, 6
    s_add_u32 s77, s77, s3
    s_add_u32 s77, s77, 47872
    v_lshlrev_b32 v32, 2, v0
    v_mov_b32_dpp v29, v28 quad_perm:[1,1,1,1] row_mask:0xf bank_mask:0xf
    v_mov_b32_dpp v30, v28 quad_perm:[2,2,2,2] row_mask:0xf bank_mask:0xf
    v_mov_b32_dpp v31, v28 quad_perm:[3,3,3,3] row_mask:0xf bank_mask:0xf
    s_mov_b32 exec_lo, 0x1111
    s_mov_b32 exec_hi, 0x0
    buffer_store_dwordx4 v[28:31], v32, s[8:11], s77 offen
    s_cmp_eq_u32 s10, 0
    s_cbranch_scc1 SLOW9
BACK9:
    s_mov_b64 exec, -1
NOOWN0:
    buffer_load_dwordx2 v[24:25], v4, s[16:19], s3 offen sc1
    buffer_load_dwordx4 v[88:91], v3, s[16:19], s3 offen offset:0 sc1
    buffer_load_dwordx4 v[92:95], v3, s[16:19], s3 offen offset:1024 sc1
    buffer_load_dwordx4 v[96:99], v3, s[16:19], s3 offen offset:2048 sc1
    ds_read_b64_tr_b16 v[72:73], v2 offset:4128
    ds_read_b64_tr_b16 v[74:75], v2 offset:4384
    ds_read_b64_tr_b16 v[52:53], v2 offset:6144
    ds_read_b64_tr_b16 v[54:55], v2 offset:6400
    ds_read_b64_tr_b16 v[76:77], v2 offset:6176
    ds_read_b64_tr_b16 v[78:79], v2 offset:6432
    ds_read_b64_tr_b16 v[56:57], v2 offset:8192
    ds_read_b64_tr_b16 v[58:59], v2 offset:8448
    ds_read_b64_tr_b16 v[80:81], v2 offset:8224
    ds_read_b64_tr_b16 v[82:83], v2 offset:8480
    ds_read_b64_tr_b16 v[60:61], v2 offset:10240
    ds_read_b64_tr_b16 v[62:63], v2 offset:10496
    ds_read_b64_tr_b16 v[84:85], v2 offset:10272
    ds_read_b64_tr_b16 v[86:87], v2 offset:10528
    v_accvgpr_read_b32 v5, a249
    v_and_b32 v18, 3, v0
    v_lshrrev_b32 v6, 5, v0
    v_lshl_add_u32 v18, v6, 2, v18
    v_mul_u32_u24 v18, 10240, v18
    v_bfe_u32 v6, v0, 3, 2
    v_lshl_add_u32 v18, v6, 4, v18
    v_and_b32 v6, 0xffffff7f, v5
    v_bfe_u32 v26, v0, 3, 1
    v_mul_u32_u24 v26, 0xaaaa, v26
    v_add_u32 v26, 0x4444, v26
    v_mov_b32 v28, 0
    v_mov_b32 v29, 0
    v_mov_b32 v30, 0
    v_mov_b32 v31, 0
    v_mov_b32 v32, 0
    v_mov_b32 v33, 0
    v_mov_b32 v34, 0
    v_mov_b32 v35, 0
WCHK:
    s_waitcnt vmcnt(0)
    v_max3_u32 v38, v88, v92, v96
    v_max_u32 v38, v38, v25
    v_cmp_eq_u32 vcc, -1, v38
    s_cbranch_vccnz AGAIN10
POLLX10:
    s_waitcnt lgkmcnt(0)
    v_max_f32_dpp v27, v24, v24 quad_perm:[1,0,3,2] row_mask:0xf bank_mask:0xf
    v_smfmac_f32_16x16x64_bf16 v[28:31], v[88:91], v[40:47], v26
    v_smfmac_f32_16x16x64_bf16 v[32:35], v[88:91], v[64:71], v26
    v_max_f32_dpp v27, v27, v27 quad_perm:[2,3,0,1] row_mask:0xf bank_mask:0xf
    v_smfmac_f32_16x16x64_bf16 v[28:31], v[92:95], v[48:55], v26
    v_smfmac_f32_16x16x64_bf16 v[32:35], v[92:95], v[72:79], v26
    v_max_f32_dpp v27, v27, v27 row_ror:4 row_mask:0xf bank_mask:0xf
    v_sub_f32 v24, v24, v27
    v_exp_f32 v24, v24
    v_smfmac_f32_16x16x64_bf16 v[28:31], v[96:99], v[56:63], v26
    v_smfmac_f32_16x16x64_bf16 v[32:35], v[96:99], v[80:87], v26
    v_mul_f32 v36, v24, v25
    s_cmp_lg_u32 s72, 0
    s_nop 0
    v_add_f32_dpp v36, v36, v36 quad_perm:[1,0,3,2] row_mask:0xf bank_mask:0xf
    s_nop 1
    v_add_f32_dpp v36, v36, v36 quad_perm:[2,3,0,1] row_mask:0xf bank_mask:0xf
    v_mul_f32_dpp v28, v24, v28 row_newbcast:0 row_mask:0xf bank_mask:0xf
    v_mul_f32_dpp v30, v24, v30 row_newbcast:2 row_mask:0xf bank_mask:0xf
    v_add_f32_dpp v36, v36, v36 row_ror:4 row_mask:0xf bank_mask:0xf
    v_mul_f32_dpp v32, v24, v32 row_newbcast:0 row_mask:0xf bank_mask:0xf
    v_mul_f32_dpp v34, v24, v34 row_newbcast:2 row_mask:0xf bank_mask:0xf
    v_rcp_f32 v36, v36
    v_fmac_f32_dpp v28, v24, v29 row_newbcast:1 row_mask:0xf bank_mask:0xf
    v_fmac_f32_dpp v30, v24, v31 row_newbcast:3 row_mask:0xf bank_mask:0xf
    v_fmac_f32_dpp v32, v24, v33 row_newbcast:1 row_mask:0xf bank_mask:0xf
    v_fmac_f32_dpp v34, v24, v35 row_newbcast:3 row_mask:0xf bank_mask:0xf
    v_add_f32 v28, v28, v30
    v_add_f32 v32, v32, v34
    s_nop 1
    v_permlane16_swap_b32 v28, v32
    v_add_f32 v37, v28, v32
    v_add_f32 v28, v28, v32
    s_nop 1
    v_permlane32_swap_b32 v28, v37
    v_add_f32 v28, v28, v37
    v_mul_f32 v28, v28, v36
    ds_write_b32 v5, v28
    s_waitcnt lgkmcnt(0)
    s_barrier
    s_cbranch_scc1 WNOT0
    ds_read2st64_b32 v[28:29], v6 offset0:0 offset1:1
    ds_read2st64_b32 v[30:31], v6 offset0:2 offset1:3
    s_waitcnt lgkmcnt(1)
    v_add_f32 v28, v28, v29
    s_waitcnt lgkmcnt(0)
    v_add_f32 v30, v30, v31
    v_add_f32 v28, v28, v30
    s_nop 1
    v_mov_b32_dpp v29, v28 row_shl:1 row_mask:0xf bank_mask:0xf
    v_cvt_pk_bf16_f32 v32, v28, v29
    s_nop 1
    v_mov_b32_dpp v28, v32 quad_perm:[0,0,0,0] row_mask:0xf bank_mask:0xf
    v_mov_b32_dpp v29, v32 quad_perm:[2,2,2,2] row_mask:0xf bank_mask:0xf
    s_nop 0
    v_mov_b32_dpp v30, v28 row_shl:4 row_mask:0xf bank_mask:0xf
    v_mov_b32_dpp v31, v29 row_shl:4 row_mask:0xf bank_mask:0xf
    s_mov_b64 exec, s[46:47]
    buffer_store_dwordx4 v[28:31], v18, s[16:19], s80 offen sc1
    s_mov_b64 exec, s[92:93]
    buffer_store_dwordx4 v[28:31], v18, s[8:11], s81 offen
    s_cmp_eq_u32 s10, 0
    s_cbranch_scc1 SLOW11
BACK11:
    s_mov_b64 exec, -1
    v_add_u32 v111, 49152, v2
    s_cmp_lg_u32 s74, 0
    s_cbranch_scc1 W2OK
    v_lshrrev_b32 v38, 2, v0
    v_mul_u32_u24 v38, 1280, v38
    v_and_b32 v39, 3, v0
    v_lshl_add_u32 v39, v39, 4, v38
    s_mul_i32 s77, s68, 245760
    s_lshl_b32 s78, s69, 6
    s_add_u32 s77, s77, s78
    s_mov_b32 m0, 106496
    s_nop 0
    buffer_load_dwordx4 v39, s[32:35], s77 offen lds
    s_add_u32 s77, s77, 20480
    s_mov_b32 m0, 107520
    s_nop 0
    buffer_load_dwordx4 v39, s[32:35], s77 offen lds
    s_add_u32 s77, s77, 20480
    s_mov_b32 m0, 108544
    s_nop 0
    buffer_load_dwordx4 v39, s[32:35], s77 offen lds
    s_add_u32 s77, s77, 20480
    s_mov_b32 m0, 109568
    s_nop 0
    buffer_load_dwordx4 v39, s[32:35], s77 offen lds
    s_add_u32 s77, s77, 20480
    s_mov_b32 m0, 110592
    s_nop 0
    buffer_load_dwordx4 v39, s[32:35], s77 offen lds
    s_add_u32 s77, s77, 20480
    s_mov_b32 m0, 111616
    s_nop 0
    buffer_load_dwordx4 v39, s[32:35], s77 offen lds
    s_add_u32 s77, s77, 20480
    s_mov_b32 m0, 112640
    s_nop 0
    buffer_load_dwordx4 v39, s[32:35], s77 offen lds
    s_add_u32 s77, s77, 20480
    s_mov_b32 m0, 113664
    s_nop 0
    buffer_load_dwordx4 v39, s[32:35], s77 offen lds
    s_add_u32 s77, s77, 20480
    s_mov_b32 m0, 114688
    s_nop 0
    buffer_load_dwordx4 v39, s[32:35], s77 offen lds
    s_add_u32 s77, s77, 20480
    s_mov_b32 m0, 115712
    s_nop 0
    buffer_load_dwordx4 v39, s[32:35], s77 offen lds
    s_add_u32 s77, s77, 20480
    s_mov_b32 m0, 116736
    s_nop 0
    buffer_load_dwordx4 v39, s[32:35], s77 offen lds
    s_add_u32 s77, s77, 20480
    s_mov_b32 m0, 117760
    s_nop 0
    buffer_load_dwordx4 v39, s[32:35], s77 offen lds
    s_add_u32 s77, s77, 20480
    s_branch W2X
W2OK:
    ds_read_b64_tr_b16 v[40:41], v111 offset:0
    ds_read_b64_tr_b16 v[42:43], v111 offset:256
    ds_read_b64_tr_b16 v[64:65], v111 offset:32
    ds_read_b64_tr_b16 v[66:67], v111 offset:288
    ds_read_b64_tr_b16 v[44:45], v111 offset:2048
    ds_read_b64_tr_b16 v[46:47], v111 offset:2304
    ds_read_b64_tr_b16 v[68:69], v111 offset:2080
    ds_read_b64_tr_b16 v[70:71], v111 offset:2336
    ds_read_b64_tr_b16 v[48:49], v111 offset:4096
    ds_read_b64_tr_b16 v[50:51], v111 offset:4352
    ds_read_b64_tr_b16 v[72:73], v111 offset:4128
    ds_read_b64_tr_b16 v[74:75], v111 offset:4384
    ds_read_b64_tr_b16 v[52:53], v111 offset:6144
    ds_read_b64_tr_b16 v[54:55], v111 offset:6400
    ds_read_b64_tr_b16 v[76:77], v111 offset:6176
    ds_read_b64_tr_b16 v[78:79], v111 offset:6432
    ds_read_b64_tr_b16 v[56:57], v111 offset:8192
    ds_read_b64_tr_b16 v[58:59], v111 offset:8448
    ds_read_b64_tr_b16 v[80:81], v111 offset:8224
    ds_read_b64_tr_b16 v[82:83], v111 offset:8480
    ds_read_b64_tr_b16 v[60:61], v111 offset:10240
    ds_read_b64_tr_b16 v[62:63], v111 offset:10496
    ds_read_b64_tr_b16 v[84:85], v111 offset:10272
    ds_read_b64_tr_b16 v[86:87], v111 offset:10528
W2X:
    v_mov_b32 v100, 0
    v_mov_b32 v101, 0
    v_mov_b32 v104, 0
    v_mov_b32 v105, 0
    s_add_u32 s96, s80, 81920
    s_add_u32 s97, s81, 1280
STB:
    s_mul_i32 s77, s72, 48
    v_min_u32 v6, 47, v0
    v_add_u32 v6, s77, v6
    v_lshlrev_b32 v4, 4, v6
    v_add_u32 v108, 7168, v4
    v_lshlrev_b32 v4, 3, v6
    v_cmp_le_u32 vcc, 48, v0
    v_mov_b32 v24, 1536
    s_nop 0
    v_cndmask_b32 v4, v4, v24, vcc
    v_add_u32 v5, 3584, v4
    v_lshrrev_b32 v24, 4, v6
    v_lshlrev_b32 v24, 5, v24
    v_bfe_u32 v25, v6, 1, 1
    v_lshl_add_u32 v24, v25, 4, v24
    v_bfe_u32 v25, v6, 2, 2
    v_lshl_add_u32 v24, v25, 2, v24
    v_and_b32 v25, 1, v6
    v_lshl_add_u32 v24, v25, 1, v24
    v_add_u32 v24, 118784, v24
    v_mov_b32 v25, 119168
    v_cndmask_b32 v6, v24, v25, vcc
    v_mov_b32 v109, 0x3727c5ac
    v_mov_b32 v110, 0x3acccccd
    s_add_u32 s79, s3, 50432
    v_accvgpr_read_b32 v2, a250
    v_accvgpr_read_b32 v3, a251
    s_add_u32 s6, s74, s72
    s_mov_b32 s76, 1
    s_cmp_eq_u32 s74, 0
    s_cbranch_scc1 GPF
GPO:
    s_cmp_eq_u32 s72, 1
    s_cbranch_scc1 WOWN
GP1:
    buffer_load_dwordx2 v[32:33], v4, s[16:19], s79 offen offset:0 sc1
    buffer_load_dwordx2 v[34:35], v4, s[16:19], s79 offen offset:1792 sc1
    buffer_load_dwordx2 v[36:37], v5, s[16:19], s79 offen offset:0 sc1
    buffer_load_dwordx2 v[38:39], v5, s[16:19], s79 offen offset:1792 sc1
    s_waitcnt vmcnt(0)
    v_add_f32 v24, v32, v34
    v_add_f32 v28, v33, v35
    v_add_f32 v26, v36, v38
    v_add_f32 v30, v37, v39
    v_add_f32 v28, v28, v30
    v_add_f32 v24, v24, v26
    v_cmp_u_f32 vcc, v24, v28
    s_cbranch_vccnz GA1
GPX:
    v_readlane_b32 s77, v28, 48
    v_readlane_b32 s78, v24, 48
    s_cmp_lg_u32 s6, 1
    s_cbranch_scc0 OWL
OWB:
    v_mul_f32 v25, s77, v110
    v_fma_f32 v26, s78, v110, v109
    v_fma_f32 v26, -v25, v25, v26
    v_add_f32 v25, 1.0, v25
    v_max_f32 v26, v26, v109
    v_fma_f32 v24, -v25, v2, v24
    v_rsq_f32 v27, v26
    v_mul_f32 v29, 0xbfb8aa3b, v24
    v_mul_f32 v29, v29, v27
    v_exp_f32 v29, v29
    v_fma_f32 v28, -v25, v3, v28
    v_fma_f32 v29, v29, v26, v26
    v_rcp_f32 v29, v29
    v_mul_f32 v28, v28, v24
    v_mul_f32 v28, v28, v29
    v_cvt_pk_bf16_f32 v28, v28, v28
    ds_write_b16 v6, v28
    v_accvgpr_write_b32 a250, v2
    v_accvgpr_write_b32 a251, v3
    s_cmp_lg_u32 s72, 0
    s_waitcnt lgkmcnt(0)
    s_barrier
    s_cbranch_scc1 STBX
    ds_read_b128 v[88:91], v13 offset:0
    ds_read_b128 v[92:95], v13 offset:128
    ds_read_b128 v[96:99], v13 offset:256
    s_waitcnt lgkmcnt(2)
    v_smfmac_f32_16x16x64_bf16 v[100:103], v[88:91], v[40:47], v14
    v_smfmac_f32_16x16x64_bf16 v[104:107], v[88:91], v[64:71], v14
    s_waitcnt lgkmcnt(1)
    v_smfmac_f32_16x16x64_bf16 v[100:103], v[92:95], v[48:55], v14
    v_smfmac_f32_16x16x64_bf16 v[104:107], v[92:95], v[72:79], v14
    s_waitcnt lgkmcnt(0)
    v_smfmac_f32_16x16x64_bf16 v[100:103], v[96:99], v[56:63], v14
    v_smfmac_f32_16x16x64_bf16 v[104:107], v[96:99], v[80:87], v14
    s_nop 6
    v_add_f32 v28, v100, v101
    s_nop 1
    v_add_f32_dpp v28, v104, v105 quad_perm:[0,1,2,3] row_mask:0xa bank_mask:0xf
    s_nop 1
    v_mov_b32_dpp v29, v28 row_shl:1 row_mask:0xf bank_mask:0xf
    v_cvt_pk_bf16_f32 v32, v28, v29
    s_nop 1
    v_mov_b32_dpp v28, v32 quad_perm:[0,0,0,0] row_mask:0xf bank_mask:0xf
    v_mov_b32_dpp v29, v32 quad_perm:[2,2,2,2] row_mask:0xf bank_mask:0xf
    s_nop 0
    v_mov_b32_dpp v30, v28 row_shl:4 row_mask:0xf bank_mask:0xf
    v_mov_b32_dpp v31, v29 row_shl:4 row_mask:0xf bank_mask:0xf
    s_mov_b64 exec, s[48:49]
    buffer_store_dwordx4 v[28:31], v18, s[16:19], s96 offen sc1
    s_mov_b64 exec, s[92:93]
    buffer_store_dwordx4 v[28:31], v18, s[8:11], s97 offen
    s_cmp_eq_u32 s10, 0
    s_cbranch_scc1 SLOW12
BACK12:
    s_mov_b64 exec, -1
    s_branch NEXT
AGAIN3:
    s_add_u32 s76, s76, 1
    s_cmp_lt_u32 s76, 32768
    s_cbranch_scc1 POLL3
    s_branch POLLX3
BR4:
    s_cmp_ge_u32 s76, 32768
    s_cbranch_scc1 BX4
    s_mov_b64 exec, vcc
    buffer_load_dwordx4 v[80:83], v8, s[16:19], 0 offen sc1
    s_add_u32 s76, s76, 1
    s_waitcnt vmcnt(0)
    s_branch BW4
AGAIN6:
    s_add_u32 s76, s76, 1
    s_cmp_lt_u32 s76, 32768
    s_cbranch_scc1 POLL6
    s_branch POLLX6
OML:
    v_mul_f32 v35, v32, v33
    s_nop 1
    v_add_f32_dpp v35, v35, v35 quad_perm:[1,0,3,2] row_mask:0xf bank_mask:0xf
    s_nop 1
    v_add_f32_dpp v35, v35, v35 quad_perm:[2,3,0,1] row_mask:0xf bank_mask:0xf
    s_mov_b64 exec, 1
    buffer_store_dwordx2 v[34:35], v1, s[8:11], s78 offen
    s_cmp_eq_u32 s10, 0
    s_cbranch_scc1 SLOW13
BACK13:
    s_mov_b64 exec, -1
    s_waitcnt lgkmcnt(0)
    s_branch ODONE
WLATE:
    v_lshrrev_b32 v38, 2, v0
    v_mul_u32_u24 v38, 1280, v38
    v_and_b32 v39, 3, v0
    v_lshl_add_u32 v39, v39, 4, v38
    s_mov_b32 m0, s67
    s_add_u32 s67, s67, 1024
    buffer_load_dwordx4 v39, s[24:27], s66 offen  lds
    s_add_u32 s66, s66, 20480
    s_mov_b32 m0, s67
    s_add_u32 s67, s67, 1024
    buffer_load_dwordx4 v39, s[24:27], s66 offen  lds
    s_add_u32 s66, s66, 20480
    s_mov_b32 m0, s67
    s_add_u32 s67, s67, 1024
    buffer_load_dwordx4 v39, s[24:27], s66 offen  lds
    s_add_u32 s66, s66, 20480
    s_mov_b32 m0, s67
    s_add_u32 s67, s67, 1024
    buffer_load_dwordx4 v39, s[24:27], s66 offen  lds
    s_add_u32 s66, s66, 20480
    s_mov_b32 m0, s67
    s_add_u32 s67, s67, 1024
    buffer_load_dwordx4 v39, s[24:27], s66 offen  lds
    s_add_u32 s66, s66, 20480
    s_mov_b32 m0, s67
    s_add_u32 s67, s67, 1024
    buffer_load_dwordx4 v39, s[24:27], s66 offen  lds
    s_add_u32 s66, s66, 20480
    v_accvgpr_read_b32 v2, a246
    v_accvgpr_read_b32 v3, a247
    v_accvgpr_read_b32 v4, a248
    buffer_load_dwordx2 v[24:25], v4, s[16:19], s3 offen sc1
    buffer_load_dwordx4 v[88:91], v3, s[16:19], s3 offen offset:0 sc1
    buffer_load_dwordx4 v[92:95], v3, s[16:19], s3 offen offset:1024 sc1
    buffer_load_dwordx4 v[96:99], v3, s[16:19], s3 offen offset:2048 sc1
    s_add_u32 s77, s3, 1638400
    buffer_store_dword v7, v10, s[8:11], s77 offen
    s_cmp_eq_u32 s10, 0
    s_cbranch_scc1 SLOW14
BACK14:
    v_accvgpr_read_b32 v5, a249
    v_and_b32 v18, 3, v0
    v_lshrrev_b32 v6, 5, v0
    v_lshl_add_u32 v18, v6, 2, v18
    v_mul_u32_u24 v18, 10240, v18
    v_bfe_u32 v6, v0, 3, 2
    v_lshl_add_u32 v18, v6, 4, v18
    v_and_b32 v6, 0xffffff7f, v5
    v_bfe_u32 v26, v0, 3, 1
    v_mul_u32_u24 v26, 0xaaaa, v26
    v_add_u32 v26, 0x4444, v26
    v_mov_b32 v28, 0
    v_mov_b32 v29, 0
    v_mov_b32 v30, 0
    v_mov_b32 v31, 0
    v_mov_b32 v32, 0
    v_mov_b32 v33, 0
    v_mov_b32 v34, 0
    v_mov_b32 v35, 0
    s_waitcnt vmcnt(11)
    ds_read_b64_tr_b16 v[40:41], v2 offset:0
    ds_read_b64_tr_b16 v[42:43], v2 offset:256
    ds_read_b64_tr_b16 v[64:65], v2 offset:32
    ds_read_b64_tr_b16 v[66:67], v2 offset:288
    ds_read_b64_tr_b16 v[44:45], v2 offset:2048
    ds_read_b64_tr_b16 v[46:47], v2 offset:2304
    ds_read_b64_tr_b16 v[68:69], v2 offset:2080
    ds_read_b64_tr_b16 v[70:71], v2 offset:2336
    ds_read_b64_tr_b16 v[48:49], v2 offset:4096
    ds_read_b64_tr_b16 v[50:51], v2 offset:4352
    ds_read_b64_tr_b16 v[72:73], v2 offset:4128
    ds_read_b64_tr_b16 v[74:75], v2 offset:4384
    s_waitcnt vmcnt(5)
    ds_read_b64_tr_b16 v[52:53], v2 offset:6144
    ds_read_b64_tr_b16 v[54:55], v2 offset:6400
    ds_read_b64_tr_b16 v[76:77], v2 offset:6176
    ds_read_b64_tr_b16 v[78:79], v2 offset:6432
    ds_read_b64_tr_b16 v[56:57], v2 offset:8192
    ds_read_b64_tr_b16 v[58:59], v2 offset:8448
    ds_read_b64_tr_b16 v[80:81], v2 offset:8224
    ds_read_b64_tr_b16 v[82:83], v2 offset:8480
    ds_read_b64_tr_b16 v[60:61], v2 offset:10240
    ds_read_b64_tr_b16 v[62:63], v2 offset:10496
    ds_read_b64_tr_b16 v[84:85], v2 offset:10272
    ds_read_b64_tr_b16 v[86:87], v2 offset:10528
    s_branch WCHK
AGAIN10:
    s_mov_b64 s[94:95], exec
    s_mov_b32 s76, 1
AG210:
    s_mov_b64 exec, vcc
    buffer_load_dwordx2 v[24:25], v4, s[16:19], s3 offen sc1
    buffer_load_dwordx4 v[88:91], v3, s[16:19], s3 offen offset:0 sc1
    buffer_load_dwordx4 v[92:95], v3, s[16:19], s3 offen offset:1024 sc1
    buffer_load_dwordx4 v[96:99], v3, s[16:19], s3 offen offset:2048 sc1
AG310_0:
    s_mov_b64 exec, s[94:95]
    s_add_u32 s76, s76, 1
    s_cmp_ge_u32 s76, 32768
    s_waitcnt vmcnt(0)
    v_max3_u32 v38, v88, v92, v96
    v_max_u32 v38, v38, v25
    v_cmp_eq_u32 vcc, -1, v38
    s_cbranch_vccz POLLX10
    s_cbranch_scc0 AG210
    s_branch POLLX10
GA1:
    s_add_u32 s76, s76, 1
    s_cmp_lt_u32 s76, 32768
    s_cbranch_scc1 GP1
    s_branch GPX
GPF:
    s_cmp_lg_u32 s72, 0
    s_cbranch_scc1 GP0
    buffer_load_dwordx4 v[32:35], v108, s[16:19], s79 offen sc1
    buffer_load_dwordx4 v[36:39], v108, s[16:19], s79 offen offset:3072 sc1
    s_waitcnt vmcnt(2)
    ds_read_b64_tr_b16 v[40:41], v111 offset:0
    ds_read_b64_tr_b16 v[42:43], v111 offset:256
    ds_read_b64_tr_b16 v[64:65], v111 offset:32
    ds_read_b64_tr_b16 v[66:67], v111 offset:288
    ds_read_b64_tr_b16 v[44:45], v111 offset:2048
    ds_read_b64_tr_b16 v[46:47], v111 offset:2304
    ds_read_b64_tr_b16 v[68:69], v111 offset:2080
    ds_read_b64_tr_b16 v[70:71], v111 offset:2336
    ds_read_b64_tr_b16 v[48:49], v111 offset:4096
    ds_read_b64_tr_b16 v[50:51], v111 offset:4352
    ds_read_b64_tr_b16 v[72:73], v111 offset:4128
    ds_read_b64_tr_b16 v[74:75], v111 offset:4384
    ds_read_b64_tr_b16 v[52:53], v111 offset:6144
    ds_read_b64_tr_b16 v[54:55], v111 offset:6400
    ds_read_b64_tr_b16 v[76:77], v111 offset:6176
    ds_read_b64_tr_b16 v[78:79], v111 offset:6432
    ds_read_b64_tr_b16 v[56:57], v111 offset:8192
    ds_read_b64_tr_b16 v[58:59], v111 offset:8448
    ds_read_b64_tr_b16 v[80:81], v111 offset:8224
    ds_read_b64_tr_b16 v[82:83], v111 offset:8480
    ds_read_b64_tr_b16 v[60:61], v111 offset:10240
    ds_read_b64_tr_b16 v[62:63], v111 offset:10496
    ds_read_b64_tr_b16 v[84:85], v111 offset:10272
    ds_read_b64_tr_b16 v[86:87], v111 offset:10528
    s_branch GPW
GP0:
    buffer_load_dwordx4 v[32:35], v108, s[16:19], s79 offen sc1
    buffer_load_dwordx4 v[36:39], v108, s[16:19], s79 offen offset:3072 sc1
GPW:
    s_add_u32 s76, s76, 1
    s_cmp_ge_u32 s76, 32768
    s_waitcnt vmcnt(0)
    v_add_f32 v2, v32, v33
    v_add_f32 v3, v36, v37
    v_add_f32 v34, v34, v35
    v_add_f32 v38, v38, v39
    v_add_f32 v2, v2, v34
    v_add_f32 v3, v3, v38
    v_cmp_u_f32 vcc, v2, v3
    s_cbranch_scc1 GPO
    s_cbranch_vccnz GP0
    s_branch GPO
OWL:
    buffer_load_dword v34, v100, s[16:19], 0 offen sc1
    buffer_load_dword v35, v101, s[16:19], 0 offen sc1
    s_branch OWB
WNOT0:
    s_cmp_lg_u32 s74, 0
    s_cbranch_scc1 STB
    s_cmp_eq_u32 s72, 1
    s_cbranch_scc1 WPREP
    s_cmp_eq_u32 s72, 3
    s_cbranch_scc1 WLC
    v_mov_b32 v52, -1
    v_mov_b32 v53, -1
    v_mov_b32 v54, -1
    v_mov_b32 v55, -1
    s_add_u32 s77, s80, 819200
    s_add_u32 s7, s77, 81920
    s_sleep 8
    s_mov_b64 exec, s[44:45]
    buffer_store_dwordx4 v[52:55], v18, s[16:19], s77 offen sc1
    s_mov_b64 exec, s[92:93]
    buffer_store_dwordx4 v[52:55], v18, s[16:19], s7 offen sc1
    s_mov_b64 exec, -1
    s_branch WPREP
WLC:
    s_mul_i32 s77, s69, 1248
    s_add_u32 s78, s3, 851968
    v_add_u32 v100, s77, v1
    v_min_u32 v100, 24816, v100
    s_add_u32 s77, s77, 1024
    v_add_u32 v101, s77, v1
    v_min_u32 v101, 24816, v101
    s_add_u32 s77, s77, 1024
    v_mov_b32 v104, -1
    v_mov_b32 v105, -1
    v_mov_b32 v106, -1
    v_mov_b32 v107, -1
    ds_read_b64_tr_b16 v[40:41], v16 offset:0
    ds_read_b64_tr_b16 v[42:43], v16 offset:1536
    ds_read_b64_tr_b16 v[44:45], v16 offset:12288
    ds_read_b64_tr_b16 v[46:47], v16 offset:13824
    ds_read_b64_tr_b16 v[48:49], v17 offset:24576
    ds_read_b64_tr_b16 v[50:51], v16 offset:32
    ds_read_b64_tr_b16 v[52:53], v16 offset:1568
    ds_read_b64_tr_b16 v[54:55], v16 offset:12320
    ds_read_b64_tr_b16 v[56:57], v16 offset:13856
    ds_read_b64_tr_b16 v[58:59], v17 offset:24608
    ds_read_b64_tr_b16 v[60:61], v16 offset:64
    ds_read_b64_tr_b16 v[62:63], v16 offset:1600
    ds_read_b64_tr_b16 v[64:65], v16 offset:12352
    ds_read_b64_tr_b16 v[66:67], v16 offset:13888
    ds_read_b64_tr_b16 v[68:69], v17 offset:24640
    v_and_b32 v25, 15, v0
    v_cmp_eq_u32 vcc, 12, v25
    v_mov_b32 v36, 0x3f803f80
    s_nop 0
    v_cndmask_b32 v70, 0, v36, vcc
    v_mov_b32 v71, v70
    v_mov_b32 v72, v70
    v_mov_b32 v73, v70
    v_mov_b32 v74, v70
    v_mov_b32 v75, v70
    v_mov_b32 v76, v70
    v_mov_b32 v77, v70
    v_mov_b32 v78, v70
    v_mov_b32 v79, v70
    s_mov_b32 s77, 4096
    v_mul_u32_u24 v96, 103, v0
    v_lshrrev_b32 v96, 10, v96
    v_lshl_add_u32 v96, v96, 4, v1
    v_add_u32 v96, s77, v96
    v_mul_u32_u24 v97, 176, v25
    v_add_u32 v97, s77, v97
    v_lshrrev_b32 v28, 4, v0
    v_lshl_add_u32 v98, v28, 3, v97
    v_lshl_add_u32 v97, v28, 4, v97
    buffer_store_dwordx4 v[104:107], v100, s[8:11], s78 offen
    s_cmp_eq_u32 s10, 0
    s_cbranch_scc1 SLOW15
BACK15:
    buffer_store_dwordx4 v[104:107], v101, s[8:11], s78 offen
    s_cmp_eq_u32 s10, 0
    s_cbranch_scc1 SLOW16
BACK16:
    s_branch STB
WPREP:
    s_nop 1
    ds_read_b64_tr_b16 v[40:41], v16 offset:0
    ds_read_b64_tr_b16 v[42:43], v16 offset:1536
    ds_read_b64_tr_b16 v[44:45], v16 offset:12288
    ds_read_b64_tr_b16 v[46:47], v16 offset:13824
    ds_read_b64_tr_b16 v[48:49], v17 offset:24576
    ds_read_b64_tr_b16 v[50:51], v16 offset:32
    ds_read_b64_tr_b16 v[52:53], v16 offset:1568
    ds_read_b64_tr_b16 v[54:55], v16 offset:12320
    ds_read_b64_tr_b16 v[56:57], v16 offset:13856
    ds_read_b64_tr_b16 v[58:59], v17 offset:24608
    ds_read_b64_tr_b16 v[60:61], v16 offset:64
    ds_read_b64_tr_b16 v[62:63], v16 offset:1600
    ds_read_b64_tr_b16 v[64:65], v16 offset:12352
    ds_read_b64_tr_b16 v[66:67], v16 offset:13888
    ds_read_b64_tr_b16 v[68:69], v17 offset:24640
    v_and_b32 v25, 15, v0
    v_cmp_eq_u32 vcc, 12, v25
    v_mov_b32 v36, 0x3f803f80
    s_nop 0
    v_cndmask_b32 v70, 0, v36, vcc
    v_mov_b32 v71, v70
    v_mov_b32 v72, v70
    v_mov_b32 v73, v70
    v_mov_b32 v74, v70
    v_mov_b32 v75, v70
    v_mov_b32 v76, v70
    v_mov_b32 v77, v70
    v_mov_b32 v78, v70
    v_mov_b32 v79, v70
    s_mov_b32 s77, 4096
    v_mul_u32_u24 v96, 103, v0
    v_lshrrev_b32 v96, 10, v96
    v_lshl_add_u32 v96, v96, 4, v1
    v_add_u32 v96, s77, v96
    v_mul_u32_u24 v97, 176, v25
    v_add_u32 v97, s77, v97
    v_lshrrev_b32 v28, 4, v0
    v_lshl_add_u32 v98, v28, 3, v97
    v_lshl_add_u32 v97, v28, 4, v97
    s_branch STB
WOWN:
    v_and_b32 v25, 15, v0
    v_lshrrev_b32 v26, 4, v0
    s_mul_i32 s7, s68, 10240
    s_cmp_eq_u32 s74, 0
    s_cselect_b32 s7, 0, s7
    s_add_u32 s7, s7, 655360
    v_mul_u32_u24 v37, 1280, v26
    v_add_u32 v37, s7, v37
    s_mul_i32 s7, s68, 81920
    s_add_u32 s7, s7, 45312
    v_mov_b32 v38, s7
    v_cmp_eq_u32 vcc, s68, v26
    s_nop 1
    v_cndmask_b32 v37, v37, v38, vcc
    v_add_u32 v39, 4, v26
    s_mul_i32 s7, s68, 10240
    s_cmp_eq_u32 s74, 0
    s_cselect_b32 s7, 0, s7
    s_add_u32 s7, s7, 655360
    v_mul_u32_u24 v38, 1280, v39
    v_add_u32 v38, s7, v38
    s_mul_i32 s7, s68, 81920
    s_add_u32 s7, s7, 45312
    v_mov_b32 v28, s7
    v_cmp_eq_u32 vcc, s68, v39
    s_nop 1
    v_cndmask_b32 v38, v38, v28, vcc
    s_lshl_b32 s77, s69, 6
    s_add_u32 s77, s77, s74
    v_lshl_add_u32 v25, v25, 2, s77
    v_add_u32 v100, v25, v37
    v_add_u32 v101, v25, v38
    s_cmp_eq_u32 s74, 0
    s_cbranch_scc1 GP1
    s_sleep 9
    s_mov_b32 s76, 1
POLL17:
    buffer_load_dword v28, v100, s[16:19], 0 offen sc1
    buffer_load_dword v29, v101, s[16:19], 0 offen sc1
POLLW17:
    s_waitcnt vmcnt(0)
    v_max_u32 v30, v28, v29
    v_cmp_eq_u32 vcc, -1, v30
    s_cbranch_vccnz AGAIN17
POLLX17:
    v_lshlrev_b32 v30, 16, v28
    v_and_b32 v28, 0xffff0000, v28
    v_lshlrev_b32 v31, 16, v29
    v_and_b32 v29, 0xffff0000, v29
    v_add_f32 v30, v30, v31
    v_add_f32 v28, v28, v29
    v_mov_b32 v31, v30
    v_mov_b32 v29, v28
    s_nop 0
    v_permlane32_swap_b32 v30, v31
    v_permlane32_swap_b32 v28, v29
    v_add_f32 v30, v30, v31
    v_add_f32 v28, v28, v29
    v_mov_b32 v31, v30
    v_mov_b32 v29, v28
    s_nop 0
    v_permlane16_swap_b32 v30, v31
    v_permlane16_swap_b32 v28, v29
    v_add_f32 v30, v30, v31
    v_add_f32 v28, v28, v29
    v_add_f32 v22, v22, v30
    v_add_f32 v23, v23, v28
    v_cvt_pk_bf16_f32 v28, v22, v23
    s_branch GP1
STBX:
    s_cmp_lg_u32 s72, 1
    s_cbranch_scc1 NEXT
    s_cmp_lg_u32 s74, 0
    s_cbranch_scc1 FINAL
    s_waitcnt vmcnt(0)
    v_mov_b32 v28, v34
    v_mov_b32 v29, v35
    v_max_u32 v30, v28, v29
    v_cmp_eq_u32 vcc, -1, v30
    s_cbranch_vccnz RETRY18
OK18:
    v_lshlrev_b32 v30, 16, v28
    v_and_b32 v28, 0xffff0000, v28
    v_lshlrev_b32 v31, 16, v29
    v_and_b32 v29, 0xffff0000, v29
    v_add_f32 v30, v30, v31
    v_add_f32 v28, v28, v29
    v_mov_b32 v31, v30
    v_mov_b32 v29, v28
    s_nop 0
    v_permlane32_swap_b32 v30, v31
    v_permlane32_swap_b32 v28, v29
    v_add_f32 v30, v30, v31
    v_add_f32 v28, v28, v29
    v_mov_b32 v31, v30
    v_mov_b32 v29, v28
    s_nop 0
    v_permlane16_swap_b32 v30, v31
    v_permlane16_swap_b32 v28, v29
    v_add_f32 v30, v30, v31
    v_add_f32 v28, v28, v29
    v_add_f32 v22, v22, v30
    v_add_f32 v23, v23, v28
    v_cvt_pk_bf16_f32 v28, v22, v23
    s_lshl_b32 s77, s69, 6
    s_add_u32 s77, s77, s3
    s_add_u32 s77, s77, 49152
    v_lshlrev_b32 v32, 2, v0
    v_mov_b32_dpp v29, v28 quad_perm:[1,1,1,1] row_mask:0xf bank_mask:0xf
    v_mov_b32_dpp v30, v28 quad_perm:[2,2,2,2] row_mask:0xf bank_mask:0xf
    v_mov_b32_dpp v31, v28 quad_perm:[3,3,3,3] row_mask:0xf bank_mask:0xf
    s_mov_b32 exec_lo, 0x1111
    s_mov_b32 exec_hi, 0x0
    buffer_store_dwordx4 v[28:31], v32, s[8:11], s77 offen
    s_cmp_eq_u32 s10, 0
    s_cbranch_scc1 SLOW19
BACK19:
    s_mov_b64 exec, -1
    s_branch NEXT
FINAL:
    s_cmp_lg_u32 s68, 0
    s_cbranch_scc1 DONE
    s_lshl_b32 s77, s69, 6
    v_lshlrev_b32 v37, 2, v0
    s_add_u32 s79, s77, s3
    s_add_u32 s79, s79, 46592
    s_mov_b64 exec, 15
    s_mov_b32 s76, 1
POLL20:
    buffer_load_dword v28, v1, s[16:19], s79 offen sc1
POLLW20:
    s_waitcnt vmcnt(0)
    v_cmp_eq_u32 vcc, -1, v28
    s_cbranch_vccnz AGAIN20
POLLX20:
    s_mov_b64 exec, -1
    s_mov_b32 s76, 1
POLL21:
    buffer_load_dword v28, v20, s[16:19], s74 offen sc1
    buffer_load_dword v29, v21, s[16:19], s74 offen sc1
POLLW21:
    s_waitcnt vmcnt(0)
    v_max_u32 v30, v28, v29
    v_cmp_eq_u32 vcc, -1, v30
    s_cbranch_vccnz AGAIN21
POLLX21:
    v_lshlrev_b32 v30, 16, v28
    v_and_b32 v28, 0xffff0000, v28
    v_lshlrev_b32 v31, 16, v29
    v_and_b32 v29, 0xffff0000, v29
    v_add_f32 v30, v30, v31
    v_add_f32 v28, v28, v29
    v_mov_b32 v31, v30
    v_mov_b32 v29, v28
    s_nop 0
    v_permlane32_swap_b32 v30, v31
    v_permlane32_swap_b32 v28, v29
    v_add_f32 v30, v30, v31
    v_add_f32 v28, v28, v29
    v_mov_b32 v31, v30
    v_mov_b32 v29, v28
    s_nop 0
    v_permlane16_swap_b32 v30, v31
    v_permlane16_swap_b32 v28, v29
    v_add_f32 v30, v30, v31
    v_add_f32 v28, v28, v29
    v_add_f32 v22, v22, v30
    v_add_f32 v23, v23, v28
    v_cvt_pk_bf16_f32 v28, v22, v23
    s_mov_b32 exec_lo, 0xffff
    s_mov_b32 exec_hi, 0x0
    buffer_store_dword v28, v37, s[40:43], s77 offen
    s_mov_b64 exec, -1
    s_endpgm
AGAIN17:
    s_sleep 2
    s_add_u32 s76, s76, 1
    s_cmp_lt_u32 s76, 32768
    s_cbranch_scc1 POLL17
    s_branch POLLX17
AGAIN20:
    s_add_u32 s76, s76, 1
    s_cmp_lt_u32 s76, 32768
    s_cbranch_scc1 POLL20
    s_branch POLLX20
AGAIN21:
    s_add_u32 s76, s76, 1
    s_cmp_lt_u32 s76, 32768
    s_cbranch_scc1 POLL21
    s_branch POLLX21
ROLEF:
    v_and_b32 v25, 15, v0
    v_lshrrev_b32 v26, 4, v0
    v_bfe_u32 v27, v0, 2, 2
    v_and_b32 v36, 3, v0
    s_cmp_lg_u32 s74, 0
    s_cbranch_scc1 FW
    s_sub_u32 s96, s69, 20
    s_lshl_b32 s96, s96, 2
    s_add_u32 s96, s96, s72
    s_mul_i32 s96, s96, 688
    v_add_u32 v21, s96, v1
    v_min_u32 v21, 32752, v21
    s_add_u32 s97, s3, 819200
    v_mov_b32 v28, -1
    v_mov_b32 v29, -1
    v_mov_b32 v30, -1
    v_mov_b32 v31, -1
    buffer_store_dwordx4 v[28:31], v21, s[8:11], s97 offen
    s_cmp_eq_u32 s10, 0
    s_cbranch_scc1 SLOW22
BACK22:
    s_add_u32 s77, s3, 1638400
    buffer_store_dword v7, v10, s[8:11], s77 offen
    s_cmp_eq_u32 s10, 0
    s_cbranch_scc1 SLOW23
BACK23:
    v_lshrrev_b32 v38, 3, v0
    v_mul_u32_u24 v38, 3072, v38
    v_and_b32 v39, 7, v0
    v_lshl_add_u32 v38, v39, 4, v38
    v_bfe_u32 v39, v0, 4, 1
    v_lshlrev_b32 v39, 5, v39
    v_xor_b32 v38, v38, v39
    v_xor_b32 v39, 64, v38
    s_mov_b32 m0, s67
    s_add_u32 s67, s67, 1024
    buffer_load_dwordx4 v38, s[36:39], s66 offen nt lds
    s_add_u32 s66, s66, 24576
    s_mov_b32 m0, s67
    s_add_u32 s67, s67, 1024
    buffer_load_dwordx4 v39, s[36:39], s66 offen nt lds
    s_add_u32 s66, s66, 24576
    s_mov_b32 m0, s67
    s_add_u32 s67, s67, 1024
    buffer_load_dwordx4 v38, s[36:39], s66 offen nt lds
    s_add_u32 s66, s66, 24576
    s_mov_b32 m0, s67
    s_add_u32 s67, s67, 1024
    buffer_load_dwordx4 v39, s[36:39], s66 offen nt lds
    s_add_u32 s66, s66, 24576
    s_mov_b32 m0, s67
    s_add_u32 s67, s67, 1024
    buffer_load_dwordx4 v38, s[36:39], s66 offen nt lds
    s_add_u32 s66, s66, 24576
    s_mov_b32 m0, s67
    s_add_u32 s67, s67, 1024
    buffer_load_dwordx4 v39, s[36:39], s66 offen nt lds
    s_add_u32 s66, s66, 24576
    s_mov_b32 m0, s67
    s_add_u32 s67, s67, 1024
    buffer_load_dwordx4 v38, s[36:39], s66 offen nt lds
    s_add_u32 s66, s66, 24576
    s_mov_b32 m0, s67
    s_add_u32 s67, s67, 1024
    buffer_load_dwordx4 v39, s[36:39], s66 offen nt lds
    s_add_u32 s66, s66, 24576
FW:
    s_lshl_b32 s77, s72, 5
    v_lshl_add_u32 v80, v36, 3, s77
    v_lshrrev_b32 v37, 1, v27
    v_and_b32 v38, 1, v26
    v_lshl_add_u32 v37, v38, 1, v37
    v_lshlrev_b32 v37, 5, v37
    v_xor_b32 v80, v80, v37
    v_lshl_add_u32 v37, v26, 3, v27
    v_lshl_add_u32 v80, v37, 7, v80
    v_add_u32 v80, 57344, v80
    s_sub_u32 s79, s69, 20
    s_and_b32 s7, s79, 12
    s_add_u32 s7, s7, s72
    s_lshl_b32 s78, s7, 8
    v_lshl_add_u32 v83, v25, 4, s78
    v_lshrrev_b32 v84, 1, v83
    v_mov_b32 v37, 1536
    v_cmp_le_u32 vcc, 2, v26
    s_nop 1
    v_cndmask_b32 v84, v84, v37, vcc
    v_and_b32 v37, 1, v26
    v_mul_u32_u24 v37, 4, v37
    v_add_u32 v84, v84, v37
    s_cmp_eq_u32 s7, 0
    s_mov_b32 s52, -1
    s_cselect_b32 s53, 0x10001, 0
    s_and_b32 s79, s79, 3
    s_mul_i32 s78, s79, 1788
    s_sub_u32 s78, 7168, s78
    v_add_u32 v83, s78, v83
    s_mul_i32 s78, s79, 1792
    s_add_u32 s78, s78, s3
    s_add_u32 s78, s78, 50432
    s_mul_i32 s79, s79, 320
    v_cmp_eq_u32 vcc, 12, v25
    v_mov_b32 v38, 0x3f803f80
    s_nop 0
    v_cndmask_b32 v88, 0, v38, vcc
    v_mov_b32 v89, v88
    v_mov_b32 v90, v88
    v_mov_b32 v91, v88
    v_mov_b32 v92, v88
    v_mov_b32 v93, v88
    v_mov_b32 v94, v88
    v_mov_b32 v95, v88
    v_mov_b32 v96, v88
    v_mov_b32 v97, v88
    v_mov_b32 v98, v88
    v_mov_b32 v99, v88
    v_mov_b32 v100, v88
    v_mov_b32 v101, v88
    v_mov_b32 v102, v88
    v_mov_b32 v103, v88
    v_mov_b32 v104, v88
    v_mov_b32 v105, v88
    v_mov_b32 v106, v88
    v_mov_b32 v107, v88
    v_mul_u32_u24 v6, 336, v25
    v_lshl_add_u32 v6, v26, 4, v6
    s_mul_i32 s77, s72, 45
    v_min_u32 v27, 44, v0
    v_add_u32 v27, s77, v27
    v_mul_u32_u24 v37, 205, v27
    v_lshrrev_b32 v37, 12, v37
    v_add_u32 v87, v37, v27
    v_lshlrev_b32 v87, 4, v87
    v_mul_u32_u24 v38, 20, v37
    v_sub_u32 v27, v27, v38
    v_lshlrev_b32 v27, 4, v27
    s_mul_i32 s7, s68, 10240
    s_cmp_eq_u32 s74, 0
    s_cselect_b32 s7, 0, s7
    s_add_u32 s7, s7, 655360
    v_mul_u32_u24 v86, 1280, v37
    v_add_u32 v86, s7, v86
    s_mul_i32 s7, s68, 81920
    s_add_u32 s7, s7, 45312
    v_mov_b32 v38, s7
    v_cmp_eq_u32 vcc, s68, v37
    s_nop 1
    v_cndmask_b32 v86, v86, v38, vcc
    v_add_u32 v38, 2560, v38
    v_cmp_le_u32 vcc, 8, v37
    s_nop 1
    v_cndmask_b32 v86, v86, v38, vcc
    v_add_u32 v86, v86, v27
    s_add_u32 s77, s79, s74
    s_add_u32 s79, s79, s3
    s_add_u32 s79, s79, 45312
    s_cmp_lg_u32 s74, 0
    s_cbranch_scc1 FW1
    s_waitcnt vmcnt(0)
    s_barrier
FW1:
    s_mov_b32 exec_lo, 0xfffff
    s_mov_b32 exec_hi, 0x0
    s_mov_b32 s76, 1
    buffer_load_dword v36, v1, s[16:19], s79 offen sc1
    s_mov_b64 exec, -1
    ds_read_b64_tr_b16 v[40:41], v80 offset:0
    ds_read_b64_tr_b16 v[42:43], v80 offset:512
    ds_read_b64_tr_b16 v[44:45], v80 offset:4096
    ds_read_b64_tr_b16 v[46:47], v80 offset:4608
    ds_read_b64_tr_b16 v[48:49], v80 offset:8192
    ds_read_b64_tr_b16 v[50:51], v80 offset:8704
    ds_read_b64_tr_b16 v[52:53], v80 offset:12288
    ds_read_b64_tr_b16 v[54:55], v80 offset:12800
    ds_read_b64_tr_b16 v[56:57], v80 offset:16384
    ds_read_b64_tr_b16 v[58:59], v80 offset:16896
    ds_read_b64_tr_b16 v[60:61], v80 offset:20480
    ds_read_b64_tr_b16 v[62:63], v80 offset:20992
    ds_read_b64_tr_b16 v[64:65], v80 offset:24576
    ds_read_b64_tr_b16 v[66:67], v80 offset:25088
    ds_read_b64_tr_b16 v[68:69], v80 offset:28672
    ds_read_b64_tr_b16 v[70:71], v80 offset:29184
    ds_read_b64_tr_b16 v[72:73], v80 offset:32768
    ds_read_b64_tr_b16 v[74:75], v80 offset:33280
    ds_read_b64_tr_b16 v[76:77], v80 offset:36864
    ds_read_b64_tr_b16 v[78:79], v80 offset:37376
    s_mov_b32 exec_lo, 0xfffff
    s_mov_b32 exec_hi, 0x0
    s_branch POLLW24
POLL24:
    buffer_load_dword v36, v1, s[16:19], s79 offen sc1
POLLW24:
    s_waitcnt vmcnt(0)
    v_cmp_eq_u32 vcc, -1, v36
    s_cbranch_vccnz AGAIN24
POLLX24:
    s_mov_b64 exec, s[86:87]
    buffer_load_dwordx4 v[24:27], v86, s[16:19], s77 offen sc1
    s_cmp_eq_u32 s74, 0
    s_cbranch_scc1 CSP
    s_waitcnt vmcnt(0)
CSB:
    s_waitcnt vmcnt(2)
BW25:
    ds_write_b128 v87, v[24:27]
    v_cmp_eq_u32 vcc, -1, v24
    s_cbranch_vccnz BR25
BX25:
    s_mov_b64 exec, s[84:85]
    s_waitcnt lgkmcnt(0)
    s_barrier
    ds_read_b128 v[88:91], v6 offset:0
    ds_read_b128 v[92:95], v6 offset:64
    ds_read_b128 v[96:99], v6 offset:128
    ds_read_b128 v[100:103], v6 offset:192
    ds_read_b128 v[104:107], v6 offset:256
    s_mov_b64 exec, -1
    s_waitcnt lgkmcnt(4)
    v_mfma_f32_16x16x32_bf16 v[32:35], v[88:91], v[88:91], 0
    s_waitcnt lgkmcnt(3)
    v_mfma_f32_16x16x32_bf16 v[32:35], v[92:95], v[92:95], v[32:35]
    s_waitcnt lgkmcnt(2)
    v_mfma_f32_16x16x32_bf16 v[32:35], v[96:99], v[96:99], v[32:35]
    s_waitcnt lgkmcnt(1)
    v_mfma_f32_16x16x32_bf16 v[32:35], v[100:103], v[100:103], v[32:35]
    s_waitcnt lgkmcnt(0)
    v_mfma_f32_16x16x32_bf16 v[32:35], v[104:107], v[104:107], v[32:35]
    v_mfma_f32_16x16x32_bf16 v[24:27], v[88:91], v[40:43], 0
    v_mov_b32 v36, 0
    v_mov_b32 v37, 0
    v_mfma_f32_16x16x32_bf16 v[24:27], v[92:95], v[44:47], v[24:27]
    v_mov_b32 v38, 0
    s_nop 0
    v_mfma_f32_16x16x32_bf16 v[24:27], v[96:99], v[48:51], v[24:27]
    v_mfma_f32_16x16x32_bf16 v[24:27], v[100:103], v[52:55], v[24:27]
    v_add_f32 v32, v32, v33
    v_add_f32 v34, v34, v35
    v_mfma_f32_16x16x32_bf16 v[24:27], v[104:107], v[56:59], v[24:27]
    v_mfma_f32_16x16x32_bf16 v[28:31], v[88:91], v[60:63], 0
    v_add_f32_dpp v36, v32, v34 quad_perm:[0,1,2,3] row_mask:0xf bank_mask:0x7
    v_mfma_f32_16x16x32_bf16 v[28:31], v[92:95], v[64:67], v[28:31]
    s_nop 0
    v_add_f32_dpp v36, v36, v36 row_ror:8 row_mask:0xf bank_mask:0xf
    v_mfma_f32_16x16x32_bf16 v[28:31], v[96:99], v[68:71], v[28:31]
    s_nop 0
    v_add_f32_dpp v36, v36, v36 row_ror:4 row_mask:0xf bank_mask:0xf
    v_mfma_f32_16x16x32_bf16 v[28:31], v[100:103], v[72:75], v[28:31]
    s_nop 0
    v_add_f32_dpp v36, v36, v36 row_ror:2 row_mask:0xf bank_mask:0xf
    v_mfma_f32_16x16x32_bf16 v[28:31], v[104:107], v[76:79], v[28:31]
    v_add_f32 v25, v24, v25
    v_add_f32_dpp v37, v36, v36 row_ror:1 row_mask:0x7 bank_mask:0xf
    v_add_f32_dpp v38, v36, v36 row_ror:1 row_mask:0x8 bank_mask:0xf
    v_add_f32 v26, v26, v27
    v_add_f32 v25, v25, v26
    s_nop 1
    v_permlane32_swap_b32 v25, v37
    v_add_f32 v29, v28, v29
    v_add_f32 v30, v30, v31
    v_add_f32 v29, v29, v30
    v_add_f32 v25, v25, v37
    s_nop 0
    v_permlane32_swap_b32 v29, v38
    v_add_f32 v29, v29, v38
    s_nop 1
    v_permlane16_swap_b32 v25, v29
    s_mov_b64 exec, s[52:53]
    v_add_f32 v25, v25, v29
    buffer_store_dword v25, v84, s[8:11], s78 offen
    s_cmp_eq_u32 s10, 0
    s_cbranch_scc1 SLOW26
BACK26:
    s_mov_b64 exec, -1
NEXT:
    s_cmp_lg_u32 s74, 0
    s_cbranch_scc1 DONE
    s_mov_b32 s74, 819200
    s_add_u32 s3, s3, 819200
    s_add_u32 s80, s80, 819200
    s_add_u32 s81, s81, 819200
    s_mov_b64 s[46:47], s[44:45]
    s_mov_b64 s[48:49], s[92:93]
    s_branch LOOP
AGAIN24:
    s_add_u32 s76, s76, 1
    s_cmp_lt_u32 s76, 32768
    s_cbranch_scc1 POLL24
    s_branch POLLX24
CSP:
    s_mov_b64 exec, -1
    s_waitcnt lgkmcnt(0)
    v_mfma_f32_16x16x32_bf16 v[108:111], v[88:91], v[40:43], 0
    v_mfma_f32_16x16x32_bf16 v[2:5], v[88:91], v[60:63], 0
    v_mfma_f32_16x16x32_bf16 v[108:111], v[92:95], v[44:47], v[108:111]
    v_mfma_f32_16x16x32_bf16 v[2:5], v[92:95], v[64:67], v[2:5]
    v_mfma_f32_16x16x32_bf16 v[108:111], v[96:99], v[48:51], v[108:111]
    v_mfma_f32_16x16x32_bf16 v[2:5], v[96:99], v[68:71], v[2:5]
    v_mfma_f32_16x16x32_bf16 v[108:111], v[100:103], v[52:55], v[108:111]
    v_mfma_f32_16x16x32_bf16 v[2:5], v[100:103], v[72:75], v[2:5]
    v_mfma_f32_16x16x32_bf16 v[108:111], v[104:107], v[56:59], v[108:111]
    v_mfma_f32_16x16x32_bf16 v[2:5], v[104:107], v[76:79], v[2:5]
    s_mov_b32 exec_lo, 0x0
    s_mov_b32 exec_hi, 0xffff0000
    s_nop 4
    buffer_store_dword v108, v83, s[8:11], s78 offen
    s_cmp_eq_u32 s10, 0
    s_cbranch_scc1 SLOW27
BACK27:
    buffer_store_dword v2, v83, s[8:11], s78 offen offset:3072
    s_cmp_eq_u32 s10, 0
    s_cbranch_scc1 SLOW28
BACK28:
    s_mov_b64 exec, s[86:87]
    s_branch CSB
BR25:
    s_cmp_ge_u32 s76, 32768
    s_cbranch_scc1 BX25
    s_mov_b64 exec, vcc
    buffer_load_dwordx4 v[24:27], v86, s[16:19], s77 offen sc1
    s_add_u32 s76, s76, 1
    s_waitcnt vmcnt(0)
    s_branch BW25
DONE:
    s_endpgm
TAGLOOP:
    s_mov_b32 s76, 0
TAGL2:
    s_sleep 8
    global_load_dword v98, v100, s[64:65] sc1
    s_waitcnt vmcnt(0)
    v_readfirstlane_b32 s96, v98
    s_nop 0
    s_cmp_lg_u32 s96, 0
    s_cbranch_scc1 TAGOK
    s_add_u32 s76, s76, 1
    s_cmp_lt_u32 s76, 32768
    s_cbranch_scc1 TAGL2
    s_branch TAGOK
DMAF:
    s_sub_u32 s78, s69, 20
    s_and_b32 s66, s78, 3
    s_lshl_b32 s66, s66, 1
    s_and_b32 s79, s72, 1
    s_add_u32 s66, s66, s79
    s_mul_i32 s66, s66, 245760
    s_lshr_b32 s78, s78, 2
    s_lshl_b32 s78, s78, 7
    s_add_u32 s66, s66, s78
    s_mul_i32 s78, s68, 384
    s_add_u32 s66, s66, s78
    s_mul_i32 s67, s72, 10240
    s_add_u32 s67, s67, 57344
    s_branch DMAX
RDYLOOP:
    s_mov_b32 s76, 0
RDYL2:
    s_sleep 8
    buffer_load_dwordx2 v[98:99], v100, s[16:19], 0 offen offset:384 sc1
    s_waitcnt vmcnt(0)
    v_cmp_ne_u32 vcc, s96, v98
    s_cbranch_vccz RDYOK
    s_add_u32 s76, s76, 1
    s_cmp_lt_u32 s76, 32768
    s_cbranch_scc1 RDYL2
    s_branch RDYOK
SLOW1:
    buffer_store_dwordx4 v[28:31], v27, s[16:19], s77 offen sc1
    s_branch BACK1
SLOW2:
    buffer_store_dwordx4 v[24:27], v106, s[16:19], 0 offen sc1
    s_branch BACK2
SLOW5:
    buffer_store_dword v24, v10, s[16:19], s3 offen sc1
    s_branch BACK5
SLOW7:
    buffer_store_dwordx4 v[28:31], v26, s[16:19], s77 offen sc1
    s_branch BACK7
RETRY8:
    s_mov_b32 s76, 1
POLL29:
    buffer_load_dword v28, v20, s[16:19], 0 offen sc1
    buffer_load_dword v29, v21, s[16:19], 0 offen sc1
POLLW29:
    s_waitcnt vmcnt(0)
    v_max_u32 v30, v28, v29
    v_cmp_eq_u32 vcc, -1, v30
    s_cbranch_vccnz AGAIN29
POLLX29:
    s_branch OK8
AGAIN29:
    s_add_u32 s76, s76, 1
    s_cmp_lt_u32 s76, 32768
    s_cbranch_scc1 POLL29
    s_branch POLLX29
SLOW9:
    buffer_store_dwordx4 v[28:31], v32, s[16:19], s77 offen sc1
    s_branch BACK9
SLOW11:
    buffer_store_dwordx4 v[28:31], v18, s[16:19], s81 offen sc1
    s_branch BACK11
SLOW12:
    buffer_store_dwordx4 v[28:31], v18, s[16:19], s97 offen sc1
    s_branch BACK12
SLOW13:
    buffer_store_dwordx2 v[34:35], v1, s[16:19], s78 offen sc1
    s_branch BACK13
SLOW14:
    buffer_store_dword v7, v10, s[16:19], s77 offen sc1
    s_branch BACK14
SLOW15:
    buffer_store_dwordx4 v[104:107], v100, s[16:19], s78 offen sc1
    s_branch BACK15
SLOW16:
    buffer_store_dwordx4 v[104:107], v101, s[16:19], s78 offen sc1
    s_branch BACK16
RETRY18:
    s_mov_b32 s76, 1
POLL30:
    buffer_load_dword v28, v100, s[16:19], 0 offen sc1
    buffer_load_dword v29, v101, s[16:19], 0 offen sc1
POLLW30:
    s_waitcnt vmcnt(0)
    v_max_u32 v30, v28, v29
    v_cmp_eq_u32 vcc, -1, v30
    s_cbranch_vccnz AGAIN30
POLLX30:
    s_branch OK18
AGAIN30:
    s_add_u32 s76, s76, 1
    s_cmp_lt_u32 s76, 32768
    s_cbranch_scc1 POLL30
    s_branch POLLX30
SLOW19:
    buffer_store_dwordx4 v[28:31], v32, s[16:19], s77 offen sc1
    s_branch BACK19
SLOW22:
    buffer_store_dwordx4 v[28:31], v21, s[16:19], s97 offen sc1
    s_branch BACK22
SLOW23:
    buffer_store_dword v7, v10, s[16:19], s77 offen sc1
    s_branch BACK23
SLOW26:
    buffer_store_dword v25, v84, s[16:19], s78 offen sc1
    s_branch BACK26
SLOW27:
    buffer_store_dword v108, v83, s[16:19], s78 offen sc1
    s_branch BACK27
SLOW28:
    buffer_store_dword v2, v83, s[16:19], s78 offen offset:3072 sc1
    s_branch BACK28
CODE_END:
    s_endpgm
.section .rodata,"a"
.p2align 6
.amdhsa_kernel interleave_layers__sliding_block_cached__glu_gated_swiglu__decode_kernel
  .amdhsa_next_free_vgpr 512
  .amdhsa_next_free_sgpr 102
  .amdhsa_accum_offset 256
  .amdhsa_group_segment_fixed_size 0
  .amdhsa_kernarg_size 96
  .amdhsa_user_sgpr_count 2
  .amdhsa_user_sgpr_kernarg_segment_ptr 1
  .amdhsa_system_sgpr_workgroup_id_x 1
.end_amdhsa_kernel
```
